```python
import torch

def _softmax(x, axis=-1):
    return torch.softmax(x, dim=axis)

def _gelu(x):
    return torch.nn.functional.gelu(x, approximate='tanh')

def _silu(x):
    return torch.nn.functional.silu(x)

def _sigmoid(x):
    return torch.sigmoid(x)

def _layernorm(x, axis=-1, eps=1e-05):
    m = x.mean(dim=axis, keepdim=True)
    v = x.var(dim=axis, keepdim=True, unbiased=False)
    return (x - m) / torch.sqrt(v + eps)

def _scatter_add(tgt, idx, src, axis=0):
    return tgt.clone().index_add_(axis, idx, src)

def _segment_sum(src, seg, n):
    out = torch.zeros((n,) + src.shape[1:], dtype=src.dtype)
    return out.index_add_(0, seg, src)

def _pad(x, pw):
    flat = tuple((v for pair in reversed(pw) for v in pair))
    return torch.nn.functional.pad(x, flat)
kernel_name = 'parallel_sum__memory_aug_recurrent_mem_tr__glu_gated_glu__prompt'

def setup_inputs():

    _w = lambda a: (lambda t: t.to(torch.bfloat16) if t.is_floating_point() else t)(torch.as_tensor(a))

    def _A_setup():
        B, S, Dm = (1, 2048, 640)
        H, Dh = (32, 192)
        M, seg = (8, 32)
        seg = min(seg, S)
        S = S // seg * seg
        return {'x': _w((lambda *s: torch.randn(*s, dtype=torch.bfloat16) * 0.05)(B, S, Dm)), 'mem0': _w((lambda *s: torch.randn(*s, dtype=torch.bfloat16) * 1.6)(B, M, Dm)), 'Wq': _w((lambda *s: torch.randn(*s, dtype=torch.bfloat16) * 0.8)(Dm, H, Dh) * Dm ** (-0.5)), 'Wk': _w((lambda *s: torch.randn(*s, dtype=torch.bfloat16) * 0.8)(Dm, H, Dh) * Dm ** (-0.5)), 'Wv': _w((lambda *s: torch.randn(*s, dtype=torch.bfloat16) * 1.6)(Dm, H, Dh) * Dm ** (-0.5)), 'Wo': _w((lambda *s: torch.randn(*s, dtype=torch.bfloat16) * 1.6)(H, Dh, Dm) * (H * Dh) ** (-0.5)), 'seg_len': seg}
    _A_in = _A_setup()

    def _B_setup():
        B, S, D, F = (1, 2048, 640, 1536)
        return {'x': _w((lambda *s: torch.randn(*s, dtype=torch.bfloat16) * 0.05)(B, S, D)), 'w_gate': _w((lambda *s: torch.randn(*s, dtype=torch.bfloat16) * 0.05)(D, F)), 'w_up': _w((lambda *s: torch.randn(*s, dtype=torch.bfloat16) * 0.05)(D, F)), 'w_down': _w((lambda *s: torch.randn(*s, dtype=torch.bfloat16) * 0.05)(F, D))}
    _B_in = _B_setup()
    return {'A_x': _A_in['x'], 'A_mem0': _A_in['mem0'], 'A_Wq': _A_in['Wq'], 'A_Wk': _A_in['Wk'], 'A_Wv': _A_in['Wv'], 'A_Wo': _A_in['Wo'], 'A_seg_len': _A_in['seg_len'], 'B_x': _B_in['x'], 'B_w_gate': _B_in['w_gate'], 'B_w_up': _B_in['w_up'], 'B_w_down': _B_in['w_down']}

def reference(A_x, A_mem0, A_Wq, A_Wk, A_Wv, A_Wo, A_seg_len, B_x, B_w_gate, B_w_up, B_w_down):

    def _A_ref(x, mem0, Wq, Wk, Wv, Wo, seg_len):
        B, S, Dm = x.shape
        H, Dh = (Wq.shape[1], Wq.shape[2])
        M = mem0.shape[1]
        scale = Dh ** (-0.5)
        n_seg = S // seg_len
        L = M + seg_len
        idx = torch.arange(L)
        mask = (idx[:, None] < M) | (idx[:, None] >= idx[None, :])
        mem = mem0
        outs = []
        for s in range(n_seg):
            xs = x[:, s * seg_len:(s + 1) * seg_len, :].clone()
            h = torch.concatenate([mem, xs], axis=1)
            q = torch.einsum('btd,dhe->bhte', h, Wq)
            k = torch.einsum('btd,dhe->bhte', h, Wk)
            v = torch.einsum('btd,dhe->bhte', h, Wv)
            scores = torch.einsum('bhqe,bhke->bhqk', q, k) * scale
            scores = torch.where(mask[None, None], scores, -1000000000.0)
            p = _softmax(scores, axis=-1)
            o = torch.einsum('bhqk,bhke->bhqe', p, v)
            o = torch.einsum('bhte,hed->btd', o, Wo)
            mem = o[:, :M, :].clone()
            outs.append(o[:, M:, :])
        return torch.concatenate(outs, axis=1)

    def _B_ref(x, w_gate, w_up, w_down):
        g = torch.einsum('bsd,df->bsf', x, w_gate)
        u = torch.einsum('bsd,df->bsf', x, w_up)
        h = _sigmoid(g) * u
        return torch.einsum('bsf,fd->bsd', h, w_down)
    x = A_x
    xn = _layernorm(x, axis=-1)
    return x + _A_ref(xn, A_mem0, A_Wq, A_Wk, A_Wv, A_Wo, A_seg_len) + _B_ref(xn, B_w_gate, B_w_up, B_w_down)
```

```asm
; @launch grid=(256,1,1) block=(256,1,1) lds=163840
.amdgcn_target "amdgcn-amd-amdhsa--gfx950"
.text
.globl parallel_sum__memory_aug_recurrent_mem_tr__glu_gated_glu__prompt_kernel
.p2align 8
.type parallel_sum__memory_aug_recurrent_mem_tr__glu_gated_glu__prompt_kernel,@function
parallel_sum__memory_aug_recurrent_mem_tr__glu_gated_glu__prompt_kernel:
 s_cmp_ge_u32 s2, 256
 s_cbranch_scc1 main_end0
 s_load_dwordx4 s[4:7], s[0:1], 96
 s_getreg_b32 s80, hwreg(HW_REG_XCC_ID, 0, 3)
 v_lshrrev_b32 v1, 6, v0
 s_nop 0
 v_readfirstlane_b32 s14, v1
 s_waitcnt lgkmcnt(0)
 s_mov_b64 s[90:91], s[4:5]
 s_mov_b32 s8, s6
 s_and_b32 s9, s7, 0xffff
 s_mov_b32 s10, 0x10000000
 s_mov_b32 s11, 0x20000
 v_mov_b32 v60, 0
 v_mov_b32 v61, 1
 s_or_b32 s28, s2, s14
 s_cbranch_scc1 tk_skip
 v_lshlrev_b32 v2, 4, v0
 v_mov_b32 v4, 0
 v_mov_b32 v5, 0
 v_mov_b32 v6, 0
 v_mov_b32 v7, 0
 s_mov_b32 s28, 6361088
 buffer_store_dwordx4 v[4:7], v2, s[8:11], s28 offen sc1
 s_waitcnt vmcnt(0)
 global_store_dword v60, v61, s[90:91] sc1
tk_skip:
 s_cmp_eq_u32 s14, 1
 s_cbranch_scc0 wm_skip
 s_load_dwordx8 s[64:71], s[0:1], 16
 v_and_b32 v2, 63, v0
 s_getpc_b64 s[28:29]
 s_lshr_b32 s24, s2, 3
 s_min_u32 s24, s24, 13
 s_lshl_b32 s24, s24, 13
 s_add_u32 s28, s28, s24
 s_addc_u32 s29, s29, 0
 v_lshlrev_b32 v4, 7, v2
 v_mov_b32 v5, s29
 v_add_co_u32 v4, vcc, s28, v4
 s_nop 1
 v_addc_co_u32 v5, vcc, 0, v5, vcc
 global_load_dword v52, v[4:5], off
 v_min_u32 v3, 59, v2
 v_lshlrev_b32 v3, 17, v3
 s_waitcnt lgkmcnt(0)
 global_load_dword v53, v3, s[64:65]
 global_load_dword v54, v3, s[66:67]
 global_load_dword v55, v3, s[68:69]
 global_load_dword v56, v3, s[70:71]
wm_skip:
 s_load_dwordx4 s[4:7], s[0:1], 0
 s_waitcnt lgkmcnt(0)
 s_mov_b32 s16, s4
 s_and_b32 s17, s5, 0xffff
 s_mov_b32 s18, 0x280000
 s_mov_b32 s19, 0x20000
 s_mov_b32 s20, s6
 s_and_b32 s21, s7, 0xffff
 s_mov_b32 s22, 0x2800
 s_mov_b32 s23, 0x20000
 s_sub_u32 s24, s2, 16
 s_cmp_lt_u32 s24, 32
 s_cbranch_scc0 init_np
 s_cmp_eq_u32 s14, 2
 s_cbranch_scc0 init_np
 s_lshl_b32 s25, s24, 13
 s_add_u32 s25, s25, 180355072
 s_bfe_u32 s26, s24, 0x20002
 s_cmp_eq_u32 s26, 0
 s_cselect_b32 s26, 0, -1
 v_mov_b32 v2, 0x1f80
 v_mov_b32 v4, s26
 s_mov_b32 s30, -1
 s_mov_b64 exec, 1
 buffer_store_dword v4, v2, s[8:11], s25 offen sc1
 s_waitcnt vmcnt(0)
 s_memtime s[26:27]
 s_waitcnt lgkmcnt(0)
 buffer_load_dword v3, v2, s[8:11], s25 offen sc1
 s_waitcnt vmcnt(0)
 s_memtime s[28:29]
 s_waitcnt lgkmcnt(0)
 s_sub_u32 s26, s28, s26
 s_min_u32 s30, s30, s26
 buffer_store_dword v4, v2, s[8:11], s25 offen sc1
 s_waitcnt vmcnt(0)
 s_memtime s[26:27]
 s_waitcnt lgkmcnt(0)
 buffer_load_dword v3, v2, s[8:11], s25 offen sc1
 s_waitcnt vmcnt(0)
 s_memtime s[28:29]
 s_waitcnt lgkmcnt(0)
 s_sub_u32 s26, s28, s26
 s_min_u32 s30, s30, s26
 s_getreg_b32 s26, hwreg(HW_REG_XCC_ID, 2, 1)
 s_sub_u32 s27, 1060, s30
 s_cmp_eq_u32 s26, 1
 s_cselect_b32 s30, s27, s30
 s_lshl_b32 s24, s24, 2
 s_add_u32 s24, s24, 6356992
 v_mov_b32 v2, 0
 v_mov_b32 v3, s30
 buffer_store_dword v3, v2, s[8:11], s24 offen sc1
 s_mov_b64 exec, -1
init_np:
 v_and_b32 v2, 31, v0
 v_lshrrev_b32 v3, 5, v0
 s_lshl_b32 s3, s2, 3
 v_add_u32 v3, s3, v3
 v_mul_u32_u24 v4, 1280, v3
 v_lshl_add_u32 v4, v2, 3, v4
 buffer_load_dwordx2 v[10:11], v4, s[16:19], 0 offen offset:0
 buffer_load_dwordx2 v[12:13], v4, s[16:19], 0 offen offset:256
 buffer_load_dwordx2 v[14:15], v4, s[16:19], 0 offen offset:512
 buffer_load_dwordx2 v[16:17], v4, s[16:19], 0 offen offset:768
 buffer_load_dwordx2 v[18:19], v4, s[16:19], 0 offen offset:1024
 s_cmp_eq_u32 s14, 3
 s_cbranch_scc1 init_ln
 v_lshlrev_b32 v5, 4, v0
 v_mov_b32 v40, -1
 v_mov_b32 v41, -1
 v_mov_b32 v42, -1
 v_mov_b32 v43, -1
 v_min_u32 v6, 2544, v5
 s_lshr_b32 s24, s2, 7
 s_lshl_b32 s24, s24, 20
 s_bfe_u32 s25, s2, 0x10006
 s_lshl_b32 s25, s25, 18
 s_add_u32 s24, s24, s25
 s_and_b32 s25, s2, 63
 s_mul_i32 s25, s25, 2560
 s_add_u32 s24, s24, s25
 s_add_u32 s24, s24, 4194304
 buffer_store_dwordx4 v[40:43], v6, s[8:11], s24 offen sc1
 s_sub_u32 s24, s2, 64
 s_cmp_lt_u32 s24, 24
 s_cbranch_scc0 init_p0
 s_and_b32 s25, s24, 3
 s_mul_i32 s25, s25, 2560
 s_bfe_u32 s26, s24, 0x10002
 s_lshl_b32 s26, s26, 16
 s_add_u32 s25, s25, s26
 s_lshr_b32 s24, s24, 3
 s_mov_b32 s26, 3407872
 s_cmp_eq_u32 s24, 0
 s_cselect_b32 s26, 3162112, s26
 s_cmp_eq_u32 s24, 2
 s_cselect_b32 s26, 3424256, s26
 s_add_u32 s25, s25, s26
 buffer_store_dwordx4 v[40:43], v6, s[8:11], s25 offen sc1
init_p0:
 s_bitcmp1_b32 s2, 6
 s_cbranch_scc1 init_p1
 s_bfe_u32 s25, s2, 0x20005
 s_cmp_eq_u32 s25, 0
 s_cselect_b32 s25, 0, -1
 v_mov_b32 v44, s25
 v_mov_b32 v45, s25
 v_mov_b32 v46, s25
 v_mov_b32 v47, s25
 s_lshl_b32 s24, s2, 10
 s_add_u32 s24, s24, 180355072
 v_and_b32 v6, 0x3ff, v5
 buffer_store_dwordx4 v[44:47], v6, s[8:11], s24 offen sc1
 s_nop 1
init_p1:
 s_cmp_ge_u32 s2, 8
 s_cbranch_scc1 init_ln
 v_mov_b32 v44, 0
 v_mov_b32 v45, 0
 v_mov_b32 v46, 0
 v_mov_b32 v47, 0
 s_cmp_ge_u32 s2, 4
 s_cbranch_scc1 init_fl
 s_lshl_b32 s24, s2, 16
 s_add_u32 s24, s24, 3145728
 v_add_u32 v6, 0, v0
 v_min_u32 v6, 639, v6
 v_and_b32 v7, 7, v6
 v_lshrrev_b32 v8, 3, v6
 v_mul_u32_u24 v7, 1280, v7
 v_lshl_add_u32 v7, v8, 4, v7
 v_lshlrev_b32 v6, 4, v6
 s_cmp_ge_u32 s2, 2
 s_cbranch_scc1 init_z0
 buffer_load_dwordx4 v[44:47], v7, s[20:23], 0 offen
 s_waitcnt vmcnt(0)
init_z0:
 buffer_store_dwordx4 v[44:47], v6, s[8:11], s24 offen sc1
 s_nop 1
 v_add_u32 v6, 192, v0
 v_min_u32 v6, 639, v6
 v_and_b32 v7, 7, v6
 v_lshrrev_b32 v8, 3, v6
 v_mul_u32_u24 v7, 1280, v7
 v_lshl_add_u32 v7, v8, 4, v7
 v_lshlrev_b32 v6, 4, v6
 s_cmp_ge_u32 s2, 2
 s_cbranch_scc1 init_z1
 buffer_load_dwordx4 v[44:47], v7, s[20:23], 0 offen
 s_waitcnt vmcnt(0)
init_z1:
 buffer_store_dwordx4 v[44:47], v6, s[8:11], s24 offen sc1
 s_nop 1
 v_add_u32 v6, 384, v0
 v_min_u32 v6, 639, v6
 v_and_b32 v7, 7, v6
 v_lshrrev_b32 v8, 3, v6
 v_mul_u32_u24 v7, 1280, v7
 v_lshl_add_u32 v7, v8, 4, v7
 v_lshlrev_b32 v6, 4, v6
 s_cmp_ge_u32 s2, 2
 s_cbranch_scc1 init_z2
 buffer_load_dwordx4 v[44:47], v7, s[20:23], 0 offen
 s_waitcnt vmcnt(0)
init_z2:
 buffer_store_dwordx4 v[44:47], v6, s[8:11], s24 offen sc1
 s_nop 1
 v_add_u32 v6, 576, v0
 v_min_u32 v6, 639, v6
 v_and_b32 v7, 7, v6
 v_lshrrev_b32 v8, 3, v6
 v_mul_u32_u24 v7, 1280, v7
 v_lshl_add_u32 v7, v8, 4, v7
 v_lshlrev_b32 v6, 4, v6
 s_cmp_ge_u32 s2, 2
 s_cbranch_scc1 init_z3
 buffer_load_dwordx4 v[44:47], v7, s[20:23], 0 offen
 s_waitcnt vmcnt(0)
init_z3:
 buffer_store_dwordx4 v[44:47], v6, s[8:11], s24 offen sc1
 s_nop 1
 s_branch init_ln
init_fl:
 s_sub_u32 s24, s2, 4
 s_lshl_b32 s24, s24, 14
 s_add_u32 s24, s24, 6291456
 buffer_store_dwordx4 v[44:47], v5, s[8:11], s24 offen sc1
 s_add_u32 s24, s24, 3072
 buffer_store_dwordx4 v[44:47], v5, s[8:11], s24 offen sc1
 s_add_u32 s24, s24, 3072
 buffer_store_dwordx4 v[44:47], v5, s[8:11], s24 offen sc1
 s_add_u32 s24, s24, 3072
 buffer_store_dwordx4 v[44:47], v5, s[8:11], s24 offen sc1
 s_add_u32 s24, s24, 3072
 buffer_store_dwordx4 v[44:47], v5, s[8:11], s24 offen sc1
 s_add_u32 s24, s24, 1024
 buffer_store_dwordx4 v[44:47], v5, s[8:11], s24 offen sc1
 s_add_u32 s24, s24, 1024
init_ln:
 s_waitcnt vmcnt(0)
 v_lshlrev_b32 v20, 16, v10
 v_and_b32 v21, 0xffff0000, v10
 v_lshlrev_b32 v22, 16, v11
 v_and_b32 v23, 0xffff0000, v11
 v_lshlrev_b32 v24, 16, v12
 v_and_b32 v25, 0xffff0000, v12
 v_lshlrev_b32 v26, 16, v13
 v_and_b32 v27, 0xffff0000, v13
 v_lshlrev_b32 v28, 16, v14
 v_and_b32 v29, 0xffff0000, v14
 v_lshlrev_b32 v30, 16, v15
 v_and_b32 v31, 0xffff0000, v15
 v_lshlrev_b32 v32, 16, v16
 v_and_b32 v33, 0xffff0000, v16
 v_lshlrev_b32 v34, 16, v17
 v_and_b32 v35, 0xffff0000, v17
 v_lshlrev_b32 v36, 16, v18
 v_and_b32 v37, 0xffff0000, v18
 v_lshlrev_b32 v38, 16, v19
 v_and_b32 v39, 0xffff0000, v19
 v_add_f32 v6, v20, v21
 v_add_f32 v6, v6, v22
 v_add_f32 v6, v6, v23
 v_add_f32 v6, v6, v24
 v_add_f32 v6, v6, v25
 v_add_f32 v6, v6, v26
 v_add_f32 v6, v6, v27
 v_add_f32 v6, v6, v28
 v_add_f32 v6, v6, v29
 v_add_f32 v6, v6, v30
 v_add_f32 v6, v6, v31
 v_add_f32 v6, v6, v32
 v_add_f32 v6, v6, v33
 v_add_f32 v6, v6, v34
 v_add_f32 v6, v6, v35
 v_add_f32 v6, v6, v36
 v_add_f32 v6, v6, v37
 v_add_f32 v6, v6, v38
 v_add_f32 v6, v6, v39
 s_nop 1
 v_add_f32_dpp v6, v6, v6 row_ror:1 row_mask:0xf bank_mask:0xf
 s_nop 1
 v_add_f32_dpp v6, v6, v6 row_ror:2 row_mask:0xf bank_mask:0xf
 s_nop 1
 v_add_f32_dpp v6, v6, v6 row_ror:4 row_mask:0xf bank_mask:0xf
 s_nop 1
 v_add_f32_dpp v6, v6, v6 row_ror:8 row_mask:0xf bank_mask:0xf
 v_mov_b32 v9, v6
 s_nop 1
 v_permlane16_swap_b32 v6, v9
 s_nop 1
 v_add_f32 v6, v6, v9
 v_mul_f32 v6, 0x3acccccd, v6
 v_sub_f32 v8, v20, v6
 v_mul_f32 v7, v8, v8
 v_sub_f32 v8, v21, v6
 v_fmac_f32 v7, v8, v8
 v_sub_f32 v8, v22, v6
 v_fmac_f32 v7, v8, v8
 v_sub_f32 v8, v23, v6
 v_fmac_f32 v7, v8, v8
 v_sub_f32 v8, v24, v6
 v_fmac_f32 v7, v8, v8
 v_sub_f32 v8, v25, v6
 v_fmac_f32 v7, v8, v8
 v_sub_f32 v8, v26, v6
 v_fmac_f32 v7, v8, v8
 v_sub_f32 v8, v27, v6
 v_fmac_f32 v7, v8, v8
 v_sub_f32 v8, v28, v6
 v_fmac_f32 v7, v8, v8
 v_sub_f32 v8, v29, v6
 v_fmac_f32 v7, v8, v8
 v_sub_f32 v8, v30, v6
 v_fmac_f32 v7, v8, v8
 v_sub_f32 v8, v31, v6
 v_fmac_f32 v7, v8, v8
 v_sub_f32 v8, v32, v6
 v_fmac_f32 v7, v8, v8
 v_sub_f32 v8, v33, v6
 v_fmac_f32 v7, v8, v8
 v_sub_f32 v8, v34, v6
 v_fmac_f32 v7, v8, v8
 v_sub_f32 v8, v35, v6
 v_fmac_f32 v7, v8, v8
 v_sub_f32 v8, v36, v6
 v_fmac_f32 v7, v8, v8
 v_sub_f32 v8, v37, v6
 v_fmac_f32 v7, v8, v8
 v_sub_f32 v8, v38, v6
 v_fmac_f32 v7, v8, v8
 v_sub_f32 v8, v39, v6
 v_fmac_f32 v7, v8, v8
 s_nop 1
 v_add_f32_dpp v7, v7, v7 row_ror:1 row_mask:0xf bank_mask:0xf
 s_nop 1
 v_add_f32_dpp v7, v7, v7 row_ror:2 row_mask:0xf bank_mask:0xf
 s_nop 1
 v_add_f32_dpp v7, v7, v7 row_ror:4 row_mask:0xf bank_mask:0xf
 s_nop 1
 v_add_f32_dpp v7, v7, v7 row_ror:8 row_mask:0xf bank_mask:0xf
 v_mov_b32 v9, v7
 s_nop 1
 v_permlane16_swap_b32 v7, v9
 s_nop 1
 v_add_f32 v7, v7, v9
 v_mul_f32 v7, 0x3acccccd, v7
 v_cvt_pk_bf16_f32 v6, v6, v6
 v_and_b32 v6, 0xffff0000, v6
 v_cvt_pk_bf16_f32 v7, v7, v7
 v_and_b32 v7, 0xffff0000, v7
 v_add_f32 v7, 0x3727c5ac, v7
 v_cvt_pk_bf16_f32 v7, v7, v7
 v_and_b32 v7, 0xffff0000, v7
 v_sqrt_f32 v7, v7
 s_nop 0
 v_cvt_pk_bf16_f32 v7, v7, v7
 v_and_b32 v7, 0xffff0000, v7
 v_rcp_f32 v7, v7
 v_sub_f32 v20, v20, v6
 v_sub_f32 v21, v21, v6
 v_cvt_pk_bf16_f32 v8, v20, v21
 v_lshlrev_b32 v20, 16, v8
 v_and_b32 v21, 0xffff0000, v8
 v_mul_f32 v20, v20, v7
 v_mul_f32 v21, v21, v7
 v_cvt_pk_bf16_f32 v10, v20, v21
 v_sub_f32 v22, v22, v6
 v_sub_f32 v23, v23, v6
 v_cvt_pk_bf16_f32 v8, v22, v23
 v_lshlrev_b32 v22, 16, v8
 v_and_b32 v23, 0xffff0000, v8
 v_mul_f32 v22, v22, v7
 v_mul_f32 v23, v23, v7
 v_cvt_pk_bf16_f32 v11, v22, v23
 v_sub_f32 v24, v24, v6
 v_sub_f32 v25, v25, v6
 v_cvt_pk_bf16_f32 v8, v24, v25
 v_lshlrev_b32 v24, 16, v8
 v_and_b32 v25, 0xffff0000, v8
 v_mul_f32 v24, v24, v7
 v_mul_f32 v25, v25, v7
 v_cvt_pk_bf16_f32 v12, v24, v25
 v_sub_f32 v26, v26, v6
 v_sub_f32 v27, v27, v6
 v_cvt_pk_bf16_f32 v8, v26, v27
 v_lshlrev_b32 v26, 16, v8
 v_and_b32 v27, 0xffff0000, v8
 v_mul_f32 v26, v26, v7
 v_mul_f32 v27, v27, v7
 v_cvt_pk_bf16_f32 v13, v26, v27
 v_sub_f32 v28, v28, v6
 v_sub_f32 v29, v29, v6
 v_cvt_pk_bf16_f32 v8, v28, v29
 v_lshlrev_b32 v28, 16, v8
 v_and_b32 v29, 0xffff0000, v8
 v_mul_f32 v28, v28, v7
 v_mul_f32 v29, v29, v7
 v_cvt_pk_bf16_f32 v14, v28, v29
 v_sub_f32 v30, v30, v6
 v_sub_f32 v31, v31, v6
 v_cvt_pk_bf16_f32 v8, v30, v31
 v_lshlrev_b32 v30, 16, v8
 v_and_b32 v31, 0xffff0000, v8
 v_mul_f32 v30, v30, v7
 v_mul_f32 v31, v31, v7
 v_cvt_pk_bf16_f32 v15, v30, v31
 v_sub_f32 v32, v32, v6
 v_sub_f32 v33, v33, v6
 v_cvt_pk_bf16_f32 v8, v32, v33
 v_lshlrev_b32 v32, 16, v8
 v_and_b32 v33, 0xffff0000, v8
 v_mul_f32 v32, v32, v7
 v_mul_f32 v33, v33, v7
 v_cvt_pk_bf16_f32 v16, v32, v33
 v_sub_f32 v34, v34, v6
 v_sub_f32 v35, v35, v6
 v_cvt_pk_bf16_f32 v8, v34, v35
 v_lshlrev_b32 v34, 16, v8
 v_and_b32 v35, 0xffff0000, v8
 v_mul_f32 v34, v34, v7
 v_mul_f32 v35, v35, v7
 v_cvt_pk_bf16_f32 v17, v34, v35
 v_sub_f32 v36, v36, v6
 v_sub_f32 v37, v37, v6
 v_cvt_pk_bf16_f32 v8, v36, v37
 v_lshlrev_b32 v36, 16, v8
 v_and_b32 v37, 0xffff0000, v8
 v_mul_f32 v36, v36, v7
 v_mul_f32 v37, v37, v7
 v_cvt_pk_bf16_f32 v18, v36, v37
 v_sub_f32 v38, v38, v6
 v_sub_f32 v39, v39, v6
 v_cvt_pk_bf16_f32 v8, v38, v39
 v_lshlrev_b32 v38, 16, v8
 v_and_b32 v39, 0xffff0000, v8
 v_mul_f32 v38, v38, v7
 v_mul_f32 v39, v39, v7
 v_cvt_pk_bf16_f32 v19, v38, v39
 v_lshrrev_b32 v4, 5, v0
 v_mul_u32_u24 v4, 1296, v4
 v_lshl_add_u32 v4, v2, 3, v4
 ds_write_b64 v4, v[10:11] offset:64
 ds_write_b64 v4, v[12:13] offset:320
 ds_write_b64 v4, v[14:15] offset:576
 ds_write_b64 v4, v[16:17] offset:832
 ds_write_b64 v4, v[18:19] offset:1088
 s_lshr_b32 s24, s2, 2
 s_mul_i32 s24, s24, 40960
 s_and_b32 s25, s2, 3
 s_lshl_b32 s25, s25, 7
 s_add_u32 s24, s24, s25
 s_waitcnt lgkmcnt(0)
 s_barrier
 s_cmp_eq_u32 s14, 3
 s_cbranch_scc1 init_pf
 v_add_u32 v4, 0, v0
 v_min_u32 v4, 639, v4
 v_and_b32 v5, 7, v4
 v_lshrrev_b32 v4, 3, v4
 v_mul_u32_u24 v6, 1296, v5
 v_lshl_add_u32 v6, v4, 4, v6
 ds_read_b128 v[12:15], v6 offset:64
 v_lshlrev_b32 v4, 9, v4
 v_lshl_add_u32 v8, v5, 4, v4
 v_add_u32 v4, 192, v0
 v_min_u32 v4, 639, v4
 v_and_b32 v5, 7, v4
 v_lshrrev_b32 v4, 3, v4
 v_mul_u32_u24 v6, 1296, v5
 v_lshl_add_u32 v6, v4, 4, v6
 ds_read_b128 v[16:19], v6 offset:64
 v_lshlrev_b32 v4, 9, v4
 v_lshl_add_u32 v9, v5, 4, v4
 v_add_u32 v4, 384, v0
 v_min_u32 v4, 639, v4
 v_and_b32 v5, 7, v4
 v_lshrrev_b32 v4, 3, v4
 v_mul_u32_u24 v6, 1296, v5
 v_lshl_add_u32 v6, v4, 4, v6
 ds_read_b128 v[20:23], v6 offset:64
 v_lshlrev_b32 v4, 9, v4
 v_lshl_add_u32 v10, v5, 4, v4
 v_add_u32 v4, 576, v0
 v_min_u32 v4, 639, v4
 v_and_b32 v5, 7, v4
 v_lshrrev_b32 v4, 3, v4
 v_mul_u32_u24 v6, 1296, v5
 v_lshl_add_u32 v6, v4, 4, v6
 ds_read_b128 v[24:27], v6 offset:64
 v_lshlrev_b32 v4, 9, v4
 v_lshl_add_u32 v11, v5, 4, v4
 s_waitcnt lgkmcnt(0)
 buffer_store_dwordx4 v[12:15], v8, s[8:11], s24 offen sc1
 buffer_store_dwordx4 v[16:19], v9, s[8:11], s24 offen sc1
 buffer_store_dwordx4 v[20:23], v10, s[8:11], s24 offen sc1
 buffer_store_dwordx4 v[24:27], v11, s[8:11], s24 offen sc1
 s_waitcnt vmcnt(0)
init_pf:
 s_barrier
 s_cmp_eq_u32 s14, 0
 s_cbranch_scc0 ar_skip
 s_mov_b64 exec, 1
 s_mov_b32 s45, 400000
zr_p:
 global_load_dword v62, v60, s[90:91] sc1
 s_waitcnt vmcnt(0)
 v_cmp_ne_u32 vcc, 0, v62
 s_cbranch_vccnz zr_d
 s_sub_u32 s45, s45, 1
 s_cbranch_scc0 zr_p
zr_d:
 s_lshl_b32 s28, s80, 7
 s_add_u32 s28, s28, 6361088
 v_mov_b32 v62, 1
 buffer_atomic_add v62, v60, s[8:11], s28 offen sc0 sc1
 s_waitcnt vmcnt(0)
 v_mov_b32 v2, 0
 ds_write_b32 v2, v62
 s_waitcnt lgkmcnt(0)
 s_mov_b64 exec, -1
ar_skip:
 s_barrier
 v_mov_b32 v2, 0
 ds_read_b32 v3, v2
 s_waitcnt lgkmcnt(0)
 v_readfirstlane_b32 s81, v3
 s_barrier
 s_lshl_b32 s17, s80, 5
 s_add_u32 s17, s17, s81
 s_mov_b32 s79, 0
 s_cmp_lt_u32 s80, 2
 s_cselect_b32 s28, s81, 99
 s_cmp_lt_u32 s28, 32
 s_cbranch_scc1 role_chain
redispatch:
 v_mbcnt_lo_u32_b32 v10, -1, 0
 v_and_b32 v10, 7, v10
 v_lshlrev_b32 v10, 7, v10
 s_mov_b32 s82, 6361088
 s_cmp_eq_u32 s14, 0
 s_cbranch_scc0 cen_w
 s_mov_b32 s45, 400000
 s_mov_b64 exec, 0xff
cen_p:
 buffer_load_dword v11, v10, s[8:11], s82 offen sc1
 s_waitcnt vmcnt(0)
 s_mov_b32 s28, 0
 v_readlane_b32 s29, v11, 0
 s_add_u32 s28, s28, s29
 v_readlane_b32 s29, v11, 1
 s_add_u32 s28, s28, s29
 v_readlane_b32 s29, v11, 2
 s_add_u32 s28, s28, s29
 v_readlane_b32 s29, v11, 3
 s_add_u32 s28, s28, s29
 v_readlane_b32 s29, v11, 4
 s_add_u32 s28, s28, s29
 v_readlane_b32 s29, v11, 5
 s_add_u32 s28, s28, s29
 v_readlane_b32 s29, v11, 6
 s_add_u32 s28, s28, s29
 v_readlane_b32 s29, v11, 7
 s_add_u32 s28, s28, s29
 s_cmp_ge_u32 s28, 256
 s_cbranch_scc1 cen_d
 s_sleep 2
 s_sub_u32 s45, s45, 1
 s_cbranch_scc0 cen_p
cen_d:
 v_lshrrev_b32 v9, 5, v10
 v_add_u32 v9, 163584, v9
 ds_write_b32 v9, v11
 s_waitcnt lgkmcnt(0)
 s_mov_b64 exec, -1
cen_w:
 s_barrier
 v_lshrrev_b32 v10, 5, v10
 v_add_u32 v10, 163584, v10
 ds_read_b32 v11, v10
 s_waitcnt lgkmcnt(0)
 v_readlane_b32 s82, v11, 0
 v_readlane_b32 s83, v11, 1
 v_readlane_b32 s84, v11, 2
 v_readlane_b32 s85, v11, 3
 v_readlane_b32 s86, v11, 4
 v_readlane_b32 s87, v11, 5
 v_readlane_b32 s88, v11, 6
 v_readlane_b32 s89, v11, 7
 s_barrier
 s_min_u32 s29, s82, s83
 s_cmp_ge_u32 s29, 32
 s_cselect_b32 s79, 0, 1
 s_mov_b32 s28, 0
 s_cmp_gt_u32 s80, 0
 s_cselect_b32 s29, s82, 0
 s_add_u32 s28, s28, s29
 s_cmp_gt_u32 s80, 1
 s_cselect_b32 s29, s83, 0
 s_add_u32 s28, s28, s29
 s_cmp_gt_u32 s80, 2
 s_cselect_b32 s29, s84, 0
 s_add_u32 s28, s28, s29
 s_cmp_gt_u32 s80, 3
 s_cselect_b32 s29, s85, 0
 s_add_u32 s28, s28, s29
 s_cmp_gt_u32 s80, 4
 s_cselect_b32 s29, s86, 0
 s_add_u32 s28, s28, s29
 s_cmp_gt_u32 s80, 5
 s_cselect_b32 s29, s87, 0
 s_add_u32 s28, s28, s29
 s_cmp_gt_u32 s80, 6
 s_cselect_b32 s29, s88, 0
 s_add_u32 s28, s28, s29
 s_add_u32 s17, s28, s81
 s_cmp_eq_u32 s79, 1
 s_cbranch_scc1 cen_pub
 s_cmp_eq_u32 s80, 0
 s_cselect_b32 s29, 32, 0
 s_add_u32 s17, s17, s29
cen_pub:
 s_cmp_ge_u32 s17, 64
 s_cbranch_scc1 role_worker
role_chain:
 s_lshr_b32 s12, s17, 5
 s_and_b32 s13, s17, 15
 s_lshl_b32 s15, s12, 4
 s_add_u32 s15, s15, s13
 s_bitcmp1_b32 s17, 4
 s_cbranch_scc1 role_V
 s_load_dwordx4 s[4:7], s[0:1], 16
 s_waitcnt lgkmcnt(0)
 s_mov_b32 s20, s4
 s_and_b32 s21, s5, 0xffff
 s_mov_b32 s22, 0x780000
 s_mov_b32 s23, 0x20000
 s_mov_b32 s24, s6
 s_and_b32 s25, s7, 0xffff
 s_mov_b32 s26, 0x780000
 s_mov_b32 s27, 0x20000
 s_cmp_eq_u32 s79, 1
 s_cbranch_scc1 role_S_slow
 s_branch role_S_fast
role_V:
 s_load_dwordx4 s[4:7], s[0:1], 32
 s_waitcnt lgkmcnt(0)
 s_mov_b32 s20, s4
 s_and_b32 s21, s5, 0xffff
 s_mov_b32 s22, 0x780000
 s_mov_b32 s23, 0x20000
 s_mov_b32 s24, s6
 s_and_b32 s25, s7, 0xffff
 s_mov_b32 s26, 0x780000
 s_mov_b32 s27, 0x20000
 s_cmp_eq_u32 s79, 1
 s_cbranch_scc1 role_V_slow
 s_branch role_V_fast
main_end0:
 s_endpgm
role_S_fast:
 v_lshlrev_b32 v120, 4, v0
 v_add_u32 v1, 1024, v0
 v_lshlrev_b32 v121, 3, v1
 v_and_b32 v2, 63, v0
 v_lshlrev_b32 v124, 4, v2
 v_lshrrev_b32 v3, 4, v2
 v_and_b32 v4, 15, v2
 v_bfe_u32 v5, v4, 1, 1
 v_lshrrev_b32 v6, 2, v4
 v_and_b32 v7, 1, v4
 v_lshl_add_u32 v6, v6, 1, v7
 v_lshlrev_b32 v122, 8, v3
 v_lshl_add_u32 v122, v5, 7, v122
 v_lshl_add_u32 v122, v6, 4, v122
 v_mov_b32 v123, 0x4444
 v_mov_b32 v7, 0xeeee
 v_cmp_eq_u32 vcc, 1, v5
 s_nop 1
 v_cndmask_b32 v123, v123, v7, vcc
 s_mov_b32 s42, 0x00003f80
 s_mov_b32 s43, 0x3f800000
 s_mov_b32 s40, 0x00ff00ff
 s_mov_b32 s41, 0x00ff00ff
 s_mov_b32 s45, 200000
 s_lshl_b32 s36, s12, 16
 s_add_u32 s36, s36, 3145728
 s_lshl_b32 s18, s12, 3
 s_lshl_b32 s46, s12, 7
 s_add_u32 s46, s46, 6344704
 s_mov_b32 s16, 0
 s_mul_i32 s28, s14, 384
 s_add_u32 s28, s28, 0
 v_add_u32 v8, s28, v2
 v_mul_u32_u24 v9, 0xaaab, v8
 v_lshrrev_b32 v9, 20, v9
 v_mul_u32_u24 v10, 24, v9
 v_sub_u32 v10, v8, v10
 v_bfe_u32 v11, v9, 2, 2
 v_lshlrev_b32 v11, 1, v11
 v_xor_b32 v10, v10, v11
 v_mul_u32_u24 v9, 12288, v9
 v_lshl_add_u32 v130, v10, 4, v9
 s_mul_i32 s28, s14, 384
 s_add_u32 s28, s28, 64
 v_add_u32 v8, s28, v2
 v_mul_u32_u24 v9, 0xaaab, v8
 v_lshrrev_b32 v9, 20, v9
 v_mul_u32_u24 v10, 24, v9
 v_sub_u32 v10, v8, v10
 v_bfe_u32 v11, v9, 2, 2
 v_lshlrev_b32 v11, 1, v11
 v_xor_b32 v10, v10, v11
 v_mul_u32_u24 v9, 12288, v9
 v_lshl_add_u32 v131, v10, 4, v9
 s_mul_i32 s28, s14, 384
 s_add_u32 s28, s28, 128
 v_add_u32 v8, s28, v2
 v_mul_u32_u24 v9, 0xaaab, v8
 v_lshrrev_b32 v9, 20, v9
 v_mul_u32_u24 v10, 24, v9
 v_sub_u32 v10, v8, v10
 v_bfe_u32 v11, v9, 2, 2
 v_lshlrev_b32 v11, 1, v11
 v_xor_b32 v10, v10, v11
 v_mul_u32_u24 v9, 12288, v9
 v_lshl_add_u32 v132, v10, 4, v9
 s_mul_i32 s28, s14, 384
 s_add_u32 s28, s28, 192
 v_add_u32 v8, s28, v2
 v_mul_u32_u24 v9, 0xaaab, v8
 v_lshrrev_b32 v9, 20, v9
 v_mul_u32_u24 v10, 24, v9
 v_sub_u32 v10, v8, v10
 v_bfe_u32 v11, v9, 2, 2
 v_lshlrev_b32 v11, 1, v11
 v_xor_b32 v10, v10, v11
 v_mul_u32_u24 v9, 12288, v9
 v_lshl_add_u32 v133, v10, 4, v9
 s_mul_i32 s28, s14, 384
 s_add_u32 s28, s28, 256
 v_add_u32 v8, s28, v2
 v_mul_u32_u24 v9, 0xaaab, v8
 v_lshrrev_b32 v9, 20, v9
 v_mul_u32_u24 v10, 24, v9
 v_sub_u32 v10, v8, v10
 v_bfe_u32 v11, v9, 2, 2
 v_lshlrev_b32 v11, 1, v11
 v_xor_b32 v10, v10, v11
 v_mul_u32_u24 v9, 12288, v9
 v_lshl_add_u32 v134, v10, 4, v9
 s_mul_i32 s28, s14, 384
 s_add_u32 s28, s28, 320
 v_add_u32 v8, s28, v2
 v_mul_u32_u24 v9, 0xaaab, v8
 v_lshrrev_b32 v9, 20, v9
 v_mul_u32_u24 v10, 24, v9
 v_sub_u32 v10, v8, v10
 v_bfe_u32 v11, v9, 2, 2
 v_lshlrev_b32 v11, 1, v11
 v_xor_b32 v10, v10, v11
 v_mul_u32_u24 v9, 12288, v9
 v_lshl_add_u32 v135, v10, 4, v9
 v_lshrrev_b32 v8, 1, v3
 v_lshlrev_b32 v8, 4, v8
 v_and_b32 v9, 1, v3
 v_lshl_add_u32 v8, v9, 2, v8
 v_lshrrev_b32 v9, 2, v4
 v_and_b32 v10, 1, v9
 v_add_u32 v8, v8, v10
 v_lshrrev_b32 v11, 1, v9
 v_lshl_add_u32 v8, v11, 3, v8
 v_bfe_u32 v11, v8, 2, 2
 v_mul_u32_u24 v8, 384, v8
 v_and_b32 v9, 3, v2
 v_lshl_add_u32 v8, v9, 3, v8
 s_mul_i32 s28, s14, 3
 s_add_u32 s28, s28, 0
 v_xor_b32 v9, s28, v11
 v_lshl_add_u32 v12, v9, 5, v8
 s_mul_i32 s28, s14, 3
 s_add_u32 s28, s28, 1
 v_xor_b32 v9, s28, v11
 v_lshl_add_u32 v14, v9, 5, v8
 s_mul_i32 s28, s14, 3
 s_add_u32 s28, s28, 2
 v_xor_b32 v9, s28, v11
 v_lshl_add_u32 v15, v9, 5, v8
 s_mul_i32 s47, s15, 384
 s_mul_i32 s28, s14, 6144
 s_add_u32 m0, s28, 0
 s_add_u32 s29, s47, 0
 buffer_load_dwordx4 v130, s[20:23], s29 offen lds
 s_mul_i32 s28, s14, 6144
 s_add_u32 m0, s28, 1024
 s_add_u32 s29, s47, 0
 buffer_load_dwordx4 v131, s[20:23], s29 offen lds
 s_mul_i32 s28, s14, 6144
 s_add_u32 m0, s28, 2048
 s_add_u32 s29, s47, 0
 buffer_load_dwordx4 v132, s[20:23], s29 offen lds
 s_mul_i32 s28, s14, 6144
 s_add_u32 m0, s28, 3072
 s_add_u32 s29, s47, 0
 buffer_load_dwordx4 v133, s[20:23], s29 offen lds
 s_mul_i32 s28, s14, 6144
 s_add_u32 m0, s28, 4096
 s_add_u32 s29, s47, 0
 buffer_load_dwordx4 v134, s[20:23], s29 offen lds
 s_mul_i32 s28, s14, 6144
 s_add_u32 m0, s28, 5120
 s_add_u32 s29, s47, 0
 buffer_load_dwordx4 v135, s[20:23], s29 offen lds
 s_mul_i32 s28, s14, 6144
 s_add_u32 m0, s28, 24576
 s_add_u32 s29, s47, 0
 buffer_load_dwordx4 v130, s[24:27], s29 offen lds
 s_mul_i32 s28, s14, 6144
 s_add_u32 m0, s28, 25600
 s_add_u32 s29, s47, 0
 buffer_load_dwordx4 v131, s[24:27], s29 offen lds
 s_mul_i32 s28, s14, 6144
 s_add_u32 m0, s28, 26624
 s_add_u32 s29, s47, 0
 buffer_load_dwordx4 v132, s[24:27], s29 offen lds
 s_mul_i32 s28, s14, 6144
 s_add_u32 m0, s28, 27648
 s_add_u32 s29, s47, 0
 buffer_load_dwordx4 v133, s[24:27], s29 offen lds
 s_mul_i32 s28, s14, 6144
 s_add_u32 m0, s28, 28672
 s_add_u32 s29, s47, 0
 buffer_load_dwordx4 v134, s[24:27], s29 offen lds
 s_mul_i32 s28, s14, 6144
 s_add_u32 m0, s28, 29696
 s_add_u32 s29, s47, 0
 buffer_load_dwordx4 v135, s[24:27], s29 offen lds
 s_mul_i32 s28, s14, 6144
 s_add_u32 m0, s28, 49152
 s_add_u32 s29, s47, 786432
 buffer_load_dwordx4 v130, s[20:23], s29 offen lds
 s_mul_i32 s28, s14, 6144
 s_add_u32 m0, s28, 50176
 s_add_u32 s29, s47, 786432
 buffer_load_dwordx4 v131, s[20:23], s29 offen lds
 s_mul_i32 s28, s14, 6144
 s_add_u32 m0, s28, 51200
 s_add_u32 s29, s47, 786432
 buffer_load_dwordx4 v132, s[20:23], s29 offen lds
 s_mul_i32 s28, s14, 6144
 s_add_u32 m0, s28, 52224
 s_add_u32 s29, s47, 786432
 buffer_load_dwordx4 v133, s[20:23], s29 offen lds
 s_mul_i32 s28, s14, 6144
 s_add_u32 m0, s28, 53248
 s_add_u32 s29, s47, 786432
 buffer_load_dwordx4 v134, s[20:23], s29 offen lds
 s_mul_i32 s28, s14, 6144
 s_add_u32 m0, s28, 54272
 s_add_u32 s29, s47, 786432
 buffer_load_dwordx4 v135, s[20:23], s29 offen lds
 s_mul_i32 s28, s14, 6144
 s_add_u32 m0, s28, 73728
 s_add_u32 s29, s47, 786432
 buffer_load_dwordx4 v130, s[24:27], s29 offen lds
 s_mul_i32 s28, s14, 6144
 s_add_u32 m0, s28, 74752
 s_add_u32 s29, s47, 786432
 buffer_load_dwordx4 v131, s[24:27], s29 offen lds
 s_mul_i32 s28, s14, 6144
 s_add_u32 m0, s28, 75776
 s_add_u32 s29, s47, 786432
 buffer_load_dwordx4 v132, s[24:27], s29 offen lds
 s_mul_i32 s28, s14, 6144
 s_add_u32 m0, s28, 76800
 s_add_u32 s29, s47, 786432
 buffer_load_dwordx4 v133, s[24:27], s29 offen lds
 s_mul_i32 s28, s14, 6144
 s_add_u32 m0, s28, 77824
 s_add_u32 s29, s47, 786432
 buffer_load_dwordx4 v134, s[24:27], s29 offen lds
 s_mul_i32 s28, s14, 6144
 s_add_u32 m0, s28, 78848
 s_add_u32 s29, s47, 786432
 buffer_load_dwordx4 v135, s[24:27], s29 offen lds
 s_mul_i32 s28, s14, 6144
 s_add_u32 m0, s28, 98304
 s_add_u32 s29, s47, 1572864
 buffer_load_dwordx4 v130, s[20:23], s29 offen lds
 s_mul_i32 s28, s14, 6144
 s_add_u32 m0, s28, 99328
 s_add_u32 s29, s47, 1572864
 buffer_load_dwordx4 v131, s[20:23], s29 offen lds
 s_mul_i32 s28, s14, 6144
 s_add_u32 m0, s28, 100352
 s_add_u32 s29, s47, 1572864
 buffer_load_dwordx4 v132, s[20:23], s29 offen lds
 s_mul_i32 s28, s14, 6144
 s_add_u32 m0, s28, 101376
 s_add_u32 s29, s47, 1572864
 buffer_load_dwordx4 v133, s[20:23], s29 offen lds
 s_mul_i32 s28, s14, 6144
 s_add_u32 m0, s28, 102400
 s_add_u32 s29, s47, 1572864
 buffer_load_dwordx4 v134, s[20:23], s29 offen lds
 s_mul_i32 s28, s14, 6144
 s_add_u32 m0, s28, 103424
 s_add_u32 s29, s47, 1572864
 buffer_load_dwordx4 v135, s[20:23], s29 offen lds
 s_waitcnt vmcnt(24) lgkmcnt(0)
 s_barrier
 s_mul_i32 s28, s14, 6144
 s_add_u32 m0, s28, 122880
 s_add_u32 s29, s47, 1572864
 buffer_load_dwordx4 v130, s[24:27], s29 offen lds
 s_mul_i32 s28, s14, 6144
 s_add_u32 m0, s28, 123904
 s_add_u32 s29, s47, 1572864
 buffer_load_dwordx4 v131, s[24:27], s29 offen lds
 s_mul_i32 s28, s14, 6144
 s_add_u32 m0, s28, 124928
 s_add_u32 s29, s47, 1572864
 buffer_load_dwordx4 v132, s[24:27], s29 offen lds
 s_mul_i32 s28, s14, 6144
 s_add_u32 m0, s28, 125952
 s_add_u32 s29, s47, 1572864
 buffer_load_dwordx4 v133, s[24:27], s29 offen lds
 s_mul_i32 s28, s14, 6144
 s_add_u32 m0, s28, 126976
 s_add_u32 s29, s47, 1572864
 buffer_load_dwordx4 v134, s[24:27], s29 offen lds
 s_mul_i32 s28, s14, 6144
 s_add_u32 m0, s28, 128000
 s_add_u32 s29, s47, 1572864
 buffer_load_dwordx4 v135, s[24:27], s29 offen lds
 v_add_u32 v13, 0, v12
 ds_read_b64_tr_b16 a[0:1], v13 offset:0
 ds_read_b64_tr_b16 a[2:3], v13 offset:768
 ds_read_b64_tr_b16 a[4:5], v13 offset:12288
 ds_read_b64_tr_b16 a[6:7], v13 offset:13056
 v_add_u32 v13, 0, v14
 ds_read_b64_tr_b16 a[8:9], v13 offset:0
 ds_read_b64_tr_b16 a[10:11], v13 offset:768
 ds_read_b64_tr_b16 a[12:13], v13 offset:12288
 ds_read_b64_tr_b16 a[14:15], v13 offset:13056
 v_add_u32 v13, 0, v15
 ds_read_b64_tr_b16 a[16:17], v13 offset:0
 ds_read_b64_tr_b16 a[18:19], v13 offset:768
 ds_read_b64_tr_b16 a[20:21], v13 offset:12288
 ds_read_b64_tr_b16 a[22:23], v13 offset:13056
 s_waitcnt vmcnt(24) lgkmcnt(0)
 s_barrier
 s_mul_i32 s28, s14, 6144
 s_add_u32 m0, s28, 0
 s_add_u32 s29, s47, 2359296
 buffer_load_dwordx4 v130, s[20:23], s29 offen lds
 s_mul_i32 s28, s14, 6144
 s_add_u32 m0, s28, 1024
 s_add_u32 s29, s47, 2359296
 buffer_load_dwordx4 v131, s[20:23], s29 offen lds
 s_mul_i32 s28, s14, 6144
 s_add_u32 m0, s28, 2048
 s_add_u32 s29, s47, 2359296
 buffer_load_dwordx4 v132, s[20:23], s29 offen lds
 s_mul_i32 s28, s14, 6144
 s_add_u32 m0, s28, 3072
 s_add_u32 s29, s47, 2359296
 buffer_load_dwordx4 v133, s[20:23], s29 offen lds
 s_mul_i32 s28, s14, 6144
 s_add_u32 m0, s28, 4096
 s_add_u32 s29, s47, 2359296
 buffer_load_dwordx4 v134, s[20:23], s29 offen lds
 s_mul_i32 s28, s14, 6144
 s_add_u32 m0, s28, 5120
 s_add_u32 s29, s47, 2359296
 buffer_load_dwordx4 v135, s[20:23], s29 offen lds
 v_add_u32 v13, 24576, v12
 ds_read_b64_tr_b16 v[16:17], v13 offset:0
 ds_read_b64_tr_b16 v[18:19], v13 offset:768
 ds_read_b64_tr_b16 v[20:21], v13 offset:12288
 ds_read_b64_tr_b16 v[22:23], v13 offset:13056
 v_add_u32 v13, 24576, v14
 ds_read_b64_tr_b16 a[24:25], v13 offset:0
 ds_read_b64_tr_b16 a[26:27], v13 offset:768
 ds_read_b64_tr_b16 a[28:29], v13 offset:12288
 ds_read_b64_tr_b16 a[30:31], v13 offset:13056
 v_add_u32 v13, 24576, v15
 ds_read_b64_tr_b16 a[32:33], v13 offset:0
 ds_read_b64_tr_b16 a[34:35], v13 offset:768
 ds_read_b64_tr_b16 a[36:37], v13 offset:12288
 ds_read_b64_tr_b16 a[38:39], v13 offset:13056
 s_waitcnt vmcnt(24) lgkmcnt(0)
 s_barrier
 s_mul_i32 s28, s14, 6144
 s_add_u32 m0, s28, 24576
 s_add_u32 s29, s47, 2359296
 buffer_load_dwordx4 v130, s[24:27], s29 offen lds
 s_mul_i32 s28, s14, 6144
 s_add_u32 m0, s28, 25600
 s_add_u32 s29, s47, 2359296
 buffer_load_dwordx4 v131, s[24:27], s29 offen lds
 s_mul_i32 s28, s14, 6144
 s_add_u32 m0, s28, 26624
 s_add_u32 s29, s47, 2359296
 buffer_load_dwordx4 v132, s[24:27], s29 offen lds
 s_mul_i32 s28, s14, 6144
 s_add_u32 m0, s28, 27648
 s_add_u32 s29, s47, 2359296
 buffer_load_dwordx4 v133, s[24:27], s29 offen lds
 s_mul_i32 s28, s14, 6144
 s_add_u32 m0, s28, 28672
 s_add_u32 s29, s47, 2359296
 buffer_load_dwordx4 v134, s[24:27], s29 offen lds
 s_mul_i32 s28, s14, 6144
 s_add_u32 m0, s28, 29696
 s_add_u32 s29, s47, 2359296
 buffer_load_dwordx4 v135, s[24:27], s29 offen lds
 v_add_u32 v13, 49152, v12
 ds_read_b64_tr_b16 a[40:41], v13 offset:0
 ds_read_b64_tr_b16 a[42:43], v13 offset:768
 ds_read_b64_tr_b16 a[44:45], v13 offset:12288
 ds_read_b64_tr_b16 a[46:47], v13 offset:13056
 v_add_u32 v13, 49152, v14
 ds_read_b64_tr_b16 v[24:25], v13 offset:0
 ds_read_b64_tr_b16 v[26:27], v13 offset:768
 ds_read_b64_tr_b16 v[28:29], v13 offset:12288
 ds_read_b64_tr_b16 v[30:31], v13 offset:13056
 v_add_u32 v13, 49152, v15
 ds_read_b64_tr_b16 a[48:49], v13 offset:0
 ds_read_b64_tr_b16 a[50:51], v13 offset:768
 ds_read_b64_tr_b16 a[52:53], v13 offset:12288
 ds_read_b64_tr_b16 a[54:55], v13 offset:13056
 s_waitcnt vmcnt(24) lgkmcnt(0)
 s_barrier
 s_mul_i32 s28, s14, 6144
 s_add_u32 m0, s28, 49152
 s_add_u32 s29, s47, 3145728
 buffer_load_dwordx4 v130, s[20:23], s29 offen lds
 s_mul_i32 s28, s14, 6144
 s_add_u32 m0, s28, 50176
 s_add_u32 s29, s47, 3145728
 buffer_load_dwordx4 v131, s[20:23], s29 offen lds
 s_mul_i32 s28, s14, 6144
 s_add_u32 m0, s28, 51200
 s_add_u32 s29, s47, 3145728
 buffer_load_dwordx4 v132, s[20:23], s29 offen lds
 s_mul_i32 s28, s14, 6144
 s_add_u32 m0, s28, 52224
 s_add_u32 s29, s47, 3145728
 buffer_load_dwordx4 v133, s[20:23], s29 offen lds
 s_mul_i32 s28, s14, 6144
 s_add_u32 m0, s28, 53248
 s_add_u32 s29, s47, 3145728
 buffer_load_dwordx4 v134, s[20:23], s29 offen lds
 s_mul_i32 s28, s14, 6144
 s_add_u32 m0, s28, 54272
 s_add_u32 s29, s47, 3145728
 buffer_load_dwordx4 v135, s[20:23], s29 offen lds
 v_add_u32 v13, 73728, v12
 ds_read_b64_tr_b16 a[56:57], v13 offset:0
 ds_read_b64_tr_b16 a[58:59], v13 offset:768
 ds_read_b64_tr_b16 a[60:61], v13 offset:12288
 ds_read_b64_tr_b16 a[62:63], v13 offset:13056
 v_add_u32 v13, 73728, v14
 ds_read_b64_tr_b16 a[64:65], v13 offset:0
 ds_read_b64_tr_b16 a[66:67], v13 offset:768
 ds_read_b64_tr_b16 a[68:69], v13 offset:12288
 ds_read_b64_tr_b16 a[70:71], v13 offset:13056
 v_add_u32 v13, 73728, v15
 ds_read_b64_tr_b16 v[32:33], v13 offset:0
 ds_read_b64_tr_b16 v[34:35], v13 offset:768
 ds_read_b64_tr_b16 v[36:37], v13 offset:12288
 ds_read_b64_tr_b16 v[38:39], v13 offset:13056
 s_waitcnt vmcnt(24) lgkmcnt(0)
 s_barrier
 s_mul_i32 s28, s14, 6144
 s_add_u32 m0, s28, 73728
 s_add_u32 s29, s47, 3145728
 buffer_load_dwordx4 v130, s[24:27], s29 offen lds
 s_mul_i32 s28, s14, 6144
 s_add_u32 m0, s28, 74752
 s_add_u32 s29, s47, 3145728
 buffer_load_dwordx4 v131, s[24:27], s29 offen lds
 s_mul_i32 s28, s14, 6144
 s_add_u32 m0, s28, 75776
 s_add_u32 s29, s47, 3145728
 buffer_load_dwordx4 v132, s[24:27], s29 offen lds
 s_mul_i32 s28, s14, 6144
 s_add_u32 m0, s28, 76800
 s_add_u32 s29, s47, 3145728
 buffer_load_dwordx4 v133, s[24:27], s29 offen lds
 s_mul_i32 s28, s14, 6144
 s_add_u32 m0, s28, 77824
 s_add_u32 s29, s47, 3145728
 buffer_load_dwordx4 v134, s[24:27], s29 offen lds
 s_mul_i32 s28, s14, 6144
 s_add_u32 m0, s28, 78848
 s_add_u32 s29, s47, 3145728
 buffer_load_dwordx4 v135, s[24:27], s29 offen lds
 v_add_u32 v13, 98304, v12
 ds_read_b64_tr_b16 a[72:73], v13 offset:0
 ds_read_b64_tr_b16 a[74:75], v13 offset:768
 ds_read_b64_tr_b16 a[76:77], v13 offset:12288
 ds_read_b64_tr_b16 a[78:79], v13 offset:13056
 v_add_u32 v13, 98304, v14
 ds_read_b64_tr_b16 a[80:81], v13 offset:0
 ds_read_b64_tr_b16 a[82:83], v13 offset:768
 ds_read_b64_tr_b16 a[84:85], v13 offset:12288
 ds_read_b64_tr_b16 a[86:87], v13 offset:13056
 v_add_u32 v13, 98304, v15
 ds_read_b64_tr_b16 a[88:89], v13 offset:0
 ds_read_b64_tr_b16 a[90:91], v13 offset:768
 ds_read_b64_tr_b16 a[92:93], v13 offset:12288
 ds_read_b64_tr_b16 a[94:95], v13 offset:13056
 s_waitcnt vmcnt(24) lgkmcnt(0)
 s_barrier
 s_mul_i32 s28, s14, 6144
 s_add_u32 m0, s28, 98304
 s_add_u32 s29, s47, 3932160
 buffer_load_dwordx4 v130, s[20:23], s29 offen lds
 s_mul_i32 s28, s14, 6144
 s_add_u32 m0, s28, 99328
 s_add_u32 s29, s47, 3932160
 buffer_load_dwordx4 v131, s[20:23], s29 offen lds
 s_mul_i32 s28, s14, 6144
 s_add_u32 m0, s28, 100352
 s_add_u32 s29, s47, 3932160
 buffer_load_dwordx4 v132, s[20:23], s29 offen lds
 s_mul_i32 s28, s14, 6144
 s_add_u32 m0, s28, 101376
 s_add_u32 s29, s47, 3932160
 buffer_load_dwordx4 v133, s[20:23], s29 offen lds
 s_mul_i32 s28, s14, 6144
 s_add_u32 m0, s28, 102400
 s_add_u32 s29, s47, 3932160
 buffer_load_dwordx4 v134, s[20:23], s29 offen lds
 s_mul_i32 s28, s14, 6144
 s_add_u32 m0, s28, 103424
 s_add_u32 s29, s47, 3932160
 buffer_load_dwordx4 v135, s[20:23], s29 offen lds
 v_add_u32 v13, 122880, v12
 ds_read_b64_tr_b16 v[40:41], v13 offset:0
 ds_read_b64_tr_b16 v[42:43], v13 offset:768
 ds_read_b64_tr_b16 v[44:45], v13 offset:12288
 ds_read_b64_tr_b16 v[46:47], v13 offset:13056
 v_add_u32 v13, 122880, v14
 ds_read_b64_tr_b16 a[96:97], v13 offset:0
 ds_read_b64_tr_b16 a[98:99], v13 offset:768
 ds_read_b64_tr_b16 a[100:101], v13 offset:12288
 ds_read_b64_tr_b16 a[102:103], v13 offset:13056
 v_add_u32 v13, 122880, v15
 ds_read_b64_tr_b16 a[104:105], v13 offset:0
 ds_read_b64_tr_b16 a[106:107], v13 offset:768
 ds_read_b64_tr_b16 a[108:109], v13 offset:12288
 ds_read_b64_tr_b16 a[110:111], v13 offset:13056
 s_waitcnt vmcnt(24) lgkmcnt(0)
 s_barrier
 s_mul_i32 s28, s14, 6144
 s_add_u32 m0, s28, 122880
 s_add_u32 s29, s47, 3932160
 buffer_load_dwordx4 v130, s[24:27], s29 offen lds
 s_mul_i32 s28, s14, 6144
 s_add_u32 m0, s28, 123904
 s_add_u32 s29, s47, 3932160
 buffer_load_dwordx4 v131, s[24:27], s29 offen lds
 s_mul_i32 s28, s14, 6144
 s_add_u32 m0, s28, 124928
 s_add_u32 s29, s47, 3932160
 buffer_load_dwordx4 v132, s[24:27], s29 offen lds
 s_mul_i32 s28, s14, 6144
 s_add_u32 m0, s28, 125952
 s_add_u32 s29, s47, 3932160
 buffer_load_dwordx4 v133, s[24:27], s29 offen lds
 s_mul_i32 s28, s14, 6144
 s_add_u32 m0, s28, 126976
 s_add_u32 s29, s47, 3932160
 buffer_load_dwordx4 v134, s[24:27], s29 offen lds
 s_mul_i32 s28, s14, 6144
 s_add_u32 m0, s28, 128000
 s_add_u32 s29, s47, 3932160
 buffer_load_dwordx4 v135, s[24:27], s29 offen lds
 v_add_u32 v13, 0, v12
 ds_read_b64_tr_b16 a[112:113], v13 offset:0
 ds_read_b64_tr_b16 a[114:115], v13 offset:768
 ds_read_b64_tr_b16 a[116:117], v13 offset:12288
 ds_read_b64_tr_b16 a[118:119], v13 offset:13056
 v_add_u32 v13, 0, v14
 ds_read_b64_tr_b16 v[48:49], v13 offset:0
 ds_read_b64_tr_b16 v[50:51], v13 offset:768
 ds_read_b64_tr_b16 v[52:53], v13 offset:12288
 ds_read_b64_tr_b16 v[54:55], v13 offset:13056
 v_add_u32 v13, 0, v15
 ds_read_b64_tr_b16 a[120:121], v13 offset:0
 ds_read_b64_tr_b16 a[122:123], v13 offset:768
 ds_read_b64_tr_b16 a[124:125], v13 offset:12288
 ds_read_b64_tr_b16 a[126:127], v13 offset:13056
 s_waitcnt vmcnt(24) lgkmcnt(0)
 s_barrier
 s_mul_i32 s28, s14, 6144
 s_add_u32 m0, s28, 0
 s_add_u32 s29, s47, 4718592
 buffer_load_dwordx4 v130, s[20:23], s29 offen lds
 s_mul_i32 s28, s14, 6144
 s_add_u32 m0, s28, 1024
 s_add_u32 s29, s47, 4718592
 buffer_load_dwordx4 v131, s[20:23], s29 offen lds
 s_mul_i32 s28, s14, 6144
 s_add_u32 m0, s28, 2048
 s_add_u32 s29, s47, 4718592
 buffer_load_dwordx4 v132, s[20:23], s29 offen lds
 s_mul_i32 s28, s14, 6144
 s_add_u32 m0, s28, 3072
 s_add_u32 s29, s47, 4718592
 buffer_load_dwordx4 v133, s[20:23], s29 offen lds
 s_mul_i32 s28, s14, 6144
 s_add_u32 m0, s28, 4096
 s_add_u32 s29, s47, 4718592
 buffer_load_dwordx4 v134, s[20:23], s29 offen lds
 s_mul_i32 s28, s14, 6144
 s_add_u32 m0, s28, 5120
 s_add_u32 s29, s47, 4718592
 buffer_load_dwordx4 v135, s[20:23], s29 offen lds
 v_add_u32 v13, 24576, v12
 ds_read_b64_tr_b16 a[128:129], v13 offset:0
 ds_read_b64_tr_b16 a[130:131], v13 offset:768
 ds_read_b64_tr_b16 a[132:133], v13 offset:12288
 ds_read_b64_tr_b16 a[134:135], v13 offset:13056
 v_add_u32 v13, 24576, v14
 ds_read_b64_tr_b16 a[136:137], v13 offset:0
 ds_read_b64_tr_b16 a[138:139], v13 offset:768
 ds_read_b64_tr_b16 a[140:141], v13 offset:12288
 ds_read_b64_tr_b16 a[142:143], v13 offset:13056
 v_add_u32 v13, 24576, v15
 ds_read_b64_tr_b16 v[56:57], v13 offset:0
 ds_read_b64_tr_b16 v[58:59], v13 offset:768
 ds_read_b64_tr_b16 v[60:61], v13 offset:12288
 ds_read_b64_tr_b16 v[62:63], v13 offset:13056
 s_waitcnt vmcnt(24) lgkmcnt(0)
 s_barrier
 s_mul_i32 s28, s14, 6144
 s_add_u32 m0, s28, 24576
 s_add_u32 s29, s47, 4718592
 buffer_load_dwordx4 v130, s[24:27], s29 offen lds
 s_mul_i32 s28, s14, 6144
 s_add_u32 m0, s28, 25600
 s_add_u32 s29, s47, 4718592
 buffer_load_dwordx4 v131, s[24:27], s29 offen lds
 s_mul_i32 s28, s14, 6144
 s_add_u32 m0, s28, 26624
 s_add_u32 s29, s47, 4718592
 buffer_load_dwordx4 v132, s[24:27], s29 offen lds
 s_mul_i32 s28, s14, 6144
 s_add_u32 m0, s28, 27648
 s_add_u32 s29, s47, 4718592
 buffer_load_dwordx4 v133, s[24:27], s29 offen lds
 s_mul_i32 s28, s14, 6144
 s_add_u32 m0, s28, 28672
 s_add_u32 s29, s47, 4718592
 buffer_load_dwordx4 v134, s[24:27], s29 offen lds
 s_mul_i32 s28, s14, 6144
 s_add_u32 m0, s28, 29696
 s_add_u32 s29, s47, 4718592
 buffer_load_dwordx4 v135, s[24:27], s29 offen lds
 v_add_u32 v13, 49152, v12
 ds_read_b64_tr_b16 a[144:145], v13 offset:0
 ds_read_b64_tr_b16 a[146:147], v13 offset:768
 ds_read_b64_tr_b16 a[148:149], v13 offset:12288
 ds_read_b64_tr_b16 a[150:151], v13 offset:13056
 v_add_u32 v13, 49152, v14
 ds_read_b64_tr_b16 a[152:153], v13 offset:0
 ds_read_b64_tr_b16 a[154:155], v13 offset:768
 ds_read_b64_tr_b16 a[156:157], v13 offset:12288
 ds_read_b64_tr_b16 a[158:159], v13 offset:13056
 v_add_u32 v13, 49152, v15
 ds_read_b64_tr_b16 a[160:161], v13 offset:0
 ds_read_b64_tr_b16 a[162:163], v13 offset:768
 ds_read_b64_tr_b16 a[164:165], v13 offset:12288
 ds_read_b64_tr_b16 a[166:167], v13 offset:13056
 s_waitcnt vmcnt(24) lgkmcnt(0)
 s_barrier
 s_mul_i32 s28, s14, 6144
 s_add_u32 m0, s28, 49152
 s_add_u32 s29, s47, 5505024
 buffer_load_dwordx4 v130, s[20:23], s29 offen lds
 s_mul_i32 s28, s14, 6144
 s_add_u32 m0, s28, 50176
 s_add_u32 s29, s47, 5505024
 buffer_load_dwordx4 v131, s[20:23], s29 offen lds
 s_mul_i32 s28, s14, 6144
 s_add_u32 m0, s28, 51200
 s_add_u32 s29, s47, 5505024
 buffer_load_dwordx4 v132, s[20:23], s29 offen lds
 s_mul_i32 s28, s14, 6144
 s_add_u32 m0, s28, 52224
 s_add_u32 s29, s47, 5505024
 buffer_load_dwordx4 v133, s[20:23], s29 offen lds
 s_mul_i32 s28, s14, 6144
 s_add_u32 m0, s28, 53248
 s_add_u32 s29, s47, 5505024
 buffer_load_dwordx4 v134, s[20:23], s29 offen lds
 s_mul_i32 s28, s14, 6144
 s_add_u32 m0, s28, 54272
 s_add_u32 s29, s47, 5505024
 buffer_load_dwordx4 v135, s[20:23], s29 offen lds
 v_add_u32 v13, 73728, v12
 ds_read_b64_tr_b16 a[168:169], v13 offset:0
 ds_read_b64_tr_b16 a[170:171], v13 offset:768
 ds_read_b64_tr_b16 a[172:173], v13 offset:12288
 ds_read_b64_tr_b16 a[174:175], v13 offset:13056
 v_add_u32 v13, 73728, v14
 ds_read_b64_tr_b16 a[176:177], v13 offset:0
 ds_read_b64_tr_b16 a[178:179], v13 offset:768
 ds_read_b64_tr_b16 a[180:181], v13 offset:12288
 ds_read_b64_tr_b16 a[182:183], v13 offset:13056
 v_add_u32 v13, 73728, v15
 ds_read_b64_tr_b16 a[184:185], v13 offset:0
 ds_read_b64_tr_b16 a[186:187], v13 offset:768
 ds_read_b64_tr_b16 a[188:189], v13 offset:12288
 ds_read_b64_tr_b16 a[190:191], v13 offset:13056
 s_waitcnt vmcnt(24) lgkmcnt(0)
 s_barrier
 s_mul_i32 s28, s14, 6144
 s_add_u32 m0, s28, 73728
 s_add_u32 s29, s47, 5505024
 buffer_load_dwordx4 v130, s[24:27], s29 offen lds
 s_mul_i32 s28, s14, 6144
 s_add_u32 m0, s28, 74752
 s_add_u32 s29, s47, 5505024
 buffer_load_dwordx4 v131, s[24:27], s29 offen lds
 s_mul_i32 s28, s14, 6144
 s_add_u32 m0, s28, 75776
 s_add_u32 s29, s47, 5505024
 buffer_load_dwordx4 v132, s[24:27], s29 offen lds
 s_mul_i32 s28, s14, 6144
 s_add_u32 m0, s28, 76800
 s_add_u32 s29, s47, 5505024
 buffer_load_dwordx4 v133, s[24:27], s29 offen lds
 s_mul_i32 s28, s14, 6144
 s_add_u32 m0, s28, 77824
 s_add_u32 s29, s47, 5505024
 buffer_load_dwordx4 v134, s[24:27], s29 offen lds
 s_mul_i32 s28, s14, 6144
 s_add_u32 m0, s28, 78848
 s_add_u32 s29, s47, 5505024
 buffer_load_dwordx4 v135, s[24:27], s29 offen lds
 v_add_u32 v13, 98304, v12
 ds_read_b64_tr_b16 a[192:193], v13 offset:0
 ds_read_b64_tr_b16 a[194:195], v13 offset:768
 ds_read_b64_tr_b16 a[196:197], v13 offset:12288
 ds_read_b64_tr_b16 a[198:199], v13 offset:13056
 v_add_u32 v13, 98304, v14
 ds_read_b64_tr_b16 v[72:73], v13 offset:0
 ds_read_b64_tr_b16 v[74:75], v13 offset:768
 ds_read_b64_tr_b16 v[76:77], v13 offset:12288
 ds_read_b64_tr_b16 v[78:79], v13 offset:13056
 v_add_u32 v13, 98304, v15
 ds_read_b64_tr_b16 a[200:201], v13 offset:0
 ds_read_b64_tr_b16 a[202:203], v13 offset:768
 ds_read_b64_tr_b16 a[204:205], v13 offset:12288
 ds_read_b64_tr_b16 a[206:207], v13 offset:13056
 s_waitcnt vmcnt(24) lgkmcnt(0)
 s_barrier
 s_mul_i32 s28, s14, 6144
 s_add_u32 m0, s28, 98304
 s_add_u32 s29, s47, 6291456
 buffer_load_dwordx4 v130, s[20:23], s29 offen lds
 s_mul_i32 s28, s14, 6144
 s_add_u32 m0, s28, 99328
 s_add_u32 s29, s47, 6291456
 buffer_load_dwordx4 v131, s[20:23], s29 offen lds
 s_mul_i32 s28, s14, 6144
 s_add_u32 m0, s28, 100352
 s_add_u32 s29, s47, 6291456
 buffer_load_dwordx4 v132, s[20:23], s29 offen lds
 s_mul_i32 s28, s14, 6144
 s_add_u32 m0, s28, 101376
 s_add_u32 s29, s47, 6291456
 buffer_load_dwordx4 v133, s[20:23], s29 offen lds
 s_mul_i32 s28, s14, 6144
 s_add_u32 m0, s28, 102400
 s_add_u32 s29, s47, 6291456
 buffer_load_dwordx4 v134, s[20:23], s29 offen lds
 s_mul_i32 s28, s14, 6144
 s_add_u32 m0, s28, 103424
 s_add_u32 s29, s47, 6291456
 buffer_load_dwordx4 v135, s[20:23], s29 offen lds
 v_add_u32 v13, 122880, v12
 ds_read_b64_tr_b16 v[96:97], v13 offset:0
 ds_read_b64_tr_b16 v[98:99], v13 offset:768
 ds_read_b64_tr_b16 v[100:101], v13 offset:12288
 ds_read_b64_tr_b16 v[102:103], v13 offset:13056
 v_add_u32 v13, 122880, v14
 ds_read_b64_tr_b16 v[112:113], v13 offset:0
 ds_read_b64_tr_b16 v[114:115], v13 offset:768
 ds_read_b64_tr_b16 v[116:117], v13 offset:12288
 ds_read_b64_tr_b16 v[118:119], v13 offset:13056
 v_add_u32 v13, 122880, v15
 ds_read_b64_tr_b16 a[208:209], v13 offset:0
 ds_read_b64_tr_b16 a[210:211], v13 offset:768
 ds_read_b64_tr_b16 a[212:213], v13 offset:12288
 ds_read_b64_tr_b16 a[214:215], v13 offset:13056
 s_waitcnt vmcnt(24) lgkmcnt(0)
 s_barrier
 s_mul_i32 s28, s14, 6144
 s_add_u32 m0, s28, 122880
 s_add_u32 s29, s47, 6291456
 buffer_load_dwordx4 v130, s[24:27], s29 offen lds
 s_mul_i32 s28, s14, 6144
 s_add_u32 m0, s28, 123904
 s_add_u32 s29, s47, 6291456
 buffer_load_dwordx4 v131, s[24:27], s29 offen lds
 s_mul_i32 s28, s14, 6144
 s_add_u32 m0, s28, 124928
 s_add_u32 s29, s47, 6291456
 buffer_load_dwordx4 v132, s[24:27], s29 offen lds
 s_mul_i32 s28, s14, 6144
 s_add_u32 m0, s28, 125952
 s_add_u32 s29, s47, 6291456
 buffer_load_dwordx4 v133, s[24:27], s29 offen lds
 s_mul_i32 s28, s14, 6144
 s_add_u32 m0, s28, 126976
 s_add_u32 s29, s47, 6291456
 buffer_load_dwordx4 v134, s[24:27], s29 offen lds
 s_mul_i32 s28, s14, 6144
 s_add_u32 m0, s28, 128000
 s_add_u32 s29, s47, 6291456
 buffer_load_dwordx4 v135, s[24:27], s29 offen lds
 v_add_u32 v13, 0, v12
 ds_read_b64_tr_b16 a[216:217], v13 offset:0
 ds_read_b64_tr_b16 a[218:219], v13 offset:768
 ds_read_b64_tr_b16 a[220:221], v13 offset:12288
 ds_read_b64_tr_b16 a[222:223], v13 offset:13056
 v_add_u32 v13, 0, v14
 ds_read_b64_tr_b16 a[224:225], v13 offset:0
 ds_read_b64_tr_b16 a[226:227], v13 offset:768
 ds_read_b64_tr_b16 a[228:229], v13 offset:12288
 ds_read_b64_tr_b16 a[230:231], v13 offset:13056
 v_add_u32 v13, 0, v15
 ds_read_b64_tr_b16 a[232:233], v13 offset:0
 ds_read_b64_tr_b16 a[234:235], v13 offset:768
 ds_read_b64_tr_b16 a[236:237], v13 offset:12288
 ds_read_b64_tr_b16 a[238:239], v13 offset:13056
 s_waitcnt vmcnt(24) lgkmcnt(0)
 s_barrier
 s_mul_i32 s28, s14, 6144
 s_add_u32 m0, s28, 0
 s_add_u32 s29, s47, 7077888
 buffer_load_dwordx4 v130, s[20:23], s29 offen lds
 s_mul_i32 s28, s14, 6144
 s_add_u32 m0, s28, 1024
 s_add_u32 s29, s47, 7077888
 buffer_load_dwordx4 v131, s[20:23], s29 offen lds
 s_mul_i32 s28, s14, 6144
 s_add_u32 m0, s28, 2048
 s_add_u32 s29, s47, 7077888
 buffer_load_dwordx4 v132, s[20:23], s29 offen lds
 s_mul_i32 s28, s14, 6144
 s_add_u32 m0, s28, 3072
 s_add_u32 s29, s47, 7077888
 buffer_load_dwordx4 v133, s[20:23], s29 offen lds
 s_mul_i32 s28, s14, 6144
 s_add_u32 m0, s28, 4096
 s_add_u32 s29, s47, 7077888
 buffer_load_dwordx4 v134, s[20:23], s29 offen lds
 s_mul_i32 s28, s14, 6144
 s_add_u32 m0, s28, 5120
 s_add_u32 s29, s47, 7077888
 buffer_load_dwordx4 v135, s[20:23], s29 offen lds
 v_add_u32 v13, 24576, v12
 ds_read_b64_tr_b16 a[240:241], v13 offset:0
 ds_read_b64_tr_b16 a[242:243], v13 offset:768
 ds_read_b64_tr_b16 a[244:245], v13 offset:12288
 ds_read_b64_tr_b16 a[246:247], v13 offset:13056
 v_add_u32 v13, 24576, v14
 ds_read_b64_tr_b16 a[248:249], v13 offset:0
 ds_read_b64_tr_b16 a[250:251], v13 offset:768
 ds_read_b64_tr_b16 a[252:253], v13 offset:12288
 ds_read_b64_tr_b16 a[254:255], v13 offset:13056
 v_add_u32 v13, 24576, v15
 ds_read_b64_tr_b16 v[136:137], v13 offset:0
 ds_read_b64_tr_b16 v[138:139], v13 offset:768
 ds_read_b64_tr_b16 v[140:141], v13 offset:12288
 ds_read_b64_tr_b16 v[142:143], v13 offset:13056
 s_waitcnt vmcnt(24) lgkmcnt(0)
 s_barrier
 s_mul_i32 s28, s14, 6144
 s_add_u32 m0, s28, 24576
 s_add_u32 s29, s47, 7077888
 buffer_load_dwordx4 v130, s[24:27], s29 offen lds
 s_mul_i32 s28, s14, 6144
 s_add_u32 m0, s28, 25600
 s_add_u32 s29, s47, 7077888
 buffer_load_dwordx4 v131, s[24:27], s29 offen lds
 s_mul_i32 s28, s14, 6144
 s_add_u32 m0, s28, 26624
 s_add_u32 s29, s47, 7077888
 buffer_load_dwordx4 v132, s[24:27], s29 offen lds
 s_mul_i32 s28, s14, 6144
 s_add_u32 m0, s28, 27648
 s_add_u32 s29, s47, 7077888
 buffer_load_dwordx4 v133, s[24:27], s29 offen lds
 s_mul_i32 s28, s14, 6144
 s_add_u32 m0, s28, 28672
 s_add_u32 s29, s47, 7077888
 buffer_load_dwordx4 v134, s[24:27], s29 offen lds
 s_mul_i32 s28, s14, 6144
 s_add_u32 m0, s28, 29696
 s_add_u32 s29, s47, 7077888
 buffer_load_dwordx4 v135, s[24:27], s29 offen lds
 v_add_u32 v13, 49152, v12
 ds_read_b64_tr_b16 v[64:65], v13 offset:0
 ds_read_b64_tr_b16 v[66:67], v13 offset:768
 ds_read_b64_tr_b16 v[68:69], v13 offset:12288
 ds_read_b64_tr_b16 v[70:71], v13 offset:13056
 v_add_u32 v13, 49152, v14
 ds_read_b64_tr_b16 v[144:145], v13 offset:0
 ds_read_b64_tr_b16 v[146:147], v13 offset:768
 ds_read_b64_tr_b16 v[148:149], v13 offset:12288
 ds_read_b64_tr_b16 v[150:151], v13 offset:13056
 v_add_u32 v13, 49152, v15
 ds_read_b64_tr_b16 v[88:89], v13 offset:0
 ds_read_b64_tr_b16 v[90:91], v13 offset:768
 ds_read_b64_tr_b16 v[92:93], v13 offset:12288
 ds_read_b64_tr_b16 v[94:95], v13 offset:13056
 s_waitcnt vmcnt(24) lgkmcnt(0)
 s_barrier
 v_add_u32 v13, 73728, v12
 ds_read_b64_tr_b16 v[152:153], v13 offset:0
 ds_read_b64_tr_b16 v[154:155], v13 offset:768
 ds_read_b64_tr_b16 v[156:157], v13 offset:12288
 ds_read_b64_tr_b16 v[158:159], v13 offset:13056
 v_add_u32 v13, 73728, v14
 ds_read_b64_tr_b16 v[160:161], v13 offset:0
 ds_read_b64_tr_b16 v[162:163], v13 offset:768
 ds_read_b64_tr_b16 v[164:165], v13 offset:12288
 ds_read_b64_tr_b16 v[166:167], v13 offset:13056
 v_add_u32 v13, 73728, v15
 ds_read_b64_tr_b16 v[168:169], v13 offset:0
 ds_read_b64_tr_b16 v[170:171], v13 offset:768
 ds_read_b64_tr_b16 v[172:173], v13 offset:12288
 ds_read_b64_tr_b16 v[174:175], v13 offset:13056
 s_waitcnt vmcnt(18) lgkmcnt(0)
 s_barrier
 v_add_u32 v13, 98304, v12
 ds_read_b64_tr_b16 v[176:177], v13 offset:0
 ds_read_b64_tr_b16 v[178:179], v13 offset:768
 ds_read_b64_tr_b16 v[180:181], v13 offset:12288
 ds_read_b64_tr_b16 v[182:183], v13 offset:13056
 v_add_u32 v13, 98304, v14
 ds_read_b64_tr_b16 v[184:185], v13 offset:0
 ds_read_b64_tr_b16 v[186:187], v13 offset:768
 ds_read_b64_tr_b16 v[188:189], v13 offset:12288
 ds_read_b64_tr_b16 v[190:191], v13 offset:13056
 v_add_u32 v13, 98304, v15
 ds_read_b64_tr_b16 v[192:193], v13 offset:0
 ds_read_b64_tr_b16 v[194:195], v13 offset:768
 ds_read_b64_tr_b16 v[196:197], v13 offset:12288
 ds_read_b64_tr_b16 v[198:199], v13 offset:13056
 s_waitcnt vmcnt(12) lgkmcnt(0)
 s_barrier
 v_add_u32 v13, 122880, v12
 ds_read_b64_tr_b16 v[104:105], v13 offset:0
 ds_read_b64_tr_b16 v[106:107], v13 offset:768
 ds_read_b64_tr_b16 v[108:109], v13 offset:12288
 ds_read_b64_tr_b16 v[110:111], v13 offset:13056
 v_add_u32 v13, 122880, v14
 ds_read_b64_tr_b16 v[200:201], v13 offset:0
 ds_read_b64_tr_b16 v[202:203], v13 offset:768
 ds_read_b64_tr_b16 v[204:205], v13 offset:12288
 ds_read_b64_tr_b16 v[206:207], v13 offset:13056
 v_add_u32 v13, 122880, v15
 ds_read_b64_tr_b16 v[208:209], v13 offset:0
 ds_read_b64_tr_b16 v[210:211], v13 offset:768
 ds_read_b64_tr_b16 v[212:213], v13 offset:12288
 ds_read_b64_tr_b16 v[214:215], v13 offset:13056
 s_waitcnt vmcnt(6) lgkmcnt(0)
 s_barrier
 v_add_u32 v13, 0, v12
 ds_read_b64_tr_b16 v[216:217], v13 offset:0
 ds_read_b64_tr_b16 v[218:219], v13 offset:768
 ds_read_b64_tr_b16 v[220:221], v13 offset:12288
 ds_read_b64_tr_b16 v[222:223], v13 offset:13056
 v_add_u32 v13, 0, v14
 ds_read_b64_tr_b16 v[80:81], v13 offset:0
 ds_read_b64_tr_b16 v[82:83], v13 offset:768
 ds_read_b64_tr_b16 v[84:85], v13 offset:12288
 ds_read_b64_tr_b16 v[86:87], v13 offset:13056
 v_add_u32 v13, 0, v15
 ds_read_b64_tr_b16 v[224:225], v13 offset:0
 ds_read_b64_tr_b16 v[226:227], v13 offset:768
 ds_read_b64_tr_b16 v[228:229], v13 offset:12288
 ds_read_b64_tr_b16 v[230:231], v13 offset:13056
 s_waitcnt vmcnt(0) lgkmcnt(0)
 s_barrier
 v_add_u32 v13, 24576, v12
 ds_read_b64_tr_b16 v[232:233], v13 offset:0
 ds_read_b64_tr_b16 v[234:235], v13 offset:768
 ds_read_b64_tr_b16 v[236:237], v13 offset:12288
 ds_read_b64_tr_b16 v[238:239], v13 offset:13056
 v_add_u32 v13, 24576, v14
 ds_read_b64_tr_b16 v[240:241], v13 offset:0
 ds_read_b64_tr_b16 v[242:243], v13 offset:768
 ds_read_b64_tr_b16 v[244:245], v13 offset:12288
 ds_read_b64_tr_b16 v[246:247], v13 offset:13056
 v_add_u32 v13, 24576, v15
 ds_read_b64_tr_b16 v[248:249], v13 offset:0
 ds_read_b64_tr_b16 v[250:251], v13 offset:768
 ds_read_b64_tr_b16 v[252:253], v13 offset:12288
 ds_read_b64_tr_b16 v[254:255], v13 offset:13056
 s_waitcnt lgkmcnt(0)
 s_barrier
 v_mbcnt_lo_u32_b32 v10, -1, 0
 v_and_b32 v10, 7, v10
 v_lshlrev_b32 v10, 7, v10
 s_mov_b32 s82, 6361088
 s_cmp_eq_u32 s14, 0
 s_cbranch_scc0 vs_w
 s_mov_b32 s45, 400000
 s_mov_b64 exec, 0xff
vs_p:
 buffer_load_dword v11, v10, s[8:11], s82 offen sc1
 s_waitcnt vmcnt(0)
 s_mov_b32 s28, 0
 v_readlane_b32 s29, v11, 0
 s_add_u32 s28, s28, s29
 v_readlane_b32 s29, v11, 1
 s_add_u32 s28, s28, s29
 v_readlane_b32 s29, v11, 2
 s_add_u32 s28, s28, s29
 v_readlane_b32 s29, v11, 3
 s_add_u32 s28, s28, s29
 v_readlane_b32 s29, v11, 4
 s_add_u32 s28, s28, s29
 v_readlane_b32 s29, v11, 5
 s_add_u32 s28, s28, s29
 v_readlane_b32 s29, v11, 6
 s_add_u32 s28, s28, s29
 v_readlane_b32 s29, v11, 7
 s_add_u32 s28, s28, s29
 s_cmp_ge_u32 s28, 256
 s_cbranch_scc1 vs_d
 s_sleep 2
 s_sub_u32 s45, s45, 1
 s_cbranch_scc0 vs_p
vs_d:
 v_lshrrev_b32 v9, 5, v10
 v_add_u32 v9, 163584, v9
 ds_write_b32 v9, v11
 s_waitcnt lgkmcnt(0)
 s_mov_b64 exec, -1
vs_w:
 s_barrier
 v_lshrrev_b32 v10, 5, v10
 v_add_u32 v10, 163584, v10
 ds_read_b32 v11, v10
 s_waitcnt lgkmcnt(0)
 v_readlane_b32 s82, v11, 0
 v_readlane_b32 s83, v11, 1
 v_readlane_b32 s84, v11, 2
 v_readlane_b32 s85, v11, 3
 v_readlane_b32 s86, v11, 4
 v_readlane_b32 s87, v11, 5
 v_readlane_b32 s88, v11, 6
 v_readlane_b32 s89, v11, 7
 s_barrier
 s_min_u32 s29, s82, s83
 s_cmp_ge_u32 s29, 32
 s_cbranch_scc0 redispatch
 s_mov_b32 s45, 200000
 v_lshlrev_b32 v7, 3, v4
 s_mov_b32 s28, 6356992
 buffer_load_dwordx2 v[8:9], v7, s[8:11], s28 offen sc1
 s_waitcnt vmcnt(0)
 v_cmp_lt_i32 vcc, v9, v8
 s_and_b32 s19, vcc_lo, 65535
 s_mul_i32 s28, s14, 26624
 s_add_u32 s28, s28, 40960
 v_add_u32 v126, s28, v124
 ds_write_b128 v126, v[16:19] offset:0
 ds_write_b128 v126, v[20:23] offset:1024
 ds_write_b128 v126, v[24:27] offset:2048
 ds_write_b128 v126, v[28:31] offset:3072
 ds_write_b128 v126, v[32:35] offset:4096
 ds_write_b128 v126, v[36:39] offset:5120
 ds_write_b128 v126, v[40:43] offset:6144
 ds_write_b128 v126, v[44:47] offset:7168
 ds_write_b128 v126, v[48:51] offset:8192
 ds_write_b128 v126, v[52:55] offset:9216
 ds_write_b128 v126, v[56:59] offset:10240
 ds_write_b128 v126, v[60:63] offset:11264
 ds_write_b128 v126, v[64:67] offset:12288
 ds_write_b128 v126, v[68:71] offset:13312
 ds_write_b128 v126, v[72:75] offset:14336
 ds_write_b128 v126, v[76:79] offset:15360
 ds_write_b128 v126, v[80:83] offset:16384
 ds_write_b128 v126, v[84:87] offset:17408
 ds_write_b128 v126, v[88:91] offset:18432
 ds_write_b128 v126, v[92:95] offset:19456
 ds_write_b128 v126, v[96:99] offset:20480
 ds_write_b128 v126, v[100:103] offset:21504
 ds_write_b128 v126, v[104:107] offset:22528
 ds_write_b128 v126, v[108:111] offset:23552
 ds_write_b128 v126, v[112:115] offset:24576
 ds_write_b128 v126, v[116:119] offset:25600
 s_waitcnt lgkmcnt(0)
 v_lshrrev_b32 v8, 2, v4
 v_and_b32 v8, 1, v8
 v_lshlrev_b32 v8, 7, v8
 v_lshl_add_u32 v8, v3, 5, v8
 v_lshrrev_b32 v9, 3, v4
 v_lshl_add_u32 v8, v9, 3, v8
 v_and_b32 v9, 3, v4
 v_lshl_add_u32 v8, v9, 1, v8
 s_mul_i32 s28, s14, 768
 s_add_u32 s28, s28, 10240
 v_add_u32 v125, s28, v8
 v_and_b32 v9, 7, v4
 v_lshlrev_b32 v9, 4, v9
 v_lshl_add_u32 v127, v3, 7, v9
 s_and_b32 s28, s14, 2
 s_mul_i32 s28, s28, 3072
 v_add_u32 v130, s28, v124
 v_mov_b32 v10, 0xf149f2ca
 v_mov_b32 v11, 0
 v_cmp_gt_u32 vcc, 2, v3
 s_nop 1
 v_cndmask_b32 v116, v10, v11, vcc
 v_cndmask_b32 v117, v10, v11, vcc
 v_cndmask_b32 v118, v10, v11, vcc
 v_cndmask_b32 v119, v10, v11, vcc
 s_cmp_eq_u32 s14, 0
 s_cbranch_scc1 w0_1
 s_sub_u32 s28, s14, 1
 s_lshl_b32 s28, s28, 4
 v_add_u32 v8, s28, v4
 v_lshrrev_b32 v9, 1, v3
 v_lshlrev_b32 v9, 4, v9
 v_and_b32 v12, 1, v3
 v_lshl_add_u32 v9, v12, 2, v9
 v_add_u32 v13, 0, v9
 v_cmp_le_u32 vcc, v13, v8
 s_nop 1
 v_cndmask_b32 v108, v10, v11, vcc
 v_add_u32 v13, 1, v9
 v_cmp_le_u32 vcc, v13, v8
 s_nop 1
 v_cndmask_b32 v109, v10, v11, vcc
 v_add_u32 v13, 2, v9
 v_cmp_le_u32 vcc, v13, v8
 s_nop 1
 v_cndmask_b32 v110, v10, v11, vcc
 v_add_u32 v13, 3, v9
 v_cmp_le_u32 vcc, v13, v8
 s_nop 1
 v_cndmask_b32 v111, v10, v11, vcc
 v_add_u32 v13, 8, v9
 v_cmp_le_u32 vcc, v13, v8
 s_nop 1
 v_cndmask_b32 v112, v10, v11, vcc
 v_add_u32 v13, 9, v9
 v_cmp_le_u32 vcc, v13, v8
 s_nop 1
 v_cndmask_b32 v113, v10, v11, vcc
 v_add_u32 v13, 10, v9
 v_cmp_le_u32 vcc, v13, v8
 s_nop 1
 v_cndmask_b32 v114, v10, v11, vcc
 v_add_u32 v13, 11, v9
 v_cmp_le_u32 vcc, v13, v8
 s_nop 1
 v_cndmask_b32 v115, v10, v11, vcc
 v_lshrrev_b32 v9, 1, v3
 v_lshlrev_b32 v9, 10, v9
 v_lshl_add_u32 v9, v8, 5, v9
 v_lshl_add_u32 v128, v12, 4, v9
 v_lshlrev_b32 v9, 4, v8
 v_lshl_add_u32 v9, v3, 3, v9
 v_add_u32 v129, 2048, v9
 s_branch wd_2
w0_1:
 v_lshrrev_b32 v8, 3, v4
 v_lshl_add_u32 v128, v8, 3, v127
 v_and_b32 v9, 7, v4
 v_lshlrev_b32 v9, 4, v9
 v_lshl_add_u32 v9, v3, 2, v9
 v_add_u32 v129, 512, v9
 v_mov_b32 v9, 137216
 v_cndmask_b32 v132, v9, v127, s[40:41]
 v_cndmask_b32 v133, v127, v9, s[40:41]
 v_lshrrev_b32 v9, 2, v4
 v_and_b32 v12, 1, v4
 v_lshl_add_u32 v9, v9, 1, v12
 v_lshlrev_b32 v9, 4, v9
 v_lshl_add_u32 v134, v3, 7, v9
 v_cndmask_b32 v112, v10, v11, s[40:41]
 v_cndmask_b32 v113, v10, v11, s[40:41]
 v_mov_b32 v114, 0
 v_mov_b32 v115, 0
 v_mov_b32 v116, 0x3dd53b95
 v_mov_b32 v12, 0
 v_mov_b32 v13, 0
 v_mov_b32 v14, 0
 v_mov_b32 v15, 0
 v_add_u32 v9, 147456, v124
 ds_write_b128 v9, v[12:15]
 ds_write_b128 v9, v[12:15] offset:1024
 ds_write_b128 v9, v[12:15] offset:2048
wd_2:
 s_mov_b32 s44, 0x3dd53b95
 s_mul_i32 s37, s15, 12288
 s_lshl_b32 s50, s12, 20
 s_mul_i32 s28, s13, 10240
 s_add_u32 s50, s50, s28
 s_add_u32 s50, s50, 4194304
 s_mul_i32 s51, s15, 10240
 s_add_u32 s51, s51, 25165824
 v_add_u32 v135, 4096, v120
 s_mul_i32 s38, s13, 640
 s_lshl_b32 s28, s12, 16
 s_add_u32 s38, s38, s28
 s_add_u32 s38, s38, 3407872
 s_mul_i32 s39, s15, 2560
 s_add_u32 s39, s39, 18874368
 s_mul_i32 s48, s12, 655360
 s_add_u32 s48, s48, 96468992
 s_mul_i32 s28, s13, 40
 s_mul_i32 s29, s14, 160
 v_and_b32 v8, 63, v2
 v_add_u32 v8, 0, v8
 v_add_u32 v8, s29, v8
 v_and_b32 v13, 1, v8
 v_lshrrev_b32 v8, 1, v8
 v_mul_u32_u24 v9, 0xccd, v8
 v_lshrrev_b32 v9, 16, v9
 v_mul_u32_u24 v10, 20, v9
 v_sub_u32 v10, v8, v10
 v_cmp_le_u32 vcc, 10, v10
 v_subrev_u32 v11, 10, v10
 s_nop 0
 v_cndmask_b32 v10, v10, v11, vcc
 v_cndmask_b32 v11, 0, 1, vcc
 v_lshl_add_u32 v10, v10, 2, s28
 v_mul_u32_u24 v9, 40960, v9
 v_lshl_add_u32 v9, v11, 10, v9
 v_lshrrev_b32 v11, 5, v10
 v_lshl_add_u32 v9, v11, 11, v9
 v_and_b32 v11, 31, v10
 v_lshl_add_u32 v9, v11, 5, v9
 v_lshl_add_u32 v131, v13, 6, v9
 v_and_b32 v8, 63, v2
 v_add_u32 v8, 64, v8
 v_add_u32 v8, s29, v8
 v_and_b32 v13, 1, v8
 v_lshrrev_b32 v8, 1, v8
 v_mul_u32_u24 v9, 0xccd, v8
 v_lshrrev_b32 v9, 16, v9
 v_mul_u32_u24 v10, 20, v9
 v_sub_u32 v10, v8, v10
 v_cmp_le_u32 vcc, 10, v10
 v_subrev_u32 v11, 10, v10
 s_nop 0
 v_cndmask_b32 v10, v10, v11, vcc
 v_cndmask_b32 v11, 0, 1, vcc
 v_lshl_add_u32 v10, v10, 2, s28
 v_mul_u32_u24 v9, 40960, v9
 v_lshl_add_u32 v9, v11, 10, v9
 v_lshrrev_b32 v11, 5, v10
 v_lshl_add_u32 v9, v11, 11, v9
 v_and_b32 v11, 31, v10
 v_lshl_add_u32 v9, v11, 5, v9
 v_lshl_add_u32 v119, v13, 6, v9
 v_and_b32 v8, 31, v2
 v_add_u32 v8, 128, v8
 v_add_u32 v8, s29, v8
 v_and_b32 v13, 1, v8
 v_lshrrev_b32 v8, 1, v8
 v_mul_u32_u24 v9, 0xccd, v8
 v_lshrrev_b32 v9, 16, v9
 v_mul_u32_u24 v10, 20, v9
 v_sub_u32 v10, v8, v10
 v_cmp_le_u32 vcc, 10, v10
 v_subrev_u32 v11, 10, v10
 s_nop 0
 v_cndmask_b32 v10, v10, v11, vcc
 v_cndmask_b32 v11, 0, 1, vcc
 v_lshl_add_u32 v10, v10, 2, s28
 v_mul_u32_u24 v9, 40960, v9
 v_lshl_add_u32 v9, v11, 10, v9
 v_lshrrev_b32 v11, 5, v10
 v_lshl_add_u32 v9, v11, 11, v9
 v_and_b32 v11, 31, v10
 v_lshl_add_u32 v9, v11, 5, v9
 v_lshl_add_u32 v117, v13, 6, v9
 s_cmp_eq_u32 s14, 3
 s_cbranch_scc0 n3_3
 s_and_b32 s28, s16, 3
 s_cbranch_scc1 fo_5
 s_lshr_b32 s28, s16, 2
 s_lshl_b32 s28, s28, 5
 s_add_u32 s28, s28, s15
 s_lshl_b32 s28, s28, 2
 s_add_u32 s28, s28, 6324224
 v_bfe_u32 v36, v124, 4, 1
 v_lshlrev_b32 v36, 12, v36
fq_4:
 buffer_load_dword v37, v36, s[8:11], s28 offen sc1
 s_waitcnt vmcnt(0)
 v_cmp_gt_u32 vcc, 2, v37
 s_cbranch_vccz fo_5
 s_sub_u32 s45, s45, 1
 s_cbranch_scc0 fq_4
 s_mov_b32 s45, 0
fo_5:
 s_mul_i32 s28, s16, 393216
 s_add_u32 s28, s28, s37
 s_add_u32 s29, s28, 71303168
 s_add_u32 s28, s28, 46137344
 s_mov_b32 m0, 16384
 s_nop 0
 buffer_load_dwordx4 v124, s[8:11], s28 offen sc1 lds
 s_add_u32 s28, s28, 1024
 s_mov_b32 m0, 17408
 s_nop 0
 buffer_load_dwordx4 v124, s[8:11], s28 offen sc1 lds
 s_add_u32 s28, s28, 1024
 s_mov_b32 m0, 18432
 s_nop 0
 buffer_load_dwordx4 v124, s[8:11], s28 offen sc1 lds
 s_add_u32 s28, s28, 1024
 s_mov_b32 m0, 19456
 s_nop 0
 buffer_load_dwordx4 v124, s[8:11], s28 offen sc1 lds
 s_add_u32 s28, s28, 1024
 s_mov_b32 m0, 20480
 s_nop 0
 buffer_load_dwordx4 v124, s[8:11], s28 offen sc1 lds
 s_add_u32 s28, s28, 1024
 s_mov_b32 m0, 21504
 s_nop 0
 buffer_load_dwordx4 v124, s[8:11], s28 offen sc1 lds
 s_add_u32 s28, s28, 1024
 s_mov_b32 m0, 22528
 s_nop 0
 buffer_load_dwordx4 v124, s[8:11], s28 offen sc1 lds
 s_add_u32 s28, s28, 1024
 s_mov_b32 m0, 23552
 s_nop 0
 buffer_load_dwordx4 v124, s[8:11], s28 offen sc1 lds
 s_add_u32 s28, s28, 1024
 s_mov_b32 m0, 24576
 s_nop 0
 buffer_load_dwordx4 v124, s[8:11], s28 offen sc1 lds
 s_add_u32 s28, s28, 1024
 s_mov_b32 m0, 25600
 s_nop 0
 buffer_load_dwordx4 v124, s[8:11], s28 offen sc1 lds
 s_add_u32 s28, s28, 1024
 s_mov_b32 m0, 26624
 s_nop 0
 buffer_load_dwordx4 v124, s[8:11], s28 offen sc1 lds
 s_add_u32 s28, s28, 1024
 s_mov_b32 m0, 27648
 s_nop 0
 buffer_load_dwordx4 v124, s[8:11], s28 offen sc1 lds
 s_add_u32 s28, s28, 1024
 s_mov_b32 m0, 28672
 s_nop 0
 buffer_load_dwordx4 v124, s[8:11], s29 offen sc1 lds
 s_add_u32 s29, s29, 1024
 s_mov_b32 m0, 29696
 s_nop 0
 buffer_load_dwordx4 v124, s[8:11], s29 offen sc1 lds
 s_add_u32 s29, s29, 1024
 s_mov_b32 m0, 30720
 s_nop 0
 buffer_load_dwordx4 v124, s[8:11], s29 offen sc1 lds
 s_add_u32 s29, s29, 1024
 s_mov_b32 m0, 31744
 s_nop 0
 buffer_load_dwordx4 v124, s[8:11], s29 offen sc1 lds
 s_add_u32 s29, s29, 1024
 s_mov_b32 m0, 32768
 s_nop 0
 buffer_load_dwordx4 v124, s[8:11], s29 offen sc1 lds
 s_add_u32 s29, s29, 1024
 s_mov_b32 m0, 33792
 s_nop 0
 buffer_load_dwordx4 v124, s[8:11], s29 offen sc1 lds
 s_add_u32 s29, s29, 1024
 s_mov_b32 m0, 34816
 s_nop 0
 buffer_load_dwordx4 v124, s[8:11], s29 offen sc1 lds
 s_add_u32 s29, s29, 1024
 s_mov_b32 m0, 35840
 s_nop 0
 buffer_load_dwordx4 v124, s[8:11], s29 offen sc1 lds
 s_add_u32 s29, s29, 1024
 s_mov_b32 m0, 36864
 s_nop 0
 buffer_load_dwordx4 v124, s[8:11], s29 offen sc1 lds
 s_add_u32 s29, s29, 1024
 s_mov_b32 m0, 37888
 s_nop 0
 buffer_load_dwordx4 v124, s[8:11], s29 offen sc1 lds
 s_add_u32 s29, s29, 1024
 s_mov_b32 m0, 38912
 s_nop 0
 buffer_load_dwordx4 v124, s[8:11], s29 offen sc1 lds
 s_add_u32 s29, s29, 1024
 s_mov_b32 m0, 39936
 s_nop 0
 buffer_load_dwordx4 v124, s[8:11], s29 offen sc1 lds
 s_add_u32 s29, s29, 1024
n3_3:
 .p2align 6
Sstep_6:
 s_and_b32 s28, s16, 3
 s_lshl_b32 s29, s28, 1
 s_add_u32 s29, s29, s18
 s_lshr_b32 s17, s19, s29
 s_lshl_b32 s29, s29, 14
 s_add_u32 s29, s29, 180355072
 s_and_b32 s31, s17, 1
 s_lshl_b32 s31, s31, 13
 s_add_u32 s31, s31, s29
 s_and_b32 s17, s17, 2
 s_lshl_b32 s17, s17, 12
 s_add_u32 s17, s17, s29
 s_add_u32 s17, s17, 8192
 s_lshl_b32 s28, s28, 14
 s_add_u32 s30, s28, s36
 s_add_u32 s34, s30, 4096
 s_add_u32 s35, s31, 4096
 v_pk_mov_b32 v[48:49], 0, 0
 v_pk_mov_b32 v[50:51], 0, 0
 v_pk_mov_b32 v[52:53], 0, 0
 v_pk_mov_b32 v[54:55], 0, 0
 v_pk_mov_b32 v[56:57], 0, 0
 v_pk_mov_b32 v[58:59], 0, 0
 v_pk_mov_b32 v[60:61], 0, 0
 v_pk_mov_b32 v[62:63], 0, 0
 v_pk_mov_b32 v[64:65], 0, 0
 v_pk_mov_b32 v[66:67], 0, 0
 v_pk_mov_b32 v[68:69], 0, 0
 v_pk_mov_b32 v[70:71], 0, 0
 s_sub_u32 s49, s16, 1
 s_max_i32 s49, s49, 0
 s_mul_i32 s53, s49, 327680
 s_add_u32 s53, s53, s51
 s_and_b32 s52, s49, 3
 s_lshl_b32 s52, s52, 18
 s_add_u32 s52, s52, s50
 s_add_u32 s54, s16, 2
 s_and_b32 s54, s54, 3
 s_lshl_b32 s54, s54, 18
 s_add_u32 s54, s54, s50
 s_add_u32 s55, s16, 1
 s_min_u32 s55, s55, 63
 s_mul_i32 s55, s55, 1310720
 s_add_u32 s55, s55, s48
 ds_read_b128 v[72:75], v126 offset:0
 ds_read_b128 v[76:79], v126 offset:1024
 ds_read_b128 v[80:83], v126 offset:2048
 ds_read_b128 v[84:87], v126 offset:3072
 ds_read_b128 v[88:91], v126 offset:4096
 ds_read_b128 v[92:95], v126 offset:5120
pl_7:
 buffer_load_dwordx4 v[96:99], v120, s[8:11], s30 offen offset:0 sc1
 buffer_load_dwordx4 v[100:103], v120, s[8:11], s34 offen offset:0 sc1
 buffer_load_dwordx2 v[104:105], v121, s[8:11], s30 offen sc1
 s_waitcnt vmcnt(0)
 v_max3_u32 v0, v96, v100, v104
 v_cmp_eq_u32 vcc, -1, v0
 s_cbranch_vccz ok_11
 s_sub_u32 s45, s45, 1
 s_cbranch_scc0 pl_7
 s_mov_b32 s45, 0
ok_11:
 buffer_load_dwordx4 v[36:39], v120, s[8:11], s31 offen offset:0 sc1
 buffer_load_dwordx4 v[40:43], v120, s[8:11], s35 offen offset:0 sc1
 buffer_load_dwordx2 v[44:45], v121, s[8:11], s17 offen sc1
 v_lshlrev_b32 v16, 16, v96
 v_and_b32 v17, 0xffff0000, v96
 v_lshlrev_b32 v18, 16, v97
 v_and_b32 v19, 0xffff0000, v97
 v_lshlrev_b32 v20, 16, v98
 v_and_b32 v21, 0xffff0000, v98
 v_lshlrev_b32 v22, 16, v99
 v_and_b32 v23, 0xffff0000, v99
 v_lshlrev_b32 v24, 16, v100
 v_and_b32 v25, 0xffff0000, v100
 v_lshlrev_b32 v26, 16, v101
 v_and_b32 v27, 0xffff0000, v101
 v_lshlrev_b32 v28, 16, v102
 v_and_b32 v29, 0xffff0000, v102
 v_lshlrev_b32 v30, 16, v103
 v_and_b32 v31, 0xffff0000, v103
 v_lshlrev_b32 v32, 16, v104
 v_and_b32 v33, 0xffff0000, v104
 v_lshlrev_b32 v34, 16, v105
 v_and_b32 v35, 0xffff0000, v105
 s_branch g_9
pr_8:
 buffer_load_dwordx4 v[36:39], v120, s[8:11], s31 offen offset:0 sc1
 buffer_load_dwordx4 v[40:43], v120, s[8:11], s35 offen offset:0 sc1
 buffer_load_dwordx2 v[44:45], v121, s[8:11], s17 offen sc1
g_9:
 s_waitcnt vmcnt(0)
 v_max3_u32 v0, v36, v40, v44
 v_cmp_eq_u32 vcc, -1, v0
 v_dot2_f32_bf16 v4, v36, s42, v16
 v_dot2_f32_bf16 v5, v36, s43, v17
 v_dot2_f32_bf16 v6, v37, s42, v18
 v_dot2_f32_bf16 v7, v37, s43, v19
 v_dot2_f32_bf16 v8, v38, s42, v20
 v_dot2_f32_bf16 v9, v38, s43, v21
 v_dot2_f32_bf16 v10, v39, s42, v22
 v_dot2_f32_bf16 v11, v39, s43, v23
 s_cbranch_vccz ok_12
 s_sub_u32 s45, s45, 1
 s_cbranch_scc0 pr_8
 s_mov_b32 s45, 0
ok_12:
 v_cvt_pk_bf16_f32 v96, v4, v5
 v_cvt_pk_bf16_f32 v97, v6, v7
 v_cvt_pk_bf16_f32 v98, v8, v9
 v_cvt_pk_bf16_f32 v99, v10, v11
 ds_write_b128 v120, v[96:99] offset:0
 v_dot2_f32_bf16 v24, v40, s42, v24
 v_dot2_f32_bf16 v25, v40, s43, v25
 v_dot2_f32_bf16 v26, v41, s42, v26
 v_dot2_f32_bf16 v27, v41, s43, v27
 v_dot2_f32_bf16 v28, v42, s42, v28
 v_dot2_f32_bf16 v29, v42, s43, v29
 v_dot2_f32_bf16 v30, v43, s42, v30
 v_dot2_f32_bf16 v31, v43, s43, v31
 v_cvt_pk_bf16_f32 v100, v24, v25
 v_cvt_pk_bf16_f32 v101, v26, v27
 v_cvt_pk_bf16_f32 v102, v28, v29
 v_cvt_pk_bf16_f32 v103, v30, v31
 ds_write_b128 v120, v[100:103] offset:4096
 v_dot2_f32_bf16 v32, v44, s42, v32
 v_dot2_f32_bf16 v33, v44, s43, v33
 v_dot2_f32_bf16 v34, v45, s42, v34
 v_dot2_f32_bf16 v35, v45, s43, v35
 s_nop 0
 v_cvt_pk_bf16_f32 v104, v32, v33
 s_nop 0
 v_cvt_pk_bf16_f32 v105, v34, v35
 ds_write_b64 v121, v[104:105]
gs_10:
 s_waitcnt lgkmcnt(0)
 s_barrier
 ds_read_b128 v[0:3], v122 offset:0
 ds_read_b128 v[4:7], v122 offset:1024
 s_waitcnt lgkmcnt(1)
 v_smfmac_f32_16x16x64_bf16 v[48:51], v[0:3], a[0:7], v123
 ds_read_b128 v[8:11], v122 offset:2048
 v_smfmac_f32_16x16x64_bf16 v[52:55], v[0:3], a[8:15], v123
 ds_read_b128 v[12:15], v122 offset:3072
 v_smfmac_f32_16x16x64_bf16 v[56:59], v[0:3], a[16:23], v123
 ds_read_b128 v[16:19], v122 offset:4096
 v_smfmac_f32_16x16x64_bf16 v[60:63], v[0:3], v[72:79], v123
 ds_read_b128 v[72:75], v126 offset:6144
 ds_read_b128 v[76:79], v126 offset:7168
 ds_read_b128 v[20:23], v122 offset:5120
 v_smfmac_f32_16x16x64_bf16 v[64:67], v[0:3], a[24:31], v123
 ds_read_b128 v[24:27], v122 offset:6144
 v_smfmac_f32_16x16x64_bf16 v[68:71], v[0:3], a[32:39], v123
 ds_read_b128 v[28:31], v122 offset:7168
 s_waitcnt lgkmcnt(8)
 v_smfmac_f32_16x16x64_bf16 v[48:51], v[4:7], a[40:47], v123
 ds_read_b128 v[32:35], v122 offset:8192
 v_smfmac_f32_16x16x64_bf16 v[52:55], v[4:7], v[80:87], v123
 ds_read_b128 v[80:83], v126 offset:8192
 ds_read_b128 v[84:87], v126 offset:9216
 ds_read_b128 v[36:39], v122 offset:9216
 v_smfmac_f32_16x16x64_bf16 v[56:59], v[4:7], a[48:55], v123
 v_smfmac_f32_16x16x64_bf16 v[60:63], v[4:7], a[56:63], v123
 buffer_load_dwordx4 v[96:99], v120, s[8:11], s52 offen sc1
 v_smfmac_f32_16x16x64_bf16 v[64:67], v[4:7], a[64:71], v123
 v_smfmac_f32_16x16x64_bf16 v[68:71], v[4:7], v[88:95], v123
 ds_read_b128 v[88:91], v126 offset:10240
 ds_read_b128 v[92:95], v126 offset:11264
 buffer_load_dwordx4 v[100:103], v135, s[8:11], s52 offen sc1
 s_waitcnt lgkmcnt(13)
 v_smfmac_f32_16x16x64_bf16 v[48:51], v[8:11], a[72:79], v123
 v_smfmac_f32_16x16x64_bf16 v[52:55], v[8:11], a[80:87], v123
 buffer_load_dwordx2 v[104:105], v121, s[8:11], s52 offen sc1
 v_smfmac_f32_16x16x64_bf16 v[56:59], v[8:11], a[88:95], v123
 s_waitcnt lgkmcnt(9)
 v_smfmac_f32_16x16x64_bf16 v[60:63], v[8:11], v[72:79], v123
 ds_read_b128 v[72:75], v126 offset:12288
 ds_read_b128 v[76:79], v126 offset:13312
 v_smfmac_f32_16x16x64_bf16 v[64:67], v[8:11], a[96:103], v123
 v_mov_b32 v40, -1
 v_mov_b32 v41, -1
 v_mov_b32 v42, -1
 v_mov_b32 v43, -1
 buffer_store_dwordx4 v[40:43], v120, s[8:11], s54 offen
 v_smfmac_f32_16x16x64_bf16 v[68:71], v[8:11], a[104:111], v123
 v_smfmac_f32_16x16x64_bf16 v[48:51], v[12:15], a[112:119], v123
 s_waitcnt lgkmcnt(5)
 v_smfmac_f32_16x16x64_bf16 v[52:55], v[12:15], v[80:87], v123
 ds_read_b128 v[80:83], v126 offset:14336
 ds_read_b128 v[84:87], v126 offset:15360
 v_smfmac_f32_16x16x64_bf16 v[56:59], v[12:15], a[120:127], v123
 buffer_store_dwordx4 v[40:43], v135, s[8:11], s54 offen
 v_smfmac_f32_16x16x64_bf16 v[60:63], v[12:15], a[128:135], v123
 v_smfmac_f32_16x16x64_bf16 v[64:67], v[12:15], a[136:143], v123
 s_waitcnt lgkmcnt(4)
 v_smfmac_f32_16x16x64_bf16 v[68:71], v[12:15], v[88:95], v123
 ds_read_b128 v[88:91], v126 offset:16384
 ds_read_b128 v[92:95], v126 offset:17408
 v_smfmac_f32_16x16x64_bf16 v[48:51], v[16:19], a[144:151], v123
 ds_read_b128 v[0:3], v124 offset:16384
 buffer_store_dwordx2 v[40:41], v121, s[8:11], s54 offen
 v_smfmac_f32_16x16x64_bf16 v[48:51], v[20:23], a[192:199], v123
 ds_read_b128 v[4:7], v124 offset:17408
 v_smfmac_f32_16x16x64_bf16 v[48:51], v[24:27], a[216:223], v123
 ds_read_b128 v[8:11], v124 offset:18432
 s_waitcnt lgkmcnt(7)
 v_smfmac_f32_16x16x64_bf16 v[48:51], v[28:31], v[72:79], v123
 ds_read_b128 v[72:75], v126 offset:18432
 ds_read_b128 v[76:79], v126 offset:19456
 ds_read_b128 v[12:15], v124 offset:19456
 v_smfmac_f32_16x16x64_bf16 v[48:51], v[32:35], v[176:183], v123
 v_smfmac_f32_16x16x64_bf16 v[48:51], v[36:39], v[216:223], v123
 v_smfmac_f32_16x16x64_bf16 v[52:55], v[16:19], a[152:159], v123
 ds_read_b128 v[40:43], v124 offset:26624
 s_waitcnt lgkmcnt(9)
 v_smfmac_f32_16x16x64_bf16 v[52:55], v[20:23], v[80:87], v123
 ds_read_b128 v[80:83], v126 offset:20480
 ds_read_b128 v[84:87], v126 offset:21504
 ds_read_b128 v[44:47], v124 offset:27648
 v_smfmac_f32_16x16x64_bf16 v[52:55], v[24:27], a[224:231], v123
 v_smfmac_f32_16x16x64_bf16 v[52:55], v[28:31], v[144:151], v123
 v_smfmac_f32_16x16x64_bf16 v[52:55], v[32:35], v[184:191], v123
 s_waitcnt vmcnt(3)
 buffer_store_dwordx4 v[96:99], v120, s[8:11], s53 offen sc1
 s_waitcnt lgkmcnt(10)
 v_smfmac_f32_16x16x64_bf16 v[52:55], v[36:39], v[88:95], v123
 ds_read_b128 v[88:91], v126 offset:22528
 ds_read_b128 v[92:95], v126 offset:23552
 v_smfmac_f32_16x16x64_bf16 v[56:59], v[16:19], a[160:167], v123
 v_smfmac_f32_16x16x64_bf16 v[56:59], v[20:23], a[200:207], v123
 v_pk_add_f32 v[48:49], v[48:49], v[50:51]
 v_cvt_pk_bf16_f32 v49, v48, v49
 v_smfmac_f32_16x16x64_bf16 v[56:59], v[24:27], a[232:239], v123
 ds_write_b16 v125, v49 offset:0
 ds_write_b16_d16_hi v125, v49 offset:16
 s_waitcnt lgkmcnt(9)
 v_smfmac_f32_16x16x64_bf16 v[56:59], v[28:31], v[72:79], v123
 ds_read_b128 v[72:75], v126 offset:24576
 ds_read_b128 v[76:79], v126 offset:25600
 v_smfmac_f32_16x16x64_bf16 v[56:59], v[32:35], v[192:199], v123
 buffer_store_dwordx4 v[100:103], v135, s[8:11], s53 offen sc1
 v_smfmac_f32_16x16x64_bf16 v[56:59], v[36:39], v[224:231], v123
 v_smfmac_f32_16x16x64_bf16 v[60:63], v[16:19], a[168:175], v123
 s_waitcnt lgkmcnt(7)
 v_smfmac_f32_16x16x64_bf16 v[60:63], v[20:23], v[80:87], v123
 v_pk_add_f32 v[52:53], v[52:53], v[54:55]
 v_cvt_pk_bf16_f32 v53, v52, v53
 v_smfmac_f32_16x16x64_bf16 v[60:63], v[24:27], a[240:247], v123
 ds_write_b16 v125, v53 offset:256
 ds_write_b16_d16_hi v125, v53 offset:272
 v_smfmac_f32_16x16x64_bf16 v[60:63], v[28:31], v[152:159], v123
 s_waitcnt lgkmcnt(6)
 v_smfmac_f32_16x16x64_bf16 v[60:63], v[32:35], v[88:95], v123
 buffer_store_dwordx2 v[104:105], v121, s[8:11], s53 offen sc1
 v_smfmac_f32_16x16x64_bf16 v[60:63], v[36:39], v[232:239], v123
 v_smfmac_f32_16x16x64_bf16 v[64:67], v[16:19], a[176:183], v123
 s_waitcnt lgkmcnt(2)
 v_smfmac_f32_16x16x64_bf16 v[64:67], v[20:23], v[72:79], v123
 v_pk_add_f32 v[56:57], v[56:57], v[58:59]
 v_cvt_pk_bf16_f32 v57, v56, v57
 v_smfmac_f32_16x16x64_bf16 v[64:67], v[24:27], a[248:255], v123
 ds_write_b16 v125, v57 offset:512
 ds_write_b16_d16_hi v125, v57 offset:528
 v_smfmac_f32_16x16x64_bf16 v[64:67], v[28:31], v[160:167], v123
 v_smfmac_f32_16x16x64_bf16 v[64:67], v[32:35], v[200:207], v123
 v_smfmac_f32_16x16x64_bf16 v[64:67], v[36:39], v[240:247], v123
 v_smfmac_f32_16x16x64_bf16 v[68:71], v[16:19], a[184:191], v123
 ds_read_b128 v[16:19], v124 offset:20480
 v_smfmac_f32_16x16x64_bf16 v[68:71], v[20:23], a[208:215], v123
 ds_read_b128 v[20:23], v124 offset:21504
 v_pk_add_f32 v[60:61], v[60:61], v[62:63]
 v_cvt_pk_bf16_f32 v61, v60, v61
 v_smfmac_f32_16x16x64_bf16 v[68:71], v[24:27], v[136:143], v123
 ds_read_b128 v[24:27], v124 offset:22528
 ds_write_b16 v125, v61 offset:3072
 ds_write_b16_d16_hi v125, v61 offset:3088
 v_smfmac_f32_16x16x64_bf16 v[68:71], v[28:31], v[168:175], v123
 ds_read_b128 v[28:31], v124 offset:23552
 v_smfmac_f32_16x16x64_bf16 v[68:71], v[32:35], v[208:215], v123
 ds_read_b128 v[32:35], v124 offset:24576
 v_smfmac_f32_16x16x64_bf16 v[68:71], v[36:39], v[248:255], v123
 ds_read_b128 v[36:39], v124 offset:25600
 s_nop 0
 v_pk_add_f32 v[64:65], v[64:65], v[66:67]
 v_cvt_pk_bf16_f32 v65, v64, v65
 ds_write_b16 v125, v65 offset:3328
 ds_write_b16_d16_hi v125, v65 offset:3344
 s_nop 1
 v_pk_add_f32 v[68:69], v[68:69], v[70:71]
 v_cvt_pk_bf16_f32 v69, v68, v69
 ds_write_b16 v125, v69 offset:3584
 ds_write_b16_d16_hi v125, v69 offset:3600
 s_waitcnt lgkmcnt(0)
 s_barrier
 s_cmp_eq_u32 s14, 0
 s_cbranch_scc0 wx_13
 ds_read_b128 v[72:75], v132 offset:10240
 ds_read_b128 v[100:103], v133 offset:10240
 ds_read_b128 v[48:51], v134 offset:13312
 ds_read_b128 v[76:79], v132 offset:10752
 ds_read_b128 v[104:107], v133 offset:10752
 ds_read_b128 v[52:55], v134 offset:13824
 s_and_b32 s28, s16, 3
 s_lshl_b32 s28, s28, 14
 s_add_u32 s32, s28, s38
 s_waitcnt lgkmcnt(5)
 v_mfma_f32_16x16x32_bf16 v[96:99], v[0:3], v[72:75], 0
 ds_read_b128 v[0:3], v133 offset:11264
 s_waitcnt lgkmcnt(5)
 v_mfma_f32_16x16x32_bf16 v[96:99], v[24:27], v[100:103], v[96:99]
 ds_read_b128 v[80:83], v132 offset:11264
 ds_read_b128 v[56:59], v134 offset:14336
 s_waitcnt lgkmcnt(6)
 v_mfma_f32_16x16x32_bf16 v[108:111], v[48:51], v[72:75], v[112:115]
 s_waitcnt lgkmcnt(5)
 v_mfma_f32_16x16x32_bf16 v[96:99], v[4:7], v[76:79], v[96:99]
 ds_read_b128 v[4:7], v133 offset:11776
 s_waitcnt lgkmcnt(5)
 v_mfma_f32_16x16x32_bf16 v[96:99], v[28:31], v[104:107], v[96:99]
 ds_read_b128 v[84:87], v132 offset:11776
 ds_read_b128 v[60:63], v134 offset:14848
 s_waitcnt lgkmcnt(6)
 v_mfma_f32_16x16x32_bf16 v[108:111], v[52:55], v[76:79], v[108:111]
 s_waitcnt lgkmcnt(4)
 v_mfma_f32_16x16x32_bf16 v[96:99], v[8:11], v[80:83], v[96:99]
 ds_read_b128 v[8:11], v133 offset:12288
 v_mfma_f32_16x16x32_bf16 v[96:99], v[32:35], v[0:3], v[96:99]
 ds_read_b128 v[88:91], v132 offset:12288
 ds_read_b128 v[64:67], v134 offset:15360
 s_waitcnt lgkmcnt(6)
 v_mfma_f32_16x16x32_bf16 v[108:111], v[56:59], v[80:83], v[108:111]
 s_waitcnt lgkmcnt(4)
 v_mfma_f32_16x16x32_bf16 v[96:99], v[12:15], v[84:87], v[96:99]
 ds_read_b128 v[12:15], v133 offset:12800
 v_mfma_f32_16x16x32_bf16 v[96:99], v[36:39], v[4:7], v[96:99]
 ds_read_b128 v[92:95], v132 offset:12800
 ds_read_b128 v[68:71], v134 offset:15872
 s_waitcnt lgkmcnt(6)
 v_mfma_f32_16x16x32_bf16 v[108:111], v[60:63], v[84:87], v[108:111]
 s_waitcnt lgkmcnt(4)
 v_mfma_f32_16x16x32_bf16 v[96:99], v[16:19], v[88:91], v[96:99]
 v_mfma_f32_16x16x32_bf16 v[96:99], v[40:43], v[8:11], v[96:99]
 s_waitcnt lgkmcnt(1)
 v_mfma_f32_16x16x32_bf16 v[96:99], v[20:23], v[92:95], v[96:99]
 v_mfma_f32_16x16x32_bf16 v[96:99], v[44:47], v[12:15], v[96:99]
 v_mfma_f32_16x16x32_bf16 v[108:111], v[64:67], v[88:91], v[108:111]
 s_waitcnt lgkmcnt(0)
 v_mfma_f32_16x16x32_bf16 v[108:111], v[68:71], v[92:95], v[108:111]
 s_nop 5
 v_max3_f32 v6, v96, v97, v98
 v_max_f32 v6, v6, v99
 v_max3_f32 v6, v6, v108, v109
 s_nop 1
 v_max_f32_dpp v6, v6, v6 row_ror:8 row_mask:0xf bank_mask:0xf
 v_mov_b32 v7, v6
 s_nop 1
 v_permlane16_swap_b32 v6, v7
 v_max_f32 v6, v6, v7
 v_mov_b32 v7, v6
 s_nop 1
 v_permlane32_swap_b32 v6, v7
 v_max_f32 v6, v6, v7
 v_mul_f32 v6, s44, v6
 v_pk_fma_f32 v[96:97], v[96:97], v[116:117], v[6:7] op_sel_hi:[1,0,0] neg_lo:[0,0,1] neg_hi:[0,0,1]
 v_pk_fma_f32 v[98:99], v[98:99], v[116:117], v[6:7] op_sel_hi:[1,0,0] neg_lo:[0,0,1] neg_hi:[0,0,1]
 v_pk_fma_f32 v[108:109], v[108:109], v[116:117], v[6:7] op_sel_hi:[1,0,0] neg_lo:[0,0,1] neg_hi:[0,0,1]
 v_exp_f32 v96, v96
 v_exp_f32 v97, v97
 v_exp_f32 v98, v98
 v_exp_f32 v99, v99
 v_exp_f32 v108, v108
 v_exp_f32 v109, v109
 v_pk_add_f32 v[6:7], v[96:97], v[98:99]
 v_pk_add_f32 v[6:7], v[6:7], v[108:109]
 v_add_f32 v6, v6, v7
 s_nop 1
 v_add_f32_dpp v6, v6, v6 row_ror:8 row_mask:0xf bank_mask:0xf
 v_mov_b32 v7, v6
 s_nop 1
 v_permlane16_swap_b32 v6, v7
 v_add_f32 v6, v6, v7
 v_mov_b32 v7, v6
 s_nop 1
 v_permlane32_swap_b32 v6, v7
 v_add_f32 v6, v6, v7
 v_rcp_f32 v6, v6
 s_nop 0
 v_pk_mul_f32 v[96:97], v[96:97], v[6:7] op_sel_hi:[1,0]
 v_pk_mul_f32 v[98:99], v[98:99], v[6:7] op_sel_hi:[1,0]
 v_pk_mul_f32 v[108:109], v[108:109], v[6:7] op_sel_hi:[1,0]
 v_cvt_pk_bf16_f32 v8, v96, v97
 v_cvt_pk_bf16_f32 v9, v98, v99
 v_cvt_pk_bf16_f32 v10, v108, v109
 buffer_store_dwordx2 v[8:9], v128, s[8:11], s32 offen
 s_mov_b64 exec, s[40:41]
 buffer_store_dword v10, v129, s[8:11], s32 offen
 s_mov_b64 exec, -1
 s_barrier
 s_branch wend_15
wx_13:
 s_cmp_eq_u32 s14, 3
 s_cbranch_scc1 w3_14
 s_sleep 3
 ds_read_b128 v[72:75], v130 offset:28672
 ds_read_b128 v[48:51], v127 offset:13312
 ds_read_b128 v[76:79], v130 offset:29696
 ds_read_b128 v[52:55], v127 offset:13824
 ds_read_b128 v[80:83], v130 offset:30720
 ds_read_b128 v[56:59], v127 offset:14336
 ds_read_b128 v[84:87], v130 offset:31744
 ds_read_b128 v[60:63], v127 offset:14848
 ds_read_b128 v[88:91], v130 offset:32768
 ds_read_b128 v[64:67], v127 offset:15360
 ds_read_b128 v[92:95], v130 offset:33792
 ds_read_b128 v[68:71], v127 offset:15872
 s_mul_i32 s28, s16, 81920
 s_add_u32 s32, s28, s39
 s_waitcnt lgkmcnt(10)
 v_mfma_f32_16x16x32_bf16 v[96:99], v[0:3], v[72:75], v[108:111]
 v_mfma_f32_16x16x32_bf16 v[100:103], v[24:27], v[72:75], v[112:115]
 v_mfma_f32_16x16x32_bf16 v[104:107], v[48:51], v[72:75], 0
 s_waitcnt lgkmcnt(8)
 v_mfma_f32_16x16x32_bf16 v[96:99], v[4:7], v[76:79], v[96:99]
 v_mfma_f32_16x16x32_bf16 v[100:103], v[28:31], v[76:79], v[100:103]
 v_mfma_f32_16x16x32_bf16 v[104:107], v[52:55], v[76:79], v[104:107]
 s_waitcnt lgkmcnt(6)
 v_mfma_f32_16x16x32_bf16 v[96:99], v[8:11], v[80:83], v[96:99]
 v_mfma_f32_16x16x32_bf16 v[100:103], v[32:35], v[80:83], v[100:103]
 v_mfma_f32_16x16x32_bf16 v[104:107], v[56:59], v[80:83], v[104:107]
 s_waitcnt lgkmcnt(4)
 v_mfma_f32_16x16x32_bf16 v[96:99], v[12:15], v[84:87], v[96:99]
 v_mfma_f32_16x16x32_bf16 v[100:103], v[36:39], v[84:87], v[100:103]
 v_mfma_f32_16x16x32_bf16 v[104:107], v[60:63], v[84:87], v[104:107]
 s_waitcnt lgkmcnt(2)
 v_mfma_f32_16x16x32_bf16 v[96:99], v[16:19], v[88:91], v[96:99]
 v_mfma_f32_16x16x32_bf16 v[100:103], v[40:43], v[88:91], v[100:103]
 v_mfma_f32_16x16x32_bf16 v[104:107], v[64:67], v[88:91], v[104:107]
 s_waitcnt lgkmcnt(0)
 v_mfma_f32_16x16x32_bf16 v[96:99], v[20:23], v[92:95], v[96:99]
 v_mfma_f32_16x16x32_bf16 v[100:103], v[44:47], v[92:95], v[100:103]
 v_mfma_f32_16x16x32_bf16 v[104:107], v[68:71], v[92:95], v[104:107]
 s_barrier
 s_nop 6
 s_nop 1
 v_add_f32 v104, v104, v116
 v_add_f32 v105, v105, v116
 v_add_f32 v106, v106, v116
 v_add_f32 v107, v107, v116
 v_max3_f32 v6, v96, v97, v98
 v_max3_f32 v7, v99, v100, v101
 v_max3_f32 v8, v102, v103, v104
 v_max3_f32 v9, v105, v106, v107
 v_max3_f32 v6, v6, v7, v8
 v_max_f32 v6, v6, v9
 v_mov_b32 v7, v6
 s_nop 1
 v_permlane16_swap_b32 v6, v7
 v_max_f32 v6, v6, v7
 v_mov_b32 v7, v6
 s_nop 1
 v_permlane32_swap_b32 v6, v7
 v_max_f32 v6, v6, v7
 v_mul_f32 v6, s44, v6
 v_fma_f32 v96, v96, s44, -v6
 v_fma_f32 v97, v97, s44, -v6
 v_fma_f32 v98, v98, s44, -v6
 v_fma_f32 v99, v99, s44, -v6
 v_fma_f32 v100, v100, s44, -v6
 v_fma_f32 v101, v101, s44, -v6
 v_fma_f32 v102, v102, s44, -v6
 v_fma_f32 v103, v103, s44, -v6
 v_fma_f32 v104, v104, s44, -v6
 v_fma_f32 v105, v105, s44, -v6
 v_fma_f32 v106, v106, s44, -v6
 v_fma_f32 v107, v107, s44, -v6
 v_exp_f32 v96, v96
 v_exp_f32 v97, v97
 v_exp_f32 v98, v98
 v_exp_f32 v99, v99
 v_exp_f32 v100, v100
 v_exp_f32 v101, v101
 v_exp_f32 v102, v102
 v_exp_f32 v103, v103
 v_exp_f32 v104, v104
 v_exp_f32 v105, v105
 v_exp_f32 v106, v106
 v_exp_f32 v107, v107
 v_add_f32 v6, v96, v97
 v_add_f32 v6, v6, v98
 v_add_f32 v6, v6, v99
 v_add_f32 v6, v6, v100
 v_add_f32 v6, v6, v101
 v_add_f32 v6, v6, v102
 v_add_f32 v6, v6, v103
 v_add_f32 v6, v6, v104
 v_add_f32 v6, v6, v105
 v_add_f32 v6, v6, v106
 v_add_f32 v6, v6, v107
 v_mov_b32 v7, v6
 s_nop 1
 v_permlane16_swap_b32 v6, v7
 v_add_f32 v6, v6, v7
 v_mov_b32 v7, v6
 s_nop 1
 v_permlane32_swap_b32 v6, v7
 v_add_f32 v6, v6, v7
 v_rcp_f32 v6, v6
 s_nop 0
 v_mul_f32 v96, v96, v6
 v_mul_f32 v97, v97, v6
 v_mul_f32 v98, v98, v6
 v_mul_f32 v99, v99, v6
 v_mul_f32 v100, v100, v6
 v_mul_f32 v101, v101, v6
 v_mul_f32 v102, v102, v6
 v_mul_f32 v103, v103, v6
 v_mul_f32 v104, v104, v6
 v_mul_f32 v105, v105, v6
 v_mul_f32 v106, v106, v6
 v_mul_f32 v107, v107, v6
 v_cvt_pk_bf16_f32 v8, v96, v97
 v_cvt_pk_bf16_f32 v9, v98, v99
 v_cvt_pk_bf16_f32 v10, v100, v101
 v_cvt_pk_bf16_f32 v11, v102, v103
 v_cvt_pk_bf16_f32 v12, v104, v105
 v_cvt_pk_bf16_f32 v13, v106, v107
 buffer_store_dwordx4 v[8:11], v128, s[8:11], s32 offen sc1
 s_mov_b32 exec_hi, 0
 buffer_store_dwordx2 v[12:13], v129, s[8:11], s32 offen sc1
 s_mov_b32 exec_hi, -1
 s_branch wend_15
w3_14:
 s_add_u32 s28, s16, 2
 s_and_b32 s28, s28, 3
 s_lshl_b32 s28, s28, 14
 s_add_u32 s28, s28, s38
 v_mov_b32 v0, -1
 v_mov_b32 v1, -1
 v_mov_b32 v2, -1
 v_mov_b32 v3, -1
 s_mov_b32 exec_hi, 0xff
 buffer_store_dwordx4 v[0:3], v124, s[8:11], s28 offen
 s_mov_b32 exec_hi, -1
 s_barrier
 s_add_u32 s33, s16, 1
 s_min_u32 s33, s33, 63
 s_mul_i32 s28, s33, 393216
 s_add_u32 s28, s28, s37
 s_add_u32 s29, s28, 71303168
 s_add_u32 s28, s28, 46137344
 s_mov_b32 m0, 16384
 s_nop 0
 buffer_load_dwordx4 v124, s[8:11], s28 offen sc1 lds
 s_add_u32 s28, s28, 1024
 s_mov_b32 m0, 17408
 s_nop 0
 buffer_load_dwordx4 v124, s[8:11], s28 offen sc1 lds
 s_add_u32 s28, s28, 1024
 s_mov_b32 m0, 18432
 s_nop 0
 buffer_load_dwordx4 v124, s[8:11], s28 offen sc1 lds
 s_add_u32 s28, s28, 1024
 s_mov_b32 m0, 19456
 s_nop 0
 buffer_load_dwordx4 v124, s[8:11], s28 offen sc1 lds
 s_add_u32 s28, s28, 1024
 s_mov_b32 m0, 20480
 s_nop 0
 buffer_load_dwordx4 v124, s[8:11], s28 offen sc1 lds
 s_add_u32 s28, s28, 1024
 s_mov_b32 m0, 21504
 s_nop 0
 buffer_load_dwordx4 v124, s[8:11], s28 offen sc1 lds
 s_add_u32 s28, s28, 1024
 s_mov_b32 m0, 22528
 s_nop 0
 buffer_load_dwordx4 v124, s[8:11], s28 offen sc1 lds
 s_add_u32 s28, s28, 1024
 s_mov_b32 m0, 23552
 s_nop 0
 buffer_load_dwordx4 v124, s[8:11], s28 offen sc1 lds
 s_add_u32 s28, s28, 1024
 s_mov_b32 m0, 24576
 s_nop 0
 buffer_load_dwordx4 v124, s[8:11], s28 offen sc1 lds
 s_add_u32 s28, s28, 1024
 s_mov_b32 m0, 25600
 s_nop 0
 buffer_load_dwordx4 v124, s[8:11], s28 offen sc1 lds
 s_add_u32 s28, s28, 1024
 s_mov_b32 m0, 26624
 s_nop 0
 buffer_load_dwordx4 v124, s[8:11], s28 offen sc1 lds
 s_add_u32 s28, s28, 1024
 s_mov_b32 m0, 27648
 s_nop 0
 buffer_load_dwordx4 v124, s[8:11], s28 offen sc1 lds
 s_add_u32 s28, s28, 1024
 s_mov_b32 m0, 28672
 s_nop 0
 buffer_load_dwordx4 v124, s[8:11], s29 offen sc1 lds
 s_add_u32 s29, s29, 1024
 s_mov_b32 m0, 29696
 s_nop 0
 buffer_load_dwordx4 v124, s[8:11], s29 offen sc1 lds
 s_add_u32 s29, s29, 1024
 s_mov_b32 m0, 30720
 s_nop 0
 buffer_load_dwordx4 v124, s[8:11], s29 offen sc1 lds
 s_add_u32 s29, s29, 1024
 s_mov_b32 m0, 31744
 s_nop 0
 buffer_load_dwordx4 v124, s[8:11], s29 offen sc1 lds
 s_add_u32 s29, s29, 1024
 s_mov_b32 m0, 32768
 s_nop 0
 buffer_load_dwordx4 v124, s[8:11], s29 offen sc1 lds
 s_add_u32 s29, s29, 1024
 s_mov_b32 m0, 33792
 s_nop 0
 buffer_load_dwordx4 v124, s[8:11], s29 offen sc1 lds
 s_add_u32 s29, s29, 1024
 s_mov_b32 m0, 34816
 s_nop 0
 buffer_load_dwordx4 v124, s[8:11], s29 offen sc1 lds
 s_add_u32 s29, s29, 1024
 s_mov_b32 m0, 35840
 s_nop 0
 buffer_load_dwordx4 v124, s[8:11], s29 offen sc1 lds
 s_add_u32 s29, s29, 1024
 s_mov_b32 m0, 36864
 s_nop 0
 buffer_load_dwordx4 v124, s[8:11], s29 offen sc1 lds
 s_add_u32 s29, s29, 1024
 s_mov_b32 m0, 37888
 s_nop 0
 buffer_load_dwordx4 v124, s[8:11], s29 offen sc1 lds
 s_add_u32 s29, s29, 1024
 s_mov_b32 m0, 38912
 s_nop 0
 buffer_load_dwordx4 v124, s[8:11], s29 offen sc1 lds
 s_add_u32 s29, s29, 1024
 s_mov_b32 m0, 39936
 s_nop 0
 buffer_load_dwordx4 v124, s[8:11], s29 offen sc1 lds
 s_add_u32 s29, s29, 1024
 s_cmp_lt_u32 s16, 2
 s_cbranch_scc1 nf_17
 s_sub_u32 s29, s16, 2
 s_lshl_b32 s28, s29, 7
 s_add_u32 s28, s28, 6291456
 s_mov_b64 exec, 1
 v_mov_b32 v104, 0
 v_mov_b32 v105, 1
 buffer_atomic_add v105, v104, s[8:11], s28 offen sc1
 s_mov_b64 exec, -1
nf_17:
 s_add_u32 s33, s16, 2
 s_min_u32 s33, s33, 63
 s_and_b32 s28, s33, 3
 s_cbranch_scc1 fo_19
 s_lshr_b32 s28, s33, 2
 s_lshl_b32 s28, s28, 5
 s_add_u32 s28, s28, s15
 s_lshl_b32 s28, s28, 2
 s_add_u32 s28, s28, 6324224
 v_bfe_u32 v36, v124, 4, 1
 v_lshlrev_b32 v36, 12, v36
fq_18:
 buffer_load_dword v37, v36, s[8:11], s28 offen sc1
 s_waitcnt vmcnt(0)
 v_cmp_gt_u32 vcc, 2, v37
 s_cbranch_vccz fo_19
 s_sub_u32 s45, s45, 1
 s_cbranch_scc0 fq_18
 s_mov_b32 s45, 0
fo_19:
 s_branch w4_16
wend_15:
w4_16:
 s_add_u32 s16, s16, 1
 s_cmp_lt_u32 s16, 64
 s_cbranch_scc1 Sstep_6
 s_waitcnt vmcnt(0)
 s_barrier
 s_cmp_eq_u32 s14, 3
 s_cbranch_scc0 e3_20
 s_mov_b32 s29, 62
 s_lshl_b32 s28, s29, 7
 s_add_u32 s28, s28, 6291456
 s_mov_b64 exec, 1
 v_mov_b32 v104, 0
 v_mov_b32 v105, 1
 buffer_atomic_add v105, v104, s[8:11], s28 offen sc1
 s_mov_b64 exec, -1
rt_21:
 s_mov_b32 s49, 63
 s_and_b32 s28, s49, 3
 s_lshl_b32 s28, s28, 18
 s_add_u32 s28, s28, s50
 buffer_load_dwordx4 v[8:11], v124, s[8:11], s28 offen offset:0 sc1
 buffer_load_dwordx4 v[12:15], v124, s[8:11], s28 offen offset:1024 sc1
 buffer_load_dwordx4 v[16:19], v124, s[8:11], s28 offen offset:2048 sc1
 buffer_load_dwordx4 v[20:23], v124, s[8:11], s28 offen offset:3072 sc1
 s_add_u32 s28, s28, 4096
 buffer_load_dwordx4 v[24:27], v124, s[8:11], s28 offen offset:0 sc1
 buffer_load_dwordx4 v[28:31], v124, s[8:11], s28 offen offset:1024 sc1
 buffer_load_dwordx4 v[32:35], v124, s[8:11], s28 offen offset:2048 sc1
 buffer_load_dwordx4 v[36:39], v124, s[8:11], s28 offen offset:3072 sc1
 s_add_u32 s28, s28, 4096
 buffer_load_dwordx4 v[40:43], v124, s[8:11], s28 offen offset:0 sc1
 buffer_load_dwordx4 v[44:47], v124, s[8:11], s28 offen offset:1024 sc1
 s_waitcnt vmcnt(0)
 v_max3_u32 v0, v8, v12, v16
 v_max3_u32 v1, v20, v24, v28
 v_max3_u32 v2, v32, v36, v40
 v_max3_u32 v3, v44, v0, v1
 v_max_u32 v4, v2, v3
 v_cmp_eq_u32 vcc, -1, v4
 s_cbranch_vccz ok_22
 s_sub_u32 s45, s45, 1
 s_cbranch_scc0 rt_21
 s_mov_b32 s45, 0
ok_22:
 s_mul_i32 s28, s49, 327680
 s_add_u32 s28, s28, s51
 buffer_store_dwordx4 v[8:11], v124, s[8:11], s28 offen offset:0 sc1
 buffer_store_dwordx4 v[12:15], v124, s[8:11], s28 offen offset:1024 sc1
 buffer_store_dwordx4 v[16:19], v124, s[8:11], s28 offen offset:2048 sc1
 buffer_store_dwordx4 v[20:23], v124, s[8:11], s28 offen offset:3072 sc1
 s_add_u32 s28, s28, 4096
 buffer_store_dwordx4 v[24:27], v124, s[8:11], s28 offen offset:0 sc1
 buffer_store_dwordx4 v[28:31], v124, s[8:11], s28 offen offset:1024 sc1
 buffer_store_dwordx4 v[32:35], v124, s[8:11], s28 offen offset:2048 sc1
 buffer_store_dwordx4 v[36:39], v124, s[8:11], s28 offen offset:3072 sc1
 s_add_u32 s28, s28, 4096
 buffer_store_dwordx4 v[40:43], v124, s[8:11], s28 offen offset:0 sc1
 buffer_store_dwordx4 v[44:47], v124, s[8:11], s28 offen offset:1024 sc1
 s_waitcnt vmcnt(0)
 s_mov_b32 s29, 63
 s_lshl_b32 s28, s29, 7
 s_add_u32 s28, s28, 6291456
 s_mov_b64 exec, 1
 v_mov_b32 v104, 0
 v_mov_b32 v105, 1
 buffer_atomic_add v105, v104, s[8:11], s28 offen sc1
 s_mov_b64 exec, -1
e3_20:
 s_mov_b32 s46, s13
 s_endpgm
role_V_fast:
 v_lshlrev_b32 v148, 4, v0
 v_add_u32 v1, 1024, v0
 v_lshlrev_b32 v149, 3, v1
 v_and_b32 v2, 63, v0
 v_lshlrev_b32 v152, 4, v2
 v_lshrrev_b32 v3, 4, v2
 v_and_b32 v4, 15, v2
 v_bfe_u32 v5, v4, 1, 1
 v_lshrrev_b32 v6, 2, v4
 v_and_b32 v7, 1, v4
 v_lshl_add_u32 v6, v6, 1, v7
 v_lshlrev_b32 v150, 8, v3
 v_lshl_add_u32 v150, v5, 7, v150
 v_lshl_add_u32 v150, v6, 4, v150
 v_mov_b32 v151, 0x4444
 v_mov_b32 v7, 0xeeee
 v_cmp_eq_u32 vcc, 1, v5
 s_nop 1
 v_cndmask_b32 v151, v151, v7, vcc
 s_mov_b32 s42, 0x00003f80
 s_mov_b32 s43, 0x3f800000
 s_mov_b32 s40, 0x00ff00ff
 s_mov_b32 s41, 0x00ff00ff
 s_mov_b32 s45, 200000
 s_lshl_b32 s36, s12, 16
 s_add_u32 s36, s36, 3145728
 s_lshl_b32 s18, s12, 3
 s_lshl_b32 s46, s12, 7
 s_add_u32 s46, s46, 6344704
 s_mov_b32 s16, 0
 s_mul_i32 s28, s14, 384
 s_add_u32 s28, s28, 0
 v_add_u32 v8, s28, v2
 v_mul_u32_u24 v9, 0xaaab, v8
 v_lshrrev_b32 v9, 20, v9
 v_mul_u32_u24 v10, 24, v9
 v_sub_u32 v10, v8, v10
 v_bfe_u32 v11, v9, 2, 2
 v_lshlrev_b32 v11, 1, v11
 v_xor_b32 v10, v10, v11
 v_mul_u32_u24 v9, 12288, v9
 v_lshl_add_u32 v153, v10, 4, v9
 s_mul_i32 s28, s14, 384
 s_add_u32 s28, s28, 64
 v_add_u32 v8, s28, v2
 v_mul_u32_u24 v9, 0xaaab, v8
 v_lshrrev_b32 v9, 20, v9
 v_mul_u32_u24 v10, 24, v9
 v_sub_u32 v10, v8, v10
 v_bfe_u32 v11, v9, 2, 2
 v_lshlrev_b32 v11, 1, v11
 v_xor_b32 v10, v10, v11
 v_mul_u32_u24 v9, 12288, v9
 v_lshl_add_u32 v154, v10, 4, v9
 s_mul_i32 s28, s14, 384
 s_add_u32 s28, s28, 128
 v_add_u32 v8, s28, v2
 v_mul_u32_u24 v9, 0xaaab, v8
 v_lshrrev_b32 v9, 20, v9
 v_mul_u32_u24 v10, 24, v9
 v_sub_u32 v10, v8, v10
 v_bfe_u32 v11, v9, 2, 2
 v_lshlrev_b32 v11, 1, v11
 v_xor_b32 v10, v10, v11
 v_mul_u32_u24 v9, 12288, v9
 v_lshl_add_u32 v155, v10, 4, v9
 s_mul_i32 s28, s14, 384
 s_add_u32 s28, s28, 192
 v_add_u32 v8, s28, v2
 v_mul_u32_u24 v9, 0xaaab, v8
 v_lshrrev_b32 v9, 20, v9
 v_mul_u32_u24 v10, 24, v9
 v_sub_u32 v10, v8, v10
 v_bfe_u32 v11, v9, 2, 2
 v_lshlrev_b32 v11, 1, v11
 v_xor_b32 v10, v10, v11
 v_mul_u32_u24 v9, 12288, v9
 v_lshl_add_u32 v156, v10, 4, v9
 s_mul_i32 s28, s14, 384
 s_add_u32 s28, s28, 256
 v_add_u32 v8, s28, v2
 v_mul_u32_u24 v9, 0xaaab, v8
 v_lshrrev_b32 v9, 20, v9
 v_mul_u32_u24 v10, 24, v9
 v_sub_u32 v10, v8, v10
 v_bfe_u32 v11, v9, 2, 2
 v_lshlrev_b32 v11, 1, v11
 v_xor_b32 v10, v10, v11
 v_mul_u32_u24 v9, 12288, v9
 v_lshl_add_u32 v157, v10, 4, v9
 s_mul_i32 s28, s14, 384
 s_add_u32 s28, s28, 320
 v_add_u32 v8, s28, v2
 v_mul_u32_u24 v9, 0xaaab, v8
 v_lshrrev_b32 v9, 20, v9
 v_mul_u32_u24 v10, 24, v9
 v_sub_u32 v10, v8, v10
 v_bfe_u32 v11, v9, 2, 2
 v_lshlrev_b32 v11, 1, v11
 v_xor_b32 v10, v10, v11
 v_mul_u32_u24 v9, 12288, v9
 v_lshl_add_u32 v158, v10, 4, v9
 v_lshrrev_b32 v8, 1, v3
 v_lshlrev_b32 v8, 4, v8
 v_and_b32 v9, 1, v3
 v_lshl_add_u32 v8, v9, 2, v8
 v_lshrrev_b32 v9, 2, v4
 v_and_b32 v10, 1, v9
 v_add_u32 v8, v8, v10
 v_lshrrev_b32 v11, 1, v9
 v_lshl_add_u32 v8, v11, 3, v8
 v_bfe_u32 v11, v8, 2, 2
 v_mul_u32_u24 v8, 384, v8
 v_and_b32 v9, 3, v2
 v_lshl_add_u32 v8, v9, 3, v8
 s_mul_i32 s28, s14, 3
 s_add_u32 s28, s28, 0
 v_xor_b32 v9, s28, v11
 v_lshl_add_u32 v163, v9, 5, v8
 s_mul_i32 s28, s14, 3
 s_add_u32 s28, s28, 1
 v_xor_b32 v9, s28, v11
 v_lshl_add_u32 v164, v9, 5, v8
 s_mul_i32 s28, s14, 3
 s_add_u32 s28, s28, 2
 v_xor_b32 v9, s28, v11
 v_lshl_add_u32 v165, v9, 5, v8
 v_lshrrev_b32 v8, 1, v3
 v_lshlrev_b32 v8, 4, v8
 v_and_b32 v9, 1, v3
 v_lshl_add_u32 v8, v9, 2, v8
 v_lshrrev_b32 v9, 2, v4
 v_and_b32 v10, 1, v9
 v_add_u32 v8, v8, v10
 v_lshrrev_b32 v11, 1, v9
 v_lshl_add_u32 v8, v11, 3, v8
 v_bfe_u32 v11, v8, 2, 2
 v_lshl_add_u32 v11, v11, 1, v10
 v_mul_u32_u24 v8, 256, v8
 v_and_b32 v9, 3, v2
 v_lshl_add_u32 v8, v9, 3, v8
 s_mul_i32 s28, s14, 2
 s_add_u32 s28, s28, 0
 v_xor_b32 v9, s28, v11
 v_lshl_add_u32 v166, v9, 5, v8
 s_mul_i32 s28, s14, 2
 s_add_u32 s28, s28, 1
 v_xor_b32 v9, s28, v11
 v_lshl_add_u32 v5, v9, 5, v8
 s_lshl_b32 s28, s14, 4
 s_add_u32 s28, s28, 0
 v_add_u32 v8, s28, v3
 v_mul_u32_u24 v8, 1280, v8
 v_and_b32 v9, 1, v3
 v_or_b32 v9, 0, v9
 v_lshlrev_b32 v9, 1, v9
 v_xor_b32 v9, v9, v4
 v_lshl_add_u32 v159, v9, 4, v8
 s_lshl_b32 s28, s14, 4
 s_add_u32 s28, s28, 4
 v_add_u32 v8, s28, v3
 v_mul_u32_u24 v8, 1280, v8
 v_and_b32 v9, 1, v3
 v_or_b32 v9, 2, v9
 v_lshlrev_b32 v9, 1, v9
 v_xor_b32 v9, v9, v4
 v_lshl_add_u32 v160, v9, 4, v8
 s_lshl_b32 s28, s14, 4
 s_add_u32 s28, s28, 8
 v_add_u32 v8, s28, v3
 v_mul_u32_u24 v8, 1280, v8
 v_and_b32 v9, 1, v3
 v_or_b32 v9, 4, v9
 v_lshlrev_b32 v9, 1, v9
 v_xor_b32 v9, v9, v4
 v_lshl_add_u32 v161, v9, 4, v8
 s_lshl_b32 s28, s14, 4
 s_add_u32 s28, s28, 12
 v_add_u32 v8, s28, v3
 v_mul_u32_u24 v8, 1280, v8
 v_and_b32 v9, 1, v3
 v_or_b32 v9, 6, v9
 v_lshlrev_b32 v9, 1, v9
 v_xor_b32 v9, v9, v4
 v_lshl_add_u32 v162, v9, 4, v8
 s_mul_i32 s47, s15, 384
 s_mul_i32 s48, s15, 245760
 s_mul_i32 s28, s14, 6144
 s_add_u32 m0, s28, 0
 s_add_u32 s29, s47, 0
 buffer_load_dwordx4 v153, s[20:23], s29 offen lds
 s_mul_i32 s28, s14, 6144
 s_add_u32 m0, s28, 1024
 s_add_u32 s29, s47, 0
 buffer_load_dwordx4 v154, s[20:23], s29 offen lds
 s_mul_i32 s28, s14, 6144
 s_add_u32 m0, s28, 2048
 s_add_u32 s29, s47, 0
 buffer_load_dwordx4 v155, s[20:23], s29 offen lds
 s_mul_i32 s28, s14, 6144
 s_add_u32 m0, s28, 3072
 s_add_u32 s29, s47, 0
 buffer_load_dwordx4 v156, s[20:23], s29 offen lds
 s_mul_i32 s28, s14, 6144
 s_add_u32 m0, s28, 4096
 s_add_u32 s29, s47, 0
 buffer_load_dwordx4 v157, s[20:23], s29 offen lds
 s_mul_i32 s28, s14, 6144
 s_add_u32 m0, s28, 5120
 s_add_u32 s29, s47, 0
 buffer_load_dwordx4 v158, s[20:23], s29 offen lds
 s_mul_i32 s28, s14, 6144
 s_add_u32 m0, s28, 24576
 s_add_u32 s29, s47, 786432
 buffer_load_dwordx4 v153, s[20:23], s29 offen lds
 s_mul_i32 s28, s14, 6144
 s_add_u32 m0, s28, 25600
 s_add_u32 s29, s47, 786432
 buffer_load_dwordx4 v154, s[20:23], s29 offen lds
 s_mul_i32 s28, s14, 6144
 s_add_u32 m0, s28, 26624
 s_add_u32 s29, s47, 786432
 buffer_load_dwordx4 v155, s[20:23], s29 offen lds
 s_mul_i32 s28, s14, 6144
 s_add_u32 m0, s28, 27648
 s_add_u32 s29, s47, 786432
 buffer_load_dwordx4 v156, s[20:23], s29 offen lds
 s_mul_i32 s28, s14, 6144
 s_add_u32 m0, s28, 28672
 s_add_u32 s29, s47, 786432
 buffer_load_dwordx4 v157, s[20:23], s29 offen lds
 s_mul_i32 s28, s14, 6144
 s_add_u32 m0, s28, 29696
 s_add_u32 s29, s47, 786432
 buffer_load_dwordx4 v158, s[20:23], s29 offen lds
 s_mul_i32 s28, s14, 6144
 s_add_u32 m0, s28, 49152
 s_add_u32 s29, s47, 1572864
 buffer_load_dwordx4 v153, s[20:23], s29 offen lds
 s_mul_i32 s28, s14, 6144
 s_add_u32 m0, s28, 50176
 s_add_u32 s29, s47, 1572864
 buffer_load_dwordx4 v154, s[20:23], s29 offen lds
 s_mul_i32 s28, s14, 6144
 s_add_u32 m0, s28, 51200
 s_add_u32 s29, s47, 1572864
 buffer_load_dwordx4 v155, s[20:23], s29 offen lds
 s_mul_i32 s28, s14, 6144
 s_add_u32 m0, s28, 52224
 s_add_u32 s29, s47, 1572864
 buffer_load_dwordx4 v156, s[20:23], s29 offen lds
 s_mul_i32 s28, s14, 6144
 s_add_u32 m0, s28, 53248
 s_add_u32 s29, s47, 1572864
 buffer_load_dwordx4 v157, s[20:23], s29 offen lds
 s_mul_i32 s28, s14, 6144
 s_add_u32 m0, s28, 54272
 s_add_u32 s29, s47, 1572864
 buffer_load_dwordx4 v158, s[20:23], s29 offen lds
 s_mul_i32 s28, s14, 6144
 s_add_u32 m0, s28, 73728
 s_add_u32 s29, s47, 2359296
 buffer_load_dwordx4 v153, s[20:23], s29 offen lds
 s_mul_i32 s28, s14, 6144
 s_add_u32 m0, s28, 74752
 s_add_u32 s29, s47, 2359296
 buffer_load_dwordx4 v154, s[20:23], s29 offen lds
 s_mul_i32 s28, s14, 6144
 s_add_u32 m0, s28, 75776
 s_add_u32 s29, s47, 2359296
 buffer_load_dwordx4 v155, s[20:23], s29 offen lds
 s_mul_i32 s28, s14, 6144
 s_add_u32 m0, s28, 76800
 s_add_u32 s29, s47, 2359296
 buffer_load_dwordx4 v156, s[20:23], s29 offen lds
 s_mul_i32 s28, s14, 6144
 s_add_u32 m0, s28, 77824
 s_add_u32 s29, s47, 2359296
 buffer_load_dwordx4 v157, s[20:23], s29 offen lds
 s_mul_i32 s28, s14, 6144
 s_add_u32 m0, s28, 78848
 s_add_u32 s29, s47, 2359296
 buffer_load_dwordx4 v158, s[20:23], s29 offen lds
 s_mul_i32 s28, s14, 6144
 s_add_u32 m0, s28, 98304
 s_add_u32 s29, s47, 3145728
 buffer_load_dwordx4 v153, s[20:23], s29 offen lds
 s_mul_i32 s28, s14, 6144
 s_add_u32 m0, s28, 99328
 s_add_u32 s29, s47, 3145728
 buffer_load_dwordx4 v154, s[20:23], s29 offen lds
 s_mul_i32 s28, s14, 6144
 s_add_u32 m0, s28, 100352
 s_add_u32 s29, s47, 3145728
 buffer_load_dwordx4 v155, s[20:23], s29 offen lds
 s_mul_i32 s28, s14, 6144
 s_add_u32 m0, s28, 101376
 s_add_u32 s29, s47, 3145728
 buffer_load_dwordx4 v156, s[20:23], s29 offen lds
 s_mul_i32 s28, s14, 6144
 s_add_u32 m0, s28, 102400
 s_add_u32 s29, s47, 3145728
 buffer_load_dwordx4 v157, s[20:23], s29 offen lds
 s_mul_i32 s28, s14, 6144
 s_add_u32 m0, s28, 103424
 s_add_u32 s29, s47, 3145728
 buffer_load_dwordx4 v158, s[20:23], s29 offen lds
 s_waitcnt vmcnt(24) lgkmcnt(0)
 s_barrier
 s_mul_i32 s28, s14, 6144
 s_add_u32 m0, s28, 122880
 s_add_u32 s29, s47, 3932160
 buffer_load_dwordx4 v153, s[20:23], s29 offen lds
 s_mul_i32 s28, s14, 6144
 s_add_u32 m0, s28, 123904
 s_add_u32 s29, s47, 3932160
 buffer_load_dwordx4 v154, s[20:23], s29 offen lds
 s_mul_i32 s28, s14, 6144
 s_add_u32 m0, s28, 124928
 s_add_u32 s29, s47, 3932160
 buffer_load_dwordx4 v155, s[20:23], s29 offen lds
 s_mul_i32 s28, s14, 6144
 s_add_u32 m0, s28, 125952
 s_add_u32 s29, s47, 3932160
 buffer_load_dwordx4 v156, s[20:23], s29 offen lds
 s_mul_i32 s28, s14, 6144
 s_add_u32 m0, s28, 126976
 s_add_u32 s29, s47, 3932160
 buffer_load_dwordx4 v157, s[20:23], s29 offen lds
 s_mul_i32 s28, s14, 6144
 s_add_u32 m0, s28, 128000
 s_add_u32 s29, s47, 3932160
 buffer_load_dwordx4 v158, s[20:23], s29 offen lds
 v_add_u32 v167, 0, v163
 ds_read_b64_tr_b16 a[0:1], v167 offset:0
 ds_read_b64_tr_b16 a[2:3], v167 offset:768
 ds_read_b64_tr_b16 a[4:5], v167 offset:12288
 ds_read_b64_tr_b16 a[6:7], v167 offset:13056
 v_add_u32 v167, 0, v164
 ds_read_b64_tr_b16 a[8:9], v167 offset:0
 ds_read_b64_tr_b16 a[10:11], v167 offset:768
 ds_read_b64_tr_b16 a[12:13], v167 offset:12288
 ds_read_b64_tr_b16 a[14:15], v167 offset:13056
 v_add_u32 v167, 0, v165
 ds_read_b64_tr_b16 v[12:13], v167 offset:0
 ds_read_b64_tr_b16 v[14:15], v167 offset:768
 ds_read_b64_tr_b16 v[16:17], v167 offset:12288
 ds_read_b64_tr_b16 v[18:19], v167 offset:13056
 s_waitcnt vmcnt(24) lgkmcnt(0)
 s_barrier
 s_mul_i32 s28, s14, 6144
 s_add_u32 m0, s28, 0
 s_add_u32 s29, s47, 4718592
 buffer_load_dwordx4 v153, s[20:23], s29 offen lds
 s_mul_i32 s28, s14, 6144
 s_add_u32 m0, s28, 1024
 s_add_u32 s29, s47, 4718592
 buffer_load_dwordx4 v154, s[20:23], s29 offen lds
 s_mul_i32 s28, s14, 6144
 s_add_u32 m0, s28, 2048
 s_add_u32 s29, s47, 4718592
 buffer_load_dwordx4 v155, s[20:23], s29 offen lds
 s_mul_i32 s28, s14, 6144
 s_add_u32 m0, s28, 3072
 s_add_u32 s29, s47, 4718592
 buffer_load_dwordx4 v156, s[20:23], s29 offen lds
 s_mul_i32 s28, s14, 6144
 s_add_u32 m0, s28, 4096
 s_add_u32 s29, s47, 4718592
 buffer_load_dwordx4 v157, s[20:23], s29 offen lds
 s_mul_i32 s28, s14, 6144
 s_add_u32 m0, s28, 5120
 s_add_u32 s29, s47, 4718592
 buffer_load_dwordx4 v158, s[20:23], s29 offen lds
 v_add_u32 v167, 24576, v163
 ds_read_b64_tr_b16 a[16:17], v167 offset:0
 ds_read_b64_tr_b16 a[18:19], v167 offset:768
 ds_read_b64_tr_b16 a[20:21], v167 offset:12288
 ds_read_b64_tr_b16 a[22:23], v167 offset:13056
 v_add_u32 v167, 24576, v164
 ds_read_b64_tr_b16 a[24:25], v167 offset:0
 ds_read_b64_tr_b16 a[26:27], v167 offset:768
 ds_read_b64_tr_b16 a[28:29], v167 offset:12288
 ds_read_b64_tr_b16 a[30:31], v167 offset:13056
 v_add_u32 v167, 24576, v165
 ds_read_b64_tr_b16 v[20:21], v167 offset:0
 ds_read_b64_tr_b16 v[22:23], v167 offset:768
 ds_read_b64_tr_b16 v[24:25], v167 offset:12288
 ds_read_b64_tr_b16 v[26:27], v167 offset:13056
 s_waitcnt vmcnt(24) lgkmcnt(0)
 s_barrier
 s_mul_i32 s28, s14, 6144
 s_add_u32 m0, s28, 24576
 s_add_u32 s29, s47, 5505024
 buffer_load_dwordx4 v153, s[20:23], s29 offen lds
 s_mul_i32 s28, s14, 6144
 s_add_u32 m0, s28, 25600
 s_add_u32 s29, s47, 5505024
 buffer_load_dwordx4 v154, s[20:23], s29 offen lds
 s_mul_i32 s28, s14, 6144
 s_add_u32 m0, s28, 26624
 s_add_u32 s29, s47, 5505024
 buffer_load_dwordx4 v155, s[20:23], s29 offen lds
 s_mul_i32 s28, s14, 6144
 s_add_u32 m0, s28, 27648
 s_add_u32 s29, s47, 5505024
 buffer_load_dwordx4 v156, s[20:23], s29 offen lds
 s_mul_i32 s28, s14, 6144
 s_add_u32 m0, s28, 28672
 s_add_u32 s29, s47, 5505024
 buffer_load_dwordx4 v157, s[20:23], s29 offen lds
 s_mul_i32 s28, s14, 6144
 s_add_u32 m0, s28, 29696
 s_add_u32 s29, s47, 5505024
 buffer_load_dwordx4 v158, s[20:23], s29 offen lds
 v_add_u32 v167, 49152, v163
 ds_read_b64_tr_b16 a[32:33], v167 offset:0
 ds_read_b64_tr_b16 a[34:35], v167 offset:768
 ds_read_b64_tr_b16 a[36:37], v167 offset:12288
 ds_read_b64_tr_b16 a[38:39], v167 offset:13056
 v_add_u32 v167, 49152, v164
 ds_read_b64_tr_b16 a[40:41], v167 offset:0
 ds_read_b64_tr_b16 a[42:43], v167 offset:768
 ds_read_b64_tr_b16 a[44:45], v167 offset:12288
 ds_read_b64_tr_b16 a[46:47], v167 offset:13056
 v_add_u32 v167, 49152, v165
 ds_read_b64_tr_b16 a[48:49], v167 offset:0
 ds_read_b64_tr_b16 a[50:51], v167 offset:768
 ds_read_b64_tr_b16 a[52:53], v167 offset:12288
 ds_read_b64_tr_b16 a[54:55], v167 offset:13056
 s_waitcnt vmcnt(24) lgkmcnt(0)
 s_barrier
 s_mul_i32 s28, s14, 6144
 s_add_u32 m0, s28, 49152
 s_add_u32 s29, s47, 6291456
 buffer_load_dwordx4 v153, s[20:23], s29 offen lds
 s_mul_i32 s28, s14, 6144
 s_add_u32 m0, s28, 50176
 s_add_u32 s29, s47, 6291456
 buffer_load_dwordx4 v154, s[20:23], s29 offen lds
 s_mul_i32 s28, s14, 6144
 s_add_u32 m0, s28, 51200
 s_add_u32 s29, s47, 6291456
 buffer_load_dwordx4 v155, s[20:23], s29 offen lds
 s_mul_i32 s28, s14, 6144
 s_add_u32 m0, s28, 52224
 s_add_u32 s29, s47, 6291456
 buffer_load_dwordx4 v156, s[20:23], s29 offen lds
 s_mul_i32 s28, s14, 6144
 s_add_u32 m0, s28, 53248
 s_add_u32 s29, s47, 6291456
 buffer_load_dwordx4 v157, s[20:23], s29 offen lds
 s_mul_i32 s28, s14, 6144
 s_add_u32 m0, s28, 54272
 s_add_u32 s29, s47, 6291456
 buffer_load_dwordx4 v158, s[20:23], s29 offen lds
 v_add_u32 v167, 73728, v163
 ds_read_b64_tr_b16 v[28:29], v167 offset:0
 ds_read_b64_tr_b16 v[30:31], v167 offset:768
 ds_read_b64_tr_b16 v[32:33], v167 offset:12288
 ds_read_b64_tr_b16 v[34:35], v167 offset:13056
 v_add_u32 v167, 73728, v164
 ds_read_b64_tr_b16 a[56:57], v167 offset:0
 ds_read_b64_tr_b16 a[58:59], v167 offset:768
 ds_read_b64_tr_b16 a[60:61], v167 offset:12288
 ds_read_b64_tr_b16 a[62:63], v167 offset:13056
 v_add_u32 v167, 73728, v165
 ds_read_b64_tr_b16 a[64:65], v167 offset:0
 ds_read_b64_tr_b16 a[66:67], v167 offset:768
 ds_read_b64_tr_b16 a[68:69], v167 offset:12288
 ds_read_b64_tr_b16 a[70:71], v167 offset:13056
 s_waitcnt vmcnt(24) lgkmcnt(0)
 s_barrier
 s_mul_i32 s28, s14, 6144
 s_add_u32 m0, s28, 73728
 s_add_u32 s29, s47, 7077888
 buffer_load_dwordx4 v153, s[20:23], s29 offen lds
 s_mul_i32 s28, s14, 6144
 s_add_u32 m0, s28, 74752
 s_add_u32 s29, s47, 7077888
 buffer_load_dwordx4 v154, s[20:23], s29 offen lds
 s_mul_i32 s28, s14, 6144
 s_add_u32 m0, s28, 75776
 s_add_u32 s29, s47, 7077888
 buffer_load_dwordx4 v155, s[20:23], s29 offen lds
 s_mul_i32 s28, s14, 6144
 s_add_u32 m0, s28, 76800
 s_add_u32 s29, s47, 7077888
 buffer_load_dwordx4 v156, s[20:23], s29 offen lds
 s_mul_i32 s28, s14, 6144
 s_add_u32 m0, s28, 77824
 s_add_u32 s29, s47, 7077888
 buffer_load_dwordx4 v157, s[20:23], s29 offen lds
 s_mul_i32 s28, s14, 6144
 s_add_u32 m0, s28, 78848
 s_add_u32 s29, s47, 7077888
 buffer_load_dwordx4 v158, s[20:23], s29 offen lds
 v_add_u32 v167, 98304, v163
 ds_read_b64_tr_b16 v[36:37], v167 offset:0
 ds_read_b64_tr_b16 v[38:39], v167 offset:768
 ds_read_b64_tr_b16 v[40:41], v167 offset:12288
 ds_read_b64_tr_b16 v[42:43], v167 offset:13056
 v_add_u32 v167, 98304, v164
 ds_read_b64_tr_b16 a[72:73], v167 offset:0
 ds_read_b64_tr_b16 a[74:75], v167 offset:768
 ds_read_b64_tr_b16 a[76:77], v167 offset:12288
 ds_read_b64_tr_b16 a[78:79], v167 offset:13056
 v_add_u32 v167, 98304, v165
 ds_read_b64_tr_b16 a[80:81], v167 offset:0
 ds_read_b64_tr_b16 a[82:83], v167 offset:768
 ds_read_b64_tr_b16 a[84:85], v167 offset:12288
 ds_read_b64_tr_b16 a[86:87], v167 offset:13056
 s_waitcnt vmcnt(24) lgkmcnt(0)
 s_barrier
 s_mul_i32 s28, s14, 4096
 s_add_u32 m0, s28, 98304
 s_add_u32 s29, s48, 0
 buffer_load_dwordx4 v159, s[24:27], s29 offen lds
 s_mul_i32 s28, s14, 4096
 s_add_u32 m0, s28, 99328
 s_add_u32 s29, s48, 0
 buffer_load_dwordx4 v160, s[24:27], s29 offen lds
 s_mul_i32 s28, s14, 4096
 s_add_u32 m0, s28, 100352
 s_add_u32 s29, s48, 0
 buffer_load_dwordx4 v161, s[24:27], s29 offen lds
 s_mul_i32 s28, s14, 4096
 s_add_u32 m0, s28, 101376
 s_add_u32 s29, s48, 0
 buffer_load_dwordx4 v162, s[24:27], s29 offen lds
 v_add_u32 v167, 122880, v163
 ds_read_b64_tr_b16 a[88:89], v167 offset:0
 ds_read_b64_tr_b16 a[90:91], v167 offset:768
 ds_read_b64_tr_b16 a[92:93], v167 offset:12288
 ds_read_b64_tr_b16 a[94:95], v167 offset:13056
 v_add_u32 v167, 122880, v164
 ds_read_b64_tr_b16 v[52:53], v167 offset:0
 ds_read_b64_tr_b16 v[54:55], v167 offset:768
 ds_read_b64_tr_b16 v[56:57], v167 offset:12288
 ds_read_b64_tr_b16 v[58:59], v167 offset:13056
 v_add_u32 v167, 122880, v165
 ds_read_b64_tr_b16 a[96:97], v167 offset:0
 ds_read_b64_tr_b16 a[98:99], v167 offset:768
 ds_read_b64_tr_b16 a[100:101], v167 offset:12288
 ds_read_b64_tr_b16 a[102:103], v167 offset:13056
 s_waitcnt vmcnt(22) lgkmcnt(0)
 s_barrier
 s_mul_i32 s28, s14, 4096
 s_add_u32 m0, s28, 122880
 s_add_u32 s29, s48, 256
 buffer_load_dwordx4 v159, s[24:27], s29 offen lds
 s_mul_i32 s28, s14, 4096
 s_add_u32 m0, s28, 123904
 s_add_u32 s29, s48, 256
 buffer_load_dwordx4 v160, s[24:27], s29 offen lds
 s_mul_i32 s28, s14, 4096
 s_add_u32 m0, s28, 124928
 s_add_u32 s29, s48, 256
 buffer_load_dwordx4 v161, s[24:27], s29 offen lds
 s_mul_i32 s28, s14, 4096
 s_add_u32 m0, s28, 125952
 s_add_u32 s29, s48, 256
 buffer_load_dwordx4 v162, s[24:27], s29 offen lds
 v_add_u32 v167, 0, v163
 ds_read_b64_tr_b16 a[104:105], v167 offset:0
 ds_read_b64_tr_b16 a[106:107], v167 offset:768
 ds_read_b64_tr_b16 a[108:109], v167 offset:12288
 ds_read_b64_tr_b16 a[110:111], v167 offset:13056
 v_add_u32 v167, 0, v164
 ds_read_b64_tr_b16 a[112:113], v167 offset:0
 ds_read_b64_tr_b16 a[114:115], v167 offset:768
 ds_read_b64_tr_b16 a[116:117], v167 offset:12288
 ds_read_b64_tr_b16 a[118:119], v167 offset:13056
 v_add_u32 v167, 0, v165
 ds_read_b64_tr_b16 v[68:69], v167 offset:0
 ds_read_b64_tr_b16 v[70:71], v167 offset:768
 ds_read_b64_tr_b16 v[72:73], v167 offset:12288
 ds_read_b64_tr_b16 v[74:75], v167 offset:13056
 s_waitcnt vmcnt(20) lgkmcnt(0)
 s_barrier
 s_mul_i32 s28, s14, 4096
 s_add_u32 m0, s28, 0
 s_add_u32 s29, s48, 512
 buffer_load_dwordx4 v159, s[24:27], s29 offen lds
 s_mul_i32 s28, s14, 4096
 s_add_u32 m0, s28, 1024
 s_add_u32 s29, s48, 512
 buffer_load_dwordx4 v160, s[24:27], s29 offen lds
 s_mul_i32 s28, s14, 4096
 s_add_u32 m0, s28, 2048
 s_add_u32 s29, s48, 512
 buffer_load_dwordx4 v161, s[24:27], s29 offen lds
 s_mul_i32 s28, s14, 4096
 s_add_u32 m0, s28, 3072
 s_add_u32 s29, s48, 512
 buffer_load_dwordx4 v162, s[24:27], s29 offen lds
 v_add_u32 v167, 24576, v163
 ds_read_b64_tr_b16 a[120:121], v167 offset:0
 ds_read_b64_tr_b16 a[122:123], v167 offset:768
 ds_read_b64_tr_b16 a[124:125], v167 offset:12288
 ds_read_b64_tr_b16 a[126:127], v167 offset:13056
 v_add_u32 v167, 24576, v164
 ds_read_b64_tr_b16 a[128:129], v167 offset:0
 ds_read_b64_tr_b16 a[130:131], v167 offset:768
 ds_read_b64_tr_b16 a[132:133], v167 offset:12288
 ds_read_b64_tr_b16 a[134:135], v167 offset:13056
 v_add_u32 v167, 24576, v165
 ds_read_b64_tr_b16 a[136:137], v167 offset:0
 ds_read_b64_tr_b16 a[138:139], v167 offset:768
 ds_read_b64_tr_b16 a[140:141], v167 offset:12288
 ds_read_b64_tr_b16 a[142:143], v167 offset:13056
 s_waitcnt vmcnt(18) lgkmcnt(0)
 s_barrier
 s_mul_i32 s28, s14, 4096
 s_add_u32 m0, s28, 24576
 s_add_u32 s29, s48, 768
 buffer_load_dwordx4 v159, s[24:27], s29 offen lds
 s_mul_i32 s28, s14, 4096
 s_add_u32 m0, s28, 25600
 s_add_u32 s29, s48, 768
 buffer_load_dwordx4 v160, s[24:27], s29 offen lds
 s_mul_i32 s28, s14, 4096
 s_add_u32 m0, s28, 26624
 s_add_u32 s29, s48, 768
 buffer_load_dwordx4 v161, s[24:27], s29 offen lds
 s_mul_i32 s28, s14, 4096
 s_add_u32 m0, s28, 27648
 s_add_u32 s29, s48, 768
 buffer_load_dwordx4 v162, s[24:27], s29 offen lds
 v_add_u32 v167, 49152, v163
 ds_read_b64_tr_b16 v[44:45], v167 offset:0
 ds_read_b64_tr_b16 v[46:47], v167 offset:768
 ds_read_b64_tr_b16 v[48:49], v167 offset:12288
 ds_read_b64_tr_b16 v[50:51], v167 offset:13056
 v_add_u32 v167, 49152, v164
 ds_read_b64_tr_b16 a[144:145], v167 offset:0
 ds_read_b64_tr_b16 a[146:147], v167 offset:768
 ds_read_b64_tr_b16 a[148:149], v167 offset:12288
 ds_read_b64_tr_b16 a[150:151], v167 offset:13056
 v_add_u32 v167, 49152, v165
 ds_read_b64_tr_b16 a[152:153], v167 offset:0
 ds_read_b64_tr_b16 a[154:155], v167 offset:768
 ds_read_b64_tr_b16 a[156:157], v167 offset:12288
 ds_read_b64_tr_b16 a[158:159], v167 offset:13056
 s_waitcnt vmcnt(16) lgkmcnt(0)
 s_barrier
 s_mul_i32 s28, s14, 4096
 s_add_u32 m0, s28, 49152
 s_add_u32 s29, s48, 1024
 buffer_load_dwordx4 v159, s[24:27], s29 offen lds
 s_mul_i32 s28, s14, 4096
 s_add_u32 m0, s28, 50176
 s_add_u32 s29, s48, 1024
 buffer_load_dwordx4 v160, s[24:27], s29 offen lds
 s_mul_i32 s28, s14, 4096
 s_add_u32 m0, s28, 51200
 s_add_u32 s29, s48, 1024
 buffer_load_dwordx4 v161, s[24:27], s29 offen lds
 s_mul_i32 s28, s14, 4096
 s_add_u32 m0, s28, 52224
 s_add_u32 s29, s48, 1024
 buffer_load_dwordx4 v162, s[24:27], s29 offen lds
 v_add_u32 v167, 73728, v163
 ds_read_b64_tr_b16 a[160:161], v167 offset:0
 ds_read_b64_tr_b16 a[162:163], v167 offset:768
 ds_read_b64_tr_b16 a[164:165], v167 offset:12288
 ds_read_b64_tr_b16 a[166:167], v167 offset:13056
 v_add_u32 v167, 73728, v164
 ds_read_b64_tr_b16 v[60:61], v167 offset:0
 ds_read_b64_tr_b16 v[62:63], v167 offset:768
 ds_read_b64_tr_b16 v[64:65], v167 offset:12288
 ds_read_b64_tr_b16 v[66:67], v167 offset:13056
 v_add_u32 v167, 73728, v165
 ds_read_b64_tr_b16 a[168:169], v167 offset:0
 ds_read_b64_tr_b16 a[170:171], v167 offset:768
 ds_read_b64_tr_b16 a[172:173], v167 offset:12288
 ds_read_b64_tr_b16 a[174:175], v167 offset:13056
 s_waitcnt vmcnt(16) lgkmcnt(0)
 s_barrier
 s_mul_i32 s28, s14, 4096
 s_add_u32 m0, s28, 73728
 s_add_u32 s29, s48, 81920
 buffer_load_dwordx4 v159, s[24:27], s29 offen lds
 s_mul_i32 s28, s14, 4096
 s_add_u32 m0, s28, 74752
 s_add_u32 s29, s48, 81920
 buffer_load_dwordx4 v160, s[24:27], s29 offen lds
 s_mul_i32 s28, s14, 4096
 s_add_u32 m0, s28, 75776
 s_add_u32 s29, s48, 81920
 buffer_load_dwordx4 v161, s[24:27], s29 offen lds
 s_mul_i32 s28, s14, 4096
 s_add_u32 m0, s28, 76800
 s_add_u32 s29, s48, 81920
 buffer_load_dwordx4 v162, s[24:27], s29 offen lds
 v_add_u32 v167, 98304, v166
 ds_read_b64_tr_b16 v[76:77], v167 offset:0
 ds_read_b64_tr_b16 v[78:79], v167 offset:512
 ds_read_b64_tr_b16 v[80:81], v167 offset:8192
 ds_read_b64_tr_b16 v[82:83], v167 offset:8704
 v_add_u32 v167, 98304, v5
 ds_read_b64_tr_b16 v[84:85], v167 offset:0
 ds_read_b64_tr_b16 v[86:87], v167 offset:512
 ds_read_b64_tr_b16 v[88:89], v167 offset:8192
 ds_read_b64_tr_b16 v[90:91], v167 offset:8704
 s_waitcnt vmcnt(16) lgkmcnt(0)
 s_barrier
 s_mul_i32 s28, s14, 4096
 s_add_u32 m0, s28, 98304
 s_add_u32 s29, s48, 82176
 buffer_load_dwordx4 v159, s[24:27], s29 offen lds
 s_mul_i32 s28, s14, 4096
 s_add_u32 m0, s28, 99328
 s_add_u32 s29, s48, 82176
 buffer_load_dwordx4 v160, s[24:27], s29 offen lds
 s_mul_i32 s28, s14, 4096
 s_add_u32 m0, s28, 100352
 s_add_u32 s29, s48, 82176
 buffer_load_dwordx4 v161, s[24:27], s29 offen lds
 s_mul_i32 s28, s14, 4096
 s_add_u32 m0, s28, 101376
 s_add_u32 s29, s48, 82176
 buffer_load_dwordx4 v162, s[24:27], s29 offen lds
 v_add_u32 v167, 122880, v166
 ds_read_b64_tr_b16 a[208:209], v167 offset:0
 ds_read_b64_tr_b16 a[210:211], v167 offset:512
 ds_read_b64_tr_b16 a[212:213], v167 offset:8192
 ds_read_b64_tr_b16 a[214:215], v167 offset:8704
 v_add_u32 v167, 122880, v5
 ds_read_b64_tr_b16 a[224:225], v167 offset:0
 ds_read_b64_tr_b16 a[226:227], v167 offset:512
 ds_read_b64_tr_b16 a[228:229], v167 offset:8192
 ds_read_b64_tr_b16 a[230:231], v167 offset:8704
 s_waitcnt vmcnt(16) lgkmcnt(0)
 s_barrier
 s_mul_i32 s28, s14, 4096
 s_add_u32 m0, s28, 122880
 s_add_u32 s29, s48, 82432
 buffer_load_dwordx4 v159, s[24:27], s29 offen lds
 s_mul_i32 s28, s14, 4096
 s_add_u32 m0, s28, 123904
 s_add_u32 s29, s48, 82432
 buffer_load_dwordx4 v160, s[24:27], s29 offen lds
 s_mul_i32 s28, s14, 4096
 s_add_u32 m0, s28, 124928
 s_add_u32 s29, s48, 82432
 buffer_load_dwordx4 v161, s[24:27], s29 offen lds
 s_mul_i32 s28, s14, 4096
 s_add_u32 m0, s28, 125952
 s_add_u32 s29, s48, 82432
 buffer_load_dwordx4 v162, s[24:27], s29 offen lds
 v_add_u32 v167, 0, v166
 ds_read_b64_tr_b16 a[240:241], v167 offset:0
 ds_read_b64_tr_b16 a[242:243], v167 offset:512
 ds_read_b64_tr_b16 a[244:245], v167 offset:8192
 ds_read_b64_tr_b16 a[246:247], v167 offset:8704
 v_add_u32 v167, 0, v5
 ds_read_b64_tr_b16 v[168:169], v167 offset:0
 ds_read_b64_tr_b16 v[170:171], v167 offset:512
 ds_read_b64_tr_b16 v[172:173], v167 offset:8192
 ds_read_b64_tr_b16 v[174:175], v167 offset:8704
 s_waitcnt vmcnt(16) lgkmcnt(0)
 s_barrier
 s_mul_i32 s28, s14, 4096
 s_add_u32 m0, s28, 0
 s_add_u32 s29, s48, 82688
 buffer_load_dwordx4 v159, s[24:27], s29 offen lds
 s_mul_i32 s28, s14, 4096
 s_add_u32 m0, s28, 1024
 s_add_u32 s29, s48, 82688
 buffer_load_dwordx4 v160, s[24:27], s29 offen lds
 s_mul_i32 s28, s14, 4096
 s_add_u32 m0, s28, 2048
 s_add_u32 s29, s48, 82688
 buffer_load_dwordx4 v161, s[24:27], s29 offen lds
 s_mul_i32 s28, s14, 4096
 s_add_u32 m0, s28, 3072
 s_add_u32 s29, s48, 82688
 buffer_load_dwordx4 v162, s[24:27], s29 offen lds
 v_add_u32 v167, 24576, v166
 ds_read_b64_tr_b16 v[184:185], v167 offset:0
 ds_read_b64_tr_b16 v[186:187], v167 offset:512
 ds_read_b64_tr_b16 v[188:189], v167 offset:8192
 ds_read_b64_tr_b16 v[190:191], v167 offset:8704
 v_add_u32 v167, 24576, v5
 ds_read_b64_tr_b16 v[124:125], v167 offset:0
 ds_read_b64_tr_b16 v[126:127], v167 offset:512
 ds_read_b64_tr_b16 v[128:129], v167 offset:8192
 ds_read_b64_tr_b16 v[130:131], v167 offset:8704
 s_waitcnt vmcnt(16) lgkmcnt(0)
 s_barrier
 s_mul_i32 s28, s14, 4096
 s_add_u32 m0, s28, 24576
 s_add_u32 s29, s48, 82944
 buffer_load_dwordx4 v159, s[24:27], s29 offen lds
 s_mul_i32 s28, s14, 4096
 s_add_u32 m0, s28, 25600
 s_add_u32 s29, s48, 82944
 buffer_load_dwordx4 v160, s[24:27], s29 offen lds
 s_mul_i32 s28, s14, 4096
 s_add_u32 m0, s28, 26624
 s_add_u32 s29, s48, 82944
 buffer_load_dwordx4 v161, s[24:27], s29 offen lds
 s_mul_i32 s28, s14, 4096
 s_add_u32 m0, s28, 27648
 s_add_u32 s29, s48, 82944
 buffer_load_dwordx4 v162, s[24:27], s29 offen lds
 v_add_u32 v167, 49152, v166
 ds_read_b64_tr_b16 v[132:133], v167 offset:0
 ds_read_b64_tr_b16 v[134:135], v167 offset:512
 ds_read_b64_tr_b16 v[136:137], v167 offset:8192
 ds_read_b64_tr_b16 v[138:139], v167 offset:8704
 v_add_u32 v167, 49152, v5
 ds_read_b64_tr_b16 v[240:241], v167 offset:0
 ds_read_b64_tr_b16 v[242:243], v167 offset:512
 ds_read_b64_tr_b16 v[244:245], v167 offset:8192
 ds_read_b64_tr_b16 v[246:247], v167 offset:8704
 s_waitcnt vmcnt(16) lgkmcnt(0)
 s_barrier
 s_mul_i32 s28, s14, 4096
 s_add_u32 m0, s28, 49152
 s_add_u32 s29, s48, 163840
 buffer_load_dwordx4 v159, s[24:27], s29 offen lds
 s_mul_i32 s28, s14, 4096
 s_add_u32 m0, s28, 50176
 s_add_u32 s29, s48, 163840
 buffer_load_dwordx4 v160, s[24:27], s29 offen lds
 s_mul_i32 s28, s14, 4096
 s_add_u32 m0, s28, 51200
 s_add_u32 s29, s48, 163840
 buffer_load_dwordx4 v161, s[24:27], s29 offen lds
 s_mul_i32 s28, s14, 4096
 s_add_u32 m0, s28, 52224
 s_add_u32 s29, s48, 163840
 buffer_load_dwordx4 v162, s[24:27], s29 offen lds
 v_add_u32 v167, 73728, v166
 ds_read_b64_tr_b16 a[176:177], v167 offset:0
 ds_read_b64_tr_b16 a[178:179], v167 offset:512
 ds_read_b64_tr_b16 a[180:181], v167 offset:8192
 ds_read_b64_tr_b16 a[182:183], v167 offset:8704
 v_add_u32 v167, 73728, v5
 ds_read_b64_tr_b16 a[192:193], v167 offset:0
 ds_read_b64_tr_b16 a[194:195], v167 offset:512
 ds_read_b64_tr_b16 a[196:197], v167 offset:8192
 ds_read_b64_tr_b16 a[198:199], v167 offset:8704
 s_waitcnt vmcnt(16) lgkmcnt(0)
 s_barrier
 s_mul_i32 s28, s14, 4096
 s_add_u32 m0, s28, 73728
 s_add_u32 s29, s48, 164096
 buffer_load_dwordx4 v159, s[24:27], s29 offen lds
 s_mul_i32 s28, s14, 4096
 s_add_u32 m0, s28, 74752
 s_add_u32 s29, s48, 164096
 buffer_load_dwordx4 v160, s[24:27], s29 offen lds
 s_mul_i32 s28, s14, 4096
 s_add_u32 m0, s28, 75776
 s_add_u32 s29, s48, 164096
 buffer_load_dwordx4 v161, s[24:27], s29 offen lds
 s_mul_i32 s28, s14, 4096
 s_add_u32 m0, s28, 76800
 s_add_u32 s29, s48, 164096
 buffer_load_dwordx4 v162, s[24:27], s29 offen lds
 v_add_u32 v167, 98304, v166
 ds_read_b64_tr_b16 v[92:93], v167 offset:0
 ds_read_b64_tr_b16 v[94:95], v167 offset:512
 ds_read_b64_tr_b16 v[96:97], v167 offset:8192
 ds_read_b64_tr_b16 v[98:99], v167 offset:8704
 v_add_u32 v167, 98304, v5
 ds_read_b64_tr_b16 v[100:101], v167 offset:0
 ds_read_b64_tr_b16 v[102:103], v167 offset:512
 ds_read_b64_tr_b16 v[104:105], v167 offset:8192
 ds_read_b64_tr_b16 v[106:107], v167 offset:8704
 s_waitcnt vmcnt(16) lgkmcnt(0)
 s_barrier
 s_mul_i32 s28, s14, 4096
 s_add_u32 m0, s28, 98304
 s_add_u32 s29, s48, 164352
 buffer_load_dwordx4 v159, s[24:27], s29 offen lds
 s_mul_i32 s28, s14, 4096
 s_add_u32 m0, s28, 99328
 s_add_u32 s29, s48, 164352
 buffer_load_dwordx4 v160, s[24:27], s29 offen lds
 s_mul_i32 s28, s14, 4096
 s_add_u32 m0, s28, 100352
 s_add_u32 s29, s48, 164352
 buffer_load_dwordx4 v161, s[24:27], s29 offen lds
 s_mul_i32 s28, s14, 4096
 s_add_u32 m0, s28, 101376
 s_add_u32 s29, s48, 164352
 buffer_load_dwordx4 v162, s[24:27], s29 offen lds
 v_add_u32 v167, 122880, v166
 ds_read_b64_tr_b16 a[248:249], v167 offset:0
 ds_read_b64_tr_b16 a[250:251], v167 offset:512
 ds_read_b64_tr_b16 a[252:253], v167 offset:8192
 ds_read_b64_tr_b16 a[254:255], v167 offset:8704
 v_add_u32 v167, 122880, v5
 ds_read_b64_tr_b16 v[176:177], v167 offset:0
 ds_read_b64_tr_b16 v[178:179], v167 offset:512
 ds_read_b64_tr_b16 v[180:181], v167 offset:8192
 ds_read_b64_tr_b16 v[182:183], v167 offset:8704
 s_waitcnt vmcnt(16) lgkmcnt(0)
 s_barrier
 s_mul_i32 s28, s14, 4096
 s_add_u32 m0, s28, 122880
 s_add_u32 s29, s48, 164608
 buffer_load_dwordx4 v159, s[24:27], s29 offen lds
 s_mul_i32 s28, s14, 4096
 s_add_u32 m0, s28, 123904
 s_add_u32 s29, s48, 164608
 buffer_load_dwordx4 v160, s[24:27], s29 offen lds
 s_mul_i32 s28, s14, 4096
 s_add_u32 m0, s28, 124928
 s_add_u32 s29, s48, 164608
 buffer_load_dwordx4 v161, s[24:27], s29 offen lds
 s_mul_i32 s28, s14, 4096
 s_add_u32 m0, s28, 125952
 s_add_u32 s29, s48, 164608
 buffer_load_dwordx4 v162, s[24:27], s29 offen lds
 v_add_u32 v167, 0, v166
 ds_read_b64_tr_b16 v[192:193], v167 offset:0
 ds_read_b64_tr_b16 v[194:195], v167 offset:512
 ds_read_b64_tr_b16 v[196:197], v167 offset:8192
 ds_read_b64_tr_b16 v[198:199], v167 offset:8704
 v_add_u32 v167, 0, v5
 ds_read_b64_tr_b16 v[208:209], v167 offset:0
 ds_read_b64_tr_b16 v[210:211], v167 offset:512
 ds_read_b64_tr_b16 v[212:213], v167 offset:8192
 ds_read_b64_tr_b16 v[214:215], v167 offset:8704
 s_waitcnt vmcnt(16) lgkmcnt(0)
 s_barrier
 s_mul_i32 s28, s14, 4096
 s_add_u32 m0, s28, 0
 s_add_u32 s29, s48, 164864
 buffer_load_dwordx4 v159, s[24:27], s29 offen lds
 s_mul_i32 s28, s14, 4096
 s_add_u32 m0, s28, 1024
 s_add_u32 s29, s48, 164864
 buffer_load_dwordx4 v160, s[24:27], s29 offen lds
 s_mul_i32 s28, s14, 4096
 s_add_u32 m0, s28, 2048
 s_add_u32 s29, s48, 164864
 buffer_load_dwordx4 v161, s[24:27], s29 offen lds
 s_mul_i32 s28, s14, 4096
 s_add_u32 m0, s28, 3072
 s_add_u32 s29, s48, 164864
 buffer_load_dwordx4 v162, s[24:27], s29 offen lds
 v_add_u32 v167, 24576, v166
 ds_read_b64_tr_b16 v[224:225], v167 offset:0
 ds_read_b64_tr_b16 v[226:227], v167 offset:512
 ds_read_b64_tr_b16 v[228:229], v167 offset:8192
 ds_read_b64_tr_b16 v[230:231], v167 offset:8704
 v_add_u32 v167, 24576, v5
 ds_read_b64_tr_b16 v[140:141], v167 offset:0
 ds_read_b64_tr_b16 v[142:143], v167 offset:512
 ds_read_b64_tr_b16 v[144:145], v167 offset:8192
 ds_read_b64_tr_b16 v[146:147], v167 offset:8704
 s_waitcnt vmcnt(16) lgkmcnt(0)
 s_barrier
 v_add_u32 v167, 49152, v166
 ds_read_b64_tr_b16 a[184:185], v167 offset:0
 ds_read_b64_tr_b16 a[186:187], v167 offset:512
 ds_read_b64_tr_b16 a[188:189], v167 offset:8192
 ds_read_b64_tr_b16 a[190:191], v167 offset:8704
 v_add_u32 v167, 49152, v5
 ds_read_b64_tr_b16 a[200:201], v167 offset:0
 ds_read_b64_tr_b16 a[202:203], v167 offset:512
 ds_read_b64_tr_b16 a[204:205], v167 offset:8192
 ds_read_b64_tr_b16 a[206:207], v167 offset:8704
 s_waitcnt vmcnt(12) lgkmcnt(0)
 s_barrier
 v_add_u32 v167, 73728, v166
 ds_read_b64_tr_b16 a[216:217], v167 offset:0
 ds_read_b64_tr_b16 a[218:219], v167 offset:512
 ds_read_b64_tr_b16 a[220:221], v167 offset:8192
 ds_read_b64_tr_b16 a[222:223], v167 offset:8704
 v_add_u32 v167, 73728, v5
 ds_read_b64_tr_b16 a[232:233], v167 offset:0
 ds_read_b64_tr_b16 a[234:235], v167 offset:512
 ds_read_b64_tr_b16 a[236:237], v167 offset:8192
 ds_read_b64_tr_b16 a[238:239], v167 offset:8704
 s_waitcnt vmcnt(8) lgkmcnt(0)
 s_barrier
 v_add_u32 v167, 98304, v166
 ds_read_b64_tr_b16 v[108:109], v167 offset:0
 ds_read_b64_tr_b16 v[110:111], v167 offset:512
 ds_read_b64_tr_b16 v[112:113], v167 offset:8192
 ds_read_b64_tr_b16 v[114:115], v167 offset:8704
 v_add_u32 v167, 98304, v5
 ds_read_b64_tr_b16 v[116:117], v167 offset:0
 ds_read_b64_tr_b16 v[118:119], v167 offset:512
 ds_read_b64_tr_b16 v[120:121], v167 offset:8192
 ds_read_b64_tr_b16 v[122:123], v167 offset:8704
 s_waitcnt vmcnt(4) lgkmcnt(0)
 s_barrier
 v_add_u32 v167, 122880, v166
 ds_read_b64_tr_b16 v[200:201], v167 offset:0
 ds_read_b64_tr_b16 v[202:203], v167 offset:512
 ds_read_b64_tr_b16 v[204:205], v167 offset:8192
 ds_read_b64_tr_b16 v[206:207], v167 offset:8704
 v_add_u32 v167, 122880, v5
 ds_read_b64_tr_b16 v[216:217], v167 offset:0
 ds_read_b64_tr_b16 v[218:219], v167 offset:512
 ds_read_b64_tr_b16 v[220:221], v167 offset:8192
 ds_read_b64_tr_b16 v[222:223], v167 offset:8704
 s_waitcnt vmcnt(0) lgkmcnt(0)
 s_barrier
 v_add_u32 v167, 0, v166
 ds_read_b64_tr_b16 v[232:233], v167 offset:0
 ds_read_b64_tr_b16 v[234:235], v167 offset:512
 ds_read_b64_tr_b16 v[236:237], v167 offset:8192
 ds_read_b64_tr_b16 v[238:239], v167 offset:8704
 v_add_u32 v167, 0, v5
 ds_read_b64_tr_b16 v[248:249], v167 offset:0
 ds_read_b64_tr_b16 v[250:251], v167 offset:512
 ds_read_b64_tr_b16 v[252:253], v167 offset:8192
 ds_read_b64_tr_b16 v[254:255], v167 offset:8704
 s_waitcnt lgkmcnt(0)
 s_barrier
 v_mbcnt_lo_u32_b32 v10, -1, 0
 v_and_b32 v10, 7, v10
 v_lshlrev_b32 v10, 7, v10
 s_mov_b32 s82, 6361088
 s_cmp_eq_u32 s14, 0
 s_cbranch_scc0 vv_w
 s_mov_b32 s45, 400000
 s_mov_b64 exec, 0xff
vv_p:
 buffer_load_dword v11, v10, s[8:11], s82 offen sc1
 s_waitcnt vmcnt(0)
 s_mov_b32 s28, 0
 v_readlane_b32 s29, v11, 0
 s_add_u32 s28, s28, s29
 v_readlane_b32 s29, v11, 1
 s_add_u32 s28, s28, s29
 v_readlane_b32 s29, v11, 2
 s_add_u32 s28, s28, s29
 v_readlane_b32 s29, v11, 3
 s_add_u32 s28, s28, s29
 v_readlane_b32 s29, v11, 4
 s_add_u32 s28, s28, s29
 v_readlane_b32 s29, v11, 5
 s_add_u32 s28, s28, s29
 v_readlane_b32 s29, v11, 6
 s_add_u32 s28, s28, s29
 v_readlane_b32 s29, v11, 7
 s_add_u32 s28, s28, s29
 s_cmp_ge_u32 s28, 256
 s_cbranch_scc1 vv_d
 s_sleep 2
 s_sub_u32 s45, s45, 1
 s_cbranch_scc0 vv_p
vv_d:
 v_lshrrev_b32 v9, 5, v10
 v_add_u32 v9, 163584, v9
 ds_write_b32 v9, v11
 s_waitcnt lgkmcnt(0)
 s_mov_b64 exec, -1
vv_w:
 s_barrier
 v_lshrrev_b32 v10, 5, v10
 v_add_u32 v10, 163584, v10
 ds_read_b32 v11, v10
 s_waitcnt lgkmcnt(0)
 v_readlane_b32 s82, v11, 0
 v_readlane_b32 s83, v11, 1
 v_readlane_b32 s84, v11, 2
 v_readlane_b32 s85, v11, 3
 v_readlane_b32 s86, v11, 4
 v_readlane_b32 s87, v11, 5
 v_readlane_b32 s88, v11, 6
 v_readlane_b32 s89, v11, 7
 s_barrier
 s_min_u32 s29, s82, s83
 s_cmp_ge_u32 s29, 32
 s_cbranch_scc0 redispatch
 s_mov_b32 s45, 200000
 v_lshlrev_b32 v7, 3, v4
 s_mov_b32 s28, 6356992
 buffer_load_dwordx2 v[8:9], v7, s[8:11], s28 offen sc1
 s_waitcnt vmcnt(0)
 v_cmp_lt_i32 vcc, v9, v8
 s_and_b32 s19, vcc_lo, 65535
 s_mul_i32 s28, s14, 34816
 s_add_u32 s28, s28, 16384
 v_add_u32 v154, s28, v152
 ds_write_b128 v154, v[12:15] offset:0
 ds_write_b128 v154, v[16:19] offset:1024
 ds_write_b128 v154, v[20:23] offset:2048
 ds_write_b128 v154, v[24:27] offset:3072
 ds_write_b128 v154, v[28:31] offset:4096
 ds_write_b128 v154, v[32:35] offset:5120
 ds_write_b128 v154, v[36:39] offset:6144
 ds_write_b128 v154, v[40:43] offset:7168
 ds_write_b128 v154, v[44:47] offset:8192
 ds_write_b128 v154, v[48:51] offset:9216
 ds_write_b128 v154, v[52:55] offset:10240
 ds_write_b128 v154, v[56:59] offset:11264
 ds_write_b128 v154, v[60:63] offset:12288
 ds_write_b128 v154, v[64:67] offset:13312
 ds_write_b128 v154, v[68:71] offset:14336
 ds_write_b128 v154, v[72:75] offset:15360
 ds_write_b128 v154, v[76:79] offset:16384
 ds_write_b128 v154, v[80:83] offset:17408
 ds_write_b128 v154, v[84:87] offset:18432
 ds_write_b128 v154, v[88:91] offset:19456
 ds_write_b128 v154, v[92:95] offset:20480
 ds_write_b128 v154, v[96:99] offset:21504
 ds_write_b128 v154, v[100:103] offset:22528
 ds_write_b128 v154, v[104:107] offset:23552
 ds_write_b128 v154, v[108:111] offset:24576
 ds_write_b128 v154, v[112:115] offset:25600
 ds_write_b128 v154, v[116:119] offset:26624
 ds_write_b128 v154, v[120:123] offset:27648
 ds_write_b128 v154, v[124:127] offset:28672
 ds_write_b128 v154, v[128:131] offset:29696
 ds_write_b128 v154, v[132:135] offset:30720
 ds_write_b128 v154, v[136:139] offset:31744
 ds_write_b128 v154, v[140:143] offset:32768
 ds_write_b128 v154, v[144:147] offset:33792
 s_waitcnt lgkmcnt(0)
 v_lshrrev_b32 v8, 3, v4
 v_lshlrev_b32 v8, 7, v8
 v_lshl_add_u32 v8, v3, 5, v8
 v_and_b32 v9, 7, v4
 v_lshl_add_u32 v8, v9, 1, v8
 s_mul_i32 s28, s14, 768
 s_add_u32 s28, s28, 10240
 v_add_u32 v153, s28, v8
 s_mul_i32 s28, s13, 40
 v_add_u32 v10, s28, v4
 v_add_u32 v11, 16, v10
 v_add_u32 v12, s28, v9
 v_add_u32 v12, 32, v12
 v_lshrrev_b32 v13, 5, v10
 v_lshlrev_b32 v13, 11, v13
 v_and_b32 v14, 31, v10
 v_lshl_add_u32 v13, v14, 5, v13
 v_lshrrev_b32 v14, 1, v3
 v_lshl_add_u32 v13, v14, 10, v13
 v_and_b32 v14, 1, v3
 v_lshl_add_u32 v155, v14, 4, v13
 v_lshrrev_b32 v13, 5, v11
 v_lshlrev_b32 v13, 11, v13
 v_and_b32 v14, 31, v11
 v_lshl_add_u32 v13, v14, 5, v13
 v_lshrrev_b32 v14, 1, v3
 v_lshl_add_u32 v13, v14, 10, v13
 v_and_b32 v14, 1, v3
 v_lshl_add_u32 v156, v14, 4, v13
 v_lshrrev_b32 v13, 5, v12
 v_lshlrev_b32 v13, 11, v13
 v_and_b32 v14, 31, v12
 v_lshl_add_u32 v13, v14, 5, v13
 v_lshrrev_b32 v14, 1, v3
 v_lshl_add_u32 v13, v14, 10, v13
 v_and_b32 v14, 1, v3
 v_lshl_add_u32 v167, v14, 4, v13
 v_lshrrev_b32 v13, 1, v3
 v_lshlrev_b32 v13, 11, v13
 v_and_b32 v14, 1, v3
 v_lshl_add_u32 v13, v14, 8, v13
 v_lshl_add_u32 v13, v4, 4, v13
 s_lshl_b32 s28, s14, 9
 v_add_u32 v157, s28, v13
 v_lshlrev_b32 v13, 4, v4
 v_lshl_add_u32 v13, v3, 2, v13
 v_add_u32 v166, s28, v13
 s_lshl_b32 s28, s14, 2
 v_add_u32 v13, s28, v3
 v_mul_u32_u24 v14, 10240, v13
 v_lshl_add_u32 v158, v10, 4, v14
 v_lshl_add_u32 v159, v12, 4, v14
 v_mul_u32_u24 v14, 640, v13
 v_lshl_add_u32 v14, v9, 4, v14
 v_add_u32 v161, 512, v14
 s_mul_i32 s28, s14, 2560
 v_lshlrev_b32 v14, 7, v3
 v_lshl_add_u32 v14, v9, 4, v14
 v_lshrrev_b32 v15, 3, v4
 v_mul_u32_u24 v15, 640, v15
 v_add3_u32 v160, s28, v14, v15
 s_mul_i32 s28, s14, 1536
 s_add_u32 s28, s28, 155648
 v_add_u32 v162, s28, v14
 v_lshrrev_b32 v15, 3, v4
 v_lshl_add_u32 v162, v15, 9, v162
 v_lshrrev_b32 v13, 3, v2
 v_lshlrev_b32 v13, 8, v13
 v_lshl_add_u32 v163, v9, 4, v13
 v_add_u32 v163, 155648, v163
 s_mul_i32 s28, s13, 640
 v_add_u32 v164, s28, v152
 s_lshl_b32 s37, s12, 4
 s_lshl_b32 s28, s14, 2
 s_add_u32 s37, s37, s28
 s_mul_i32 s37, s37, 40960
 s_add_u32 s37, s37, 96468992
 s_lshl_b32 s38, s12, 20
 s_add_u32 s38, s38, 4194304
 s_mul_i32 s47, s13, 10240
 s_mul_i32 s39, s15, 10240
 s_add_u32 s39, s39, 25165824
 s_xor_b32 s49, s12, 1
 s_lshl_b32 s49, s49, 3
 v_cmp_gt_u32 vcc, 8192, v164
 s_mov_b64 s[58:59], vcc
 v_mov_b32 v136, 0
 v_mov_b32 v137, 0
 v_mov_b32 v138, 0
 v_mov_b32 v139, 0
 v_mov_b32 v140, 0
 v_mov_b32 v141, 0
 v_mov_b32 v142, 0
 v_mov_b32 v143, 0
 v_mov_b32 v144, 0
 v_mov_b32 v145, 0
 v_mov_b32 v146, 0
 v_mov_b32 v147, 0
 s_and_b32 s28, s14, 1
 s_mul_i32 s28, s28, 48
 v_add_u32 v13, s28, v2
 v_lshlrev_b32 v166, 4, v13
 v_add_u32 v166, 155648, v166
 v_lshrrev_b32 v14, 4, v13
 v_lshlrev_b32 v14, 7, v14
 v_and_b32 v15, 7, v13
 v_lshl_add_u32 v14, v15, 4, v14
 v_bfe_u32 v15, v13, 3, 1
 v_lshl_add_u32 v14, v15, 3, v14
 s_mul_i32 s28, s13, 640
 v_add_u32 v163, s28, v14
 v_cmp_gt_u32 vcc, 8192, v163
 s_mov_b64 s[4:5], vcc
 s_mov_b32 s6, -1
 s_cmp_eq_u32 s14, 0
 s_cselect_b32 s7, 0xffff, 0
 s_lshr_b32 s28, s16, 2
 s_lshl_b32 s28, s28, 5
 s_lshl_b32 s29, s12, 4
 s_add_u32 s28, s28, s29
 s_lshl_b32 s28, s28, 2
 s_add_u32 s28, s28, 6328320
 v_bfe_u32 v100, v152, 4, 4
 v_lshlrev_b32 v100, 2, v100
fu_23:
 buffer_load_dword v101, v100, s[8:11], s28 offen sc1
 s_waitcnt vmcnt(0)
 v_cmp_gt_u32 vcc, 2, v101
 s_cbranch_vccz fo_24
 s_sub_u32 s45, s45, 1
 s_cbranch_scc0 fu_23
 s_mov_b32 s45, 0
fo_24:
 .p2align 6
Vstep_25:
 s_and_b32 s28, s16, 3
 s_lshl_b32 s29, s28, 1
 s_add_u32 s29, s29, s18
 s_lshr_b32 s17, s19, s29
 s_lshl_b32 s29, s29, 14
 s_add_u32 s29, s29, 180355072
 s_and_b32 s31, s17, 1
 s_lshl_b32 s31, s31, 13
 s_add_u32 s31, s31, s29
 s_and_b32 s17, s17, 2
 s_lshl_b32 s17, s17, 12
 s_add_u32 s17, s17, s29
 s_add_u32 s17, s17, 8192
 s_lshl_b32 s28, s28, 14
 s_add_u32 s30, s28, s36
 s_add_u32 s34, s30, 4096
 s_add_u32 s35, s31, 4096
 v_pk_mov_b32 v[88:89], 0, 0
 v_pk_mov_b32 v[90:91], 0, 0
 v_pk_mov_b32 v[92:93], 0, 0
 v_pk_mov_b32 v[94:95], 0, 0
 v_pk_mov_b32 v[96:97], 0, 0
 v_pk_mov_b32 v[98:99], 0, 0
 ds_read_b128 v[100:103], v154 offset:0
 ds_read_b128 v[104:107], v154 offset:1024
 ds_read_b128 v[108:111], v154 offset:2048
 ds_read_b128 v[112:115], v154 offset:3072
 ds_read_b128 v[116:119], v154 offset:4096
 ds_read_b128 v[120:123], v154 offset:5120
 s_mul_i32 s50, s16, 1310720
 s_add_u32 s50, s50, s37
 s_add_u32 s28, s16, 2
 s_and_b32 s28, s28, 3
 s_lshl_b32 s51, s28, 18
 s_add_u32 s51, s51, s38
 s_add_u32 s51, s51, s47
 s_lshl_b32 s28, s28, 14
 s_add_u32 s60, s28, s36
 s_sub_u32 s54, s16, 1
 s_max_i32 s54, s54, 0
 s_mul_i32 s54, s54, 327680
 s_add_u32 s54, s54, s39
 s_and_b32 s28, s16, 3
 s_lshl_b32 s55, s28, 18
 s_add_u32 s55, s55, s38
 s_add_u32 s56, s55, s47
 s_lshl_b32 s57, s28, 14
 s_add_u32 s57, s57, s36
 s_add_u32 s57, s57, 262144
 s_cmp_eq_u32 s14, 2
 s_cbranch_scc0 w1_27
 s_add_u32 s28, s16, 2
 s_and_b32 s28, s28, 3
 s_lshl_b32 s29, s28, 1
 s_add_u32 s29, s29, s49
 s_lshr_b32 s61, s19, s29
 s_lshl_b32 s29, s29, 14
 s_add_u32 s29, s29, 180355072
 s_and_b32 s53, s61, 1
 s_lshl_b32 s53, s53, 13
 s_add_u32 s53, s53, s29
 s_and_b32 s61, s61, 2
 s_lshl_b32 s61, s61, 12
 s_add_u32 s61, s61, s29
 s_add_u32 s61, s61, 8192
 s_lshl_b32 s28, s28, 14
 s_add_u32 s52, s28, s36
 v_mov_b32 v165, s61
 v_mov_b32 v20, s53
 v_cndmask_b32 v165, v165, v20, s[58:59]
 v_add_u32 v165, v165, v164
 v_mov_b32 v0, -1
 v_mov_b32 v1, -1
 v_mov_b32 v2, -1
 v_mov_b32 v3, -1
 s_mov_b32 exec_hi, 0xff
 buffer_store_dwordx4 v[0:3], v164, s[8:11], s52 offen
 buffer_store_dwordx4 v[0:3], v165, s[8:11], 0 offen sc1
 s_mov_b32 exec_hi, -1
w1_27:
 s_cmp_le_u32 s14, 1
 s_cbranch_scc0 w0_26
 s_add_u32 s28, s16, 1
 s_and_b32 s28, s28, 3
 s_lshl_b32 s29, s28, 1
 s_add_u32 s29, s29, s49
 s_lshr_b32 s61, s19, s29
 s_lshl_b32 s29, s29, 14
 s_add_u32 s29, s29, 180355072
 s_and_b32 s53, s61, 1
 s_lshl_b32 s53, s53, 13
 s_add_u32 s53, s53, s29
 s_and_b32 s61, s61, 2
 s_lshl_b32 s61, s61, 12
 s_add_u32 s61, s61, s29
 s_add_u32 s61, s61, 8192
 s_lshl_b32 s28, s28, 14
 s_add_u32 s52, s28, s36
 v_mov_b32 v165, s61
 v_mov_b32 v20, s53
 v_cndmask_b32 v165, v165, v20, s[4:5]
 v_add_u32 v165, v165, v163
w0_26:
pl_28:
 buffer_load_dwordx4 v[124:127], v148, s[8:11], s30 offen offset:0 sc1
 buffer_load_dwordx4 v[128:131], v148, s[8:11], s34 offen offset:0 sc1
 buffer_load_dwordx2 v[132:133], v149, s[8:11], s30 offen sc1
 s_waitcnt vmcnt(0)
 v_max3_u32 v0, v124, v128, v132
 v_cmp_eq_u32 vcc, -1, v0
 s_cbranch_vccz ok_32
 s_sub_u32 s45, s45, 1
 s_cbranch_scc0 pl_28
 s_mov_b32 s45, 0
ok_32:
 buffer_load_dwordx4 v[40:43], v148, s[8:11], s31 offen offset:0 sc1
 buffer_load_dwordx4 v[44:47], v148, s[8:11], s35 offen offset:0 sc1
 buffer_load_dwordx2 v[48:49], v149, s[8:11], s17 offen sc1
 v_lshlrev_b32 v16, 16, v124
 v_and_b32 v17, 0xffff0000, v124
 v_lshlrev_b32 v18, 16, v125
 v_and_b32 v19, 0xffff0000, v125
 v_lshlrev_b32 v20, 16, v126
 v_and_b32 v21, 0xffff0000, v126
 v_lshlrev_b32 v22, 16, v127
 v_and_b32 v23, 0xffff0000, v127
 v_lshlrev_b32 v24, 16, v128
 v_and_b32 v25, 0xffff0000, v128
 v_lshlrev_b32 v26, 16, v129
 v_and_b32 v27, 0xffff0000, v129
 v_lshlrev_b32 v28, 16, v130
 v_and_b32 v29, 0xffff0000, v130
 v_lshlrev_b32 v30, 16, v131
 v_and_b32 v31, 0xffff0000, v131
 v_lshlrev_b32 v32, 16, v132
 v_and_b32 v33, 0xffff0000, v132
 v_lshlrev_b32 v34, 16, v133
 v_and_b32 v35, 0xffff0000, v133
 s_branch g_30
pr_29:
 buffer_load_dwordx4 v[40:43], v148, s[8:11], s31 offen offset:0 sc1
 buffer_load_dwordx4 v[44:47], v148, s[8:11], s35 offen offset:0 sc1
 buffer_load_dwordx2 v[48:49], v149, s[8:11], s17 offen sc1
g_30:
 s_waitcnt vmcnt(0)
 v_max3_u32 v0, v40, v44, v48
 v_cmp_eq_u32 vcc, -1, v0
 v_dot2_f32_bf16 v4, v40, s42, v16
 v_dot2_f32_bf16 v5, v40, s43, v17
 v_dot2_f32_bf16 v6, v41, s42, v18
 v_dot2_f32_bf16 v7, v41, s43, v19
 v_dot2_f32_bf16 v8, v42, s42, v20
 v_dot2_f32_bf16 v9, v42, s43, v21
 v_dot2_f32_bf16 v10, v43, s42, v22
 v_dot2_f32_bf16 v11, v43, s43, v23
 s_cbranch_vccz ok_33
 s_sub_u32 s45, s45, 1
 s_cbranch_scc0 pr_29
 s_mov_b32 s45, 0
ok_33:
 v_cvt_pk_bf16_f32 v124, v4, v5
 v_cvt_pk_bf16_f32 v125, v6, v7
 v_cvt_pk_bf16_f32 v126, v8, v9
 v_cvt_pk_bf16_f32 v127, v10, v11
 ds_write_b128 v148, v[124:127] offset:0
 v_dot2_f32_bf16 v24, v44, s42, v24
 v_dot2_f32_bf16 v25, v44, s43, v25
 v_dot2_f32_bf16 v26, v45, s42, v26
 v_dot2_f32_bf16 v27, v45, s43, v27
 v_dot2_f32_bf16 v28, v46, s42, v28
 v_dot2_f32_bf16 v29, v46, s43, v29
 v_dot2_f32_bf16 v30, v47, s42, v30
 v_dot2_f32_bf16 v31, v47, s43, v31
 v_cvt_pk_bf16_f32 v128, v24, v25
 v_cvt_pk_bf16_f32 v129, v26, v27
 v_cvt_pk_bf16_f32 v130, v28, v29
 v_cvt_pk_bf16_f32 v131, v30, v31
 ds_write_b128 v148, v[128:131] offset:4096
 v_dot2_f32_bf16 v32, v48, s42, v32
 v_dot2_f32_bf16 v33, v48, s43, v33
 v_dot2_f32_bf16 v34, v49, s42, v34
 v_dot2_f32_bf16 v35, v49, s43, v35
 s_nop 0
 v_cvt_pk_bf16_f32 v132, v32, v33
 s_nop 0
 v_cvt_pk_bf16_f32 v133, v34, v35
 ds_write_b64 v149, v[132:133]
 buffer_load_dwordx4 v[40:43], v155, s[8:11], s50 offen
 buffer_load_dwordx4 v[44:47], v156, s[8:11], s50 offen
 s_mov_b64 exec, s[40:41]
 buffer_load_dwordx4 v[48:51], v167, s[8:11], s50 offen
 s_mov_b64 exec, -1
 s_add_u32 s50, s50, 40960
 buffer_load_dwordx4 v[52:55], v155, s[8:11], s50 offen
 buffer_load_dwordx4 v[56:59], v156, s[8:11], s50 offen
 s_mov_b64 exec, s[40:41]
 buffer_load_dwordx4 v[60:63], v167, s[8:11], s50 offen
 s_mov_b64 exec, -1
 s_add_u32 s50, s50, 40960
gs_31:
 s_waitcnt lgkmcnt(0)
 s_barrier
 ds_read_b128 v[0:3], v150 offset:0
 ds_read_b128 v[4:7], v150 offset:1024
 ds_read_b128 v[8:11], v150 offset:2048
 s_waitcnt lgkmcnt(2)
 v_smfmac_f32_16x16x64_bf16 v[88:91], v[0:3], a[0:7], v151
 ds_read_b128 v[12:15], v150 offset:3072
 v_smfmac_f32_16x16x64_bf16 v[92:95], v[0:3], a[8:15], v151
 ds_read_b128 v[16:19], v150 offset:4096
 v_smfmac_f32_16x16x64_bf16 v[96:99], v[0:3], v[100:107], v151
 ds_read_b128 v[100:103], v154 offset:6144
 ds_read_b128 v[104:107], v154 offset:7168
 ds_read_b128 v[20:23], v150 offset:5120
 buffer_load_dwordx4 v[64:67], v155, s[8:11], s50 offen
 s_waitcnt lgkmcnt(6)
 v_smfmac_f32_16x16x64_bf16 v[88:91], v[4:7], a[16:23], v151
 ds_read_b128 v[24:27], v150 offset:6144
 v_smfmac_f32_16x16x64_bf16 v[92:95], v[4:7], a[24:31], v151
 ds_read_b128 v[28:31], v150 offset:7168
 v_smfmac_f32_16x16x64_bf16 v[96:99], v[4:7], v[108:115], v151
 ds_read_b128 v[108:111], v154 offset:8192
 ds_read_b128 v[112:115], v154 offset:9216
 ds_read_b128 v[32:35], v150 offset:8192
 buffer_load_dwordx4 v[68:71], v156, s[8:11], s50 offen
 s_waitcnt lgkmcnt(10)
 v_smfmac_f32_16x16x64_bf16 v[88:91], v[8:11], a[32:39], v151
 ds_read_b128 v[36:39], v150 offset:9216
 v_smfmac_f32_16x16x64_bf16 v[92:95], v[8:11], a[40:47], v151
 v_smfmac_f32_16x16x64_bf16 v[96:99], v[8:11], a[48:55], v151
 s_mov_b64 exec, s[40:41]
 buffer_load_dwordx4 v[72:75], v167, s[8:11], s50 offen
 s_mov_b64 exec, -1
 s_add_u32 s50, s50, 40960
 s_waitcnt lgkmcnt(10)
 v_smfmac_f32_16x16x64_bf16 v[88:91], v[12:15], v[116:123], v151
 ds_read_b128 v[116:119], v154 offset:10240
 ds_read_b128 v[120:123], v154 offset:11264
 v_smfmac_f32_16x16x64_bf16 v[92:95], v[12:15], a[56:63], v151
 v_smfmac_f32_16x16x64_bf16 v[96:99], v[12:15], a[64:71], v151
 buffer_load_dwordx4 v[76:79], v155, s[8:11], s50 offen
 s_waitcnt lgkmcnt(9)
 v_smfmac_f32_16x16x64_bf16 v[88:91], v[16:19], v[100:107], v151
 ds_read_b128 v[100:103], v154 offset:12288
 ds_read_b128 v[104:107], v154 offset:13312
 s_waitcnt lgkmcnt(10)
 v_smfmac_f32_16x16x64_bf16 v[88:91], v[20:23], a[88:95], v151
 s_waitcnt lgkmcnt(9)
 v_smfmac_f32_16x16x64_bf16 v[88:91], v[24:27], a[104:111], v151
 buffer_load_dwordx4 v[80:83], v156, s[8:11], s50 offen
 s_waitcnt lgkmcnt(8)
 v_smfmac_f32_16x16x64_bf16 v[88:91], v[28:31], a[120:127], v151
 s_waitcnt lgkmcnt(5)
 v_smfmac_f32_16x16x64_bf16 v[88:91], v[32:35], v[108:115], v151
 ds_read_b128 v[108:111], v154 offset:14336
 ds_read_b128 v[112:115], v154 offset:15360
 s_waitcnt lgkmcnt(6)
 v_smfmac_f32_16x16x64_bf16 v[88:91], v[36:39], a[160:167], v151
 s_mov_b64 exec, s[40:41]
 buffer_load_dwordx4 v[84:87], v167, s[8:11], s50 offen
 s_mov_b64 exec, -1
 s_add_u32 s50, s50, 40960
 v_smfmac_f32_16x16x64_bf16 v[92:95], v[16:19], a[72:79], v151
 s_waitcnt lgkmcnt(4)
 v_smfmac_f32_16x16x64_bf16 v[92:95], v[20:23], v[116:123], v151
 ds_read_b128 v[116:119], v154 offset:16384
 ds_read_b128 v[120:123], v154 offset:17408
 v_smfmac_f32_16x16x64_bf16 v[92:95], v[24:27], a[112:119], v151
 v_smfmac_f32_16x16x64_bf16 v[92:95], v[28:31], a[128:135], v151
 v_smfmac_f32_16x16x64_bf16 v[92:95], v[32:35], a[144:151], v151
 s_waitcnt lgkmcnt(4)
 v_smfmac_f32_16x16x64_bf16 v[92:95], v[36:39], v[100:107], v151
 ds_read_b128 v[100:103], v154 offset:18432
 ds_read_b128 v[104:107], v154 offset:19456
 v_smfmac_f32_16x16x64_bf16 v[96:99], v[16:19], a[80:87], v151
 v_smfmac_f32_16x16x64_bf16 v[96:99], v[20:23], a[96:103], v151
 v_pk_add_f32 v[88:89], v[88:89], v[90:91]
 v_cvt_pk_bf16_f32 v89, v88, v89
 s_waitcnt lgkmcnt(4)
 v_smfmac_f32_16x16x64_bf16 v[96:99], v[24:27], v[108:115], v151
 ds_read_b128 v[108:111], v154 offset:20480
 ds_read_b128 v[112:115], v154 offset:21504
 ds_write_b16 v153, v89 offset:0
 ds_write_b16_d16_hi v153, v89 offset:16
 v_smfmac_f32_16x16x64_bf16 v[96:99], v[28:31], a[136:143], v151
 v_smfmac_f32_16x16x64_bf16 v[96:99], v[32:35], a[152:159], v151
 v_smfmac_f32_16x16x64_bf16 v[96:99], v[36:39], a[168:175], v151
 v_pk_mov_b32 v[0:1], 0, 0
 v_pk_mov_b32 v[2:3], 0, 0
 v_pk_add_f32 v[92:93], v[92:93], v[94:95]
 v_cvt_pk_bf16_f32 v93, v92, v93
 ds_write_b16 v153, v93 offset:256
 ds_write_b16_d16_hi v153, v93 offset:272
 v_pk_mov_b32 v[4:5], 0, 0
 v_pk_mov_b32 v[6:7], 0, 0
 v_pk_mov_b32 v[8:9], 0, 0
 v_pk_add_f32 v[96:97], v[96:97], v[98:99]
 v_cvt_pk_bf16_f32 v97, v96, v97
 ds_write_b16 v153, v97 offset:512
 ds_write_b16_d16_hi v153, v97 offset:528
 v_pk_mov_b32 v[10:11], 0, 0
 v_pk_mov_b32 v[12:13], 0, 0
 v_pk_mov_b32 v[14:15], 0, 0
 v_pk_mov_b32 v[16:17], 0, 0
 v_pk_mov_b32 v[18:19], 0, 0
 v_pk_mov_b32 v[20:21], 0, 0
 v_pk_mov_b32 v[22:23], 0, 0
 v_pk_mov_b32 v[24:25], 0, 0
 v_pk_mov_b32 v[26:27], 0, 0
 v_pk_mov_b32 v[28:29], 0, 0
 v_pk_mov_b32 v[30:31], 0, 0
 v_pk_mov_b32 v[32:33], 0, 0
 v_pk_mov_b32 v[34:35], 0, 0
 v_pk_mov_b32 v[36:37], 0, 0
 v_pk_mov_b32 v[38:39], 0, 0
 s_waitcnt lgkmcnt(0)
 s_barrier
 ds_read_b128 v[124:127], v150 offset:10240
 ds_read_b128 v[128:131], v150 offset:11264
 ds_read_b128 v[132:135], v150 offset:12288
 s_waitcnt lgkmcnt(2)
 v_smfmac_f32_16x16x64_bf16 v[0:3], v[124:127], v[116:123], v151
 ds_read_b128 v[116:119], v154 offset:22528
 ds_read_b128 v[120:123], v154 offset:23552
 s_waitcnt lgkmcnt(3)
 v_smfmac_f32_16x16x64_bf16 v[0:3], v[128:131], a[176:183], v151
 s_waitcnt lgkmcnt(2)
 v_smfmac_f32_16x16x64_bf16 v[0:3], v[132:135], a[184:191], v151
 v_smfmac_f32_16x16x64_bf16 v[4:7], v[124:127], v[100:107], v151
 ds_read_b128 v[100:103], v154 offset:24576
 ds_read_b128 v[104:107], v154 offset:25600
 v_smfmac_f32_16x16x64_bf16 v[4:7], v[128:131], a[192:199], v151
 v_smfmac_f32_16x16x64_bf16 v[4:7], v[132:135], a[200:207], v151
 v_smfmac_f32_16x16x64_bf16 v[8:11], v[124:127], a[208:215], v151
 v_smfmac_f32_16x16x64_bf16 v[8:11], v[128:131], v[108:115], v151
 ds_read_b128 v[108:111], v154 offset:26624
 ds_read_b128 v[112:115], v154 offset:27648
 v_smfmac_f32_16x16x64_bf16 v[8:11], v[132:135], a[216:223], v151
 v_smfmac_f32_16x16x64_bf16 v[12:15], v[124:127], a[224:231], v151
 s_waitcnt lgkmcnt(4)
 v_smfmac_f32_16x16x64_bf16 v[12:15], v[128:131], v[116:123], v151
 ds_read_b128 v[116:119], v154 offset:28672
 ds_read_b128 v[120:123], v154 offset:29696
 v_smfmac_f32_16x16x64_bf16 v[12:15], v[132:135], a[232:239], v151
 v_pk_add_f32 v[0:1], v[0:1], v[2:3]
 v_cvt_pk_bf16_f32 v136, v0, v1
 v_smfmac_f32_16x16x64_bf16 v[16:19], v[124:127], a[240:247], v151
 v_smfmac_f32_16x16x64_bf16 v[16:19], v[128:131], a[248:255], v151
 s_waitcnt lgkmcnt(4)
 v_smfmac_f32_16x16x64_bf16 v[16:19], v[132:135], v[100:107], v151
 ds_read_b128 v[100:103], v154 offset:30720
 ds_read_b128 v[104:107], v154 offset:31744
 v_pk_add_f32 v[4:5], v[4:5], v[6:7]
 v_cvt_pk_bf16_f32 v137, v4, v5
 v_smfmac_f32_16x16x64_bf16 v[20:23], v[124:127], v[168:175], v151
 v_smfmac_f32_16x16x64_bf16 v[20:23], v[128:131], v[176:183], v151
 s_waitcnt lgkmcnt(4)
 v_smfmac_f32_16x16x64_bf16 v[20:23], v[132:135], v[108:115], v151
 ds_read_b128 v[108:111], v154 offset:32768
 ds_read_b128 v[112:115], v154 offset:33792
 v_pk_add_f32 v[8:9], v[8:9], v[10:11]
 v_cvt_pk_bf16_f32 v138, v8, v9
 v_smfmac_f32_16x16x64_bf16 v[24:27], v[124:127], v[184:191], v151
 v_smfmac_f32_16x16x64_bf16 v[24:27], v[128:131], v[192:199], v151
 v_smfmac_f32_16x16x64_bf16 v[24:27], v[132:135], v[200:207], v151
 v_pk_add_f32 v[12:13], v[12:13], v[14:15]
 v_cvt_pk_bf16_f32 v139, v12, v13
 s_waitcnt lgkmcnt(4)
 v_smfmac_f32_16x16x64_bf16 v[28:31], v[124:127], v[116:123], v151
 v_smfmac_f32_16x16x64_bf16 v[28:31], v[128:131], v[208:215], v151
 v_permlane32_swap_b32 v136, v138
 v_permlane32_swap_b32 v137, v139
 v_smfmac_f32_16x16x64_bf16 v[28:31], v[132:135], v[216:223], v151
 v_pk_add_f32 v[16:17], v[16:17], v[18:19]
 v_cvt_pk_bf16_f32 v140, v16, v17
 s_waitcnt lgkmcnt(2)
 v_smfmac_f32_16x16x64_bf16 v[32:35], v[124:127], v[100:107], v151
 v_permlane16_swap_b32 v136, v137
 v_permlane16_swap_b32 v138, v139
 buffer_store_dwordx4 v[136:139], v157, s[8:11], s56 offen
 s_add_u32 s56, s56, 4096
 v_smfmac_f32_16x16x64_bf16 v[32:35], v[128:131], v[224:231], v151
 v_smfmac_f32_16x16x64_bf16 v[32:35], v[132:135], v[232:239], v151
 v_pk_add_f32 v[20:21], v[20:21], v[22:23]
 v_cvt_pk_bf16_f32 v141, v20, v21
 v_smfmac_f32_16x16x64_bf16 v[36:39], v[124:127], v[240:247], v151
 s_waitcnt lgkmcnt(0)
 v_smfmac_f32_16x16x64_bf16 v[36:39], v[128:131], v[108:115], v151
 v_smfmac_f32_16x16x64_bf16 v[36:39], v[132:135], v[248:255], v151
 v_pk_add_f32 v[24:25], v[24:25], v[26:27]
 v_cvt_pk_bf16_f32 v142, v24, v25
 v_pk_add_f32 v[28:29], v[28:29], v[30:31]
 v_cvt_pk_bf16_f32 v143, v28, v29
 s_nop 0
 v_pk_add_f32 v[32:33], v[32:33], v[34:35]
 v_cvt_pk_bf16_f32 v144, v32, v33
 v_permlane32_swap_b32 v140, v142
 v_permlane32_swap_b32 v141, v143
 v_pk_add_f32 v[36:37], v[36:37], v[38:39]
 v_cvt_pk_bf16_f32 v145, v36, v37
 v_permlane16_swap_b32 v140, v141
 v_permlane16_swap_b32 v142, v143
 buffer_store_dwordx4 v[140:143], v157, s[8:11], s56 offen
 s_add_u32 s56, s56, 4096
 v_permlane32_swap_b32 v144, v146
 v_permlane32_swap_b32 v145, v147
 s_nop 1
 v_permlane16_swap_b32 v144, v145
 v_permlane16_swap_b32 v146, v147
 s_mov_b32 exec_hi, 0
 buffer_store_dwordx4 v[144:147], v157, s[8:11], s56 offen
 s_mov_b32 exec_hi, -1
 s_cmp_eq_u32 s16, 63
 s_cbranch_scc1 last_34
 s_waitcnt vmcnt(0)
pu_35:
 buffer_load_dwordx4 v[124:127], v158, s[8:11], s55 offen sc1
 buffer_load_dwordx4 v[128:131], v158, s[8:11], s55 offen offset:256 sc1
 buffer_load_dwordx4 v[132:135], v159, s[8:11], s55 offen sc1
 buffer_load_dwordx4 v[0:3], v160, s[8:11], s57 offen offset:0 sc1
 buffer_load_dwordx4 v[8:11], v160, s[8:11], s57 offen offset:1280 sc1
 buffer_load_dwordx4 v[16:19], v161, s[8:11], s57 offen sc1
 s_waitcnt vmcnt(3)
 v_max3_u32 v100, v124, v128, v132
 v_cmp_eq_u32 vcc, -1, v100
 s_cbranch_vccz ok_38
 s_sub_u32 s45, s45, 1
 s_cbranch_scc0 pu_35
 s_mov_b32 s45, 0
ok_38:
 s_branch pc_37
pp_36:
 buffer_load_dwordx4 v[0:3], v160, s[8:11], s57 offen offset:0 sc1
 buffer_load_dwordx4 v[8:11], v160, s[8:11], s57 offen offset:1280 sc1
 buffer_load_dwordx4 v[16:19], v161, s[8:11], s57 offen sc1
pc_37:
 s_waitcnt vmcnt(0)
 v_max3_u32 v20, v0, v8, v16
 v_cmp_eq_u32 vcc, -1, v20
 v_mfma_f32_16x16x32_bf16 v[88:91], v[40:43], v[0:3], 0
 v_mov_b32_dpp v4, v0 row_ror:8 row_mask:0xf bank_mask:0xf
 v_mov_b32_dpp v5, v1 row_ror:8 row_mask:0xf bank_mask:0xf
 v_mov_b32_dpp v6, v2 row_ror:8 row_mask:0xf bank_mask:0xf
 v_mov_b32_dpp v7, v3 row_ror:8 row_mask:0xf bank_mask:0xf
 s_cbranch_vccz ok_39
 s_sub_u32 s45, s45, 1
 s_cbranch_scc0 pp_36
 s_mov_b32 s45, 0
ok_39:
 v_mfma_f32_16x16x32_bf16 v[92:95], v[44:47], v[0:3], 0
 v_mfma_f32_16x16x32_bf16 v[96:99], v[48:51], v[0:3], 0
 v_mfma_f32_16x16x32_bf16 v[88:91], v[52:55], v[4:7], v[88:91]
 v_mfma_f32_16x16x32_bf16 v[92:95], v[56:59], v[4:7], v[92:95]
 v_mfma_f32_16x16x32_bf16 v[96:99], v[60:63], v[4:7], v[96:99]
 v_mfma_f32_16x16x32_bf16 v[88:91], v[64:67], v[8:11], v[88:91]
 v_mov_b32_dpp v12, v8 row_ror:8 row_mask:0xf bank_mask:0xf
 v_mov_b32_dpp v13, v9 row_ror:8 row_mask:0xf bank_mask:0xf
 v_mov_b32_dpp v14, v10 row_ror:8 row_mask:0xf bank_mask:0xf
 v_mov_b32_dpp v15, v11 row_ror:8 row_mask:0xf bank_mask:0xf
 v_mfma_f32_16x16x32_bf16 v[92:95], v[68:71], v[8:11], v[92:95]
 v_mfma_f32_16x16x32_bf16 v[96:99], v[72:75], v[8:11], v[96:99]
 v_mfma_f32_16x16x32_bf16 v[88:91], v[76:79], v[12:15], v[88:91]
 v_mfma_f32_16x16x32_bf16 v[92:95], v[80:83], v[12:15], v[92:95]
 v_mfma_f32_16x16x32_bf16 v[96:99], v[84:87], v[12:15], v[96:99]
 v_mfma_f32_16x16x32_bf16 v[88:91], v[124:127], v[16:19], v[88:91]
 v_mfma_f32_16x16x32_bf16 v[92:95], v[128:131], v[16:19], v[92:95]
 v_mfma_f32_16x16x32_bf16 v[96:99], v[132:135], v[16:19], v[96:99]
 s_nop 6
 v_mov_b32_dpp v88, v92 row_ror:8 row_mask:0xf bank_mask:0xc
 v_mov_b32_dpp v89, v93 row_ror:8 row_mask:0xf bank_mask:0xc
 v_mov_b32_dpp v90, v94 row_ror:8 row_mask:0xf bank_mask:0xc
 v_mov_b32_dpp v91, v95 row_ror:8 row_mask:0xf bank_mask:0xc
 ds_write_b128 v162, v[88:91]
 s_mov_b64 exec, s[40:41]
 ds_write_b128 v162, v[96:99] offset:1024
 s_mov_b64 exec, -1
 s_waitcnt vmcnt(0) lgkmcnt(0)
 s_barrier
 s_cmp_ge_u32 s14, 2
 s_cbranch_scc1 nx_40
 ds_read_b128 v[0:3], v166 offset:0
 ds_read_b128 v[4:7], v166 offset:1536
 ds_read_b128 v[8:11], v166 offset:3072
 ds_read_b128 v[12:15], v166 offset:4608
 s_waitcnt lgkmcnt(2)
 v_pk_add_f32 v[0:1], v[0:1], v[4:5]
 v_pk_add_f32 v[2:3], v[2:3], v[6:7]
 s_waitcnt lgkmcnt(0)
 v_pk_add_f32 v[8:9], v[8:9], v[12:13]
 v_pk_add_f32 v[10:11], v[10:11], v[14:15]
 v_pk_add_f32 v[0:1], v[0:1], v[8:9]
 v_pk_add_f32 v[2:3], v[2:3], v[10:11]
 s_mov_b64 exec, s[6:7]
 v_cvt_pk_bf16_f32 v4, v0, v1
 v_cvt_pk_bf16_f32 v5, v2, v3
 buffer_store_dwordx2 v[4:5], v165, s[8:11], 0 offen sc1
 buffer_store_dwordx2 v[4:5], v163, s[8:11], s52 offen
 s_mov_b64 exec, -1
nx_40:
 s_add_u32 s16, s16, 1
 s_branch Vstep_25
last_34:
 s_add_u32 s46, s13, 16
 s_endpgm
role_S_slow:
 s_branch role_S_slow2
role_V_slow:
 s_branch role_V_slow2
role_worker:
 s_sub_u32 s17, s17, 64
 s_load_dwordx8 s[64:71], s[0:1], 16
 s_load_dwordx4 s[72:75], s[0:1], 64
 s_load_dwordx4 s[76:79], s[0:1], 80
 s_load_dwordx2 s[80:81], s[0:1], 0
 s_waitcnt lgkmcnt(0)
 s_mov_b32 s20, s64
 s_and_b32 s21, s65, 0xffff
 s_mov_b32 s22, 0x780000
 s_mov_b32 s23, 0x20000
 s_mov_b32 s24, s66
 s_and_b32 s25, s67, 0xffff
 s_mov_b32 s26, 0x780000
 s_mov_b32 s27, 0x20000
 s_mov_b32 s32, s68
 s_and_b32 s33, s69, 0xffff
 s_mov_b32 s34, 0x780000
 s_mov_b32 s35, 0x20000
 s_mov_b32 s36, s70
 s_and_b32 s37, s71, 0xffff
 s_mov_b32 s38, 0x780000
 s_mov_b32 s39, 0x20000
 s_cmp_lt_u32 s14, 2
 s_cselect_b32 s72, s72, s74
 s_cselect_b32 s73, s73, s75
 s_mov_b32 s40, s72
 s_and_b32 s41, s73, 0xffff
 s_mov_b32 s42, 0x1e0000
 s_mov_b32 s43, 0x20000
 s_mov_b32 s60, s76
 s_and_b32 s61, s77, 0xffff
 s_mov_b32 s62, 0x1e0000
 s_mov_b32 s63, 0x20000
 s_mov_b32 s4, s78
 s_and_b32 s5, s79, 0xffff
 s_mov_b32 s6, 0x280000
 s_mov_b32 s7, 0x20000
 s_mov_b32 s56, s80
 s_and_b32 s57, s81, 0xffff
 s_mov_b32 s58, 0x280000
 s_mov_b32 s59, 0x20000
 s_mov_b32 s45, 2000000
 s_mul_i32 s19, s14, 6144
 v_and_b32 v20, 63, v0
 v_lshlrev_b32 v232, 4, v20
 v_and_b32 v1, 31, v20
 v_lshrrev_b32 v2, 5, v20
 v_bfe_u32 v3, v20, 2, 2
 v_bfe_u32 v4, v20, 4, 1
 v_and_b32 v5, 3, v20
 v_lshlrev_b32 v5, 3, v5
 v_lshl_add_u32 v5, v4, 5, v5
 v_bfe_u32 v6, v20, 3, 1
 v_lshlrev_b32 v6, 6, v6
 v_lshl_add_u32 v7, v2, 3, v3
 v_mul_u32_u24 v8, 384, v7
 v_add_u32 v8, v8, v5
 v_add_u32 v30, v8, v6
 v_sub_u32 v31, v8, v6
 v_mul_u32_u24 v8, 192, v7
 v_add_u32 v32, v8, v5
 v_lshl_add_u32 v7, v2, 2, v3
 v_lshl_add_u32 v8, v7, 7, v5
 v_add_u32 v33, v8, v6
 v_sub_u32 v34, v8, v6
 v_lshl_add_u32 v8, v7, 8, v5
 v_xor_b32 v9, 0, v3
 v_lshl_add_u32 v40, v9, 6, v8
 v_xor_b32 v9, 1, v3
 v_lshl_add_u32 v41, v9, 6, v8
 v_xor_b32 v9, 2, v3
 v_lshl_add_u32 v42, v9, 6, v8
 v_xor_b32 v9, 3, v3
 v_lshl_add_u32 v43, v9, 6, v8
 v_lshlrev_b32 v8, 5, v1
 v_lshl_add_u32 v52, v2, 4, v8
 v_mul_u32_u24 v8, 10240, v2
 v_lshl_add_u32 v53, v1, 4, v8
 v_mul_u32_u24 v8, 2560, v2
 v_lshl_add_u32 v54, v1, 4, v8
 v_mul_u32_u24 v8, 1280, v1
 v_lshl_add_u32 v55, v2, 3, v8
 v_lshrrev_b32 v8, 4, v1
 v_mul_u32_u24 v9, 6144, v8
 v_and_b32 v10, 15, v1
 v_lshl_add_u32 v9, v10, 4, v9
 v_lshl_add_u32 v56, v2, 8, v9
 v_bfe_u32 v9, v1, 3, 1
 v_mul_u32_u24 v9, 6144, v9
 v_lshl_add_u32 v9, v8, 7, v9
 v_and_b32 v10, 7, v1
 v_lshl_add_u32 v9, v10, 4, v9
 v_lshl_add_u32 v57, v2, 8, v9
 v_add_u32 v8, 0, v20
 v_mul_u32_u24 v9, 0xaaab, v8
 v_lshrrev_b32 v11, 19, v9
 v_lshrrev_b32 v9, 20, v9
 v_mul_u32_u24 v10, 24, v9
 v_sub_u32 v10, v8, v10
 v_bfe_u32 v12, v9, 1, 1
 v_lshlrev_b32 v12, 2, v12
 v_xor_b32 v10, v10, v12
 s_lshl_b32 s28, s14, 4
 v_add_u32 v9, s28, v9
 v_mul_u32_u24 v9, 12288, v9
 v_lshl_add_u32 v44, v10, 4, v9
 v_mul_u32_u24 v10, 12, v11
 v_sub_u32 v10, v8, v10
 s_and_b32 s28, s14, 1
 s_lshl_b32 s28, s28, 5
 v_add_u32 v11, s28, v11
 v_mul_u32_u24 v11, 3072, v11
 v_lshl_add_u32 v48, v10, 4, v11
 v_add_u32 v8, 64, v20
 v_mul_u32_u24 v9, 0xaaab, v8
 v_lshrrev_b32 v11, 19, v9
 v_lshrrev_b32 v9, 20, v9
 v_mul_u32_u24 v10, 24, v9
 v_sub_u32 v10, v8, v10
 v_bfe_u32 v12, v9, 1, 1
 v_lshlrev_b32 v12, 2, v12
 v_xor_b32 v10, v10, v12
 s_lshl_b32 s28, s14, 4
 v_add_u32 v9, s28, v9
 v_mul_u32_u24 v9, 12288, v9
 v_lshl_add_u32 v45, v10, 4, v9
 v_mul_u32_u24 v10, 12, v11
 v_sub_u32 v10, v8, v10
 s_and_b32 s28, s14, 1
 s_lshl_b32 s28, s28, 5
 v_add_u32 v11, s28, v11
 v_mul_u32_u24 v11, 3072, v11
 v_lshl_add_u32 v49, v10, 4, v11
 v_add_u32 v8, 128, v20
 v_mul_u32_u24 v9, 0xaaab, v8
 v_lshrrev_b32 v11, 19, v9
 v_lshrrev_b32 v9, 20, v9
 v_mul_u32_u24 v10, 24, v9
 v_sub_u32 v10, v8, v10
 v_bfe_u32 v12, v9, 1, 1
 v_lshlrev_b32 v12, 2, v12
 v_xor_b32 v10, v10, v12
 s_lshl_b32 s28, s14, 4
 v_add_u32 v9, s28, v9
 v_mul_u32_u24 v9, 12288, v9
 v_lshl_add_u32 v46, v10, 4, v9
 v_mul_u32_u24 v10, 12, v11
 v_sub_u32 v10, v8, v10
 s_and_b32 s28, s14, 1
 s_lshl_b32 s28, s28, 5
 v_add_u32 v11, s28, v11
 v_mul_u32_u24 v11, 3072, v11
 v_lshl_add_u32 v50, v10, 4, v11
 v_lshrrev_b32 v8, 3, v20
 v_and_b32 v9, 7, v20
 v_bfe_u32 v10, v8, 1, 1
 v_lshlrev_b32 v10, 2, v10
 v_xor_b32 v9, v9, v10
 s_mul_i32 s28, s14, 48
 v_add_u32 v8, s28, v8
 v_mul_u32_u24 v8, 1280, v8
 v_lshl_add_u32 v35, v9, 4, v8
 v_lshrrev_b32 v8, 4, v20
 v_and_b32 v9, 15, v20
 v_lshlrev_b32 v10, 2, v8
 v_xor_b32 v9, v9, v10
 s_mul_i32 s28, s14, 24
 v_add_u32 v8, s28, v8
 v_mul_u32_u24 v8, 1280, v8
 v_lshl_add_u32 v36, v9, 4, v8
 v_accvgpr_write_b32 a200, v30
 v_accvgpr_write_b32 a201, v31
 v_accvgpr_write_b32 a202, v32
 v_accvgpr_write_b32 a203, v33
 v_accvgpr_write_b32 a204, v34
 v_accvgpr_write_b32 a205, v35
 v_accvgpr_write_b32 a206, v36
 v_accvgpr_write_b32 a207, v37
 v_accvgpr_write_b32 a208, v38
 v_accvgpr_write_b32 a209, v39
 v_accvgpr_write_b32 a210, v40
 v_accvgpr_write_b32 a211, v41
 v_accvgpr_write_b32 a212, v42
 v_accvgpr_write_b32 a213, v43
 v_accvgpr_write_b32 a214, v44
 v_accvgpr_write_b32 a215, v45
 v_accvgpr_write_b32 a216, v46
 v_accvgpr_write_b32 a217, v47
 v_accvgpr_write_b32 a218, v48
 v_accvgpr_write_b32 a219, v49
 v_accvgpr_write_b32 a220, v50
 v_accvgpr_write_b32 a221, v51
 v_accvgpr_write_b32 a222, v52
 v_accvgpr_write_b32 a223, v53
 v_accvgpr_write_b32 a224, v54
 v_accvgpr_write_b32 a225, v55
 v_accvgpr_write_b32 a226, v56
 v_accvgpr_write_b32 a227, v57
 s_add_u32 s18, s17, 0
wk_loop:
 s_cmp_ge_u32 s18, 2768
 s_cbranch_scc1 wk_done
 s_cmp_ge_u32 s18, 1488
 s_cbranch_scc0 wk_n4
 s_sub_u32 s28, s18, 1488
 s_mul_i32 s50, s28, 0xccd
 s_lshr_b32 s50, s50, 16
 s_mul_i32 s51, s50, 20
 s_sub_u32 s51, s28, s51
 v_accvgpr_read_b32 v235, a225
 v_accvgpr_read_b32 v244, a222
 v_accvgpr_read_b32 v245, a223
 v_accvgpr_read_b32 v246, a224
 s_lshr_b32 s28, s50, 2
 s_mul_i32 s28, s28, 5
 s_lshr_b32 s52, s51, 2
 s_add_u32 s28, s28, s52
 s_lshl_b32 s28, s28, 2
 s_add_u32 s28, s28, 6336512
 s_cmp_eq_u32 s14, 0
 s_cbranch_scc0 so_44
 v_mov_b32 v233, 0
 s_mov_b64 exec, 1
sp_43:
 buffer_load_dword v234, v233, s[8:11], s28 offen sc1
 s_waitcnt vmcnt(0)
 v_readfirstlane_b32 s29, v234
 s_cmp_ge_u32 s29, 1
 s_cbranch_scc1 so_44
 s_sleep 32
 s_sub_u32 s45, s45, 1
 s_cbranch_scc0 sp_43
 s_mov_b32 s45, 0
so_44:
 s_mov_b64 exec, -1
 s_barrier
 s_lshl_b32 s52, s50, 5
 s_lshl_b32 s28, s14, 3
 s_add_u32 s52, s52, s28
 s_mul_i32 s53, s50, 20
 s_add_u32 s53, s53, s51
 s_lshl_b32 s53, s53, 12
 s_lshl_b32 s28, s14, 10
 s_add_u32 s53, s53, s28
 s_add_u32 s53, s53, 7340032
 buffer_load_dwordx4 v[180:183], v232, s[8:11], s53 offen
 s_sub_u32 s28, s50, 2
 s_max_i32 s28, s28, 0
 s_lshl_b32 s28, s28, 7
 s_add_u32 s28, s28, 6291456
 s_cmp_eq_u32 s14, 0
 s_cbranch_scc0 so_47
 v_mov_b32 v233, 0
 s_mov_b64 exec, 1
sp_46:
 buffer_load_dword v234, v233, s[8:11], s28 offen sc1
 s_waitcnt vmcnt(0)
 v_readfirstlane_b32 s29, v234
 s_cmp_ge_u32 s29, 32
 s_cbranch_scc1 so_47
 s_sleep 32
 s_sub_u32 s45, s45, 1
 s_cbranch_scc0 sp_46
 s_mov_b32 s45, 0
so_47:
 s_mov_b64 exec, -1
 s_barrier
 s_mul_i32 s53, s52, 40960
 s_lshl_b32 s28, s51, 11
 s_add_u32 s53, s53, s28
 s_add_u32 s53, s53, 96468992
 s_mul_i32 s54, s52, 2560
 s_add_u32 s54, s54, 18874368
 s_mul_i32 s55, s52, 10240
 s_lshl_b32 s28, s51, 9
 s_add_u32 s55, s55, s28
 s_add_u32 s55, s55, 25165824
 buffer_load_dwordx4 v[16:19], v244, s[8:11], s53 offen offset:0
 buffer_load_dwordx4 v[24:27], v244, s[8:11], s53 offen offset:1024
 s_add_u32 s53, s53, 40960
 buffer_load_dwordx4 v[32:35], v244, s[8:11], s53 offen offset:0
 buffer_load_dwordx4 v[40:43], v244, s[8:11], s53 offen offset:1024
 s_add_u32 s53, s53, 40960
 buffer_load_dwordx4 v[48:51], v244, s[8:11], s53 offen offset:0
 buffer_load_dwordx4 v[56:59], v244, s[8:11], s53 offen offset:1024
 s_add_u32 s53, s53, 40960
 buffer_load_dwordx4 v[64:67], v244, s[8:11], s53 offen offset:0
 buffer_load_dwordx4 v[72:75], v244, s[8:11], s53 offen offset:1024
 s_add_u32 s53, s53, 40960
 buffer_load_dwordx4 v[80:83], v244, s[8:11], s53 offen offset:0
 buffer_load_dwordx4 v[88:91], v244, s[8:11], s53 offen offset:1024
 s_add_u32 s53, s53, 40960
 buffer_load_dwordx4 v[96:99], v244, s[8:11], s53 offen offset:0
 buffer_load_dwordx4 v[104:107], v244, s[8:11], s53 offen offset:1024
 s_add_u32 s53, s53, 40960
 buffer_load_dwordx4 v[112:115], v244, s[8:11], s53 offen offset:0
 buffer_load_dwordx4 v[120:123], v244, s[8:11], s53 offen offset:1024
 s_add_u32 s53, s53, 40960
 buffer_load_dwordx4 v[128:131], v244, s[8:11], s53 offen offset:0
 buffer_load_dwordx4 v[136:139], v244, s[8:11], s53 offen offset:1024
 s_add_u32 s53, s53, 40960
 s_lshl_b32 s28, s50, 7
 s_add_u32 s28, s28, 6291456
 s_cmp_eq_u32 s14, 0
 s_cbranch_scc0 so_50
 v_mov_b32 v233, 0
 s_mov_b64 exec, 1
sp_49:
 buffer_load_dword v234, v233, s[8:11], s28 offen sc1
 s_waitcnt vmcnt(0)
 v_readfirstlane_b32 s29, v234
 s_cmp_ge_u32 s29, 32
 s_cbranch_scc1 so_50
 s_sleep 2
 s_cmp_ge_u32 s50, 61
 s_cbranch_scc1 ss_51
 s_sleep 32
ss_51:
 s_sub_u32 s45, s45, 1
 s_cbranch_scc0 sp_49
 s_mov_b32 s45, 0
so_50:
 s_mov_b64 exec, -1
 s_barrier
 buffer_load_dwordx4 v[20:23], v244, s[8:11], s54 offen offset:0
 buffer_load_dwordx4 v[28:31], v244, s[8:11], s54 offen offset:1024
 buffer_load_dwordx4 v[144:147], v245, s[8:11], s55 offen
 buffer_load_dwordx4 v[148:151], v246, s[8:11], s54 offen offset:2048
 s_add_u32 s55, s55, 20480
 s_add_u32 s54, s54, 2560
 buffer_load_dwordx4 v[36:39], v244, s[8:11], s54 offen offset:0
 buffer_load_dwordx4 v[44:47], v244, s[8:11], s54 offen offset:1024
 s_add_u32 s54, s54, 2560
 buffer_load_dwordx4 v[52:55], v244, s[8:11], s54 offen offset:0
 buffer_load_dwordx4 v[60:63], v244, s[8:11], s54 offen offset:1024
 buffer_load_dwordx4 v[152:155], v245, s[8:11], s55 offen
 buffer_load_dwordx4 v[156:159], v246, s[8:11], s54 offen offset:2048
 s_add_u32 s55, s55, 20480
 s_add_u32 s54, s54, 2560
 buffer_load_dwordx4 v[68:71], v244, s[8:11], s54 offen offset:0
 buffer_load_dwordx4 v[76:79], v244, s[8:11], s54 offen offset:1024
 s_add_u32 s54, s54, 2560
 buffer_load_dwordx4 v[84:87], v244, s[8:11], s54 offen offset:0
 buffer_load_dwordx4 v[92:95], v244, s[8:11], s54 offen offset:1024
 buffer_load_dwordx4 v[160:163], v245, s[8:11], s55 offen
 buffer_load_dwordx4 v[164:167], v246, s[8:11], s54 offen offset:2048
 s_add_u32 s55, s55, 20480
 s_add_u32 s54, s54, 2560
 buffer_load_dwordx4 v[100:103], v244, s[8:11], s54 offen offset:0
 buffer_load_dwordx4 v[108:111], v244, s[8:11], s54 offen offset:1024
 s_add_u32 s54, s54, 2560
 buffer_load_dwordx4 v[116:119], v244, s[8:11], s54 offen offset:0
 buffer_load_dwordx4 v[124:127], v244, s[8:11], s54 offen offset:1024
 buffer_load_dwordx4 v[168:171], v245, s[8:11], s55 offen
 buffer_load_dwordx4 v[172:175], v246, s[8:11], s54 offen offset:2048
 s_add_u32 s55, s55, 20480
 s_add_u32 s54, s54, 2560
 buffer_load_dwordx4 v[132:135], v244, s[8:11], s54 offen offset:0
 buffer_load_dwordx4 v[140:143], v244, s[8:11], s54 offen offset:1024
 s_add_u32 s54, s54, 2560
 s_waitcnt vmcnt(23)
 v_mfma_f32_32x32x16_bf16 v[0:15], v[16:19], v[20:23], 0
 s_waitcnt vmcnt(22)
 v_mfma_f32_32x32x16_bf16 v[0:15], v[24:27], v[28:31], v[0:15]
 s_waitcnt vmcnt(20)
 v_mfma_f32_32x32x16_bf16 v[0:15], v[144:147], v[148:151], v[0:15]
 s_waitcnt vmcnt(19)
 v_mfma_f32_32x32x16_bf16 v[0:15], v[32:35], v[36:39], v[0:15]
 s_waitcnt vmcnt(18)
 v_mfma_f32_32x32x16_bf16 v[0:15], v[40:43], v[44:47], v[0:15]
 s_waitcnt vmcnt(17)
 v_mfma_f32_32x32x16_bf16 v[0:15], v[48:51], v[52:55], v[0:15]
 s_waitcnt vmcnt(16)
 v_mfma_f32_32x32x16_bf16 v[0:15], v[56:59], v[60:63], v[0:15]
 s_waitcnt vmcnt(14)
 v_mfma_f32_32x32x16_bf16 v[0:15], v[152:155], v[156:159], v[0:15]
 s_waitcnt vmcnt(13)
 v_mfma_f32_32x32x16_bf16 v[0:15], v[64:67], v[68:71], v[0:15]
 s_waitcnt vmcnt(12)
 v_mfma_f32_32x32x16_bf16 v[0:15], v[72:75], v[76:79], v[0:15]
 s_waitcnt vmcnt(11)
 v_mfma_f32_32x32x16_bf16 v[0:15], v[80:83], v[84:87], v[0:15]
 s_waitcnt vmcnt(10)
 v_mfma_f32_32x32x16_bf16 v[0:15], v[88:91], v[92:95], v[0:15]
 s_waitcnt vmcnt(8)
 v_mfma_f32_32x32x16_bf16 v[0:15], v[160:163], v[164:167], v[0:15]
 s_waitcnt vmcnt(7)
 v_mfma_f32_32x32x16_bf16 v[0:15], v[96:99], v[100:103], v[0:15]
 s_waitcnt vmcnt(6)
 v_mfma_f32_32x32x16_bf16 v[0:15], v[104:107], v[108:111], v[0:15]
 s_waitcnt vmcnt(5)
 v_mfma_f32_32x32x16_bf16 v[0:15], v[112:115], v[116:119], v[0:15]
 s_waitcnt vmcnt(4)
 v_mfma_f32_32x32x16_bf16 v[0:15], v[120:123], v[124:127], v[0:15]
 s_waitcnt vmcnt(2)
 v_mfma_f32_32x32x16_bf16 v[0:15], v[168:171], v[172:175], v[0:15]
 s_waitcnt vmcnt(1)
 v_mfma_f32_32x32x16_bf16 v[0:15], v[128:131], v[132:135], v[0:15]
 s_waitcnt vmcnt(0)
 v_mfma_f32_32x32x16_bf16 v[0:15], v[136:139], v[140:143], v[0:15]
 s_lshl_b32 s28, s14, 12
 v_add_u32 v184, s28, v232
 s_lshl_b32 s28, s14, 10
 v_add_u32 v185, s28, v232
 s_nop 15
 ds_write_b128 v184, v[0:3] offset:0
 ds_write_b128 v184, v[4:7] offset:1024
 ds_write_b128 v184, v[8:11] offset:2048
 ds_write_b128 v184, v[12:15] offset:3072
 s_waitcnt lgkmcnt(0)
 s_barrier
 ds_read_b128 v[16:19], v185 offset:0
 ds_read_b128 v[20:23], v185 offset:4096
 ds_read_b128 v[24:27], v185 offset:8192
 ds_read_b128 v[28:31], v185 offset:12288
 s_mul_i32 s53, s50, 40960
 s_lshl_b32 s28, s51, 6
 s_add_u32 s53, s53, s28
 s_lshl_b32 s28, s14, 4
 s_add_u32 s53, s53, s28
 s_waitcnt lgkmcnt(0)
 v_pk_add_f32 v[180:181], v[180:181], v[16:17]
 v_pk_add_f32 v[182:183], v[182:183], v[18:19]
 v_pk_add_f32 v[180:181], v[180:181], v[20:21]
 v_pk_add_f32 v[182:183], v[182:183], v[22:23]
 v_pk_add_f32 v[180:181], v[180:181], v[24:25]
 v_pk_add_f32 v[182:183], v[182:183], v[26:27]
 v_pk_add_f32 v[180:181], v[180:181], v[28:29]
 v_pk_add_f32 v[182:183], v[182:183], v[30:31]
 v_cvt_pk_bf16_f32 v180, v180, v181
 v_cvt_pk_bf16_f32 v181, v182, v183
 buffer_store_dwordx2 v[180:181], v235, s[4:7], s53 offen
 s_barrier
wk_next:
 s_add_u32 s18, s18, 192
 s_branch wk_loop
wk_done:
 s_endpgm
wk_n4:
 s_cmp_ge_u32 s18, 1408
 s_cbranch_scc0 wk_n3
 s_sub_u32 s28, s18, 1408
 s_lshr_b32 s51, s28, 4
 s_and_b32 s50, s28, 15
 v_accvgpr_read_b32 v235, a225
 v_accvgpr_read_b32 v236, a206
 v_accvgpr_read_b32 v240, a210
 v_accvgpr_read_b32 v241, a211
 v_accvgpr_read_b32 v242, a212
 v_accvgpr_read_b32 v243, a213
 v_add_u32 v248, 0x10000, v240
 v_add_u32 v249, 0x10000, v241
 v_add_u32 v250, 0x10000, v242
 v_add_u32 v251, 0x10000, v243
 s_lshl_b32 s28, s50, 7
 s_add_u32 s28, s28, 6332416
 s_cmp_eq_u32 s14, 0
 s_cbranch_scc0 so_53
 v_mov_b32 v233, 0
 s_mov_b64 exec, 1
sp_52:
 buffer_load_dword v234, v233, s[8:11], s28 offen sc1
 s_waitcnt vmcnt(0)
 v_readfirstlane_b32 s29, v234
 s_cmp_ge_u32 s29, 16
 s_cbranch_scc1 so_53
 s_sleep 32
 s_sub_u32 s45, s45, 1
 s_cbranch_scc0 sp_52
 s_mov_b32 s45, 0
so_53:
 s_mov_b64 exec, -1
 s_barrier
 s_lshl_b32 s52, s51, 8
 s_lshl_b32 s53, s50, 2
 s_add_u32 s53, s53, s14
 s_mul_i32 s54, s53, 98304
 s_add_u32 s54, s54, 12582912
 s_mul_i32 s55, s53, 40960
 s_add_u32 s55, s55, s52
 buffer_load_dwordx2 v[64:65], v235, s[56:59], s55 offen offset:0
 buffer_load_dwordx2 v[66:67], v235, s[56:59], s55 offen offset:16
 buffer_load_dwordx2 v[68:69], v235, s[56:59], s55 offen offset:32
 buffer_load_dwordx2 v[70:71], v235, s[56:59], s55 offen offset:48
 buffer_load_dwordx2 v[72:73], v235, s[56:59], s55 offen offset:64
 buffer_load_dwordx2 v[74:75], v235, s[56:59], s55 offen offset:80
 buffer_load_dwordx2 v[76:77], v235, s[56:59], s55 offen offset:96
 buffer_load_dwordx2 v[78:79], v235, s[56:59], s55 offen offset:112
 buffer_load_dwordx2 v[80:81], v235, s[56:59], s55 offen offset:128
 buffer_load_dwordx2 v[82:83], v235, s[56:59], s55 offen offset:144
 buffer_load_dwordx2 v[84:85], v235, s[56:59], s55 offen offset:160
 buffer_load_dwordx2 v[86:87], v235, s[56:59], s55 offen offset:176
 buffer_load_dwordx2 v[88:89], v235, s[56:59], s55 offen offset:192
 buffer_load_dwordx2 v[90:91], v235, s[56:59], s55 offen offset:208
 buffer_load_dwordx2 v[92:93], v235, s[56:59], s55 offen offset:224
 buffer_load_dwordx2 v[94:95], v235, s[56:59], s55 offen offset:240
 buffer_load_dwordx4 a[0:3], v232, s[8:11], s54 offen offset:0
 buffer_load_dwordx4 a[4:7], v232, s[8:11], s54 offen offset:1024
 buffer_load_dwordx4 a[8:11], v232, s[8:11], s54 offen offset:2048
 s_add_u32 s54, s54, 3072
 buffer_load_dwordx4 a[12:15], v232, s[8:11], s54 offen offset:0
 buffer_load_dwordx4 a[16:19], v232, s[8:11], s54 offen offset:1024
 buffer_load_dwordx4 a[20:23], v232, s[8:11], s54 offen offset:2048
 s_add_u32 s54, s54, 3072
 buffer_load_dwordx4 a[24:27], v232, s[8:11], s54 offen offset:0
 buffer_load_dwordx4 a[28:31], v232, s[8:11], s54 offen offset:1024
 buffer_load_dwordx4 a[32:35], v232, s[8:11], s54 offen offset:2048
 s_add_u32 s54, s54, 3072
 buffer_load_dwordx4 a[36:39], v232, s[8:11], s54 offen offset:0
 buffer_load_dwordx4 a[40:43], v232, s[8:11], s54 offen offset:1024
 buffer_load_dwordx4 a[44:47], v232, s[8:11], s54 offen offset:2048
 s_add_u32 s54, s54, 3072
 buffer_load_dwordx4 a[48:51], v232, s[8:11], s54 offen offset:0
 buffer_load_dwordx4 a[52:55], v232, s[8:11], s54 offen offset:1024
 buffer_load_dwordx4 a[56:59], v232, s[8:11], s54 offen offset:2048
 s_add_u32 s54, s54, 3072
 buffer_load_dwordx4 a[60:63], v232, s[8:11], s54 offen offset:0
 buffer_load_dwordx4 a[64:67], v232, s[8:11], s54 offen offset:1024
 buffer_load_dwordx4 a[68:71], v232, s[8:11], s54 offen offset:2048
 s_add_u32 s54, s54, 3072
 buffer_load_dwordx4 a[72:75], v232, s[8:11], s54 offen offset:0
 buffer_load_dwordx4 a[76:79], v232, s[8:11], s54 offen offset:1024
 buffer_load_dwordx4 a[80:83], v232, s[8:11], s54 offen offset:2048
 s_add_u32 s54, s54, 3072
 buffer_load_dwordx4 a[84:87], v232, s[8:11], s54 offen offset:0
 buffer_load_dwordx4 a[88:91], v232, s[8:11], s54 offen offset:1024
 buffer_load_dwordx4 a[92:95], v232, s[8:11], s54 offen offset:2048
 s_add_u32 s54, s54, 3072
 s_add_u32 m0, s19, 0
 s_add_u32 s29, s52, 0
 buffer_load_dwordx4 v236, s[60:63], s29 offen lds
 s_add_u32 m0, s19, 1024
 s_add_u32 s29, s52, 5120
 buffer_load_dwordx4 v236, s[60:63], s29 offen lds
 s_add_u32 m0, s19, 2048
 s_add_u32 s29, s52, 10240
 buffer_load_dwordx4 v236, s[60:63], s29 offen lds
 s_add_u32 m0, s19, 3072
 s_add_u32 s29, s52, 15360
 buffer_load_dwordx4 v236, s[60:63], s29 offen lds
 s_add_u32 m0, s19, 4096
 s_add_u32 s29, s52, 20480
 buffer_load_dwordx4 v236, s[60:63], s29 offen lds
 s_add_u32 m0, s19, 5120
 s_add_u32 s29, s52, 25600
 buffer_load_dwordx4 v236, s[60:63], s29 offen lds
 s_add_u32 m0, s19, 24576
 s_add_u32 s29, s52, 122880
 buffer_load_dwordx4 v236, s[60:63], s29 offen lds
 s_add_u32 m0, s19, 25600
 s_add_u32 s29, s52, 128000
 buffer_load_dwordx4 v236, s[60:63], s29 offen lds
 s_add_u32 m0, s19, 26624
 s_add_u32 s29, s52, 133120
 buffer_load_dwordx4 v236, s[60:63], s29 offen lds
 s_add_u32 m0, s19, 27648
 s_add_u32 s29, s52, 138240
 buffer_load_dwordx4 v236, s[60:63], s29 offen lds
 s_add_u32 m0, s19, 28672
 s_add_u32 s29, s52, 143360
 buffer_load_dwordx4 v236, s[60:63], s29 offen lds
 s_add_u32 m0, s19, 29696
 s_add_u32 s29, s52, 148480
 buffer_load_dwordx4 v236, s[60:63], s29 offen lds
 s_add_u32 m0, s19, 49152
 s_add_u32 s29, s52, 245760
 buffer_load_dwordx4 v236, s[60:63], s29 offen lds
 s_add_u32 m0, s19, 50176
 s_add_u32 s29, s52, 250880
 buffer_load_dwordx4 v236, s[60:63], s29 offen lds
 s_add_u32 m0, s19, 51200
 s_add_u32 s29, s52, 256000
 buffer_load_dwordx4 v236, s[60:63], s29 offen lds
 s_add_u32 m0, s19, 52224
 s_add_u32 s29, s52, 261120
 buffer_load_dwordx4 v236, s[60:63], s29 offen lds
 s_add_u32 m0, s19, 53248
 s_add_u32 s29, s52, 266240
 buffer_load_dwordx4 v236, s[60:63], s29 offen lds
 s_add_u32 m0, s19, 54272
 s_add_u32 s29, s52, 271360
 buffer_load_dwordx4 v236, s[60:63], s29 offen lds
 s_add_u32 m0, s19, 73728
 s_add_u32 s29, s52, 368640
 buffer_load_dwordx4 v236, s[60:63], s29 offen lds
 s_add_u32 m0, s19, 74752
 s_add_u32 s29, s52, 373760
 buffer_load_dwordx4 v236, s[60:63], s29 offen lds
 s_add_u32 m0, s19, 75776
 s_add_u32 s29, s52, 378880
 buffer_load_dwordx4 v236, s[60:63], s29 offen lds
 s_add_u32 m0, s19, 76800
 s_add_u32 s29, s52, 384000
 buffer_load_dwordx4 v236, s[60:63], s29 offen lds
 s_add_u32 m0, s19, 77824
 s_add_u32 s29, s52, 389120
 buffer_load_dwordx4 v236, s[60:63], s29 offen lds
 s_add_u32 m0, s19, 78848
 s_add_u32 s29, s52, 394240
 buffer_load_dwordx4 v236, s[60:63], s29 offen lds
 s_waitcnt vmcnt(18)
 s_waitcnt vmcnt(12)
 s_barrier
 ds_read_b64_tr_b16 v[192:193], v240 offset:0
 ds_read_b64_tr_b16 v[194:195], v240 offset:2048
 ds_read_b64_tr_b16 v[196:197], v241 offset:0
 ds_read_b64_tr_b16 v[198:199], v241 offset:2048
 ds_read_b64_tr_b16 v[200:201], v242 offset:0
 ds_read_b64_tr_b16 v[202:203], v242 offset:2048
 ds_read_b64_tr_b16 v[204:205], v243 offset:0
 ds_read_b64_tr_b16 v[206:207], v243 offset:2048
 ds_read_b64_tr_b16 v[208:209], v240 offset:4096
 ds_read_b64_tr_b16 v[210:211], v240 offset:6144
 s_waitcnt lgkmcnt(8)
 v_mfma_f32_32x32x16_bf16 v[0:15], v[192:195], a[0:3], 0
 ds_read_b64_tr_b16 v[212:213], v241 offset:4096
 ds_read_b64_tr_b16 v[214:215], v241 offset:6144
 s_waitcnt lgkmcnt(8)
 v_mfma_f32_32x32x16_bf16 v[16:31], v[196:199], a[0:3], 0
 s_add_u32 m0, s19, 98304
 s_add_u32 s29, s52, 491520
 buffer_load_dwordx4 v236, s[60:63], s29 offen lds
 s_add_u32 m0, s19, 99328
 s_add_u32 s29, s52, 496640
 buffer_load_dwordx4 v236, s[60:63], s29 offen lds
 s_add_u32 m0, s19, 100352
 s_add_u32 s29, s52, 501760
 buffer_load_dwordx4 v236, s[60:63], s29 offen lds
 s_add_u32 m0, s19, 101376
 s_add_u32 s29, s52, 506880
 buffer_load_dwordx4 v236, s[60:63], s29 offen lds
 s_add_u32 m0, s19, 102400
 s_add_u32 s29, s52, 512000
 buffer_load_dwordx4 v236, s[60:63], s29 offen lds
 s_add_u32 m0, s19, 103424
 s_add_u32 s29, s52, 517120
 buffer_load_dwordx4 v236, s[60:63], s29 offen lds
 ds_read_b64_tr_b16 v[192:193], v242 offset:4096
 ds_read_b64_tr_b16 v[194:195], v242 offset:6144
 s_waitcnt lgkmcnt(8)
 v_mfma_f32_32x32x16_bf16 v[32:47], v[200:203], a[0:3], 0
 ds_read_b64_tr_b16 v[196:197], v243 offset:4096
 ds_read_b64_tr_b16 v[198:199], v243 offset:6144
 s_waitcnt lgkmcnt(8)
 v_mfma_f32_32x32x16_bf16 v[48:63], v[204:207], a[0:3], 0
 ds_read_b64_tr_b16 v[200:201], v240 offset:8192
 ds_read_b64_tr_b16 v[202:203], v240 offset:10240
 s_waitcnt lgkmcnt(8)
 v_mfma_f32_32x32x16_bf16 v[0:15], v[208:211], a[4:7], v[0:15]
 ds_read_b64_tr_b16 v[204:205], v241 offset:8192
 ds_read_b64_tr_b16 v[206:207], v241 offset:10240
 s_waitcnt lgkmcnt(8)
 v_mfma_f32_32x32x16_bf16 v[16:31], v[212:215], a[4:7], v[16:31]
 ds_read_b64_tr_b16 v[208:209], v242 offset:8192
 ds_read_b64_tr_b16 v[210:211], v242 offset:10240
 s_waitcnt lgkmcnt(8)
 v_mfma_f32_32x32x16_bf16 v[32:47], v[192:195], a[4:7], v[32:47]
 ds_read_b64_tr_b16 v[212:213], v243 offset:8192
 ds_read_b64_tr_b16 v[214:215], v243 offset:10240
 s_waitcnt lgkmcnt(8)
 v_mfma_f32_32x32x16_bf16 v[48:63], v[196:199], a[4:7], v[48:63]
 ds_read_b64_tr_b16 v[192:193], v240 offset:12288
 ds_read_b64_tr_b16 v[194:195], v240 offset:14336
 s_waitcnt lgkmcnt(8)
 v_mfma_f32_32x32x16_bf16 v[0:15], v[200:203], a[8:11], v[0:15]
 buffer_load_dwordx4 a[96:99], v232, s[8:11], s54 offen offset:0
 buffer_load_dwordx4 a[100:103], v232, s[8:11], s54 offen offset:1024
 buffer_load_dwordx4 a[104:107], v232, s[8:11], s54 offen offset:2048
 s_add_u32 s54, s54, 3072
 buffer_load_dwordx4 a[108:111], v232, s[8:11], s54 offen offset:0
 buffer_load_dwordx4 a[112:115], v232, s[8:11], s54 offen offset:1024
 buffer_load_dwordx4 a[116:119], v232, s[8:11], s54 offen offset:2048
 s_add_u32 s54, s54, 3072
 ds_read_b64_tr_b16 v[196:197], v241 offset:12288
 ds_read_b64_tr_b16 v[198:199], v241 offset:14336
 s_waitcnt lgkmcnt(8)
 v_mfma_f32_32x32x16_bf16 v[16:31], v[204:207], a[8:11], v[16:31]
 ds_read_b64_tr_b16 v[200:201], v242 offset:12288
 ds_read_b64_tr_b16 v[202:203], v242 offset:14336
 s_waitcnt lgkmcnt(8)
 v_mfma_f32_32x32x16_bf16 v[32:47], v[208:211], a[8:11], v[32:47]
 ds_read_b64_tr_b16 v[204:205], v243 offset:12288
 ds_read_b64_tr_b16 v[206:207], v243 offset:14336
 s_waitcnt lgkmcnt(8)
 v_mfma_f32_32x32x16_bf16 v[48:63], v[212:215], a[8:11], v[48:63]
 ds_read_b64_tr_b16 v[208:209], v240 offset:16384
 ds_read_b64_tr_b16 v[210:211], v240 offset:18432
 s_waitcnt lgkmcnt(8)
 v_mfma_f32_32x32x16_bf16 v[0:15], v[192:195], a[12:15], v[0:15]
 ds_read_b64_tr_b16 v[212:213], v241 offset:16384
 ds_read_b64_tr_b16 v[214:215], v241 offset:18432
 s_waitcnt lgkmcnt(8)
 v_mfma_f32_32x32x16_bf16 v[16:31], v[196:199], a[12:15], v[16:31]
 ds_read_b64_tr_b16 v[192:193], v242 offset:16384
 ds_read_b64_tr_b16 v[194:195], v242 offset:18432
 s_waitcnt lgkmcnt(8)
 v_mfma_f32_32x32x16_bf16 v[32:47], v[200:203], a[12:15], v[32:47]
 ds_read_b64_tr_b16 v[196:197], v243 offset:16384
 ds_read_b64_tr_b16 v[198:199], v243 offset:18432
 s_waitcnt lgkmcnt(8)
 v_mfma_f32_32x32x16_bf16 v[48:63], v[204:207], a[12:15], v[48:63]
 ds_read_b64_tr_b16 v[200:201], v240 offset:20480
 ds_read_b64_tr_b16 v[202:203], v240 offset:22528
 s_waitcnt lgkmcnt(8)
 v_mfma_f32_32x32x16_bf16 v[0:15], v[208:211], a[16:19], v[0:15]
 ds_read_b64_tr_b16 v[204:205], v241 offset:20480
 ds_read_b64_tr_b16 v[206:207], v241 offset:22528
 s_waitcnt lgkmcnt(8)
 v_mfma_f32_32x32x16_bf16 v[16:31], v[212:215], a[16:19], v[16:31]
 ds_read_b64_tr_b16 v[208:209], v242 offset:20480
 ds_read_b64_tr_b16 v[210:211], v242 offset:22528
 s_waitcnt lgkmcnt(8)
 v_mfma_f32_32x32x16_bf16 v[32:47], v[192:195], a[16:19], v[32:47]
 ds_read_b64_tr_b16 v[212:213], v243 offset:20480
 ds_read_b64_tr_b16 v[214:215], v243 offset:22528
 s_waitcnt lgkmcnt(8)
 v_mfma_f32_32x32x16_bf16 v[48:63], v[196:199], a[16:19], v[48:63]
 ds_read_b64_tr_b16 v[192:193], v240 offset:24576
 ds_read_b64_tr_b16 v[194:195], v240 offset:26624
 s_waitcnt lgkmcnt(8)
 v_mfma_f32_32x32x16_bf16 v[0:15], v[200:203], a[20:23], v[0:15]
 ds_read_b64_tr_b16 v[196:197], v241 offset:24576
 ds_read_b64_tr_b16 v[198:199], v241 offset:26624
 s_waitcnt lgkmcnt(8)
 v_mfma_f32_32x32x16_bf16 v[16:31], v[204:207], a[20:23], v[16:31]
 ds_read_b64_tr_b16 v[200:201], v242 offset:24576
 ds_read_b64_tr_b16 v[202:203], v242 offset:26624
 s_waitcnt lgkmcnt(8)
 v_mfma_f32_32x32x16_bf16 v[32:47], v[208:211], a[20:23], v[32:47]
 ds_read_b64_tr_b16 v[204:205], v243 offset:24576
 ds_read_b64_tr_b16 v[206:207], v243 offset:26624
 s_waitcnt lgkmcnt(8)
 v_mfma_f32_32x32x16_bf16 v[48:63], v[212:215], a[20:23], v[48:63]
 s_waitcnt vmcnt(18)
 s_barrier
 ds_read_b64_tr_b16 v[208:209], v240 offset:28672
 ds_read_b64_tr_b16 v[210:211], v240 offset:30720
 s_waitcnt lgkmcnt(8)
 v_mfma_f32_32x32x16_bf16 v[0:15], v[192:195], a[24:27], v[0:15]
 ds_read_b64_tr_b16 v[212:213], v241 offset:28672
 ds_read_b64_tr_b16 v[214:215], v241 offset:30720
 s_waitcnt lgkmcnt(8)
 v_mfma_f32_32x32x16_bf16 v[16:31], v[196:199], a[24:27], v[16:31]
 s_add_u32 m0, s19, 0
 s_add_u32 s29, s52, 614400
 buffer_load_dwordx4 v236, s[60:63], s29 offen lds
 s_add_u32 m0, s19, 1024
 s_add_u32 s29, s52, 619520
 buffer_load_dwordx4 v236, s[60:63], s29 offen lds
 s_add_u32 m0, s19, 2048
 s_add_u32 s29, s52, 624640
 buffer_load_dwordx4 v236, s[60:63], s29 offen lds
 s_add_u32 m0, s19, 3072
 s_add_u32 s29, s52, 629760
 buffer_load_dwordx4 v236, s[60:63], s29 offen lds
 s_add_u32 m0, s19, 4096
 s_add_u32 s29, s52, 634880
 buffer_load_dwordx4 v236, s[60:63], s29 offen lds
 s_add_u32 m0, s19, 5120
 s_add_u32 s29, s52, 640000
 buffer_load_dwordx4 v236, s[60:63], s29 offen lds
 ds_read_b64_tr_b16 v[192:193], v242 offset:28672
 ds_read_b64_tr_b16 v[194:195], v242 offset:30720
 s_waitcnt lgkmcnt(8)
 v_mfma_f32_32x32x16_bf16 v[32:47], v[200:203], a[24:27], v[32:47]
 ds_read_b64_tr_b16 v[196:197], v243 offset:28672
 ds_read_b64_tr_b16 v[198:199], v243 offset:30720
 s_waitcnt lgkmcnt(8)
 v_mfma_f32_32x32x16_bf16 v[48:63], v[204:207], a[24:27], v[48:63]
 ds_read_b64_tr_b16 v[200:201], v240 offset:32768
 ds_read_b64_tr_b16 v[202:203], v240 offset:34816
 s_waitcnt lgkmcnt(8)
 v_mfma_f32_32x32x16_bf16 v[0:15], v[208:211], a[28:31], v[0:15]
 ds_read_b64_tr_b16 v[204:205], v241 offset:32768
 ds_read_b64_tr_b16 v[206:207], v241 offset:34816
 s_waitcnt lgkmcnt(8)
 v_mfma_f32_32x32x16_bf16 v[16:31], v[212:215], a[28:31], v[16:31]
 ds_read_b64_tr_b16 v[208:209], v242 offset:32768
 ds_read_b64_tr_b16 v[210:211], v242 offset:34816
 s_waitcnt lgkmcnt(8)
 v_mfma_f32_32x32x16_bf16 v[32:47], v[192:195], a[28:31], v[32:47]
 ds_read_b64_tr_b16 v[212:213], v243 offset:32768
 ds_read_b64_tr_b16 v[214:215], v243 offset:34816
 s_waitcnt lgkmcnt(8)
 v_mfma_f32_32x32x16_bf16 v[48:63], v[196:199], a[28:31], v[48:63]
 ds_read_b64_tr_b16 v[192:193], v240 offset:36864
 ds_read_b64_tr_b16 v[194:195], v240 offset:38912
 s_waitcnt lgkmcnt(8)
 v_mfma_f32_32x32x16_bf16 v[0:15], v[200:203], a[32:35], v[0:15]
 buffer_load_dwordx4 a[120:123], v232, s[8:11], s54 offen offset:0
 buffer_load_dwordx4 a[124:127], v232, s[8:11], s54 offen offset:1024
 buffer_load_dwordx4 a[128:131], v232, s[8:11], s54 offen offset:2048
 s_add_u32 s54, s54, 3072
 buffer_load_dwordx4 a[132:135], v232, s[8:11], s54 offen offset:0
 buffer_load_dwordx4 a[136:139], v232, s[8:11], s54 offen offset:1024
 buffer_load_dwordx4 a[140:143], v232, s[8:11], s54 offen offset:2048
 s_add_u32 s54, s54, 3072
 ds_read_b64_tr_b16 v[196:197], v241 offset:36864
 ds_read_b64_tr_b16 v[198:199], v241 offset:38912
 s_waitcnt lgkmcnt(8)
 v_mfma_f32_32x32x16_bf16 v[16:31], v[204:207], a[32:35], v[16:31]
 ds_read_b64_tr_b16 v[200:201], v242 offset:36864
 ds_read_b64_tr_b16 v[202:203], v242 offset:38912
 s_waitcnt lgkmcnt(8)
 v_mfma_f32_32x32x16_bf16 v[32:47], v[208:211], a[32:35], v[32:47]
 ds_read_b64_tr_b16 v[204:205], v243 offset:36864
 ds_read_b64_tr_b16 v[206:207], v243 offset:38912
 s_waitcnt lgkmcnt(8)
 v_mfma_f32_32x32x16_bf16 v[48:63], v[212:215], a[32:35], v[48:63]
 ds_read_b64_tr_b16 v[208:209], v240 offset:40960
 ds_read_b64_tr_b16 v[210:211], v240 offset:43008
 s_waitcnt lgkmcnt(8)
 v_mfma_f32_32x32x16_bf16 v[0:15], v[192:195], a[36:39], v[0:15]
 ds_read_b64_tr_b16 v[212:213], v241 offset:40960
 ds_read_b64_tr_b16 v[214:215], v241 offset:43008
 s_waitcnt lgkmcnt(8)
 v_mfma_f32_32x32x16_bf16 v[16:31], v[196:199], a[36:39], v[16:31]
 ds_read_b64_tr_b16 v[192:193], v242 offset:40960
 ds_read_b64_tr_b16 v[194:195], v242 offset:43008
 s_waitcnt lgkmcnt(8)
 v_mfma_f32_32x32x16_bf16 v[32:47], v[200:203], a[36:39], v[32:47]
 ds_read_b64_tr_b16 v[196:197], v243 offset:40960
 ds_read_b64_tr_b16 v[198:199], v243 offset:43008
 s_waitcnt lgkmcnt(8)
 v_mfma_f32_32x32x16_bf16 v[48:63], v[204:207], a[36:39], v[48:63]
 ds_read_b64_tr_b16 v[200:201], v240 offset:45056
 ds_read_b64_tr_b16 v[202:203], v240 offset:47104
 s_waitcnt lgkmcnt(8)
 v_mfma_f32_32x32x16_bf16 v[0:15], v[208:211], a[40:43], v[0:15]
 ds_read_b64_tr_b16 v[204:205], v241 offset:45056
 ds_read_b64_tr_b16 v[206:207], v241 offset:47104
 s_waitcnt lgkmcnt(8)
 v_mfma_f32_32x32x16_bf16 v[16:31], v[212:215], a[40:43], v[16:31]
 ds_read_b64_tr_b16 v[208:209], v242 offset:45056
 ds_read_b64_tr_b16 v[210:211], v242 offset:47104
 s_waitcnt lgkmcnt(8)
 v_mfma_f32_32x32x16_bf16 v[32:47], v[192:195], a[40:43], v[32:47]
 ds_read_b64_tr_b16 v[212:213], v243 offset:45056
 ds_read_b64_tr_b16 v[214:215], v243 offset:47104
 s_waitcnt lgkmcnt(8)
 v_mfma_f32_32x32x16_bf16 v[48:63], v[196:199], a[40:43], v[48:63]
 ds_read_b64_tr_b16 v[192:193], v240 offset:49152
 ds_read_b64_tr_b16 v[194:195], v240 offset:51200
 s_waitcnt lgkmcnt(8)
 v_mfma_f32_32x32x16_bf16 v[0:15], v[200:203], a[44:47], v[0:15]
 ds_read_b64_tr_b16 v[196:197], v241 offset:49152
 ds_read_b64_tr_b16 v[198:199], v241 offset:51200
 s_waitcnt lgkmcnt(8)
 v_mfma_f32_32x32x16_bf16 v[16:31], v[204:207], a[44:47], v[16:31]
 ds_read_b64_tr_b16 v[200:201], v242 offset:49152
 ds_read_b64_tr_b16 v[202:203], v242 offset:51200
 s_waitcnt lgkmcnt(8)
 v_mfma_f32_32x32x16_bf16 v[32:47], v[208:211], a[44:47], v[32:47]
 ds_read_b64_tr_b16 v[204:205], v243 offset:49152
 ds_read_b64_tr_b16 v[206:207], v243 offset:51200
 s_waitcnt lgkmcnt(8)
 v_mfma_f32_32x32x16_bf16 v[48:63], v[212:215], a[44:47], v[48:63]
 s_waitcnt vmcnt(24)
 s_barrier
 ds_read_b64_tr_b16 v[208:209], v240 offset:53248
 ds_read_b64_tr_b16 v[210:211], v240 offset:55296
 s_waitcnt lgkmcnt(8)
 v_mfma_f32_32x32x16_bf16 v[0:15], v[192:195], a[48:51], v[0:15]
 ds_read_b64_tr_b16 v[212:213], v241 offset:53248
 ds_read_b64_tr_b16 v[214:215], v241 offset:55296
 s_waitcnt lgkmcnt(8)
 v_mfma_f32_32x32x16_bf16 v[16:31], v[196:199], a[48:51], v[16:31]
 s_add_u32 m0, s19, 24576
 s_add_u32 s29, s52, 737280
 buffer_load_dwordx4 v236, s[60:63], s29 offen lds
 s_add_u32 m0, s19, 25600
 s_add_u32 s29, s52, 742400
 buffer_load_dwordx4 v236, s[60:63], s29 offen lds
 s_add_u32 m0, s19, 26624
 s_add_u32 s29, s52, 747520
 buffer_load_dwordx4 v236, s[60:63], s29 offen lds
 s_add_u32 m0, s19, 27648
 s_add_u32 s29, s52, 752640
 buffer_load_dwordx4 v236, s[60:63], s29 offen lds
 s_add_u32 m0, s19, 28672
 s_add_u32 s29, s52, 757760
 buffer_load_dwordx4 v236, s[60:63], s29 offen lds
 s_add_u32 m0, s19, 29696
 s_add_u32 s29, s52, 762880
 buffer_load_dwordx4 v236, s[60:63], s29 offen lds
 ds_read_b64_tr_b16 v[192:193], v242 offset:53248
 ds_read_b64_tr_b16 v[194:195], v242 offset:55296
 s_waitcnt lgkmcnt(8)
 v_mfma_f32_32x32x16_bf16 v[32:47], v[200:203], a[48:51], v[32:47]
 ds_read_b64_tr_b16 v[196:197], v243 offset:53248
 ds_read_b64_tr_b16 v[198:199], v243 offset:55296
 s_waitcnt lgkmcnt(8)
 v_mfma_f32_32x32x16_bf16 v[48:63], v[204:207], a[48:51], v[48:63]
 ds_read_b64_tr_b16 v[200:201], v240 offset:57344
 ds_read_b64_tr_b16 v[202:203], v240 offset:59392
 s_waitcnt lgkmcnt(8)
 v_mfma_f32_32x32x16_bf16 v[0:15], v[208:211], a[52:55], v[0:15]
 ds_read_b64_tr_b16 v[204:205], v241 offset:57344
 ds_read_b64_tr_b16 v[206:207], v241 offset:59392
 s_waitcnt lgkmcnt(8)
 v_mfma_f32_32x32x16_bf16 v[16:31], v[212:215], a[52:55], v[16:31]
 ds_read_b64_tr_b16 v[208:209], v242 offset:57344
 ds_read_b64_tr_b16 v[210:211], v242 offset:59392
 s_waitcnt lgkmcnt(8)
 v_mfma_f32_32x32x16_bf16 v[32:47], v[192:195], a[52:55], v[32:47]
 ds_read_b64_tr_b16 v[212:213], v243 offset:57344
 ds_read_b64_tr_b16 v[214:215], v243 offset:59392
 s_waitcnt lgkmcnt(8)
 v_mfma_f32_32x32x16_bf16 v[48:63], v[196:199], a[52:55], v[48:63]
 ds_read_b64_tr_b16 v[192:193], v240 offset:61440
 ds_read_b64_tr_b16 v[194:195], v240 offset:63488
 s_waitcnt lgkmcnt(8)
 v_mfma_f32_32x32x16_bf16 v[0:15], v[200:203], a[56:59], v[0:15]
 buffer_load_dwordx4 a[0:3], v232, s[8:11], s54 offen offset:0
 buffer_load_dwordx4 a[4:7], v232, s[8:11], s54 offen offset:1024
 buffer_load_dwordx4 a[8:11], v232, s[8:11], s54 offen offset:2048
 s_add_u32 s54, s54, 3072
 buffer_load_dwordx4 a[12:15], v232, s[8:11], s54 offen offset:0
 buffer_load_dwordx4 a[16:19], v232, s[8:11], s54 offen offset:1024
 buffer_load_dwordx4 a[20:23], v232, s[8:11], s54 offen offset:2048
 s_add_u32 s54, s54, 3072
 ds_read_b64_tr_b16 v[196:197], v241 offset:61440
 ds_read_b64_tr_b16 v[198:199], v241 offset:63488
 s_waitcnt lgkmcnt(8)
 v_mfma_f32_32x32x16_bf16 v[16:31], v[204:207], a[56:59], v[16:31]
 ds_read_b64_tr_b16 v[200:201], v242 offset:61440
 ds_read_b64_tr_b16 v[202:203], v242 offset:63488
 s_waitcnt lgkmcnt(8)
 v_mfma_f32_32x32x16_bf16 v[32:47], v[208:211], a[56:59], v[32:47]
 ds_read_b64_tr_b16 v[204:205], v243 offset:61440
 ds_read_b64_tr_b16 v[206:207], v243 offset:63488
 s_waitcnt lgkmcnt(8)
 v_mfma_f32_32x32x16_bf16 v[48:63], v[212:215], a[56:59], v[48:63]
 ds_read_b64_tr_b16 v[208:209], v248 offset:0
 ds_read_b64_tr_b16 v[210:211], v248 offset:2048
 s_waitcnt lgkmcnt(8)
 v_mfma_f32_32x32x16_bf16 v[0:15], v[192:195], a[60:63], v[0:15]
 ds_read_b64_tr_b16 v[212:213], v249 offset:0
 ds_read_b64_tr_b16 v[214:215], v249 offset:2048
 s_waitcnt lgkmcnt(8)
 v_mfma_f32_32x32x16_bf16 v[16:31], v[196:199], a[60:63], v[16:31]
 ds_read_b64_tr_b16 v[192:193], v250 offset:0
 ds_read_b64_tr_b16 v[194:195], v250 offset:2048
 s_waitcnt lgkmcnt(8)
 v_mfma_f32_32x32x16_bf16 v[32:47], v[200:203], a[60:63], v[32:47]
 ds_read_b64_tr_b16 v[196:197], v251 offset:0
 ds_read_b64_tr_b16 v[198:199], v251 offset:2048
 s_waitcnt lgkmcnt(8)
 v_mfma_f32_32x32x16_bf16 v[48:63], v[204:207], a[60:63], v[48:63]
 ds_read_b64_tr_b16 v[200:201], v248 offset:4096
 ds_read_b64_tr_b16 v[202:203], v248 offset:6144
 s_waitcnt lgkmcnt(8)
 v_mfma_f32_32x32x16_bf16 v[0:15], v[208:211], a[64:67], v[0:15]
 ds_read_b64_tr_b16 v[204:205], v249 offset:4096
 ds_read_b64_tr_b16 v[206:207], v249 offset:6144
 s_waitcnt lgkmcnt(8)
 v_mfma_f32_32x32x16_bf16 v[16:31], v[212:215], a[64:67], v[16:31]
 ds_read_b64_tr_b16 v[208:209], v250 offset:4096
 ds_read_b64_tr_b16 v[210:211], v250 offset:6144
 s_waitcnt lgkmcnt(8)
 v_mfma_f32_32x32x16_bf16 v[32:47], v[192:195], a[64:67], v[32:47]
 ds_read_b64_tr_b16 v[212:213], v251 offset:4096
 ds_read_b64_tr_b16 v[214:215], v251 offset:6144
 s_waitcnt lgkmcnt(8)
 v_mfma_f32_32x32x16_bf16 v[48:63], v[196:199], a[64:67], v[48:63]
 ds_read_b64_tr_b16 v[192:193], v248 offset:8192
 ds_read_b64_tr_b16 v[194:195], v248 offset:10240
 s_waitcnt lgkmcnt(8)
 v_mfma_f32_32x32x16_bf16 v[0:15], v[200:203], a[68:71], v[0:15]
 ds_read_b64_tr_b16 v[196:197], v249 offset:8192
 ds_read_b64_tr_b16 v[198:199], v249 offset:10240
 s_waitcnt lgkmcnt(8)
 v_mfma_f32_32x32x16_bf16 v[16:31], v[204:207], a[68:71], v[16:31]
 ds_read_b64_tr_b16 v[200:201], v250 offset:8192
 ds_read_b64_tr_b16 v[202:203], v250 offset:10240
 s_waitcnt lgkmcnt(8)
 v_mfma_f32_32x32x16_bf16 v[32:47], v[208:211], a[68:71], v[32:47]
 ds_read_b64_tr_b16 v[204:205], v251 offset:8192
 ds_read_b64_tr_b16 v[206:207], v251 offset:10240
 s_waitcnt lgkmcnt(8)
 v_mfma_f32_32x32x16_bf16 v[48:63], v[212:215], a[68:71], v[48:63]
 s_waitcnt vmcnt(30)
 s_barrier
 ds_read_b64_tr_b16 v[208:209], v248 offset:12288
 ds_read_b64_tr_b16 v[210:211], v248 offset:14336
 s_waitcnt lgkmcnt(8)
 v_mfma_f32_32x32x16_bf16 v[0:15], v[192:195], a[72:75], v[0:15]
 ds_read_b64_tr_b16 v[212:213], v249 offset:12288
 ds_read_b64_tr_b16 v[214:215], v249 offset:14336
 s_waitcnt lgkmcnt(8)
 v_mfma_f32_32x32x16_bf16 v[16:31], v[196:199], a[72:75], v[16:31]
 s_add_u32 m0, s19, 49152
 s_add_u32 s29, s52, 860160
 buffer_load_dwordx4 v236, s[60:63], s29 offen lds
 s_add_u32 m0, s19, 50176
 s_add_u32 s29, s52, 865280
 buffer_load_dwordx4 v236, s[60:63], s29 offen lds
 s_add_u32 m0, s19, 51200
 s_add_u32 s29, s52, 870400
 buffer_load_dwordx4 v236, s[60:63], s29 offen lds
 s_add_u32 m0, s19, 52224
 s_add_u32 s29, s52, 875520
 buffer_load_dwordx4 v236, s[60:63], s29 offen lds
 s_add_u32 m0, s19, 53248
 s_add_u32 s29, s52, 880640
 buffer_load_dwordx4 v236, s[60:63], s29 offen lds
 s_add_u32 m0, s19, 54272
 s_add_u32 s29, s52, 885760
 buffer_load_dwordx4 v236, s[60:63], s29 offen lds
 ds_read_b64_tr_b16 v[192:193], v250 offset:12288
 ds_read_b64_tr_b16 v[194:195], v250 offset:14336
 s_waitcnt lgkmcnt(8)
 v_mfma_f32_32x32x16_bf16 v[32:47], v[200:203], a[72:75], v[32:47]
 ds_read_b64_tr_b16 v[196:197], v251 offset:12288
 ds_read_b64_tr_b16 v[198:199], v251 offset:14336
 s_waitcnt lgkmcnt(8)
 v_mfma_f32_32x32x16_bf16 v[48:63], v[204:207], a[72:75], v[48:63]
 ds_read_b64_tr_b16 v[200:201], v248 offset:16384
 ds_read_b64_tr_b16 v[202:203], v248 offset:18432
 s_waitcnt lgkmcnt(8)
 v_mfma_f32_32x32x16_bf16 v[0:15], v[208:211], a[76:79], v[0:15]
 ds_read_b64_tr_b16 v[204:205], v249 offset:16384
 ds_read_b64_tr_b16 v[206:207], v249 offset:18432
 s_waitcnt lgkmcnt(8)
 v_mfma_f32_32x32x16_bf16 v[16:31], v[212:215], a[76:79], v[16:31]
 ds_read_b64_tr_b16 v[208:209], v250 offset:16384
 ds_read_b64_tr_b16 v[210:211], v250 offset:18432
 s_waitcnt lgkmcnt(8)
 v_mfma_f32_32x32x16_bf16 v[32:47], v[192:195], a[76:79], v[32:47]
 ds_read_b64_tr_b16 v[212:213], v251 offset:16384
 ds_read_b64_tr_b16 v[214:215], v251 offset:18432
 s_waitcnt lgkmcnt(8)
 v_mfma_f32_32x32x16_bf16 v[48:63], v[196:199], a[76:79], v[48:63]
 ds_read_b64_tr_b16 v[192:193], v248 offset:20480
 ds_read_b64_tr_b16 v[194:195], v248 offset:22528
 s_waitcnt lgkmcnt(8)
 v_mfma_f32_32x32x16_bf16 v[0:15], v[200:203], a[80:83], v[0:15]
 buffer_load_dwordx4 a[24:27], v232, s[8:11], s54 offen offset:0
 buffer_load_dwordx4 a[28:31], v232, s[8:11], s54 offen offset:1024
 buffer_load_dwordx4 a[32:35], v232, s[8:11], s54 offen offset:2048
 s_add_u32 s54, s54, 3072
 buffer_load_dwordx4 a[36:39], v232, s[8:11], s54 offen offset:0
 buffer_load_dwordx4 a[40:43], v232, s[8:11], s54 offen offset:1024
 buffer_load_dwordx4 a[44:47], v232, s[8:11], s54 offen offset:2048
 s_add_u32 s54, s54, 3072
 ds_read_b64_tr_b16 v[196:197], v249 offset:20480
 ds_read_b64_tr_b16 v[198:199], v249 offset:22528
 s_waitcnt lgkmcnt(8)
 v_mfma_f32_32x32x16_bf16 v[16:31], v[204:207], a[80:83], v[16:31]
 ds_read_b64_tr_b16 v[200:201], v250 offset:20480
 ds_read_b64_tr_b16 v[202:203], v250 offset:22528
 s_waitcnt lgkmcnt(8)
 v_mfma_f32_32x32x16_bf16 v[32:47], v[208:211], a[80:83], v[32:47]
 ds_read_b64_tr_b16 v[204:205], v251 offset:20480
 ds_read_b64_tr_b16 v[206:207], v251 offset:22528
 s_waitcnt lgkmcnt(8)
 v_mfma_f32_32x32x16_bf16 v[48:63], v[212:215], a[80:83], v[48:63]
 ds_read_b64_tr_b16 v[208:209], v248 offset:24576
 ds_read_b64_tr_b16 v[210:211], v248 offset:26624
 s_waitcnt lgkmcnt(8)
 v_mfma_f32_32x32x16_bf16 v[0:15], v[192:195], a[84:87], v[0:15]
 ds_read_b64_tr_b16 v[212:213], v249 offset:24576
 ds_read_b64_tr_b16 v[214:215], v249 offset:26624
 s_waitcnt lgkmcnt(8)
 v_mfma_f32_32x32x16_bf16 v[16:31], v[196:199], a[84:87], v[16:31]
 ds_read_b64_tr_b16 v[192:193], v250 offset:24576
 ds_read_b64_tr_b16 v[194:195], v250 offset:26624
 s_waitcnt lgkmcnt(8)
 v_mfma_f32_32x32x16_bf16 v[32:47], v[200:203], a[84:87], v[32:47]
 ds_read_b64_tr_b16 v[196:197], v251 offset:24576
 ds_read_b64_tr_b16 v[198:199], v251 offset:26624
 s_waitcnt lgkmcnt(8)
 v_mfma_f32_32x32x16_bf16 v[48:63], v[204:207], a[84:87], v[48:63]
 ds_read_b64_tr_b16 v[200:201], v248 offset:28672
 ds_read_b64_tr_b16 v[202:203], v248 offset:30720
 s_waitcnt lgkmcnt(8)
 v_mfma_f32_32x32x16_bf16 v[0:15], v[208:211], a[88:91], v[0:15]
 ds_read_b64_tr_b16 v[204:205], v249 offset:28672
 ds_read_b64_tr_b16 v[206:207], v249 offset:30720
 s_waitcnt lgkmcnt(8)
 v_mfma_f32_32x32x16_bf16 v[16:31], v[212:215], a[88:91], v[16:31]
 ds_read_b64_tr_b16 v[208:209], v250 offset:28672
 ds_read_b64_tr_b16 v[210:211], v250 offset:30720
 s_waitcnt lgkmcnt(8)
 v_mfma_f32_32x32x16_bf16 v[32:47], v[192:195], a[88:91], v[32:47]
 ds_read_b64_tr_b16 v[212:213], v251 offset:28672
 ds_read_b64_tr_b16 v[214:215], v251 offset:30720
 s_waitcnt lgkmcnt(8)
 v_mfma_f32_32x32x16_bf16 v[48:63], v[196:199], a[88:91], v[48:63]
 ds_read_b64_tr_b16 v[192:193], v248 offset:32768
 ds_read_b64_tr_b16 v[194:195], v248 offset:34816
 s_waitcnt lgkmcnt(8)
 v_mfma_f32_32x32x16_bf16 v[0:15], v[200:203], a[92:95], v[0:15]
 ds_read_b64_tr_b16 v[196:197], v249 offset:32768
 ds_read_b64_tr_b16 v[198:199], v249 offset:34816
 s_waitcnt lgkmcnt(8)
 v_mfma_f32_32x32x16_bf16 v[16:31], v[204:207], a[92:95], v[16:31]
 ds_read_b64_tr_b16 v[200:201], v250 offset:32768
 ds_read_b64_tr_b16 v[202:203], v250 offset:34816
 s_waitcnt lgkmcnt(8)
 v_mfma_f32_32x32x16_bf16 v[32:47], v[208:211], a[92:95], v[32:47]
 ds_read_b64_tr_b16 v[204:205], v251 offset:32768
 ds_read_b64_tr_b16 v[206:207], v251 offset:34816
 s_waitcnt lgkmcnt(8)
 v_mfma_f32_32x32x16_bf16 v[48:63], v[212:215], a[92:95], v[48:63]
 s_waitcnt vmcnt(30)
 s_barrier
 ds_read_b64_tr_b16 v[208:209], v248 offset:36864
 ds_read_b64_tr_b16 v[210:211], v248 offset:38912
 s_waitcnt lgkmcnt(8)
 v_mfma_f32_32x32x16_bf16 v[0:15], v[192:195], a[96:99], v[0:15]
 ds_read_b64_tr_b16 v[212:213], v249 offset:36864
 ds_read_b64_tr_b16 v[214:215], v249 offset:38912
 s_waitcnt lgkmcnt(8)
 v_mfma_f32_32x32x16_bf16 v[16:31], v[196:199], a[96:99], v[16:31]
 s_add_u32 m0, s19, 73728
 s_add_u32 s29, s52, 983040
 buffer_load_dwordx4 v236, s[60:63], s29 offen lds
 s_add_u32 m0, s19, 74752
 s_add_u32 s29, s52, 988160
 buffer_load_dwordx4 v236, s[60:63], s29 offen lds
 s_add_u32 m0, s19, 75776
 s_add_u32 s29, s52, 993280
 buffer_load_dwordx4 v236, s[60:63], s29 offen lds
 s_add_u32 m0, s19, 76800
 s_add_u32 s29, s52, 998400
 buffer_load_dwordx4 v236, s[60:63], s29 offen lds
 s_add_u32 m0, s19, 77824
 s_add_u32 s29, s52, 1003520
 buffer_load_dwordx4 v236, s[60:63], s29 offen lds
 s_add_u32 m0, s19, 78848
 s_add_u32 s29, s52, 1008640
 buffer_load_dwordx4 v236, s[60:63], s29 offen lds
 ds_read_b64_tr_b16 v[192:193], v250 offset:36864
 ds_read_b64_tr_b16 v[194:195], v250 offset:38912
 s_waitcnt lgkmcnt(8)
 v_mfma_f32_32x32x16_bf16 v[32:47], v[200:203], a[96:99], v[32:47]
 ds_read_b64_tr_b16 v[196:197], v251 offset:36864
 ds_read_b64_tr_b16 v[198:199], v251 offset:38912
 s_waitcnt lgkmcnt(8)
 v_mfma_f32_32x32x16_bf16 v[48:63], v[204:207], a[96:99], v[48:63]
 ds_read_b64_tr_b16 v[200:201], v248 offset:40960
 ds_read_b64_tr_b16 v[202:203], v248 offset:43008
 s_waitcnt lgkmcnt(8)
 v_mfma_f32_32x32x16_bf16 v[0:15], v[208:211], a[100:103], v[0:15]
 ds_read_b64_tr_b16 v[204:205], v249 offset:40960
 ds_read_b64_tr_b16 v[206:207], v249 offset:43008
 s_waitcnt lgkmcnt(8)
 v_mfma_f32_32x32x16_bf16 v[16:31], v[212:215], a[100:103], v[16:31]
 ds_read_b64_tr_b16 v[208:209], v250 offset:40960
 ds_read_b64_tr_b16 v[210:211], v250 offset:43008
 s_waitcnt lgkmcnt(8)
 v_mfma_f32_32x32x16_bf16 v[32:47], v[192:195], a[100:103], v[32:47]
 ds_read_b64_tr_b16 v[212:213], v251 offset:40960
 ds_read_b64_tr_b16 v[214:215], v251 offset:43008
 s_waitcnt lgkmcnt(8)
 v_mfma_f32_32x32x16_bf16 v[48:63], v[196:199], a[100:103], v[48:63]
 ds_read_b64_tr_b16 v[192:193], v248 offset:45056
 ds_read_b64_tr_b16 v[194:195], v248 offset:47104
 s_waitcnt lgkmcnt(8)
 v_mfma_f32_32x32x16_bf16 v[0:15], v[200:203], a[104:107], v[0:15]
 buffer_load_dwordx4 a[48:51], v232, s[8:11], s54 offen offset:0
 buffer_load_dwordx4 a[52:55], v232, s[8:11], s54 offen offset:1024
 buffer_load_dwordx4 a[56:59], v232, s[8:11], s54 offen offset:2048
 s_add_u32 s54, s54, 3072
 buffer_load_dwordx4 a[60:63], v232, s[8:11], s54 offen offset:0
 buffer_load_dwordx4 a[64:67], v232, s[8:11], s54 offen offset:1024
 buffer_load_dwordx4 a[68:71], v232, s[8:11], s54 offen offset:2048
 s_add_u32 s54, s54, 3072
 ds_read_b64_tr_b16 v[196:197], v249 offset:45056
 ds_read_b64_tr_b16 v[198:199], v249 offset:47104
 s_waitcnt lgkmcnt(8)
 v_mfma_f32_32x32x16_bf16 v[16:31], v[204:207], a[104:107], v[16:31]
 ds_read_b64_tr_b16 v[200:201], v250 offset:45056
 ds_read_b64_tr_b16 v[202:203], v250 offset:47104
 s_waitcnt lgkmcnt(8)
 v_mfma_f32_32x32x16_bf16 v[32:47], v[208:211], a[104:107], v[32:47]
 ds_read_b64_tr_b16 v[204:205], v251 offset:45056
 ds_read_b64_tr_b16 v[206:207], v251 offset:47104
 s_waitcnt lgkmcnt(8)
 v_mfma_f32_32x32x16_bf16 v[48:63], v[212:215], a[104:107], v[48:63]
 ds_read_b64_tr_b16 v[208:209], v248 offset:49152
 ds_read_b64_tr_b16 v[210:211], v248 offset:51200
 s_waitcnt lgkmcnt(8)
 v_mfma_f32_32x32x16_bf16 v[0:15], v[192:195], a[108:111], v[0:15]
 ds_read_b64_tr_b16 v[212:213], v249 offset:49152
 ds_read_b64_tr_b16 v[214:215], v249 offset:51200
 s_waitcnt lgkmcnt(8)
 v_mfma_f32_32x32x16_bf16 v[16:31], v[196:199], a[108:111], v[16:31]
 ds_read_b64_tr_b16 v[192:193], v250 offset:49152
 ds_read_b64_tr_b16 v[194:195], v250 offset:51200
 s_waitcnt lgkmcnt(8)
 v_mfma_f32_32x32x16_bf16 v[32:47], v[200:203], a[108:111], v[32:47]
 ds_read_b64_tr_b16 v[196:197], v251 offset:49152
 ds_read_b64_tr_b16 v[198:199], v251 offset:51200
 s_waitcnt lgkmcnt(8)
 v_mfma_f32_32x32x16_bf16 v[48:63], v[204:207], a[108:111], v[48:63]
 ds_read_b64_tr_b16 v[200:201], v248 offset:53248
 ds_read_b64_tr_b16 v[202:203], v248 offset:55296
 s_waitcnt lgkmcnt(8)
 v_mfma_f32_32x32x16_bf16 v[0:15], v[208:211], a[112:115], v[0:15]
 ds_read_b64_tr_b16 v[204:205], v249 offset:53248
 ds_read_b64_tr_b16 v[206:207], v249 offset:55296
 s_waitcnt lgkmcnt(8)
 v_mfma_f32_32x32x16_bf16 v[16:31], v[212:215], a[112:115], v[16:31]
 ds_read_b64_tr_b16 v[208:209], v250 offset:53248
 ds_read_b64_tr_b16 v[210:211], v250 offset:55296
 s_waitcnt lgkmcnt(8)
 v_mfma_f32_32x32x16_bf16 v[32:47], v[192:195], a[112:115], v[32:47]
 ds_read_b64_tr_b16 v[212:213], v251 offset:53248
 ds_read_b64_tr_b16 v[214:215], v251 offset:55296
 s_waitcnt lgkmcnt(8)
 v_mfma_f32_32x32x16_bf16 v[48:63], v[196:199], a[112:115], v[48:63]
 ds_read_b64_tr_b16 v[192:193], v240 offset:0
 ds_read_b64_tr_b16 v[194:195], v240 offset:2048
 s_waitcnt lgkmcnt(8)
 v_mfma_f32_32x32x16_bf16 v[0:15], v[200:203], a[116:119], v[0:15]
 ds_read_b64_tr_b16 v[196:197], v241 offset:0
 ds_read_b64_tr_b16 v[198:199], v241 offset:2048
 s_waitcnt lgkmcnt(8)
 v_mfma_f32_32x32x16_bf16 v[16:31], v[204:207], a[116:119], v[16:31]
 ds_read_b64_tr_b16 v[200:201], v242 offset:0
 ds_read_b64_tr_b16 v[202:203], v242 offset:2048
 s_waitcnt lgkmcnt(8)
 v_mfma_f32_32x32x16_bf16 v[32:47], v[208:211], a[116:119], v[32:47]
 ds_read_b64_tr_b16 v[204:205], v243 offset:0
 ds_read_b64_tr_b16 v[206:207], v243 offset:2048
 s_waitcnt lgkmcnt(8)
 v_mfma_f32_32x32x16_bf16 v[48:63], v[212:215], a[116:119], v[48:63]
 s_waitcnt vmcnt(30)
 s_barrier
 ds_read_b64_tr_b16 v[208:209], v240 offset:4096
 ds_read_b64_tr_b16 v[210:211], v240 offset:6144
 s_waitcnt lgkmcnt(8)
 v_mfma_f32_32x32x16_bf16 v[0:15], v[192:195], a[120:123], v[0:15]
 ds_read_b64_tr_b16 v[212:213], v241 offset:4096
 ds_read_b64_tr_b16 v[214:215], v241 offset:6144
 s_waitcnt lgkmcnt(8)
 v_mfma_f32_32x32x16_bf16 v[16:31], v[196:199], a[120:123], v[16:31]
 s_add_u32 m0, s19, 98304
 s_add_u32 s29, s52, 1105920
 buffer_load_dwordx4 v236, s[60:63], s29 offen lds
 s_add_u32 m0, s19, 99328
 s_add_u32 s29, s52, 1111040
 buffer_load_dwordx4 v236, s[60:63], s29 offen lds
 s_add_u32 m0, s19, 100352
 s_add_u32 s29, s52, 1116160
 buffer_load_dwordx4 v236, s[60:63], s29 offen lds
 s_add_u32 m0, s19, 101376
 s_add_u32 s29, s52, 1121280
 buffer_load_dwordx4 v236, s[60:63], s29 offen lds
 s_add_u32 m0, s19, 102400
 s_add_u32 s29, s52, 1126400
 buffer_load_dwordx4 v236, s[60:63], s29 offen lds
 s_add_u32 m0, s19, 103424
 s_add_u32 s29, s52, 1131520
 buffer_load_dwordx4 v236, s[60:63], s29 offen lds
 ds_read_b64_tr_b16 v[192:193], v242 offset:4096
 ds_read_b64_tr_b16 v[194:195], v242 offset:6144
 s_waitcnt lgkmcnt(8)
 v_mfma_f32_32x32x16_bf16 v[32:47], v[200:203], a[120:123], v[32:47]
 ds_read_b64_tr_b16 v[196:197], v243 offset:4096
 ds_read_b64_tr_b16 v[198:199], v243 offset:6144
 s_waitcnt lgkmcnt(8)
 v_mfma_f32_32x32x16_bf16 v[48:63], v[204:207], a[120:123], v[48:63]
 ds_read_b64_tr_b16 v[200:201], v240 offset:8192
 ds_read_b64_tr_b16 v[202:203], v240 offset:10240
 s_waitcnt lgkmcnt(8)
 v_mfma_f32_32x32x16_bf16 v[0:15], v[208:211], a[124:127], v[0:15]
 ds_read_b64_tr_b16 v[204:205], v241 offset:8192
 ds_read_b64_tr_b16 v[206:207], v241 offset:10240
 s_waitcnt lgkmcnt(8)
 v_mfma_f32_32x32x16_bf16 v[16:31], v[212:215], a[124:127], v[16:31]
 ds_read_b64_tr_b16 v[208:209], v242 offset:8192
 ds_read_b64_tr_b16 v[210:211], v242 offset:10240
 s_waitcnt lgkmcnt(8)
 v_mfma_f32_32x32x16_bf16 v[32:47], v[192:195], a[124:127], v[32:47]
 ds_read_b64_tr_b16 v[212:213], v243 offset:8192
 ds_read_b64_tr_b16 v[214:215], v243 offset:10240
 s_waitcnt lgkmcnt(8)
 v_mfma_f32_32x32x16_bf16 v[48:63], v[196:199], a[124:127], v[48:63]
 ds_read_b64_tr_b16 v[192:193], v240 offset:12288
 ds_read_b64_tr_b16 v[194:195], v240 offset:14336
 s_waitcnt lgkmcnt(8)
 v_mfma_f32_32x32x16_bf16 v[0:15], v[200:203], a[128:131], v[0:15]
 buffer_load_dwordx4 a[72:75], v232, s[8:11], s54 offen offset:0
 buffer_load_dwordx4 a[76:79], v232, s[8:11], s54 offen offset:1024
 buffer_load_dwordx4 a[80:83], v232, s[8:11], s54 offen offset:2048
 s_add_u32 s54, s54, 3072
 buffer_load_dwordx4 a[84:87], v232, s[8:11], s54 offen offset:0
 buffer_load_dwordx4 a[88:91], v232, s[8:11], s54 offen offset:1024
 buffer_load_dwordx4 a[92:95], v232, s[8:11], s54 offen offset:2048
 s_add_u32 s54, s54, 3072
 ds_read_b64_tr_b16 v[196:197], v241 offset:12288
 ds_read_b64_tr_b16 v[198:199], v241 offset:14336
 s_waitcnt lgkmcnt(8)
 v_mfma_f32_32x32x16_bf16 v[16:31], v[204:207], a[128:131], v[16:31]
 ds_read_b64_tr_b16 v[200:201], v242 offset:12288
 ds_read_b64_tr_b16 v[202:203], v242 offset:14336
 s_waitcnt lgkmcnt(8)
 v_mfma_f32_32x32x16_bf16 v[32:47], v[208:211], a[128:131], v[32:47]
 ds_read_b64_tr_b16 v[204:205], v243 offset:12288
 ds_read_b64_tr_b16 v[206:207], v243 offset:14336
 s_waitcnt lgkmcnt(8)
 v_mfma_f32_32x32x16_bf16 v[48:63], v[212:215], a[128:131], v[48:63]
 ds_read_b64_tr_b16 v[208:209], v240 offset:16384
 ds_read_b64_tr_b16 v[210:211], v240 offset:18432
 s_waitcnt lgkmcnt(8)
 v_mfma_f32_32x32x16_bf16 v[0:15], v[192:195], a[132:135], v[0:15]
 ds_read_b64_tr_b16 v[212:213], v241 offset:16384
 ds_read_b64_tr_b16 v[214:215], v241 offset:18432
 s_waitcnt lgkmcnt(8)
 v_mfma_f32_32x32x16_bf16 v[16:31], v[196:199], a[132:135], v[16:31]
 ds_read_b64_tr_b16 v[192:193], v242 offset:16384
 ds_read_b64_tr_b16 v[194:195], v242 offset:18432
 s_waitcnt lgkmcnt(8)
 v_mfma_f32_32x32x16_bf16 v[32:47], v[200:203], a[132:135], v[32:47]
 ds_read_b64_tr_b16 v[196:197], v243 offset:16384
 ds_read_b64_tr_b16 v[198:199], v243 offset:18432
 s_waitcnt lgkmcnt(8)
 v_mfma_f32_32x32x16_bf16 v[48:63], v[204:207], a[132:135], v[48:63]
 ds_read_b64_tr_b16 v[200:201], v240 offset:20480
 ds_read_b64_tr_b16 v[202:203], v240 offset:22528
 s_waitcnt lgkmcnt(8)
 v_mfma_f32_32x32x16_bf16 v[0:15], v[208:211], a[136:139], v[0:15]
 ds_read_b64_tr_b16 v[204:205], v241 offset:20480
 ds_read_b64_tr_b16 v[206:207], v241 offset:22528
 s_waitcnt lgkmcnt(8)
 v_mfma_f32_32x32x16_bf16 v[16:31], v[212:215], a[136:139], v[16:31]
 ds_read_b64_tr_b16 v[208:209], v242 offset:20480
 ds_read_b64_tr_b16 v[210:211], v242 offset:22528
 s_waitcnt lgkmcnt(8)
 v_mfma_f32_32x32x16_bf16 v[32:47], v[192:195], a[136:139], v[32:47]
 ds_read_b64_tr_b16 v[212:213], v243 offset:20480
 ds_read_b64_tr_b16 v[214:215], v243 offset:22528
 s_waitcnt lgkmcnt(8)
 v_mfma_f32_32x32x16_bf16 v[48:63], v[196:199], a[136:139], v[48:63]
 ds_read_b64_tr_b16 v[192:193], v240 offset:24576
 ds_read_b64_tr_b16 v[194:195], v240 offset:26624
 s_waitcnt lgkmcnt(8)
 v_mfma_f32_32x32x16_bf16 v[0:15], v[200:203], a[140:143], v[0:15]
 ds_read_b64_tr_b16 v[196:197], v241 offset:24576
 ds_read_b64_tr_b16 v[198:199], v241 offset:26624
 s_waitcnt lgkmcnt(8)
 v_mfma_f32_32x32x16_bf16 v[16:31], v[204:207], a[140:143], v[16:31]
 ds_read_b64_tr_b16 v[200:201], v242 offset:24576
 ds_read_b64_tr_b16 v[202:203], v242 offset:26624
 s_waitcnt lgkmcnt(8)
 v_mfma_f32_32x32x16_bf16 v[32:47], v[208:211], a[140:143], v[32:47]
 ds_read_b64_tr_b16 v[204:205], v243 offset:24576
 ds_read_b64_tr_b16 v[206:207], v243 offset:26624
 s_waitcnt lgkmcnt(8)
 v_mfma_f32_32x32x16_bf16 v[48:63], v[212:215], a[140:143], v[48:63]
 s_waitcnt vmcnt(30)
 s_barrier
 ds_read_b64_tr_b16 v[208:209], v240 offset:28672
 ds_read_b64_tr_b16 v[210:211], v240 offset:30720
 s_waitcnt lgkmcnt(8)
 v_mfma_f32_32x32x16_bf16 v[0:15], v[192:195], a[0:3], v[0:15]
 ds_read_b64_tr_b16 v[212:213], v241 offset:28672
 ds_read_b64_tr_b16 v[214:215], v241 offset:30720
 s_waitcnt lgkmcnt(8)
 v_mfma_f32_32x32x16_bf16 v[16:31], v[196:199], a[0:3], v[16:31]
 s_add_u32 m0, s19, 0
 s_add_u32 s29, s52, 1228800
 buffer_load_dwordx4 v236, s[60:63], s29 offen lds
 s_add_u32 m0, s19, 1024
 s_add_u32 s29, s52, 1233920
 buffer_load_dwordx4 v236, s[60:63], s29 offen lds
 s_add_u32 m0, s19, 2048
 s_add_u32 s29, s52, 1239040
 buffer_load_dwordx4 v236, s[60:63], s29 offen lds
 s_add_u32 m0, s19, 3072
 s_add_u32 s29, s52, 1244160
 buffer_load_dwordx4 v236, s[60:63], s29 offen lds
 s_add_u32 m0, s19, 4096
 s_add_u32 s29, s52, 1249280
 buffer_load_dwordx4 v236, s[60:63], s29 offen lds
 s_add_u32 m0, s19, 5120
 s_add_u32 s29, s52, 1254400
 buffer_load_dwordx4 v236, s[60:63], s29 offen lds
 ds_read_b64_tr_b16 v[192:193], v242 offset:28672
 ds_read_b64_tr_b16 v[194:195], v242 offset:30720
 s_waitcnt lgkmcnt(8)
 v_mfma_f32_32x32x16_bf16 v[32:47], v[200:203], a[0:3], v[32:47]
 ds_read_b64_tr_b16 v[196:197], v243 offset:28672
 ds_read_b64_tr_b16 v[198:199], v243 offset:30720
 s_waitcnt lgkmcnt(8)
 v_mfma_f32_32x32x16_bf16 v[48:63], v[204:207], a[0:3], v[48:63]
 ds_read_b64_tr_b16 v[200:201], v240 offset:32768
 ds_read_b64_tr_b16 v[202:203], v240 offset:34816
 s_waitcnt lgkmcnt(8)
 v_mfma_f32_32x32x16_bf16 v[0:15], v[208:211], a[4:7], v[0:15]
 ds_read_b64_tr_b16 v[204:205], v241 offset:32768
 ds_read_b64_tr_b16 v[206:207], v241 offset:34816
 s_waitcnt lgkmcnt(8)
 v_mfma_f32_32x32x16_bf16 v[16:31], v[212:215], a[4:7], v[16:31]
 ds_read_b64_tr_b16 v[208:209], v242 offset:32768
 ds_read_b64_tr_b16 v[210:211], v242 offset:34816
 s_waitcnt lgkmcnt(8)
 v_mfma_f32_32x32x16_bf16 v[32:47], v[192:195], a[4:7], v[32:47]
 ds_read_b64_tr_b16 v[212:213], v243 offset:32768
 ds_read_b64_tr_b16 v[214:215], v243 offset:34816
 s_waitcnt lgkmcnt(8)
 v_mfma_f32_32x32x16_bf16 v[48:63], v[196:199], a[4:7], v[48:63]
 ds_read_b64_tr_b16 v[192:193], v240 offset:36864
 ds_read_b64_tr_b16 v[194:195], v240 offset:38912
 s_waitcnt lgkmcnt(8)
 v_mfma_f32_32x32x16_bf16 v[0:15], v[200:203], a[8:11], v[0:15]
 buffer_load_dwordx4 a[96:99], v232, s[8:11], s54 offen offset:0
 buffer_load_dwordx4 a[100:103], v232, s[8:11], s54 offen offset:1024
 buffer_load_dwordx4 a[104:107], v232, s[8:11], s54 offen offset:2048
 s_add_u32 s54, s54, 3072
 buffer_load_dwordx4 a[108:111], v232, s[8:11], s54 offen offset:0
 buffer_load_dwordx4 a[112:115], v232, s[8:11], s54 offen offset:1024
 buffer_load_dwordx4 a[116:119], v232, s[8:11], s54 offen offset:2048
 s_add_u32 s54, s54, 3072
 ds_read_b64_tr_b16 v[196:197], v241 offset:36864
 ds_read_b64_tr_b16 v[198:199], v241 offset:38912
 s_waitcnt lgkmcnt(8)
 v_mfma_f32_32x32x16_bf16 v[16:31], v[204:207], a[8:11], v[16:31]
 ds_read_b64_tr_b16 v[200:201], v242 offset:36864
 ds_read_b64_tr_b16 v[202:203], v242 offset:38912
 s_waitcnt lgkmcnt(8)
 v_mfma_f32_32x32x16_bf16 v[32:47], v[208:211], a[8:11], v[32:47]
 ds_read_b64_tr_b16 v[204:205], v243 offset:36864
 ds_read_b64_tr_b16 v[206:207], v243 offset:38912
 s_waitcnt lgkmcnt(8)
 v_mfma_f32_32x32x16_bf16 v[48:63], v[212:215], a[8:11], v[48:63]
 ds_read_b64_tr_b16 v[208:209], v240 offset:40960
 ds_read_b64_tr_b16 v[210:211], v240 offset:43008
 s_waitcnt lgkmcnt(8)
 v_mfma_f32_32x32x16_bf16 v[0:15], v[192:195], a[12:15], v[0:15]
 ds_read_b64_tr_b16 v[212:213], v241 offset:40960
 ds_read_b64_tr_b16 v[214:215], v241 offset:43008
 s_waitcnt lgkmcnt(8)
 v_mfma_f32_32x32x16_bf16 v[16:31], v[196:199], a[12:15], v[16:31]
 ds_read_b64_tr_b16 v[192:193], v242 offset:40960
 ds_read_b64_tr_b16 v[194:195], v242 offset:43008
 s_waitcnt lgkmcnt(8)
 v_mfma_f32_32x32x16_bf16 v[32:47], v[200:203], a[12:15], v[32:47]
 ds_read_b64_tr_b16 v[196:197], v243 offset:40960
 ds_read_b64_tr_b16 v[198:199], v243 offset:43008
 s_waitcnt lgkmcnt(8)
 v_mfma_f32_32x32x16_bf16 v[48:63], v[204:207], a[12:15], v[48:63]
 ds_read_b64_tr_b16 v[200:201], v240 offset:45056
 ds_read_b64_tr_b16 v[202:203], v240 offset:47104
 s_waitcnt lgkmcnt(8)
 v_mfma_f32_32x32x16_bf16 v[0:15], v[208:211], a[16:19], v[0:15]
 ds_read_b64_tr_b16 v[204:205], v241 offset:45056
 ds_read_b64_tr_b16 v[206:207], v241 offset:47104
 s_waitcnt lgkmcnt(8)
 v_mfma_f32_32x32x16_bf16 v[16:31], v[212:215], a[16:19], v[16:31]
 ds_read_b64_tr_b16 v[208:209], v242 offset:45056
 ds_read_b64_tr_b16 v[210:211], v242 offset:47104
 s_waitcnt lgkmcnt(8)
 v_mfma_f32_32x32x16_bf16 v[32:47], v[192:195], a[16:19], v[32:47]
 ds_read_b64_tr_b16 v[212:213], v243 offset:45056
 ds_read_b64_tr_b16 v[214:215], v243 offset:47104
 s_waitcnt lgkmcnt(8)
 v_mfma_f32_32x32x16_bf16 v[48:63], v[196:199], a[16:19], v[48:63]
 ds_read_b64_tr_b16 v[192:193], v240 offset:49152
 ds_read_b64_tr_b16 v[194:195], v240 offset:51200
 s_waitcnt lgkmcnt(8)
 v_mfma_f32_32x32x16_bf16 v[0:15], v[200:203], a[20:23], v[0:15]
 ds_read_b64_tr_b16 v[196:197], v241 offset:49152
 ds_read_b64_tr_b16 v[198:199], v241 offset:51200
 s_waitcnt lgkmcnt(8)
 v_mfma_f32_32x32x16_bf16 v[16:31], v[204:207], a[20:23], v[16:31]
 ds_read_b64_tr_b16 v[200:201], v242 offset:49152
 ds_read_b64_tr_b16 v[202:203], v242 offset:51200
 s_waitcnt lgkmcnt(8)
 v_mfma_f32_32x32x16_bf16 v[32:47], v[208:211], a[20:23], v[32:47]
 ds_read_b64_tr_b16 v[204:205], v243 offset:49152
 ds_read_b64_tr_b16 v[206:207], v243 offset:51200
 s_waitcnt lgkmcnt(8)
 v_mfma_f32_32x32x16_bf16 v[48:63], v[212:215], a[20:23], v[48:63]
 s_waitcnt vmcnt(30)
 s_barrier
 ds_read_b64_tr_b16 v[208:209], v240 offset:53248
 ds_read_b64_tr_b16 v[210:211], v240 offset:55296
 s_waitcnt lgkmcnt(8)
 v_mfma_f32_32x32x16_bf16 v[0:15], v[192:195], a[24:27], v[0:15]
 ds_read_b64_tr_b16 v[212:213], v241 offset:53248
 ds_read_b64_tr_b16 v[214:215], v241 offset:55296
 s_waitcnt lgkmcnt(8)
 v_mfma_f32_32x32x16_bf16 v[16:31], v[196:199], a[24:27], v[16:31]
 s_add_u32 m0, s19, 24576
 s_add_u32 s29, s52, 1351680
 buffer_load_dwordx4 v236, s[60:63], s29 offen lds
 s_add_u32 m0, s19, 25600
 s_add_u32 s29, s52, 1356800
 buffer_load_dwordx4 v236, s[60:63], s29 offen lds
 s_add_u32 m0, s19, 26624
 s_add_u32 s29, s52, 1361920
 buffer_load_dwordx4 v236, s[60:63], s29 offen lds
 s_add_u32 m0, s19, 27648
 s_add_u32 s29, s52, 1367040
 buffer_load_dwordx4 v236, s[60:63], s29 offen lds
 s_add_u32 m0, s19, 28672
 s_add_u32 s29, s52, 1372160
 buffer_load_dwordx4 v236, s[60:63], s29 offen lds
 s_add_u32 m0, s19, 29696
 s_add_u32 s29, s52, 1377280
 buffer_load_dwordx4 v236, s[60:63], s29 offen lds
 ds_read_b64_tr_b16 v[192:193], v242 offset:53248
 ds_read_b64_tr_b16 v[194:195], v242 offset:55296
 s_waitcnt lgkmcnt(8)
 v_mfma_f32_32x32x16_bf16 v[32:47], v[200:203], a[24:27], v[32:47]
 ds_read_b64_tr_b16 v[196:197], v243 offset:53248
 ds_read_b64_tr_b16 v[198:199], v243 offset:55296
 s_waitcnt lgkmcnt(8)
 v_mfma_f32_32x32x16_bf16 v[48:63], v[204:207], a[24:27], v[48:63]
 ds_read_b64_tr_b16 v[200:201], v240 offset:57344
 ds_read_b64_tr_b16 v[202:203], v240 offset:59392
 s_waitcnt lgkmcnt(8)
 v_mfma_f32_32x32x16_bf16 v[0:15], v[208:211], a[28:31], v[0:15]
 ds_read_b64_tr_b16 v[204:205], v241 offset:57344
 ds_read_b64_tr_b16 v[206:207], v241 offset:59392
 s_waitcnt lgkmcnt(8)
 v_mfma_f32_32x32x16_bf16 v[16:31], v[212:215], a[28:31], v[16:31]
 ds_read_b64_tr_b16 v[208:209], v242 offset:57344
 ds_read_b64_tr_b16 v[210:211], v242 offset:59392
 s_waitcnt lgkmcnt(8)
 v_mfma_f32_32x32x16_bf16 v[32:47], v[192:195], a[28:31], v[32:47]
 ds_read_b64_tr_b16 v[212:213], v243 offset:57344
 ds_read_b64_tr_b16 v[214:215], v243 offset:59392
 s_waitcnt lgkmcnt(8)
 v_mfma_f32_32x32x16_bf16 v[48:63], v[196:199], a[28:31], v[48:63]
 ds_read_b64_tr_b16 v[192:193], v240 offset:61440
 ds_read_b64_tr_b16 v[194:195], v240 offset:63488
 s_waitcnt lgkmcnt(8)
 v_mfma_f32_32x32x16_bf16 v[0:15], v[200:203], a[32:35], v[0:15]
 buffer_load_dwordx4 a[120:123], v232, s[8:11], s54 offen offset:0
 buffer_load_dwordx4 a[124:127], v232, s[8:11], s54 offen offset:1024
 buffer_load_dwordx4 a[128:131], v232, s[8:11], s54 offen offset:2048
 s_add_u32 s54, s54, 3072
 buffer_load_dwordx4 a[132:135], v232, s[8:11], s54 offen offset:0
 buffer_load_dwordx4 a[136:139], v232, s[8:11], s54 offen offset:1024
 buffer_load_dwordx4 a[140:143], v232, s[8:11], s54 offen offset:2048
 s_add_u32 s54, s54, 3072
 ds_read_b64_tr_b16 v[196:197], v241 offset:61440
 ds_read_b64_tr_b16 v[198:199], v241 offset:63488
 s_waitcnt lgkmcnt(8)
 v_mfma_f32_32x32x16_bf16 v[16:31], v[204:207], a[32:35], v[16:31]
 ds_read_b64_tr_b16 v[200:201], v242 offset:61440
 ds_read_b64_tr_b16 v[202:203], v242 offset:63488
 s_waitcnt lgkmcnt(8)
 v_mfma_f32_32x32x16_bf16 v[32:47], v[208:211], a[32:35], v[32:47]
 ds_read_b64_tr_b16 v[204:205], v243 offset:61440
 ds_read_b64_tr_b16 v[206:207], v243 offset:63488
 s_waitcnt lgkmcnt(8)
 v_mfma_f32_32x32x16_bf16 v[48:63], v[212:215], a[32:35], v[48:63]
 ds_read_b64_tr_b16 v[208:209], v248 offset:0
 ds_read_b64_tr_b16 v[210:211], v248 offset:2048
 s_waitcnt lgkmcnt(8)
 v_mfma_f32_32x32x16_bf16 v[0:15], v[192:195], a[36:39], v[0:15]
 ds_read_b64_tr_b16 v[212:213], v249 offset:0
 ds_read_b64_tr_b16 v[214:215], v249 offset:2048
 s_waitcnt lgkmcnt(8)
 v_mfma_f32_32x32x16_bf16 v[16:31], v[196:199], a[36:39], v[16:31]
 ds_read_b64_tr_b16 v[192:193], v250 offset:0
 ds_read_b64_tr_b16 v[194:195], v250 offset:2048
 s_waitcnt lgkmcnt(8)
 v_mfma_f32_32x32x16_bf16 v[32:47], v[200:203], a[36:39], v[32:47]
 ds_read_b64_tr_b16 v[196:197], v251 offset:0
 ds_read_b64_tr_b16 v[198:199], v251 offset:2048
 s_waitcnt lgkmcnt(8)
 v_mfma_f32_32x32x16_bf16 v[48:63], v[204:207], a[36:39], v[48:63]
 ds_read_b64_tr_b16 v[200:201], v248 offset:4096
 ds_read_b64_tr_b16 v[202:203], v248 offset:6144
 s_waitcnt lgkmcnt(8)
 v_mfma_f32_32x32x16_bf16 v[0:15], v[208:211], a[40:43], v[0:15]
 ds_read_b64_tr_b16 v[204:205], v249 offset:4096
 ds_read_b64_tr_b16 v[206:207], v249 offset:6144
 s_waitcnt lgkmcnt(8)
 v_mfma_f32_32x32x16_bf16 v[16:31], v[212:215], a[40:43], v[16:31]
 ds_read_b64_tr_b16 v[208:209], v250 offset:4096
 ds_read_b64_tr_b16 v[210:211], v250 offset:6144
 s_waitcnt lgkmcnt(8)
 v_mfma_f32_32x32x16_bf16 v[32:47], v[192:195], a[40:43], v[32:47]
 ds_read_b64_tr_b16 v[212:213], v251 offset:4096
 ds_read_b64_tr_b16 v[214:215], v251 offset:6144
 s_waitcnt lgkmcnt(8)
 v_mfma_f32_32x32x16_bf16 v[48:63], v[196:199], a[40:43], v[48:63]
 ds_read_b64_tr_b16 v[192:193], v248 offset:8192
 ds_read_b64_tr_b16 v[194:195], v248 offset:10240
 s_waitcnt lgkmcnt(8)
 v_mfma_f32_32x32x16_bf16 v[0:15], v[200:203], a[44:47], v[0:15]
 ds_read_b64_tr_b16 v[196:197], v249 offset:8192
 ds_read_b64_tr_b16 v[198:199], v249 offset:10240
 s_waitcnt lgkmcnt(8)
 v_mfma_f32_32x32x16_bf16 v[16:31], v[204:207], a[44:47], v[16:31]
 ds_read_b64_tr_b16 v[200:201], v250 offset:8192
 ds_read_b64_tr_b16 v[202:203], v250 offset:10240
 s_waitcnt lgkmcnt(8)
 v_mfma_f32_32x32x16_bf16 v[32:47], v[208:211], a[44:47], v[32:47]
 ds_read_b64_tr_b16 v[204:205], v251 offset:8192
 ds_read_b64_tr_b16 v[206:207], v251 offset:10240
 s_waitcnt lgkmcnt(8)
 v_mfma_f32_32x32x16_bf16 v[48:63], v[212:215], a[44:47], v[48:63]
 s_waitcnt vmcnt(30)
 s_barrier
 ds_read_b64_tr_b16 v[208:209], v248 offset:12288
 ds_read_b64_tr_b16 v[210:211], v248 offset:14336
 s_waitcnt lgkmcnt(8)
 v_mfma_f32_32x32x16_bf16 v[0:15], v[192:195], a[48:51], v[0:15]
 ds_read_b64_tr_b16 v[212:213], v249 offset:12288
 ds_read_b64_tr_b16 v[214:215], v249 offset:14336
 s_waitcnt lgkmcnt(8)
 v_mfma_f32_32x32x16_bf16 v[16:31], v[196:199], a[48:51], v[16:31]
 s_add_u32 m0, s19, 49152
 s_add_u32 s29, s52, 1474560
 buffer_load_dwordx4 v236, s[60:63], s29 offen lds
 s_add_u32 m0, s19, 50176
 s_add_u32 s29, s52, 1479680
 buffer_load_dwordx4 v236, s[60:63], s29 offen lds
 s_add_u32 m0, s19, 51200
 s_add_u32 s29, s52, 1484800
 buffer_load_dwordx4 v236, s[60:63], s29 offen lds
 s_add_u32 m0, s19, 52224
 s_add_u32 s29, s52, 1489920
 buffer_load_dwordx4 v236, s[60:63], s29 offen lds
 s_add_u32 m0, s19, 53248
 s_add_u32 s29, s52, 1495040
 buffer_load_dwordx4 v236, s[60:63], s29 offen lds
 s_add_u32 m0, s19, 54272
 s_add_u32 s29, s52, 1500160
 buffer_load_dwordx4 v236, s[60:63], s29 offen lds
 ds_read_b64_tr_b16 v[192:193], v250 offset:12288
 ds_read_b64_tr_b16 v[194:195], v250 offset:14336
 s_waitcnt lgkmcnt(8)
 v_mfma_f32_32x32x16_bf16 v[32:47], v[200:203], a[48:51], v[32:47]
 ds_read_b64_tr_b16 v[196:197], v251 offset:12288
 ds_read_b64_tr_b16 v[198:199], v251 offset:14336
 s_waitcnt lgkmcnt(8)
 v_mfma_f32_32x32x16_bf16 v[48:63], v[204:207], a[48:51], v[48:63]
 ds_read_b64_tr_b16 v[200:201], v248 offset:16384
 ds_read_b64_tr_b16 v[202:203], v248 offset:18432
 s_waitcnt lgkmcnt(8)
 v_mfma_f32_32x32x16_bf16 v[0:15], v[208:211], a[52:55], v[0:15]
 ds_read_b64_tr_b16 v[204:205], v249 offset:16384
 ds_read_b64_tr_b16 v[206:207], v249 offset:18432
 s_waitcnt lgkmcnt(8)
 v_mfma_f32_32x32x16_bf16 v[16:31], v[212:215], a[52:55], v[16:31]
 ds_read_b64_tr_b16 v[208:209], v250 offset:16384
 ds_read_b64_tr_b16 v[210:211], v250 offset:18432
 s_waitcnt lgkmcnt(8)
 v_mfma_f32_32x32x16_bf16 v[32:47], v[192:195], a[52:55], v[32:47]
 ds_read_b64_tr_b16 v[212:213], v251 offset:16384
 ds_read_b64_tr_b16 v[214:215], v251 offset:18432
 s_waitcnt lgkmcnt(8)
 v_mfma_f32_32x32x16_bf16 v[48:63], v[196:199], a[52:55], v[48:63]
 ds_read_b64_tr_b16 v[192:193], v248 offset:20480
 ds_read_b64_tr_b16 v[194:195], v248 offset:22528
 s_waitcnt lgkmcnt(8)
 v_mfma_f32_32x32x16_bf16 v[0:15], v[200:203], a[56:59], v[0:15]
 buffer_load_dwordx4 a[0:3], v232, s[8:11], s54 offen offset:0
 buffer_load_dwordx4 a[4:7], v232, s[8:11], s54 offen offset:1024
 buffer_load_dwordx4 a[8:11], v232, s[8:11], s54 offen offset:2048
 s_add_u32 s54, s54, 3072
 buffer_load_dwordx4 a[12:15], v232, s[8:11], s54 offen offset:0
 buffer_load_dwordx4 a[16:19], v232, s[8:11], s54 offen offset:1024
 buffer_load_dwordx4 a[20:23], v232, s[8:11], s54 offen offset:2048
 s_add_u32 s54, s54, 3072
 ds_read_b64_tr_b16 v[196:197], v249 offset:20480
 ds_read_b64_tr_b16 v[198:199], v249 offset:22528
 s_waitcnt lgkmcnt(8)
 v_mfma_f32_32x32x16_bf16 v[16:31], v[204:207], a[56:59], v[16:31]
 ds_read_b64_tr_b16 v[200:201], v250 offset:20480
 ds_read_b64_tr_b16 v[202:203], v250 offset:22528
 s_waitcnt lgkmcnt(8)
 v_mfma_f32_32x32x16_bf16 v[32:47], v[208:211], a[56:59], v[32:47]
 ds_read_b64_tr_b16 v[204:205], v251 offset:20480
 ds_read_b64_tr_b16 v[206:207], v251 offset:22528
 s_waitcnt lgkmcnt(8)
 v_mfma_f32_32x32x16_bf16 v[48:63], v[212:215], a[56:59], v[48:63]
 ds_read_b64_tr_b16 v[208:209], v248 offset:24576
 ds_read_b64_tr_b16 v[210:211], v248 offset:26624
 s_waitcnt lgkmcnt(8)
 v_mfma_f32_32x32x16_bf16 v[0:15], v[192:195], a[60:63], v[0:15]
 ds_read_b64_tr_b16 v[212:213], v249 offset:24576
 ds_read_b64_tr_b16 v[214:215], v249 offset:26624
 s_waitcnt lgkmcnt(8)
 v_mfma_f32_32x32x16_bf16 v[16:31], v[196:199], a[60:63], v[16:31]
 ds_read_b64_tr_b16 v[192:193], v250 offset:24576
 ds_read_b64_tr_b16 v[194:195], v250 offset:26624
 s_waitcnt lgkmcnt(8)
 v_mfma_f32_32x32x16_bf16 v[32:47], v[200:203], a[60:63], v[32:47]
 ds_read_b64_tr_b16 v[196:197], v251 offset:24576
 ds_read_b64_tr_b16 v[198:199], v251 offset:26624
 s_waitcnt lgkmcnt(8)
 v_mfma_f32_32x32x16_bf16 v[48:63], v[204:207], a[60:63], v[48:63]
 ds_read_b64_tr_b16 v[200:201], v248 offset:28672
 ds_read_b64_tr_b16 v[202:203], v248 offset:30720
 s_waitcnt lgkmcnt(8)
 v_mfma_f32_32x32x16_bf16 v[0:15], v[208:211], a[64:67], v[0:15]
 ds_read_b64_tr_b16 v[204:205], v249 offset:28672
 ds_read_b64_tr_b16 v[206:207], v249 offset:30720
 s_waitcnt lgkmcnt(8)
 v_mfma_f32_32x32x16_bf16 v[16:31], v[212:215], a[64:67], v[16:31]
 ds_read_b64_tr_b16 v[208:209], v250 offset:28672
 ds_read_b64_tr_b16 v[210:211], v250 offset:30720
 s_waitcnt lgkmcnt(8)
 v_mfma_f32_32x32x16_bf16 v[32:47], v[192:195], a[64:67], v[32:47]
 ds_read_b64_tr_b16 v[212:213], v251 offset:28672
 ds_read_b64_tr_b16 v[214:215], v251 offset:30720
 s_waitcnt lgkmcnt(8)
 v_mfma_f32_32x32x16_bf16 v[48:63], v[196:199], a[64:67], v[48:63]
 ds_read_b64_tr_b16 v[192:193], v248 offset:32768
 ds_read_b64_tr_b16 v[194:195], v248 offset:34816
 s_waitcnt lgkmcnt(8)
 v_mfma_f32_32x32x16_bf16 v[0:15], v[200:203], a[68:71], v[0:15]
 ds_read_b64_tr_b16 v[196:197], v249 offset:32768
 ds_read_b64_tr_b16 v[198:199], v249 offset:34816
 s_waitcnt lgkmcnt(8)
 v_mfma_f32_32x32x16_bf16 v[16:31], v[204:207], a[68:71], v[16:31]
 ds_read_b64_tr_b16 v[200:201], v250 offset:32768
 ds_read_b64_tr_b16 v[202:203], v250 offset:34816
 s_waitcnt lgkmcnt(8)
 v_mfma_f32_32x32x16_bf16 v[32:47], v[208:211], a[68:71], v[32:47]
 ds_read_b64_tr_b16 v[204:205], v251 offset:32768
 ds_read_b64_tr_b16 v[206:207], v251 offset:34816
 s_waitcnt lgkmcnt(8)
 v_mfma_f32_32x32x16_bf16 v[48:63], v[212:215], a[68:71], v[48:63]
 s_waitcnt vmcnt(30)
 s_barrier
 ds_read_b64_tr_b16 v[208:209], v248 offset:36864
 ds_read_b64_tr_b16 v[210:211], v248 offset:38912
 s_waitcnt lgkmcnt(8)
 v_mfma_f32_32x32x16_bf16 v[0:15], v[192:195], a[72:75], v[0:15]
 ds_read_b64_tr_b16 v[212:213], v249 offset:36864
 ds_read_b64_tr_b16 v[214:215], v249 offset:38912
 s_waitcnt lgkmcnt(8)
 v_mfma_f32_32x32x16_bf16 v[16:31], v[196:199], a[72:75], v[16:31]
 s_add_u32 m0, s19, 73728
 s_add_u32 s29, s52, 1597440
 buffer_load_dwordx4 v236, s[60:63], s29 offen lds
 s_add_u32 m0, s19, 74752
 s_add_u32 s29, s52, 1602560
 buffer_load_dwordx4 v236, s[60:63], s29 offen lds
 s_add_u32 m0, s19, 75776
 s_add_u32 s29, s52, 1607680
 buffer_load_dwordx4 v236, s[60:63], s29 offen lds
 s_add_u32 m0, s19, 76800
 s_add_u32 s29, s52, 1612800
 buffer_load_dwordx4 v236, s[60:63], s29 offen lds
 s_add_u32 m0, s19, 77824
 s_add_u32 s29, s52, 1617920
 buffer_load_dwordx4 v236, s[60:63], s29 offen lds
 s_add_u32 m0, s19, 78848
 s_add_u32 s29, s52, 1623040
 buffer_load_dwordx4 v236, s[60:63], s29 offen lds
 ds_read_b64_tr_b16 v[192:193], v250 offset:36864
 ds_read_b64_tr_b16 v[194:195], v250 offset:38912
 s_waitcnt lgkmcnt(8)
 v_mfma_f32_32x32x16_bf16 v[32:47], v[200:203], a[72:75], v[32:47]
 ds_read_b64_tr_b16 v[196:197], v251 offset:36864
 ds_read_b64_tr_b16 v[198:199], v251 offset:38912
 s_waitcnt lgkmcnt(8)
 v_mfma_f32_32x32x16_bf16 v[48:63], v[204:207], a[72:75], v[48:63]
 ds_read_b64_tr_b16 v[200:201], v248 offset:40960
 ds_read_b64_tr_b16 v[202:203], v248 offset:43008
 s_waitcnt lgkmcnt(8)
 v_mfma_f32_32x32x16_bf16 v[0:15], v[208:211], a[76:79], v[0:15]
 ds_read_b64_tr_b16 v[204:205], v249 offset:40960
 ds_read_b64_tr_b16 v[206:207], v249 offset:43008
 s_waitcnt lgkmcnt(8)
 v_mfma_f32_32x32x16_bf16 v[16:31], v[212:215], a[76:79], v[16:31]
 ds_read_b64_tr_b16 v[208:209], v250 offset:40960
 ds_read_b64_tr_b16 v[210:211], v250 offset:43008
 s_waitcnt lgkmcnt(8)
 v_mfma_f32_32x32x16_bf16 v[32:47], v[192:195], a[76:79], v[32:47]
 ds_read_b64_tr_b16 v[212:213], v251 offset:40960
 ds_read_b64_tr_b16 v[214:215], v251 offset:43008
 s_waitcnt lgkmcnt(8)
 v_mfma_f32_32x32x16_bf16 v[48:63], v[196:199], a[76:79], v[48:63]
 ds_read_b64_tr_b16 v[192:193], v248 offset:45056
 ds_read_b64_tr_b16 v[194:195], v248 offset:47104
 s_waitcnt lgkmcnt(8)
 v_mfma_f32_32x32x16_bf16 v[0:15], v[200:203], a[80:83], v[0:15]
 buffer_load_dwordx4 a[24:27], v232, s[8:11], s54 offen offset:0
 buffer_load_dwordx4 a[28:31], v232, s[8:11], s54 offen offset:1024
 buffer_load_dwordx4 a[32:35], v232, s[8:11], s54 offen offset:2048
 s_add_u32 s54, s54, 3072
 buffer_load_dwordx4 a[36:39], v232, s[8:11], s54 offen offset:0
 buffer_load_dwordx4 a[40:43], v232, s[8:11], s54 offen offset:1024
 buffer_load_dwordx4 a[44:47], v232, s[8:11], s54 offen offset:2048
 s_add_u32 s54, s54, 3072
 ds_read_b64_tr_b16 v[196:197], v249 offset:45056
 ds_read_b64_tr_b16 v[198:199], v249 offset:47104
 s_waitcnt lgkmcnt(8)
 v_mfma_f32_32x32x16_bf16 v[16:31], v[204:207], a[80:83], v[16:31]
 ds_read_b64_tr_b16 v[200:201], v250 offset:45056
 ds_read_b64_tr_b16 v[202:203], v250 offset:47104
 s_waitcnt lgkmcnt(8)
 v_mfma_f32_32x32x16_bf16 v[32:47], v[208:211], a[80:83], v[32:47]
 ds_read_b64_tr_b16 v[204:205], v251 offset:45056
 ds_read_b64_tr_b16 v[206:207], v251 offset:47104
 s_waitcnt lgkmcnt(8)
 v_mfma_f32_32x32x16_bf16 v[48:63], v[212:215], a[80:83], v[48:63]
 ds_read_b64_tr_b16 v[208:209], v248 offset:49152
 ds_read_b64_tr_b16 v[210:211], v248 offset:51200
 s_waitcnt lgkmcnt(8)
 v_mfma_f32_32x32x16_bf16 v[0:15], v[192:195], a[84:87], v[0:15]
 ds_read_b64_tr_b16 v[212:213], v249 offset:49152
 ds_read_b64_tr_b16 v[214:215], v249 offset:51200
 s_waitcnt lgkmcnt(8)
 v_mfma_f32_32x32x16_bf16 v[16:31], v[196:199], a[84:87], v[16:31]
 ds_read_b64_tr_b16 v[192:193], v250 offset:49152
 ds_read_b64_tr_b16 v[194:195], v250 offset:51200
 s_waitcnt lgkmcnt(8)
 v_mfma_f32_32x32x16_bf16 v[32:47], v[200:203], a[84:87], v[32:47]
 ds_read_b64_tr_b16 v[196:197], v251 offset:49152
 ds_read_b64_tr_b16 v[198:199], v251 offset:51200
 s_waitcnt lgkmcnt(8)
 v_mfma_f32_32x32x16_bf16 v[48:63], v[204:207], a[84:87], v[48:63]
 ds_read_b64_tr_b16 v[200:201], v248 offset:53248
 ds_read_b64_tr_b16 v[202:203], v248 offset:55296
 s_waitcnt lgkmcnt(8)
 v_mfma_f32_32x32x16_bf16 v[0:15], v[208:211], a[88:91], v[0:15]
 ds_read_b64_tr_b16 v[204:205], v249 offset:53248
 ds_read_b64_tr_b16 v[206:207], v249 offset:55296
 s_waitcnt lgkmcnt(8)
 v_mfma_f32_32x32x16_bf16 v[16:31], v[212:215], a[88:91], v[16:31]
 ds_read_b64_tr_b16 v[208:209], v250 offset:53248
 ds_read_b64_tr_b16 v[210:211], v250 offset:55296
 s_waitcnt lgkmcnt(8)
 v_mfma_f32_32x32x16_bf16 v[32:47], v[192:195], a[88:91], v[32:47]
 ds_read_b64_tr_b16 v[212:213], v251 offset:53248
 ds_read_b64_tr_b16 v[214:215], v251 offset:55296
 s_waitcnt lgkmcnt(8)
 v_mfma_f32_32x32x16_bf16 v[48:63], v[196:199], a[88:91], v[48:63]
 ds_read_b64_tr_b16 v[192:193], v240 offset:0
 ds_read_b64_tr_b16 v[194:195], v240 offset:2048
 s_waitcnt lgkmcnt(8)
 v_mfma_f32_32x32x16_bf16 v[0:15], v[200:203], a[92:95], v[0:15]
 ds_read_b64_tr_b16 v[196:197], v241 offset:0
 ds_read_b64_tr_b16 v[198:199], v241 offset:2048
 s_waitcnt lgkmcnt(8)
 v_mfma_f32_32x32x16_bf16 v[16:31], v[204:207], a[92:95], v[16:31]
 ds_read_b64_tr_b16 v[200:201], v242 offset:0
 ds_read_b64_tr_b16 v[202:203], v242 offset:2048
 s_waitcnt lgkmcnt(8)
 v_mfma_f32_32x32x16_bf16 v[32:47], v[208:211], a[92:95], v[32:47]
 ds_read_b64_tr_b16 v[204:205], v243 offset:0
 ds_read_b64_tr_b16 v[206:207], v243 offset:2048
 s_waitcnt lgkmcnt(8)
 v_mfma_f32_32x32x16_bf16 v[48:63], v[212:215], a[92:95], v[48:63]
 s_waitcnt vmcnt(30)
 s_barrier
 ds_read_b64_tr_b16 v[208:209], v240 offset:4096
 ds_read_b64_tr_b16 v[210:211], v240 offset:6144
 s_waitcnt lgkmcnt(8)
 v_mfma_f32_32x32x16_bf16 v[0:15], v[192:195], a[96:99], v[0:15]
 ds_read_b64_tr_b16 v[212:213], v241 offset:4096
 ds_read_b64_tr_b16 v[214:215], v241 offset:6144
 s_waitcnt lgkmcnt(8)
 v_mfma_f32_32x32x16_bf16 v[16:31], v[196:199], a[96:99], v[16:31]
 s_add_u32 m0, s19, 98304
 s_add_u32 s29, s52, 1720320
 buffer_load_dwordx4 v236, s[60:63], s29 offen lds
 s_add_u32 m0, s19, 99328
 s_add_u32 s29, s52, 1725440
 buffer_load_dwordx4 v236, s[60:63], s29 offen lds
 s_add_u32 m0, s19, 100352
 s_add_u32 s29, s52, 1730560
 buffer_load_dwordx4 v236, s[60:63], s29 offen lds
 s_add_u32 m0, s19, 101376
 s_add_u32 s29, s52, 1735680
 buffer_load_dwordx4 v236, s[60:63], s29 offen lds
 s_add_u32 m0, s19, 102400
 s_add_u32 s29, s52, 1740800
 buffer_load_dwordx4 v236, s[60:63], s29 offen lds
 s_add_u32 m0, s19, 103424
 s_add_u32 s29, s52, 1745920
 buffer_load_dwordx4 v236, s[60:63], s29 offen lds
 ds_read_b64_tr_b16 v[192:193], v242 offset:4096
 ds_read_b64_tr_b16 v[194:195], v242 offset:6144
 s_waitcnt lgkmcnt(8)
 v_mfma_f32_32x32x16_bf16 v[32:47], v[200:203], a[96:99], v[32:47]
 ds_read_b64_tr_b16 v[196:197], v243 offset:4096
 ds_read_b64_tr_b16 v[198:199], v243 offset:6144
 s_waitcnt lgkmcnt(8)
 v_mfma_f32_32x32x16_bf16 v[48:63], v[204:207], a[96:99], v[48:63]
 ds_read_b64_tr_b16 v[200:201], v240 offset:8192
 ds_read_b64_tr_b16 v[202:203], v240 offset:10240
 s_waitcnt lgkmcnt(8)
 v_mfma_f32_32x32x16_bf16 v[0:15], v[208:211], a[100:103], v[0:15]
 ds_read_b64_tr_b16 v[204:205], v241 offset:8192
 ds_read_b64_tr_b16 v[206:207], v241 offset:10240
 s_waitcnt lgkmcnt(8)
 v_mfma_f32_32x32x16_bf16 v[16:31], v[212:215], a[100:103], v[16:31]
 ds_read_b64_tr_b16 v[208:209], v242 offset:8192
 ds_read_b64_tr_b16 v[210:211], v242 offset:10240
 s_waitcnt lgkmcnt(8)
 v_mfma_f32_32x32x16_bf16 v[32:47], v[192:195], a[100:103], v[32:47]
 ds_read_b64_tr_b16 v[212:213], v243 offset:8192
 ds_read_b64_tr_b16 v[214:215], v243 offset:10240
 s_waitcnt lgkmcnt(8)
 v_mfma_f32_32x32x16_bf16 v[48:63], v[196:199], a[100:103], v[48:63]
 ds_read_b64_tr_b16 v[192:193], v240 offset:12288
 ds_read_b64_tr_b16 v[194:195], v240 offset:14336
 s_waitcnt lgkmcnt(8)
 v_mfma_f32_32x32x16_bf16 v[0:15], v[200:203], a[104:107], v[0:15]
 buffer_load_dwordx4 a[48:51], v232, s[8:11], s54 offen offset:0
 buffer_load_dwordx4 a[52:55], v232, s[8:11], s54 offen offset:1024
 buffer_load_dwordx4 a[56:59], v232, s[8:11], s54 offen offset:2048
 s_add_u32 s54, s54, 3072
 buffer_load_dwordx4 a[60:63], v232, s[8:11], s54 offen offset:0
 buffer_load_dwordx4 a[64:67], v232, s[8:11], s54 offen offset:1024
 buffer_load_dwordx4 a[68:71], v232, s[8:11], s54 offen offset:2048
 s_add_u32 s54, s54, 3072
 ds_read_b64_tr_b16 v[196:197], v241 offset:12288
 ds_read_b64_tr_b16 v[198:199], v241 offset:14336
 s_waitcnt lgkmcnt(8)
 v_mfma_f32_32x32x16_bf16 v[16:31], v[204:207], a[104:107], v[16:31]
 ds_read_b64_tr_b16 v[200:201], v242 offset:12288
 ds_read_b64_tr_b16 v[202:203], v242 offset:14336
 s_waitcnt lgkmcnt(8)
 v_mfma_f32_32x32x16_bf16 v[32:47], v[208:211], a[104:107], v[32:47]
 ds_read_b64_tr_b16 v[204:205], v243 offset:12288
 ds_read_b64_tr_b16 v[206:207], v243 offset:14336
 s_waitcnt lgkmcnt(8)
 v_mfma_f32_32x32x16_bf16 v[48:63], v[212:215], a[104:107], v[48:63]
 ds_read_b64_tr_b16 v[208:209], v240 offset:16384
 ds_read_b64_tr_b16 v[210:211], v240 offset:18432
 s_waitcnt lgkmcnt(8)
 v_mfma_f32_32x32x16_bf16 v[0:15], v[192:195], a[108:111], v[0:15]
 ds_read_b64_tr_b16 v[212:213], v241 offset:16384
 ds_read_b64_tr_b16 v[214:215], v241 offset:18432
 s_waitcnt lgkmcnt(8)
 v_mfma_f32_32x32x16_bf16 v[16:31], v[196:199], a[108:111], v[16:31]
 ds_read_b64_tr_b16 v[192:193], v242 offset:16384
 ds_read_b64_tr_b16 v[194:195], v242 offset:18432
 s_waitcnt lgkmcnt(8)
 v_mfma_f32_32x32x16_bf16 v[32:47], v[200:203], a[108:111], v[32:47]
 ds_read_b64_tr_b16 v[196:197], v243 offset:16384
 ds_read_b64_tr_b16 v[198:199], v243 offset:18432
 s_waitcnt lgkmcnt(8)
 v_mfma_f32_32x32x16_bf16 v[48:63], v[204:207], a[108:111], v[48:63]
 ds_read_b64_tr_b16 v[200:201], v240 offset:20480
 ds_read_b64_tr_b16 v[202:203], v240 offset:22528
 s_waitcnt lgkmcnt(8)
 v_mfma_f32_32x32x16_bf16 v[0:15], v[208:211], a[112:115], v[0:15]
 ds_read_b64_tr_b16 v[204:205], v241 offset:20480
 ds_read_b64_tr_b16 v[206:207], v241 offset:22528
 s_waitcnt lgkmcnt(8)
 v_mfma_f32_32x32x16_bf16 v[16:31], v[212:215], a[112:115], v[16:31]
 ds_read_b64_tr_b16 v[208:209], v242 offset:20480
 ds_read_b64_tr_b16 v[210:211], v242 offset:22528
 s_waitcnt lgkmcnt(8)
 v_mfma_f32_32x32x16_bf16 v[32:47], v[192:195], a[112:115], v[32:47]
 ds_read_b64_tr_b16 v[212:213], v243 offset:20480
 ds_read_b64_tr_b16 v[214:215], v243 offset:22528
 s_waitcnt lgkmcnt(8)
 v_mfma_f32_32x32x16_bf16 v[48:63], v[196:199], a[112:115], v[48:63]
 ds_read_b64_tr_b16 v[192:193], v240 offset:24576
 ds_read_b64_tr_b16 v[194:195], v240 offset:26624
 s_waitcnt lgkmcnt(8)
 v_mfma_f32_32x32x16_bf16 v[0:15], v[200:203], a[116:119], v[0:15]
 ds_read_b64_tr_b16 v[196:197], v241 offset:24576
 ds_read_b64_tr_b16 v[198:199], v241 offset:26624
 s_waitcnt lgkmcnt(8)
 v_mfma_f32_32x32x16_bf16 v[16:31], v[204:207], a[116:119], v[16:31]
 ds_read_b64_tr_b16 v[200:201], v242 offset:24576
 ds_read_b64_tr_b16 v[202:203], v242 offset:26624
 s_waitcnt lgkmcnt(8)
 v_mfma_f32_32x32x16_bf16 v[32:47], v[208:211], a[116:119], v[32:47]
 ds_read_b64_tr_b16 v[204:205], v243 offset:24576
 ds_read_b64_tr_b16 v[206:207], v243 offset:26624
 s_waitcnt lgkmcnt(8)
 v_mfma_f32_32x32x16_bf16 v[48:63], v[212:215], a[116:119], v[48:63]
 s_waitcnt vmcnt(30)
 s_barrier
 ds_read_b64_tr_b16 v[208:209], v240 offset:28672
 ds_read_b64_tr_b16 v[210:211], v240 offset:30720
 s_waitcnt lgkmcnt(8)
 v_mfma_f32_32x32x16_bf16 v[0:15], v[192:195], a[120:123], v[0:15]
 ds_read_b64_tr_b16 v[212:213], v241 offset:28672
 ds_read_b64_tr_b16 v[214:215], v241 offset:30720
 s_waitcnt lgkmcnt(8)
 v_mfma_f32_32x32x16_bf16 v[16:31], v[196:199], a[120:123], v[16:31]
 s_add_u32 m0, s19, 0
 s_add_u32 s29, s52, 1843200
 buffer_load_dwordx4 v236, s[60:63], s29 offen lds
 s_add_u32 m0, s19, 1024
 s_add_u32 s29, s52, 1848320
 buffer_load_dwordx4 v236, s[60:63], s29 offen lds
 s_add_u32 m0, s19, 2048
 s_add_u32 s29, s52, 1853440
 buffer_load_dwordx4 v236, s[60:63], s29 offen lds
 s_add_u32 m0, s19, 3072
 s_add_u32 s29, s52, 1858560
 buffer_load_dwordx4 v236, s[60:63], s29 offen lds
 s_add_u32 m0, s19, 4096
 s_add_u32 s29, s52, 1863680
 buffer_load_dwordx4 v236, s[60:63], s29 offen lds
 s_add_u32 m0, s19, 5120
 s_add_u32 s29, s52, 1868800
 buffer_load_dwordx4 v236, s[60:63], s29 offen lds
 ds_read_b64_tr_b16 v[192:193], v242 offset:28672
 ds_read_b64_tr_b16 v[194:195], v242 offset:30720
 s_waitcnt lgkmcnt(8)
 v_mfma_f32_32x32x16_bf16 v[32:47], v[200:203], a[120:123], v[32:47]
 ds_read_b64_tr_b16 v[196:197], v243 offset:28672
 ds_read_b64_tr_b16 v[198:199], v243 offset:30720
 s_waitcnt lgkmcnt(8)
 v_mfma_f32_32x32x16_bf16 v[48:63], v[204:207], a[120:123], v[48:63]
 ds_read_b64_tr_b16 v[200:201], v240 offset:32768
 ds_read_b64_tr_b16 v[202:203], v240 offset:34816
 s_waitcnt lgkmcnt(8)
 v_mfma_f32_32x32x16_bf16 v[0:15], v[208:211], a[124:127], v[0:15]
 ds_read_b64_tr_b16 v[204:205], v241 offset:32768
 ds_read_b64_tr_b16 v[206:207], v241 offset:34816
 s_waitcnt lgkmcnt(8)
 v_mfma_f32_32x32x16_bf16 v[16:31], v[212:215], a[124:127], v[16:31]
 ds_read_b64_tr_b16 v[208:209], v242 offset:32768
 ds_read_b64_tr_b16 v[210:211], v242 offset:34816
 s_waitcnt lgkmcnt(8)
 v_mfma_f32_32x32x16_bf16 v[32:47], v[192:195], a[124:127], v[32:47]
 ds_read_b64_tr_b16 v[212:213], v243 offset:32768
 ds_read_b64_tr_b16 v[214:215], v243 offset:34816
 s_waitcnt lgkmcnt(8)
 v_mfma_f32_32x32x16_bf16 v[48:63], v[196:199], a[124:127], v[48:63]
 ds_read_b64_tr_b16 v[192:193], v240 offset:36864
 ds_read_b64_tr_b16 v[194:195], v240 offset:38912
 s_waitcnt lgkmcnt(8)
 v_mfma_f32_32x32x16_bf16 v[0:15], v[200:203], a[128:131], v[0:15]
 buffer_load_dwordx4 a[72:75], v232, s[8:11], s54 offen offset:0
 buffer_load_dwordx4 a[76:79], v232, s[8:11], s54 offen offset:1024
 buffer_load_dwordx4 a[80:83], v232, s[8:11], s54 offen offset:2048
 s_add_u32 s54, s54, 3072
 buffer_load_dwordx4 a[84:87], v232, s[8:11], s54 offen offset:0
 buffer_load_dwordx4 a[88:91], v232, s[8:11], s54 offen offset:1024
 buffer_load_dwordx4 a[92:95], v232, s[8:11], s54 offen offset:2048
 s_add_u32 s54, s54, 3072
 ds_read_b64_tr_b16 v[196:197], v241 offset:36864
 ds_read_b64_tr_b16 v[198:199], v241 offset:38912
 s_waitcnt lgkmcnt(8)
 v_mfma_f32_32x32x16_bf16 v[16:31], v[204:207], a[128:131], v[16:31]
 ds_read_b64_tr_b16 v[200:201], v242 offset:36864
 ds_read_b64_tr_b16 v[202:203], v242 offset:38912
 s_waitcnt lgkmcnt(8)
 v_mfma_f32_32x32x16_bf16 v[32:47], v[208:211], a[128:131], v[32:47]
 ds_read_b64_tr_b16 v[204:205], v243 offset:36864
 ds_read_b64_tr_b16 v[206:207], v243 offset:38912
 s_waitcnt lgkmcnt(8)
 v_mfma_f32_32x32x16_bf16 v[48:63], v[212:215], a[128:131], v[48:63]
 ds_read_b64_tr_b16 v[208:209], v240 offset:40960
 ds_read_b64_tr_b16 v[210:211], v240 offset:43008
 s_waitcnt lgkmcnt(8)
 v_mfma_f32_32x32x16_bf16 v[0:15], v[192:195], a[132:135], v[0:15]
 ds_read_b64_tr_b16 v[212:213], v241 offset:40960
 ds_read_b64_tr_b16 v[214:215], v241 offset:43008
 s_waitcnt lgkmcnt(8)
 v_mfma_f32_32x32x16_bf16 v[16:31], v[196:199], a[132:135], v[16:31]
 ds_read_b64_tr_b16 v[192:193], v242 offset:40960
 ds_read_b64_tr_b16 v[194:195], v242 offset:43008
 s_waitcnt lgkmcnt(8)
 v_mfma_f32_32x32x16_bf16 v[32:47], v[200:203], a[132:135], v[32:47]
 ds_read_b64_tr_b16 v[196:197], v243 offset:40960
 ds_read_b64_tr_b16 v[198:199], v243 offset:43008
 s_waitcnt lgkmcnt(8)
 v_mfma_f32_32x32x16_bf16 v[48:63], v[204:207], a[132:135], v[48:63]
 ds_read_b64_tr_b16 v[200:201], v240 offset:45056
 ds_read_b64_tr_b16 v[202:203], v240 offset:47104
 s_waitcnt lgkmcnt(8)
 v_mfma_f32_32x32x16_bf16 v[0:15], v[208:211], a[136:139], v[0:15]
 ds_read_b64_tr_b16 v[204:205], v241 offset:45056
 ds_read_b64_tr_b16 v[206:207], v241 offset:47104
 s_waitcnt lgkmcnt(8)
 v_mfma_f32_32x32x16_bf16 v[16:31], v[212:215], a[136:139], v[16:31]
 ds_read_b64_tr_b16 v[208:209], v242 offset:45056
 ds_read_b64_tr_b16 v[210:211], v242 offset:47104
 s_waitcnt lgkmcnt(8)
 v_mfma_f32_32x32x16_bf16 v[32:47], v[192:195], a[136:139], v[32:47]
 ds_read_b64_tr_b16 v[212:213], v243 offset:45056
 ds_read_b64_tr_b16 v[214:215], v243 offset:47104
 s_waitcnt lgkmcnt(8)
 v_mfma_f32_32x32x16_bf16 v[48:63], v[196:199], a[136:139], v[48:63]
 ds_read_b64_tr_b16 v[192:193], v240 offset:49152
 ds_read_b64_tr_b16 v[194:195], v240 offset:51200
 s_waitcnt lgkmcnt(8)
 v_mfma_f32_32x32x16_bf16 v[0:15], v[200:203], a[140:143], v[0:15]
 ds_read_b64_tr_b16 v[196:197], v241 offset:49152
 ds_read_b64_tr_b16 v[198:199], v241 offset:51200
 s_waitcnt lgkmcnt(8)
 v_mfma_f32_32x32x16_bf16 v[16:31], v[204:207], a[140:143], v[16:31]
 ds_read_b64_tr_b16 v[200:201], v242 offset:49152
 ds_read_b64_tr_b16 v[202:203], v242 offset:51200
 s_waitcnt lgkmcnt(8)
 v_mfma_f32_32x32x16_bf16 v[32:47], v[208:211], a[140:143], v[32:47]
 ds_read_b64_tr_b16 v[204:205], v243 offset:49152
 ds_read_b64_tr_b16 v[206:207], v243 offset:51200
 s_waitcnt lgkmcnt(8)
 v_mfma_f32_32x32x16_bf16 v[48:63], v[212:215], a[140:143], v[48:63]
 s_waitcnt vmcnt(30)
 s_barrier
 ds_read_b64_tr_b16 v[208:209], v240 offset:53248
 ds_read_b64_tr_b16 v[210:211], v240 offset:55296
 s_waitcnt lgkmcnt(8)
 v_mfma_f32_32x32x16_bf16 v[0:15], v[192:195], a[0:3], v[0:15]
 ds_read_b64_tr_b16 v[212:213], v241 offset:53248
 ds_read_b64_tr_b16 v[214:215], v241 offset:55296
 s_waitcnt lgkmcnt(8)
 v_mfma_f32_32x32x16_bf16 v[16:31], v[196:199], a[0:3], v[16:31]
 ds_read_b64_tr_b16 v[192:193], v242 offset:53248
 ds_read_b64_tr_b16 v[194:195], v242 offset:55296
 s_waitcnt lgkmcnt(8)
 v_mfma_f32_32x32x16_bf16 v[32:47], v[200:203], a[0:3], v[32:47]
 ds_read_b64_tr_b16 v[196:197], v243 offset:53248
 ds_read_b64_tr_b16 v[198:199], v243 offset:55296
 s_waitcnt lgkmcnt(8)
 v_mfma_f32_32x32x16_bf16 v[48:63], v[204:207], a[0:3], v[48:63]
 ds_read_b64_tr_b16 v[200:201], v240 offset:57344
 ds_read_b64_tr_b16 v[202:203], v240 offset:59392
 s_waitcnt lgkmcnt(8)
 v_mfma_f32_32x32x16_bf16 v[0:15], v[208:211], a[4:7], v[0:15]
 ds_read_b64_tr_b16 v[204:205], v241 offset:57344
 ds_read_b64_tr_b16 v[206:207], v241 offset:59392
 s_waitcnt lgkmcnt(8)
 v_mfma_f32_32x32x16_bf16 v[16:31], v[212:215], a[4:7], v[16:31]
 ds_read_b64_tr_b16 v[208:209], v242 offset:57344
 ds_read_b64_tr_b16 v[210:211], v242 offset:59392
 s_waitcnt lgkmcnt(8)
 v_mfma_f32_32x32x16_bf16 v[32:47], v[192:195], a[4:7], v[32:47]
 ds_read_b64_tr_b16 v[212:213], v243 offset:57344
 ds_read_b64_tr_b16 v[214:215], v243 offset:59392
 s_waitcnt lgkmcnt(8)
 v_mfma_f32_32x32x16_bf16 v[48:63], v[196:199], a[4:7], v[48:63]
 ds_read_b64_tr_b16 v[192:193], v240 offset:61440
 ds_read_b64_tr_b16 v[194:195], v240 offset:63488
 s_waitcnt lgkmcnt(8)
 v_mfma_f32_32x32x16_bf16 v[0:15], v[200:203], a[8:11], v[0:15]
 ds_read_b64_tr_b16 v[196:197], v241 offset:61440
 ds_read_b64_tr_b16 v[198:199], v241 offset:63488
 s_waitcnt lgkmcnt(8)
 v_mfma_f32_32x32x16_bf16 v[16:31], v[204:207], a[8:11], v[16:31]
 ds_read_b64_tr_b16 v[200:201], v242 offset:61440
 ds_read_b64_tr_b16 v[202:203], v242 offset:63488
 s_waitcnt lgkmcnt(8)
 v_mfma_f32_32x32x16_bf16 v[32:47], v[208:211], a[8:11], v[32:47]
 ds_read_b64_tr_b16 v[204:205], v243 offset:61440
 ds_read_b64_tr_b16 v[206:207], v243 offset:63488
 s_waitcnt lgkmcnt(8)
 v_mfma_f32_32x32x16_bf16 v[48:63], v[212:215], a[8:11], v[48:63]
 ds_read_b64_tr_b16 v[208:209], v248 offset:0
 ds_read_b64_tr_b16 v[210:211], v248 offset:2048
 s_waitcnt lgkmcnt(8)
 v_mfma_f32_32x32x16_bf16 v[0:15], v[192:195], a[12:15], v[0:15]
 ds_read_b64_tr_b16 v[212:213], v249 offset:0
 ds_read_b64_tr_b16 v[214:215], v249 offset:2048
 s_waitcnt lgkmcnt(8)
 v_mfma_f32_32x32x16_bf16 v[16:31], v[196:199], a[12:15], v[16:31]
 ds_read_b64_tr_b16 v[192:193], v250 offset:0
 ds_read_b64_tr_b16 v[194:195], v250 offset:2048
 s_waitcnt lgkmcnt(8)
 v_mfma_f32_32x32x16_bf16 v[32:47], v[200:203], a[12:15], v[32:47]
 ds_read_b64_tr_b16 v[196:197], v251 offset:0
 ds_read_b64_tr_b16 v[198:199], v251 offset:2048
 s_waitcnt lgkmcnt(8)
 v_mfma_f32_32x32x16_bf16 v[48:63], v[204:207], a[12:15], v[48:63]
 ds_read_b64_tr_b16 v[200:201], v248 offset:4096
 ds_read_b64_tr_b16 v[202:203], v248 offset:6144
 s_waitcnt lgkmcnt(8)
 v_mfma_f32_32x32x16_bf16 v[0:15], v[208:211], a[16:19], v[0:15]
 ds_read_b64_tr_b16 v[204:205], v249 offset:4096
 ds_read_b64_tr_b16 v[206:207], v249 offset:6144
 s_waitcnt lgkmcnt(8)
 v_mfma_f32_32x32x16_bf16 v[16:31], v[212:215], a[16:19], v[16:31]
 ds_read_b64_tr_b16 v[208:209], v250 offset:4096
 ds_read_b64_tr_b16 v[210:211], v250 offset:6144
 s_waitcnt lgkmcnt(8)
 v_mfma_f32_32x32x16_bf16 v[32:47], v[192:195], a[16:19], v[32:47]
 ds_read_b64_tr_b16 v[212:213], v251 offset:4096
 ds_read_b64_tr_b16 v[214:215], v251 offset:6144
 s_waitcnt lgkmcnt(8)
 v_mfma_f32_32x32x16_bf16 v[48:63], v[196:199], a[16:19], v[48:63]
 ds_read_b64_tr_b16 v[192:193], v248 offset:8192
 ds_read_b64_tr_b16 v[194:195], v248 offset:10240
 s_waitcnt lgkmcnt(8)
 v_mfma_f32_32x32x16_bf16 v[0:15], v[200:203], a[20:23], v[0:15]
 ds_read_b64_tr_b16 v[196:197], v249 offset:8192
 ds_read_b64_tr_b16 v[198:199], v249 offset:10240
 s_waitcnt lgkmcnt(8)
 v_mfma_f32_32x32x16_bf16 v[16:31], v[204:207], a[20:23], v[16:31]
 ds_read_b64_tr_b16 v[200:201], v250 offset:8192
 ds_read_b64_tr_b16 v[202:203], v250 offset:10240
 s_waitcnt lgkmcnt(8)
 v_mfma_f32_32x32x16_bf16 v[32:47], v[208:211], a[20:23], v[32:47]
 ds_read_b64_tr_b16 v[204:205], v251 offset:8192
 ds_read_b64_tr_b16 v[206:207], v251 offset:10240
 s_waitcnt lgkmcnt(8)
 v_mfma_f32_32x32x16_bf16 v[48:63], v[212:215], a[20:23], v[48:63]
 s_waitcnt vmcnt(18)
 s_barrier
 ds_read_b64_tr_b16 v[208:209], v248 offset:12288
 ds_read_b64_tr_b16 v[210:211], v248 offset:14336
 s_waitcnt lgkmcnt(8)
 v_mfma_f32_32x32x16_bf16 v[0:15], v[192:195], a[24:27], v[0:15]
 ds_read_b64_tr_b16 v[212:213], v249 offset:12288
 ds_read_b64_tr_b16 v[214:215], v249 offset:14336
 s_waitcnt lgkmcnt(8)
 v_mfma_f32_32x32x16_bf16 v[16:31], v[196:199], a[24:27], v[16:31]
 ds_read_b64_tr_b16 v[192:193], v250 offset:12288
 ds_read_b64_tr_b16 v[194:195], v250 offset:14336
 s_waitcnt lgkmcnt(8)
 v_mfma_f32_32x32x16_bf16 v[32:47], v[200:203], a[24:27], v[32:47]
 ds_read_b64_tr_b16 v[196:197], v251 offset:12288
 ds_read_b64_tr_b16 v[198:199], v251 offset:14336
 s_waitcnt lgkmcnt(8)
 v_mfma_f32_32x32x16_bf16 v[48:63], v[204:207], a[24:27], v[48:63]
 ds_read_b64_tr_b16 v[200:201], v248 offset:16384
 ds_read_b64_tr_b16 v[202:203], v248 offset:18432
 s_waitcnt lgkmcnt(8)
 v_mfma_f32_32x32x16_bf16 v[0:15], v[208:211], a[28:31], v[0:15]
 ds_read_b64_tr_b16 v[204:205], v249 offset:16384
 ds_read_b64_tr_b16 v[206:207], v249 offset:18432
 s_waitcnt lgkmcnt(8)
 v_mfma_f32_32x32x16_bf16 v[16:31], v[212:215], a[28:31], v[16:31]
 ds_read_b64_tr_b16 v[208:209], v250 offset:16384
 ds_read_b64_tr_b16 v[210:211], v250 offset:18432
 s_waitcnt lgkmcnt(8)
 v_mfma_f32_32x32x16_bf16 v[32:47], v[192:195], a[28:31], v[32:47]
 ds_read_b64_tr_b16 v[212:213], v251 offset:16384
 ds_read_b64_tr_b16 v[214:215], v251 offset:18432
 s_waitcnt lgkmcnt(8)
 v_mfma_f32_32x32x16_bf16 v[48:63], v[196:199], a[28:31], v[48:63]
 ds_read_b64_tr_b16 v[192:193], v248 offset:20480
 ds_read_b64_tr_b16 v[194:195], v248 offset:22528
 s_waitcnt lgkmcnt(8)
 v_mfma_f32_32x32x16_bf16 v[0:15], v[200:203], a[32:35], v[0:15]
 ds_read_b64_tr_b16 v[196:197], v249 offset:20480
 ds_read_b64_tr_b16 v[198:199], v249 offset:22528
 s_waitcnt lgkmcnt(8)
 v_mfma_f32_32x32x16_bf16 v[16:31], v[204:207], a[32:35], v[16:31]
 ds_read_b64_tr_b16 v[200:201], v250 offset:20480
 ds_read_b64_tr_b16 v[202:203], v250 offset:22528
 s_waitcnt lgkmcnt(8)
 v_mfma_f32_32x32x16_bf16 v[32:47], v[208:211], a[32:35], v[32:47]
 ds_read_b64_tr_b16 v[204:205], v251 offset:20480
 ds_read_b64_tr_b16 v[206:207], v251 offset:22528
 s_waitcnt lgkmcnt(8)
 v_mfma_f32_32x32x16_bf16 v[48:63], v[212:215], a[32:35], v[48:63]
 ds_read_b64_tr_b16 v[208:209], v248 offset:24576
 ds_read_b64_tr_b16 v[210:211], v248 offset:26624
 s_waitcnt lgkmcnt(8)
 v_mfma_f32_32x32x16_bf16 v[0:15], v[192:195], a[36:39], v[0:15]
 ds_read_b64_tr_b16 v[212:213], v249 offset:24576
 ds_read_b64_tr_b16 v[214:215], v249 offset:26624
 s_waitcnt lgkmcnt(8)
 v_mfma_f32_32x32x16_bf16 v[16:31], v[196:199], a[36:39], v[16:31]
 ds_read_b64_tr_b16 v[192:193], v250 offset:24576
 ds_read_b64_tr_b16 v[194:195], v250 offset:26624
 s_waitcnt lgkmcnt(8)
 v_mfma_f32_32x32x16_bf16 v[32:47], v[200:203], a[36:39], v[32:47]
 ds_read_b64_tr_b16 v[196:197], v251 offset:24576
 ds_read_b64_tr_b16 v[198:199], v251 offset:26624
 s_waitcnt lgkmcnt(8)
 v_mfma_f32_32x32x16_bf16 v[48:63], v[204:207], a[36:39], v[48:63]
 ds_read_b64_tr_b16 v[200:201], v248 offset:28672
 ds_read_b64_tr_b16 v[202:203], v248 offset:30720
 s_waitcnt lgkmcnt(8)
 v_mfma_f32_32x32x16_bf16 v[0:15], v[208:211], a[40:43], v[0:15]
 ds_read_b64_tr_b16 v[204:205], v249 offset:28672
 ds_read_b64_tr_b16 v[206:207], v249 offset:30720
 s_waitcnt lgkmcnt(8)
 v_mfma_f32_32x32x16_bf16 v[16:31], v[212:215], a[40:43], v[16:31]
 ds_read_b64_tr_b16 v[208:209], v250 offset:28672
 ds_read_b64_tr_b16 v[210:211], v250 offset:30720
 s_waitcnt lgkmcnt(8)
 v_mfma_f32_32x32x16_bf16 v[32:47], v[192:195], a[40:43], v[32:47]
 ds_read_b64_tr_b16 v[212:213], v251 offset:28672
 ds_read_b64_tr_b16 v[214:215], v251 offset:30720
 s_waitcnt lgkmcnt(8)
 v_mfma_f32_32x32x16_bf16 v[48:63], v[196:199], a[40:43], v[48:63]
 ds_read_b64_tr_b16 v[192:193], v248 offset:32768
 ds_read_b64_tr_b16 v[194:195], v248 offset:34816
 s_waitcnt lgkmcnt(8)
 v_mfma_f32_32x32x16_bf16 v[0:15], v[200:203], a[44:47], v[0:15]
 ds_read_b64_tr_b16 v[196:197], v249 offset:32768
 ds_read_b64_tr_b16 v[198:199], v249 offset:34816
 s_waitcnt lgkmcnt(8)
 v_mfma_f32_32x32x16_bf16 v[16:31], v[204:207], a[44:47], v[16:31]
 ds_read_b64_tr_b16 v[200:201], v250 offset:32768
 ds_read_b64_tr_b16 v[202:203], v250 offset:34816
 s_waitcnt lgkmcnt(8)
 v_mfma_f32_32x32x16_bf16 v[32:47], v[208:211], a[44:47], v[32:47]
 ds_read_b64_tr_b16 v[204:205], v251 offset:32768
 ds_read_b64_tr_b16 v[206:207], v251 offset:34816
 s_waitcnt lgkmcnt(8)
 v_mfma_f32_32x32x16_bf16 v[48:63], v[212:215], a[44:47], v[48:63]
 s_waitcnt vmcnt(6)
 s_barrier
 ds_read_b64_tr_b16 v[208:209], v248 offset:36864
 ds_read_b64_tr_b16 v[210:211], v248 offset:38912
 s_waitcnt lgkmcnt(8)
 v_mfma_f32_32x32x16_bf16 v[0:15], v[192:195], a[48:51], v[0:15]
 ds_read_b64_tr_b16 v[212:213], v249 offset:36864
 ds_read_b64_tr_b16 v[214:215], v249 offset:38912
 s_waitcnt lgkmcnt(8)
 v_mfma_f32_32x32x16_bf16 v[16:31], v[196:199], a[48:51], v[16:31]
 ds_read_b64_tr_b16 v[192:193], v250 offset:36864
 ds_read_b64_tr_b16 v[194:195], v250 offset:38912
 s_waitcnt lgkmcnt(8)
 v_mfma_f32_32x32x16_bf16 v[32:47], v[200:203], a[48:51], v[32:47]
 ds_read_b64_tr_b16 v[196:197], v251 offset:36864
 ds_read_b64_tr_b16 v[198:199], v251 offset:38912
 s_waitcnt lgkmcnt(8)
 v_mfma_f32_32x32x16_bf16 v[48:63], v[204:207], a[48:51], v[48:63]
 ds_read_b64_tr_b16 v[200:201], v248 offset:40960
 ds_read_b64_tr_b16 v[202:203], v248 offset:43008
 s_waitcnt lgkmcnt(8)
 v_mfma_f32_32x32x16_bf16 v[0:15], v[208:211], a[52:55], v[0:15]
 ds_read_b64_tr_b16 v[204:205], v249 offset:40960
 ds_read_b64_tr_b16 v[206:207], v249 offset:43008
 s_waitcnt lgkmcnt(8)
 v_mfma_f32_32x32x16_bf16 v[16:31], v[212:215], a[52:55], v[16:31]
 ds_read_b64_tr_b16 v[208:209], v250 offset:40960
 ds_read_b64_tr_b16 v[210:211], v250 offset:43008
 s_waitcnt lgkmcnt(8)
 v_mfma_f32_32x32x16_bf16 v[32:47], v[192:195], a[52:55], v[32:47]
 ds_read_b64_tr_b16 v[212:213], v251 offset:40960
 ds_read_b64_tr_b16 v[214:215], v251 offset:43008
 s_waitcnt lgkmcnt(8)
 v_mfma_f32_32x32x16_bf16 v[48:63], v[196:199], a[52:55], v[48:63]
 ds_read_b64_tr_b16 v[192:193], v248 offset:45056
 ds_read_b64_tr_b16 v[194:195], v248 offset:47104
 s_waitcnt lgkmcnt(8)
 v_mfma_f32_32x32x16_bf16 v[0:15], v[200:203], a[56:59], v[0:15]
 ds_read_b64_tr_b16 v[196:197], v249 offset:45056
 ds_read_b64_tr_b16 v[198:199], v249 offset:47104
 s_waitcnt lgkmcnt(8)
 v_mfma_f32_32x32x16_bf16 v[16:31], v[204:207], a[56:59], v[16:31]
 ds_read_b64_tr_b16 v[200:201], v250 offset:45056
 ds_read_b64_tr_b16 v[202:203], v250 offset:47104
 s_waitcnt lgkmcnt(8)
 v_mfma_f32_32x32x16_bf16 v[32:47], v[208:211], a[56:59], v[32:47]
 ds_read_b64_tr_b16 v[204:205], v251 offset:45056
 ds_read_b64_tr_b16 v[206:207], v251 offset:47104
 s_waitcnt lgkmcnt(8)
 v_mfma_f32_32x32x16_bf16 v[48:63], v[212:215], a[56:59], v[48:63]
 ds_read_b64_tr_b16 v[208:209], v248 offset:49152
 ds_read_b64_tr_b16 v[210:211], v248 offset:51200
 s_waitcnt lgkmcnt(8)
 v_mfma_f32_32x32x16_bf16 v[0:15], v[192:195], a[60:63], v[0:15]
 ds_read_b64_tr_b16 v[212:213], v249 offset:49152
 ds_read_b64_tr_b16 v[214:215], v249 offset:51200
 s_waitcnt lgkmcnt(8)
 v_mfma_f32_32x32x16_bf16 v[16:31], v[196:199], a[60:63], v[16:31]
 ds_read_b64_tr_b16 v[192:193], v250 offset:49152
 ds_read_b64_tr_b16 v[194:195], v250 offset:51200
 s_waitcnt lgkmcnt(8)
 v_mfma_f32_32x32x16_bf16 v[32:47], v[200:203], a[60:63], v[32:47]
 ds_read_b64_tr_b16 v[196:197], v251 offset:49152
 ds_read_b64_tr_b16 v[198:199], v251 offset:51200
 s_waitcnt lgkmcnt(8)
 v_mfma_f32_32x32x16_bf16 v[48:63], v[204:207], a[60:63], v[48:63]
 ds_read_b64_tr_b16 v[200:201], v248 offset:53248
 ds_read_b64_tr_b16 v[202:203], v248 offset:55296
 s_waitcnt lgkmcnt(8)
 v_mfma_f32_32x32x16_bf16 v[0:15], v[208:211], a[64:67], v[0:15]
 ds_read_b64_tr_b16 v[204:205], v249 offset:53248
 ds_read_b64_tr_b16 v[206:207], v249 offset:55296
 s_waitcnt lgkmcnt(8)
 v_mfma_f32_32x32x16_bf16 v[16:31], v[212:215], a[64:67], v[16:31]
 ds_read_b64_tr_b16 v[208:209], v250 offset:53248
 ds_read_b64_tr_b16 v[210:211], v250 offset:55296
 s_waitcnt lgkmcnt(8)
 v_mfma_f32_32x32x16_bf16 v[32:47], v[192:195], a[64:67], v[32:47]
 ds_read_b64_tr_b16 v[212:213], v251 offset:53248
 ds_read_b64_tr_b16 v[214:215], v251 offset:55296
 s_waitcnt lgkmcnt(8)
 v_mfma_f32_32x32x16_bf16 v[48:63], v[196:199], a[64:67], v[48:63]
 ds_read_b64_tr_b16 v[192:193], v240 offset:0
 ds_read_b64_tr_b16 v[194:195], v240 offset:2048
 s_waitcnt lgkmcnt(8)
 v_mfma_f32_32x32x16_bf16 v[0:15], v[200:203], a[68:71], v[0:15]
 ds_read_b64_tr_b16 v[196:197], v241 offset:0
 ds_read_b64_tr_b16 v[198:199], v241 offset:2048
 s_waitcnt lgkmcnt(8)
 v_mfma_f32_32x32x16_bf16 v[16:31], v[204:207], a[68:71], v[16:31]
 ds_read_b64_tr_b16 v[200:201], v242 offset:0
 ds_read_b64_tr_b16 v[202:203], v242 offset:2048
 s_waitcnt lgkmcnt(8)
 v_mfma_f32_32x32x16_bf16 v[32:47], v[208:211], a[68:71], v[32:47]
 ds_read_b64_tr_b16 v[204:205], v243 offset:0
 ds_read_b64_tr_b16 v[206:207], v243 offset:2048
 s_waitcnt lgkmcnt(8)
 v_mfma_f32_32x32x16_bf16 v[48:63], v[212:215], a[68:71], v[48:63]
 s_barrier
 ds_read_b64_tr_b16 v[208:209], v240 offset:4096
 ds_read_b64_tr_b16 v[210:211], v240 offset:6144
 s_waitcnt vmcnt(0)
 s_waitcnt lgkmcnt(8)
 v_mfma_f32_32x32x16_bf16 v[0:15], v[192:195], a[72:75], v[0:15]
 ds_read_b64_tr_b16 v[212:213], v241 offset:4096
 ds_read_b64_tr_b16 v[214:215], v241 offset:6144
 s_waitcnt lgkmcnt(8)
 v_mfma_f32_32x32x16_bf16 v[16:31], v[196:199], a[72:75], v[16:31]
 ds_read_b64_tr_b16 v[192:193], v242 offset:4096
 ds_read_b64_tr_b16 v[194:195], v242 offset:6144
 s_waitcnt lgkmcnt(8)
 v_mfma_f32_32x32x16_bf16 v[32:47], v[200:203], a[72:75], v[32:47]
 ds_read_b64_tr_b16 v[196:197], v243 offset:4096
 ds_read_b64_tr_b16 v[198:199], v243 offset:6144
 s_waitcnt lgkmcnt(8)
 v_mfma_f32_32x32x16_bf16 v[48:63], v[204:207], a[72:75], v[48:63]
 ds_read_b64_tr_b16 v[200:201], v240 offset:8192
 ds_read_b64_tr_b16 v[202:203], v240 offset:10240
 s_waitcnt lgkmcnt(8)
 v_mfma_f32_32x32x16_bf16 v[0:15], v[208:211], a[76:79], v[0:15]
 ds_read_b64_tr_b16 v[204:205], v241 offset:8192
 ds_read_b64_tr_b16 v[206:207], v241 offset:10240
 s_waitcnt lgkmcnt(8)
 v_mfma_f32_32x32x16_bf16 v[16:31], v[212:215], a[76:79], v[16:31]
 ds_read_b64_tr_b16 v[208:209], v242 offset:8192
 ds_read_b64_tr_b16 v[210:211], v242 offset:10240
 s_waitcnt lgkmcnt(8)
 v_mfma_f32_32x32x16_bf16 v[32:47], v[192:195], a[76:79], v[32:47]
 ds_read_b64_tr_b16 v[212:213], v243 offset:8192
 ds_read_b64_tr_b16 v[214:215], v243 offset:10240
 s_waitcnt lgkmcnt(8)
 v_mfma_f32_32x32x16_bf16 v[48:63], v[196:199], a[76:79], v[48:63]
 ds_read_b64_tr_b16 v[192:193], v240 offset:12288
 ds_read_b64_tr_b16 v[194:195], v240 offset:14336
 s_waitcnt lgkmcnt(8)
 v_mfma_f32_32x32x16_bf16 v[0:15], v[200:203], a[80:83], v[0:15]
 ds_read_b64_tr_b16 v[196:197], v241 offset:12288
 ds_read_b64_tr_b16 v[198:199], v241 offset:14336
 s_waitcnt lgkmcnt(8)
 v_mfma_f32_32x32x16_bf16 v[16:31], v[204:207], a[80:83], v[16:31]
 ds_read_b64_tr_b16 v[200:201], v242 offset:12288
 ds_read_b64_tr_b16 v[202:203], v242 offset:14336
 s_waitcnt lgkmcnt(8)
 v_mfma_f32_32x32x16_bf16 v[32:47], v[208:211], a[80:83], v[32:47]
 ds_read_b64_tr_b16 v[204:205], v243 offset:12288
 ds_read_b64_tr_b16 v[206:207], v243 offset:14336
 s_waitcnt lgkmcnt(8)
 v_mfma_f32_32x32x16_bf16 v[48:63], v[212:215], a[80:83], v[48:63]
 ds_read_b64_tr_b16 v[208:209], v240 offset:16384
 ds_read_b64_tr_b16 v[210:211], v240 offset:18432
 s_waitcnt lgkmcnt(8)
 v_mfma_f32_32x32x16_bf16 v[0:15], v[192:195], a[84:87], v[0:15]
 ds_read_b64_tr_b16 v[212:213], v241 offset:16384
 ds_read_b64_tr_b16 v[214:215], v241 offset:18432
 s_waitcnt lgkmcnt(8)
 v_mfma_f32_32x32x16_bf16 v[16:31], v[196:199], a[84:87], v[16:31]
 ds_read_b64_tr_b16 v[192:193], v242 offset:16384
 ds_read_b64_tr_b16 v[194:195], v242 offset:18432
 s_waitcnt lgkmcnt(8)
 v_mfma_f32_32x32x16_bf16 v[32:47], v[200:203], a[84:87], v[32:47]
 ds_read_b64_tr_b16 v[196:197], v243 offset:16384
 ds_read_b64_tr_b16 v[198:199], v243 offset:18432
 s_waitcnt lgkmcnt(8)
 v_mfma_f32_32x32x16_bf16 v[48:63], v[204:207], a[84:87], v[48:63]
 ds_read_b64_tr_b16 v[200:201], v240 offset:20480
 ds_read_b64_tr_b16 v[202:203], v240 offset:22528
 s_waitcnt lgkmcnt(8)
 v_mfma_f32_32x32x16_bf16 v[0:15], v[208:211], a[88:91], v[0:15]
 ds_read_b64_tr_b16 v[204:205], v241 offset:20480
 ds_read_b64_tr_b16 v[206:207], v241 offset:22528
 s_waitcnt lgkmcnt(8)
 v_mfma_f32_32x32x16_bf16 v[16:31], v[212:215], a[88:91], v[16:31]
 ds_read_b64_tr_b16 v[208:209], v242 offset:20480
 ds_read_b64_tr_b16 v[210:211], v242 offset:22528
 s_waitcnt lgkmcnt(8)
 v_mfma_f32_32x32x16_bf16 v[32:47], v[192:195], a[88:91], v[32:47]
 ds_read_b64_tr_b16 v[212:213], v243 offset:20480
 ds_read_b64_tr_b16 v[214:215], v243 offset:22528
 s_waitcnt lgkmcnt(8)
 v_mfma_f32_32x32x16_bf16 v[48:63], v[196:199], a[88:91], v[48:63]
 s_waitcnt lgkmcnt(6)
 v_mfma_f32_32x32x16_bf16 v[0:15], v[200:203], a[92:95], v[0:15]
 s_waitcnt lgkmcnt(4)
 v_mfma_f32_32x32x16_bf16 v[16:31], v[204:207], a[92:95], v[16:31]
 s_waitcnt lgkmcnt(2)
 v_mfma_f32_32x32x16_bf16 v[32:47], v[208:211], a[92:95], v[32:47]
 s_waitcnt lgkmcnt(0)
 v_mfma_f32_32x32x16_bf16 v[48:63], v[212:215], a[92:95], v[48:63]
 s_mul_i32 s53, s53, 81920
 s_lshl_b32 s28, s51, 14
 s_add_u32 s53, s53, s28
 s_add_u32 s53, s53, 7340032
 s_nop 15
 v_lshlrev_b32 v96, 16, v64
 v_and_b32 v97, 0xffff0000, v64
 v_lshlrev_b32 v98, 16, v65
 v_and_b32 v99, 0xffff0000, v65
 v_pk_add_f32 v[0:1], v[0:1], v[96:97]
 v_pk_add_f32 v[2:3], v[2:3], v[98:99]
 buffer_store_dwordx4 v[0:3], v232, s[8:11], s53 offen offset:0 sc1
 v_lshlrev_b32 v96, 16, v66
 v_and_b32 v97, 0xffff0000, v66
 v_lshlrev_b32 v98, 16, v67
 v_and_b32 v99, 0xffff0000, v67
 v_pk_add_f32 v[4:5], v[4:5], v[96:97]
 v_pk_add_f32 v[6:7], v[6:7], v[98:99]
 buffer_store_dwordx4 v[4:7], v232, s[8:11], s53 offen offset:1024 sc1
 v_lshlrev_b32 v96, 16, v68
 v_and_b32 v97, 0xffff0000, v68
 v_lshlrev_b32 v98, 16, v69
 v_and_b32 v99, 0xffff0000, v69
 v_pk_add_f32 v[8:9], v[8:9], v[96:97]
 v_pk_add_f32 v[10:11], v[10:11], v[98:99]
 buffer_store_dwordx4 v[8:11], v232, s[8:11], s53 offen offset:2048 sc1
 v_lshlrev_b32 v96, 16, v70
 v_and_b32 v97, 0xffff0000, v70
 v_lshlrev_b32 v98, 16, v71
 v_and_b32 v99, 0xffff0000, v71
 v_pk_add_f32 v[12:13], v[12:13], v[96:97]
 v_pk_add_f32 v[14:15], v[14:15], v[98:99]
 buffer_store_dwordx4 v[12:15], v232, s[8:11], s53 offen offset:3072 sc1
 s_add_u32 s53, s53, 4096
 v_lshlrev_b32 v96, 16, v72
 v_and_b32 v97, 0xffff0000, v72
 v_lshlrev_b32 v98, 16, v73
 v_and_b32 v99, 0xffff0000, v73
 v_pk_add_f32 v[16:17], v[16:17], v[96:97]
 v_pk_add_f32 v[18:19], v[18:19], v[98:99]
 buffer_store_dwordx4 v[16:19], v232, s[8:11], s53 offen offset:0 sc1
 v_lshlrev_b32 v96, 16, v74
 v_and_b32 v97, 0xffff0000, v74
 v_lshlrev_b32 v98, 16, v75
 v_and_b32 v99, 0xffff0000, v75
 v_pk_add_f32 v[20:21], v[20:21], v[96:97]
 v_pk_add_f32 v[22:23], v[22:23], v[98:99]
 buffer_store_dwordx4 v[20:23], v232, s[8:11], s53 offen offset:1024 sc1
 v_lshlrev_b32 v96, 16, v76
 v_and_b32 v97, 0xffff0000, v76
 v_lshlrev_b32 v98, 16, v77
 v_and_b32 v99, 0xffff0000, v77
 v_pk_add_f32 v[24:25], v[24:25], v[96:97]
 v_pk_add_f32 v[26:27], v[26:27], v[98:99]
 buffer_store_dwordx4 v[24:27], v232, s[8:11], s53 offen offset:2048 sc1
 v_lshlrev_b32 v96, 16, v78
 v_and_b32 v97, 0xffff0000, v78
 v_lshlrev_b32 v98, 16, v79
 v_and_b32 v99, 0xffff0000, v79
 v_pk_add_f32 v[28:29], v[28:29], v[96:97]
 v_pk_add_f32 v[30:31], v[30:31], v[98:99]
 buffer_store_dwordx4 v[28:31], v232, s[8:11], s53 offen offset:3072 sc1
 s_add_u32 s53, s53, 4096
 v_lshlrev_b32 v96, 16, v80
 v_and_b32 v97, 0xffff0000, v80
 v_lshlrev_b32 v98, 16, v81
 v_and_b32 v99, 0xffff0000, v81
 v_pk_add_f32 v[32:33], v[32:33], v[96:97]
 v_pk_add_f32 v[34:35], v[34:35], v[98:99]
 buffer_store_dwordx4 v[32:35], v232, s[8:11], s53 offen offset:0 sc1
 v_lshlrev_b32 v96, 16, v82
 v_and_b32 v97, 0xffff0000, v82
 v_lshlrev_b32 v98, 16, v83
 v_and_b32 v99, 0xffff0000, v83
 v_pk_add_f32 v[36:37], v[36:37], v[96:97]
 v_pk_add_f32 v[38:39], v[38:39], v[98:99]
 buffer_store_dwordx4 v[36:39], v232, s[8:11], s53 offen offset:1024 sc1
 v_lshlrev_b32 v96, 16, v84
 v_and_b32 v97, 0xffff0000, v84
 v_lshlrev_b32 v98, 16, v85
 v_and_b32 v99, 0xffff0000, v85
 v_pk_add_f32 v[40:41], v[40:41], v[96:97]
 v_pk_add_f32 v[42:43], v[42:43], v[98:99]
 buffer_store_dwordx4 v[40:43], v232, s[8:11], s53 offen offset:2048 sc1
 v_lshlrev_b32 v96, 16, v86
 v_and_b32 v97, 0xffff0000, v86
 v_lshlrev_b32 v98, 16, v87
 v_and_b32 v99, 0xffff0000, v87
 v_pk_add_f32 v[44:45], v[44:45], v[96:97]
 v_pk_add_f32 v[46:47], v[46:47], v[98:99]
 buffer_store_dwordx4 v[44:47], v232, s[8:11], s53 offen offset:3072 sc1
 s_add_u32 s53, s53, 4096
 v_lshlrev_b32 v96, 16, v88
 v_and_b32 v97, 0xffff0000, v88
 v_lshlrev_b32 v98, 16, v89
 v_and_b32 v99, 0xffff0000, v89
 v_pk_add_f32 v[48:49], v[48:49], v[96:97]
 v_pk_add_f32 v[50:51], v[50:51], v[98:99]
 buffer_store_dwordx4 v[48:51], v232, s[8:11], s53 offen offset:0 sc1
 v_lshlrev_b32 v96, 16, v90
 v_and_b32 v97, 0xffff0000, v90
 v_lshlrev_b32 v98, 16, v91
 v_and_b32 v99, 0xffff0000, v91
 v_pk_add_f32 v[52:53], v[52:53], v[96:97]
 v_pk_add_f32 v[54:55], v[54:55], v[98:99]
 buffer_store_dwordx4 v[52:55], v232, s[8:11], s53 offen offset:1024 sc1
 v_lshlrev_b32 v96, 16, v92
 v_and_b32 v97, 0xffff0000, v92
 v_lshlrev_b32 v98, 16, v93
 v_and_b32 v99, 0xffff0000, v93
 v_pk_add_f32 v[56:57], v[56:57], v[96:97]
 v_pk_add_f32 v[58:59], v[58:59], v[98:99]
 buffer_store_dwordx4 v[56:59], v232, s[8:11], s53 offen offset:2048 sc1
 v_lshlrev_b32 v96, 16, v94
 v_and_b32 v97, 0xffff0000, v94
 v_lshlrev_b32 v98, 16, v95
 v_and_b32 v99, 0xffff0000, v95
 v_pk_add_f32 v[60:61], v[60:61], v[96:97]
 v_pk_add_f32 v[62:63], v[62:63], v[98:99]
 buffer_store_dwordx4 v[60:63], v232, s[8:11], s53 offen offset:3072 sc1
 s_add_u32 s53, s53, 4096
 s_mul_i32 s28, s50, 5
 s_add_u32 s28, s28, s51
 s_lshl_b32 s28, s28, 2
 s_add_u32 s28, s28, 6336512
 s_waitcnt vmcnt(0)
 s_barrier
 s_cmp_eq_u32 s14, 0
 s_cbranch_scc0 sg_55
 s_mov_b64 exec, 1
 v_mov_b32 v233, 0
 v_mov_b32 v234, 1
 buffer_atomic_add v234, v233, s[8:11], s28 offen sc1
 s_mov_b64 exec, -1
sg_55:
 s_branch wk_next
wk_n3:
 s_cmp_ge_u32 s18, 1152
 s_cbranch_scc0 wk_n2
 s_sub_u32 s28, s18, 1152
 s_lshr_b32 s51, s28, 4
 s_and_b32 s50, s28, 15
 v_accvgpr_read_b32 v240, a202
 v_accvgpr_read_b32 v236, a218
 v_accvgpr_read_b32 v237, a219
 v_accvgpr_read_b32 v238, a220
 v_add_u32 v248, 0x10000, v240
 s_mul_i32 s52, s51, 192
 s_lshl_b32 s48, s50, 2
 s_add_u32 s48, s48, s14
 s_mul_i32 s48, s48, 40960
 s_add_u32 m0, s19, 0
 s_add_u32 s29, s52, 0
 buffer_load_dwordx4 v236, s[40:43], s29 offen lds
 s_add_u32 m0, s19, 1024
 s_add_u32 s29, s52, 0
 buffer_load_dwordx4 v237, s[40:43], s29 offen lds
 s_add_u32 m0, s19, 2048
 s_add_u32 s29, s52, 0
 buffer_load_dwordx4 v238, s[40:43], s29 offen lds
 s_add_u32 m0, s19, 3072
 s_add_u32 s29, s52, 49152
 buffer_load_dwordx4 v236, s[40:43], s29 offen lds
 s_add_u32 m0, s19, 4096
 s_add_u32 s29, s52, 49152
 buffer_load_dwordx4 v237, s[40:43], s29 offen lds
 s_add_u32 m0, s19, 5120
 s_add_u32 s29, s52, 49152
 buffer_load_dwordx4 v238, s[40:43], s29 offen lds
 buffer_load_dwordx4 a[0:3], v232, s[8:11], s48 offen offset:0
 buffer_load_dwordx4 a[4:7], v232, s[8:11], s48 offen offset:1024
 buffer_load_dwordx4 a[8:11], v232, s[8:11], s48 offen offset:2048
 buffer_load_dwordx4 a[12:15], v232, s[8:11], s48 offen offset:3072
 s_add_u32 s48, s48, 4096
 s_add_u32 m0, s19, 24576
 s_add_u32 s29, s52, 196608
 buffer_load_dwordx4 v236, s[40:43], s29 offen lds
 s_add_u32 m0, s19, 25600
 s_add_u32 s29, s52, 196608
 buffer_load_dwordx4 v237, s[40:43], s29 offen lds
 s_add_u32 m0, s19, 26624
 s_add_u32 s29, s52, 196608
 buffer_load_dwordx4 v238, s[40:43], s29 offen lds
 s_add_u32 m0, s19, 27648
 s_add_u32 s29, s52, 245760
 buffer_load_dwordx4 v236, s[40:43], s29 offen lds
 s_add_u32 m0, s19, 28672
 s_add_u32 s29, s52, 245760
 buffer_load_dwordx4 v237, s[40:43], s29 offen lds
 s_add_u32 m0, s19, 29696
 s_add_u32 s29, s52, 245760
 buffer_load_dwordx4 v238, s[40:43], s29 offen lds
 buffer_load_dwordx4 a[16:19], v232, s[8:11], s48 offen offset:0
 buffer_load_dwordx4 a[20:23], v232, s[8:11], s48 offen offset:1024
 buffer_load_dwordx4 a[24:27], v232, s[8:11], s48 offen offset:2048
 buffer_load_dwordx4 a[28:31], v232, s[8:11], s48 offen offset:3072
 s_add_u32 s48, s48, 4096
 s_add_u32 m0, s19, 49152
 s_add_u32 s29, s52, 393216
 buffer_load_dwordx4 v236, s[40:43], s29 offen lds
 s_add_u32 m0, s19, 50176
 s_add_u32 s29, s52, 393216
 buffer_load_dwordx4 v237, s[40:43], s29 offen lds
 s_add_u32 m0, s19, 51200
 s_add_u32 s29, s52, 393216
 buffer_load_dwordx4 v238, s[40:43], s29 offen lds
 s_add_u32 m0, s19, 52224
 s_add_u32 s29, s52, 442368
 buffer_load_dwordx4 v236, s[40:43], s29 offen lds
 s_add_u32 m0, s19, 53248
 s_add_u32 s29, s52, 442368
 buffer_load_dwordx4 v237, s[40:43], s29 offen lds
 s_add_u32 m0, s19, 54272
 s_add_u32 s29, s52, 442368
 buffer_load_dwordx4 v238, s[40:43], s29 offen lds
 buffer_load_dwordx4 a[32:35], v232, s[8:11], s48 offen offset:0
 buffer_load_dwordx4 a[36:39], v232, s[8:11], s48 offen offset:1024
 buffer_load_dwordx4 a[40:43], v232, s[8:11], s48 offen offset:2048
 buffer_load_dwordx4 a[44:47], v232, s[8:11], s48 offen offset:3072
 s_add_u32 s48, s48, 4096
 s_add_u32 m0, s19, 73728
 s_add_u32 s29, s52, 589824
 buffer_load_dwordx4 v236, s[40:43], s29 offen lds
 s_add_u32 m0, s19, 74752
 s_add_u32 s29, s52, 589824
 buffer_load_dwordx4 v237, s[40:43], s29 offen lds
 s_add_u32 m0, s19, 75776
 s_add_u32 s29, s52, 589824
 buffer_load_dwordx4 v238, s[40:43], s29 offen lds
 s_add_u32 m0, s19, 76800
 s_add_u32 s29, s52, 638976
 buffer_load_dwordx4 v236, s[40:43], s29 offen lds
 s_add_u32 m0, s19, 77824
 s_add_u32 s29, s52, 638976
 buffer_load_dwordx4 v237, s[40:43], s29 offen lds
 s_add_u32 m0, s19, 78848
 s_add_u32 s29, s52, 638976
 buffer_load_dwordx4 v238, s[40:43], s29 offen lds
 buffer_load_dwordx4 a[48:51], v232, s[8:11], s48 offen offset:0
 buffer_load_dwordx4 a[52:55], v232, s[8:11], s48 offen offset:1024
 buffer_load_dwordx4 a[56:59], v232, s[8:11], s48 offen offset:2048
 buffer_load_dwordx4 a[60:63], v232, s[8:11], s48 offen offset:3072
 s_add_u32 s48, s48, 4096
 s_waitcnt vmcnt(34)
 s_waitcnt vmcnt(24)
 s_barrier
 ds_read_b64_tr_b16 v[192:193], v240 offset:0
 ds_read_b64_tr_b16 v[194:195], v240 offset:768
 ds_read_b64_tr_b16 v[196:197], v240 offset:64
 ds_read_b64_tr_b16 v[198:199], v240 offset:832
 ds_read_b64_tr_b16 v[200:201], v240 offset:128
 ds_read_b64_tr_b16 v[202:203], v240 offset:896
 ds_read_b64_tr_b16 v[204:205], v240 offset:12288
 ds_read_b64_tr_b16 v[206:207], v240 offset:13056
 ds_read_b64_tr_b16 v[208:209], v240 offset:12352
 ds_read_b64_tr_b16 v[210:211], v240 offset:13120
 s_waitcnt lgkmcnt(8)
 v_mfma_f32_32x32x16_bf16 v[0:15], v[192:195], a[0:3], 0
 ds_read_b64_tr_b16 v[212:213], v240 offset:12416
 ds_read_b64_tr_b16 v[214:215], v240 offset:13184
 s_waitcnt lgkmcnt(8)
 v_mfma_f32_32x32x16_bf16 v[16:31], v[196:199], a[0:3], 0
 s_add_u32 m0, s19, 98304
 s_add_u32 s29, s52, 786432
 buffer_load_dwordx4 v236, s[40:43], s29 offen lds
 s_add_u32 m0, s19, 99328
 s_add_u32 s29, s52, 786432
 buffer_load_dwordx4 v237, s[40:43], s29 offen lds
 s_add_u32 m0, s19, 100352
 s_add_u32 s29, s52, 786432
 buffer_load_dwordx4 v238, s[40:43], s29 offen lds
 s_add_u32 m0, s19, 101376
 s_add_u32 s29, s52, 835584
 buffer_load_dwordx4 v236, s[40:43], s29 offen lds
 s_add_u32 m0, s19, 102400
 s_add_u32 s29, s52, 835584
 buffer_load_dwordx4 v237, s[40:43], s29 offen lds
 s_add_u32 m0, s19, 103424
 s_add_u32 s29, s52, 835584
 buffer_load_dwordx4 v238, s[40:43], s29 offen lds
 ds_read_b64_tr_b16 v[192:193], v240 offset:3072
 ds_read_b64_tr_b16 v[194:195], v240 offset:3840
 s_waitcnt lgkmcnt(8)
 v_mfma_f32_32x32x16_bf16 v[32:47], v[200:203], a[0:3], 0
 ds_read_b64_tr_b16 v[196:197], v240 offset:3136
 ds_read_b64_tr_b16 v[198:199], v240 offset:3904
 s_waitcnt lgkmcnt(8)
 v_mfma_f32_32x32x16_bf16 v[48:63], v[204:207], a[0:3], 0
 ds_read_b64_tr_b16 v[200:201], v240 offset:3200
 ds_read_b64_tr_b16 v[202:203], v240 offset:3968
 s_waitcnt lgkmcnt(8)
 v_mfma_f32_32x32x16_bf16 v[64:79], v[208:211], a[0:3], 0
 ds_read_b64_tr_b16 v[204:205], v240 offset:15360
 ds_read_b64_tr_b16 v[206:207], v240 offset:16128
 s_waitcnt lgkmcnt(8)
 v_mfma_f32_32x32x16_bf16 v[80:95], v[212:215], a[0:3], 0
 ds_read_b64_tr_b16 v[208:209], v240 offset:15424
 ds_read_b64_tr_b16 v[210:211], v240 offset:16192
 s_waitcnt lgkmcnt(8)
 v_mfma_f32_32x32x16_bf16 v[0:15], v[192:195], a[4:7], v[0:15]
 ds_read_b64_tr_b16 v[212:213], v240 offset:15488
 ds_read_b64_tr_b16 v[214:215], v240 offset:16256
 s_waitcnt lgkmcnt(8)
 v_mfma_f32_32x32x16_bf16 v[16:31], v[196:199], a[4:7], v[16:31]
 ds_read_b64_tr_b16 v[192:193], v240 offset:6144
 ds_read_b64_tr_b16 v[194:195], v240 offset:6912
 s_waitcnt lgkmcnt(8)
 v_mfma_f32_32x32x16_bf16 v[32:47], v[200:203], a[4:7], v[32:47]
 buffer_load_dwordx4 a[64:67], v232, s[8:11], s48 offen offset:0
 buffer_load_dwordx4 a[68:71], v232, s[8:11], s48 offen offset:1024
 buffer_load_dwordx4 a[72:75], v232, s[8:11], s48 offen offset:2048
 buffer_load_dwordx4 a[76:79], v232, s[8:11], s48 offen offset:3072
 s_add_u32 s48, s48, 4096
 ds_read_b64_tr_b16 v[196:197], v240 offset:6208
 ds_read_b64_tr_b16 v[198:199], v240 offset:6976
 s_waitcnt lgkmcnt(8)
 v_mfma_f32_32x32x16_bf16 v[48:63], v[204:207], a[4:7], v[48:63]
 ds_read_b64_tr_b16 v[200:201], v240 offset:6272
 ds_read_b64_tr_b16 v[202:203], v240 offset:7040
 s_waitcnt lgkmcnt(8)
 v_mfma_f32_32x32x16_bf16 v[64:79], v[208:211], a[4:7], v[64:79]
 ds_read_b64_tr_b16 v[204:205], v240 offset:18432
 ds_read_b64_tr_b16 v[206:207], v240 offset:19200
 s_waitcnt lgkmcnt(8)
 v_mfma_f32_32x32x16_bf16 v[80:95], v[212:215], a[4:7], v[80:95]
 ds_read_b64_tr_b16 v[208:209], v240 offset:18496
 ds_read_b64_tr_b16 v[210:211], v240 offset:19264
 s_waitcnt lgkmcnt(8)
 v_mfma_f32_32x32x16_bf16 v[0:15], v[192:195], a[8:11], v[0:15]
 ds_read_b64_tr_b16 v[212:213], v240 offset:18560
 ds_read_b64_tr_b16 v[214:215], v240 offset:19328
 s_waitcnt lgkmcnt(8)
 v_mfma_f32_32x32x16_bf16 v[16:31], v[196:199], a[8:11], v[16:31]
 ds_read_b64_tr_b16 v[192:193], v240 offset:9216
 ds_read_b64_tr_b16 v[194:195], v240 offset:9984
 s_waitcnt lgkmcnt(8)
 v_mfma_f32_32x32x16_bf16 v[32:47], v[200:203], a[8:11], v[32:47]
 ds_read_b64_tr_b16 v[196:197], v240 offset:9280
 ds_read_b64_tr_b16 v[198:199], v240 offset:10048
 s_waitcnt lgkmcnt(8)
 v_mfma_f32_32x32x16_bf16 v[48:63], v[204:207], a[8:11], v[48:63]
 ds_read_b64_tr_b16 v[200:201], v240 offset:9344
 ds_read_b64_tr_b16 v[202:203], v240 offset:10112
 s_waitcnt lgkmcnt(8)
 v_mfma_f32_32x32x16_bf16 v[64:79], v[208:211], a[8:11], v[64:79]
 ds_read_b64_tr_b16 v[204:205], v240 offset:21504
 ds_read_b64_tr_b16 v[206:207], v240 offset:22272
 s_waitcnt lgkmcnt(8)
 v_mfma_f32_32x32x16_bf16 v[80:95], v[212:215], a[8:11], v[80:95]
 ds_read_b64_tr_b16 v[208:209], v240 offset:21568
 ds_read_b64_tr_b16 v[210:211], v240 offset:22336
 s_waitcnt lgkmcnt(8)
 v_mfma_f32_32x32x16_bf16 v[0:15], v[192:195], a[12:15], v[0:15]
 ds_read_b64_tr_b16 v[212:213], v240 offset:21632
 ds_read_b64_tr_b16 v[214:215], v240 offset:22400
 s_waitcnt lgkmcnt(8)
 v_mfma_f32_32x32x16_bf16 v[16:31], v[196:199], a[12:15], v[16:31]
 ds_read_b64_tr_b16 v[192:193], v240 offset:24576
 ds_read_b64_tr_b16 v[194:195], v240 offset:25344
 s_waitcnt lgkmcnt(8)
 v_mfma_f32_32x32x16_bf16 v[32:47], v[200:203], a[12:15], v[32:47]
 ds_read_b64_tr_b16 v[196:197], v240 offset:24640
 ds_read_b64_tr_b16 v[198:199], v240 offset:25408
 s_waitcnt lgkmcnt(8)
 v_mfma_f32_32x32x16_bf16 v[48:63], v[204:207], a[12:15], v[48:63]
 ds_read_b64_tr_b16 v[200:201], v240 offset:24704
 ds_read_b64_tr_b16 v[202:203], v240 offset:25472
 s_waitcnt lgkmcnt(8)
 v_mfma_f32_32x32x16_bf16 v[64:79], v[208:211], a[12:15], v[64:79]
 ds_read_b64_tr_b16 v[204:205], v240 offset:36864
 ds_read_b64_tr_b16 v[206:207], v240 offset:37632
 s_waitcnt lgkmcnt(8)
 v_mfma_f32_32x32x16_bf16 v[80:95], v[212:215], a[12:15], v[80:95]
 s_waitcnt vmcnt(24)
 s_barrier
 ds_read_b64_tr_b16 v[208:209], v240 offset:36928
 ds_read_b64_tr_b16 v[210:211], v240 offset:37696
 s_waitcnt lgkmcnt(8)
 v_mfma_f32_32x32x16_bf16 v[0:15], v[192:195], a[16:19], v[0:15]
 ds_read_b64_tr_b16 v[212:213], v240 offset:36992
 ds_read_b64_tr_b16 v[214:215], v240 offset:37760
 s_waitcnt lgkmcnt(8)
 v_mfma_f32_32x32x16_bf16 v[16:31], v[196:199], a[16:19], v[16:31]
 s_add_u32 m0, s19, 0
 s_add_u32 s29, s52, 983040
 buffer_load_dwordx4 v236, s[40:43], s29 offen lds
 s_add_u32 m0, s19, 1024
 s_add_u32 s29, s52, 983040
 buffer_load_dwordx4 v237, s[40:43], s29 offen lds
 s_add_u32 m0, s19, 2048
 s_add_u32 s29, s52, 983040
 buffer_load_dwordx4 v238, s[40:43], s29 offen lds
 s_add_u32 m0, s19, 3072
 s_add_u32 s29, s52, 1032192
 buffer_load_dwordx4 v236, s[40:43], s29 offen lds
 s_add_u32 m0, s19, 4096
 s_add_u32 s29, s52, 1032192
 buffer_load_dwordx4 v237, s[40:43], s29 offen lds
 s_add_u32 m0, s19, 5120
 s_add_u32 s29, s52, 1032192
 buffer_load_dwordx4 v238, s[40:43], s29 offen lds
 ds_read_b64_tr_b16 v[192:193], v240 offset:27648
 ds_read_b64_tr_b16 v[194:195], v240 offset:28416
 s_waitcnt lgkmcnt(8)
 v_mfma_f32_32x32x16_bf16 v[32:47], v[200:203], a[16:19], v[32:47]
 ds_read_b64_tr_b16 v[196:197], v240 offset:27712
 ds_read_b64_tr_b16 v[198:199], v240 offset:28480
 s_waitcnt lgkmcnt(8)
 v_mfma_f32_32x32x16_bf16 v[48:63], v[204:207], a[16:19], v[48:63]
 ds_read_b64_tr_b16 v[200:201], v240 offset:27776
 ds_read_b64_tr_b16 v[202:203], v240 offset:28544
 s_waitcnt lgkmcnt(8)
 v_mfma_f32_32x32x16_bf16 v[64:79], v[208:211], a[16:19], v[64:79]
 ds_read_b64_tr_b16 v[204:205], v240 offset:39936
 ds_read_b64_tr_b16 v[206:207], v240 offset:40704
 s_waitcnt lgkmcnt(8)
 v_mfma_f32_32x32x16_bf16 v[80:95], v[212:215], a[16:19], v[80:95]
 ds_read_b64_tr_b16 v[208:209], v240 offset:40000
 ds_read_b64_tr_b16 v[210:211], v240 offset:40768
 s_waitcnt lgkmcnt(8)
 v_mfma_f32_32x32x16_bf16 v[0:15], v[192:195], a[20:23], v[0:15]
 ds_read_b64_tr_b16 v[212:213], v240 offset:40064
 ds_read_b64_tr_b16 v[214:215], v240 offset:40832
 s_waitcnt lgkmcnt(8)
 v_mfma_f32_32x32x16_bf16 v[16:31], v[196:199], a[20:23], v[16:31]
 ds_read_b64_tr_b16 v[192:193], v240 offset:30720
 ds_read_b64_tr_b16 v[194:195], v240 offset:31488
 s_waitcnt lgkmcnt(8)
 v_mfma_f32_32x32x16_bf16 v[32:47], v[200:203], a[20:23], v[32:47]
 buffer_load_dwordx4 a[80:83], v232, s[8:11], s48 offen offset:0
 buffer_load_dwordx4 a[84:87], v232, s[8:11], s48 offen offset:1024
 buffer_load_dwordx4 a[88:91], v232, s[8:11], s48 offen offset:2048
 buffer_load_dwordx4 a[92:95], v232, s[8:11], s48 offen offset:3072
 s_add_u32 s48, s48, 4096
 ds_read_b64_tr_b16 v[196:197], v240 offset:30784
 ds_read_b64_tr_b16 v[198:199], v240 offset:31552
 s_waitcnt lgkmcnt(8)
 v_mfma_f32_32x32x16_bf16 v[48:63], v[204:207], a[20:23], v[48:63]
 ds_read_b64_tr_b16 v[200:201], v240 offset:30848
 ds_read_b64_tr_b16 v[202:203], v240 offset:31616
 s_waitcnt lgkmcnt(8)
 v_mfma_f32_32x32x16_bf16 v[64:79], v[208:211], a[20:23], v[64:79]
 ds_read_b64_tr_b16 v[204:205], v240 offset:43008
 ds_read_b64_tr_b16 v[206:207], v240 offset:43776
 s_waitcnt lgkmcnt(8)
 v_mfma_f32_32x32x16_bf16 v[80:95], v[212:215], a[20:23], v[80:95]
 ds_read_b64_tr_b16 v[208:209], v240 offset:43072
 ds_read_b64_tr_b16 v[210:211], v240 offset:43840
 s_waitcnt lgkmcnt(8)
 v_mfma_f32_32x32x16_bf16 v[0:15], v[192:195], a[24:27], v[0:15]
 ds_read_b64_tr_b16 v[212:213], v240 offset:43136
 ds_read_b64_tr_b16 v[214:215], v240 offset:43904
 s_waitcnt lgkmcnt(8)
 v_mfma_f32_32x32x16_bf16 v[16:31], v[196:199], a[24:27], v[16:31]
 ds_read_b64_tr_b16 v[192:193], v240 offset:33792
 ds_read_b64_tr_b16 v[194:195], v240 offset:34560
 s_waitcnt lgkmcnt(8)
 v_mfma_f32_32x32x16_bf16 v[32:47], v[200:203], a[24:27], v[32:47]
 ds_read_b64_tr_b16 v[196:197], v240 offset:33856
 ds_read_b64_tr_b16 v[198:199], v240 offset:34624
 s_waitcnt lgkmcnt(8)
 v_mfma_f32_32x32x16_bf16 v[48:63], v[204:207], a[24:27], v[48:63]
 ds_read_b64_tr_b16 v[200:201], v240 offset:33920
 ds_read_b64_tr_b16 v[202:203], v240 offset:34688
 s_waitcnt lgkmcnt(8)
 v_mfma_f32_32x32x16_bf16 v[64:79], v[208:211], a[24:27], v[64:79]
 ds_read_b64_tr_b16 v[204:205], v240 offset:46080
 ds_read_b64_tr_b16 v[206:207], v240 offset:46848
 s_waitcnt lgkmcnt(8)
 v_mfma_f32_32x32x16_bf16 v[80:95], v[212:215], a[24:27], v[80:95]
 ds_read_b64_tr_b16 v[208:209], v240 offset:46144
 ds_read_b64_tr_b16 v[210:211], v240 offset:46912
 s_waitcnt lgkmcnt(8)
 v_mfma_f32_32x32x16_bf16 v[0:15], v[192:195], a[28:31], v[0:15]
 ds_read_b64_tr_b16 v[212:213], v240 offset:46208
 ds_read_b64_tr_b16 v[214:215], v240 offset:46976
 s_waitcnt lgkmcnt(8)
 v_mfma_f32_32x32x16_bf16 v[16:31], v[196:199], a[28:31], v[16:31]
 ds_read_b64_tr_b16 v[192:193], v240 offset:49152
 ds_read_b64_tr_b16 v[194:195], v240 offset:49920
 s_waitcnt lgkmcnt(8)
 v_mfma_f32_32x32x16_bf16 v[32:47], v[200:203], a[28:31], v[32:47]
 ds_read_b64_tr_b16 v[196:197], v240 offset:49216
 ds_read_b64_tr_b16 v[198:199], v240 offset:49984
 s_waitcnt lgkmcnt(8)
 v_mfma_f32_32x32x16_bf16 v[48:63], v[204:207], a[28:31], v[48:63]
 ds_read_b64_tr_b16 v[200:201], v240 offset:49280
 ds_read_b64_tr_b16 v[202:203], v240 offset:50048
 s_waitcnt lgkmcnt(8)
 v_mfma_f32_32x32x16_bf16 v[64:79], v[208:211], a[28:31], v[64:79]
 ds_read_b64_tr_b16 v[204:205], v240 offset:61440
 ds_read_b64_tr_b16 v[206:207], v240 offset:62208
 s_waitcnt lgkmcnt(8)
 v_mfma_f32_32x32x16_bf16 v[80:95], v[212:215], a[28:31], v[80:95]
 s_waitcnt vmcnt(24)
 s_barrier
 ds_read_b64_tr_b16 v[208:209], v240 offset:61504
 ds_read_b64_tr_b16 v[210:211], v240 offset:62272
 s_waitcnt lgkmcnt(8)
 v_mfma_f32_32x32x16_bf16 v[0:15], v[192:195], a[32:35], v[0:15]
 ds_read_b64_tr_b16 v[212:213], v240 offset:61568
 ds_read_b64_tr_b16 v[214:215], v240 offset:62336
 s_waitcnt lgkmcnt(8)
 v_mfma_f32_32x32x16_bf16 v[16:31], v[196:199], a[32:35], v[16:31]
 s_add_u32 m0, s19, 24576
 s_add_u32 s29, s52, 1179648
 buffer_load_dwordx4 v236, s[40:43], s29 offen lds
 s_add_u32 m0, s19, 25600
 s_add_u32 s29, s52, 1179648
 buffer_load_dwordx4 v237, s[40:43], s29 offen lds
 s_add_u32 m0, s19, 26624
 s_add_u32 s29, s52, 1179648
 buffer_load_dwordx4 v238, s[40:43], s29 offen lds
 s_add_u32 m0, s19, 27648
 s_add_u32 s29, s52, 1228800
 buffer_load_dwordx4 v236, s[40:43], s29 offen lds
 s_add_u32 m0, s19, 28672
 s_add_u32 s29, s52, 1228800
 buffer_load_dwordx4 v237, s[40:43], s29 offen lds
 s_add_u32 m0, s19, 29696
 s_add_u32 s29, s52, 1228800
 buffer_load_dwordx4 v238, s[40:43], s29 offen lds
 ds_read_b64_tr_b16 v[192:193], v240 offset:52224
 ds_read_b64_tr_b16 v[194:195], v240 offset:52992
 s_waitcnt lgkmcnt(8)
 v_mfma_f32_32x32x16_bf16 v[32:47], v[200:203], a[32:35], v[32:47]
 ds_read_b64_tr_b16 v[196:197], v240 offset:52288
 ds_read_b64_tr_b16 v[198:199], v240 offset:53056
 s_waitcnt lgkmcnt(8)
 v_mfma_f32_32x32x16_bf16 v[48:63], v[204:207], a[32:35], v[48:63]
 ds_read_b64_tr_b16 v[200:201], v240 offset:52352
 ds_read_b64_tr_b16 v[202:203], v240 offset:53120
 s_waitcnt lgkmcnt(8)
 v_mfma_f32_32x32x16_bf16 v[64:79], v[208:211], a[32:35], v[64:79]
 ds_read_b64_tr_b16 v[204:205], v240 offset:64512
 ds_read_b64_tr_b16 v[206:207], v240 offset:65280
 s_waitcnt lgkmcnt(8)
 v_mfma_f32_32x32x16_bf16 v[80:95], v[212:215], a[32:35], v[80:95]
 ds_read_b64_tr_b16 v[208:209], v240 offset:64576
 ds_read_b64_tr_b16 v[210:211], v240 offset:65344
 s_waitcnt lgkmcnt(8)
 v_mfma_f32_32x32x16_bf16 v[0:15], v[192:195], a[36:39], v[0:15]
 ds_read_b64_tr_b16 v[212:213], v240 offset:64640
 ds_read_b64_tr_b16 v[214:215], v240 offset:65408
 s_waitcnt lgkmcnt(8)
 v_mfma_f32_32x32x16_bf16 v[16:31], v[196:199], a[36:39], v[16:31]
 ds_read_b64_tr_b16 v[192:193], v240 offset:55296
 ds_read_b64_tr_b16 v[194:195], v240 offset:56064
 s_waitcnt lgkmcnt(8)
 v_mfma_f32_32x32x16_bf16 v[32:47], v[200:203], a[36:39], v[32:47]
 buffer_load_dwordx4 a[96:99], v232, s[8:11], s48 offen offset:0
 buffer_load_dwordx4 a[100:103], v232, s[8:11], s48 offen offset:1024
 buffer_load_dwordx4 a[104:107], v232, s[8:11], s48 offen offset:2048
 buffer_load_dwordx4 a[108:111], v232, s[8:11], s48 offen offset:3072
 s_add_u32 s48, s48, 4096
 ds_read_b64_tr_b16 v[196:197], v240 offset:55360
 ds_read_b64_tr_b16 v[198:199], v240 offset:56128
 s_waitcnt lgkmcnt(8)
 v_mfma_f32_32x32x16_bf16 v[48:63], v[204:207], a[36:39], v[48:63]
 ds_read_b64_tr_b16 v[200:201], v240 offset:55424
 ds_read_b64_tr_b16 v[202:203], v240 offset:56192
 s_waitcnt lgkmcnt(8)
 v_mfma_f32_32x32x16_bf16 v[64:79], v[208:211], a[36:39], v[64:79]
 ds_read_b64_tr_b16 v[204:205], v248 offset:2048
 ds_read_b64_tr_b16 v[206:207], v248 offset:2816
 s_waitcnt lgkmcnt(8)
 v_mfma_f32_32x32x16_bf16 v[80:95], v[212:215], a[36:39], v[80:95]
 ds_read_b64_tr_b16 v[208:209], v248 offset:2112
 ds_read_b64_tr_b16 v[210:211], v248 offset:2880
 s_waitcnt lgkmcnt(8)
 v_mfma_f32_32x32x16_bf16 v[0:15], v[192:195], a[40:43], v[0:15]
 ds_read_b64_tr_b16 v[212:213], v248 offset:2176
 ds_read_b64_tr_b16 v[214:215], v248 offset:2944
 s_waitcnt lgkmcnt(8)
 v_mfma_f32_32x32x16_bf16 v[16:31], v[196:199], a[40:43], v[16:31]
 ds_read_b64_tr_b16 v[192:193], v240 offset:58368
 ds_read_b64_tr_b16 v[194:195], v240 offset:59136
 s_waitcnt lgkmcnt(8)
 v_mfma_f32_32x32x16_bf16 v[32:47], v[200:203], a[40:43], v[32:47]
 ds_read_b64_tr_b16 v[196:197], v240 offset:58432
 ds_read_b64_tr_b16 v[198:199], v240 offset:59200
 s_waitcnt lgkmcnt(8)
 v_mfma_f32_32x32x16_bf16 v[48:63], v[204:207], a[40:43], v[48:63]
 ds_read_b64_tr_b16 v[200:201], v240 offset:58496
 ds_read_b64_tr_b16 v[202:203], v240 offset:59264
 s_waitcnt lgkmcnt(8)
 v_mfma_f32_32x32x16_bf16 v[64:79], v[208:211], a[40:43], v[64:79]
 ds_read_b64_tr_b16 v[204:205], v248 offset:5120
 ds_read_b64_tr_b16 v[206:207], v248 offset:5888
 s_waitcnt lgkmcnt(8)
 v_mfma_f32_32x32x16_bf16 v[80:95], v[212:215], a[40:43], v[80:95]
 ds_read_b64_tr_b16 v[208:209], v248 offset:5184
 ds_read_b64_tr_b16 v[210:211], v248 offset:5952
 s_waitcnt lgkmcnt(8)
 v_mfma_f32_32x32x16_bf16 v[0:15], v[192:195], a[44:47], v[0:15]
 ds_read_b64_tr_b16 v[212:213], v248 offset:5248
 ds_read_b64_tr_b16 v[214:215], v248 offset:6016
 s_waitcnt lgkmcnt(8)
 v_mfma_f32_32x32x16_bf16 v[16:31], v[196:199], a[44:47], v[16:31]
 ds_read_b64_tr_b16 v[192:193], v248 offset:8192
 ds_read_b64_tr_b16 v[194:195], v248 offset:8960
 s_waitcnt lgkmcnt(8)
 v_mfma_f32_32x32x16_bf16 v[32:47], v[200:203], a[44:47], v[32:47]
 ds_read_b64_tr_b16 v[196:197], v248 offset:8256
 ds_read_b64_tr_b16 v[198:199], v248 offset:9024
 s_waitcnt lgkmcnt(8)
 v_mfma_f32_32x32x16_bf16 v[48:63], v[204:207], a[44:47], v[48:63]
 ds_read_b64_tr_b16 v[200:201], v248 offset:8320
 ds_read_b64_tr_b16 v[202:203], v248 offset:9088
 s_waitcnt lgkmcnt(8)
 v_mfma_f32_32x32x16_bf16 v[64:79], v[208:211], a[44:47], v[64:79]
 ds_read_b64_tr_b16 v[204:205], v248 offset:20480
 ds_read_b64_tr_b16 v[206:207], v248 offset:21248
 s_waitcnt lgkmcnt(8)
 v_mfma_f32_32x32x16_bf16 v[80:95], v[212:215], a[44:47], v[80:95]
 s_waitcnt vmcnt(24)
 s_barrier
 ds_read_b64_tr_b16 v[208:209], v248 offset:20544
 ds_read_b64_tr_b16 v[210:211], v248 offset:21312
 s_waitcnt lgkmcnt(8)
 v_mfma_f32_32x32x16_bf16 v[0:15], v[192:195], a[48:51], v[0:15]
 ds_read_b64_tr_b16 v[212:213], v248 offset:20608
 ds_read_b64_tr_b16 v[214:215], v248 offset:21376
 s_waitcnt lgkmcnt(8)
 v_mfma_f32_32x32x16_bf16 v[16:31], v[196:199], a[48:51], v[16:31]
 s_add_u32 m0, s19, 49152
 s_add_u32 s29, s52, 1376256
 buffer_load_dwordx4 v236, s[40:43], s29 offen lds
 s_add_u32 m0, s19, 50176
 s_add_u32 s29, s52, 1376256
 buffer_load_dwordx4 v237, s[40:43], s29 offen lds
 s_add_u32 m0, s19, 51200
 s_add_u32 s29, s52, 1376256
 buffer_load_dwordx4 v238, s[40:43], s29 offen lds
 s_add_u32 m0, s19, 52224
 s_add_u32 s29, s52, 1425408
 buffer_load_dwordx4 v236, s[40:43], s29 offen lds
 s_add_u32 m0, s19, 53248
 s_add_u32 s29, s52, 1425408
 buffer_load_dwordx4 v237, s[40:43], s29 offen lds
 s_add_u32 m0, s19, 54272
 s_add_u32 s29, s52, 1425408
 buffer_load_dwordx4 v238, s[40:43], s29 offen lds
 ds_read_b64_tr_b16 v[192:193], v248 offset:11264
 ds_read_b64_tr_b16 v[194:195], v248 offset:12032
 s_waitcnt lgkmcnt(8)
 v_mfma_f32_32x32x16_bf16 v[32:47], v[200:203], a[48:51], v[32:47]
 ds_read_b64_tr_b16 v[196:197], v248 offset:11328
 ds_read_b64_tr_b16 v[198:199], v248 offset:12096
 s_waitcnt lgkmcnt(8)
 v_mfma_f32_32x32x16_bf16 v[48:63], v[204:207], a[48:51], v[48:63]
 ds_read_b64_tr_b16 v[200:201], v248 offset:11392
 ds_read_b64_tr_b16 v[202:203], v248 offset:12160
 s_waitcnt lgkmcnt(8)
 v_mfma_f32_32x32x16_bf16 v[64:79], v[208:211], a[48:51], v[64:79]
 ds_read_b64_tr_b16 v[204:205], v248 offset:23552
 ds_read_b64_tr_b16 v[206:207], v248 offset:24320
 s_waitcnt lgkmcnt(8)
 v_mfma_f32_32x32x16_bf16 v[80:95], v[212:215], a[48:51], v[80:95]
 ds_read_b64_tr_b16 v[208:209], v248 offset:23616
 ds_read_b64_tr_b16 v[210:211], v248 offset:24384
 s_waitcnt lgkmcnt(8)
 v_mfma_f32_32x32x16_bf16 v[0:15], v[192:195], a[52:55], v[0:15]
 ds_read_b64_tr_b16 v[212:213], v248 offset:23680
 ds_read_b64_tr_b16 v[214:215], v248 offset:24448
 s_waitcnt lgkmcnt(8)
 v_mfma_f32_32x32x16_bf16 v[16:31], v[196:199], a[52:55], v[16:31]
 ds_read_b64_tr_b16 v[192:193], v248 offset:14336
 ds_read_b64_tr_b16 v[194:195], v248 offset:15104
 s_waitcnt lgkmcnt(8)
 v_mfma_f32_32x32x16_bf16 v[32:47], v[200:203], a[52:55], v[32:47]
 buffer_load_dwordx4 a[112:115], v232, s[8:11], s48 offen offset:0
 buffer_load_dwordx4 a[116:119], v232, s[8:11], s48 offen offset:1024
 buffer_load_dwordx4 a[120:123], v232, s[8:11], s48 offen offset:2048
 buffer_load_dwordx4 a[124:127], v232, s[8:11], s48 offen offset:3072
 s_add_u32 s48, s48, 4096
 ds_read_b64_tr_b16 v[196:197], v248 offset:14400
 ds_read_b64_tr_b16 v[198:199], v248 offset:15168
 s_waitcnt lgkmcnt(8)
 v_mfma_f32_32x32x16_bf16 v[48:63], v[204:207], a[52:55], v[48:63]
 ds_read_b64_tr_b16 v[200:201], v248 offset:14464
 ds_read_b64_tr_b16 v[202:203], v248 offset:15232
 s_waitcnt lgkmcnt(8)
 v_mfma_f32_32x32x16_bf16 v[64:79], v[208:211], a[52:55], v[64:79]
 ds_read_b64_tr_b16 v[204:205], v248 offset:26624
 ds_read_b64_tr_b16 v[206:207], v248 offset:27392
 s_waitcnt lgkmcnt(8)
 v_mfma_f32_32x32x16_bf16 v[80:95], v[212:215], a[52:55], v[80:95]
 ds_read_b64_tr_b16 v[208:209], v248 offset:26688
 ds_read_b64_tr_b16 v[210:211], v248 offset:27456
 s_waitcnt lgkmcnt(8)
 v_mfma_f32_32x32x16_bf16 v[0:15], v[192:195], a[56:59], v[0:15]
 ds_read_b64_tr_b16 v[212:213], v248 offset:26752
 ds_read_b64_tr_b16 v[214:215], v248 offset:27520
 s_waitcnt lgkmcnt(8)
 v_mfma_f32_32x32x16_bf16 v[16:31], v[196:199], a[56:59], v[16:31]
 ds_read_b64_tr_b16 v[192:193], v248 offset:17408
 ds_read_b64_tr_b16 v[194:195], v248 offset:18176
 s_waitcnt lgkmcnt(8)
 v_mfma_f32_32x32x16_bf16 v[32:47], v[200:203], a[56:59], v[32:47]
 ds_read_b64_tr_b16 v[196:197], v248 offset:17472
 ds_read_b64_tr_b16 v[198:199], v248 offset:18240
 s_waitcnt lgkmcnt(8)
 v_mfma_f32_32x32x16_bf16 v[48:63], v[204:207], a[56:59], v[48:63]
 ds_read_b64_tr_b16 v[200:201], v248 offset:17536
 ds_read_b64_tr_b16 v[202:203], v248 offset:18304
 s_waitcnt lgkmcnt(8)
 v_mfma_f32_32x32x16_bf16 v[64:79], v[208:211], a[56:59], v[64:79]
 ds_read_b64_tr_b16 v[204:205], v248 offset:29696
 ds_read_b64_tr_b16 v[206:207], v248 offset:30464
 s_waitcnt lgkmcnt(8)
 v_mfma_f32_32x32x16_bf16 v[80:95], v[212:215], a[56:59], v[80:95]
 ds_read_b64_tr_b16 v[208:209], v248 offset:29760
 ds_read_b64_tr_b16 v[210:211], v248 offset:30528
 s_waitcnt lgkmcnt(8)
 v_mfma_f32_32x32x16_bf16 v[0:15], v[192:195], a[60:63], v[0:15]
 ds_read_b64_tr_b16 v[212:213], v248 offset:29824
 ds_read_b64_tr_b16 v[214:215], v248 offset:30592
 s_waitcnt lgkmcnt(8)
 v_mfma_f32_32x32x16_bf16 v[16:31], v[196:199], a[60:63], v[16:31]
 ds_read_b64_tr_b16 v[192:193], v248 offset:32768
 ds_read_b64_tr_b16 v[194:195], v248 offset:33536
 s_waitcnt lgkmcnt(8)
 v_mfma_f32_32x32x16_bf16 v[32:47], v[200:203], a[60:63], v[32:47]
 ds_read_b64_tr_b16 v[196:197], v248 offset:32832
 ds_read_b64_tr_b16 v[198:199], v248 offset:33600
 s_waitcnt lgkmcnt(8)
 v_mfma_f32_32x32x16_bf16 v[48:63], v[204:207], a[60:63], v[48:63]
 ds_read_b64_tr_b16 v[200:201], v248 offset:32896
 ds_read_b64_tr_b16 v[202:203], v248 offset:33664
 s_waitcnt lgkmcnt(8)
 v_mfma_f32_32x32x16_bf16 v[64:79], v[208:211], a[60:63], v[64:79]
 ds_read_b64_tr_b16 v[204:205], v248 offset:45056
 ds_read_b64_tr_b16 v[206:207], v248 offset:45824
 s_waitcnt lgkmcnt(8)
 v_mfma_f32_32x32x16_bf16 v[80:95], v[212:215], a[60:63], v[80:95]
 s_waitcnt vmcnt(24)
 s_barrier
 ds_read_b64_tr_b16 v[208:209], v248 offset:45120
 ds_read_b64_tr_b16 v[210:211], v248 offset:45888
 s_waitcnt lgkmcnt(8)
 v_mfma_f32_32x32x16_bf16 v[0:15], v[192:195], a[64:67], v[0:15]
 ds_read_b64_tr_b16 v[212:213], v248 offset:45184
 ds_read_b64_tr_b16 v[214:215], v248 offset:45952
 s_waitcnt lgkmcnt(8)
 v_mfma_f32_32x32x16_bf16 v[16:31], v[196:199], a[64:67], v[16:31]
 s_add_u32 m0, s19, 73728
 s_add_u32 s29, s52, 1572864
 buffer_load_dwordx4 v236, s[40:43], s29 offen lds
 s_add_u32 m0, s19, 74752
 s_add_u32 s29, s52, 1572864
 buffer_load_dwordx4 v237, s[40:43], s29 offen lds
 s_add_u32 m0, s19, 75776
 s_add_u32 s29, s52, 1572864
 buffer_load_dwordx4 v238, s[40:43], s29 offen lds
 s_add_u32 m0, s19, 76800
 s_add_u32 s29, s52, 1622016
 buffer_load_dwordx4 v236, s[40:43], s29 offen lds
 s_add_u32 m0, s19, 77824
 s_add_u32 s29, s52, 1622016
 buffer_load_dwordx4 v237, s[40:43], s29 offen lds
 s_add_u32 m0, s19, 78848
 s_add_u32 s29, s52, 1622016
 buffer_load_dwordx4 v238, s[40:43], s29 offen lds
 ds_read_b64_tr_b16 v[192:193], v248 offset:35840
 ds_read_b64_tr_b16 v[194:195], v248 offset:36608
 s_waitcnt lgkmcnt(8)
 v_mfma_f32_32x32x16_bf16 v[32:47], v[200:203], a[64:67], v[32:47]
 ds_read_b64_tr_b16 v[196:197], v248 offset:35904
 ds_read_b64_tr_b16 v[198:199], v248 offset:36672
 s_waitcnt lgkmcnt(8)
 v_mfma_f32_32x32x16_bf16 v[48:63], v[204:207], a[64:67], v[48:63]
 ds_read_b64_tr_b16 v[200:201], v248 offset:35968
 ds_read_b64_tr_b16 v[202:203], v248 offset:36736
 s_waitcnt lgkmcnt(8)
 v_mfma_f32_32x32x16_bf16 v[64:79], v[208:211], a[64:67], v[64:79]
 ds_read_b64_tr_b16 v[204:205], v248 offset:48128
 ds_read_b64_tr_b16 v[206:207], v248 offset:48896
 s_waitcnt lgkmcnt(8)
 v_mfma_f32_32x32x16_bf16 v[80:95], v[212:215], a[64:67], v[80:95]
 ds_read_b64_tr_b16 v[208:209], v248 offset:48192
 ds_read_b64_tr_b16 v[210:211], v248 offset:48960
 s_waitcnt lgkmcnt(8)
 v_mfma_f32_32x32x16_bf16 v[0:15], v[192:195], a[68:71], v[0:15]
 ds_read_b64_tr_b16 v[212:213], v248 offset:48256
 ds_read_b64_tr_b16 v[214:215], v248 offset:49024
 s_waitcnt lgkmcnt(8)
 v_mfma_f32_32x32x16_bf16 v[16:31], v[196:199], a[68:71], v[16:31]
 ds_read_b64_tr_b16 v[192:193], v248 offset:38912
 ds_read_b64_tr_b16 v[194:195], v248 offset:39680
 s_waitcnt lgkmcnt(8)
 v_mfma_f32_32x32x16_bf16 v[32:47], v[200:203], a[68:71], v[32:47]
 buffer_load_dwordx4 a[128:131], v232, s[8:11], s48 offen offset:0
 buffer_load_dwordx4 a[132:135], v232, s[8:11], s48 offen offset:1024
 buffer_load_dwordx4 a[136:139], v232, s[8:11], s48 offen offset:2048
 buffer_load_dwordx4 a[140:143], v232, s[8:11], s48 offen offset:3072
 s_add_u32 s48, s48, 4096
 ds_read_b64_tr_b16 v[196:197], v248 offset:38976
 ds_read_b64_tr_b16 v[198:199], v248 offset:39744
 s_waitcnt lgkmcnt(8)
 v_mfma_f32_32x32x16_bf16 v[48:63], v[204:207], a[68:71], v[48:63]
 ds_read_b64_tr_b16 v[200:201], v248 offset:39040
 ds_read_b64_tr_b16 v[202:203], v248 offset:39808
 s_waitcnt lgkmcnt(8)
 v_mfma_f32_32x32x16_bf16 v[64:79], v[208:211], a[68:71], v[64:79]
 ds_read_b64_tr_b16 v[204:205], v248 offset:51200
 ds_read_b64_tr_b16 v[206:207], v248 offset:51968
 s_waitcnt lgkmcnt(8)
 v_mfma_f32_32x32x16_bf16 v[80:95], v[212:215], a[68:71], v[80:95]
 ds_read_b64_tr_b16 v[208:209], v248 offset:51264
 ds_read_b64_tr_b16 v[210:211], v248 offset:52032
 s_waitcnt lgkmcnt(8)
 v_mfma_f32_32x32x16_bf16 v[0:15], v[192:195], a[72:75], v[0:15]
 ds_read_b64_tr_b16 v[212:213], v248 offset:51328
 ds_read_b64_tr_b16 v[214:215], v248 offset:52096
 s_waitcnt lgkmcnt(8)
 v_mfma_f32_32x32x16_bf16 v[16:31], v[196:199], a[72:75], v[16:31]
 ds_read_b64_tr_b16 v[192:193], v248 offset:41984
 ds_read_b64_tr_b16 v[194:195], v248 offset:42752
 s_waitcnt lgkmcnt(8)
 v_mfma_f32_32x32x16_bf16 v[32:47], v[200:203], a[72:75], v[32:47]
 ds_read_b64_tr_b16 v[196:197], v248 offset:42048
 ds_read_b64_tr_b16 v[198:199], v248 offset:42816
 s_waitcnt lgkmcnt(8)
 v_mfma_f32_32x32x16_bf16 v[48:63], v[204:207], a[72:75], v[48:63]
 ds_read_b64_tr_b16 v[200:201], v248 offset:42112
 ds_read_b64_tr_b16 v[202:203], v248 offset:42880
 s_waitcnt lgkmcnt(8)
 v_mfma_f32_32x32x16_bf16 v[64:79], v[208:211], a[72:75], v[64:79]
 ds_read_b64_tr_b16 v[204:205], v248 offset:54272
 ds_read_b64_tr_b16 v[206:207], v248 offset:55040
 s_waitcnt lgkmcnt(8)
 v_mfma_f32_32x32x16_bf16 v[80:95], v[212:215], a[72:75], v[80:95]
 ds_read_b64_tr_b16 v[208:209], v248 offset:54336
 ds_read_b64_tr_b16 v[210:211], v248 offset:55104
 s_waitcnt lgkmcnt(8)
 v_mfma_f32_32x32x16_bf16 v[0:15], v[192:195], a[76:79], v[0:15]
 ds_read_b64_tr_b16 v[212:213], v248 offset:54400
 ds_read_b64_tr_b16 v[214:215], v248 offset:55168
 s_waitcnt lgkmcnt(8)
 v_mfma_f32_32x32x16_bf16 v[16:31], v[196:199], a[76:79], v[16:31]
 ds_read_b64_tr_b16 v[192:193], v240 offset:0
 ds_read_b64_tr_b16 v[194:195], v240 offset:768
 s_waitcnt lgkmcnt(8)
 v_mfma_f32_32x32x16_bf16 v[32:47], v[200:203], a[76:79], v[32:47]
 ds_read_b64_tr_b16 v[196:197], v240 offset:64
 ds_read_b64_tr_b16 v[198:199], v240 offset:832
 s_waitcnt lgkmcnt(8)
 v_mfma_f32_32x32x16_bf16 v[48:63], v[204:207], a[76:79], v[48:63]
 ds_read_b64_tr_b16 v[200:201], v240 offset:128
 ds_read_b64_tr_b16 v[202:203], v240 offset:896
 s_waitcnt lgkmcnt(8)
 v_mfma_f32_32x32x16_bf16 v[64:79], v[208:211], a[76:79], v[64:79]
 ds_read_b64_tr_b16 v[204:205], v240 offset:12288
 ds_read_b64_tr_b16 v[206:207], v240 offset:13056
 s_waitcnt lgkmcnt(8)
 v_mfma_f32_32x32x16_bf16 v[80:95], v[212:215], a[76:79], v[80:95]
 s_waitcnt vmcnt(24)
 s_barrier
 ds_read_b64_tr_b16 v[208:209], v240 offset:12352
 ds_read_b64_tr_b16 v[210:211], v240 offset:13120
 s_waitcnt lgkmcnt(8)
 v_mfma_f32_32x32x16_bf16 v[0:15], v[192:195], a[80:83], v[0:15]
 ds_read_b64_tr_b16 v[212:213], v240 offset:12416
 ds_read_b64_tr_b16 v[214:215], v240 offset:13184
 s_waitcnt lgkmcnt(8)
 v_mfma_f32_32x32x16_bf16 v[16:31], v[196:199], a[80:83], v[16:31]
 s_add_u32 m0, s19, 98304
 s_add_u32 s29, s52, 1769472
 buffer_load_dwordx4 v236, s[40:43], s29 offen lds
 s_add_u32 m0, s19, 99328
 s_add_u32 s29, s52, 1769472
 buffer_load_dwordx4 v237, s[40:43], s29 offen lds
 s_add_u32 m0, s19, 100352
 s_add_u32 s29, s52, 1769472
 buffer_load_dwordx4 v238, s[40:43], s29 offen lds
 s_add_u32 m0, s19, 101376
 s_add_u32 s29, s52, 1818624
 buffer_load_dwordx4 v236, s[40:43], s29 offen lds
 s_add_u32 m0, s19, 102400
 s_add_u32 s29, s52, 1818624
 buffer_load_dwordx4 v237, s[40:43], s29 offen lds
 s_add_u32 m0, s19, 103424
 s_add_u32 s29, s52, 1818624
 buffer_load_dwordx4 v238, s[40:43], s29 offen lds
 ds_read_b64_tr_b16 v[192:193], v240 offset:3072
 ds_read_b64_tr_b16 v[194:195], v240 offset:3840
 s_waitcnt lgkmcnt(8)
 v_mfma_f32_32x32x16_bf16 v[32:47], v[200:203], a[80:83], v[32:47]
 ds_read_b64_tr_b16 v[196:197], v240 offset:3136
 ds_read_b64_tr_b16 v[198:199], v240 offset:3904
 s_waitcnt lgkmcnt(8)
 v_mfma_f32_32x32x16_bf16 v[48:63], v[204:207], a[80:83], v[48:63]
 ds_read_b64_tr_b16 v[200:201], v240 offset:3200
 ds_read_b64_tr_b16 v[202:203], v240 offset:3968
 s_waitcnt lgkmcnt(8)
 v_mfma_f32_32x32x16_bf16 v[64:79], v[208:211], a[80:83], v[64:79]
 ds_read_b64_tr_b16 v[204:205], v240 offset:15360
 ds_read_b64_tr_b16 v[206:207], v240 offset:16128
 s_waitcnt lgkmcnt(8)
 v_mfma_f32_32x32x16_bf16 v[80:95], v[212:215], a[80:83], v[80:95]
 ds_read_b64_tr_b16 v[208:209], v240 offset:15424
 ds_read_b64_tr_b16 v[210:211], v240 offset:16192
 s_waitcnt lgkmcnt(8)
 v_mfma_f32_32x32x16_bf16 v[0:15], v[192:195], a[84:87], v[0:15]
 ds_read_b64_tr_b16 v[212:213], v240 offset:15488
 ds_read_b64_tr_b16 v[214:215], v240 offset:16256
 s_waitcnt lgkmcnt(8)
 v_mfma_f32_32x32x16_bf16 v[16:31], v[196:199], a[84:87], v[16:31]
 ds_read_b64_tr_b16 v[192:193], v240 offset:6144
 ds_read_b64_tr_b16 v[194:195], v240 offset:6912
 s_waitcnt lgkmcnt(8)
 v_mfma_f32_32x32x16_bf16 v[32:47], v[200:203], a[84:87], v[32:47]
 buffer_load_dwordx4 a[144:147], v232, s[8:11], s48 offen offset:0
 buffer_load_dwordx4 a[148:151], v232, s[8:11], s48 offen offset:1024
 buffer_load_dwordx4 a[152:155], v232, s[8:11], s48 offen offset:2048
 buffer_load_dwordx4 a[156:159], v232, s[8:11], s48 offen offset:3072
 s_add_u32 s48, s48, 4096
 ds_read_b64_tr_b16 v[196:197], v240 offset:6208
 ds_read_b64_tr_b16 v[198:199], v240 offset:6976
 s_waitcnt lgkmcnt(8)
 v_mfma_f32_32x32x16_bf16 v[48:63], v[204:207], a[84:87], v[48:63]
 ds_read_b64_tr_b16 v[200:201], v240 offset:6272
 ds_read_b64_tr_b16 v[202:203], v240 offset:7040
 s_waitcnt lgkmcnt(8)
 v_mfma_f32_32x32x16_bf16 v[64:79], v[208:211], a[84:87], v[64:79]
 ds_read_b64_tr_b16 v[204:205], v240 offset:18432
 ds_read_b64_tr_b16 v[206:207], v240 offset:19200
 s_waitcnt lgkmcnt(8)
 v_mfma_f32_32x32x16_bf16 v[80:95], v[212:215], a[84:87], v[80:95]
 ds_read_b64_tr_b16 v[208:209], v240 offset:18496
 ds_read_b64_tr_b16 v[210:211], v240 offset:19264
 s_waitcnt lgkmcnt(8)
 v_mfma_f32_32x32x16_bf16 v[0:15], v[192:195], a[88:91], v[0:15]
 ds_read_b64_tr_b16 v[212:213], v240 offset:18560
 ds_read_b64_tr_b16 v[214:215], v240 offset:19328
 s_waitcnt lgkmcnt(8)
 v_mfma_f32_32x32x16_bf16 v[16:31], v[196:199], a[88:91], v[16:31]
 ds_read_b64_tr_b16 v[192:193], v240 offset:9216
 ds_read_b64_tr_b16 v[194:195], v240 offset:9984
 s_waitcnt lgkmcnt(8)
 v_mfma_f32_32x32x16_bf16 v[32:47], v[200:203], a[88:91], v[32:47]
 ds_read_b64_tr_b16 v[196:197], v240 offset:9280
 ds_read_b64_tr_b16 v[198:199], v240 offset:10048
 s_waitcnt lgkmcnt(8)
 v_mfma_f32_32x32x16_bf16 v[48:63], v[204:207], a[88:91], v[48:63]
 ds_read_b64_tr_b16 v[200:201], v240 offset:9344
 ds_read_b64_tr_b16 v[202:203], v240 offset:10112
 s_waitcnt lgkmcnt(8)
 v_mfma_f32_32x32x16_bf16 v[64:79], v[208:211], a[88:91], v[64:79]
 ds_read_b64_tr_b16 v[204:205], v240 offset:21504
 ds_read_b64_tr_b16 v[206:207], v240 offset:22272
 s_waitcnt lgkmcnt(8)
 v_mfma_f32_32x32x16_bf16 v[80:95], v[212:215], a[88:91], v[80:95]
 ds_read_b64_tr_b16 v[208:209], v240 offset:21568
 ds_read_b64_tr_b16 v[210:211], v240 offset:22336
 s_waitcnt lgkmcnt(8)
 v_mfma_f32_32x32x16_bf16 v[0:15], v[192:195], a[92:95], v[0:15]
 ds_read_b64_tr_b16 v[212:213], v240 offset:21632
 ds_read_b64_tr_b16 v[214:215], v240 offset:22400
 s_waitcnt lgkmcnt(8)
 v_mfma_f32_32x32x16_bf16 v[16:31], v[196:199], a[92:95], v[16:31]
 ds_read_b64_tr_b16 v[192:193], v240 offset:24576
 ds_read_b64_tr_b16 v[194:195], v240 offset:25344
 s_waitcnt lgkmcnt(8)
 v_mfma_f32_32x32x16_bf16 v[32:47], v[200:203], a[92:95], v[32:47]
 ds_read_b64_tr_b16 v[196:197], v240 offset:24640
 ds_read_b64_tr_b16 v[198:199], v240 offset:25408
 s_waitcnt lgkmcnt(8)
 v_mfma_f32_32x32x16_bf16 v[48:63], v[204:207], a[92:95], v[48:63]
 ds_read_b64_tr_b16 v[200:201], v240 offset:24704
 ds_read_b64_tr_b16 v[202:203], v240 offset:25472
 s_waitcnt lgkmcnt(8)
 v_mfma_f32_32x32x16_bf16 v[64:79], v[208:211], a[92:95], v[64:79]
 ds_read_b64_tr_b16 v[204:205], v240 offset:36864
 ds_read_b64_tr_b16 v[206:207], v240 offset:37632
 s_waitcnt lgkmcnt(8)
 v_mfma_f32_32x32x16_bf16 v[80:95], v[212:215], a[92:95], v[80:95]
 s_waitcnt vmcnt(24)
 s_barrier
 ds_read_b64_tr_b16 v[208:209], v240 offset:36928
 ds_read_b64_tr_b16 v[210:211], v240 offset:37696
 s_waitcnt lgkmcnt(8)
 v_mfma_f32_32x32x16_bf16 v[0:15], v[192:195], a[96:99], v[0:15]
 ds_read_b64_tr_b16 v[212:213], v240 offset:36992
 ds_read_b64_tr_b16 v[214:215], v240 offset:37760
 s_waitcnt lgkmcnt(8)
 v_mfma_f32_32x32x16_bf16 v[16:31], v[196:199], a[96:99], v[16:31]
 ds_read_b64_tr_b16 v[192:193], v240 offset:27648
 ds_read_b64_tr_b16 v[194:195], v240 offset:28416
 s_waitcnt lgkmcnt(8)
 v_mfma_f32_32x32x16_bf16 v[32:47], v[200:203], a[96:99], v[32:47]
 ds_read_b64_tr_b16 v[196:197], v240 offset:27712
 ds_read_b64_tr_b16 v[198:199], v240 offset:28480
 s_waitcnt lgkmcnt(8)
 v_mfma_f32_32x32x16_bf16 v[48:63], v[204:207], a[96:99], v[48:63]
 ds_read_b64_tr_b16 v[200:201], v240 offset:27776
 ds_read_b64_tr_b16 v[202:203], v240 offset:28544
 s_waitcnt lgkmcnt(8)
 v_mfma_f32_32x32x16_bf16 v[64:79], v[208:211], a[96:99], v[64:79]
 ds_read_b64_tr_b16 v[204:205], v240 offset:39936
 ds_read_b64_tr_b16 v[206:207], v240 offset:40704
 s_waitcnt lgkmcnt(8)
 v_mfma_f32_32x32x16_bf16 v[80:95], v[212:215], a[96:99], v[80:95]
 ds_read_b64_tr_b16 v[208:209], v240 offset:40000
 ds_read_b64_tr_b16 v[210:211], v240 offset:40768
 s_waitcnt lgkmcnt(8)
 v_mfma_f32_32x32x16_bf16 v[0:15], v[192:195], a[100:103], v[0:15]
 ds_read_b64_tr_b16 v[212:213], v240 offset:40064
 ds_read_b64_tr_b16 v[214:215], v240 offset:40832
 s_waitcnt lgkmcnt(8)
 v_mfma_f32_32x32x16_bf16 v[16:31], v[196:199], a[100:103], v[16:31]
 ds_read_b64_tr_b16 v[192:193], v240 offset:30720
 ds_read_b64_tr_b16 v[194:195], v240 offset:31488
 s_waitcnt lgkmcnt(8)
 v_mfma_f32_32x32x16_bf16 v[32:47], v[200:203], a[100:103], v[32:47]
 ds_read_b64_tr_b16 v[196:197], v240 offset:30784
 ds_read_b64_tr_b16 v[198:199], v240 offset:31552
 s_waitcnt lgkmcnt(8)
 v_mfma_f32_32x32x16_bf16 v[48:63], v[204:207], a[100:103], v[48:63]
 ds_read_b64_tr_b16 v[200:201], v240 offset:30848
 ds_read_b64_tr_b16 v[202:203], v240 offset:31616
 s_waitcnt lgkmcnt(8)
 v_mfma_f32_32x32x16_bf16 v[64:79], v[208:211], a[100:103], v[64:79]
 ds_read_b64_tr_b16 v[204:205], v240 offset:43008
 ds_read_b64_tr_b16 v[206:207], v240 offset:43776
 s_waitcnt lgkmcnt(8)
 v_mfma_f32_32x32x16_bf16 v[80:95], v[212:215], a[100:103], v[80:95]
 ds_read_b64_tr_b16 v[208:209], v240 offset:43072
 ds_read_b64_tr_b16 v[210:211], v240 offset:43840
 s_waitcnt lgkmcnt(8)
 v_mfma_f32_32x32x16_bf16 v[0:15], v[192:195], a[104:107], v[0:15]
 ds_read_b64_tr_b16 v[212:213], v240 offset:43136
 ds_read_b64_tr_b16 v[214:215], v240 offset:43904
 s_waitcnt lgkmcnt(8)
 v_mfma_f32_32x32x16_bf16 v[16:31], v[196:199], a[104:107], v[16:31]
 ds_read_b64_tr_b16 v[192:193], v240 offset:33792
 ds_read_b64_tr_b16 v[194:195], v240 offset:34560
 s_waitcnt lgkmcnt(8)
 v_mfma_f32_32x32x16_bf16 v[32:47], v[200:203], a[104:107], v[32:47]
 ds_read_b64_tr_b16 v[196:197], v240 offset:33856
 ds_read_b64_tr_b16 v[198:199], v240 offset:34624
 s_waitcnt lgkmcnt(8)
 v_mfma_f32_32x32x16_bf16 v[48:63], v[204:207], a[104:107], v[48:63]
 ds_read_b64_tr_b16 v[200:201], v240 offset:33920
 ds_read_b64_tr_b16 v[202:203], v240 offset:34688
 s_waitcnt lgkmcnt(8)
 v_mfma_f32_32x32x16_bf16 v[64:79], v[208:211], a[104:107], v[64:79]
 ds_read_b64_tr_b16 v[204:205], v240 offset:46080
 ds_read_b64_tr_b16 v[206:207], v240 offset:46848
 s_waitcnt lgkmcnt(8)
 v_mfma_f32_32x32x16_bf16 v[80:95], v[212:215], a[104:107], v[80:95]
 ds_read_b64_tr_b16 v[208:209], v240 offset:46144
 ds_read_b64_tr_b16 v[210:211], v240 offset:46912
 s_waitcnt lgkmcnt(8)
 v_mfma_f32_32x32x16_bf16 v[0:15], v[192:195], a[108:111], v[0:15]
 ds_read_b64_tr_b16 v[212:213], v240 offset:46208
 ds_read_b64_tr_b16 v[214:215], v240 offset:46976
 s_waitcnt lgkmcnt(8)
 v_mfma_f32_32x32x16_bf16 v[16:31], v[196:199], a[108:111], v[16:31]
 ds_read_b64_tr_b16 v[192:193], v240 offset:49152
 ds_read_b64_tr_b16 v[194:195], v240 offset:49920
 s_waitcnt lgkmcnt(8)
 v_mfma_f32_32x32x16_bf16 v[32:47], v[200:203], a[108:111], v[32:47]
 ds_read_b64_tr_b16 v[196:197], v240 offset:49216
 ds_read_b64_tr_b16 v[198:199], v240 offset:49984
 s_waitcnt lgkmcnt(8)
 v_mfma_f32_32x32x16_bf16 v[48:63], v[204:207], a[108:111], v[48:63]
 ds_read_b64_tr_b16 v[200:201], v240 offset:49280
 ds_read_b64_tr_b16 v[202:203], v240 offset:50048
 s_waitcnt lgkmcnt(8)
 v_mfma_f32_32x32x16_bf16 v[64:79], v[208:211], a[108:111], v[64:79]
 ds_read_b64_tr_b16 v[204:205], v240 offset:61440
 ds_read_b64_tr_b16 v[206:207], v240 offset:62208
 s_waitcnt lgkmcnt(8)
 v_mfma_f32_32x32x16_bf16 v[80:95], v[212:215], a[108:111], v[80:95]
 s_waitcnt vmcnt(14)
 s_barrier
 ds_read_b64_tr_b16 v[208:209], v240 offset:61504
 ds_read_b64_tr_b16 v[210:211], v240 offset:62272
 s_waitcnt lgkmcnt(8)
 v_mfma_f32_32x32x16_bf16 v[0:15], v[192:195], a[112:115], v[0:15]
 ds_read_b64_tr_b16 v[212:213], v240 offset:61568
 ds_read_b64_tr_b16 v[214:215], v240 offset:62336
 s_waitcnt lgkmcnt(8)
 v_mfma_f32_32x32x16_bf16 v[16:31], v[196:199], a[112:115], v[16:31]
 ds_read_b64_tr_b16 v[192:193], v240 offset:52224
 ds_read_b64_tr_b16 v[194:195], v240 offset:52992
 s_waitcnt lgkmcnt(8)
 v_mfma_f32_32x32x16_bf16 v[32:47], v[200:203], a[112:115], v[32:47]
 ds_read_b64_tr_b16 v[196:197], v240 offset:52288
 ds_read_b64_tr_b16 v[198:199], v240 offset:53056
 s_waitcnt lgkmcnt(8)
 v_mfma_f32_32x32x16_bf16 v[48:63], v[204:207], a[112:115], v[48:63]
 ds_read_b64_tr_b16 v[200:201], v240 offset:52352
 ds_read_b64_tr_b16 v[202:203], v240 offset:53120
 s_waitcnt lgkmcnt(8)
 v_mfma_f32_32x32x16_bf16 v[64:79], v[208:211], a[112:115], v[64:79]
 ds_read_b64_tr_b16 v[204:205], v240 offset:64512
 ds_read_b64_tr_b16 v[206:207], v240 offset:65280
 s_waitcnt lgkmcnt(8)
 v_mfma_f32_32x32x16_bf16 v[80:95], v[212:215], a[112:115], v[80:95]
 ds_read_b64_tr_b16 v[208:209], v240 offset:64576
 ds_read_b64_tr_b16 v[210:211], v240 offset:65344
 s_waitcnt lgkmcnt(8)
 v_mfma_f32_32x32x16_bf16 v[0:15], v[192:195], a[116:119], v[0:15]
 ds_read_b64_tr_b16 v[212:213], v240 offset:64640
 ds_read_b64_tr_b16 v[214:215], v240 offset:65408
 s_waitcnt lgkmcnt(8)
 v_mfma_f32_32x32x16_bf16 v[16:31], v[196:199], a[116:119], v[16:31]
 ds_read_b64_tr_b16 v[192:193], v240 offset:55296
 ds_read_b64_tr_b16 v[194:195], v240 offset:56064
 s_waitcnt lgkmcnt(8)
 v_mfma_f32_32x32x16_bf16 v[32:47], v[200:203], a[116:119], v[32:47]
 ds_read_b64_tr_b16 v[196:197], v240 offset:55360
 ds_read_b64_tr_b16 v[198:199], v240 offset:56128
 s_waitcnt lgkmcnt(8)
 v_mfma_f32_32x32x16_bf16 v[48:63], v[204:207], a[116:119], v[48:63]
 ds_read_b64_tr_b16 v[200:201], v240 offset:55424
 ds_read_b64_tr_b16 v[202:203], v240 offset:56192
 s_waitcnt lgkmcnt(8)
 v_mfma_f32_32x32x16_bf16 v[64:79], v[208:211], a[116:119], v[64:79]
 ds_read_b64_tr_b16 v[204:205], v248 offset:2048
 ds_read_b64_tr_b16 v[206:207], v248 offset:2816
 s_waitcnt lgkmcnt(8)
 v_mfma_f32_32x32x16_bf16 v[80:95], v[212:215], a[116:119], v[80:95]
 ds_read_b64_tr_b16 v[208:209], v248 offset:2112
 ds_read_b64_tr_b16 v[210:211], v248 offset:2880
 s_waitcnt lgkmcnt(8)
 v_mfma_f32_32x32x16_bf16 v[0:15], v[192:195], a[120:123], v[0:15]
 ds_read_b64_tr_b16 v[212:213], v248 offset:2176
 ds_read_b64_tr_b16 v[214:215], v248 offset:2944
 s_waitcnt lgkmcnt(8)
 v_mfma_f32_32x32x16_bf16 v[16:31], v[196:199], a[120:123], v[16:31]
 ds_read_b64_tr_b16 v[192:193], v240 offset:58368
 ds_read_b64_tr_b16 v[194:195], v240 offset:59136
 s_waitcnt lgkmcnt(8)
 v_mfma_f32_32x32x16_bf16 v[32:47], v[200:203], a[120:123], v[32:47]
 ds_read_b64_tr_b16 v[196:197], v240 offset:58432
 ds_read_b64_tr_b16 v[198:199], v240 offset:59200
 s_waitcnt lgkmcnt(8)
 v_mfma_f32_32x32x16_bf16 v[48:63], v[204:207], a[120:123], v[48:63]
 ds_read_b64_tr_b16 v[200:201], v240 offset:58496
 ds_read_b64_tr_b16 v[202:203], v240 offset:59264
 s_waitcnt lgkmcnt(8)
 v_mfma_f32_32x32x16_bf16 v[64:79], v[208:211], a[120:123], v[64:79]
 ds_read_b64_tr_b16 v[204:205], v248 offset:5120
 ds_read_b64_tr_b16 v[206:207], v248 offset:5888
 s_waitcnt lgkmcnt(8)
 v_mfma_f32_32x32x16_bf16 v[80:95], v[212:215], a[120:123], v[80:95]
 ds_read_b64_tr_b16 v[208:209], v248 offset:5184
 ds_read_b64_tr_b16 v[210:211], v248 offset:5952
 s_waitcnt lgkmcnt(8)
 v_mfma_f32_32x32x16_bf16 v[0:15], v[192:195], a[124:127], v[0:15]
 ds_read_b64_tr_b16 v[212:213], v248 offset:5248
 ds_read_b64_tr_b16 v[214:215], v248 offset:6016
 s_waitcnt lgkmcnt(8)
 v_mfma_f32_32x32x16_bf16 v[16:31], v[196:199], a[124:127], v[16:31]
 ds_read_b64_tr_b16 v[192:193], v248 offset:8192
 ds_read_b64_tr_b16 v[194:195], v248 offset:8960
 s_waitcnt lgkmcnt(8)
 v_mfma_f32_32x32x16_bf16 v[32:47], v[200:203], a[124:127], v[32:47]
 ds_read_b64_tr_b16 v[196:197], v248 offset:8256
 ds_read_b64_tr_b16 v[198:199], v248 offset:9024
 s_waitcnt lgkmcnt(8)
 v_mfma_f32_32x32x16_bf16 v[48:63], v[204:207], a[124:127], v[48:63]
 ds_read_b64_tr_b16 v[200:201], v248 offset:8320
 ds_read_b64_tr_b16 v[202:203], v248 offset:9088
 s_waitcnt lgkmcnt(8)
 v_mfma_f32_32x32x16_bf16 v[64:79], v[208:211], a[124:127], v[64:79]
 ds_read_b64_tr_b16 v[204:205], v248 offset:20480
 ds_read_b64_tr_b16 v[206:207], v248 offset:21248
 s_waitcnt lgkmcnt(8)
 v_mfma_f32_32x32x16_bf16 v[80:95], v[212:215], a[124:127], v[80:95]
 s_waitcnt vmcnt(4)
 s_barrier
 ds_read_b64_tr_b16 v[208:209], v248 offset:20544
 ds_read_b64_tr_b16 v[210:211], v248 offset:21312
 s_waitcnt lgkmcnt(8)
 v_mfma_f32_32x32x16_bf16 v[0:15], v[192:195], a[128:131], v[0:15]
 ds_read_b64_tr_b16 v[212:213], v248 offset:20608
 ds_read_b64_tr_b16 v[214:215], v248 offset:21376
 s_waitcnt lgkmcnt(8)
 v_mfma_f32_32x32x16_bf16 v[16:31], v[196:199], a[128:131], v[16:31]
 ds_read_b64_tr_b16 v[192:193], v248 offset:11264
 ds_read_b64_tr_b16 v[194:195], v248 offset:12032
 s_waitcnt lgkmcnt(8)
 v_mfma_f32_32x32x16_bf16 v[32:47], v[200:203], a[128:131], v[32:47]
 ds_read_b64_tr_b16 v[196:197], v248 offset:11328
 ds_read_b64_tr_b16 v[198:199], v248 offset:12096
 s_waitcnt lgkmcnt(8)
 v_mfma_f32_32x32x16_bf16 v[48:63], v[204:207], a[128:131], v[48:63]
 ds_read_b64_tr_b16 v[200:201], v248 offset:11392
 ds_read_b64_tr_b16 v[202:203], v248 offset:12160
 s_waitcnt lgkmcnt(8)
 v_mfma_f32_32x32x16_bf16 v[64:79], v[208:211], a[128:131], v[64:79]
 ds_read_b64_tr_b16 v[204:205], v248 offset:23552
 ds_read_b64_tr_b16 v[206:207], v248 offset:24320
 s_waitcnt lgkmcnt(8)
 v_mfma_f32_32x32x16_bf16 v[80:95], v[212:215], a[128:131], v[80:95]
 ds_read_b64_tr_b16 v[208:209], v248 offset:23616
 ds_read_b64_tr_b16 v[210:211], v248 offset:24384
 s_waitcnt lgkmcnt(8)
 v_mfma_f32_32x32x16_bf16 v[0:15], v[192:195], a[132:135], v[0:15]
 ds_read_b64_tr_b16 v[212:213], v248 offset:23680
 ds_read_b64_tr_b16 v[214:215], v248 offset:24448
 s_waitcnt lgkmcnt(8)
 v_mfma_f32_32x32x16_bf16 v[16:31], v[196:199], a[132:135], v[16:31]
 ds_read_b64_tr_b16 v[192:193], v248 offset:14336
 ds_read_b64_tr_b16 v[194:195], v248 offset:15104
 s_waitcnt lgkmcnt(8)
 v_mfma_f32_32x32x16_bf16 v[32:47], v[200:203], a[132:135], v[32:47]
 ds_read_b64_tr_b16 v[196:197], v248 offset:14400
 ds_read_b64_tr_b16 v[198:199], v248 offset:15168
 s_waitcnt lgkmcnt(8)
 v_mfma_f32_32x32x16_bf16 v[48:63], v[204:207], a[132:135], v[48:63]
 ds_read_b64_tr_b16 v[200:201], v248 offset:14464
 ds_read_b64_tr_b16 v[202:203], v248 offset:15232
 s_waitcnt lgkmcnt(8)
 v_mfma_f32_32x32x16_bf16 v[64:79], v[208:211], a[132:135], v[64:79]
 ds_read_b64_tr_b16 v[204:205], v248 offset:26624
 ds_read_b64_tr_b16 v[206:207], v248 offset:27392
 s_waitcnt lgkmcnt(8)
 v_mfma_f32_32x32x16_bf16 v[80:95], v[212:215], a[132:135], v[80:95]
 ds_read_b64_tr_b16 v[208:209], v248 offset:26688
 ds_read_b64_tr_b16 v[210:211], v248 offset:27456
 s_waitcnt lgkmcnt(8)
 v_mfma_f32_32x32x16_bf16 v[0:15], v[192:195], a[136:139], v[0:15]
 ds_read_b64_tr_b16 v[212:213], v248 offset:26752
 ds_read_b64_tr_b16 v[214:215], v248 offset:27520
 s_waitcnt lgkmcnt(8)
 v_mfma_f32_32x32x16_bf16 v[16:31], v[196:199], a[136:139], v[16:31]
 ds_read_b64_tr_b16 v[192:193], v248 offset:17408
 ds_read_b64_tr_b16 v[194:195], v248 offset:18176
 s_waitcnt lgkmcnt(8)
 v_mfma_f32_32x32x16_bf16 v[32:47], v[200:203], a[136:139], v[32:47]
 ds_read_b64_tr_b16 v[196:197], v248 offset:17472
 ds_read_b64_tr_b16 v[198:199], v248 offset:18240
 s_waitcnt lgkmcnt(8)
 v_mfma_f32_32x32x16_bf16 v[48:63], v[204:207], a[136:139], v[48:63]
 ds_read_b64_tr_b16 v[200:201], v248 offset:17536
 ds_read_b64_tr_b16 v[202:203], v248 offset:18304
 s_waitcnt lgkmcnt(8)
 v_mfma_f32_32x32x16_bf16 v[64:79], v[208:211], a[136:139], v[64:79]
 ds_read_b64_tr_b16 v[204:205], v248 offset:29696
 ds_read_b64_tr_b16 v[206:207], v248 offset:30464
 s_waitcnt lgkmcnt(8)
 v_mfma_f32_32x32x16_bf16 v[80:95], v[212:215], a[136:139], v[80:95]
 ds_read_b64_tr_b16 v[208:209], v248 offset:29760
 ds_read_b64_tr_b16 v[210:211], v248 offset:30528
 s_waitcnt lgkmcnt(8)
 v_mfma_f32_32x32x16_bf16 v[0:15], v[192:195], a[140:143], v[0:15]
 ds_read_b64_tr_b16 v[212:213], v248 offset:29824
 ds_read_b64_tr_b16 v[214:215], v248 offset:30592
 s_waitcnt lgkmcnt(8)
 v_mfma_f32_32x32x16_bf16 v[16:31], v[196:199], a[140:143], v[16:31]
 ds_read_b64_tr_b16 v[192:193], v248 offset:32768
 ds_read_b64_tr_b16 v[194:195], v248 offset:33536
 s_waitcnt lgkmcnt(8)
 v_mfma_f32_32x32x16_bf16 v[32:47], v[200:203], a[140:143], v[32:47]
 ds_read_b64_tr_b16 v[196:197], v248 offset:32832
 ds_read_b64_tr_b16 v[198:199], v248 offset:33600
 s_waitcnt lgkmcnt(8)
 v_mfma_f32_32x32x16_bf16 v[48:63], v[204:207], a[140:143], v[48:63]
 ds_read_b64_tr_b16 v[200:201], v248 offset:32896
 ds_read_b64_tr_b16 v[202:203], v248 offset:33664
 s_waitcnt lgkmcnt(8)
 v_mfma_f32_32x32x16_bf16 v[64:79], v[208:211], a[140:143], v[64:79]
 ds_read_b64_tr_b16 v[204:205], v248 offset:45056
 ds_read_b64_tr_b16 v[206:207], v248 offset:45824
 s_waitcnt lgkmcnt(8)
 v_mfma_f32_32x32x16_bf16 v[80:95], v[212:215], a[140:143], v[80:95]
 s_barrier
 ds_read_b64_tr_b16 v[208:209], v248 offset:45120
 ds_read_b64_tr_b16 v[210:211], v248 offset:45888
 s_waitcnt vmcnt(0)
 s_waitcnt lgkmcnt(8)
 v_mfma_f32_32x32x16_bf16 v[0:15], v[192:195], a[144:147], v[0:15]
 ds_read_b64_tr_b16 v[212:213], v248 offset:45184
 ds_read_b64_tr_b16 v[214:215], v248 offset:45952
 s_waitcnt lgkmcnt(8)
 v_mfma_f32_32x32x16_bf16 v[16:31], v[196:199], a[144:147], v[16:31]
 ds_read_b64_tr_b16 v[192:193], v248 offset:35840
 ds_read_b64_tr_b16 v[194:195], v248 offset:36608
 s_waitcnt lgkmcnt(8)
 v_mfma_f32_32x32x16_bf16 v[32:47], v[200:203], a[144:147], v[32:47]
 ds_read_b64_tr_b16 v[196:197], v248 offset:35904
 ds_read_b64_tr_b16 v[198:199], v248 offset:36672
 s_waitcnt lgkmcnt(8)
 v_mfma_f32_32x32x16_bf16 v[48:63], v[204:207], a[144:147], v[48:63]
 ds_read_b64_tr_b16 v[200:201], v248 offset:35968
 ds_read_b64_tr_b16 v[202:203], v248 offset:36736
 s_waitcnt lgkmcnt(8)
 v_mfma_f32_32x32x16_bf16 v[64:79], v[208:211], a[144:147], v[64:79]
 ds_read_b64_tr_b16 v[204:205], v248 offset:48128
 ds_read_b64_tr_b16 v[206:207], v248 offset:48896
 s_waitcnt lgkmcnt(8)
 v_mfma_f32_32x32x16_bf16 v[80:95], v[212:215], a[144:147], v[80:95]
 ds_read_b64_tr_b16 v[208:209], v248 offset:48192
 ds_read_b64_tr_b16 v[210:211], v248 offset:48960
 s_waitcnt lgkmcnt(8)
 v_mfma_f32_32x32x16_bf16 v[0:15], v[192:195], a[148:151], v[0:15]
 ds_read_b64_tr_b16 v[212:213], v248 offset:48256
 ds_read_b64_tr_b16 v[214:215], v248 offset:49024
 s_waitcnt lgkmcnt(8)
 v_mfma_f32_32x32x16_bf16 v[16:31], v[196:199], a[148:151], v[16:31]
 ds_read_b64_tr_b16 v[192:193], v248 offset:38912
 ds_read_b64_tr_b16 v[194:195], v248 offset:39680
 s_waitcnt lgkmcnt(8)
 v_mfma_f32_32x32x16_bf16 v[32:47], v[200:203], a[148:151], v[32:47]
 ds_read_b64_tr_b16 v[196:197], v248 offset:38976
 ds_read_b64_tr_b16 v[198:199], v248 offset:39744
 s_waitcnt lgkmcnt(8)
 v_mfma_f32_32x32x16_bf16 v[48:63], v[204:207], a[148:151], v[48:63]
 ds_read_b64_tr_b16 v[200:201], v248 offset:39040
 ds_read_b64_tr_b16 v[202:203], v248 offset:39808
 s_waitcnt lgkmcnt(8)
 v_mfma_f32_32x32x16_bf16 v[64:79], v[208:211], a[148:151], v[64:79]
 ds_read_b64_tr_b16 v[204:205], v248 offset:51200
 ds_read_b64_tr_b16 v[206:207], v248 offset:51968
 s_waitcnt lgkmcnt(8)
 v_mfma_f32_32x32x16_bf16 v[80:95], v[212:215], a[148:151], v[80:95]
 ds_read_b64_tr_b16 v[208:209], v248 offset:51264
 ds_read_b64_tr_b16 v[210:211], v248 offset:52032
 s_waitcnt lgkmcnt(8)
 v_mfma_f32_32x32x16_bf16 v[0:15], v[192:195], a[152:155], v[0:15]
 ds_read_b64_tr_b16 v[212:213], v248 offset:51328
 ds_read_b64_tr_b16 v[214:215], v248 offset:52096
 s_waitcnt lgkmcnt(8)
 v_mfma_f32_32x32x16_bf16 v[16:31], v[196:199], a[152:155], v[16:31]
 ds_read_b64_tr_b16 v[192:193], v248 offset:41984
 ds_read_b64_tr_b16 v[194:195], v248 offset:42752
 s_waitcnt lgkmcnt(8)
 v_mfma_f32_32x32x16_bf16 v[32:47], v[200:203], a[152:155], v[32:47]
 ds_read_b64_tr_b16 v[196:197], v248 offset:42048
 ds_read_b64_tr_b16 v[198:199], v248 offset:42816
 s_waitcnt lgkmcnt(8)
 v_mfma_f32_32x32x16_bf16 v[48:63], v[204:207], a[152:155], v[48:63]
 ds_read_b64_tr_b16 v[200:201], v248 offset:42112
 ds_read_b64_tr_b16 v[202:203], v248 offset:42880
 s_waitcnt lgkmcnt(8)
 v_mfma_f32_32x32x16_bf16 v[64:79], v[208:211], a[152:155], v[64:79]
 ds_read_b64_tr_b16 v[204:205], v248 offset:54272
 ds_read_b64_tr_b16 v[206:207], v248 offset:55040
 s_waitcnt lgkmcnt(8)
 v_mfma_f32_32x32x16_bf16 v[80:95], v[212:215], a[152:155], v[80:95]
 ds_read_b64_tr_b16 v[208:209], v248 offset:54336
 ds_read_b64_tr_b16 v[210:211], v248 offset:55104
 s_waitcnt lgkmcnt(8)
 v_mfma_f32_32x32x16_bf16 v[0:15], v[192:195], a[156:159], v[0:15]
 ds_read_b64_tr_b16 v[212:213], v248 offset:54400
 ds_read_b64_tr_b16 v[214:215], v248 offset:55168
 s_waitcnt lgkmcnt(8)
 v_mfma_f32_32x32x16_bf16 v[16:31], v[196:199], a[156:159], v[16:31]
 s_waitcnt lgkmcnt(6)
 v_mfma_f32_32x32x16_bf16 v[32:47], v[200:203], a[156:159], v[32:47]
 s_waitcnt lgkmcnt(4)
 v_mfma_f32_32x32x16_bf16 v[48:63], v[204:207], a[156:159], v[48:63]
 s_waitcnt lgkmcnt(2)
 v_mfma_f32_32x32x16_bf16 v[64:79], v[208:211], a[156:159], v[64:79]
 s_waitcnt lgkmcnt(0)
 v_mfma_f32_32x32x16_bf16 v[80:95], v[212:215], a[156:159], v[80:95]
 s_lshl_b32 s53, s50, 2
 s_add_u32 s53, s53, s14
 s_mul_i32 s53, s53, 98304
 s_mul_i32 s28, s51, 6144
 s_add_u32 s53, s53, s28
 s_add_u32 s53, s53, 12582912
 s_mov_b32 s28, 0xbfb8aa3b
 s_nop 15
 v_mul_f32 v0, s28, v0
 v_mul_f32 v1, s28, v1
 v_mul_f32 v2, s28, v2
 v_mul_f32 v3, s28, v3
 v_mul_f32 v4, s28, v4
 v_mul_f32 v5, s28, v5
 v_mul_f32 v6, s28, v6
 v_mul_f32 v7, s28, v7
 v_mul_f32 v8, s28, v8
 v_mul_f32 v9, s28, v9
 v_mul_f32 v10, s28, v10
 v_mul_f32 v11, s28, v11
 v_mul_f32 v12, s28, v12
 v_mul_f32 v13, s28, v13
 v_mul_f32 v14, s28, v14
 v_mul_f32 v15, s28, v15
 v_exp_f32 v0, v0
 v_exp_f32 v1, v1
 v_exp_f32 v2, v2
 v_exp_f32 v3, v3
 v_exp_f32 v4, v4
 v_exp_f32 v5, v5
 v_exp_f32 v6, v6
 v_exp_f32 v7, v7
 v_exp_f32 v8, v8
 v_exp_f32 v9, v9
 v_exp_f32 v10, v10
 v_exp_f32 v11, v11
 v_exp_f32 v12, v12
 v_exp_f32 v13, v13
 v_exp_f32 v14, v14
 v_exp_f32 v15, v15
 v_add_f32 v0, 1.0, v0
 v_add_f32 v1, 1.0, v1
 v_add_f32 v2, 1.0, v2
 v_add_f32 v3, 1.0, v3
 v_add_f32 v4, 1.0, v4
 v_add_f32 v5, 1.0, v5
 v_add_f32 v6, 1.0, v6
 v_add_f32 v7, 1.0, v7
 v_add_f32 v8, 1.0, v8
 v_add_f32 v9, 1.0, v9
 v_add_f32 v10, 1.0, v10
 v_add_f32 v11, 1.0, v11
 v_add_f32 v12, 1.0, v12
 v_add_f32 v13, 1.0, v13
 v_add_f32 v14, 1.0, v14
 v_add_f32 v15, 1.0, v15
 v_rcp_f32 v0, v0
 v_rcp_f32 v1, v1
 v_rcp_f32 v2, v2
 v_rcp_f32 v3, v3
 v_rcp_f32 v4, v4
 v_rcp_f32 v5, v5
 v_rcp_f32 v6, v6
 v_rcp_f32 v7, v7
 v_rcp_f32 v8, v8
 v_rcp_f32 v9, v9
 v_rcp_f32 v10, v10
 v_rcp_f32 v11, v11
 v_rcp_f32 v12, v12
 v_rcp_f32 v13, v13
 v_rcp_f32 v14, v14
 v_rcp_f32 v15, v15
 v_mul_f32 v0, v0, v48
 v_mul_f32 v1, v1, v49
 v_mul_f32 v2, v2, v50
 v_mul_f32 v3, v3, v51
 v_mul_f32 v4, v4, v52
 v_mul_f32 v5, v5, v53
 v_mul_f32 v6, v6, v54
 v_mul_f32 v7, v7, v55
 v_mul_f32 v8, v8, v56
 v_mul_f32 v9, v9, v57
 v_mul_f32 v10, v10, v58
 v_mul_f32 v11, v11, v59
 v_mul_f32 v12, v12, v60
 v_mul_f32 v13, v13, v61
 v_mul_f32 v14, v14, v62
 v_mul_f32 v15, v15, v63
 v_cvt_pk_bf16_f32 v96, v0, v1
 v_cvt_pk_bf16_f32 v97, v2, v3
 v_cvt_pk_bf16_f32 v98, v4, v5
 v_cvt_pk_bf16_f32 v99, v6, v7
 v_cvt_pk_bf16_f32 v100, v8, v9
 v_cvt_pk_bf16_f32 v101, v10, v11
 v_cvt_pk_bf16_f32 v102, v12, v13
 v_cvt_pk_bf16_f32 v103, v14, v15
 buffer_store_dwordx4 v[96:99], v232, s[8:11], s53 offen offset:0 sc1
 buffer_store_dwordx4 v[100:103], v232, s[8:11], s53 offen offset:1024 sc1
 s_add_u32 s53, s53, 2048
 v_mul_f32 v16, s28, v16
 v_mul_f32 v17, s28, v17
 v_mul_f32 v18, s28, v18
 v_mul_f32 v19, s28, v19
 v_mul_f32 v20, s28, v20
 v_mul_f32 v21, s28, v21
 v_mul_f32 v22, s28, v22
 v_mul_f32 v23, s28, v23
 v_mul_f32 v24, s28, v24
 v_mul_f32 v25, s28, v25
 v_mul_f32 v26, s28, v26
 v_mul_f32 v27, s28, v27
 v_mul_f32 v28, s28, v28
 v_mul_f32 v29, s28, v29
 v_mul_f32 v30, s28, v30
 v_mul_f32 v31, s28, v31
 v_exp_f32 v16, v16
 v_exp_f32 v17, v17
 v_exp_f32 v18, v18
 v_exp_f32 v19, v19
 v_exp_f32 v20, v20
 v_exp_f32 v21, v21
 v_exp_f32 v22, v22
 v_exp_f32 v23, v23
 v_exp_f32 v24, v24
 v_exp_f32 v25, v25
 v_exp_f32 v26, v26
 v_exp_f32 v27, v27
 v_exp_f32 v28, v28
 v_exp_f32 v29, v29
 v_exp_f32 v30, v30
 v_exp_f32 v31, v31
 v_add_f32 v16, 1.0, v16
 v_add_f32 v17, 1.0, v17
 v_add_f32 v18, 1.0, v18
 v_add_f32 v19, 1.0, v19
 v_add_f32 v20, 1.0, v20
 v_add_f32 v21, 1.0, v21
 v_add_f32 v22, 1.0, v22
 v_add_f32 v23, 1.0, v23
 v_add_f32 v24, 1.0, v24
 v_add_f32 v25, 1.0, v25
 v_add_f32 v26, 1.0, v26
 v_add_f32 v27, 1.0, v27
 v_add_f32 v28, 1.0, v28
 v_add_f32 v29, 1.0, v29
 v_add_f32 v30, 1.0, v30
 v_add_f32 v31, 1.0, v31
 v_rcp_f32 v16, v16
 v_rcp_f32 v17, v17
 v_rcp_f32 v18, v18
 v_rcp_f32 v19, v19
 v_rcp_f32 v20, v20
 v_rcp_f32 v21, v21
 v_rcp_f32 v22, v22
 v_rcp_f32 v23, v23
 v_rcp_f32 v24, v24
 v_rcp_f32 v25, v25
 v_rcp_f32 v26, v26
 v_rcp_f32 v27, v27
 v_rcp_f32 v28, v28
 v_rcp_f32 v29, v29
 v_rcp_f32 v30, v30
 v_rcp_f32 v31, v31
 v_mul_f32 v16, v16, v64
 v_mul_f32 v17, v17, v65
 v_mul_f32 v18, v18, v66
 v_mul_f32 v19, v19, v67
 v_mul_f32 v20, v20, v68
 v_mul_f32 v21, v21, v69
 v_mul_f32 v22, v22, v70
 v_mul_f32 v23, v23, v71
 v_mul_f32 v24, v24, v72
 v_mul_f32 v25, v25, v73
 v_mul_f32 v26, v26, v74
 v_mul_f32 v27, v27, v75
 v_mul_f32 v28, v28, v76
 v_mul_f32 v29, v29, v77
 v_mul_f32 v30, v30, v78
 v_mul_f32 v31, v31, v79
 v_cvt_pk_bf16_f32 v104, v16, v17
 v_cvt_pk_bf16_f32 v105, v18, v19
 v_cvt_pk_bf16_f32 v106, v20, v21
 v_cvt_pk_bf16_f32 v107, v22, v23
 v_cvt_pk_bf16_f32 v108, v24, v25
 v_cvt_pk_bf16_f32 v109, v26, v27
 v_cvt_pk_bf16_f32 v110, v28, v29
 v_cvt_pk_bf16_f32 v111, v30, v31
 buffer_store_dwordx4 v[104:107], v232, s[8:11], s53 offen offset:0 sc1
 buffer_store_dwordx4 v[108:111], v232, s[8:11], s53 offen offset:1024 sc1
 s_add_u32 s53, s53, 2048
 v_mul_f32 v32, s28, v32
 v_mul_f32 v33, s28, v33
 v_mul_f32 v34, s28, v34
 v_mul_f32 v35, s28, v35
 v_mul_f32 v36, s28, v36
 v_mul_f32 v37, s28, v37
 v_mul_f32 v38, s28, v38
 v_mul_f32 v39, s28, v39
 v_mul_f32 v40, s28, v40
 v_mul_f32 v41, s28, v41
 v_mul_f32 v42, s28, v42
 v_mul_f32 v43, s28, v43
 v_mul_f32 v44, s28, v44
 v_mul_f32 v45, s28, v45
 v_mul_f32 v46, s28, v46
 v_mul_f32 v47, s28, v47
 v_exp_f32 v32, v32
 v_exp_f32 v33, v33
 v_exp_f32 v34, v34
 v_exp_f32 v35, v35
 v_exp_f32 v36, v36
 v_exp_f32 v37, v37
 v_exp_f32 v38, v38
 v_exp_f32 v39, v39
 v_exp_f32 v40, v40
 v_exp_f32 v41, v41
 v_exp_f32 v42, v42
 v_exp_f32 v43, v43
 v_exp_f32 v44, v44
 v_exp_f32 v45, v45
 v_exp_f32 v46, v46
 v_exp_f32 v47, v47
 v_add_f32 v32, 1.0, v32
 v_add_f32 v33, 1.0, v33
 v_add_f32 v34, 1.0, v34
 v_add_f32 v35, 1.0, v35
 v_add_f32 v36, 1.0, v36
 v_add_f32 v37, 1.0, v37
 v_add_f32 v38, 1.0, v38
 v_add_f32 v39, 1.0, v39
 v_add_f32 v40, 1.0, v40
 v_add_f32 v41, 1.0, v41
 v_add_f32 v42, 1.0, v42
 v_add_f32 v43, 1.0, v43
 v_add_f32 v44, 1.0, v44
 v_add_f32 v45, 1.0, v45
 v_add_f32 v46, 1.0, v46
 v_add_f32 v47, 1.0, v47
 v_rcp_f32 v32, v32
 v_rcp_f32 v33, v33
 v_rcp_f32 v34, v34
 v_rcp_f32 v35, v35
 v_rcp_f32 v36, v36
 v_rcp_f32 v37, v37
 v_rcp_f32 v38, v38
 v_rcp_f32 v39, v39
 v_rcp_f32 v40, v40
 v_rcp_f32 v41, v41
 v_rcp_f32 v42, v42
 v_rcp_f32 v43, v43
 v_rcp_f32 v44, v44
 v_rcp_f32 v45, v45
 v_rcp_f32 v46, v46
 v_rcp_f32 v47, v47
 v_mul_f32 v32, v32, v80
 v_mul_f32 v33, v33, v81
 v_mul_f32 v34, v34, v82
 v_mul_f32 v35, v35, v83
 v_mul_f32 v36, v36, v84
 v_mul_f32 v37, v37, v85
 v_mul_f32 v38, v38, v86
 v_mul_f32 v39, v39, v87
 v_mul_f32 v40, v40, v88
 v_mul_f32 v41, v41, v89
 v_mul_f32 v42, v42, v90
 v_mul_f32 v43, v43, v91
 v_mul_f32 v44, v44, v92
 v_mul_f32 v45, v45, v93
 v_mul_f32 v46, v46, v94
 v_mul_f32 v47, v47, v95
 v_cvt_pk_bf16_f32 v112, v32, v33
 v_cvt_pk_bf16_f32 v113, v34, v35
 v_cvt_pk_bf16_f32 v114, v36, v37
 v_cvt_pk_bf16_f32 v115, v38, v39
 v_cvt_pk_bf16_f32 v116, v40, v41
 v_cvt_pk_bf16_f32 v117, v42, v43
 v_cvt_pk_bf16_f32 v118, v44, v45
 v_cvt_pk_bf16_f32 v119, v46, v47
 buffer_store_dwordx4 v[112:115], v232, s[8:11], s53 offen offset:0 sc1
 buffer_store_dwordx4 v[116:119], v232, s[8:11], s53 offen offset:1024 sc1
 s_add_u32 s53, s53, 2048
 s_lshl_b32 s28, s50, 7
 s_add_u32 s28, s28, 6332416
 s_waitcnt vmcnt(0)
 s_barrier
 s_cmp_eq_u32 s14, 0
 s_cbranch_scc0 sg_56
 s_mov_b64 exec, 1
 v_mov_b32 v233, 0
 v_mov_b32 v234, 1
 buffer_atomic_add v234, v233, s[8:11], s28 offen sc1
 s_mov_b64 exec, -1
sg_56:
 s_branch wk_next
wk_n2:
 s_sub_u32 s48, s18, 384
 s_mul_i32 s28, s48, 0x5556
 s_lshr_b32 s28, s28, 16
 s_mul_i32 s29, s28, 3
 s_sub_u32 s29, s48, s29
 s_lshr_b32 s50, s28, 6
 s_mul_i32 s50, s50, 3
 s_add_u32 s50, s50, s29
 s_add_u32 s50, s50, 4
 s_and_b32 s49, s28, 63
 s_mul_i32 s28, s17, 0x2aab
 s_lshr_b32 s28, s28, 16
 s_mul_i32 s29, s28, 6
 s_sub_u32 s48, s17, s29
 s_lshl_b32 s28, s28, 1
 s_and_b32 s29, s48, 1
 s_add_u32 s29, s29, s28
 s_cmp_lt_u32 s18, 192
 s_cselect_b32 s28, 1, 3
 s_cmp_lt_u32 s18, 384
 s_cselect_b32 s50, s28, s50
 s_cselect_b32 s49, s29, s49
 s_cselect_b32 s48, s48, 7
 s_lshr_b32 s51, s49, 1
 v_accvgpr_read_b32 v240, a200
 v_accvgpr_read_b32 v241, a201
 v_accvgpr_read_b32 v242, a203
 v_accvgpr_read_b32 v243, a204
 v_accvgpr_read_b32 v239, a205
 v_accvgpr_read_b32 v244, a226
 v_accvgpr_read_b32 v245, a227
 v_accvgpr_read_b32 v236, a214
 v_accvgpr_read_b32 v237, a215
 v_accvgpr_read_b32 v238, a216
 v_add_u32 v248, 0x10000, v240
 v_add_u32 v249, 0x10000, v241
 v_add_u32 v250, 0x10000, v242
 v_add_u32 v251, 0x10000, v243
 s_cmp_lt_u32 s48, 4
 s_cbranch_scc1 wk_sp
 s_bitcmp1_b32 s49, 0
 s_cbranch_scc1 wk_vu
 s_mul_i32 s52, s51, 384
 s_lshl_b32 s48, s50, 2
 s_add_u32 s48, s48, s14
 s_mul_i32 s48, s48, 40960
 s_lshl_b32 s53, s50, 2
 s_add_u32 s53, s53, s14
 s_lshl_b32 s53, s53, 5
 s_add_u32 s53, s53, s51
 s_mul_i32 s53, s53, 12288
 s_add_u32 s54, s53, 46137344
 s_add_u32 s53, s53, 71303168
 s_add_u32 m0, s19, 0
 s_add_u32 s29, s52, 0
 buffer_load_dwordx4 v236, s[20:23], s29 offen lds
 s_add_u32 m0, s19, 1024
 s_add_u32 s29, s52, 0
 buffer_load_dwordx4 v237, s[20:23], s29 offen lds
 s_add_u32 m0, s19, 2048
 s_add_u32 s29, s52, 0
 buffer_load_dwordx4 v238, s[20:23], s29 offen lds
 s_add_u32 m0, s19, 3072
 s_add_u32 s29, s52, 98304
 buffer_load_dwordx4 v236, s[20:23], s29 offen lds
 s_add_u32 m0, s19, 4096
 s_add_u32 s29, s52, 98304
 buffer_load_dwordx4 v237, s[20:23], s29 offen lds
 s_add_u32 m0, s19, 5120
 s_add_u32 s29, s52, 98304
 buffer_load_dwordx4 v238, s[20:23], s29 offen lds
 buffer_load_dwordx4 a[0:3], v232, s[8:11], s48 offen offset:0
 buffer_load_dwordx4 a[4:7], v232, s[8:11], s48 offen offset:1024
 buffer_load_dwordx4 a[8:11], v232, s[8:11], s48 offen offset:2048
 buffer_load_dwordx4 a[12:15], v232, s[8:11], s48 offen offset:3072
 s_add_u32 s48, s48, 4096
 s_add_u32 m0, s19, 24576
 s_add_u32 s29, s52, 786432
 buffer_load_dwordx4 v236, s[20:23], s29 offen lds
 s_add_u32 m0, s19, 25600
 s_add_u32 s29, s52, 786432
 buffer_load_dwordx4 v237, s[20:23], s29 offen lds
 s_add_u32 m0, s19, 26624
 s_add_u32 s29, s52, 786432
 buffer_load_dwordx4 v238, s[20:23], s29 offen lds
 s_add_u32 m0, s19, 27648
 s_add_u32 s29, s52, 884736
 buffer_load_dwordx4 v236, s[20:23], s29 offen lds
 s_add_u32 m0, s19, 28672
 s_add_u32 s29, s52, 884736
 buffer_load_dwordx4 v237, s[20:23], s29 offen lds
 s_add_u32 m0, s19, 29696
 s_add_u32 s29, s52, 884736
 buffer_load_dwordx4 v238, s[20:23], s29 offen lds
 buffer_load_dwordx4 a[16:19], v232, s[8:11], s48 offen offset:0
 buffer_load_dwordx4 a[20:23], v232, s[8:11], s48 offen offset:1024
 buffer_load_dwordx4 a[24:27], v232, s[8:11], s48 offen offset:2048
 buffer_load_dwordx4 a[28:31], v232, s[8:11], s48 offen offset:3072
 s_add_u32 s48, s48, 4096
 s_add_u32 m0, s19, 49152
 s_add_u32 s29, s52, 1572864
 buffer_load_dwordx4 v236, s[20:23], s29 offen lds
 s_add_u32 m0, s19, 50176
 s_add_u32 s29, s52, 1572864
 buffer_load_dwordx4 v237, s[20:23], s29 offen lds
 s_add_u32 m0, s19, 51200
 s_add_u32 s29, s52, 1572864
 buffer_load_dwordx4 v238, s[20:23], s29 offen lds
 s_add_u32 m0, s19, 52224
 s_add_u32 s29, s52, 1671168
 buffer_load_dwordx4 v236, s[20:23], s29 offen lds
 s_add_u32 m0, s19, 53248
 s_add_u32 s29, s52, 1671168
 buffer_load_dwordx4 v237, s[20:23], s29 offen lds
 s_add_u32 m0, s19, 54272
 s_add_u32 s29, s52, 1671168
 buffer_load_dwordx4 v238, s[20:23], s29 offen lds
 buffer_load_dwordx4 a[32:35], v232, s[8:11], s48 offen offset:0
 buffer_load_dwordx4 a[36:39], v232, s[8:11], s48 offen offset:1024
 buffer_load_dwordx4 a[40:43], v232, s[8:11], s48 offen offset:2048
 buffer_load_dwordx4 a[44:47], v232, s[8:11], s48 offen offset:3072
 s_add_u32 s48, s48, 4096
 s_add_u32 m0, s19, 73728
 s_add_u32 s29, s52, 2359296
 buffer_load_dwordx4 v236, s[20:23], s29 offen lds
 s_add_u32 m0, s19, 74752
 s_add_u32 s29, s52, 2359296
 buffer_load_dwordx4 v237, s[20:23], s29 offen lds
 s_add_u32 m0, s19, 75776
 s_add_u32 s29, s52, 2359296
 buffer_load_dwordx4 v238, s[20:23], s29 offen lds
 s_add_u32 m0, s19, 76800
 s_add_u32 s29, s52, 2457600
 buffer_load_dwordx4 v236, s[20:23], s29 offen lds
 s_add_u32 m0, s19, 77824
 s_add_u32 s29, s52, 2457600
 buffer_load_dwordx4 v237, s[20:23], s29 offen lds
 s_add_u32 m0, s19, 78848
 s_add_u32 s29, s52, 2457600
 buffer_load_dwordx4 v238, s[20:23], s29 offen lds
 buffer_load_dwordx4 a[48:51], v232, s[8:11], s48 offen offset:0
 buffer_load_dwordx4 a[52:55], v232, s[8:11], s48 offen offset:1024
 buffer_load_dwordx4 a[56:59], v232, s[8:11], s48 offen offset:2048
 buffer_load_dwordx4 a[60:63], v232, s[8:11], s48 offen offset:3072
 s_add_u32 s48, s48, 4096
 s_waitcnt vmcnt(34)
 s_waitcnt vmcnt(24)
 s_barrier
 ds_read_b64_tr_b16 v[192:193], v240 offset:0
 ds_read_b64_tr_b16 v[194:195], v240 offset:1536
 ds_read_b64_tr_b16 v[196:197], v241 offset:64
 ds_read_b64_tr_b16 v[198:199], v241 offset:1600
 ds_read_b64_tr_b16 v[200:201], v240 offset:128
 ds_read_b64_tr_b16 v[202:203], v240 offset:1664
 ds_read_b64_tr_b16 v[204:205], v241 offset:192
 ds_read_b64_tr_b16 v[206:207], v241 offset:1728
 ds_read_b64_tr_b16 v[208:209], v240 offset:256
 ds_read_b64_tr_b16 v[210:211], v240 offset:1792
 s_waitcnt lgkmcnt(8)
 v_mfma_f32_32x32x16_bf16 v[0:15], v[192:195], a[0:3], 0
 ds_read_b64_tr_b16 v[212:213], v241 offset:320
 ds_read_b64_tr_b16 v[214:215], v241 offset:1856
 s_waitcnt lgkmcnt(8)
 v_mfma_f32_32x32x16_bf16 v[16:31], v[196:199], a[0:3], 0
 s_add_u32 m0, s19, 98304
 s_add_u32 s29, s52, 3145728
 buffer_load_dwordx4 v236, s[20:23], s29 offen lds
 s_add_u32 m0, s19, 99328
 s_add_u32 s29, s52, 3145728
 buffer_load_dwordx4 v237, s[20:23], s29 offen lds
 s_add_u32 m0, s19, 100352
 s_add_u32 s29, s52, 3145728
 buffer_load_dwordx4 v238, s[20:23], s29 offen lds
 s_add_u32 m0, s19, 101376
 s_add_u32 s29, s52, 3244032
 buffer_load_dwordx4 v236, s[20:23], s29 offen lds
 s_add_u32 m0, s19, 102400
 s_add_u32 s29, s52, 3244032
 buffer_load_dwordx4 v237, s[20:23], s29 offen lds
 s_add_u32 m0, s19, 103424
 s_add_u32 s29, s52, 3244032
 buffer_load_dwordx4 v238, s[20:23], s29 offen lds
 ds_read_b64_tr_b16 v[192:193], v240 offset:6144
 ds_read_b64_tr_b16 v[194:195], v240 offset:7680
 s_waitcnt lgkmcnt(8)
 v_mfma_f32_32x32x16_bf16 v[32:47], v[200:203], a[0:3], 0
 ds_read_b64_tr_b16 v[196:197], v241 offset:6208
 ds_read_b64_tr_b16 v[198:199], v241 offset:7744
 s_waitcnt lgkmcnt(8)
 v_mfma_f32_32x32x16_bf16 v[48:63], v[204:207], a[0:3], 0
 ds_read_b64_tr_b16 v[200:201], v240 offset:6272
 ds_read_b64_tr_b16 v[202:203], v240 offset:7808
 s_waitcnt lgkmcnt(8)
 v_mfma_f32_32x32x16_bf16 v[64:79], v[208:211], a[0:3], 0
 ds_read_b64_tr_b16 v[204:205], v241 offset:6336
 ds_read_b64_tr_b16 v[206:207], v241 offset:7872
 s_waitcnt lgkmcnt(8)
 v_mfma_f32_32x32x16_bf16 v[80:95], v[212:215], a[0:3], 0
 ds_read_b64_tr_b16 v[208:209], v240 offset:6400
 ds_read_b64_tr_b16 v[210:211], v240 offset:7936
 s_waitcnt lgkmcnt(8)
 v_mfma_f32_32x32x16_bf16 v[0:15], v[192:195], a[4:7], v[0:15]
 ds_read_b64_tr_b16 v[212:213], v241 offset:6464
 ds_read_b64_tr_b16 v[214:215], v241 offset:8000
 s_waitcnt lgkmcnt(8)
 v_mfma_f32_32x32x16_bf16 v[16:31], v[196:199], a[4:7], v[16:31]
 ds_read_b64_tr_b16 v[192:193], v240 offset:12288
 ds_read_b64_tr_b16 v[194:195], v240 offset:13824
 s_waitcnt lgkmcnt(8)
 v_mfma_f32_32x32x16_bf16 v[32:47], v[200:203], a[4:7], v[32:47]
 buffer_load_dwordx4 a[64:67], v232, s[8:11], s48 offen offset:0
 buffer_load_dwordx4 a[68:71], v232, s[8:11], s48 offen offset:1024
 buffer_load_dwordx4 a[72:75], v232, s[8:11], s48 offen offset:2048
 buffer_load_dwordx4 a[76:79], v232, s[8:11], s48 offen offset:3072
 s_add_u32 s48, s48, 4096
 ds_read_b64_tr_b16 v[196:197], v241 offset:12352
 ds_read_b64_tr_b16 v[198:199], v241 offset:13888
 s_waitcnt lgkmcnt(8)
 v_mfma_f32_32x32x16_bf16 v[48:63], v[204:207], a[4:7], v[48:63]
 ds_read_b64_tr_b16 v[200:201], v240 offset:12416
 ds_read_b64_tr_b16 v[202:203], v240 offset:13952
 s_waitcnt lgkmcnt(8)
 v_mfma_f32_32x32x16_bf16 v[64:79], v[208:211], a[4:7], v[64:79]
 ds_read_b64_tr_b16 v[204:205], v241 offset:12480
 ds_read_b64_tr_b16 v[206:207], v241 offset:14016
 s_waitcnt lgkmcnt(8)
 v_mfma_f32_32x32x16_bf16 v[80:95], v[212:215], a[4:7], v[80:95]
 ds_read_b64_tr_b16 v[208:209], v240 offset:12544
 ds_read_b64_tr_b16 v[210:211], v240 offset:14080
 s_waitcnt lgkmcnt(8)
 v_mfma_f32_32x32x16_bf16 v[0:15], v[192:195], a[8:11], v[0:15]
 ds_read_b64_tr_b16 v[212:213], v241 offset:12608
 ds_read_b64_tr_b16 v[214:215], v241 offset:14144
 s_waitcnt lgkmcnt(8)
 v_mfma_f32_32x32x16_bf16 v[16:31], v[196:199], a[8:11], v[16:31]
 ds_read_b64_tr_b16 v[192:193], v240 offset:18432
 ds_read_b64_tr_b16 v[194:195], v240 offset:19968
 s_waitcnt lgkmcnt(8)
 v_mfma_f32_32x32x16_bf16 v[32:47], v[200:203], a[8:11], v[32:47]
 ds_read_b64_tr_b16 v[196:197], v241 offset:18496
 ds_read_b64_tr_b16 v[198:199], v241 offset:20032
 s_waitcnt lgkmcnt(8)
 v_mfma_f32_32x32x16_bf16 v[48:63], v[204:207], a[8:11], v[48:63]
 ds_read_b64_tr_b16 v[200:201], v240 offset:18560
 ds_read_b64_tr_b16 v[202:203], v240 offset:20096
 s_waitcnt lgkmcnt(8)
 v_mfma_f32_32x32x16_bf16 v[64:79], v[208:211], a[8:11], v[64:79]
 ds_read_b64_tr_b16 v[204:205], v241 offset:18624
 ds_read_b64_tr_b16 v[206:207], v241 offset:20160
 s_waitcnt lgkmcnt(8)
 v_mfma_f32_32x32x16_bf16 v[80:95], v[212:215], a[8:11], v[80:95]
 ds_read_b64_tr_b16 v[208:209], v240 offset:18688
 ds_read_b64_tr_b16 v[210:211], v240 offset:20224
 s_waitcnt lgkmcnt(8)
 v_mfma_f32_32x32x16_bf16 v[0:15], v[192:195], a[12:15], v[0:15]
 ds_read_b64_tr_b16 v[212:213], v241 offset:18752
 ds_read_b64_tr_b16 v[214:215], v241 offset:20288
 s_waitcnt lgkmcnt(8)
 v_mfma_f32_32x32x16_bf16 v[16:31], v[196:199], a[12:15], v[16:31]
 ds_read_b64_tr_b16 v[192:193], v240 offset:24576
 ds_read_b64_tr_b16 v[194:195], v240 offset:26112
 s_waitcnt lgkmcnt(8)
 v_mfma_f32_32x32x16_bf16 v[32:47], v[200:203], a[12:15], v[32:47]
 ds_read_b64_tr_b16 v[196:197], v241 offset:24640
 ds_read_b64_tr_b16 v[198:199], v241 offset:26176
 s_waitcnt lgkmcnt(8)
 v_mfma_f32_32x32x16_bf16 v[48:63], v[204:207], a[12:15], v[48:63]
 ds_read_b64_tr_b16 v[200:201], v240 offset:24704
 ds_read_b64_tr_b16 v[202:203], v240 offset:26240
 s_waitcnt lgkmcnt(8)
 v_mfma_f32_32x32x16_bf16 v[64:79], v[208:211], a[12:15], v[64:79]
 ds_read_b64_tr_b16 v[204:205], v241 offset:24768
 ds_read_b64_tr_b16 v[206:207], v241 offset:26304
 s_waitcnt lgkmcnt(8)
 v_mfma_f32_32x32x16_bf16 v[80:95], v[212:215], a[12:15], v[80:95]
 s_waitcnt vmcnt(24)
 s_barrier
 ds_read_b64_tr_b16 v[208:209], v240 offset:24832
 ds_read_b64_tr_b16 v[210:211], v240 offset:26368
 s_waitcnt lgkmcnt(8)
 v_mfma_f32_32x32x16_bf16 v[0:15], v[192:195], a[16:19], v[0:15]
 ds_read_b64_tr_b16 v[212:213], v241 offset:24896
 ds_read_b64_tr_b16 v[214:215], v241 offset:26432
 s_waitcnt lgkmcnt(8)
 v_mfma_f32_32x32x16_bf16 v[16:31], v[196:199], a[16:19], v[16:31]
 s_add_u32 m0, s19, 0
 s_add_u32 s29, s52, 3932160
 buffer_load_dwordx4 v236, s[20:23], s29 offen lds
 s_add_u32 m0, s19, 1024
 s_add_u32 s29, s52, 3932160
 buffer_load_dwordx4 v237, s[20:23], s29 offen lds
 s_add_u32 m0, s19, 2048
 s_add_u32 s29, s52, 3932160
 buffer_load_dwordx4 v238, s[20:23], s29 offen lds
 s_add_u32 m0, s19, 3072
 s_add_u32 s29, s52, 4030464
 buffer_load_dwordx4 v236, s[20:23], s29 offen lds
 s_add_u32 m0, s19, 4096
 s_add_u32 s29, s52, 4030464
 buffer_load_dwordx4 v237, s[20:23], s29 offen lds
 s_add_u32 m0, s19, 5120
 s_add_u32 s29, s52, 4030464
 buffer_load_dwordx4 v238, s[20:23], s29 offen lds
 ds_read_b64_tr_b16 v[192:193], v240 offset:30720
 ds_read_b64_tr_b16 v[194:195], v240 offset:32256
 s_waitcnt lgkmcnt(8)
 v_mfma_f32_32x32x16_bf16 v[32:47], v[200:203], a[16:19], v[32:47]
 ds_read_b64_tr_b16 v[196:197], v241 offset:30784
 ds_read_b64_tr_b16 v[198:199], v241 offset:32320
 s_waitcnt lgkmcnt(8)
 v_mfma_f32_32x32x16_bf16 v[48:63], v[204:207], a[16:19], v[48:63]
 ds_read_b64_tr_b16 v[200:201], v240 offset:30848
 ds_read_b64_tr_b16 v[202:203], v240 offset:32384
 s_waitcnt lgkmcnt(8)
 v_mfma_f32_32x32x16_bf16 v[64:79], v[208:211], a[16:19], v[64:79]
 ds_read_b64_tr_b16 v[204:205], v241 offset:30912
 ds_read_b64_tr_b16 v[206:207], v241 offset:32448
 s_waitcnt lgkmcnt(8)
 v_mfma_f32_32x32x16_bf16 v[80:95], v[212:215], a[16:19], v[80:95]
 ds_read_b64_tr_b16 v[208:209], v240 offset:30976
 ds_read_b64_tr_b16 v[210:211], v240 offset:32512
 s_waitcnt lgkmcnt(8)
 v_mfma_f32_32x32x16_bf16 v[0:15], v[192:195], a[20:23], v[0:15]
 ds_read_b64_tr_b16 v[212:213], v241 offset:31040
 ds_read_b64_tr_b16 v[214:215], v241 offset:32576
 s_waitcnt lgkmcnt(8)
 v_mfma_f32_32x32x16_bf16 v[16:31], v[196:199], a[20:23], v[16:31]
 ds_read_b64_tr_b16 v[192:193], v240 offset:36864
 ds_read_b64_tr_b16 v[194:195], v240 offset:38400
 s_waitcnt lgkmcnt(8)
 v_mfma_f32_32x32x16_bf16 v[32:47], v[200:203], a[20:23], v[32:47]
 buffer_load_dwordx4 a[80:83], v232, s[8:11], s48 offen offset:0
 buffer_load_dwordx4 a[84:87], v232, s[8:11], s48 offen offset:1024
 buffer_load_dwordx4 a[88:91], v232, s[8:11], s48 offen offset:2048
 buffer_load_dwordx4 a[92:95], v232, s[8:11], s48 offen offset:3072
 s_add_u32 s48, s48, 4096
 ds_read_b64_tr_b16 v[196:197], v241 offset:36928
 ds_read_b64_tr_b16 v[198:199], v241 offset:38464
 s_waitcnt lgkmcnt(8)
 v_mfma_f32_32x32x16_bf16 v[48:63], v[204:207], a[20:23], v[48:63]
 ds_read_b64_tr_b16 v[200:201], v240 offset:36992
 ds_read_b64_tr_b16 v[202:203], v240 offset:38528
 s_waitcnt lgkmcnt(8)
 v_mfma_f32_32x32x16_bf16 v[64:79], v[208:211], a[20:23], v[64:79]
 ds_read_b64_tr_b16 v[204:205], v241 offset:37056
 ds_read_b64_tr_b16 v[206:207], v241 offset:38592
 s_waitcnt lgkmcnt(8)
 v_mfma_f32_32x32x16_bf16 v[80:95], v[212:215], a[20:23], v[80:95]
 ds_read_b64_tr_b16 v[208:209], v240 offset:37120
 ds_read_b64_tr_b16 v[210:211], v240 offset:38656
 s_waitcnt lgkmcnt(8)
 v_mfma_f32_32x32x16_bf16 v[0:15], v[192:195], a[24:27], v[0:15]
 ds_read_b64_tr_b16 v[212:213], v241 offset:37184
 ds_read_b64_tr_b16 v[214:215], v241 offset:38720
 s_waitcnt lgkmcnt(8)
 v_mfma_f32_32x32x16_bf16 v[16:31], v[196:199], a[24:27], v[16:31]
 ds_read_b64_tr_b16 v[192:193], v240 offset:43008
 ds_read_b64_tr_b16 v[194:195], v240 offset:44544
 s_waitcnt lgkmcnt(8)
 v_mfma_f32_32x32x16_bf16 v[32:47], v[200:203], a[24:27], v[32:47]
 ds_read_b64_tr_b16 v[196:197], v241 offset:43072
 ds_read_b64_tr_b16 v[198:199], v241 offset:44608
 s_waitcnt lgkmcnt(8)
 v_mfma_f32_32x32x16_bf16 v[48:63], v[204:207], a[24:27], v[48:63]
 ds_read_b64_tr_b16 v[200:201], v240 offset:43136
 ds_read_b64_tr_b16 v[202:203], v240 offset:44672
 s_waitcnt lgkmcnt(8)
 v_mfma_f32_32x32x16_bf16 v[64:79], v[208:211], a[24:27], v[64:79]
 ds_read_b64_tr_b16 v[204:205], v241 offset:43200
 ds_read_b64_tr_b16 v[206:207], v241 offset:44736
 s_waitcnt lgkmcnt(8)
 v_mfma_f32_32x32x16_bf16 v[80:95], v[212:215], a[24:27], v[80:95]
 ds_read_b64_tr_b16 v[208:209], v240 offset:43264
 ds_read_b64_tr_b16 v[210:211], v240 offset:44800
 s_waitcnt lgkmcnt(8)
 v_mfma_f32_32x32x16_bf16 v[0:15], v[192:195], a[28:31], v[0:15]
 ds_read_b64_tr_b16 v[212:213], v241 offset:43328
 ds_read_b64_tr_b16 v[214:215], v241 offset:44864
 s_waitcnt lgkmcnt(8)
 v_mfma_f32_32x32x16_bf16 v[16:31], v[196:199], a[28:31], v[16:31]
 ds_read_b64_tr_b16 v[192:193], v240 offset:49152
 ds_read_b64_tr_b16 v[194:195], v240 offset:50688
 s_waitcnt lgkmcnt(8)
 v_mfma_f32_32x32x16_bf16 v[32:47], v[200:203], a[28:31], v[32:47]
 ds_read_b64_tr_b16 v[196:197], v241 offset:49216
 ds_read_b64_tr_b16 v[198:199], v241 offset:50752
 s_waitcnt lgkmcnt(8)
 v_mfma_f32_32x32x16_bf16 v[48:63], v[204:207], a[28:31], v[48:63]
 ds_read_b64_tr_b16 v[200:201], v240 offset:49280
 ds_read_b64_tr_b16 v[202:203], v240 offset:50816
 s_waitcnt lgkmcnt(8)
 v_mfma_f32_32x32x16_bf16 v[64:79], v[208:211], a[28:31], v[64:79]
 ds_read_b64_tr_b16 v[204:205], v241 offset:49344
 ds_read_b64_tr_b16 v[206:207], v241 offset:50880
 s_waitcnt lgkmcnt(8)
 v_mfma_f32_32x32x16_bf16 v[80:95], v[212:215], a[28:31], v[80:95]
 s_waitcnt vmcnt(24)
 s_barrier
 ds_read_b64_tr_b16 v[208:209], v240 offset:49408
 ds_read_b64_tr_b16 v[210:211], v240 offset:50944
 s_waitcnt lgkmcnt(8)
 v_mfma_f32_32x32x16_bf16 v[0:15], v[192:195], a[32:35], v[0:15]
 ds_read_b64_tr_b16 v[212:213], v241 offset:49472
 ds_read_b64_tr_b16 v[214:215], v241 offset:51008
 s_waitcnt lgkmcnt(8)
 v_mfma_f32_32x32x16_bf16 v[16:31], v[196:199], a[32:35], v[16:31]
 s_add_u32 m0, s19, 24576
 s_add_u32 s29, s52, 4718592
 buffer_load_dwordx4 v236, s[20:23], s29 offen lds
 s_add_u32 m0, s19, 25600
 s_add_u32 s29, s52, 4718592
 buffer_load_dwordx4 v237, s[20:23], s29 offen lds
 s_add_u32 m0, s19, 26624
 s_add_u32 s29, s52, 4718592
 buffer_load_dwordx4 v238, s[20:23], s29 offen lds
 s_add_u32 m0, s19, 27648
 s_add_u32 s29, s52, 4816896
 buffer_load_dwordx4 v236, s[20:23], s29 offen lds
 s_add_u32 m0, s19, 28672
 s_add_u32 s29, s52, 4816896
 buffer_load_dwordx4 v237, s[20:23], s29 offen lds
 s_add_u32 m0, s19, 29696
 s_add_u32 s29, s52, 4816896
 buffer_load_dwordx4 v238, s[20:23], s29 offen lds
 ds_read_b64_tr_b16 v[192:193], v240 offset:55296
 ds_read_b64_tr_b16 v[194:195], v240 offset:56832
 s_waitcnt lgkmcnt(8)
 v_mfma_f32_32x32x16_bf16 v[32:47], v[200:203], a[32:35], v[32:47]
 ds_read_b64_tr_b16 v[196:197], v241 offset:55360
 ds_read_b64_tr_b16 v[198:199], v241 offset:56896
 s_waitcnt lgkmcnt(8)
 v_mfma_f32_32x32x16_bf16 v[48:63], v[204:207], a[32:35], v[48:63]
 ds_read_b64_tr_b16 v[200:201], v240 offset:55424
 ds_read_b64_tr_b16 v[202:203], v240 offset:56960
 s_waitcnt lgkmcnt(8)
 v_mfma_f32_32x32x16_bf16 v[64:79], v[208:211], a[32:35], v[64:79]
 ds_read_b64_tr_b16 v[204:205], v241 offset:55488
 ds_read_b64_tr_b16 v[206:207], v241 offset:57024
 s_waitcnt lgkmcnt(8)
 v_mfma_f32_32x32x16_bf16 v[80:95], v[212:215], a[32:35], v[80:95]
 ds_read_b64_tr_b16 v[208:209], v240 offset:55552
 ds_read_b64_tr_b16 v[210:211], v240 offset:57088
 s_waitcnt lgkmcnt(8)
 v_mfma_f32_32x32x16_bf16 v[0:15], v[192:195], a[36:39], v[0:15]
 ds_read_b64_tr_b16 v[212:213], v241 offset:55616
 ds_read_b64_tr_b16 v[214:215], v241 offset:57152
 s_waitcnt lgkmcnt(8)
 v_mfma_f32_32x32x16_bf16 v[16:31], v[196:199], a[36:39], v[16:31]
 ds_read_b64_tr_b16 v[192:193], v240 offset:61440
 ds_read_b64_tr_b16 v[194:195], v240 offset:62976
 s_waitcnt lgkmcnt(8)
 v_mfma_f32_32x32x16_bf16 v[32:47], v[200:203], a[36:39], v[32:47]
 buffer_load_dwordx4 a[96:99], v232, s[8:11], s48 offen offset:0
 buffer_load_dwordx4 a[100:103], v232, s[8:11], s48 offen offset:1024
 buffer_load_dwordx4 a[104:107], v232, s[8:11], s48 offen offset:2048
 buffer_load_dwordx4 a[108:111], v232, s[8:11], s48 offen offset:3072
 s_add_u32 s48, s48, 4096
 ds_read_b64_tr_b16 v[196:197], v241 offset:61504
 ds_read_b64_tr_b16 v[198:199], v241 offset:63040
 s_waitcnt lgkmcnt(8)
 v_mfma_f32_32x32x16_bf16 v[48:63], v[204:207], a[36:39], v[48:63]
 ds_read_b64_tr_b16 v[200:201], v240 offset:61568
 ds_read_b64_tr_b16 v[202:203], v240 offset:63104
 s_waitcnt lgkmcnt(8)
 v_mfma_f32_32x32x16_bf16 v[64:79], v[208:211], a[36:39], v[64:79]
 ds_read_b64_tr_b16 v[204:205], v241 offset:61632
 ds_read_b64_tr_b16 v[206:207], v241 offset:63168
 s_waitcnt lgkmcnt(8)
 v_mfma_f32_32x32x16_bf16 v[80:95], v[212:215], a[36:39], v[80:95]
 ds_read_b64_tr_b16 v[208:209], v240 offset:61696
 ds_read_b64_tr_b16 v[210:211], v240 offset:63232
 s_waitcnt lgkmcnt(8)
 v_mfma_f32_32x32x16_bf16 v[0:15], v[192:195], a[40:43], v[0:15]
 ds_read_b64_tr_b16 v[212:213], v241 offset:61760
 ds_read_b64_tr_b16 v[214:215], v241 offset:63296
 s_waitcnt lgkmcnt(8)
 v_mfma_f32_32x32x16_bf16 v[16:31], v[196:199], a[40:43], v[16:31]
 ds_read_b64_tr_b16 v[192:193], v248 offset:2048
 ds_read_b64_tr_b16 v[194:195], v248 offset:3584
 s_waitcnt lgkmcnt(8)
 v_mfma_f32_32x32x16_bf16 v[32:47], v[200:203], a[40:43], v[32:47]
 ds_read_b64_tr_b16 v[196:197], v249 offset:2112
 ds_read_b64_tr_b16 v[198:199], v249 offset:3648
 s_waitcnt lgkmcnt(8)
 v_mfma_f32_32x32x16_bf16 v[48:63], v[204:207], a[40:43], v[48:63]
 ds_read_b64_tr_b16 v[200:201], v248 offset:2176
 ds_read_b64_tr_b16 v[202:203], v248 offset:3712
 s_waitcnt lgkmcnt(8)
 v_mfma_f32_32x32x16_bf16 v[64:79], v[208:211], a[40:43], v[64:79]
 ds_read_b64_tr_b16 v[204:205], v249 offset:2240
 ds_read_b64_tr_b16 v[206:207], v249 offset:3776
 s_waitcnt lgkmcnt(8)
 v_mfma_f32_32x32x16_bf16 v[80:95], v[212:215], a[40:43], v[80:95]
 ds_read_b64_tr_b16 v[208:209], v248 offset:2304
 ds_read_b64_tr_b16 v[210:211], v248 offset:3840
 s_waitcnt lgkmcnt(8)
 v_mfma_f32_32x32x16_bf16 v[0:15], v[192:195], a[44:47], v[0:15]
 ds_read_b64_tr_b16 v[212:213], v249 offset:2368
 ds_read_b64_tr_b16 v[214:215], v249 offset:3904
 s_waitcnt lgkmcnt(8)
 v_mfma_f32_32x32x16_bf16 v[16:31], v[196:199], a[44:47], v[16:31]
 ds_read_b64_tr_b16 v[192:193], v248 offset:8192
 ds_read_b64_tr_b16 v[194:195], v248 offset:9728
 s_waitcnt lgkmcnt(8)
 v_mfma_f32_32x32x16_bf16 v[32:47], v[200:203], a[44:47], v[32:47]
 ds_read_b64_tr_b16 v[196:197], v249 offset:8256
 ds_read_b64_tr_b16 v[198:199], v249 offset:9792
 s_waitcnt lgkmcnt(8)
 v_mfma_f32_32x32x16_bf16 v[48:63], v[204:207], a[44:47], v[48:63]
 ds_read_b64_tr_b16 v[200:201], v248 offset:8320
 ds_read_b64_tr_b16 v[202:203], v248 offset:9856
 s_waitcnt lgkmcnt(8)
 v_mfma_f32_32x32x16_bf16 v[64:79], v[208:211], a[44:47], v[64:79]
 ds_read_b64_tr_b16 v[204:205], v249 offset:8384
 ds_read_b64_tr_b16 v[206:207], v249 offset:9920
 s_waitcnt lgkmcnt(8)
 v_mfma_f32_32x32x16_bf16 v[80:95], v[212:215], a[44:47], v[80:95]
 s_waitcnt vmcnt(24)
 s_barrier
 ds_read_b64_tr_b16 v[208:209], v248 offset:8448
 ds_read_b64_tr_b16 v[210:211], v248 offset:9984
 s_waitcnt lgkmcnt(8)
 v_mfma_f32_32x32x16_bf16 v[0:15], v[192:195], a[48:51], v[0:15]
 ds_read_b64_tr_b16 v[212:213], v249 offset:8512
 ds_read_b64_tr_b16 v[214:215], v249 offset:10048
 s_waitcnt lgkmcnt(8)
 v_mfma_f32_32x32x16_bf16 v[16:31], v[196:199], a[48:51], v[16:31]
 s_add_u32 m0, s19, 49152
 s_add_u32 s29, s52, 5505024
 buffer_load_dwordx4 v236, s[20:23], s29 offen lds
 s_add_u32 m0, s19, 50176
 s_add_u32 s29, s52, 5505024
 buffer_load_dwordx4 v237, s[20:23], s29 offen lds
 s_add_u32 m0, s19, 51200
 s_add_u32 s29, s52, 5505024
 buffer_load_dwordx4 v238, s[20:23], s29 offen lds
 s_add_u32 m0, s19, 52224
 s_add_u32 s29, s52, 5603328
 buffer_load_dwordx4 v236, s[20:23], s29 offen lds
 s_add_u32 m0, s19, 53248
 s_add_u32 s29, s52, 5603328
 buffer_load_dwordx4 v237, s[20:23], s29 offen lds
 s_add_u32 m0, s19, 54272
 s_add_u32 s29, s52, 5603328
 buffer_load_dwordx4 v238, s[20:23], s29 offen lds
 ds_read_b64_tr_b16 v[192:193], v248 offset:14336
 ds_read_b64_tr_b16 v[194:195], v248 offset:15872
 s_waitcnt lgkmcnt(8)
 v_mfma_f32_32x32x16_bf16 v[32:47], v[200:203], a[48:51], v[32:47]
 ds_read_b64_tr_b16 v[196:197], v249 offset:14400
 ds_read_b64_tr_b16 v[198:199], v249 offset:15936
 s_waitcnt lgkmcnt(8)
 v_mfma_f32_32x32x16_bf16 v[48:63], v[204:207], a[48:51], v[48:63]
 ds_read_b64_tr_b16 v[200:201], v248 offset:14464
 ds_read_b64_tr_b16 v[202:203], v248 offset:16000
 s_waitcnt lgkmcnt(8)
 v_mfma_f32_32x32x16_bf16 v[64:79], v[208:211], a[48:51], v[64:79]
 ds_read_b64_tr_b16 v[204:205], v249 offset:14528
 ds_read_b64_tr_b16 v[206:207], v249 offset:16064
 s_waitcnt lgkmcnt(8)
 v_mfma_f32_32x32x16_bf16 v[80:95], v[212:215], a[48:51], v[80:95]
 ds_read_b64_tr_b16 v[208:209], v248 offset:14592
 ds_read_b64_tr_b16 v[210:211], v248 offset:16128
 s_waitcnt lgkmcnt(8)
 v_mfma_f32_32x32x16_bf16 v[0:15], v[192:195], a[52:55], v[0:15]
 ds_read_b64_tr_b16 v[212:213], v249 offset:14656
 ds_read_b64_tr_b16 v[214:215], v249 offset:16192
 s_waitcnt lgkmcnt(8)
 v_mfma_f32_32x32x16_bf16 v[16:31], v[196:199], a[52:55], v[16:31]
 ds_read_b64_tr_b16 v[192:193], v248 offset:20480
 ds_read_b64_tr_b16 v[194:195], v248 offset:22016
 s_waitcnt lgkmcnt(8)
 v_mfma_f32_32x32x16_bf16 v[32:47], v[200:203], a[52:55], v[32:47]
 buffer_load_dwordx4 a[112:115], v232, s[8:11], s48 offen offset:0
 buffer_load_dwordx4 a[116:119], v232, s[8:11], s48 offen offset:1024
 buffer_load_dwordx4 a[120:123], v232, s[8:11], s48 offen offset:2048
 buffer_load_dwordx4 a[124:127], v232, s[8:11], s48 offen offset:3072
 s_add_u32 s48, s48, 4096
 ds_read_b64_tr_b16 v[196:197], v249 offset:20544
 ds_read_b64_tr_b16 v[198:199], v249 offset:22080
 s_waitcnt lgkmcnt(8)
 v_mfma_f32_32x32x16_bf16 v[48:63], v[204:207], a[52:55], v[48:63]
 ds_read_b64_tr_b16 v[200:201], v248 offset:20608
 ds_read_b64_tr_b16 v[202:203], v248 offset:22144
 s_waitcnt lgkmcnt(8)
 v_mfma_f32_32x32x16_bf16 v[64:79], v[208:211], a[52:55], v[64:79]
 ds_read_b64_tr_b16 v[204:205], v249 offset:20672
 ds_read_b64_tr_b16 v[206:207], v249 offset:22208
 s_waitcnt lgkmcnt(8)
 v_mfma_f32_32x32x16_bf16 v[80:95], v[212:215], a[52:55], v[80:95]
 ds_read_b64_tr_b16 v[208:209], v248 offset:20736
 ds_read_b64_tr_b16 v[210:211], v248 offset:22272
 s_waitcnt lgkmcnt(8)
 v_mfma_f32_32x32x16_bf16 v[0:15], v[192:195], a[56:59], v[0:15]
 ds_read_b64_tr_b16 v[212:213], v249 offset:20800
 ds_read_b64_tr_b16 v[214:215], v249 offset:22336
 s_waitcnt lgkmcnt(8)
 v_mfma_f32_32x32x16_bf16 v[16:31], v[196:199], a[56:59], v[16:31]
 ds_read_b64_tr_b16 v[192:193], v248 offset:26624
 ds_read_b64_tr_b16 v[194:195], v248 offset:28160
 s_waitcnt lgkmcnt(8)
 v_mfma_f32_32x32x16_bf16 v[32:47], v[200:203], a[56:59], v[32:47]
 ds_read_b64_tr_b16 v[196:197], v249 offset:26688
 ds_read_b64_tr_b16 v[198:199], v249 offset:28224
 s_waitcnt lgkmcnt(8)
 v_mfma_f32_32x32x16_bf16 v[48:63], v[204:207], a[56:59], v[48:63]
 ds_read_b64_tr_b16 v[200:201], v248 offset:26752
 ds_read_b64_tr_b16 v[202:203], v248 offset:28288
 s_waitcnt lgkmcnt(8)
 v_mfma_f32_32x32x16_bf16 v[64:79], v[208:211], a[56:59], v[64:79]
 ds_read_b64_tr_b16 v[204:205], v249 offset:26816
 ds_read_b64_tr_b16 v[206:207], v249 offset:28352
 s_waitcnt lgkmcnt(8)
 v_mfma_f32_32x32x16_bf16 v[80:95], v[212:215], a[56:59], v[80:95]
 ds_read_b64_tr_b16 v[208:209], v248 offset:26880
 ds_read_b64_tr_b16 v[210:211], v248 offset:28416
 s_waitcnt lgkmcnt(8)
 v_mfma_f32_32x32x16_bf16 v[0:15], v[192:195], a[60:63], v[0:15]
 ds_read_b64_tr_b16 v[212:213], v249 offset:26944
 ds_read_b64_tr_b16 v[214:215], v249 offset:28480
 s_waitcnt lgkmcnt(8)
 v_mfma_f32_32x32x16_bf16 v[16:31], v[196:199], a[60:63], v[16:31]
 ds_read_b64_tr_b16 v[192:193], v248 offset:32768
 ds_read_b64_tr_b16 v[194:195], v248 offset:34304
 s_waitcnt lgkmcnt(8)
 v_mfma_f32_32x32x16_bf16 v[32:47], v[200:203], a[60:63], v[32:47]
 ds_read_b64_tr_b16 v[196:197], v249 offset:32832
 ds_read_b64_tr_b16 v[198:199], v249 offset:34368
 s_waitcnt lgkmcnt(8)
 v_mfma_f32_32x32x16_bf16 v[48:63], v[204:207], a[60:63], v[48:63]
 ds_read_b64_tr_b16 v[200:201], v248 offset:32896
 ds_read_b64_tr_b16 v[202:203], v248 offset:34432
 s_waitcnt lgkmcnt(8)
 v_mfma_f32_32x32x16_bf16 v[64:79], v[208:211], a[60:63], v[64:79]
 ds_read_b64_tr_b16 v[204:205], v249 offset:32960
 ds_read_b64_tr_b16 v[206:207], v249 offset:34496
 s_waitcnt lgkmcnt(8)
 v_mfma_f32_32x32x16_bf16 v[80:95], v[212:215], a[60:63], v[80:95]
 s_waitcnt vmcnt(24)
 s_barrier
 ds_read_b64_tr_b16 v[208:209], v248 offset:33024
 ds_read_b64_tr_b16 v[210:211], v248 offset:34560
 s_waitcnt lgkmcnt(8)
 v_mfma_f32_32x32x16_bf16 v[0:15], v[192:195], a[64:67], v[0:15]
 ds_read_b64_tr_b16 v[212:213], v249 offset:33088
 ds_read_b64_tr_b16 v[214:215], v249 offset:34624
 s_waitcnt lgkmcnt(8)
 v_mfma_f32_32x32x16_bf16 v[16:31], v[196:199], a[64:67], v[16:31]
 s_add_u32 m0, s19, 73728
 s_add_u32 s29, s52, 6291456
 buffer_load_dwordx4 v236, s[20:23], s29 offen lds
 s_add_u32 m0, s19, 74752
 s_add_u32 s29, s52, 6291456
 buffer_load_dwordx4 v237, s[20:23], s29 offen lds
 s_add_u32 m0, s19, 75776
 s_add_u32 s29, s52, 6291456
 buffer_load_dwordx4 v238, s[20:23], s29 offen lds
 s_add_u32 m0, s19, 76800
 s_add_u32 s29, s52, 6389760
 buffer_load_dwordx4 v236, s[20:23], s29 offen lds
 s_add_u32 m0, s19, 77824
 s_add_u32 s29, s52, 6389760
 buffer_load_dwordx4 v237, s[20:23], s29 offen lds
 s_add_u32 m0, s19, 78848
 s_add_u32 s29, s52, 6389760
 buffer_load_dwordx4 v238, s[20:23], s29 offen lds
 ds_read_b64_tr_b16 v[192:193], v248 offset:38912
 ds_read_b64_tr_b16 v[194:195], v248 offset:40448
 s_waitcnt lgkmcnt(8)
 v_mfma_f32_32x32x16_bf16 v[32:47], v[200:203], a[64:67], v[32:47]
 ds_read_b64_tr_b16 v[196:197], v249 offset:38976
 ds_read_b64_tr_b16 v[198:199], v249 offset:40512
 s_waitcnt lgkmcnt(8)
 v_mfma_f32_32x32x16_bf16 v[48:63], v[204:207], a[64:67], v[48:63]
 ds_read_b64_tr_b16 v[200:201], v248 offset:39040
 ds_read_b64_tr_b16 v[202:203], v248 offset:40576
 s_waitcnt lgkmcnt(8)
 v_mfma_f32_32x32x16_bf16 v[64:79], v[208:211], a[64:67], v[64:79]
 ds_read_b64_tr_b16 v[204:205], v249 offset:39104
 ds_read_b64_tr_b16 v[206:207], v249 offset:40640
 s_waitcnt lgkmcnt(8)
 v_mfma_f32_32x32x16_bf16 v[80:95], v[212:215], a[64:67], v[80:95]
 ds_read_b64_tr_b16 v[208:209], v248 offset:39168
 ds_read_b64_tr_b16 v[210:211], v248 offset:40704
 s_waitcnt lgkmcnt(8)
 v_mfma_f32_32x32x16_bf16 v[0:15], v[192:195], a[68:71], v[0:15]
 ds_read_b64_tr_b16 v[212:213], v249 offset:39232
 ds_read_b64_tr_b16 v[214:215], v249 offset:40768
 s_waitcnt lgkmcnt(8)
 v_mfma_f32_32x32x16_bf16 v[16:31], v[196:199], a[68:71], v[16:31]
 ds_read_b64_tr_b16 v[192:193], v248 offset:45056
 ds_read_b64_tr_b16 v[194:195], v248 offset:46592
 s_waitcnt lgkmcnt(8)
 v_mfma_f32_32x32x16_bf16 v[32:47], v[200:203], a[68:71], v[32:47]
 buffer_load_dwordx4 a[128:131], v232, s[8:11], s48 offen offset:0
 buffer_load_dwordx4 a[132:135], v232, s[8:11], s48 offen offset:1024
 buffer_load_dwordx4 a[136:139], v232, s[8:11], s48 offen offset:2048
 buffer_load_dwordx4 a[140:143], v232, s[8:11], s48 offen offset:3072
 s_add_u32 s48, s48, 4096
 ds_read_b64_tr_b16 v[196:197], v249 offset:45120
 ds_read_b64_tr_b16 v[198:199], v249 offset:46656
 s_waitcnt lgkmcnt(8)
 v_mfma_f32_32x32x16_bf16 v[48:63], v[204:207], a[68:71], v[48:63]
 ds_read_b64_tr_b16 v[200:201], v248 offset:45184
 ds_read_b64_tr_b16 v[202:203], v248 offset:46720
 s_waitcnt lgkmcnt(8)
 v_mfma_f32_32x32x16_bf16 v[64:79], v[208:211], a[68:71], v[64:79]
 ds_read_b64_tr_b16 v[204:205], v249 offset:45248
 ds_read_b64_tr_b16 v[206:207], v249 offset:46784
 s_waitcnt lgkmcnt(8)
 v_mfma_f32_32x32x16_bf16 v[80:95], v[212:215], a[68:71], v[80:95]
 ds_read_b64_tr_b16 v[208:209], v248 offset:45312
 ds_read_b64_tr_b16 v[210:211], v248 offset:46848
 s_waitcnt lgkmcnt(8)
 v_mfma_f32_32x32x16_bf16 v[0:15], v[192:195], a[72:75], v[0:15]
 ds_read_b64_tr_b16 v[212:213], v249 offset:45376
 ds_read_b64_tr_b16 v[214:215], v249 offset:46912
 s_waitcnt lgkmcnt(8)
 v_mfma_f32_32x32x16_bf16 v[16:31], v[196:199], a[72:75], v[16:31]
 ds_read_b64_tr_b16 v[192:193], v248 offset:51200
 ds_read_b64_tr_b16 v[194:195], v248 offset:52736
 s_waitcnt lgkmcnt(8)
 v_mfma_f32_32x32x16_bf16 v[32:47], v[200:203], a[72:75], v[32:47]
 ds_read_b64_tr_b16 v[196:197], v249 offset:51264
 ds_read_b64_tr_b16 v[198:199], v249 offset:52800
 s_waitcnt lgkmcnt(8)
 v_mfma_f32_32x32x16_bf16 v[48:63], v[204:207], a[72:75], v[48:63]
 ds_read_b64_tr_b16 v[200:201], v248 offset:51328
 ds_read_b64_tr_b16 v[202:203], v248 offset:52864
 s_waitcnt lgkmcnt(8)
 v_mfma_f32_32x32x16_bf16 v[64:79], v[208:211], a[72:75], v[64:79]
 ds_read_b64_tr_b16 v[204:205], v249 offset:51392
 ds_read_b64_tr_b16 v[206:207], v249 offset:52928
 s_waitcnt lgkmcnt(8)
 v_mfma_f32_32x32x16_bf16 v[80:95], v[212:215], a[72:75], v[80:95]
 ds_read_b64_tr_b16 v[208:209], v248 offset:51456
 ds_read_b64_tr_b16 v[210:211], v248 offset:52992
 s_waitcnt lgkmcnt(8)
 v_mfma_f32_32x32x16_bf16 v[0:15], v[192:195], a[76:79], v[0:15]
 ds_read_b64_tr_b16 v[212:213], v249 offset:51520
 ds_read_b64_tr_b16 v[214:215], v249 offset:53056
 s_waitcnt lgkmcnt(8)
 v_mfma_f32_32x32x16_bf16 v[16:31], v[196:199], a[76:79], v[16:31]
 ds_read_b64_tr_b16 v[192:193], v240 offset:0
 ds_read_b64_tr_b16 v[194:195], v240 offset:1536
 s_waitcnt lgkmcnt(8)
 v_mfma_f32_32x32x16_bf16 v[32:47], v[200:203], a[76:79], v[32:47]
 ds_read_b64_tr_b16 v[196:197], v241 offset:64
 ds_read_b64_tr_b16 v[198:199], v241 offset:1600
 s_waitcnt lgkmcnt(8)
 v_mfma_f32_32x32x16_bf16 v[48:63], v[204:207], a[76:79], v[48:63]
 ds_read_b64_tr_b16 v[200:201], v240 offset:128
 ds_read_b64_tr_b16 v[202:203], v240 offset:1664
 s_waitcnt lgkmcnt(8)
 v_mfma_f32_32x32x16_bf16 v[64:79], v[208:211], a[76:79], v[64:79]
 ds_read_b64_tr_b16 v[204:205], v241 offset:192
 ds_read_b64_tr_b16 v[206:207], v241 offset:1728
 s_waitcnt lgkmcnt(8)
 v_mfma_f32_32x32x16_bf16 v[80:95], v[212:215], a[76:79], v[80:95]
 s_waitcnt vmcnt(24)
 s_barrier
 ds_read_b64_tr_b16 v[208:209], v240 offset:256
 ds_read_b64_tr_b16 v[210:211], v240 offset:1792
 s_waitcnt lgkmcnt(8)
 v_mfma_f32_32x32x16_bf16 v[0:15], v[192:195], a[80:83], v[0:15]
 ds_read_b64_tr_b16 v[212:213], v241 offset:320
 ds_read_b64_tr_b16 v[214:215], v241 offset:1856
 s_waitcnt lgkmcnt(8)
 v_mfma_f32_32x32x16_bf16 v[16:31], v[196:199], a[80:83], v[16:31]
 s_add_u32 m0, s19, 98304
 s_add_u32 s29, s52, 7077888
 buffer_load_dwordx4 v236, s[20:23], s29 offen lds
 s_add_u32 m0, s19, 99328
 s_add_u32 s29, s52, 7077888
 buffer_load_dwordx4 v237, s[20:23], s29 offen lds
 s_add_u32 m0, s19, 100352
 s_add_u32 s29, s52, 7077888
 buffer_load_dwordx4 v238, s[20:23], s29 offen lds
 s_add_u32 m0, s19, 101376
 s_add_u32 s29, s52, 7176192
 buffer_load_dwordx4 v236, s[20:23], s29 offen lds
 s_add_u32 m0, s19, 102400
 s_add_u32 s29, s52, 7176192
 buffer_load_dwordx4 v237, s[20:23], s29 offen lds
 s_add_u32 m0, s19, 103424
 s_add_u32 s29, s52, 7176192
 buffer_load_dwordx4 v238, s[20:23], s29 offen lds
 ds_read_b64_tr_b16 v[192:193], v240 offset:6144
 ds_read_b64_tr_b16 v[194:195], v240 offset:7680
 s_waitcnt lgkmcnt(8)
 v_mfma_f32_32x32x16_bf16 v[32:47], v[200:203], a[80:83], v[32:47]
 ds_read_b64_tr_b16 v[196:197], v241 offset:6208
 ds_read_b64_tr_b16 v[198:199], v241 offset:7744
 s_waitcnt lgkmcnt(8)
 v_mfma_f32_32x32x16_bf16 v[48:63], v[204:207], a[80:83], v[48:63]
 ds_read_b64_tr_b16 v[200:201], v240 offset:6272
 ds_read_b64_tr_b16 v[202:203], v240 offset:7808
 s_waitcnt lgkmcnt(8)
 v_mfma_f32_32x32x16_bf16 v[64:79], v[208:211], a[80:83], v[64:79]
 ds_read_b64_tr_b16 v[204:205], v241 offset:6336
 ds_read_b64_tr_b16 v[206:207], v241 offset:7872
 s_waitcnt lgkmcnt(8)
 v_mfma_f32_32x32x16_bf16 v[80:95], v[212:215], a[80:83], v[80:95]
 ds_read_b64_tr_b16 v[208:209], v240 offset:6400
 ds_read_b64_tr_b16 v[210:211], v240 offset:7936
 s_waitcnt lgkmcnt(8)
 v_mfma_f32_32x32x16_bf16 v[0:15], v[192:195], a[84:87], v[0:15]
 ds_read_b64_tr_b16 v[212:213], v241 offset:6464
 ds_read_b64_tr_b16 v[214:215], v241 offset:8000
 s_waitcnt lgkmcnt(8)
 v_mfma_f32_32x32x16_bf16 v[16:31], v[196:199], a[84:87], v[16:31]
 ds_read_b64_tr_b16 v[192:193], v240 offset:12288
 ds_read_b64_tr_b16 v[194:195], v240 offset:13824
 s_waitcnt lgkmcnt(8)
 v_mfma_f32_32x32x16_bf16 v[32:47], v[200:203], a[84:87], v[32:47]
 buffer_load_dwordx4 a[144:147], v232, s[8:11], s48 offen offset:0
 buffer_load_dwordx4 a[148:151], v232, s[8:11], s48 offen offset:1024
 buffer_load_dwordx4 a[152:155], v232, s[8:11], s48 offen offset:2048
 buffer_load_dwordx4 a[156:159], v232, s[8:11], s48 offen offset:3072
 s_add_u32 s48, s48, 4096
 ds_read_b64_tr_b16 v[196:197], v241 offset:12352
 ds_read_b64_tr_b16 v[198:199], v241 offset:13888
 s_waitcnt lgkmcnt(8)
 v_mfma_f32_32x32x16_bf16 v[48:63], v[204:207], a[84:87], v[48:63]
 ds_read_b64_tr_b16 v[200:201], v240 offset:12416
 ds_read_b64_tr_b16 v[202:203], v240 offset:13952
 s_waitcnt lgkmcnt(8)
 v_mfma_f32_32x32x16_bf16 v[64:79], v[208:211], a[84:87], v[64:79]
 ds_read_b64_tr_b16 v[204:205], v241 offset:12480
 ds_read_b64_tr_b16 v[206:207], v241 offset:14016
 s_waitcnt lgkmcnt(8)
 v_mfma_f32_32x32x16_bf16 v[80:95], v[212:215], a[84:87], v[80:95]
 ds_read_b64_tr_b16 v[208:209], v240 offset:12544
 ds_read_b64_tr_b16 v[210:211], v240 offset:14080
 s_waitcnt lgkmcnt(8)
 v_mfma_f32_32x32x16_bf16 v[0:15], v[192:195], a[88:91], v[0:15]
 ds_read_b64_tr_b16 v[212:213], v241 offset:12608
 ds_read_b64_tr_b16 v[214:215], v241 offset:14144
 s_waitcnt lgkmcnt(8)
 v_mfma_f32_32x32x16_bf16 v[16:31], v[196:199], a[88:91], v[16:31]
 ds_read_b64_tr_b16 v[192:193], v240 offset:18432
 ds_read_b64_tr_b16 v[194:195], v240 offset:19968
 s_waitcnt lgkmcnt(8)
 v_mfma_f32_32x32x16_bf16 v[32:47], v[200:203], a[88:91], v[32:47]
 ds_read_b64_tr_b16 v[196:197], v241 offset:18496
 ds_read_b64_tr_b16 v[198:199], v241 offset:20032
 s_waitcnt lgkmcnt(8)
 v_mfma_f32_32x32x16_bf16 v[48:63], v[204:207], a[88:91], v[48:63]
 ds_read_b64_tr_b16 v[200:201], v240 offset:18560
 ds_read_b64_tr_b16 v[202:203], v240 offset:20096
 s_waitcnt lgkmcnt(8)
 v_mfma_f32_32x32x16_bf16 v[64:79], v[208:211], a[88:91], v[64:79]
 ds_read_b64_tr_b16 v[204:205], v241 offset:18624
 ds_read_b64_tr_b16 v[206:207], v241 offset:20160
 s_waitcnt lgkmcnt(8)
 v_mfma_f32_32x32x16_bf16 v[80:95], v[212:215], a[88:91], v[80:95]
 ds_read_b64_tr_b16 v[208:209], v240 offset:18688
 ds_read_b64_tr_b16 v[210:211], v240 offset:20224
 s_waitcnt lgkmcnt(8)
 v_mfma_f32_32x32x16_bf16 v[0:15], v[192:195], a[92:95], v[0:15]
 ds_read_b64_tr_b16 v[212:213], v241 offset:18752
 ds_read_b64_tr_b16 v[214:215], v241 offset:20288
 s_waitcnt lgkmcnt(8)
 v_mfma_f32_32x32x16_bf16 v[16:31], v[196:199], a[92:95], v[16:31]
 ds_read_b64_tr_b16 v[192:193], v240 offset:24576
 ds_read_b64_tr_b16 v[194:195], v240 offset:26112
 s_waitcnt lgkmcnt(8)
 v_mfma_f32_32x32x16_bf16 v[32:47], v[200:203], a[92:95], v[32:47]
 ds_read_b64_tr_b16 v[196:197], v241 offset:24640
 ds_read_b64_tr_b16 v[198:199], v241 offset:26176
 s_waitcnt lgkmcnt(8)
 v_mfma_f32_32x32x16_bf16 v[48:63], v[204:207], a[92:95], v[48:63]
 ds_read_b64_tr_b16 v[200:201], v240 offset:24704
 ds_read_b64_tr_b16 v[202:203], v240 offset:26240
 s_waitcnt lgkmcnt(8)
 v_mfma_f32_32x32x16_bf16 v[64:79], v[208:211], a[92:95], v[64:79]
 ds_read_b64_tr_b16 v[204:205], v241 offset:24768
 ds_read_b64_tr_b16 v[206:207], v241 offset:26304
 s_waitcnt lgkmcnt(8)
 v_mfma_f32_32x32x16_bf16 v[80:95], v[212:215], a[92:95], v[80:95]
 s_waitcnt vmcnt(24)
 s_barrier
 ds_read_b64_tr_b16 v[208:209], v240 offset:24832
 ds_read_b64_tr_b16 v[210:211], v240 offset:26368
 s_waitcnt lgkmcnt(8)
 v_mfma_f32_32x32x16_bf16 v[0:15], v[192:195], a[96:99], v[0:15]
 ds_read_b64_tr_b16 v[212:213], v241 offset:24896
 ds_read_b64_tr_b16 v[214:215], v241 offset:26432
 s_waitcnt lgkmcnt(8)
 v_mfma_f32_32x32x16_bf16 v[16:31], v[196:199], a[96:99], v[16:31]
 s_add_u32 m0, s19, 0
 s_add_u32 s29, s52, 0
 buffer_load_dwordx4 v236, s[24:27], s29 offen lds
 s_add_u32 m0, s19, 1024
 s_add_u32 s29, s52, 0
 buffer_load_dwordx4 v237, s[24:27], s29 offen lds
 s_add_u32 m0, s19, 2048
 s_add_u32 s29, s52, 0
 buffer_load_dwordx4 v238, s[24:27], s29 offen lds
 s_add_u32 m0, s19, 3072
 s_add_u32 s29, s52, 98304
 buffer_load_dwordx4 v236, s[24:27], s29 offen lds
 s_add_u32 m0, s19, 4096
 s_add_u32 s29, s52, 98304
 buffer_load_dwordx4 v237, s[24:27], s29 offen lds
 s_add_u32 m0, s19, 5120
 s_add_u32 s29, s52, 98304
 buffer_load_dwordx4 v238, s[24:27], s29 offen lds
 ds_read_b64_tr_b16 v[192:193], v240 offset:30720
 ds_read_b64_tr_b16 v[194:195], v240 offset:32256
 s_waitcnt lgkmcnt(8)
 v_mfma_f32_32x32x16_bf16 v[32:47], v[200:203], a[96:99], v[32:47]
 ds_read_b64_tr_b16 v[196:197], v241 offset:30784
 ds_read_b64_tr_b16 v[198:199], v241 offset:32320
 s_waitcnt lgkmcnt(8)
 v_mfma_f32_32x32x16_bf16 v[48:63], v[204:207], a[96:99], v[48:63]
 ds_read_b64_tr_b16 v[200:201], v240 offset:30848
 ds_read_b64_tr_b16 v[202:203], v240 offset:32384
 s_waitcnt lgkmcnt(8)
 v_mfma_f32_32x32x16_bf16 v[64:79], v[208:211], a[96:99], v[64:79]
 ds_read_b64_tr_b16 v[204:205], v241 offset:30912
 ds_read_b64_tr_b16 v[206:207], v241 offset:32448
 s_waitcnt lgkmcnt(8)
 v_mfma_f32_32x32x16_bf16 v[80:95], v[212:215], a[96:99], v[80:95]
 ds_read_b64_tr_b16 v[208:209], v240 offset:30976
 ds_read_b64_tr_b16 v[210:211], v240 offset:32512
 s_waitcnt lgkmcnt(8)
 v_mfma_f32_32x32x16_bf16 v[0:15], v[192:195], a[100:103], v[0:15]
 ds_read_b64_tr_b16 v[212:213], v241 offset:31040
 ds_read_b64_tr_b16 v[214:215], v241 offset:32576
 s_waitcnt lgkmcnt(8)
 v_mfma_f32_32x32x16_bf16 v[16:31], v[196:199], a[100:103], v[16:31]
 ds_read_b64_tr_b16 v[192:193], v240 offset:36864
 ds_read_b64_tr_b16 v[194:195], v240 offset:38400
 s_waitcnt lgkmcnt(8)
 v_mfma_f32_32x32x16_bf16 v[32:47], v[200:203], a[100:103], v[32:47]
 ds_read_b64_tr_b16 v[196:197], v241 offset:36928
 ds_read_b64_tr_b16 v[198:199], v241 offset:38464
 s_waitcnt lgkmcnt(8)
 v_mfma_f32_32x32x16_bf16 v[48:63], v[204:207], a[100:103], v[48:63]
 ds_read_b64_tr_b16 v[200:201], v240 offset:36992
 ds_read_b64_tr_b16 v[202:203], v240 offset:38528
 s_waitcnt lgkmcnt(8)
 v_mfma_f32_32x32x16_bf16 v[64:79], v[208:211], a[100:103], v[64:79]
 ds_read_b64_tr_b16 v[204:205], v241 offset:37056
 ds_read_b64_tr_b16 v[206:207], v241 offset:38592
 s_waitcnt lgkmcnt(8)
 v_mfma_f32_32x32x16_bf16 v[80:95], v[212:215], a[100:103], v[80:95]
 ds_read_b64_tr_b16 v[208:209], v240 offset:37120
 ds_read_b64_tr_b16 v[210:211], v240 offset:38656
 s_waitcnt lgkmcnt(8)
 v_mfma_f32_32x32x16_bf16 v[0:15], v[192:195], a[104:107], v[0:15]
 ds_read_b64_tr_b16 v[212:213], v241 offset:37184
 ds_read_b64_tr_b16 v[214:215], v241 offset:38720
 s_waitcnt lgkmcnt(8)
 v_mfma_f32_32x32x16_bf16 v[16:31], v[196:199], a[104:107], v[16:31]
 ds_read_b64_tr_b16 v[192:193], v240 offset:43008
 ds_read_b64_tr_b16 v[194:195], v240 offset:44544
 s_waitcnt lgkmcnt(8)
 v_mfma_f32_32x32x16_bf16 v[32:47], v[200:203], a[104:107], v[32:47]
 ds_read_b64_tr_b16 v[196:197], v241 offset:43072
 ds_read_b64_tr_b16 v[198:199], v241 offset:44608
 s_waitcnt lgkmcnt(8)
 v_mfma_f32_32x32x16_bf16 v[48:63], v[204:207], a[104:107], v[48:63]
 ds_read_b64_tr_b16 v[200:201], v240 offset:43136
 ds_read_b64_tr_b16 v[202:203], v240 offset:44672
 s_waitcnt lgkmcnt(8)
 v_mfma_f32_32x32x16_bf16 v[64:79], v[208:211], a[104:107], v[64:79]
 ds_read_b64_tr_b16 v[204:205], v241 offset:43200
 ds_read_b64_tr_b16 v[206:207], v241 offset:44736
 s_waitcnt lgkmcnt(8)
 v_mfma_f32_32x32x16_bf16 v[80:95], v[212:215], a[104:107], v[80:95]
 ds_read_b64_tr_b16 v[208:209], v240 offset:43264
 ds_read_b64_tr_b16 v[210:211], v240 offset:44800
 s_waitcnt lgkmcnt(8)
 v_mfma_f32_32x32x16_bf16 v[0:15], v[192:195], a[108:111], v[0:15]
 ds_read_b64_tr_b16 v[212:213], v241 offset:43328
 ds_read_b64_tr_b16 v[214:215], v241 offset:44864
 s_waitcnt lgkmcnt(8)
 v_mfma_f32_32x32x16_bf16 v[16:31], v[196:199], a[108:111], v[16:31]
 ds_read_b64_tr_b16 v[192:193], v240 offset:49152
 ds_read_b64_tr_b16 v[194:195], v240 offset:50688
 s_waitcnt lgkmcnt(8)
 v_mfma_f32_32x32x16_bf16 v[32:47], v[200:203], a[108:111], v[32:47]
 ds_read_b64_tr_b16 v[196:197], v241 offset:49216
 ds_read_b64_tr_b16 v[198:199], v241 offset:50752
 s_waitcnt lgkmcnt(8)
 v_mfma_f32_32x32x16_bf16 v[48:63], v[204:207], a[108:111], v[48:63]
 ds_read_b64_tr_b16 v[200:201], v240 offset:49280
 ds_read_b64_tr_b16 v[202:203], v240 offset:50816
 s_waitcnt lgkmcnt(8)
 v_mfma_f32_32x32x16_bf16 v[64:79], v[208:211], a[108:111], v[64:79]
 ds_read_b64_tr_b16 v[204:205], v241 offset:49344
 ds_read_b64_tr_b16 v[206:207], v241 offset:50880
 s_waitcnt lgkmcnt(8)
 v_mfma_f32_32x32x16_bf16 v[80:95], v[212:215], a[108:111], v[80:95]
 s_waitcnt vmcnt(20)
 s_barrier
 ds_read_b64_tr_b16 v[208:209], v240 offset:49408
 ds_read_b64_tr_b16 v[210:211], v240 offset:50944
 s_waitcnt lgkmcnt(8)
 v_mfma_f32_32x32x16_bf16 v[0:15], v[192:195], a[112:115], v[0:15]
 ds_read_b64_tr_b16 v[212:213], v241 offset:49472
 ds_read_b64_tr_b16 v[214:215], v241 offset:51008
 s_waitcnt lgkmcnt(8)
 v_mfma_f32_32x32x16_bf16 v[16:31], v[196:199], a[112:115], v[16:31]
 s_add_u32 m0, s19, 24576
 s_add_u32 s29, s52, 786432
 buffer_load_dwordx4 v236, s[24:27], s29 offen lds
 s_add_u32 m0, s19, 25600
 s_add_u32 s29, s52, 786432
 buffer_load_dwordx4 v237, s[24:27], s29 offen lds
 s_add_u32 m0, s19, 26624
 s_add_u32 s29, s52, 786432
 buffer_load_dwordx4 v238, s[24:27], s29 offen lds
 s_add_u32 m0, s19, 27648
 s_add_u32 s29, s52, 884736
 buffer_load_dwordx4 v236, s[24:27], s29 offen lds
 s_add_u32 m0, s19, 28672
 s_add_u32 s29, s52, 884736
 buffer_load_dwordx4 v237, s[24:27], s29 offen lds
 s_add_u32 m0, s19, 29696
 s_add_u32 s29, s52, 884736
 buffer_load_dwordx4 v238, s[24:27], s29 offen lds
 ds_read_b64_tr_b16 v[192:193], v240 offset:55296
 ds_read_b64_tr_b16 v[194:195], v240 offset:56832
 s_waitcnt lgkmcnt(8)
 v_mfma_f32_32x32x16_bf16 v[32:47], v[200:203], a[112:115], v[32:47]
 ds_read_b64_tr_b16 v[196:197], v241 offset:55360
 ds_read_b64_tr_b16 v[198:199], v241 offset:56896
 s_waitcnt lgkmcnt(8)
 v_mfma_f32_32x32x16_bf16 v[48:63], v[204:207], a[112:115], v[48:63]
 ds_read_b64_tr_b16 v[200:201], v240 offset:55424
 ds_read_b64_tr_b16 v[202:203], v240 offset:56960
 s_waitcnt lgkmcnt(8)
 v_mfma_f32_32x32x16_bf16 v[64:79], v[208:211], a[112:115], v[64:79]
 ds_read_b64_tr_b16 v[204:205], v241 offset:55488
 ds_read_b64_tr_b16 v[206:207], v241 offset:57024
 s_waitcnt lgkmcnt(8)
 v_mfma_f32_32x32x16_bf16 v[80:95], v[212:215], a[112:115], v[80:95]
 ds_read_b64_tr_b16 v[208:209], v240 offset:55552
 ds_read_b64_tr_b16 v[210:211], v240 offset:57088
 s_waitcnt lgkmcnt(8)
 v_mfma_f32_32x32x16_bf16 v[0:15], v[192:195], a[116:119], v[0:15]
 ds_read_b64_tr_b16 v[212:213], v241 offset:55616
 ds_read_b64_tr_b16 v[214:215], v241 offset:57152
 s_waitcnt lgkmcnt(8)
 v_mfma_f32_32x32x16_bf16 v[16:31], v[196:199], a[116:119], v[16:31]
 ds_read_b64_tr_b16 v[192:193], v240 offset:61440
 ds_read_b64_tr_b16 v[194:195], v240 offset:62976
 s_waitcnt lgkmcnt(8)
 v_mfma_f32_32x32x16_bf16 v[32:47], v[200:203], a[116:119], v[32:47]
 ds_read_b64_tr_b16 v[196:197], v241 offset:61504
 ds_read_b64_tr_b16 v[198:199], v241 offset:63040
 s_waitcnt lgkmcnt(8)
 v_mfma_f32_32x32x16_bf16 v[48:63], v[204:207], a[116:119], v[48:63]
 ds_read_b64_tr_b16 v[200:201], v240 offset:61568
 ds_read_b64_tr_b16 v[202:203], v240 offset:63104
 s_waitcnt lgkmcnt(8)
 v_mfma_f32_32x32x16_bf16 v[64:79], v[208:211], a[116:119], v[64:79]
 ds_read_b64_tr_b16 v[204:205], v241 offset:61632
 ds_read_b64_tr_b16 v[206:207], v241 offset:63168
 s_waitcnt lgkmcnt(8)
 v_mfma_f32_32x32x16_bf16 v[80:95], v[212:215], a[116:119], v[80:95]
 ds_read_b64_tr_b16 v[208:209], v240 offset:61696
 ds_read_b64_tr_b16 v[210:211], v240 offset:63232
 s_waitcnt lgkmcnt(8)
 v_mfma_f32_32x32x16_bf16 v[0:15], v[192:195], a[120:123], v[0:15]
 ds_read_b64_tr_b16 v[212:213], v241 offset:61760
 ds_read_b64_tr_b16 v[214:215], v241 offset:63296
 s_waitcnt lgkmcnt(8)
 v_mfma_f32_32x32x16_bf16 v[16:31], v[196:199], a[120:123], v[16:31]
 ds_read_b64_tr_b16 v[192:193], v248 offset:2048
 ds_read_b64_tr_b16 v[194:195], v248 offset:3584
 s_waitcnt lgkmcnt(8)
 v_mfma_f32_32x32x16_bf16 v[32:47], v[200:203], a[120:123], v[32:47]
 ds_read_b64_tr_b16 v[196:197], v249 offset:2112
 ds_read_b64_tr_b16 v[198:199], v249 offset:3648
 s_waitcnt lgkmcnt(8)
 v_mfma_f32_32x32x16_bf16 v[48:63], v[204:207], a[120:123], v[48:63]
 ds_read_b64_tr_b16 v[200:201], v248 offset:2176
 ds_read_b64_tr_b16 v[202:203], v248 offset:3712
 s_waitcnt lgkmcnt(8)
 v_mfma_f32_32x32x16_bf16 v[64:79], v[208:211], a[120:123], v[64:79]
 ds_read_b64_tr_b16 v[204:205], v249 offset:2240
 ds_read_b64_tr_b16 v[206:207], v249 offset:3776
 s_waitcnt lgkmcnt(8)
 v_mfma_f32_32x32x16_bf16 v[80:95], v[212:215], a[120:123], v[80:95]
 ds_read_b64_tr_b16 v[208:209], v248 offset:2304
 ds_read_b64_tr_b16 v[210:211], v248 offset:3840
 s_waitcnt lgkmcnt(8)
 v_mfma_f32_32x32x16_bf16 v[0:15], v[192:195], a[124:127], v[0:15]
 ds_read_b64_tr_b16 v[212:213], v249 offset:2368
 ds_read_b64_tr_b16 v[214:215], v249 offset:3904
 s_waitcnt lgkmcnt(8)
 v_mfma_f32_32x32x16_bf16 v[16:31], v[196:199], a[124:127], v[16:31]
 ds_read_b64_tr_b16 v[192:193], v248 offset:8192
 ds_read_b64_tr_b16 v[194:195], v248 offset:9728
 s_waitcnt lgkmcnt(8)
 v_mfma_f32_32x32x16_bf16 v[32:47], v[200:203], a[124:127], v[32:47]
 ds_read_b64_tr_b16 v[196:197], v249 offset:8256
 ds_read_b64_tr_b16 v[198:199], v249 offset:9792
 s_waitcnt lgkmcnt(8)
 v_mfma_f32_32x32x16_bf16 v[48:63], v[204:207], a[124:127], v[48:63]
 ds_read_b64_tr_b16 v[200:201], v248 offset:8320
 ds_read_b64_tr_b16 v[202:203], v248 offset:9856
 s_waitcnt lgkmcnt(8)
 v_mfma_f32_32x32x16_bf16 v[64:79], v[208:211], a[124:127], v[64:79]
 ds_read_b64_tr_b16 v[204:205], v249 offset:8384
 ds_read_b64_tr_b16 v[206:207], v249 offset:9920
 s_waitcnt lgkmcnt(8)
 v_mfma_f32_32x32x16_bf16 v[80:95], v[212:215], a[124:127], v[80:95]
 s_waitcnt vmcnt(16)
 s_barrier
 ds_read_b64_tr_b16 v[208:209], v248 offset:8448
 ds_read_b64_tr_b16 v[210:211], v248 offset:9984
 s_waitcnt lgkmcnt(8)
 v_mfma_f32_32x32x16_bf16 v[0:15], v[192:195], a[128:131], v[0:15]
 ds_read_b64_tr_b16 v[212:213], v249 offset:8512
 ds_read_b64_tr_b16 v[214:215], v249 offset:10048
 s_waitcnt lgkmcnt(8)
 v_mfma_f32_32x32x16_bf16 v[16:31], v[196:199], a[128:131], v[16:31]
 s_add_u32 m0, s19, 49152
 s_add_u32 s29, s52, 1572864
 buffer_load_dwordx4 v236, s[24:27], s29 offen lds
 s_add_u32 m0, s19, 50176
 s_add_u32 s29, s52, 1572864
 buffer_load_dwordx4 v237, s[24:27], s29 offen lds
 s_add_u32 m0, s19, 51200
 s_add_u32 s29, s52, 1572864
 buffer_load_dwordx4 v238, s[24:27], s29 offen lds
 s_add_u32 m0, s19, 52224
 s_add_u32 s29, s52, 1671168
 buffer_load_dwordx4 v236, s[24:27], s29 offen lds
 s_add_u32 m0, s19, 53248
 s_add_u32 s29, s52, 1671168
 buffer_load_dwordx4 v237, s[24:27], s29 offen lds
 s_add_u32 m0, s19, 54272
 s_add_u32 s29, s52, 1671168
 buffer_load_dwordx4 v238, s[24:27], s29 offen lds
 ds_read_b64_tr_b16 v[192:193], v248 offset:14336
 ds_read_b64_tr_b16 v[194:195], v248 offset:15872
 s_waitcnt lgkmcnt(8)
 v_mfma_f32_32x32x16_bf16 v[32:47], v[200:203], a[128:131], v[32:47]
 ds_read_b64_tr_b16 v[196:197], v249 offset:14400
 ds_read_b64_tr_b16 v[198:199], v249 offset:15936
 s_waitcnt lgkmcnt(8)
 v_mfma_f32_32x32x16_bf16 v[48:63], v[204:207], a[128:131], v[48:63]
 ds_read_b64_tr_b16 v[200:201], v248 offset:14464
 ds_read_b64_tr_b16 v[202:203], v248 offset:16000
 s_waitcnt lgkmcnt(8)
 v_mfma_f32_32x32x16_bf16 v[64:79], v[208:211], a[128:131], v[64:79]
 ds_read_b64_tr_b16 v[204:205], v249 offset:14528
 ds_read_b64_tr_b16 v[206:207], v249 offset:16064
 s_waitcnt lgkmcnt(8)
 v_mfma_f32_32x32x16_bf16 v[80:95], v[212:215], a[128:131], v[80:95]
 ds_read_b64_tr_b16 v[208:209], v248 offset:14592
 ds_read_b64_tr_b16 v[210:211], v248 offset:16128
 s_waitcnt lgkmcnt(8)
 v_mfma_f32_32x32x16_bf16 v[0:15], v[192:195], a[132:135], v[0:15]
 ds_read_b64_tr_b16 v[212:213], v249 offset:14656
 ds_read_b64_tr_b16 v[214:215], v249 offset:16192
 s_waitcnt lgkmcnt(8)
 v_mfma_f32_32x32x16_bf16 v[16:31], v[196:199], a[132:135], v[16:31]
 ds_read_b64_tr_b16 v[192:193], v248 offset:20480
 ds_read_b64_tr_b16 v[194:195], v248 offset:22016
 s_waitcnt lgkmcnt(8)
 v_mfma_f32_32x32x16_bf16 v[32:47], v[200:203], a[132:135], v[32:47]
 ds_read_b64_tr_b16 v[196:197], v249 offset:20544
 ds_read_b64_tr_b16 v[198:199], v249 offset:22080
 s_waitcnt lgkmcnt(8)
 v_mfma_f32_32x32x16_bf16 v[48:63], v[204:207], a[132:135], v[48:63]
 ds_read_b64_tr_b16 v[200:201], v248 offset:20608
 ds_read_b64_tr_b16 v[202:203], v248 offset:22144
 s_waitcnt lgkmcnt(8)
 v_mfma_f32_32x32x16_bf16 v[64:79], v[208:211], a[132:135], v[64:79]
 ds_read_b64_tr_b16 v[204:205], v249 offset:20672
 ds_read_b64_tr_b16 v[206:207], v249 offset:22208
 s_waitcnt lgkmcnt(8)
 v_mfma_f32_32x32x16_bf16 v[80:95], v[212:215], a[132:135], v[80:95]
 ds_read_b64_tr_b16 v[208:209], v248 offset:20736
 ds_read_b64_tr_b16 v[210:211], v248 offset:22272
 s_waitcnt lgkmcnt(8)
 v_mfma_f32_32x32x16_bf16 v[0:15], v[192:195], a[136:139], v[0:15]
 ds_read_b64_tr_b16 v[212:213], v249 offset:20800
 ds_read_b64_tr_b16 v[214:215], v249 offset:22336
 s_waitcnt lgkmcnt(8)
 v_mfma_f32_32x32x16_bf16 v[16:31], v[196:199], a[136:139], v[16:31]
 ds_read_b64_tr_b16 v[192:193], v248 offset:26624
 ds_read_b64_tr_b16 v[194:195], v248 offset:28160
 s_waitcnt lgkmcnt(8)
 v_mfma_f32_32x32x16_bf16 v[32:47], v[200:203], a[136:139], v[32:47]
 ds_read_b64_tr_b16 v[196:197], v249 offset:26688
 ds_read_b64_tr_b16 v[198:199], v249 offset:28224
 s_waitcnt lgkmcnt(8)
 v_mfma_f32_32x32x16_bf16 v[48:63], v[204:207], a[136:139], v[48:63]
 ds_read_b64_tr_b16 v[200:201], v248 offset:26752
 ds_read_b64_tr_b16 v[202:203], v248 offset:28288
 s_waitcnt lgkmcnt(8)
 v_mfma_f32_32x32x16_bf16 v[64:79], v[208:211], a[136:139], v[64:79]
 ds_read_b64_tr_b16 v[204:205], v249 offset:26816
 ds_read_b64_tr_b16 v[206:207], v249 offset:28352
 s_waitcnt lgkmcnt(8)
 v_mfma_f32_32x32x16_bf16 v[80:95], v[212:215], a[136:139], v[80:95]
 ds_read_b64_tr_b16 v[208:209], v248 offset:26880
 ds_read_b64_tr_b16 v[210:211], v248 offset:28416
 s_waitcnt lgkmcnt(8)
 v_mfma_f32_32x32x16_bf16 v[0:15], v[192:195], a[140:143], v[0:15]
 ds_read_b64_tr_b16 v[212:213], v249 offset:26944
 ds_read_b64_tr_b16 v[214:215], v249 offset:28480
 s_waitcnt lgkmcnt(8)
 v_mfma_f32_32x32x16_bf16 v[16:31], v[196:199], a[140:143], v[16:31]
 ds_read_b64_tr_b16 v[192:193], v248 offset:32768
 ds_read_b64_tr_b16 v[194:195], v248 offset:34304
 s_waitcnt lgkmcnt(8)
 v_mfma_f32_32x32x16_bf16 v[32:47], v[200:203], a[140:143], v[32:47]
 ds_read_b64_tr_b16 v[196:197], v249 offset:32832
 ds_read_b64_tr_b16 v[198:199], v249 offset:34368
 s_waitcnt lgkmcnt(8)
 v_mfma_f32_32x32x16_bf16 v[48:63], v[204:207], a[140:143], v[48:63]
 ds_read_b64_tr_b16 v[200:201], v248 offset:32896
 ds_read_b64_tr_b16 v[202:203], v248 offset:34432
 s_waitcnt lgkmcnt(8)
 v_mfma_f32_32x32x16_bf16 v[64:79], v[208:211], a[140:143], v[64:79]
 ds_read_b64_tr_b16 v[204:205], v249 offset:32960
 ds_read_b64_tr_b16 v[206:207], v249 offset:34496
 s_waitcnt lgkmcnt(8)
 v_mfma_f32_32x32x16_bf16 v[80:95], v[212:215], a[140:143], v[80:95]
 s_waitcnt vmcnt(12)
 s_barrier
 ds_read_b64_tr_b16 v[208:209], v248 offset:33024
 ds_read_b64_tr_b16 v[210:211], v248 offset:34560
 s_waitcnt lgkmcnt(8)
 v_mfma_f32_32x32x16_bf16 v[0:15], v[192:195], a[144:147], v[0:15]
 ds_read_b64_tr_b16 v[212:213], v249 offset:33088
 ds_read_b64_tr_b16 v[214:215], v249 offset:34624
 s_waitcnt lgkmcnt(8)
 v_mfma_f32_32x32x16_bf16 v[16:31], v[196:199], a[144:147], v[16:31]
 s_add_u32 m0, s19, 73728
 s_add_u32 s29, s52, 2359296
 buffer_load_dwordx4 v236, s[24:27], s29 offen lds
 s_add_u32 m0, s19, 74752
 s_add_u32 s29, s52, 2359296
 buffer_load_dwordx4 v237, s[24:27], s29 offen lds
 s_add_u32 m0, s19, 75776
 s_add_u32 s29, s52, 2359296
 buffer_load_dwordx4 v238, s[24:27], s29 offen lds
 s_add_u32 m0, s19, 76800
 s_add_u32 s29, s52, 2457600
 buffer_load_dwordx4 v236, s[24:27], s29 offen lds
 s_add_u32 m0, s19, 77824
 s_add_u32 s29, s52, 2457600
 buffer_load_dwordx4 v237, s[24:27], s29 offen lds
 s_add_u32 m0, s19, 78848
 s_add_u32 s29, s52, 2457600
 buffer_load_dwordx4 v238, s[24:27], s29 offen lds
 ds_read_b64_tr_b16 v[192:193], v248 offset:38912
 ds_read_b64_tr_b16 v[194:195], v248 offset:40448
 s_waitcnt lgkmcnt(8)
 v_mfma_f32_32x32x16_bf16 v[32:47], v[200:203], a[144:147], v[32:47]
 ds_read_b64_tr_b16 v[196:197], v249 offset:38976
 ds_read_b64_tr_b16 v[198:199], v249 offset:40512
 s_waitcnt lgkmcnt(8)
 v_mfma_f32_32x32x16_bf16 v[48:63], v[204:207], a[144:147], v[48:63]
 ds_read_b64_tr_b16 v[200:201], v248 offset:39040
 ds_read_b64_tr_b16 v[202:203], v248 offset:40576
 s_waitcnt lgkmcnt(8)
 v_mfma_f32_32x32x16_bf16 v[64:79], v[208:211], a[144:147], v[64:79]
 ds_read_b64_tr_b16 v[204:205], v249 offset:39104
 ds_read_b64_tr_b16 v[206:207], v249 offset:40640
 s_waitcnt lgkmcnt(8)
 v_mfma_f32_32x32x16_bf16 v[80:95], v[212:215], a[144:147], v[80:95]
 ds_read_b64_tr_b16 v[208:209], v248 offset:39168
 ds_read_b64_tr_b16 v[210:211], v248 offset:40704
 s_waitcnt lgkmcnt(8)
 v_mfma_f32_32x32x16_bf16 v[0:15], v[192:195], a[148:151], v[0:15]
 ds_read_b64_tr_b16 v[212:213], v249 offset:39232
 ds_read_b64_tr_b16 v[214:215], v249 offset:40768
 s_waitcnt lgkmcnt(8)
 v_mfma_f32_32x32x16_bf16 v[16:31], v[196:199], a[148:151], v[16:31]
 ds_read_b64_tr_b16 v[192:193], v248 offset:45056
 ds_read_b64_tr_b16 v[194:195], v248 offset:46592
 s_waitcnt lgkmcnt(8)
 v_mfma_f32_32x32x16_bf16 v[32:47], v[200:203], a[148:151], v[32:47]
 ds_read_b64_tr_b16 v[196:197], v249 offset:45120
 ds_read_b64_tr_b16 v[198:199], v249 offset:46656
 s_waitcnt lgkmcnt(8)
 v_mfma_f32_32x32x16_bf16 v[48:63], v[204:207], a[148:151], v[48:63]
 ds_read_b64_tr_b16 v[200:201], v248 offset:45184
 ds_read_b64_tr_b16 v[202:203], v248 offset:46720
 s_waitcnt lgkmcnt(8)
 v_mfma_f32_32x32x16_bf16 v[64:79], v[208:211], a[148:151], v[64:79]
 ds_read_b64_tr_b16 v[204:205], v249 offset:45248
 ds_read_b64_tr_b16 v[206:207], v249 offset:46784
 s_waitcnt lgkmcnt(8)
 v_mfma_f32_32x32x16_bf16 v[80:95], v[212:215], a[148:151], v[80:95]
 ds_read_b64_tr_b16 v[208:209], v248 offset:45312
 ds_read_b64_tr_b16 v[210:211], v248 offset:46848
 s_waitcnt lgkmcnt(8)
 v_mfma_f32_32x32x16_bf16 v[0:15], v[192:195], a[152:155], v[0:15]
 ds_read_b64_tr_b16 v[212:213], v249 offset:45376
 ds_read_b64_tr_b16 v[214:215], v249 offset:46912
 s_waitcnt lgkmcnt(8)
 v_mfma_f32_32x32x16_bf16 v[16:31], v[196:199], a[152:155], v[16:31]
 ds_read_b64_tr_b16 v[192:193], v248 offset:51200
 ds_read_b64_tr_b16 v[194:195], v248 offset:52736
 s_waitcnt lgkmcnt(8)
 v_mfma_f32_32x32x16_bf16 v[32:47], v[200:203], a[152:155], v[32:47]
 ds_read_b64_tr_b16 v[196:197], v249 offset:51264
 ds_read_b64_tr_b16 v[198:199], v249 offset:52800
 s_waitcnt lgkmcnt(8)
 v_mfma_f32_32x32x16_bf16 v[48:63], v[204:207], a[152:155], v[48:63]
 ds_read_b64_tr_b16 v[200:201], v248 offset:51328
 ds_read_b64_tr_b16 v[202:203], v248 offset:52864
 s_waitcnt lgkmcnt(8)
 v_mfma_f32_32x32x16_bf16 v[64:79], v[208:211], a[152:155], v[64:79]
 ds_read_b64_tr_b16 v[204:205], v249 offset:51392
 ds_read_b64_tr_b16 v[206:207], v249 offset:52928
 s_waitcnt lgkmcnt(8)
 v_mfma_f32_32x32x16_bf16 v[80:95], v[212:215], a[152:155], v[80:95]
 ds_read_b64_tr_b16 v[208:209], v248 offset:51456
 ds_read_b64_tr_b16 v[210:211], v248 offset:52992
 s_waitcnt lgkmcnt(8)
 v_mfma_f32_32x32x16_bf16 v[0:15], v[192:195], a[156:159], v[0:15]
 ds_read_b64_tr_b16 v[212:213], v249 offset:51520
 ds_read_b64_tr_b16 v[214:215], v249 offset:53056
 s_waitcnt lgkmcnt(8)
 v_mfma_f32_32x32x16_bf16 v[16:31], v[196:199], a[156:159], v[16:31]
 ds_read_b64_tr_b16 v[192:193], v240 offset:0
 ds_read_b64_tr_b16 v[194:195], v240 offset:1536
 s_waitcnt lgkmcnt(8)
 v_mfma_f32_32x32x16_bf16 v[32:47], v[200:203], a[156:159], v[32:47]
 ds_read_b64_tr_b16 v[196:197], v241 offset:64
 ds_read_b64_tr_b16 v[198:199], v241 offset:1600
 s_waitcnt lgkmcnt(8)
 v_mfma_f32_32x32x16_bf16 v[48:63], v[204:207], a[156:159], v[48:63]
 ds_read_b64_tr_b16 v[200:201], v240 offset:128
 ds_read_b64_tr_b16 v[202:203], v240 offset:1664
 s_waitcnt lgkmcnt(8)
 v_mfma_f32_32x32x16_bf16 v[64:79], v[208:211], a[156:159], v[64:79]
 ds_read_b64_tr_b16 v[204:205], v241 offset:192
 ds_read_b64_tr_b16 v[206:207], v241 offset:1728
 s_waitcnt lgkmcnt(8)
 v_mfma_f32_32x32x16_bf16 v[80:95], v[212:215], a[156:159], v[80:95]
 s_waitcnt vmcnt(12)
 s_barrier
 ds_read_b64_tr_b16 v[208:209], v240 offset:256
 ds_read_b64_tr_b16 v[210:211], v240 offset:1792
 s_waitcnt lgkmcnt(8)
 v_mfma_f32_32x32x16_bf16 v[96:111], v[192:195], a[0:3], 0
 ds_read_b64_tr_b16 v[212:213], v241 offset:320
 ds_read_b64_tr_b16 v[214:215], v241 offset:1856
 s_waitcnt lgkmcnt(8)
 v_mfma_f32_32x32x16_bf16 v[112:127], v[196:199], a[0:3], 0
 s_add_u32 m0, s19, 98304
 s_add_u32 s29, s52, 3145728
 buffer_load_dwordx4 v236, s[24:27], s29 offen lds
 s_add_u32 m0, s19, 99328
 s_add_u32 s29, s52, 3145728
 buffer_load_dwordx4 v237, s[24:27], s29 offen lds
 s_add_u32 m0, s19, 100352
 s_add_u32 s29, s52, 3145728
 buffer_load_dwordx4 v238, s[24:27], s29 offen lds
 s_add_u32 m0, s19, 101376
 s_add_u32 s29, s52, 3244032
 buffer_load_dwordx4 v236, s[24:27], s29 offen lds
 s_add_u32 m0, s19, 102400
 s_add_u32 s29, s52, 3244032
 buffer_load_dwordx4 v237, s[24:27], s29 offen lds
 s_add_u32 m0, s19, 103424
 s_add_u32 s29, s52, 3244032
 buffer_load_dwordx4 v238, s[24:27], s29 offen lds
 ds_read_b64_tr_b16 v[192:193], v240 offset:6144
 ds_read_b64_tr_b16 v[194:195], v240 offset:7680
 s_waitcnt lgkmcnt(8)
 v_mfma_f32_32x32x16_bf16 v[128:143], v[200:203], a[0:3], 0
 ds_read_b64_tr_b16 v[196:197], v241 offset:6208
 ds_read_b64_tr_b16 v[198:199], v241 offset:7744
 s_waitcnt lgkmcnt(8)
 v_mfma_f32_32x32x16_bf16 v[144:159], v[204:207], a[0:3], 0
 ds_read_b64_tr_b16 v[200:201], v240 offset:6272
 ds_read_b64_tr_b16 v[202:203], v240 offset:7808
 s_waitcnt lgkmcnt(8)
 v_mfma_f32_32x32x16_bf16 v[160:175], v[208:211], a[0:3], 0
 v_cvt_pk_bf16_f32 v216, v0, v1
 v_cvt_pk_bf16_f32 v217, v2, v3
 v_cvt_pk_bf16_f32 v218, v4, v5
 ds_read_b64_tr_b16 v[204:205], v241 offset:6336
 ds_read_b64_tr_b16 v[206:207], v241 offset:7872
 s_waitcnt lgkmcnt(8)
 v_mfma_f32_32x32x16_bf16 v[176:191], v[212:215], a[0:3], 0
 ds_read_b64_tr_b16 v[208:209], v240 offset:6400
 ds_read_b64_tr_b16 v[210:211], v240 offset:7936
 s_waitcnt lgkmcnt(8)
 v_mfma_f32_32x32x16_bf16 v[96:111], v[192:195], a[4:7], v[96:111]
 ds_read_b64_tr_b16 v[212:213], v241 offset:6464
 ds_read_b64_tr_b16 v[214:215], v241 offset:8000
 s_waitcnt lgkmcnt(8)
 v_mfma_f32_32x32x16_bf16 v[112:127], v[196:199], a[4:7], v[112:127]
 ds_read_b64_tr_b16 v[192:193], v240 offset:12288
 ds_read_b64_tr_b16 v[194:195], v240 offset:13824
 s_waitcnt lgkmcnt(8)
 v_mfma_f32_32x32x16_bf16 v[128:143], v[200:203], a[4:7], v[128:143]
 v_cvt_pk_bf16_f32 v219, v6, v7
 v_cvt_pk_bf16_f32 v220, v8, v9
 v_cvt_pk_bf16_f32 v221, v10, v11
 ds_read_b64_tr_b16 v[196:197], v241 offset:12352
 ds_read_b64_tr_b16 v[198:199], v241 offset:13888
 s_waitcnt lgkmcnt(8)
 v_mfma_f32_32x32x16_bf16 v[144:159], v[204:207], a[4:7], v[144:159]
 ds_read_b64_tr_b16 v[200:201], v240 offset:12416
 ds_read_b64_tr_b16 v[202:203], v240 offset:13952
 s_waitcnt lgkmcnt(8)
 v_mfma_f32_32x32x16_bf16 v[160:175], v[208:211], a[4:7], v[160:175]
 ds_read_b64_tr_b16 v[204:205], v241 offset:12480
 ds_read_b64_tr_b16 v[206:207], v241 offset:14016
 s_waitcnt lgkmcnt(8)
 v_mfma_f32_32x32x16_bf16 v[176:191], v[212:215], a[4:7], v[176:191]
 ds_read_b64_tr_b16 v[208:209], v240 offset:12544
 ds_read_b64_tr_b16 v[210:211], v240 offset:14080
 s_waitcnt lgkmcnt(8)
 v_mfma_f32_32x32x16_bf16 v[96:111], v[192:195], a[8:11], v[96:111]
 v_cvt_pk_bf16_f32 v222, v12, v13
 v_cvt_pk_bf16_f32 v223, v14, v15
 buffer_store_dwordx4 v[216:219], v244, s[8:11], s53 offen offset:0 sc1
 ds_read_b64_tr_b16 v[212:213], v241 offset:12608
 ds_read_b64_tr_b16 v[214:215], v241 offset:14144
 s_waitcnt lgkmcnt(8)
 v_mfma_f32_32x32x16_bf16 v[112:127], v[196:199], a[8:11], v[112:127]
 ds_read_b64_tr_b16 v[192:193], v240 offset:18432
 ds_read_b64_tr_b16 v[194:195], v240 offset:19968
 s_waitcnt lgkmcnt(8)
 v_mfma_f32_32x32x16_bf16 v[128:143], v[200:203], a[8:11], v[128:143]
 ds_read_b64_tr_b16 v[196:197], v241 offset:18496
 ds_read_b64_tr_b16 v[198:199], v241 offset:20032
 s_waitcnt lgkmcnt(8)
 v_mfma_f32_32x32x16_bf16 v[144:159], v[204:207], a[8:11], v[144:159]
 ds_read_b64_tr_b16 v[200:201], v240 offset:18560
 ds_read_b64_tr_b16 v[202:203], v240 offset:20096
 s_waitcnt lgkmcnt(8)
 v_mfma_f32_32x32x16_bf16 v[160:175], v[208:211], a[8:11], v[160:175]
 buffer_store_dwordx4 v[220:223], v244, s[8:11], s53 offen offset:512 sc1
 s_add_u32 s53, s53, 1024
 ds_read_b64_tr_b16 v[204:205], v241 offset:18624
 ds_read_b64_tr_b16 v[206:207], v241 offset:20160
 s_waitcnt lgkmcnt(8)
 v_mfma_f32_32x32x16_bf16 v[176:191], v[212:215], a[8:11], v[176:191]
 ds_read_b64_tr_b16 v[208:209], v240 offset:18688
 ds_read_b64_tr_b16 v[210:211], v240 offset:20224
 s_waitcnt lgkmcnt(8)
 v_mfma_f32_32x32x16_bf16 v[96:111], v[192:195], a[12:15], v[96:111]
 ds_read_b64_tr_b16 v[212:213], v241 offset:18752
 ds_read_b64_tr_b16 v[214:215], v241 offset:20288
 s_waitcnt lgkmcnt(8)
 v_mfma_f32_32x32x16_bf16 v[112:127], v[196:199], a[12:15], v[112:127]
 ds_read_b64_tr_b16 v[192:193], v240 offset:24576
 ds_read_b64_tr_b16 v[194:195], v240 offset:26112
 s_waitcnt lgkmcnt(8)
 v_mfma_f32_32x32x16_bf16 v[128:143], v[200:203], a[12:15], v[128:143]
 ds_read_b64_tr_b16 v[196:197], v241 offset:24640
 ds_read_b64_tr_b16 v[198:199], v241 offset:26176
 s_waitcnt lgkmcnt(8)
 v_mfma_f32_32x32x16_bf16 v[144:159], v[204:207], a[12:15], v[144:159]
 ds_read_b64_tr_b16 v[200:201], v240 offset:24704
 ds_read_b64_tr_b16 v[202:203], v240 offset:26240
 s_waitcnt lgkmcnt(8)
 v_mfma_f32_32x32x16_bf16 v[160:175], v[208:211], a[12:15], v[160:175]
 ds_read_b64_tr_b16 v[204:205], v241 offset:24768
 ds_read_b64_tr_b16 v[206:207], v241 offset:26304
 s_waitcnt lgkmcnt(8)
 v_mfma_f32_32x32x16_bf16 v[176:191], v[212:215], a[12:15], v[176:191]
 s_waitcnt vmcnt(14)
 s_barrier
 ds_read_b64_tr_b16 v[208:209], v240 offset:24832
 ds_read_b64_tr_b16 v[210:211], v240 offset:26368
 s_waitcnt lgkmcnt(8)
 v_mfma_f32_32x32x16_bf16 v[96:111], v[192:195], a[16:19], v[96:111]
 ds_read_b64_tr_b16 v[212:213], v241 offset:24896
 ds_read_b64_tr_b16 v[214:215], v241 offset:26432
 s_waitcnt lgkmcnt(8)
 v_mfma_f32_32x32x16_bf16 v[112:127], v[196:199], a[16:19], v[112:127]
 s_add_u32 m0, s19, 0
 s_add_u32 s29, s52, 3932160
 buffer_load_dwordx4 v236, s[24:27], s29 offen lds
 s_add_u32 m0, s19, 1024
 s_add_u32 s29, s52, 3932160
 buffer_load_dwordx4 v237, s[24:27], s29 offen lds
 s_add_u32 m0, s19, 2048
 s_add_u32 s29, s52, 3932160
 buffer_load_dwordx4 v238, s[24:27], s29 offen lds
 s_add_u32 m0, s19, 3072
 s_add_u32 s29, s52, 4030464
 buffer_load_dwordx4 v236, s[24:27], s29 offen lds
 s_add_u32 m0, s19, 4096
 s_add_u32 s29, s52, 4030464
 buffer_load_dwordx4 v237, s[24:27], s29 offen lds
 s_add_u32 m0, s19, 5120
 s_add_u32 s29, s52, 4030464
 buffer_load_dwordx4 v238, s[24:27], s29 offen lds
 ds_read_b64_tr_b16 v[192:193], v240 offset:30720
 ds_read_b64_tr_b16 v[194:195], v240 offset:32256
 s_waitcnt lgkmcnt(8)
 v_mfma_f32_32x32x16_bf16 v[128:143], v[200:203], a[16:19], v[128:143]
 ds_read_b64_tr_b16 v[196:197], v241 offset:30784
 ds_read_b64_tr_b16 v[198:199], v241 offset:32320
 s_waitcnt lgkmcnt(8)
 v_mfma_f32_32x32x16_bf16 v[144:159], v[204:207], a[16:19], v[144:159]
 ds_read_b64_tr_b16 v[200:201], v240 offset:30848
 ds_read_b64_tr_b16 v[202:203], v240 offset:32384
 s_waitcnt lgkmcnt(8)
 v_mfma_f32_32x32x16_bf16 v[160:175], v[208:211], a[16:19], v[160:175]
 v_cvt_pk_bf16_f32 v224, v16, v17
 v_cvt_pk_bf16_f32 v225, v18, v19
 v_cvt_pk_bf16_f32 v226, v20, v21
 ds_read_b64_tr_b16 v[204:205], v241 offset:30912
 ds_read_b64_tr_b16 v[206:207], v241 offset:32448
 s_waitcnt lgkmcnt(8)
 v_mfma_f32_32x32x16_bf16 v[176:191], v[212:215], a[16:19], v[176:191]
 ds_read_b64_tr_b16 v[208:209], v240 offset:30976
 ds_read_b64_tr_b16 v[210:211], v240 offset:32512
 s_waitcnt lgkmcnt(8)
 v_mfma_f32_32x32x16_bf16 v[96:111], v[192:195], a[20:23], v[96:111]
 ds_read_b64_tr_b16 v[212:213], v241 offset:31040
 ds_read_b64_tr_b16 v[214:215], v241 offset:32576
 s_waitcnt lgkmcnt(8)
 v_mfma_f32_32x32x16_bf16 v[112:127], v[196:199], a[20:23], v[112:127]
 ds_read_b64_tr_b16 v[192:193], v240 offset:36864
 ds_read_b64_tr_b16 v[194:195], v240 offset:38400
 s_waitcnt lgkmcnt(8)
 v_mfma_f32_32x32x16_bf16 v[128:143], v[200:203], a[20:23], v[128:143]
 v_cvt_pk_bf16_f32 v227, v22, v23
 v_cvt_pk_bf16_f32 v228, v24, v25
 v_cvt_pk_bf16_f32 v229, v26, v27
 ds_read_b64_tr_b16 v[196:197], v241 offset:36928
 ds_read_b64_tr_b16 v[198:199], v241 offset:38464
 s_waitcnt lgkmcnt(8)
 v_mfma_f32_32x32x16_bf16 v[144:159], v[204:207], a[20:23], v[144:159]
 ds_read_b64_tr_b16 v[200:201], v240 offset:36992
 ds_read_b64_tr_b16 v[202:203], v240 offset:38528
 s_waitcnt lgkmcnt(8)
 v_mfma_f32_32x32x16_bf16 v[160:175], v[208:211], a[20:23], v[160:175]
 ds_read_b64_tr_b16 v[204:205], v241 offset:37056
 ds_read_b64_tr_b16 v[206:207], v241 offset:38592
 s_waitcnt lgkmcnt(8)
 v_mfma_f32_32x32x16_bf16 v[176:191], v[212:215], a[20:23], v[176:191]
 ds_read_b64_tr_b16 v[208:209], v240 offset:37120
 ds_read_b64_tr_b16 v[210:211], v240 offset:38656
 s_waitcnt lgkmcnt(8)
 v_mfma_f32_32x32x16_bf16 v[96:111], v[192:195], a[24:27], v[96:111]
 v_cvt_pk_bf16_f32 v230, v28, v29
 v_cvt_pk_bf16_f32 v231, v30, v31
 buffer_store_dwordx4 v[224:227], v244, s[8:11], s53 offen offset:0 sc1
 ds_read_b64_tr_b16 v[212:213], v241 offset:37184
 ds_read_b64_tr_b16 v[214:215], v241 offset:38720
 s_waitcnt lgkmcnt(8)
 v_mfma_f32_32x32x16_bf16 v[112:127], v[196:199], a[24:27], v[112:127]
 ds_read_b64_tr_b16 v[192:193], v240 offset:43008
 ds_read_b64_tr_b16 v[194:195], v240 offset:44544
 s_waitcnt lgkmcnt(8)
 v_mfma_f32_32x32x16_bf16 v[128:143], v[200:203], a[24:27], v[128:143]
 ds_read_b64_tr_b16 v[196:197], v241 offset:43072
 ds_read_b64_tr_b16 v[198:199], v241 offset:44608
 s_waitcnt lgkmcnt(8)
 v_mfma_f32_32x32x16_bf16 v[144:159], v[204:207], a[24:27], v[144:159]
 ds_read_b64_tr_b16 v[200:201], v240 offset:43136
 ds_read_b64_tr_b16 v[202:203], v240 offset:44672
 s_waitcnt lgkmcnt(8)
 v_mfma_f32_32x32x16_bf16 v[160:175], v[208:211], a[24:27], v[160:175]
 buffer_store_dwordx4 v[228:231], v244, s[8:11], s53 offen offset:512 sc1
 s_add_u32 s53, s53, 1024
 ds_read_b64_tr_b16 v[204:205], v241 offset:43200
 ds_read_b64_tr_b16 v[206:207], v241 offset:44736
 s_waitcnt lgkmcnt(8)
 v_mfma_f32_32x32x16_bf16 v[176:191], v[212:215], a[24:27], v[176:191]
 ds_read_b64_tr_b16 v[208:209], v240 offset:43264
 ds_read_b64_tr_b16 v[210:211], v240 offset:44800
 s_waitcnt lgkmcnt(8)
 v_mfma_f32_32x32x16_bf16 v[96:111], v[192:195], a[28:31], v[96:111]
 ds_read_b64_tr_b16 v[212:213], v241 offset:43328
 ds_read_b64_tr_b16 v[214:215], v241 offset:44864
 s_waitcnt lgkmcnt(8)
 v_mfma_f32_32x32x16_bf16 v[112:127], v[196:199], a[28:31], v[112:127]
 ds_read_b64_tr_b16 v[192:193], v240 offset:49152
 ds_read_b64_tr_b16 v[194:195], v240 offset:50688
 s_waitcnt lgkmcnt(8)
 v_mfma_f32_32x32x16_bf16 v[128:143], v[200:203], a[28:31], v[128:143]
 ds_read_b64_tr_b16 v[196:197], v241 offset:49216
 ds_read_b64_tr_b16 v[198:199], v241 offset:50752
 s_waitcnt lgkmcnt(8)
 v_mfma_f32_32x32x16_bf16 v[144:159], v[204:207], a[28:31], v[144:159]
 ds_read_b64_tr_b16 v[200:201], v240 offset:49280
 ds_read_b64_tr_b16 v[202:203], v240 offset:50816
 s_waitcnt lgkmcnt(8)
 v_mfma_f32_32x32x16_bf16 v[160:175], v[208:211], a[28:31], v[160:175]
 ds_read_b64_tr_b16 v[204:205], v241 offset:49344
 ds_read_b64_tr_b16 v[206:207], v241 offset:50880
 s_waitcnt lgkmcnt(8)
 v_mfma_f32_32x32x16_bf16 v[176:191], v[212:215], a[28:31], v[176:191]
 s_waitcnt vmcnt(16)
 s_barrier
 ds_read_b64_tr_b16 v[208:209], v240 offset:49408
 ds_read_b64_tr_b16 v[210:211], v240 offset:50944
 s_waitcnt lgkmcnt(8)
 v_mfma_f32_32x32x16_bf16 v[96:111], v[192:195], a[32:35], v[96:111]
 ds_read_b64_tr_b16 v[212:213], v241 offset:49472
 ds_read_b64_tr_b16 v[214:215], v241 offset:51008
 s_waitcnt lgkmcnt(8)
 v_mfma_f32_32x32x16_bf16 v[112:127], v[196:199], a[32:35], v[112:127]
 s_add_u32 m0, s19, 24576
 s_add_u32 s29, s52, 4718592
 buffer_load_dwordx4 v236, s[24:27], s29 offen lds
 s_add_u32 m0, s19, 25600
 s_add_u32 s29, s52, 4718592
 buffer_load_dwordx4 v237, s[24:27], s29 offen lds
 s_add_u32 m0, s19, 26624
 s_add_u32 s29, s52, 4718592
 buffer_load_dwordx4 v238, s[24:27], s29 offen lds
 s_add_u32 m0, s19, 27648
 s_add_u32 s29, s52, 4816896
 buffer_load_dwordx4 v236, s[24:27], s29 offen lds
 s_add_u32 m0, s19, 28672
 s_add_u32 s29, s52, 4816896
 buffer_load_dwordx4 v237, s[24:27], s29 offen lds
 s_add_u32 m0, s19, 29696
 s_add_u32 s29, s52, 4816896
 buffer_load_dwordx4 v238, s[24:27], s29 offen lds
 ds_read_b64_tr_b16 v[192:193], v240 offset:55296
 ds_read_b64_tr_b16 v[194:195], v240 offset:56832
 s_waitcnt lgkmcnt(8)
 v_mfma_f32_32x32x16_bf16 v[128:143], v[200:203], a[32:35], v[128:143]
 ds_read_b64_tr_b16 v[196:197], v241 offset:55360
 ds_read_b64_tr_b16 v[198:199], v241 offset:56896
 s_waitcnt lgkmcnt(8)
 v_mfma_f32_32x32x16_bf16 v[144:159], v[204:207], a[32:35], v[144:159]
 ds_read_b64_tr_b16 v[200:201], v240 offset:55424
 ds_read_b64_tr_b16 v[202:203], v240 offset:56960
 s_waitcnt lgkmcnt(8)
 v_mfma_f32_32x32x16_bf16 v[160:175], v[208:211], a[32:35], v[160:175]
 v_cvt_pk_bf16_f32 v216, v32, v33
 v_cvt_pk_bf16_f32 v217, v34, v35
 v_cvt_pk_bf16_f32 v218, v36, v37
 ds_read_b64_tr_b16 v[204:205], v241 offset:55488
 ds_read_b64_tr_b16 v[206:207], v241 offset:57024
 s_waitcnt lgkmcnt(8)
 v_mfma_f32_32x32x16_bf16 v[176:191], v[212:215], a[32:35], v[176:191]
 ds_read_b64_tr_b16 v[208:209], v240 offset:55552
 ds_read_b64_tr_b16 v[210:211], v240 offset:57088
 s_waitcnt lgkmcnt(8)
 v_mfma_f32_32x32x16_bf16 v[96:111], v[192:195], a[36:39], v[96:111]
 ds_read_b64_tr_b16 v[212:213], v241 offset:55616
 ds_read_b64_tr_b16 v[214:215], v241 offset:57152
 s_waitcnt lgkmcnt(8)
 v_mfma_f32_32x32x16_bf16 v[112:127], v[196:199], a[36:39], v[112:127]
 ds_read_b64_tr_b16 v[192:193], v240 offset:61440
 ds_read_b64_tr_b16 v[194:195], v240 offset:62976
 s_waitcnt lgkmcnt(8)
 v_mfma_f32_32x32x16_bf16 v[128:143], v[200:203], a[36:39], v[128:143]
 v_cvt_pk_bf16_f32 v219, v38, v39
 v_cvt_pk_bf16_f32 v220, v40, v41
 v_cvt_pk_bf16_f32 v221, v42, v43
 ds_read_b64_tr_b16 v[196:197], v241 offset:61504
 ds_read_b64_tr_b16 v[198:199], v241 offset:63040
 s_waitcnt lgkmcnt(8)
 v_mfma_f32_32x32x16_bf16 v[144:159], v[204:207], a[36:39], v[144:159]
 ds_read_b64_tr_b16 v[200:201], v240 offset:61568
 ds_read_b64_tr_b16 v[202:203], v240 offset:63104
 s_waitcnt lgkmcnt(8)
 v_mfma_f32_32x32x16_bf16 v[160:175], v[208:211], a[36:39], v[160:175]
 ds_read_b64_tr_b16 v[204:205], v241 offset:61632
 ds_read_b64_tr_b16 v[206:207], v241 offset:63168
 s_waitcnt lgkmcnt(8)
 v_mfma_f32_32x32x16_bf16 v[176:191], v[212:215], a[36:39], v[176:191]
 ds_read_b64_tr_b16 v[208:209], v240 offset:61696
 ds_read_b64_tr_b16 v[210:211], v240 offset:63232
 s_waitcnt lgkmcnt(8)
 v_mfma_f32_32x32x16_bf16 v[96:111], v[192:195], a[40:43], v[96:111]
 v_cvt_pk_bf16_f32 v222, v44, v45
 v_cvt_pk_bf16_f32 v223, v46, v47
 buffer_store_dwordx4 v[216:219], v244, s[8:11], s53 offen offset:0 sc1
 ds_read_b64_tr_b16 v[212:213], v241 offset:61760
 ds_read_b64_tr_b16 v[214:215], v241 offset:63296
 s_waitcnt lgkmcnt(8)
 v_mfma_f32_32x32x16_bf16 v[112:127], v[196:199], a[40:43], v[112:127]
 ds_read_b64_tr_b16 v[192:193], v248 offset:2048
 ds_read_b64_tr_b16 v[194:195], v248 offset:3584
 s_waitcnt lgkmcnt(8)
 v_mfma_f32_32x32x16_bf16 v[128:143], v[200:203], a[40:43], v[128:143]
 ds_read_b64_tr_b16 v[196:197], v249 offset:2112
 ds_read_b64_tr_b16 v[198:199], v249 offset:3648
 s_waitcnt lgkmcnt(8)
 v_mfma_f32_32x32x16_bf16 v[144:159], v[204:207], a[40:43], v[144:159]
 ds_read_b64_tr_b16 v[200:201], v248 offset:2176
 ds_read_b64_tr_b16 v[202:203], v248 offset:3712
 s_waitcnt lgkmcnt(8)
 v_mfma_f32_32x32x16_bf16 v[160:175], v[208:211], a[40:43], v[160:175]
 buffer_store_dwordx4 v[220:223], v244, s[8:11], s53 offen offset:512 sc1
 s_add_u32 s53, s53, 1024
 ds_read_b64_tr_b16 v[204:205], v249 offset:2240
 ds_read_b64_tr_b16 v[206:207], v249 offset:3776
 s_waitcnt lgkmcnt(8)
 v_mfma_f32_32x32x16_bf16 v[176:191], v[212:215], a[40:43], v[176:191]
 ds_read_b64_tr_b16 v[208:209], v248 offset:2304
 ds_read_b64_tr_b16 v[210:211], v248 offset:3840
 s_waitcnt lgkmcnt(8)
 v_mfma_f32_32x32x16_bf16 v[96:111], v[192:195], a[44:47], v[96:111]
 ds_read_b64_tr_b16 v[212:213], v249 offset:2368
 ds_read_b64_tr_b16 v[214:215], v249 offset:3904
 s_waitcnt lgkmcnt(8)
 v_mfma_f32_32x32x16_bf16 v[112:127], v[196:199], a[44:47], v[112:127]
 ds_read_b64_tr_b16 v[192:193], v248 offset:8192
 ds_read_b64_tr_b16 v[194:195], v248 offset:9728
 s_waitcnt lgkmcnt(8)
 v_mfma_f32_32x32x16_bf16 v[128:143], v[200:203], a[44:47], v[128:143]
 ds_read_b64_tr_b16 v[196:197], v249 offset:8256
 ds_read_b64_tr_b16 v[198:199], v249 offset:9792
 s_waitcnt lgkmcnt(8)
 v_mfma_f32_32x32x16_bf16 v[144:159], v[204:207], a[44:47], v[144:159]
 ds_read_b64_tr_b16 v[200:201], v248 offset:8320
 ds_read_b64_tr_b16 v[202:203], v248 offset:9856
 s_waitcnt lgkmcnt(8)
 v_mfma_f32_32x32x16_bf16 v[160:175], v[208:211], a[44:47], v[160:175]
 ds_read_b64_tr_b16 v[204:205], v249 offset:8384
 ds_read_b64_tr_b16 v[206:207], v249 offset:9920
 s_waitcnt lgkmcnt(8)
 v_mfma_f32_32x32x16_bf16 v[176:191], v[212:215], a[44:47], v[176:191]
 s_waitcnt vmcnt(18)
 s_barrier
 ds_read_b64_tr_b16 v[208:209], v248 offset:8448
 ds_read_b64_tr_b16 v[210:211], v248 offset:9984
 s_waitcnt lgkmcnt(8)
 v_mfma_f32_32x32x16_bf16 v[96:111], v[192:195], a[48:51], v[96:111]
 ds_read_b64_tr_b16 v[212:213], v249 offset:8512
 ds_read_b64_tr_b16 v[214:215], v249 offset:10048
 s_waitcnt lgkmcnt(8)
 v_mfma_f32_32x32x16_bf16 v[112:127], v[196:199], a[48:51], v[112:127]
 s_add_u32 m0, s19, 49152
 s_add_u32 s29, s52, 5505024
 buffer_load_dwordx4 v236, s[24:27], s29 offen lds
 s_add_u32 m0, s19, 50176
 s_add_u32 s29, s52, 5505024
 buffer_load_dwordx4 v237, s[24:27], s29 offen lds
 s_add_u32 m0, s19, 51200
 s_add_u32 s29, s52, 5505024
 buffer_load_dwordx4 v238, s[24:27], s29 offen lds
 s_add_u32 m0, s19, 52224
 s_add_u32 s29, s52, 5603328
 buffer_load_dwordx4 v236, s[24:27], s29 offen lds
 s_add_u32 m0, s19, 53248
 s_add_u32 s29, s52, 5603328
 buffer_load_dwordx4 v237, s[24:27], s29 offen lds
 s_add_u32 m0, s19, 54272
 s_add_u32 s29, s52, 5603328
 buffer_load_dwordx4 v238, s[24:27], s29 offen lds
 ds_read_b64_tr_b16 v[192:193], v248 offset:14336
 ds_read_b64_tr_b16 v[194:195], v248 offset:15872
 s_waitcnt lgkmcnt(8)
 v_mfma_f32_32x32x16_bf16 v[128:143], v[200:203], a[48:51], v[128:143]
 ds_read_b64_tr_b16 v[196:197], v249 offset:14400
 ds_read_b64_tr_b16 v[198:199], v249 offset:15936
 s_waitcnt lgkmcnt(8)
 v_mfma_f32_32x32x16_bf16 v[144:159], v[204:207], a[48:51], v[144:159]
 ds_read_b64_tr_b16 v[200:201], v248 offset:14464
 ds_read_b64_tr_b16 v[202:203], v248 offset:16000
 s_waitcnt lgkmcnt(8)
 v_mfma_f32_32x32x16_bf16 v[160:175], v[208:211], a[48:51], v[160:175]
 v_cvt_pk_bf16_f32 v224, v48, v49
 v_cvt_pk_bf16_f32 v225, v50, v51
 v_cvt_pk_bf16_f32 v226, v52, v53
 ds_read_b64_tr_b16 v[204:205], v249 offset:14528
 ds_read_b64_tr_b16 v[206:207], v249 offset:16064
 s_waitcnt lgkmcnt(8)
 v_mfma_f32_32x32x16_bf16 v[176:191], v[212:215], a[48:51], v[176:191]
 ds_read_b64_tr_b16 v[208:209], v248 offset:14592
 ds_read_b64_tr_b16 v[210:211], v248 offset:16128
 s_waitcnt lgkmcnt(8)
 v_mfma_f32_32x32x16_bf16 v[96:111], v[192:195], a[52:55], v[96:111]
 ds_read_b64_tr_b16 v[212:213], v249 offset:14656
 ds_read_b64_tr_b16 v[214:215], v249 offset:16192
 s_waitcnt lgkmcnt(8)
 v_mfma_f32_32x32x16_bf16 v[112:127], v[196:199], a[52:55], v[112:127]
 ds_read_b64_tr_b16 v[192:193], v248 offset:20480
 ds_read_b64_tr_b16 v[194:195], v248 offset:22016
 s_waitcnt lgkmcnt(8)
 v_mfma_f32_32x32x16_bf16 v[128:143], v[200:203], a[52:55], v[128:143]
 v_cvt_pk_bf16_f32 v227, v54, v55
 v_cvt_pk_bf16_f32 v228, v56, v57
 v_cvt_pk_bf16_f32 v229, v58, v59
 ds_read_b64_tr_b16 v[196:197], v249 offset:20544
 ds_read_b64_tr_b16 v[198:199], v249 offset:22080
 s_waitcnt lgkmcnt(8)
 v_mfma_f32_32x32x16_bf16 v[144:159], v[204:207], a[52:55], v[144:159]
 ds_read_b64_tr_b16 v[200:201], v248 offset:20608
 ds_read_b64_tr_b16 v[202:203], v248 offset:22144
 s_waitcnt lgkmcnt(8)
 v_mfma_f32_32x32x16_bf16 v[160:175], v[208:211], a[52:55], v[160:175]
 ds_read_b64_tr_b16 v[204:205], v249 offset:20672
 ds_read_b64_tr_b16 v[206:207], v249 offset:22208
 s_waitcnt lgkmcnt(8)
 v_mfma_f32_32x32x16_bf16 v[176:191], v[212:215], a[52:55], v[176:191]
 ds_read_b64_tr_b16 v[208:209], v248 offset:20736
 ds_read_b64_tr_b16 v[210:211], v248 offset:22272
 s_waitcnt lgkmcnt(8)
 v_mfma_f32_32x32x16_bf16 v[96:111], v[192:195], a[56:59], v[96:111]
 v_cvt_pk_bf16_f32 v230, v60, v61
 v_cvt_pk_bf16_f32 v231, v62, v63
 buffer_store_dwordx4 v[224:227], v244, s[8:11], s53 offen offset:0 sc1
 ds_read_b64_tr_b16 v[212:213], v249 offset:20800
 ds_read_b64_tr_b16 v[214:215], v249 offset:22336
 s_waitcnt lgkmcnt(8)
 v_mfma_f32_32x32x16_bf16 v[112:127], v[196:199], a[56:59], v[112:127]
 ds_read_b64_tr_b16 v[192:193], v248 offset:26624
 ds_read_b64_tr_b16 v[194:195], v248 offset:28160
 s_waitcnt lgkmcnt(8)
 v_mfma_f32_32x32x16_bf16 v[128:143], v[200:203], a[56:59], v[128:143]
 ds_read_b64_tr_b16 v[196:197], v249 offset:26688
 ds_read_b64_tr_b16 v[198:199], v249 offset:28224
 s_waitcnt lgkmcnt(8)
 v_mfma_f32_32x32x16_bf16 v[144:159], v[204:207], a[56:59], v[144:159]
 ds_read_b64_tr_b16 v[200:201], v248 offset:26752
 ds_read_b64_tr_b16 v[202:203], v248 offset:28288
 s_waitcnt lgkmcnt(8)
 v_mfma_f32_32x32x16_bf16 v[160:175], v[208:211], a[56:59], v[160:175]
 buffer_store_dwordx4 v[228:231], v244, s[8:11], s53 offen offset:512 sc1
 s_add_u32 s53, s53, 1024
 ds_read_b64_tr_b16 v[204:205], v249 offset:26816
 ds_read_b64_tr_b16 v[206:207], v249 offset:28352
 s_waitcnt lgkmcnt(8)
 v_mfma_f32_32x32x16_bf16 v[176:191], v[212:215], a[56:59], v[176:191]
 ds_read_b64_tr_b16 v[208:209], v248 offset:26880
 ds_read_b64_tr_b16 v[210:211], v248 offset:28416
 s_waitcnt lgkmcnt(8)
 v_mfma_f32_32x32x16_bf16 v[96:111], v[192:195], a[60:63], v[96:111]
 ds_read_b64_tr_b16 v[212:213], v249 offset:26944
 ds_read_b64_tr_b16 v[214:215], v249 offset:28480
 s_waitcnt lgkmcnt(8)
 v_mfma_f32_32x32x16_bf16 v[112:127], v[196:199], a[60:63], v[112:127]
 ds_read_b64_tr_b16 v[192:193], v248 offset:32768
 ds_read_b64_tr_b16 v[194:195], v248 offset:34304
 s_waitcnt lgkmcnt(8)
 v_mfma_f32_32x32x16_bf16 v[128:143], v[200:203], a[60:63], v[128:143]
 ds_read_b64_tr_b16 v[196:197], v249 offset:32832
 ds_read_b64_tr_b16 v[198:199], v249 offset:34368
 s_waitcnt lgkmcnt(8)
 v_mfma_f32_32x32x16_bf16 v[144:159], v[204:207], a[60:63], v[144:159]
 ds_read_b64_tr_b16 v[200:201], v248 offset:32896
 ds_read_b64_tr_b16 v[202:203], v248 offset:34432
 s_waitcnt lgkmcnt(8)
 v_mfma_f32_32x32x16_bf16 v[160:175], v[208:211], a[60:63], v[160:175]
 ds_read_b64_tr_b16 v[204:205], v249 offset:32960
 ds_read_b64_tr_b16 v[206:207], v249 offset:34496
 s_waitcnt lgkmcnt(8)
 v_mfma_f32_32x32x16_bf16 v[176:191], v[212:215], a[60:63], v[176:191]
 s_waitcnt vmcnt(18)
 s_barrier
 ds_read_b64_tr_b16 v[208:209], v248 offset:33024
 ds_read_b64_tr_b16 v[210:211], v248 offset:34560
 s_waitcnt lgkmcnt(8)
 v_mfma_f32_32x32x16_bf16 v[96:111], v[192:195], a[64:67], v[96:111]
 ds_read_b64_tr_b16 v[212:213], v249 offset:33088
 ds_read_b64_tr_b16 v[214:215], v249 offset:34624
 s_waitcnt lgkmcnt(8)
 v_mfma_f32_32x32x16_bf16 v[112:127], v[196:199], a[64:67], v[112:127]
 s_add_u32 m0, s19, 73728
 s_add_u32 s29, s52, 6291456
 buffer_load_dwordx4 v236, s[24:27], s29 offen lds
 s_add_u32 m0, s19, 74752
 s_add_u32 s29, s52, 6291456
 buffer_load_dwordx4 v237, s[24:27], s29 offen lds
 s_add_u32 m0, s19, 75776
 s_add_u32 s29, s52, 6291456
 buffer_load_dwordx4 v238, s[24:27], s29 offen lds
 s_add_u32 m0, s19, 76800
 s_add_u32 s29, s52, 6389760
 buffer_load_dwordx4 v236, s[24:27], s29 offen lds
 s_add_u32 m0, s19, 77824
 s_add_u32 s29, s52, 6389760
 buffer_load_dwordx4 v237, s[24:27], s29 offen lds
 s_add_u32 m0, s19, 78848
 s_add_u32 s29, s52, 6389760
 buffer_load_dwordx4 v238, s[24:27], s29 offen lds
 ds_read_b64_tr_b16 v[192:193], v248 offset:38912
 ds_read_b64_tr_b16 v[194:195], v248 offset:40448
 s_waitcnt lgkmcnt(8)
 v_mfma_f32_32x32x16_bf16 v[128:143], v[200:203], a[64:67], v[128:143]
 ds_read_b64_tr_b16 v[196:197], v249 offset:38976
 ds_read_b64_tr_b16 v[198:199], v249 offset:40512
 s_waitcnt lgkmcnt(8)
 v_mfma_f32_32x32x16_bf16 v[144:159], v[204:207], a[64:67], v[144:159]
 ds_read_b64_tr_b16 v[200:201], v248 offset:39040
 ds_read_b64_tr_b16 v[202:203], v248 offset:40576
 s_waitcnt lgkmcnt(8)
 v_mfma_f32_32x32x16_bf16 v[160:175], v[208:211], a[64:67], v[160:175]
 v_cvt_pk_bf16_f32 v216, v64, v65
 v_cvt_pk_bf16_f32 v217, v66, v67
 v_cvt_pk_bf16_f32 v218, v68, v69
 ds_read_b64_tr_b16 v[204:205], v249 offset:39104
 ds_read_b64_tr_b16 v[206:207], v249 offset:40640
 s_waitcnt lgkmcnt(8)
 v_mfma_f32_32x32x16_bf16 v[176:191], v[212:215], a[64:67], v[176:191]
 ds_read_b64_tr_b16 v[208:209], v248 offset:39168
 ds_read_b64_tr_b16 v[210:211], v248 offset:40704
 s_waitcnt lgkmcnt(8)
 v_mfma_f32_32x32x16_bf16 v[96:111], v[192:195], a[68:71], v[96:111]
 ds_read_b64_tr_b16 v[212:213], v249 offset:39232
 ds_read_b64_tr_b16 v[214:215], v249 offset:40768
 s_waitcnt lgkmcnt(8)
 v_mfma_f32_32x32x16_bf16 v[112:127], v[196:199], a[68:71], v[112:127]
 ds_read_b64_tr_b16 v[192:193], v248 offset:45056
 ds_read_b64_tr_b16 v[194:195], v248 offset:46592
 s_waitcnt lgkmcnt(8)
 v_mfma_f32_32x32x16_bf16 v[128:143], v[200:203], a[68:71], v[128:143]
 v_cvt_pk_bf16_f32 v219, v70, v71
 v_cvt_pk_bf16_f32 v220, v72, v73
 v_cvt_pk_bf16_f32 v221, v74, v75
 ds_read_b64_tr_b16 v[196:197], v249 offset:45120
 ds_read_b64_tr_b16 v[198:199], v249 offset:46656
 s_waitcnt lgkmcnt(8)
 v_mfma_f32_32x32x16_bf16 v[144:159], v[204:207], a[68:71], v[144:159]
 ds_read_b64_tr_b16 v[200:201], v248 offset:45184
 ds_read_b64_tr_b16 v[202:203], v248 offset:46720
 s_waitcnt lgkmcnt(8)
 v_mfma_f32_32x32x16_bf16 v[160:175], v[208:211], a[68:71], v[160:175]
 ds_read_b64_tr_b16 v[204:205], v249 offset:45248
 ds_read_b64_tr_b16 v[206:207], v249 offset:46784
 s_waitcnt lgkmcnt(8)
 v_mfma_f32_32x32x16_bf16 v[176:191], v[212:215], a[68:71], v[176:191]
 ds_read_b64_tr_b16 v[208:209], v248 offset:45312
 ds_read_b64_tr_b16 v[210:211], v248 offset:46848
 s_waitcnt lgkmcnt(8)
 v_mfma_f32_32x32x16_bf16 v[96:111], v[192:195], a[72:75], v[96:111]
 v_cvt_pk_bf16_f32 v222, v76, v77
 v_cvt_pk_bf16_f32 v223, v78, v79
 buffer_store_dwordx4 v[216:219], v244, s[8:11], s53 offen offset:0 sc1
 ds_read_b64_tr_b16 v[212:213], v249 offset:45376
 ds_read_b64_tr_b16 v[214:215], v249 offset:46912
 s_waitcnt lgkmcnt(8)
 v_mfma_f32_32x32x16_bf16 v[112:127], v[196:199], a[72:75], v[112:127]
 ds_read_b64_tr_b16 v[192:193], v248 offset:51200
 ds_read_b64_tr_b16 v[194:195], v248 offset:52736
 s_waitcnt lgkmcnt(8)
 v_mfma_f32_32x32x16_bf16 v[128:143], v[200:203], a[72:75], v[128:143]
 ds_read_b64_tr_b16 v[196:197], v249 offset:51264
 ds_read_b64_tr_b16 v[198:199], v249 offset:52800
 s_waitcnt lgkmcnt(8)
 v_mfma_f32_32x32x16_bf16 v[144:159], v[204:207], a[72:75], v[144:159]
 ds_read_b64_tr_b16 v[200:201], v248 offset:51328
 ds_read_b64_tr_b16 v[202:203], v248 offset:52864
 s_waitcnt lgkmcnt(8)
 v_mfma_f32_32x32x16_bf16 v[160:175], v[208:211], a[72:75], v[160:175]
 buffer_store_dwordx4 v[220:223], v244, s[8:11], s53 offen offset:512 sc1
 s_add_u32 s53, s53, 1024
 ds_read_b64_tr_b16 v[204:205], v249 offset:51392
 ds_read_b64_tr_b16 v[206:207], v249 offset:52928
 s_waitcnt lgkmcnt(8)
 v_mfma_f32_32x32x16_bf16 v[176:191], v[212:215], a[72:75], v[176:191]
 ds_read_b64_tr_b16 v[208:209], v248 offset:51456
 ds_read_b64_tr_b16 v[210:211], v248 offset:52992
 s_waitcnt lgkmcnt(8)
 v_mfma_f32_32x32x16_bf16 v[96:111], v[192:195], a[76:79], v[96:111]
 ds_read_b64_tr_b16 v[212:213], v249 offset:51520
 ds_read_b64_tr_b16 v[214:215], v249 offset:53056
 s_waitcnt lgkmcnt(8)
 v_mfma_f32_32x32x16_bf16 v[112:127], v[196:199], a[76:79], v[112:127]
 ds_read_b64_tr_b16 v[192:193], v240 offset:0
 ds_read_b64_tr_b16 v[194:195], v240 offset:1536
 s_waitcnt lgkmcnt(8)
 v_mfma_f32_32x32x16_bf16 v[128:143], v[200:203], a[76:79], v[128:143]
 ds_read_b64_tr_b16 v[196:197], v241 offset:64
 ds_read_b64_tr_b16 v[198:199], v241 offset:1600
 s_waitcnt lgkmcnt(8)
 v_mfma_f32_32x32x16_bf16 v[144:159], v[204:207], a[76:79], v[144:159]
 ds_read_b64_tr_b16 v[200:201], v240 offset:128
 ds_read_b64_tr_b16 v[202:203], v240 offset:1664
 s_waitcnt lgkmcnt(8)
 v_mfma_f32_32x32x16_bf16 v[160:175], v[208:211], a[76:79], v[160:175]
 ds_read_b64_tr_b16 v[204:205], v241 offset:192
 ds_read_b64_tr_b16 v[206:207], v241 offset:1728
 s_waitcnt lgkmcnt(8)
 v_mfma_f32_32x32x16_bf16 v[176:191], v[212:215], a[76:79], v[176:191]
 s_waitcnt vmcnt(18)
 s_barrier
 ds_read_b64_tr_b16 v[208:209], v240 offset:256
 ds_read_b64_tr_b16 v[210:211], v240 offset:1792
 s_waitcnt lgkmcnt(8)
 v_mfma_f32_32x32x16_bf16 v[96:111], v[192:195], a[80:83], v[96:111]
 ds_read_b64_tr_b16 v[212:213], v241 offset:320
 ds_read_b64_tr_b16 v[214:215], v241 offset:1856
 s_waitcnt lgkmcnt(8)
 v_mfma_f32_32x32x16_bf16 v[112:127], v[196:199], a[80:83], v[112:127]
 s_add_u32 m0, s19, 98304
 s_add_u32 s29, s52, 7077888
 buffer_load_dwordx4 v236, s[24:27], s29 offen lds
 s_add_u32 m0, s19, 99328
 s_add_u32 s29, s52, 7077888
 buffer_load_dwordx4 v237, s[24:27], s29 offen lds
 s_add_u32 m0, s19, 100352
 s_add_u32 s29, s52, 7077888
 buffer_load_dwordx4 v238, s[24:27], s29 offen lds
 s_add_u32 m0, s19, 101376
 s_add_u32 s29, s52, 7176192
 buffer_load_dwordx4 v236, s[24:27], s29 offen lds
 s_add_u32 m0, s19, 102400
 s_add_u32 s29, s52, 7176192
 buffer_load_dwordx4 v237, s[24:27], s29 offen lds
 s_add_u32 m0, s19, 103424
 s_add_u32 s29, s52, 7176192
 buffer_load_dwordx4 v238, s[24:27], s29 offen lds
 ds_read_b64_tr_b16 v[192:193], v240 offset:6144
 ds_read_b64_tr_b16 v[194:195], v240 offset:7680
 s_waitcnt lgkmcnt(8)
 v_mfma_f32_32x32x16_bf16 v[128:143], v[200:203], a[80:83], v[128:143]
 ds_read_b64_tr_b16 v[196:197], v241 offset:6208
 ds_read_b64_tr_b16 v[198:199], v241 offset:7744
 s_waitcnt lgkmcnt(8)
 v_mfma_f32_32x32x16_bf16 v[144:159], v[204:207], a[80:83], v[144:159]
 ds_read_b64_tr_b16 v[200:201], v240 offset:6272
 ds_read_b64_tr_b16 v[202:203], v240 offset:7808
 s_waitcnt lgkmcnt(8)
 v_mfma_f32_32x32x16_bf16 v[160:175], v[208:211], a[80:83], v[160:175]
 v_cvt_pk_bf16_f32 v224, v80, v81
 v_cvt_pk_bf16_f32 v225, v82, v83
 v_cvt_pk_bf16_f32 v226, v84, v85
 ds_read_b64_tr_b16 v[204:205], v241 offset:6336
 ds_read_b64_tr_b16 v[206:207], v241 offset:7872
 s_waitcnt lgkmcnt(8)
 v_mfma_f32_32x32x16_bf16 v[176:191], v[212:215], a[80:83], v[176:191]
 ds_read_b64_tr_b16 v[208:209], v240 offset:6400
 ds_read_b64_tr_b16 v[210:211], v240 offset:7936
 s_waitcnt lgkmcnt(8)
 v_mfma_f32_32x32x16_bf16 v[96:111], v[192:195], a[84:87], v[96:111]
 ds_read_b64_tr_b16 v[212:213], v241 offset:6464
 ds_read_b64_tr_b16 v[214:215], v241 offset:8000
 s_waitcnt lgkmcnt(8)
 v_mfma_f32_32x32x16_bf16 v[112:127], v[196:199], a[84:87], v[112:127]
 ds_read_b64_tr_b16 v[192:193], v240 offset:12288
 ds_read_b64_tr_b16 v[194:195], v240 offset:13824
 s_waitcnt lgkmcnt(8)
 v_mfma_f32_32x32x16_bf16 v[128:143], v[200:203], a[84:87], v[128:143]
 v_cvt_pk_bf16_f32 v227, v86, v87
 v_cvt_pk_bf16_f32 v228, v88, v89
 v_cvt_pk_bf16_f32 v229, v90, v91
 ds_read_b64_tr_b16 v[196:197], v241 offset:12352
 ds_read_b64_tr_b16 v[198:199], v241 offset:13888
 s_waitcnt lgkmcnt(8)
 v_mfma_f32_32x32x16_bf16 v[144:159], v[204:207], a[84:87], v[144:159]
 ds_read_b64_tr_b16 v[200:201], v240 offset:12416
 ds_read_b64_tr_b16 v[202:203], v240 offset:13952
 s_waitcnt lgkmcnt(8)
 v_mfma_f32_32x32x16_bf16 v[160:175], v[208:211], a[84:87], v[160:175]
 ds_read_b64_tr_b16 v[204:205], v241 offset:12480
 ds_read_b64_tr_b16 v[206:207], v241 offset:14016
 s_waitcnt lgkmcnt(8)
 v_mfma_f32_32x32x16_bf16 v[176:191], v[212:215], a[84:87], v[176:191]
 ds_read_b64_tr_b16 v[208:209], v240 offset:12544
 ds_read_b64_tr_b16 v[210:211], v240 offset:14080
 s_waitcnt lgkmcnt(8)
 v_mfma_f32_32x32x16_bf16 v[96:111], v[192:195], a[88:91], v[96:111]
 v_cvt_pk_bf16_f32 v230, v92, v93
 v_cvt_pk_bf16_f32 v231, v94, v95
 buffer_store_dwordx4 v[224:227], v244, s[8:11], s53 offen offset:0 sc1
 ds_read_b64_tr_b16 v[212:213], v241 offset:12608
 ds_read_b64_tr_b16 v[214:215], v241 offset:14144
 s_waitcnt lgkmcnt(8)
 v_mfma_f32_32x32x16_bf16 v[112:127], v[196:199], a[88:91], v[112:127]
 ds_read_b64_tr_b16 v[192:193], v240 offset:18432
 ds_read_b64_tr_b16 v[194:195], v240 offset:19968
 s_waitcnt lgkmcnt(8)
 v_mfma_f32_32x32x16_bf16 v[128:143], v[200:203], a[88:91], v[128:143]
 ds_read_b64_tr_b16 v[196:197], v241 offset:18496
 ds_read_b64_tr_b16 v[198:199], v241 offset:20032
 s_waitcnt lgkmcnt(8)
 v_mfma_f32_32x32x16_bf16 v[144:159], v[204:207], a[88:91], v[144:159]
 ds_read_b64_tr_b16 v[200:201], v240 offset:18560
 ds_read_b64_tr_b16 v[202:203], v240 offset:20096
 s_waitcnt lgkmcnt(8)
 v_mfma_f32_32x32x16_bf16 v[160:175], v[208:211], a[88:91], v[160:175]
 buffer_store_dwordx4 v[228:231], v244, s[8:11], s53 offen offset:512 sc1
 s_add_u32 s53, s53, 1024
 ds_read_b64_tr_b16 v[204:205], v241 offset:18624
 ds_read_b64_tr_b16 v[206:207], v241 offset:20160
 s_waitcnt lgkmcnt(8)
 v_mfma_f32_32x32x16_bf16 v[176:191], v[212:215], a[88:91], v[176:191]
 ds_read_b64_tr_b16 v[208:209], v240 offset:18688
 ds_read_b64_tr_b16 v[210:211], v240 offset:20224
 s_waitcnt lgkmcnt(8)
 v_mfma_f32_32x32x16_bf16 v[96:111], v[192:195], a[92:95], v[96:111]
 ds_read_b64_tr_b16 v[212:213], v241 offset:18752
 ds_read_b64_tr_b16 v[214:215], v241 offset:20288
 s_waitcnt lgkmcnt(8)
 v_mfma_f32_32x32x16_bf16 v[112:127], v[196:199], a[92:95], v[112:127]
 ds_read_b64_tr_b16 v[192:193], v240 offset:24576
 ds_read_b64_tr_b16 v[194:195], v240 offset:26112
 s_waitcnt lgkmcnt(8)
 v_mfma_f32_32x32x16_bf16 v[128:143], v[200:203], a[92:95], v[128:143]
 ds_read_b64_tr_b16 v[196:197], v241 offset:24640
 ds_read_b64_tr_b16 v[198:199], v241 offset:26176
 s_waitcnt lgkmcnt(8)
 v_mfma_f32_32x32x16_bf16 v[144:159], v[204:207], a[92:95], v[144:159]
 ds_read_b64_tr_b16 v[200:201], v240 offset:24704
 ds_read_b64_tr_b16 v[202:203], v240 offset:26240
 s_waitcnt lgkmcnt(8)
 v_mfma_f32_32x32x16_bf16 v[160:175], v[208:211], a[92:95], v[160:175]
 ds_read_b64_tr_b16 v[204:205], v241 offset:24768
 ds_read_b64_tr_b16 v[206:207], v241 offset:26304
 s_waitcnt lgkmcnt(8)
 v_mfma_f32_32x32x16_bf16 v[176:191], v[212:215], a[92:95], v[176:191]
 s_waitcnt vmcnt(18)
 s_barrier
 ds_read_b64_tr_b16 v[208:209], v240 offset:24832
 ds_read_b64_tr_b16 v[210:211], v240 offset:26368
 s_waitcnt lgkmcnt(8)
 v_mfma_f32_32x32x16_bf16 v[96:111], v[192:195], a[96:99], v[96:111]
 ds_read_b64_tr_b16 v[212:213], v241 offset:24896
 ds_read_b64_tr_b16 v[214:215], v241 offset:26432
 s_waitcnt lgkmcnt(8)
 v_mfma_f32_32x32x16_bf16 v[112:127], v[196:199], a[96:99], v[112:127]
 ds_read_b64_tr_b16 v[192:193], v240 offset:30720
 ds_read_b64_tr_b16 v[194:195], v240 offset:32256
 s_waitcnt lgkmcnt(8)
 v_mfma_f32_32x32x16_bf16 v[128:143], v[200:203], a[96:99], v[128:143]
 ds_read_b64_tr_b16 v[196:197], v241 offset:30784
 ds_read_b64_tr_b16 v[198:199], v241 offset:32320
 s_waitcnt lgkmcnt(8)
 v_mfma_f32_32x32x16_bf16 v[144:159], v[204:207], a[96:99], v[144:159]
 ds_read_b64_tr_b16 v[200:201], v240 offset:30848
 ds_read_b64_tr_b16 v[202:203], v240 offset:32384
 s_waitcnt lgkmcnt(8)
 v_mfma_f32_32x32x16_bf16 v[160:175], v[208:211], a[96:99], v[160:175]
 ds_read_b64_tr_b16 v[204:205], v241 offset:30912
 ds_read_b64_tr_b16 v[206:207], v241 offset:32448
 s_waitcnt lgkmcnt(8)
 v_mfma_f32_32x32x16_bf16 v[176:191], v[212:215], a[96:99], v[176:191]
 ds_read_b64_tr_b16 v[208:209], v240 offset:30976
 ds_read_b64_tr_b16 v[210:211], v240 offset:32512
 s_waitcnt lgkmcnt(8)
 v_mfma_f32_32x32x16_bf16 v[96:111], v[192:195], a[100:103], v[96:111]
 ds_read_b64_tr_b16 v[212:213], v241 offset:31040
 ds_read_b64_tr_b16 v[214:215], v241 offset:32576
 s_waitcnt lgkmcnt(8)
 v_mfma_f32_32x32x16_bf16 v[112:127], v[196:199], a[100:103], v[112:127]
 ds_read_b64_tr_b16 v[192:193], v240 offset:36864
 ds_read_b64_tr_b16 v[194:195], v240 offset:38400
 s_waitcnt lgkmcnt(8)
 v_mfma_f32_32x32x16_bf16 v[128:143], v[200:203], a[100:103], v[128:143]
 ds_read_b64_tr_b16 v[196:197], v241 offset:36928
 ds_read_b64_tr_b16 v[198:199], v241 offset:38464
 s_waitcnt lgkmcnt(8)
 v_mfma_f32_32x32x16_bf16 v[144:159], v[204:207], a[100:103], v[144:159]
 ds_read_b64_tr_b16 v[200:201], v240 offset:36992
 ds_read_b64_tr_b16 v[202:203], v240 offset:38528
 s_waitcnt lgkmcnt(8)
 v_mfma_f32_32x32x16_bf16 v[160:175], v[208:211], a[100:103], v[160:175]
 ds_read_b64_tr_b16 v[204:205], v241 offset:37056
 ds_read_b64_tr_b16 v[206:207], v241 offset:38592
 s_waitcnt lgkmcnt(8)
 v_mfma_f32_32x32x16_bf16 v[176:191], v[212:215], a[100:103], v[176:191]
 ds_read_b64_tr_b16 v[208:209], v240 offset:37120
 ds_read_b64_tr_b16 v[210:211], v240 offset:38656
 s_waitcnt lgkmcnt(8)
 v_mfma_f32_32x32x16_bf16 v[96:111], v[192:195], a[104:107], v[96:111]
 ds_read_b64_tr_b16 v[212:213], v241 offset:37184
 ds_read_b64_tr_b16 v[214:215], v241 offset:38720
 s_waitcnt lgkmcnt(8)
 v_mfma_f32_32x32x16_bf16 v[112:127], v[196:199], a[104:107], v[112:127]
 ds_read_b64_tr_b16 v[192:193], v240 offset:43008
 ds_read_b64_tr_b16 v[194:195], v240 offset:44544
 s_waitcnt lgkmcnt(8)
 v_mfma_f32_32x32x16_bf16 v[128:143], v[200:203], a[104:107], v[128:143]
 ds_read_b64_tr_b16 v[196:197], v241 offset:43072
 ds_read_b64_tr_b16 v[198:199], v241 offset:44608
 s_waitcnt lgkmcnt(8)
 v_mfma_f32_32x32x16_bf16 v[144:159], v[204:207], a[104:107], v[144:159]
 ds_read_b64_tr_b16 v[200:201], v240 offset:43136
 ds_read_b64_tr_b16 v[202:203], v240 offset:44672
 s_waitcnt lgkmcnt(8)
 v_mfma_f32_32x32x16_bf16 v[160:175], v[208:211], a[104:107], v[160:175]
 ds_read_b64_tr_b16 v[204:205], v241 offset:43200
 ds_read_b64_tr_b16 v[206:207], v241 offset:44736
 s_waitcnt lgkmcnt(8)
 v_mfma_f32_32x32x16_bf16 v[176:191], v[212:215], a[104:107], v[176:191]
 ds_read_b64_tr_b16 v[208:209], v240 offset:43264
 ds_read_b64_tr_b16 v[210:211], v240 offset:44800
 s_waitcnt lgkmcnt(8)
 v_mfma_f32_32x32x16_bf16 v[96:111], v[192:195], a[108:111], v[96:111]
 ds_read_b64_tr_b16 v[212:213], v241 offset:43328
 ds_read_b64_tr_b16 v[214:215], v241 offset:44864
 s_waitcnt lgkmcnt(8)
 v_mfma_f32_32x32x16_bf16 v[112:127], v[196:199], a[108:111], v[112:127]
 ds_read_b64_tr_b16 v[192:193], v240 offset:49152
 ds_read_b64_tr_b16 v[194:195], v240 offset:50688
 s_waitcnt lgkmcnt(8)
 v_mfma_f32_32x32x16_bf16 v[128:143], v[200:203], a[108:111], v[128:143]
 ds_read_b64_tr_b16 v[196:197], v241 offset:49216
 ds_read_b64_tr_b16 v[198:199], v241 offset:50752
 s_waitcnt lgkmcnt(8)
 v_mfma_f32_32x32x16_bf16 v[144:159], v[204:207], a[108:111], v[144:159]
 ds_read_b64_tr_b16 v[200:201], v240 offset:49280
 ds_read_b64_tr_b16 v[202:203], v240 offset:50816
 s_waitcnt lgkmcnt(8)
 v_mfma_f32_32x32x16_bf16 v[160:175], v[208:211], a[108:111], v[160:175]
 ds_read_b64_tr_b16 v[204:205], v241 offset:49344
 ds_read_b64_tr_b16 v[206:207], v241 offset:50880
 s_waitcnt lgkmcnt(8)
 v_mfma_f32_32x32x16_bf16 v[176:191], v[212:215], a[108:111], v[176:191]
 s_waitcnt vmcnt(10)
 s_barrier
 ds_read_b64_tr_b16 v[208:209], v240 offset:49408
 ds_read_b64_tr_b16 v[210:211], v240 offset:50944
 s_waitcnt lgkmcnt(8)
 v_mfma_f32_32x32x16_bf16 v[96:111], v[192:195], a[112:115], v[96:111]
 ds_read_b64_tr_b16 v[212:213], v241 offset:49472
 ds_read_b64_tr_b16 v[214:215], v241 offset:51008
 s_waitcnt lgkmcnt(8)
 v_mfma_f32_32x32x16_bf16 v[112:127], v[196:199], a[112:115], v[112:127]
 ds_read_b64_tr_b16 v[192:193], v240 offset:55296
 ds_read_b64_tr_b16 v[194:195], v240 offset:56832
 s_waitcnt lgkmcnt(8)
 v_mfma_f32_32x32x16_bf16 v[128:143], v[200:203], a[112:115], v[128:143]
 ds_read_b64_tr_b16 v[196:197], v241 offset:55360
 ds_read_b64_tr_b16 v[198:199], v241 offset:56896
 s_waitcnt lgkmcnt(8)
 v_mfma_f32_32x32x16_bf16 v[144:159], v[204:207], a[112:115], v[144:159]
 ds_read_b64_tr_b16 v[200:201], v240 offset:55424
 ds_read_b64_tr_b16 v[202:203], v240 offset:56960
 s_waitcnt lgkmcnt(8)
 v_mfma_f32_32x32x16_bf16 v[160:175], v[208:211], a[112:115], v[160:175]
 ds_read_b64_tr_b16 v[204:205], v241 offset:55488
 ds_read_b64_tr_b16 v[206:207], v241 offset:57024
 s_waitcnt lgkmcnt(8)
 v_mfma_f32_32x32x16_bf16 v[176:191], v[212:215], a[112:115], v[176:191]
 ds_read_b64_tr_b16 v[208:209], v240 offset:55552
 ds_read_b64_tr_b16 v[210:211], v240 offset:57088
 s_waitcnt lgkmcnt(8)
 v_mfma_f32_32x32x16_bf16 v[96:111], v[192:195], a[116:119], v[96:111]
 ds_read_b64_tr_b16 v[212:213], v241 offset:55616
 ds_read_b64_tr_b16 v[214:215], v241 offset:57152
 s_waitcnt lgkmcnt(8)
 v_mfma_f32_32x32x16_bf16 v[112:127], v[196:199], a[116:119], v[112:127]
 ds_read_b64_tr_b16 v[192:193], v240 offset:61440
 ds_read_b64_tr_b16 v[194:195], v240 offset:62976
 s_waitcnt lgkmcnt(8)
 v_mfma_f32_32x32x16_bf16 v[128:143], v[200:203], a[116:119], v[128:143]
 ds_read_b64_tr_b16 v[196:197], v241 offset:61504
 ds_read_b64_tr_b16 v[198:199], v241 offset:63040
 s_waitcnt lgkmcnt(8)
 v_mfma_f32_32x32x16_bf16 v[144:159], v[204:207], a[116:119], v[144:159]
 ds_read_b64_tr_b16 v[200:201], v240 offset:61568
 ds_read_b64_tr_b16 v[202:203], v240 offset:63104
 s_waitcnt lgkmcnt(8)
 v_mfma_f32_32x32x16_bf16 v[160:175], v[208:211], a[116:119], v[160:175]
 ds_read_b64_tr_b16 v[204:205], v241 offset:61632
 ds_read_b64_tr_b16 v[206:207], v241 offset:63168
 s_waitcnt lgkmcnt(8)
 v_mfma_f32_32x32x16_bf16 v[176:191], v[212:215], a[116:119], v[176:191]
 ds_read_b64_tr_b16 v[208:209], v240 offset:61696
 ds_read_b64_tr_b16 v[210:211], v240 offset:63232
 s_waitcnt lgkmcnt(8)
 v_mfma_f32_32x32x16_bf16 v[96:111], v[192:195], a[120:123], v[96:111]
 ds_read_b64_tr_b16 v[212:213], v241 offset:61760
 ds_read_b64_tr_b16 v[214:215], v241 offset:63296
 s_waitcnt lgkmcnt(8)
 v_mfma_f32_32x32x16_bf16 v[112:127], v[196:199], a[120:123], v[112:127]
 ds_read_b64_tr_b16 v[192:193], v248 offset:2048
 ds_read_b64_tr_b16 v[194:195], v248 offset:3584
 s_waitcnt lgkmcnt(8)
 v_mfma_f32_32x32x16_bf16 v[128:143], v[200:203], a[120:123], v[128:143]
 ds_read_b64_tr_b16 v[196:197], v249 offset:2112
 ds_read_b64_tr_b16 v[198:199], v249 offset:3648
 s_waitcnt lgkmcnt(8)
 v_mfma_f32_32x32x16_bf16 v[144:159], v[204:207], a[120:123], v[144:159]
 ds_read_b64_tr_b16 v[200:201], v248 offset:2176
 ds_read_b64_tr_b16 v[202:203], v248 offset:3712
 s_waitcnt lgkmcnt(8)
 v_mfma_f32_32x32x16_bf16 v[160:175], v[208:211], a[120:123], v[160:175]
 ds_read_b64_tr_b16 v[204:205], v249 offset:2240
 ds_read_b64_tr_b16 v[206:207], v249 offset:3776
 s_waitcnt lgkmcnt(8)
 v_mfma_f32_32x32x16_bf16 v[176:191], v[212:215], a[120:123], v[176:191]
 ds_read_b64_tr_b16 v[208:209], v248 offset:2304
 ds_read_b64_tr_b16 v[210:211], v248 offset:3840
 s_waitcnt lgkmcnt(8)
 v_mfma_f32_32x32x16_bf16 v[96:111], v[192:195], a[124:127], v[96:111]
 ds_read_b64_tr_b16 v[212:213], v249 offset:2368
 ds_read_b64_tr_b16 v[214:215], v249 offset:3904
 s_waitcnt lgkmcnt(8)
 v_mfma_f32_32x32x16_bf16 v[112:127], v[196:199], a[124:127], v[112:127]
 ds_read_b64_tr_b16 v[192:193], v248 offset:8192
 ds_read_b64_tr_b16 v[194:195], v248 offset:9728
 s_waitcnt lgkmcnt(8)
 v_mfma_f32_32x32x16_bf16 v[128:143], v[200:203], a[124:127], v[128:143]
 ds_read_b64_tr_b16 v[196:197], v249 offset:8256
 ds_read_b64_tr_b16 v[198:199], v249 offset:9792
 s_waitcnt lgkmcnt(8)
 v_mfma_f32_32x32x16_bf16 v[144:159], v[204:207], a[124:127], v[144:159]
 ds_read_b64_tr_b16 v[200:201], v248 offset:8320
 ds_read_b64_tr_b16 v[202:203], v248 offset:9856
 s_waitcnt lgkmcnt(8)
 v_mfma_f32_32x32x16_bf16 v[160:175], v[208:211], a[124:127], v[160:175]
 ds_read_b64_tr_b16 v[204:205], v249 offset:8384
 ds_read_b64_tr_b16 v[206:207], v249 offset:9920
 s_waitcnt lgkmcnt(8)
 v_mfma_f32_32x32x16_bf16 v[176:191], v[212:215], a[124:127], v[176:191]
 s_waitcnt vmcnt(2)
 s_barrier
 ds_read_b64_tr_b16 v[208:209], v248 offset:8448
 ds_read_b64_tr_b16 v[210:211], v248 offset:9984
 s_waitcnt lgkmcnt(8)
 v_mfma_f32_32x32x16_bf16 v[96:111], v[192:195], a[128:131], v[96:111]
 ds_read_b64_tr_b16 v[212:213], v249 offset:8512
 ds_read_b64_tr_b16 v[214:215], v249 offset:10048
 s_waitcnt lgkmcnt(8)
 v_mfma_f32_32x32x16_bf16 v[112:127], v[196:199], a[128:131], v[112:127]
 ds_read_b64_tr_b16 v[192:193], v248 offset:14336
 ds_read_b64_tr_b16 v[194:195], v248 offset:15872
 s_waitcnt lgkmcnt(8)
 v_mfma_f32_32x32x16_bf16 v[128:143], v[200:203], a[128:131], v[128:143]
 ds_read_b64_tr_b16 v[196:197], v249 offset:14400
 ds_read_b64_tr_b16 v[198:199], v249 offset:15936
 s_waitcnt lgkmcnt(8)
 v_mfma_f32_32x32x16_bf16 v[144:159], v[204:207], a[128:131], v[144:159]
 ds_read_b64_tr_b16 v[200:201], v248 offset:14464
 ds_read_b64_tr_b16 v[202:203], v248 offset:16000
 s_waitcnt lgkmcnt(8)
 v_mfma_f32_32x32x16_bf16 v[160:175], v[208:211], a[128:131], v[160:175]
 ds_read_b64_tr_b16 v[204:205], v249 offset:14528
 ds_read_b64_tr_b16 v[206:207], v249 offset:16064
 s_waitcnt lgkmcnt(8)
 v_mfma_f32_32x32x16_bf16 v[176:191], v[212:215], a[128:131], v[176:191]
 ds_read_b64_tr_b16 v[208:209], v248 offset:14592
 ds_read_b64_tr_b16 v[210:211], v248 offset:16128
 s_waitcnt lgkmcnt(8)
 v_mfma_f32_32x32x16_bf16 v[96:111], v[192:195], a[132:135], v[96:111]
 ds_read_b64_tr_b16 v[212:213], v249 offset:14656
 ds_read_b64_tr_b16 v[214:215], v249 offset:16192
 s_waitcnt lgkmcnt(8)
 v_mfma_f32_32x32x16_bf16 v[112:127], v[196:199], a[132:135], v[112:127]
 ds_read_b64_tr_b16 v[192:193], v248 offset:20480
 ds_read_b64_tr_b16 v[194:195], v248 offset:22016
 s_waitcnt lgkmcnt(8)
 v_mfma_f32_32x32x16_bf16 v[128:143], v[200:203], a[132:135], v[128:143]
 ds_read_b64_tr_b16 v[196:197], v249 offset:20544
 ds_read_b64_tr_b16 v[198:199], v249 offset:22080
 s_waitcnt lgkmcnt(8)
 v_mfma_f32_32x32x16_bf16 v[144:159], v[204:207], a[132:135], v[144:159]
 ds_read_b64_tr_b16 v[200:201], v248 offset:20608
 ds_read_b64_tr_b16 v[202:203], v248 offset:22144
 s_waitcnt lgkmcnt(8)
 v_mfma_f32_32x32x16_bf16 v[160:175], v[208:211], a[132:135], v[160:175]
 ds_read_b64_tr_b16 v[204:205], v249 offset:20672
 ds_read_b64_tr_b16 v[206:207], v249 offset:22208
 s_waitcnt lgkmcnt(8)
 v_mfma_f32_32x32x16_bf16 v[176:191], v[212:215], a[132:135], v[176:191]
 ds_read_b64_tr_b16 v[208:209], v248 offset:20736
 ds_read_b64_tr_b16 v[210:211], v248 offset:22272
 s_waitcnt lgkmcnt(8)
 v_mfma_f32_32x32x16_bf16 v[96:111], v[192:195], a[136:139], v[96:111]
 ds_read_b64_tr_b16 v[212:213], v249 offset:20800
 ds_read_b64_tr_b16 v[214:215], v249 offset:22336
 s_waitcnt lgkmcnt(8)
 v_mfma_f32_32x32x16_bf16 v[112:127], v[196:199], a[136:139], v[112:127]
 ds_read_b64_tr_b16 v[192:193], v248 offset:26624
 ds_read_b64_tr_b16 v[194:195], v248 offset:28160
 s_waitcnt lgkmcnt(8)
 v_mfma_f32_32x32x16_bf16 v[128:143], v[200:203], a[136:139], v[128:143]
 ds_read_b64_tr_b16 v[196:197], v249 offset:26688
 ds_read_b64_tr_b16 v[198:199], v249 offset:28224
 s_waitcnt lgkmcnt(8)
 v_mfma_f32_32x32x16_bf16 v[144:159], v[204:207], a[136:139], v[144:159]
 ds_read_b64_tr_b16 v[200:201], v248 offset:26752
 ds_read_b64_tr_b16 v[202:203], v248 offset:28288
 s_waitcnt lgkmcnt(8)
 v_mfma_f32_32x32x16_bf16 v[160:175], v[208:211], a[136:139], v[160:175]
 ds_read_b64_tr_b16 v[204:205], v249 offset:26816
 ds_read_b64_tr_b16 v[206:207], v249 offset:28352
 s_waitcnt lgkmcnt(8)
 v_mfma_f32_32x32x16_bf16 v[176:191], v[212:215], a[136:139], v[176:191]
 ds_read_b64_tr_b16 v[208:209], v248 offset:26880
 ds_read_b64_tr_b16 v[210:211], v248 offset:28416
 s_waitcnt lgkmcnt(8)
 v_mfma_f32_32x32x16_bf16 v[96:111], v[192:195], a[140:143], v[96:111]
 ds_read_b64_tr_b16 v[212:213], v249 offset:26944
 ds_read_b64_tr_b16 v[214:215], v249 offset:28480
 s_waitcnt lgkmcnt(8)
 v_mfma_f32_32x32x16_bf16 v[112:127], v[196:199], a[140:143], v[112:127]
 ds_read_b64_tr_b16 v[192:193], v248 offset:32768
 ds_read_b64_tr_b16 v[194:195], v248 offset:34304
 s_waitcnt lgkmcnt(8)
 v_mfma_f32_32x32x16_bf16 v[128:143], v[200:203], a[140:143], v[128:143]
 ds_read_b64_tr_b16 v[196:197], v249 offset:32832
 ds_read_b64_tr_b16 v[198:199], v249 offset:34368
 s_waitcnt lgkmcnt(8)
 v_mfma_f32_32x32x16_bf16 v[144:159], v[204:207], a[140:143], v[144:159]
 ds_read_b64_tr_b16 v[200:201], v248 offset:32896
 ds_read_b64_tr_b16 v[202:203], v248 offset:34432
 s_waitcnt lgkmcnt(8)
 v_mfma_f32_32x32x16_bf16 v[160:175], v[208:211], a[140:143], v[160:175]
 ds_read_b64_tr_b16 v[204:205], v249 offset:32960
 ds_read_b64_tr_b16 v[206:207], v249 offset:34496
 s_waitcnt lgkmcnt(8)
 v_mfma_f32_32x32x16_bf16 v[176:191], v[212:215], a[140:143], v[176:191]
 s_barrier
 ds_read_b64_tr_b16 v[208:209], v248 offset:33024
 ds_read_b64_tr_b16 v[210:211], v248 offset:34560
 s_waitcnt lgkmcnt(8)
 v_mfma_f32_32x32x16_bf16 v[96:111], v[192:195], a[144:147], v[96:111]
 ds_read_b64_tr_b16 v[212:213], v249 offset:33088
 ds_read_b64_tr_b16 v[214:215], v249 offset:34624
 s_waitcnt lgkmcnt(8)
 v_mfma_f32_32x32x16_bf16 v[112:127], v[196:199], a[144:147], v[112:127]
 ds_read_b64_tr_b16 v[192:193], v248 offset:38912
 ds_read_b64_tr_b16 v[194:195], v248 offset:40448
 s_waitcnt lgkmcnt(8)
 v_mfma_f32_32x32x16_bf16 v[128:143], v[200:203], a[144:147], v[128:143]
 ds_read_b64_tr_b16 v[196:197], v249 offset:38976
 ds_read_b64_tr_b16 v[198:199], v249 offset:40512
 s_waitcnt lgkmcnt(8)
 v_mfma_f32_32x32x16_bf16 v[144:159], v[204:207], a[144:147], v[144:159]
 ds_read_b64_tr_b16 v[200:201], v248 offset:39040
 ds_read_b64_tr_b16 v[202:203], v248 offset:40576
 s_waitcnt lgkmcnt(8)
 v_mfma_f32_32x32x16_bf16 v[160:175], v[208:211], a[144:147], v[160:175]
 ds_read_b64_tr_b16 v[204:205], v249 offset:39104
 ds_read_b64_tr_b16 v[206:207], v249 offset:40640
 s_waitcnt lgkmcnt(8)
 v_mfma_f32_32x32x16_bf16 v[176:191], v[212:215], a[144:147], v[176:191]
 ds_read_b64_tr_b16 v[208:209], v248 offset:39168
 ds_read_b64_tr_b16 v[210:211], v248 offset:40704
 s_waitcnt lgkmcnt(8)
 v_mfma_f32_32x32x16_bf16 v[96:111], v[192:195], a[148:151], v[96:111]
 ds_read_b64_tr_b16 v[212:213], v249 offset:39232
 ds_read_b64_tr_b16 v[214:215], v249 offset:40768
 s_waitcnt lgkmcnt(8)
 v_mfma_f32_32x32x16_bf16 v[112:127], v[196:199], a[148:151], v[112:127]
 ds_read_b64_tr_b16 v[192:193], v248 offset:45056
 ds_read_b64_tr_b16 v[194:195], v248 offset:46592
 s_waitcnt lgkmcnt(8)
 v_mfma_f32_32x32x16_bf16 v[128:143], v[200:203], a[148:151], v[128:143]
 ds_read_b64_tr_b16 v[196:197], v249 offset:45120
 ds_read_b64_tr_b16 v[198:199], v249 offset:46656
 s_waitcnt lgkmcnt(8)
 v_mfma_f32_32x32x16_bf16 v[144:159], v[204:207], a[148:151], v[144:159]
 ds_read_b64_tr_b16 v[200:201], v248 offset:45184
 ds_read_b64_tr_b16 v[202:203], v248 offset:46720
 s_waitcnt lgkmcnt(8)
 v_mfma_f32_32x32x16_bf16 v[160:175], v[208:211], a[148:151], v[160:175]
 ds_read_b64_tr_b16 v[204:205], v249 offset:45248
 ds_read_b64_tr_b16 v[206:207], v249 offset:46784
 s_waitcnt lgkmcnt(8)
 v_mfma_f32_32x32x16_bf16 v[176:191], v[212:215], a[148:151], v[176:191]
 ds_read_b64_tr_b16 v[208:209], v248 offset:45312
 ds_read_b64_tr_b16 v[210:211], v248 offset:46848
 s_waitcnt lgkmcnt(8)
 v_mfma_f32_32x32x16_bf16 v[96:111], v[192:195], a[152:155], v[96:111]
 ds_read_b64_tr_b16 v[212:213], v249 offset:45376
 ds_read_b64_tr_b16 v[214:215], v249 offset:46912
 s_waitcnt lgkmcnt(8)
 v_mfma_f32_32x32x16_bf16 v[112:127], v[196:199], a[152:155], v[112:127]
 ds_read_b64_tr_b16 v[192:193], v248 offset:51200
 ds_read_b64_tr_b16 v[194:195], v248 offset:52736
 s_waitcnt lgkmcnt(8)
 v_mfma_f32_32x32x16_bf16 v[128:143], v[200:203], a[152:155], v[128:143]
 ds_read_b64_tr_b16 v[196:197], v249 offset:51264
 ds_read_b64_tr_b16 v[198:199], v249 offset:52800
 s_waitcnt lgkmcnt(8)
 v_mfma_f32_32x32x16_bf16 v[144:159], v[204:207], a[152:155], v[144:159]
 ds_read_b64_tr_b16 v[200:201], v248 offset:51328
 ds_read_b64_tr_b16 v[202:203], v248 offset:52864
 s_waitcnt lgkmcnt(8)
 v_mfma_f32_32x32x16_bf16 v[160:175], v[208:211], a[152:155], v[160:175]
 ds_read_b64_tr_b16 v[204:205], v249 offset:51392
 ds_read_b64_tr_b16 v[206:207], v249 offset:52928
 s_waitcnt lgkmcnt(8)
 v_mfma_f32_32x32x16_bf16 v[176:191], v[212:215], a[152:155], v[176:191]
 ds_read_b64_tr_b16 v[208:209], v248 offset:51456
 ds_read_b64_tr_b16 v[210:211], v248 offset:52992
 s_waitcnt lgkmcnt(8)
 v_mfma_f32_32x32x16_bf16 v[96:111], v[192:195], a[156:159], v[96:111]
 ds_read_b64_tr_b16 v[212:213], v249 offset:51520
 ds_read_b64_tr_b16 v[214:215], v249 offset:53056
 s_waitcnt lgkmcnt(8)
 v_mfma_f32_32x32x16_bf16 v[112:127], v[196:199], a[156:159], v[112:127]
 s_waitcnt lgkmcnt(6)
 v_mfma_f32_32x32x16_bf16 v[128:143], v[200:203], a[156:159], v[128:143]
 s_waitcnt lgkmcnt(4)
 v_mfma_f32_32x32x16_bf16 v[144:159], v[204:207], a[156:159], v[144:159]
 s_waitcnt lgkmcnt(2)
 v_mfma_f32_32x32x16_bf16 v[160:175], v[208:211], a[156:159], v[160:175]
 s_waitcnt lgkmcnt(0)
 v_mfma_f32_32x32x16_bf16 v[176:191], v[212:215], a[156:159], v[176:191]
 s_nop 15
 s_nop 3
 v_cvt_pk_bf16_f32 v216, v96, v97
 v_cvt_pk_bf16_f32 v217, v98, v99
 v_cvt_pk_bf16_f32 v218, v100, v101
 v_cvt_pk_bf16_f32 v219, v102, v103
 v_cvt_pk_bf16_f32 v220, v104, v105
 v_cvt_pk_bf16_f32 v221, v106, v107
 v_cvt_pk_bf16_f32 v222, v108, v109
 v_cvt_pk_bf16_f32 v223, v110, v111
 buffer_store_dwordx4 v[216:219], v245, s[8:11], s54 offen offset:0 sc1
 buffer_store_dwordx4 v[220:223], v245, s[8:11], s54 offen offset:512 sc1
 s_add_u32 s54, s54, 1024
 v_cvt_pk_bf16_f32 v224, v112, v113
 v_cvt_pk_bf16_f32 v225, v114, v115
 v_cvt_pk_bf16_f32 v226, v116, v117
 v_cvt_pk_bf16_f32 v227, v118, v119
 v_cvt_pk_bf16_f32 v228, v120, v121
 v_cvt_pk_bf16_f32 v229, v122, v123
 v_cvt_pk_bf16_f32 v230, v124, v125
 v_cvt_pk_bf16_f32 v231, v126, v127
 buffer_store_dwordx4 v[224:227], v245, s[8:11], s54 offen offset:0 sc1
 buffer_store_dwordx4 v[228:231], v245, s[8:11], s54 offen offset:512 sc1
 s_add_u32 s54, s54, 1024
 v_cvt_pk_bf16_f32 v216, v128, v129
 v_cvt_pk_bf16_f32 v217, v130, v131
 v_cvt_pk_bf16_f32 v218, v132, v133
 v_cvt_pk_bf16_f32 v219, v134, v135
 v_cvt_pk_bf16_f32 v220, v136, v137
 v_cvt_pk_bf16_f32 v221, v138, v139
 v_cvt_pk_bf16_f32 v222, v140, v141
 v_cvt_pk_bf16_f32 v223, v142, v143
 buffer_store_dwordx4 v[216:219], v245, s[8:11], s54 offen offset:0 sc1
 buffer_store_dwordx4 v[220:223], v245, s[8:11], s54 offen offset:512 sc1
 s_add_u32 s54, s54, 1024
 v_cvt_pk_bf16_f32 v224, v144, v145
 v_cvt_pk_bf16_f32 v225, v146, v147
 v_cvt_pk_bf16_f32 v226, v148, v149
 v_cvt_pk_bf16_f32 v227, v150, v151
 v_cvt_pk_bf16_f32 v228, v152, v153
 v_cvt_pk_bf16_f32 v229, v154, v155
 v_cvt_pk_bf16_f32 v230, v156, v157
 v_cvt_pk_bf16_f32 v231, v158, v159
 buffer_store_dwordx4 v[224:227], v245, s[8:11], s54 offen offset:0 sc1
 buffer_store_dwordx4 v[228:231], v245, s[8:11], s54 offen offset:512 sc1
 s_add_u32 s54, s54, 1024
 v_cvt_pk_bf16_f32 v216, v160, v161
 v_cvt_pk_bf16_f32 v217, v162, v163
 v_cvt_pk_bf16_f32 v218, v164, v165
 v_cvt_pk_bf16_f32 v219, v166, v167
 v_cvt_pk_bf16_f32 v220, v168, v169
 v_cvt_pk_bf16_f32 v221, v170, v171
 v_cvt_pk_bf16_f32 v222, v172, v173
 v_cvt_pk_bf16_f32 v223, v174, v175
 buffer_store_dwordx4 v[216:219], v245, s[8:11], s54 offen offset:0 sc1
 buffer_store_dwordx4 v[220:223], v245, s[8:11], s54 offen offset:512 sc1
 s_add_u32 s54, s54, 1024
 v_cvt_pk_bf16_f32 v224, v176, v177
 v_cvt_pk_bf16_f32 v225, v178, v179
 v_cvt_pk_bf16_f32 v226, v180, v181
 v_cvt_pk_bf16_f32 v227, v182, v183
 v_cvt_pk_bf16_f32 v228, v184, v185
 v_cvt_pk_bf16_f32 v229, v186, v187
 v_cvt_pk_bf16_f32 v230, v188, v189
 v_cvt_pk_bf16_f32 v231, v190, v191
 buffer_store_dwordx4 v[224:227], v245, s[8:11], s54 offen offset:0 sc1
 buffer_store_dwordx4 v[228:231], v245, s[8:11], s54 offen offset:512 sc1
 s_add_u32 s54, s54, 1024
 s_lshl_b32 s28, s50, 5
 s_add_u32 s28, s28, s51
 s_lshl_b32 s28, s28, 2
 s_add_u32 s28, s28, 6324224
 s_waitcnt vmcnt(0)
 s_barrier
 s_cmp_eq_u32 s14, 0
 s_cbranch_scc0 sg_57
 s_mov_b64 exec, 1
 v_mov_b32 v233, 0
 v_mov_b32 v234, 2
 buffer_atomic_add v234, v233, s[8:11], s28 offen sc1
 s_mov_b64 exec, -1
sg_57:
 s_branch wk_next
wk_vu:
 v_accvgpr_read_b32 v244, a222
 s_mul_i32 s52, s51, 384
 s_mul_i32 s55, s51, 245760
 s_lshl_b32 s48, s50, 2
 s_add_u32 s48, s48, s14
 s_mul_i32 s48, s48, 40960
 s_lshl_b32 s53, s50, 2
 s_add_u32 s53, s53, s14
 s_lshl_b32 s53, s53, 5
 s_add_u32 s53, s53, s51
 s_mul_i32 s53, s53, 40960
 s_add_u32 s53, s53, 96468992
 s_add_u32 m0, s19, 0
 s_add_u32 s29, s52, 0
 buffer_load_dwordx4 v236, s[32:35], s29 offen lds
 s_add_u32 m0, s19, 1024
 s_add_u32 s29, s52, 0
 buffer_load_dwordx4 v237, s[32:35], s29 offen lds
 s_add_u32 m0, s19, 2048
 s_add_u32 s29, s52, 0
 buffer_load_dwordx4 v238, s[32:35], s29 offen lds
 s_add_u32 m0, s19, 3072
 s_add_u32 s29, s52, 98304
 buffer_load_dwordx4 v236, s[32:35], s29 offen lds
 s_add_u32 m0, s19, 4096
 s_add_u32 s29, s52, 98304
 buffer_load_dwordx4 v237, s[32:35], s29 offen lds
 s_add_u32 m0, s19, 5120
 s_add_u32 s29, s52, 98304
 buffer_load_dwordx4 v238, s[32:35], s29 offen lds
 buffer_load_dwordx4 a[0:3], v232, s[8:11], s48 offen offset:0
 buffer_load_dwordx4 a[4:7], v232, s[8:11], s48 offen offset:1024
 buffer_load_dwordx4 a[8:11], v232, s[8:11], s48 offen offset:2048
 buffer_load_dwordx4 a[12:15], v232, s[8:11], s48 offen offset:3072
 s_add_u32 s48, s48, 4096
 s_add_u32 m0, s19, 24576
 s_add_u32 s29, s52, 786432
 buffer_load_dwordx4 v236, s[32:35], s29 offen lds
 s_add_u32 m0, s19, 25600
 s_add_u32 s29, s52, 786432
 buffer_load_dwordx4 v237, s[32:35], s29 offen lds
 s_add_u32 m0, s19, 26624
 s_add_u32 s29, s52, 786432
 buffer_load_dwordx4 v238, s[32:35], s29 offen lds
 s_add_u32 m0, s19, 27648
 s_add_u32 s29, s52, 884736
 buffer_load_dwordx4 v236, s[32:35], s29 offen lds
 s_add_u32 m0, s19, 28672
 s_add_u32 s29, s52, 884736
 buffer_load_dwordx4 v237, s[32:35], s29 offen lds
 s_add_u32 m0, s19, 29696
 s_add_u32 s29, s52, 884736
 buffer_load_dwordx4 v238, s[32:35], s29 offen lds
 buffer_load_dwordx4 a[16:19], v232, s[8:11], s48 offen offset:0
 buffer_load_dwordx4 a[20:23], v232, s[8:11], s48 offen offset:1024
 buffer_load_dwordx4 a[24:27], v232, s[8:11], s48 offen offset:2048
 buffer_load_dwordx4 a[28:31], v232, s[8:11], s48 offen offset:3072
 s_add_u32 s48, s48, 4096
 s_add_u32 m0, s19, 49152
 s_add_u32 s29, s52, 1572864
 buffer_load_dwordx4 v236, s[32:35], s29 offen lds
 s_add_u32 m0, s19, 50176
 s_add_u32 s29, s52, 1572864
 buffer_load_dwordx4 v237, s[32:35], s29 offen lds
 s_add_u32 m0, s19, 51200
 s_add_u32 s29, s52, 1572864
 buffer_load_dwordx4 v238, s[32:35], s29 offen lds
 s_add_u32 m0, s19, 52224
 s_add_u32 s29, s52, 1671168
 buffer_load_dwordx4 v236, s[32:35], s29 offen lds
 s_add_u32 m0, s19, 53248
 s_add_u32 s29, s52, 1671168
 buffer_load_dwordx4 v237, s[32:35], s29 offen lds
 s_add_u32 m0, s19, 54272
 s_add_u32 s29, s52, 1671168
 buffer_load_dwordx4 v238, s[32:35], s29 offen lds
 buffer_load_dwordx4 a[32:35], v232, s[8:11], s48 offen offset:0
 buffer_load_dwordx4 a[36:39], v232, s[8:11], s48 offen offset:1024
 buffer_load_dwordx4 a[40:43], v232, s[8:11], s48 offen offset:2048
 buffer_load_dwordx4 a[44:47], v232, s[8:11], s48 offen offset:3072
 s_add_u32 s48, s48, 4096
 s_add_u32 m0, s19, 73728
 s_add_u32 s29, s52, 2359296
 buffer_load_dwordx4 v236, s[32:35], s29 offen lds
 s_add_u32 m0, s19, 74752
 s_add_u32 s29, s52, 2359296
 buffer_load_dwordx4 v237, s[32:35], s29 offen lds
 s_add_u32 m0, s19, 75776
 s_add_u32 s29, s52, 2359296
 buffer_load_dwordx4 v238, s[32:35], s29 offen lds
 s_add_u32 m0, s19, 76800
 s_add_u32 s29, s52, 2457600
 buffer_load_dwordx4 v236, s[32:35], s29 offen lds
 s_add_u32 m0, s19, 77824
 s_add_u32 s29, s52, 2457600
 buffer_load_dwordx4 v237, s[32:35], s29 offen lds
 s_add_u32 m0, s19, 78848
 s_add_u32 s29, s52, 2457600
 buffer_load_dwordx4 v238, s[32:35], s29 offen lds
 buffer_load_dwordx4 a[48:51], v232, s[8:11], s48 offen offset:0
 buffer_load_dwordx4 a[52:55], v232, s[8:11], s48 offen offset:1024
 buffer_load_dwordx4 a[56:59], v232, s[8:11], s48 offen offset:2048
 buffer_load_dwordx4 a[60:63], v232, s[8:11], s48 offen offset:3072
 s_add_u32 s48, s48, 4096
 s_waitcnt vmcnt(34)
 s_waitcnt vmcnt(24)
 s_barrier
 ds_read_b64_tr_b16 v[192:193], v240 offset:0
 ds_read_b64_tr_b16 v[194:195], v240 offset:1536
 ds_read_b64_tr_b16 v[196:197], v241 offset:64
 ds_read_b64_tr_b16 v[198:199], v241 offset:1600
 ds_read_b64_tr_b16 v[200:201], v240 offset:128
 ds_read_b64_tr_b16 v[202:203], v240 offset:1664
 ds_read_b64_tr_b16 v[204:205], v241 offset:192
 ds_read_b64_tr_b16 v[206:207], v241 offset:1728
 ds_read_b64_tr_b16 v[208:209], v240 offset:256
 ds_read_b64_tr_b16 v[210:211], v240 offset:1792
 s_waitcnt lgkmcnt(8)
 v_mfma_f32_32x32x16_bf16 v[0:15], v[192:195], a[0:3], 0
 ds_read_b64_tr_b16 v[212:213], v241 offset:320
 ds_read_b64_tr_b16 v[214:215], v241 offset:1856
 s_waitcnt lgkmcnt(8)
 v_mfma_f32_32x32x16_bf16 v[16:31], v[196:199], a[0:3], 0
 s_add_u32 m0, s19, 98304
 s_add_u32 s29, s52, 3145728
 buffer_load_dwordx4 v236, s[32:35], s29 offen lds
 s_add_u32 m0, s19, 99328
 s_add_u32 s29, s52, 3145728
 buffer_load_dwordx4 v237, s[32:35], s29 offen lds
 s_add_u32 m0, s19, 100352
 s_add_u32 s29, s52, 3145728
 buffer_load_dwordx4 v238, s[32:35], s29 offen lds
 s_add_u32 m0, s19, 101376
 s_add_u32 s29, s52, 3244032
 buffer_load_dwordx4 v236, s[32:35], s29 offen lds
 s_add_u32 m0, s19, 102400
 s_add_u32 s29, s52, 3244032
 buffer_load_dwordx4 v237, s[32:35], s29 offen lds
 s_add_u32 m0, s19, 103424
 s_add_u32 s29, s52, 3244032
 buffer_load_dwordx4 v238, s[32:35], s29 offen lds
 ds_read_b64_tr_b16 v[192:193], v240 offset:6144
 ds_read_b64_tr_b16 v[194:195], v240 offset:7680
 s_waitcnt lgkmcnt(8)
 v_mfma_f32_32x32x16_bf16 v[32:47], v[200:203], a[0:3], 0
 ds_read_b64_tr_b16 v[196:197], v241 offset:6208
 ds_read_b64_tr_b16 v[198:199], v241 offset:7744
 s_waitcnt lgkmcnt(8)
 v_mfma_f32_32x32x16_bf16 v[48:63], v[204:207], a[0:3], 0
 ds_read_b64_tr_b16 v[200:201], v240 offset:6272
 ds_read_b64_tr_b16 v[202:203], v240 offset:7808
 s_waitcnt lgkmcnt(8)
 v_mfma_f32_32x32x16_bf16 v[64:79], v[208:211], a[0:3], 0
 ds_read_b64_tr_b16 v[204:205], v241 offset:6336
 ds_read_b64_tr_b16 v[206:207], v241 offset:7872
 s_waitcnt lgkmcnt(8)
 v_mfma_f32_32x32x16_bf16 v[80:95], v[212:215], a[0:3], 0
 ds_read_b64_tr_b16 v[208:209], v240 offset:6400
 ds_read_b64_tr_b16 v[210:211], v240 offset:7936
 s_waitcnt lgkmcnt(8)
 v_mfma_f32_32x32x16_bf16 v[0:15], v[192:195], a[4:7], v[0:15]
 ds_read_b64_tr_b16 v[212:213], v241 offset:6464
 ds_read_b64_tr_b16 v[214:215], v241 offset:8000
 s_waitcnt lgkmcnt(8)
 v_mfma_f32_32x32x16_bf16 v[16:31], v[196:199], a[4:7], v[16:31]
 ds_read_b64_tr_b16 v[192:193], v240 offset:12288
 ds_read_b64_tr_b16 v[194:195], v240 offset:13824
 s_waitcnt lgkmcnt(8)
 v_mfma_f32_32x32x16_bf16 v[32:47], v[200:203], a[4:7], v[32:47]
 buffer_load_dwordx4 a[64:67], v232, s[8:11], s48 offen offset:0
 buffer_load_dwordx4 a[68:71], v232, s[8:11], s48 offen offset:1024
 buffer_load_dwordx4 a[72:75], v232, s[8:11], s48 offen offset:2048
 buffer_load_dwordx4 a[76:79], v232, s[8:11], s48 offen offset:3072
 s_add_u32 s48, s48, 4096
 ds_read_b64_tr_b16 v[196:197], v241 offset:12352
 ds_read_b64_tr_b16 v[198:199], v241 offset:13888
 s_waitcnt lgkmcnt(8)
 v_mfma_f32_32x32x16_bf16 v[48:63], v[204:207], a[4:7], v[48:63]
 ds_read_b64_tr_b16 v[200:201], v240 offset:12416
 ds_read_b64_tr_b16 v[202:203], v240 offset:13952
 s_waitcnt lgkmcnt(8)
 v_mfma_f32_32x32x16_bf16 v[64:79], v[208:211], a[4:7], v[64:79]
 ds_read_b64_tr_b16 v[204:205], v241 offset:12480
 ds_read_b64_tr_b16 v[206:207], v241 offset:14016
 s_waitcnt lgkmcnt(8)
 v_mfma_f32_32x32x16_bf16 v[80:95], v[212:215], a[4:7], v[80:95]
 ds_read_b64_tr_b16 v[208:209], v240 offset:12544
 ds_read_b64_tr_b16 v[210:211], v240 offset:14080
 s_waitcnt lgkmcnt(8)
 v_mfma_f32_32x32x16_bf16 v[0:15], v[192:195], a[8:11], v[0:15]
 ds_read_b64_tr_b16 v[212:213], v241 offset:12608
 ds_read_b64_tr_b16 v[214:215], v241 offset:14144
 s_waitcnt lgkmcnt(8)
 v_mfma_f32_32x32x16_bf16 v[16:31], v[196:199], a[8:11], v[16:31]
 ds_read_b64_tr_b16 v[192:193], v240 offset:18432
 ds_read_b64_tr_b16 v[194:195], v240 offset:19968
 s_waitcnt lgkmcnt(8)
 v_mfma_f32_32x32x16_bf16 v[32:47], v[200:203], a[8:11], v[32:47]
 ds_read_b64_tr_b16 v[196:197], v241 offset:18496
 ds_read_b64_tr_b16 v[198:199], v241 offset:20032
 s_waitcnt lgkmcnt(8)
 v_mfma_f32_32x32x16_bf16 v[48:63], v[204:207], a[8:11], v[48:63]
 ds_read_b64_tr_b16 v[200:201], v240 offset:18560
 ds_read_b64_tr_b16 v[202:203], v240 offset:20096
 s_waitcnt lgkmcnt(8)
 v_mfma_f32_32x32x16_bf16 v[64:79], v[208:211], a[8:11], v[64:79]
 ds_read_b64_tr_b16 v[204:205], v241 offset:18624
 ds_read_b64_tr_b16 v[206:207], v241 offset:20160
 s_waitcnt lgkmcnt(8)
 v_mfma_f32_32x32x16_bf16 v[80:95], v[212:215], a[8:11], v[80:95]
 ds_read_b64_tr_b16 v[208:209], v240 offset:18688
 ds_read_b64_tr_b16 v[210:211], v240 offset:20224
 s_waitcnt lgkmcnt(8)
 v_mfma_f32_32x32x16_bf16 v[0:15], v[192:195], a[12:15], v[0:15]
 ds_read_b64_tr_b16 v[212:213], v241 offset:18752
 ds_read_b64_tr_b16 v[214:215], v241 offset:20288
 s_waitcnt lgkmcnt(8)
 v_mfma_f32_32x32x16_bf16 v[16:31], v[196:199], a[12:15], v[16:31]
 ds_read_b64_tr_b16 v[192:193], v240 offset:24576
 ds_read_b64_tr_b16 v[194:195], v240 offset:26112
 s_waitcnt lgkmcnt(8)
 v_mfma_f32_32x32x16_bf16 v[32:47], v[200:203], a[12:15], v[32:47]
 ds_read_b64_tr_b16 v[196:197], v241 offset:24640
 ds_read_b64_tr_b16 v[198:199], v241 offset:26176
 s_waitcnt lgkmcnt(8)
 v_mfma_f32_32x32x16_bf16 v[48:63], v[204:207], a[12:15], v[48:63]
 ds_read_b64_tr_b16 v[200:201], v240 offset:24704
 ds_read_b64_tr_b16 v[202:203], v240 offset:26240
 s_waitcnt lgkmcnt(8)
 v_mfma_f32_32x32x16_bf16 v[64:79], v[208:211], a[12:15], v[64:79]
 ds_read_b64_tr_b16 v[204:205], v241 offset:24768
 ds_read_b64_tr_b16 v[206:207], v241 offset:26304
 s_waitcnt lgkmcnt(8)
 v_mfma_f32_32x32x16_bf16 v[80:95], v[212:215], a[12:15], v[80:95]
 s_waitcnt vmcnt(24)
 s_barrier
 ds_read_b64_tr_b16 v[208:209], v240 offset:24832
 ds_read_b64_tr_b16 v[210:211], v240 offset:26368
 s_waitcnt lgkmcnt(8)
 v_mfma_f32_32x32x16_bf16 v[0:15], v[192:195], a[16:19], v[0:15]
 ds_read_b64_tr_b16 v[212:213], v241 offset:24896
 ds_read_b64_tr_b16 v[214:215], v241 offset:26432
 s_waitcnt lgkmcnt(8)
 v_mfma_f32_32x32x16_bf16 v[16:31], v[196:199], a[16:19], v[16:31]
 s_add_u32 m0, s19, 0
 s_add_u32 s29, s52, 3932160
 buffer_load_dwordx4 v236, s[32:35], s29 offen lds
 s_add_u32 m0, s19, 1024
 s_add_u32 s29, s52, 3932160
 buffer_load_dwordx4 v237, s[32:35], s29 offen lds
 s_add_u32 m0, s19, 2048
 s_add_u32 s29, s52, 3932160
 buffer_load_dwordx4 v238, s[32:35], s29 offen lds
 s_add_u32 m0, s19, 3072
 s_add_u32 s29, s52, 4030464
 buffer_load_dwordx4 v236, s[32:35], s29 offen lds
 s_add_u32 m0, s19, 4096
 s_add_u32 s29, s52, 4030464
 buffer_load_dwordx4 v237, s[32:35], s29 offen lds
 s_add_u32 m0, s19, 5120
 s_add_u32 s29, s52, 4030464
 buffer_load_dwordx4 v238, s[32:35], s29 offen lds
 ds_read_b64_tr_b16 v[192:193], v240 offset:30720
 ds_read_b64_tr_b16 v[194:195], v240 offset:32256
 s_waitcnt lgkmcnt(8)
 v_mfma_f32_32x32x16_bf16 v[32:47], v[200:203], a[16:19], v[32:47]
 ds_read_b64_tr_b16 v[196:197], v241 offset:30784
 ds_read_b64_tr_b16 v[198:199], v241 offset:32320
 s_waitcnt lgkmcnt(8)
 v_mfma_f32_32x32x16_bf16 v[48:63], v[204:207], a[16:19], v[48:63]
 ds_read_b64_tr_b16 v[200:201], v240 offset:30848
 ds_read_b64_tr_b16 v[202:203], v240 offset:32384
 s_waitcnt lgkmcnt(8)
 v_mfma_f32_32x32x16_bf16 v[64:79], v[208:211], a[16:19], v[64:79]
 ds_read_b64_tr_b16 v[204:205], v241 offset:30912
 ds_read_b64_tr_b16 v[206:207], v241 offset:32448
 s_waitcnt lgkmcnt(8)
 v_mfma_f32_32x32x16_bf16 v[80:95], v[212:215], a[16:19], v[80:95]
 ds_read_b64_tr_b16 v[208:209], v240 offset:30976
 ds_read_b64_tr_b16 v[210:211], v240 offset:32512
 s_waitcnt lgkmcnt(8)
 v_mfma_f32_32x32x16_bf16 v[0:15], v[192:195], a[20:23], v[0:15]
 ds_read_b64_tr_b16 v[212:213], v241 offset:31040
 ds_read_b64_tr_b16 v[214:215], v241 offset:32576
 s_waitcnt lgkmcnt(8)
 v_mfma_f32_32x32x16_bf16 v[16:31], v[196:199], a[20:23], v[16:31]
 ds_read_b64_tr_b16 v[192:193], v240 offset:36864
 ds_read_b64_tr_b16 v[194:195], v240 offset:38400
 s_waitcnt lgkmcnt(8)
 v_mfma_f32_32x32x16_bf16 v[32:47], v[200:203], a[20:23], v[32:47]
 buffer_load_dwordx4 a[80:83], v232, s[8:11], s48 offen offset:0
 buffer_load_dwordx4 a[84:87], v232, s[8:11], s48 offen offset:1024
 buffer_load_dwordx4 a[88:91], v232, s[8:11], s48 offen offset:2048
 buffer_load_dwordx4 a[92:95], v232, s[8:11], s48 offen offset:3072
 s_add_u32 s48, s48, 4096
 ds_read_b64_tr_b16 v[196:197], v241 offset:36928
 ds_read_b64_tr_b16 v[198:199], v241 offset:38464
 s_waitcnt lgkmcnt(8)
 v_mfma_f32_32x32x16_bf16 v[48:63], v[204:207], a[20:23], v[48:63]
 ds_read_b64_tr_b16 v[200:201], v240 offset:36992
 ds_read_b64_tr_b16 v[202:203], v240 offset:38528
 s_waitcnt lgkmcnt(8)
 v_mfma_f32_32x32x16_bf16 v[64:79], v[208:211], a[20:23], v[64:79]
 ds_read_b64_tr_b16 v[204:205], v241 offset:37056
 ds_read_b64_tr_b16 v[206:207], v241 offset:38592
 s_waitcnt lgkmcnt(8)
 v_mfma_f32_32x32x16_bf16 v[80:95], v[212:215], a[20:23], v[80:95]
 ds_read_b64_tr_b16 v[208:209], v240 offset:37120
 ds_read_b64_tr_b16 v[210:211], v240 offset:38656
 s_waitcnt lgkmcnt(8)
 v_mfma_f32_32x32x16_bf16 v[0:15], v[192:195], a[24:27], v[0:15]
 ds_read_b64_tr_b16 v[212:213], v241 offset:37184
 ds_read_b64_tr_b16 v[214:215], v241 offset:38720
 s_waitcnt lgkmcnt(8)
 v_mfma_f32_32x32x16_bf16 v[16:31], v[196:199], a[24:27], v[16:31]
 ds_read_b64_tr_b16 v[192:193], v240 offset:43008
 ds_read_b64_tr_b16 v[194:195], v240 offset:44544
 s_waitcnt lgkmcnt(8)
 v_mfma_f32_32x32x16_bf16 v[32:47], v[200:203], a[24:27], v[32:47]
 ds_read_b64_tr_b16 v[196:197], v241 offset:43072
 ds_read_b64_tr_b16 v[198:199], v241 offset:44608
 s_waitcnt lgkmcnt(8)
 v_mfma_f32_32x32x16_bf16 v[48:63], v[204:207], a[24:27], v[48:63]
 ds_read_b64_tr_b16 v[200:201], v240 offset:43136
 ds_read_b64_tr_b16 v[202:203], v240 offset:44672
 s_waitcnt lgkmcnt(8)
 v_mfma_f32_32x32x16_bf16 v[64:79], v[208:211], a[24:27], v[64:79]
 ds_read_b64_tr_b16 v[204:205], v241 offset:43200
 ds_read_b64_tr_b16 v[206:207], v241 offset:44736
 s_waitcnt lgkmcnt(8)
 v_mfma_f32_32x32x16_bf16 v[80:95], v[212:215], a[24:27], v[80:95]
 ds_read_b64_tr_b16 v[208:209], v240 offset:43264
 ds_read_b64_tr_b16 v[210:211], v240 offset:44800
 s_waitcnt lgkmcnt(8)
 v_mfma_f32_32x32x16_bf16 v[0:15], v[192:195], a[28:31], v[0:15]
 ds_read_b64_tr_b16 v[212:213], v241 offset:43328
 ds_read_b64_tr_b16 v[214:215], v241 offset:44864
 s_waitcnt lgkmcnt(8)
 v_mfma_f32_32x32x16_bf16 v[16:31], v[196:199], a[28:31], v[16:31]
 ds_read_b64_tr_b16 v[192:193], v240 offset:49152
 ds_read_b64_tr_b16 v[194:195], v240 offset:50688
 s_waitcnt lgkmcnt(8)
 v_mfma_f32_32x32x16_bf16 v[32:47], v[200:203], a[28:31], v[32:47]
 ds_read_b64_tr_b16 v[196:197], v241 offset:49216
 ds_read_b64_tr_b16 v[198:199], v241 offset:50752
 s_waitcnt lgkmcnt(8)
 v_mfma_f32_32x32x16_bf16 v[48:63], v[204:207], a[28:31], v[48:63]
 ds_read_b64_tr_b16 v[200:201], v240 offset:49280
 ds_read_b64_tr_b16 v[202:203], v240 offset:50816
 s_waitcnt lgkmcnt(8)
 v_mfma_f32_32x32x16_bf16 v[64:79], v[208:211], a[28:31], v[64:79]
 ds_read_b64_tr_b16 v[204:205], v241 offset:49344
 ds_read_b64_tr_b16 v[206:207], v241 offset:50880
 s_waitcnt lgkmcnt(8)
 v_mfma_f32_32x32x16_bf16 v[80:95], v[212:215], a[28:31], v[80:95]
 s_waitcnt vmcnt(24)
 s_barrier
 ds_read_b64_tr_b16 v[208:209], v240 offset:49408
 ds_read_b64_tr_b16 v[210:211], v240 offset:50944
 s_waitcnt lgkmcnt(8)
 v_mfma_f32_32x32x16_bf16 v[0:15], v[192:195], a[32:35], v[0:15]
 ds_read_b64_tr_b16 v[212:213], v241 offset:49472
 ds_read_b64_tr_b16 v[214:215], v241 offset:51008
 s_waitcnt lgkmcnt(8)
 v_mfma_f32_32x32x16_bf16 v[16:31], v[196:199], a[32:35], v[16:31]
 s_add_u32 m0, s19, 24576
 s_add_u32 s29, s52, 4718592
 buffer_load_dwordx4 v236, s[32:35], s29 offen lds
 s_add_u32 m0, s19, 25600
 s_add_u32 s29, s52, 4718592
 buffer_load_dwordx4 v237, s[32:35], s29 offen lds
 s_add_u32 m0, s19, 26624
 s_add_u32 s29, s52, 4718592
 buffer_load_dwordx4 v238, s[32:35], s29 offen lds
 s_add_u32 m0, s19, 27648
 s_add_u32 s29, s52, 4816896
 buffer_load_dwordx4 v236, s[32:35], s29 offen lds
 s_add_u32 m0, s19, 28672
 s_add_u32 s29, s52, 4816896
 buffer_load_dwordx4 v237, s[32:35], s29 offen lds
 s_add_u32 m0, s19, 29696
 s_add_u32 s29, s52, 4816896
 buffer_load_dwordx4 v238, s[32:35], s29 offen lds
 ds_read_b64_tr_b16 v[192:193], v240 offset:55296
 ds_read_b64_tr_b16 v[194:195], v240 offset:56832
 s_waitcnt lgkmcnt(8)
 v_mfma_f32_32x32x16_bf16 v[32:47], v[200:203], a[32:35], v[32:47]
 ds_read_b64_tr_b16 v[196:197], v241 offset:55360
 ds_read_b64_tr_b16 v[198:199], v241 offset:56896
 s_waitcnt lgkmcnt(8)
 v_mfma_f32_32x32x16_bf16 v[48:63], v[204:207], a[32:35], v[48:63]
 ds_read_b64_tr_b16 v[200:201], v240 offset:55424
 ds_read_b64_tr_b16 v[202:203], v240 offset:56960
 s_waitcnt lgkmcnt(8)
 v_mfma_f32_32x32x16_bf16 v[64:79], v[208:211], a[32:35], v[64:79]
 ds_read_b64_tr_b16 v[204:205], v241 offset:55488
 ds_read_b64_tr_b16 v[206:207], v241 offset:57024
 s_waitcnt lgkmcnt(8)
 v_mfma_f32_32x32x16_bf16 v[80:95], v[212:215], a[32:35], v[80:95]
 ds_read_b64_tr_b16 v[208:209], v240 offset:55552
 ds_read_b64_tr_b16 v[210:211], v240 offset:57088
 s_waitcnt lgkmcnt(8)
 v_mfma_f32_32x32x16_bf16 v[0:15], v[192:195], a[36:39], v[0:15]
 ds_read_b64_tr_b16 v[212:213], v241 offset:55616
 ds_read_b64_tr_b16 v[214:215], v241 offset:57152
 s_waitcnt lgkmcnt(8)
 v_mfma_f32_32x32x16_bf16 v[16:31], v[196:199], a[36:39], v[16:31]
 ds_read_b64_tr_b16 v[192:193], v240 offset:61440
 ds_read_b64_tr_b16 v[194:195], v240 offset:62976
 s_waitcnt lgkmcnt(8)
 v_mfma_f32_32x32x16_bf16 v[32:47], v[200:203], a[36:39], v[32:47]
 buffer_load_dwordx4 a[96:99], v232, s[8:11], s48 offen offset:0
 buffer_load_dwordx4 a[100:103], v232, s[8:11], s48 offen offset:1024
 buffer_load_dwordx4 a[104:107], v232, s[8:11], s48 offen offset:2048
 buffer_load_dwordx4 a[108:111], v232, s[8:11], s48 offen offset:3072
 s_add_u32 s48, s48, 4096
 ds_read_b64_tr_b16 v[196:197], v241 offset:61504
 ds_read_b64_tr_b16 v[198:199], v241 offset:63040
 s_waitcnt lgkmcnt(8)
 v_mfma_f32_32x32x16_bf16 v[48:63], v[204:207], a[36:39], v[48:63]
 ds_read_b64_tr_b16 v[200:201], v240 offset:61568
 ds_read_b64_tr_b16 v[202:203], v240 offset:63104
 s_waitcnt lgkmcnt(8)
 v_mfma_f32_32x32x16_bf16 v[64:79], v[208:211], a[36:39], v[64:79]
 ds_read_b64_tr_b16 v[204:205], v241 offset:61632
 ds_read_b64_tr_b16 v[206:207], v241 offset:63168
 s_waitcnt lgkmcnt(8)
 v_mfma_f32_32x32x16_bf16 v[80:95], v[212:215], a[36:39], v[80:95]
 ds_read_b64_tr_b16 v[208:209], v240 offset:61696
 ds_read_b64_tr_b16 v[210:211], v240 offset:63232
 s_waitcnt lgkmcnt(8)
 v_mfma_f32_32x32x16_bf16 v[0:15], v[192:195], a[40:43], v[0:15]
 ds_read_b64_tr_b16 v[212:213], v241 offset:61760
 ds_read_b64_tr_b16 v[214:215], v241 offset:63296
 s_waitcnt lgkmcnt(8)
 v_mfma_f32_32x32x16_bf16 v[16:31], v[196:199], a[40:43], v[16:31]
 ds_read_b64_tr_b16 v[192:193], v248 offset:2048
 ds_read_b64_tr_b16 v[194:195], v248 offset:3584
 s_waitcnt lgkmcnt(8)
 v_mfma_f32_32x32x16_bf16 v[32:47], v[200:203], a[40:43], v[32:47]
 ds_read_b64_tr_b16 v[196:197], v249 offset:2112
 ds_read_b64_tr_b16 v[198:199], v249 offset:3648
 s_waitcnt lgkmcnt(8)
 v_mfma_f32_32x32x16_bf16 v[48:63], v[204:207], a[40:43], v[48:63]
 ds_read_b64_tr_b16 v[200:201], v248 offset:2176
 ds_read_b64_tr_b16 v[202:203], v248 offset:3712
 s_waitcnt lgkmcnt(8)
 v_mfma_f32_32x32x16_bf16 v[64:79], v[208:211], a[40:43], v[64:79]
 ds_read_b64_tr_b16 v[204:205], v249 offset:2240
 ds_read_b64_tr_b16 v[206:207], v249 offset:3776
 s_waitcnt lgkmcnt(8)
 v_mfma_f32_32x32x16_bf16 v[80:95], v[212:215], a[40:43], v[80:95]
 ds_read_b64_tr_b16 v[208:209], v248 offset:2304
 ds_read_b64_tr_b16 v[210:211], v248 offset:3840
 s_waitcnt lgkmcnt(8)
 v_mfma_f32_32x32x16_bf16 v[0:15], v[192:195], a[44:47], v[0:15]
 ds_read_b64_tr_b16 v[212:213], v249 offset:2368
 ds_read_b64_tr_b16 v[214:215], v249 offset:3904
 s_waitcnt lgkmcnt(8)
 v_mfma_f32_32x32x16_bf16 v[16:31], v[196:199], a[44:47], v[16:31]
 ds_read_b64_tr_b16 v[192:193], v248 offset:8192
 ds_read_b64_tr_b16 v[194:195], v248 offset:9728
 s_waitcnt lgkmcnt(8)
 v_mfma_f32_32x32x16_bf16 v[32:47], v[200:203], a[44:47], v[32:47]
 ds_read_b64_tr_b16 v[196:197], v249 offset:8256
 ds_read_b64_tr_b16 v[198:199], v249 offset:9792
 s_waitcnt lgkmcnt(8)
 v_mfma_f32_32x32x16_bf16 v[48:63], v[204:207], a[44:47], v[48:63]
 ds_read_b64_tr_b16 v[200:201], v248 offset:8320
 ds_read_b64_tr_b16 v[202:203], v248 offset:9856
 s_waitcnt lgkmcnt(8)
 v_mfma_f32_32x32x16_bf16 v[64:79], v[208:211], a[44:47], v[64:79]
 ds_read_b64_tr_b16 v[204:205], v249 offset:8384
 ds_read_b64_tr_b16 v[206:207], v249 offset:9920
 s_waitcnt lgkmcnt(8)
 v_mfma_f32_32x32x16_bf16 v[80:95], v[212:215], a[44:47], v[80:95]
 s_waitcnt vmcnt(24)
 s_barrier
 ds_read_b64_tr_b16 v[208:209], v248 offset:8448
 ds_read_b64_tr_b16 v[210:211], v248 offset:9984
 s_waitcnt lgkmcnt(8)
 v_mfma_f32_32x32x16_bf16 v[0:15], v[192:195], a[48:51], v[0:15]
 ds_read_b64_tr_b16 v[212:213], v249 offset:8512
 ds_read_b64_tr_b16 v[214:215], v249 offset:10048
 s_waitcnt lgkmcnt(8)
 v_mfma_f32_32x32x16_bf16 v[16:31], v[196:199], a[48:51], v[16:31]
 s_add_u32 m0, s19, 49152
 s_add_u32 s29, s52, 5505024
 buffer_load_dwordx4 v236, s[32:35], s29 offen lds
 s_add_u32 m0, s19, 50176
 s_add_u32 s29, s52, 5505024
 buffer_load_dwordx4 v237, s[32:35], s29 offen lds
 s_add_u32 m0, s19, 51200
 s_add_u32 s29, s52, 5505024
 buffer_load_dwordx4 v238, s[32:35], s29 offen lds
 s_add_u32 m0, s19, 52224
 s_add_u32 s29, s52, 5603328
 buffer_load_dwordx4 v236, s[32:35], s29 offen lds
 s_add_u32 m0, s19, 53248
 s_add_u32 s29, s52, 5603328
 buffer_load_dwordx4 v237, s[32:35], s29 offen lds
 s_add_u32 m0, s19, 54272
 s_add_u32 s29, s52, 5603328
 buffer_load_dwordx4 v238, s[32:35], s29 offen lds
 ds_read_b64_tr_b16 v[192:193], v248 offset:14336
 ds_read_b64_tr_b16 v[194:195], v248 offset:15872
 s_waitcnt lgkmcnt(8)
 v_mfma_f32_32x32x16_bf16 v[32:47], v[200:203], a[48:51], v[32:47]
 ds_read_b64_tr_b16 v[196:197], v249 offset:14400
 ds_read_b64_tr_b16 v[198:199], v249 offset:15936
 s_waitcnt lgkmcnt(8)
 v_mfma_f32_32x32x16_bf16 v[48:63], v[204:207], a[48:51], v[48:63]
 ds_read_b64_tr_b16 v[200:201], v248 offset:14464
 ds_read_b64_tr_b16 v[202:203], v248 offset:16000
 s_waitcnt lgkmcnt(8)
 v_mfma_f32_32x32x16_bf16 v[64:79], v[208:211], a[48:51], v[64:79]
 ds_read_b64_tr_b16 v[204:205], v249 offset:14528
 ds_read_b64_tr_b16 v[206:207], v249 offset:16064
 s_waitcnt lgkmcnt(8)
 v_mfma_f32_32x32x16_bf16 v[80:95], v[212:215], a[48:51], v[80:95]
 ds_read_b64_tr_b16 v[208:209], v248 offset:14592
 ds_read_b64_tr_b16 v[210:211], v248 offset:16128
 s_waitcnt lgkmcnt(8)
 v_mfma_f32_32x32x16_bf16 v[0:15], v[192:195], a[52:55], v[0:15]
 ds_read_b64_tr_b16 v[212:213], v249 offset:14656
 ds_read_b64_tr_b16 v[214:215], v249 offset:16192
 s_waitcnt lgkmcnt(8)
 v_mfma_f32_32x32x16_bf16 v[16:31], v[196:199], a[52:55], v[16:31]
 ds_read_b64_tr_b16 v[192:193], v248 offset:20480
 ds_read_b64_tr_b16 v[194:195], v248 offset:22016
 s_waitcnt lgkmcnt(8)
 v_mfma_f32_32x32x16_bf16 v[32:47], v[200:203], a[52:55], v[32:47]
 buffer_load_dwordx4 a[112:115], v232, s[8:11], s48 offen offset:0
 buffer_load_dwordx4 a[116:119], v232, s[8:11], s48 offen offset:1024
 buffer_load_dwordx4 a[120:123], v232, s[8:11], s48 offen offset:2048
 buffer_load_dwordx4 a[124:127], v232, s[8:11], s48 offen offset:3072
 s_add_u32 s48, s48, 4096
 ds_read_b64_tr_b16 v[196:197], v249 offset:20544
 ds_read_b64_tr_b16 v[198:199], v249 offset:22080
 s_waitcnt lgkmcnt(8)
 v_mfma_f32_32x32x16_bf16 v[48:63], v[204:207], a[52:55], v[48:63]
 ds_read_b64_tr_b16 v[200:201], v248 offset:20608
 ds_read_b64_tr_b16 v[202:203], v248 offset:22144
 s_waitcnt lgkmcnt(8)
 v_mfma_f32_32x32x16_bf16 v[64:79], v[208:211], a[52:55], v[64:79]
 ds_read_b64_tr_b16 v[204:205], v249 offset:20672
 ds_read_b64_tr_b16 v[206:207], v249 offset:22208
 s_waitcnt lgkmcnt(8)
 v_mfma_f32_32x32x16_bf16 v[80:95], v[212:215], a[52:55], v[80:95]
 ds_read_b64_tr_b16 v[208:209], v248 offset:20736
 ds_read_b64_tr_b16 v[210:211], v248 offset:22272
 s_waitcnt lgkmcnt(8)
 v_mfma_f32_32x32x16_bf16 v[0:15], v[192:195], a[56:59], v[0:15]
 ds_read_b64_tr_b16 v[212:213], v249 offset:20800
 ds_read_b64_tr_b16 v[214:215], v249 offset:22336
 s_waitcnt lgkmcnt(8)
 v_mfma_f32_32x32x16_bf16 v[16:31], v[196:199], a[56:59], v[16:31]
 ds_read_b64_tr_b16 v[192:193], v248 offset:26624
 ds_read_b64_tr_b16 v[194:195], v248 offset:28160
 s_waitcnt lgkmcnt(8)
 v_mfma_f32_32x32x16_bf16 v[32:47], v[200:203], a[56:59], v[32:47]
 ds_read_b64_tr_b16 v[196:197], v249 offset:26688
 ds_read_b64_tr_b16 v[198:199], v249 offset:28224
 s_waitcnt lgkmcnt(8)
 v_mfma_f32_32x32x16_bf16 v[48:63], v[204:207], a[56:59], v[48:63]
 ds_read_b64_tr_b16 v[200:201], v248 offset:26752
 ds_read_b64_tr_b16 v[202:203], v248 offset:28288
 s_waitcnt lgkmcnt(8)
 v_mfma_f32_32x32x16_bf16 v[64:79], v[208:211], a[56:59], v[64:79]
 ds_read_b64_tr_b16 v[204:205], v249 offset:26816
 ds_read_b64_tr_b16 v[206:207], v249 offset:28352
 s_waitcnt lgkmcnt(8)
 v_mfma_f32_32x32x16_bf16 v[80:95], v[212:215], a[56:59], v[80:95]
 ds_read_b64_tr_b16 v[208:209], v248 offset:26880
 ds_read_b64_tr_b16 v[210:211], v248 offset:28416
 s_waitcnt lgkmcnt(8)
 v_mfma_f32_32x32x16_bf16 v[0:15], v[192:195], a[60:63], v[0:15]
 ds_read_b64_tr_b16 v[212:213], v249 offset:26944
 ds_read_b64_tr_b16 v[214:215], v249 offset:28480
 s_waitcnt lgkmcnt(8)
 v_mfma_f32_32x32x16_bf16 v[16:31], v[196:199], a[60:63], v[16:31]
 ds_read_b64_tr_b16 v[192:193], v248 offset:32768
 ds_read_b64_tr_b16 v[194:195], v248 offset:34304
 s_waitcnt lgkmcnt(8)
 v_mfma_f32_32x32x16_bf16 v[32:47], v[200:203], a[60:63], v[32:47]
 ds_read_b64_tr_b16 v[196:197], v249 offset:32832
 ds_read_b64_tr_b16 v[198:199], v249 offset:34368
 s_waitcnt lgkmcnt(8)
 v_mfma_f32_32x32x16_bf16 v[48:63], v[204:207], a[60:63], v[48:63]
 ds_read_b64_tr_b16 v[200:201], v248 offset:32896
 ds_read_b64_tr_b16 v[202:203], v248 offset:34432
 s_waitcnt lgkmcnt(8)
 v_mfma_f32_32x32x16_bf16 v[64:79], v[208:211], a[60:63], v[64:79]
 ds_read_b64_tr_b16 v[204:205], v249 offset:32960
 ds_read_b64_tr_b16 v[206:207], v249 offset:34496
 s_waitcnt lgkmcnt(8)
 v_mfma_f32_32x32x16_bf16 v[80:95], v[212:215], a[60:63], v[80:95]
 s_waitcnt vmcnt(24)
 s_barrier
 ds_read_b64_tr_b16 v[208:209], v248 offset:33024
 ds_read_b64_tr_b16 v[210:211], v248 offset:34560
 s_waitcnt lgkmcnt(8)
 v_mfma_f32_32x32x16_bf16 v[0:15], v[192:195], a[64:67], v[0:15]
 ds_read_b64_tr_b16 v[212:213], v249 offset:33088
 ds_read_b64_tr_b16 v[214:215], v249 offset:34624
 s_waitcnt lgkmcnt(8)
 v_mfma_f32_32x32x16_bf16 v[16:31], v[196:199], a[64:67], v[16:31]
 s_add_u32 m0, s19, 73728
 s_add_u32 s29, s52, 6291456
 buffer_load_dwordx4 v236, s[32:35], s29 offen lds
 s_add_u32 m0, s19, 74752
 s_add_u32 s29, s52, 6291456
 buffer_load_dwordx4 v237, s[32:35], s29 offen lds
 s_add_u32 m0, s19, 75776
 s_add_u32 s29, s52, 6291456
 buffer_load_dwordx4 v238, s[32:35], s29 offen lds
 s_add_u32 m0, s19, 76800
 s_add_u32 s29, s52, 6389760
 buffer_load_dwordx4 v236, s[32:35], s29 offen lds
 s_add_u32 m0, s19, 77824
 s_add_u32 s29, s52, 6389760
 buffer_load_dwordx4 v237, s[32:35], s29 offen lds
 s_add_u32 m0, s19, 78848
 s_add_u32 s29, s52, 6389760
 buffer_load_dwordx4 v238, s[32:35], s29 offen lds
 ds_read_b64_tr_b16 v[192:193], v248 offset:38912
 ds_read_b64_tr_b16 v[194:195], v248 offset:40448
 s_waitcnt lgkmcnt(8)
 v_mfma_f32_32x32x16_bf16 v[32:47], v[200:203], a[64:67], v[32:47]
 ds_read_b64_tr_b16 v[196:197], v249 offset:38976
 ds_read_b64_tr_b16 v[198:199], v249 offset:40512
 s_waitcnt lgkmcnt(8)
 v_mfma_f32_32x32x16_bf16 v[48:63], v[204:207], a[64:67], v[48:63]
 ds_read_b64_tr_b16 v[200:201], v248 offset:39040
 ds_read_b64_tr_b16 v[202:203], v248 offset:40576
 s_waitcnt lgkmcnt(8)
 v_mfma_f32_32x32x16_bf16 v[64:79], v[208:211], a[64:67], v[64:79]
 ds_read_b64_tr_b16 v[204:205], v249 offset:39104
 ds_read_b64_tr_b16 v[206:207], v249 offset:40640
 s_waitcnt lgkmcnt(8)
 v_mfma_f32_32x32x16_bf16 v[80:95], v[212:215], a[64:67], v[80:95]
 ds_read_b64_tr_b16 v[208:209], v248 offset:39168
 ds_read_b64_tr_b16 v[210:211], v248 offset:40704
 s_waitcnt lgkmcnt(8)
 v_mfma_f32_32x32x16_bf16 v[0:15], v[192:195], a[68:71], v[0:15]
 ds_read_b64_tr_b16 v[212:213], v249 offset:39232
 ds_read_b64_tr_b16 v[214:215], v249 offset:40768
 s_waitcnt lgkmcnt(8)
 v_mfma_f32_32x32x16_bf16 v[16:31], v[196:199], a[68:71], v[16:31]
 ds_read_b64_tr_b16 v[192:193], v248 offset:45056
 ds_read_b64_tr_b16 v[194:195], v248 offset:46592
 s_waitcnt lgkmcnt(8)
 v_mfma_f32_32x32x16_bf16 v[32:47], v[200:203], a[68:71], v[32:47]
 buffer_load_dwordx4 a[128:131], v232, s[8:11], s48 offen offset:0
 buffer_load_dwordx4 a[132:135], v232, s[8:11], s48 offen offset:1024
 buffer_load_dwordx4 a[136:139], v232, s[8:11], s48 offen offset:2048
 buffer_load_dwordx4 a[140:143], v232, s[8:11], s48 offen offset:3072
 s_add_u32 s48, s48, 4096
 ds_read_b64_tr_b16 v[196:197], v249 offset:45120
 ds_read_b64_tr_b16 v[198:199], v249 offset:46656
 s_waitcnt lgkmcnt(8)
 v_mfma_f32_32x32x16_bf16 v[48:63], v[204:207], a[68:71], v[48:63]
 ds_read_b64_tr_b16 v[200:201], v248 offset:45184
 ds_read_b64_tr_b16 v[202:203], v248 offset:46720
 s_waitcnt lgkmcnt(8)
 v_mfma_f32_32x32x16_bf16 v[64:79], v[208:211], a[68:71], v[64:79]
 ds_read_b64_tr_b16 v[204:205], v249 offset:45248
 ds_read_b64_tr_b16 v[206:207], v249 offset:46784
 s_waitcnt lgkmcnt(8)
 v_mfma_f32_32x32x16_bf16 v[80:95], v[212:215], a[68:71], v[80:95]
 ds_read_b64_tr_b16 v[208:209], v248 offset:45312
 ds_read_b64_tr_b16 v[210:211], v248 offset:46848
 s_waitcnt lgkmcnt(8)
 v_mfma_f32_32x32x16_bf16 v[0:15], v[192:195], a[72:75], v[0:15]
 ds_read_b64_tr_b16 v[212:213], v249 offset:45376
 ds_read_b64_tr_b16 v[214:215], v249 offset:46912
 s_waitcnt lgkmcnt(8)
 v_mfma_f32_32x32x16_bf16 v[16:31], v[196:199], a[72:75], v[16:31]
 ds_read_b64_tr_b16 v[192:193], v248 offset:51200
 ds_read_b64_tr_b16 v[194:195], v248 offset:52736
 s_waitcnt lgkmcnt(8)
 v_mfma_f32_32x32x16_bf16 v[32:47], v[200:203], a[72:75], v[32:47]
 ds_read_b64_tr_b16 v[196:197], v249 offset:51264
 ds_read_b64_tr_b16 v[198:199], v249 offset:52800
 s_waitcnt lgkmcnt(8)
 v_mfma_f32_32x32x16_bf16 v[48:63], v[204:207], a[72:75], v[48:63]
 ds_read_b64_tr_b16 v[200:201], v248 offset:51328
 ds_read_b64_tr_b16 v[202:203], v248 offset:52864
 s_waitcnt lgkmcnt(8)
 v_mfma_f32_32x32x16_bf16 v[64:79], v[208:211], a[72:75], v[64:79]
 ds_read_b64_tr_b16 v[204:205], v249 offset:51392
 ds_read_b64_tr_b16 v[206:207], v249 offset:52928
 s_waitcnt lgkmcnt(8)
 v_mfma_f32_32x32x16_bf16 v[80:95], v[212:215], a[72:75], v[80:95]
 ds_read_b64_tr_b16 v[208:209], v248 offset:51456
 ds_read_b64_tr_b16 v[210:211], v248 offset:52992
 s_waitcnt lgkmcnt(8)
 v_mfma_f32_32x32x16_bf16 v[0:15], v[192:195], a[76:79], v[0:15]
 ds_read_b64_tr_b16 v[212:213], v249 offset:51520
 ds_read_b64_tr_b16 v[214:215], v249 offset:53056
 s_waitcnt lgkmcnt(8)
 v_mfma_f32_32x32x16_bf16 v[16:31], v[196:199], a[76:79], v[16:31]
 ds_read_b64_tr_b16 v[192:193], v240 offset:0
 ds_read_b64_tr_b16 v[194:195], v240 offset:1536
 s_waitcnt lgkmcnt(8)
 v_mfma_f32_32x32x16_bf16 v[32:47], v[200:203], a[76:79], v[32:47]
 ds_read_b64_tr_b16 v[196:197], v241 offset:64
 ds_read_b64_tr_b16 v[198:199], v241 offset:1600
 s_waitcnt lgkmcnt(8)
 v_mfma_f32_32x32x16_bf16 v[48:63], v[204:207], a[76:79], v[48:63]
 ds_read_b64_tr_b16 v[200:201], v240 offset:128
 ds_read_b64_tr_b16 v[202:203], v240 offset:1664
 s_waitcnt lgkmcnt(8)
 v_mfma_f32_32x32x16_bf16 v[64:79], v[208:211], a[76:79], v[64:79]
 ds_read_b64_tr_b16 v[204:205], v241 offset:192
 ds_read_b64_tr_b16 v[206:207], v241 offset:1728
 s_waitcnt lgkmcnt(8)
 v_mfma_f32_32x32x16_bf16 v[80:95], v[212:215], a[76:79], v[80:95]
 s_waitcnt vmcnt(24)
 s_barrier
 ds_read_b64_tr_b16 v[208:209], v240 offset:256
 ds_read_b64_tr_b16 v[210:211], v240 offset:1792
 s_waitcnt lgkmcnt(8)
 v_mfma_f32_32x32x16_bf16 v[0:15], v[192:195], a[80:83], v[0:15]
 ds_read_b64_tr_b16 v[212:213], v241 offset:320
 ds_read_b64_tr_b16 v[214:215], v241 offset:1856
 s_waitcnt lgkmcnt(8)
 v_mfma_f32_32x32x16_bf16 v[16:31], v[196:199], a[80:83], v[16:31]
 s_add_u32 m0, s19, 98304
 s_add_u32 s29, s52, 7077888
 buffer_load_dwordx4 v236, s[32:35], s29 offen lds
 s_add_u32 m0, s19, 99328
 s_add_u32 s29, s52, 7077888
 buffer_load_dwordx4 v237, s[32:35], s29 offen lds
 s_add_u32 m0, s19, 100352
 s_add_u32 s29, s52, 7077888
 buffer_load_dwordx4 v238, s[32:35], s29 offen lds
 s_add_u32 m0, s19, 101376
 s_add_u32 s29, s52, 7176192
 buffer_load_dwordx4 v236, s[32:35], s29 offen lds
 s_add_u32 m0, s19, 102400
 s_add_u32 s29, s52, 7176192
 buffer_load_dwordx4 v237, s[32:35], s29 offen lds
 s_add_u32 m0, s19, 103424
 s_add_u32 s29, s52, 7176192
 buffer_load_dwordx4 v238, s[32:35], s29 offen lds
 ds_read_b64_tr_b16 v[192:193], v240 offset:6144
 ds_read_b64_tr_b16 v[194:195], v240 offset:7680
 s_waitcnt lgkmcnt(8)
 v_mfma_f32_32x32x16_bf16 v[32:47], v[200:203], a[80:83], v[32:47]
 ds_read_b64_tr_b16 v[196:197], v241 offset:6208
 ds_read_b64_tr_b16 v[198:199], v241 offset:7744
 s_waitcnt lgkmcnt(8)
 v_mfma_f32_32x32x16_bf16 v[48:63], v[204:207], a[80:83], v[48:63]
 ds_read_b64_tr_b16 v[200:201], v240 offset:6272
 ds_read_b64_tr_b16 v[202:203], v240 offset:7808
 s_waitcnt lgkmcnt(8)
 v_mfma_f32_32x32x16_bf16 v[64:79], v[208:211], a[80:83], v[64:79]
 ds_read_b64_tr_b16 v[204:205], v241 offset:6336
 ds_read_b64_tr_b16 v[206:207], v241 offset:7872
 s_waitcnt lgkmcnt(8)
 v_mfma_f32_32x32x16_bf16 v[80:95], v[212:215], a[80:83], v[80:95]
 ds_read_b64_tr_b16 v[208:209], v240 offset:6400
 ds_read_b64_tr_b16 v[210:211], v240 offset:7936
 s_waitcnt lgkmcnt(8)
 v_mfma_f32_32x32x16_bf16 v[0:15], v[192:195], a[84:87], v[0:15]
 ds_read_b64_tr_b16 v[212:213], v241 offset:6464
 ds_read_b64_tr_b16 v[214:215], v241 offset:8000
 s_waitcnt lgkmcnt(8)
 v_mfma_f32_32x32x16_bf16 v[16:31], v[196:199], a[84:87], v[16:31]
 ds_read_b64_tr_b16 v[192:193], v240 offset:12288
 ds_read_b64_tr_b16 v[194:195], v240 offset:13824
 s_waitcnt lgkmcnt(8)
 v_mfma_f32_32x32x16_bf16 v[32:47], v[200:203], a[84:87], v[32:47]
 buffer_load_dwordx4 a[144:147], v232, s[8:11], s48 offen offset:0
 buffer_load_dwordx4 a[148:151], v232, s[8:11], s48 offen offset:1024
 buffer_load_dwordx4 a[152:155], v232, s[8:11], s48 offen offset:2048
 buffer_load_dwordx4 a[156:159], v232, s[8:11], s48 offen offset:3072
 s_add_u32 s48, s48, 4096
 ds_read_b64_tr_b16 v[196:197], v241 offset:12352
 ds_read_b64_tr_b16 v[198:199], v241 offset:13888
 s_waitcnt lgkmcnt(8)
 v_mfma_f32_32x32x16_bf16 v[48:63], v[204:207], a[84:87], v[48:63]
 ds_read_b64_tr_b16 v[200:201], v240 offset:12416
 ds_read_b64_tr_b16 v[202:203], v240 offset:13952
 s_waitcnt lgkmcnt(8)
 v_mfma_f32_32x32x16_bf16 v[64:79], v[208:211], a[84:87], v[64:79]
 ds_read_b64_tr_b16 v[204:205], v241 offset:12480
 ds_read_b64_tr_b16 v[206:207], v241 offset:14016
 s_waitcnt lgkmcnt(8)
 v_mfma_f32_32x32x16_bf16 v[80:95], v[212:215], a[84:87], v[80:95]
 ds_read_b64_tr_b16 v[208:209], v240 offset:12544
 ds_read_b64_tr_b16 v[210:211], v240 offset:14080
 s_waitcnt lgkmcnt(8)
 v_mfma_f32_32x32x16_bf16 v[0:15], v[192:195], a[88:91], v[0:15]
 ds_read_b64_tr_b16 v[212:213], v241 offset:12608
 ds_read_b64_tr_b16 v[214:215], v241 offset:14144
 s_waitcnt lgkmcnt(8)
 v_mfma_f32_32x32x16_bf16 v[16:31], v[196:199], a[88:91], v[16:31]
 ds_read_b64_tr_b16 v[192:193], v240 offset:18432
 ds_read_b64_tr_b16 v[194:195], v240 offset:19968
 s_waitcnt lgkmcnt(8)
 v_mfma_f32_32x32x16_bf16 v[32:47], v[200:203], a[88:91], v[32:47]
 ds_read_b64_tr_b16 v[196:197], v241 offset:18496
 ds_read_b64_tr_b16 v[198:199], v241 offset:20032
 s_waitcnt lgkmcnt(8)
 v_mfma_f32_32x32x16_bf16 v[48:63], v[204:207], a[88:91], v[48:63]
 ds_read_b64_tr_b16 v[200:201], v240 offset:18560
 ds_read_b64_tr_b16 v[202:203], v240 offset:20096
 s_waitcnt lgkmcnt(8)
 v_mfma_f32_32x32x16_bf16 v[64:79], v[208:211], a[88:91], v[64:79]
 ds_read_b64_tr_b16 v[204:205], v241 offset:18624
 ds_read_b64_tr_b16 v[206:207], v241 offset:20160
 s_waitcnt lgkmcnt(8)
 v_mfma_f32_32x32x16_bf16 v[80:95], v[212:215], a[88:91], v[80:95]
 ds_read_b64_tr_b16 v[208:209], v240 offset:18688
 ds_read_b64_tr_b16 v[210:211], v240 offset:20224
 s_waitcnt lgkmcnt(8)
 v_mfma_f32_32x32x16_bf16 v[0:15], v[192:195], a[92:95], v[0:15]
 ds_read_b64_tr_b16 v[212:213], v241 offset:18752
 ds_read_b64_tr_b16 v[214:215], v241 offset:20288
 s_waitcnt lgkmcnt(8)
 v_mfma_f32_32x32x16_bf16 v[16:31], v[196:199], a[92:95], v[16:31]
 ds_read_b64_tr_b16 v[192:193], v240 offset:24576
 ds_read_b64_tr_b16 v[194:195], v240 offset:26112
 s_waitcnt lgkmcnt(8)
 v_mfma_f32_32x32x16_bf16 v[32:47], v[200:203], a[92:95], v[32:47]
 ds_read_b64_tr_b16 v[196:197], v241 offset:24640
 ds_read_b64_tr_b16 v[198:199], v241 offset:26176
 s_waitcnt lgkmcnt(8)
 v_mfma_f32_32x32x16_bf16 v[48:63], v[204:207], a[92:95], v[48:63]
 ds_read_b64_tr_b16 v[200:201], v240 offset:24704
 ds_read_b64_tr_b16 v[202:203], v240 offset:26240
 s_waitcnt lgkmcnt(8)
 v_mfma_f32_32x32x16_bf16 v[64:79], v[208:211], a[92:95], v[64:79]
 ds_read_b64_tr_b16 v[204:205], v241 offset:24768
 ds_read_b64_tr_b16 v[206:207], v241 offset:26304
 s_waitcnt lgkmcnt(8)
 v_mfma_f32_32x32x16_bf16 v[80:95], v[212:215], a[92:95], v[80:95]
 s_waitcnt vmcnt(24)
 s_barrier
 ds_read_b64_tr_b16 v[208:209], v240 offset:24832
 ds_read_b64_tr_b16 v[210:211], v240 offset:26368
 s_waitcnt lgkmcnt(8)
 v_mfma_f32_32x32x16_bf16 v[0:15], v[192:195], a[96:99], v[0:15]
 ds_read_b64_tr_b16 v[212:213], v241 offset:24896
 ds_read_b64_tr_b16 v[214:215], v241 offset:26432
 s_waitcnt lgkmcnt(8)
 v_mfma_f32_32x32x16_bf16 v[16:31], v[196:199], a[96:99], v[16:31]
 s_add_u32 m0, s19, 0
 s_add_u32 s29, s55, 0
 buffer_load_dwordx4 v239, s[36:39], s29 offen lds
 s_add_u32 m0, s19, 1024
 s_add_u32 s29, s55, 10240
 buffer_load_dwordx4 v239, s[36:39], s29 offen lds
 s_add_u32 m0, s19, 2048
 s_add_u32 s29, s55, 20480
 buffer_load_dwordx4 v239, s[36:39], s29 offen lds
 s_add_u32 m0, s19, 3072
 s_add_u32 s29, s55, 30720
 buffer_load_dwordx4 v239, s[36:39], s29 offen lds
 s_add_u32 m0, s19, 4096
 s_add_u32 s29, s55, 40960
 buffer_load_dwordx4 v239, s[36:39], s29 offen lds
 s_add_u32 m0, s19, 5120
 s_add_u32 s29, s55, 51200
 buffer_load_dwordx4 v239, s[36:39], s29 offen lds
 ds_read_b64_tr_b16 v[192:193], v240 offset:30720
 ds_read_b64_tr_b16 v[194:195], v240 offset:32256
 s_waitcnt lgkmcnt(8)
 v_mfma_f32_32x32x16_bf16 v[32:47], v[200:203], a[96:99], v[32:47]
 ds_read_b64_tr_b16 v[196:197], v241 offset:30784
 ds_read_b64_tr_b16 v[198:199], v241 offset:32320
 s_waitcnt lgkmcnt(8)
 v_mfma_f32_32x32x16_bf16 v[48:63], v[204:207], a[96:99], v[48:63]
 ds_read_b64_tr_b16 v[200:201], v240 offset:30848
 ds_read_b64_tr_b16 v[202:203], v240 offset:32384
 s_waitcnt lgkmcnt(8)
 v_mfma_f32_32x32x16_bf16 v[64:79], v[208:211], a[96:99], v[64:79]
 ds_read_b64_tr_b16 v[204:205], v241 offset:30912
 ds_read_b64_tr_b16 v[206:207], v241 offset:32448
 s_waitcnt lgkmcnt(8)
 v_mfma_f32_32x32x16_bf16 v[80:95], v[212:215], a[96:99], v[80:95]
 ds_read_b64_tr_b16 v[208:209], v240 offset:30976
 ds_read_b64_tr_b16 v[210:211], v240 offset:32512
 s_waitcnt lgkmcnt(8)
 v_mfma_f32_32x32x16_bf16 v[0:15], v[192:195], a[100:103], v[0:15]
 ds_read_b64_tr_b16 v[212:213], v241 offset:31040
 ds_read_b64_tr_b16 v[214:215], v241 offset:32576
 s_waitcnt lgkmcnt(8)
 v_mfma_f32_32x32x16_bf16 v[16:31], v[196:199], a[100:103], v[16:31]
 ds_read_b64_tr_b16 v[192:193], v240 offset:36864
 ds_read_b64_tr_b16 v[194:195], v240 offset:38400
 s_waitcnt lgkmcnt(8)
 v_mfma_f32_32x32x16_bf16 v[32:47], v[200:203], a[100:103], v[32:47]
 ds_read_b64_tr_b16 v[196:197], v241 offset:36928
 ds_read_b64_tr_b16 v[198:199], v241 offset:38464
 s_waitcnt lgkmcnt(8)
 v_mfma_f32_32x32x16_bf16 v[48:63], v[204:207], a[100:103], v[48:63]
 ds_read_b64_tr_b16 v[200:201], v240 offset:36992
 ds_read_b64_tr_b16 v[202:203], v240 offset:38528
 s_waitcnt lgkmcnt(8)
 v_mfma_f32_32x32x16_bf16 v[64:79], v[208:211], a[100:103], v[64:79]
 ds_read_b64_tr_b16 v[204:205], v241 offset:37056
 ds_read_b64_tr_b16 v[206:207], v241 offset:38592
 s_waitcnt lgkmcnt(8)
 v_mfma_f32_32x32x16_bf16 v[80:95], v[212:215], a[100:103], v[80:95]
 ds_read_b64_tr_b16 v[208:209], v240 offset:37120
 ds_read_b64_tr_b16 v[210:211], v240 offset:38656
 s_waitcnt lgkmcnt(8)
 v_mfma_f32_32x32x16_bf16 v[0:15], v[192:195], a[104:107], v[0:15]
 ds_read_b64_tr_b16 v[212:213], v241 offset:37184
 ds_read_b64_tr_b16 v[214:215], v241 offset:38720
 s_waitcnt lgkmcnt(8)
 v_mfma_f32_32x32x16_bf16 v[16:31], v[196:199], a[104:107], v[16:31]
 ds_read_b64_tr_b16 v[192:193], v240 offset:43008
 ds_read_b64_tr_b16 v[194:195], v240 offset:44544
 s_waitcnt lgkmcnt(8)
 v_mfma_f32_32x32x16_bf16 v[32:47], v[200:203], a[104:107], v[32:47]
 ds_read_b64_tr_b16 v[196:197], v241 offset:43072
 ds_read_b64_tr_b16 v[198:199], v241 offset:44608
 s_waitcnt lgkmcnt(8)
 v_mfma_f32_32x32x16_bf16 v[48:63], v[204:207], a[104:107], v[48:63]
 ds_read_b64_tr_b16 v[200:201], v240 offset:43136
 ds_read_b64_tr_b16 v[202:203], v240 offset:44672
 s_waitcnt lgkmcnt(8)
 v_mfma_f32_32x32x16_bf16 v[64:79], v[208:211], a[104:107], v[64:79]
 ds_read_b64_tr_b16 v[204:205], v241 offset:43200
 ds_read_b64_tr_b16 v[206:207], v241 offset:44736
 s_waitcnt lgkmcnt(8)
 v_mfma_f32_32x32x16_bf16 v[80:95], v[212:215], a[104:107], v[80:95]
 ds_read_b64_tr_b16 v[208:209], v240 offset:43264
 ds_read_b64_tr_b16 v[210:211], v240 offset:44800
 s_waitcnt lgkmcnt(8)
 v_mfma_f32_32x32x16_bf16 v[0:15], v[192:195], a[108:111], v[0:15]
 ds_read_b64_tr_b16 v[212:213], v241 offset:43328
 ds_read_b64_tr_b16 v[214:215], v241 offset:44864
 s_waitcnt lgkmcnt(8)
 v_mfma_f32_32x32x16_bf16 v[16:31], v[196:199], a[108:111], v[16:31]
 ds_read_b64_tr_b16 v[192:193], v240 offset:49152
 ds_read_b64_tr_b16 v[194:195], v240 offset:50688
 s_waitcnt lgkmcnt(8)
 v_mfma_f32_32x32x16_bf16 v[32:47], v[200:203], a[108:111], v[32:47]
 ds_read_b64_tr_b16 v[196:197], v241 offset:49216
 ds_read_b64_tr_b16 v[198:199], v241 offset:50752
 s_waitcnt lgkmcnt(8)
 v_mfma_f32_32x32x16_bf16 v[48:63], v[204:207], a[108:111], v[48:63]
 ds_read_b64_tr_b16 v[200:201], v240 offset:49280
 ds_read_b64_tr_b16 v[202:203], v240 offset:50816
 s_waitcnt lgkmcnt(8)
 v_mfma_f32_32x32x16_bf16 v[64:79], v[208:211], a[108:111], v[64:79]
 ds_read_b64_tr_b16 v[204:205], v241 offset:49344
 ds_read_b64_tr_b16 v[206:207], v241 offset:50880
 s_waitcnt lgkmcnt(8)
 v_mfma_f32_32x32x16_bf16 v[80:95], v[212:215], a[108:111], v[80:95]
 s_waitcnt vmcnt(20)
 s_barrier
 ds_read_b64_tr_b16 v[208:209], v240 offset:49408
 ds_read_b64_tr_b16 v[210:211], v240 offset:50944
 s_waitcnt lgkmcnt(8)
 v_mfma_f32_32x32x16_bf16 v[0:15], v[192:195], a[112:115], v[0:15]
 ds_read_b64_tr_b16 v[212:213], v241 offset:49472
 ds_read_b64_tr_b16 v[214:215], v241 offset:51008
 s_waitcnt lgkmcnt(8)
 v_mfma_f32_32x32x16_bf16 v[16:31], v[196:199], a[112:115], v[16:31]
 s_add_u32 m0, s19, 24576
 s_add_u32 s29, s55, 128
 buffer_load_dwordx4 v239, s[36:39], s29 offen lds
 s_add_u32 m0, s19, 25600
 s_add_u32 s29, s55, 10368
 buffer_load_dwordx4 v239, s[36:39], s29 offen lds
 s_add_u32 m0, s19, 26624
 s_add_u32 s29, s55, 20608
 buffer_load_dwordx4 v239, s[36:39], s29 offen lds
 s_add_u32 m0, s19, 27648
 s_add_u32 s29, s55, 30848
 buffer_load_dwordx4 v239, s[36:39], s29 offen lds
 s_add_u32 m0, s19, 28672
 s_add_u32 s29, s55, 41088
 buffer_load_dwordx4 v239, s[36:39], s29 offen lds
 s_add_u32 m0, s19, 29696
 s_add_u32 s29, s55, 51328
 buffer_load_dwordx4 v239, s[36:39], s29 offen lds
 ds_read_b64_tr_b16 v[192:193], v240 offset:55296
 ds_read_b64_tr_b16 v[194:195], v240 offset:56832
 s_waitcnt lgkmcnt(8)
 v_mfma_f32_32x32x16_bf16 v[32:47], v[200:203], a[112:115], v[32:47]
 ds_read_b64_tr_b16 v[196:197], v241 offset:55360
 ds_read_b64_tr_b16 v[198:199], v241 offset:56896
 s_waitcnt lgkmcnt(8)
 v_mfma_f32_32x32x16_bf16 v[48:63], v[204:207], a[112:115], v[48:63]
 ds_read_b64_tr_b16 v[200:201], v240 offset:55424
 ds_read_b64_tr_b16 v[202:203], v240 offset:56960
 s_waitcnt lgkmcnt(8)
 v_mfma_f32_32x32x16_bf16 v[64:79], v[208:211], a[112:115], v[64:79]
 ds_read_b64_tr_b16 v[204:205], v241 offset:55488
 ds_read_b64_tr_b16 v[206:207], v241 offset:57024
 s_waitcnt lgkmcnt(8)
 v_mfma_f32_32x32x16_bf16 v[80:95], v[212:215], a[112:115], v[80:95]
 ds_read_b64_tr_b16 v[208:209], v240 offset:55552
 ds_read_b64_tr_b16 v[210:211], v240 offset:57088
 s_waitcnt lgkmcnt(8)
 v_mfma_f32_32x32x16_bf16 v[0:15], v[192:195], a[116:119], v[0:15]
 ds_read_b64_tr_b16 v[212:213], v241 offset:55616
 ds_read_b64_tr_b16 v[214:215], v241 offset:57152
 s_waitcnt lgkmcnt(8)
 v_mfma_f32_32x32x16_bf16 v[16:31], v[196:199], a[116:119], v[16:31]
 ds_read_b64_tr_b16 v[192:193], v240 offset:61440
 ds_read_b64_tr_b16 v[194:195], v240 offset:62976
 s_waitcnt lgkmcnt(8)
 v_mfma_f32_32x32x16_bf16 v[32:47], v[200:203], a[116:119], v[32:47]
 ds_read_b64_tr_b16 v[196:197], v241 offset:61504
 ds_read_b64_tr_b16 v[198:199], v241 offset:63040
 s_waitcnt lgkmcnt(8)
 v_mfma_f32_32x32x16_bf16 v[48:63], v[204:207], a[116:119], v[48:63]
 ds_read_b64_tr_b16 v[200:201], v240 offset:61568
 ds_read_b64_tr_b16 v[202:203], v240 offset:63104
 s_waitcnt lgkmcnt(8)
 v_mfma_f32_32x32x16_bf16 v[64:79], v[208:211], a[116:119], v[64:79]
 ds_read_b64_tr_b16 v[204:205], v241 offset:61632
 ds_read_b64_tr_b16 v[206:207], v241 offset:63168
 s_waitcnt lgkmcnt(8)
 v_mfma_f32_32x32x16_bf16 v[80:95], v[212:215], a[116:119], v[80:95]
 ds_read_b64_tr_b16 v[208:209], v240 offset:61696
 ds_read_b64_tr_b16 v[210:211], v240 offset:63232
 s_waitcnt lgkmcnt(8)
 v_mfma_f32_32x32x16_bf16 v[0:15], v[192:195], a[120:123], v[0:15]
 ds_read_b64_tr_b16 v[212:213], v241 offset:61760
 ds_read_b64_tr_b16 v[214:215], v241 offset:63296
 s_waitcnt lgkmcnt(8)
 v_mfma_f32_32x32x16_bf16 v[16:31], v[196:199], a[120:123], v[16:31]
 ds_read_b64_tr_b16 v[192:193], v248 offset:2048
 ds_read_b64_tr_b16 v[194:195], v248 offset:3584
 s_waitcnt lgkmcnt(8)
 v_mfma_f32_32x32x16_bf16 v[32:47], v[200:203], a[120:123], v[32:47]
 ds_read_b64_tr_b16 v[196:197], v249 offset:2112
 ds_read_b64_tr_b16 v[198:199], v249 offset:3648
 s_waitcnt lgkmcnt(8)
 v_mfma_f32_32x32x16_bf16 v[48:63], v[204:207], a[120:123], v[48:63]
 ds_read_b64_tr_b16 v[200:201], v248 offset:2176
 ds_read_b64_tr_b16 v[202:203], v248 offset:3712
 s_waitcnt lgkmcnt(8)
 v_mfma_f32_32x32x16_bf16 v[64:79], v[208:211], a[120:123], v[64:79]
 ds_read_b64_tr_b16 v[204:205], v249 offset:2240
 ds_read_b64_tr_b16 v[206:207], v249 offset:3776
 s_waitcnt lgkmcnt(8)
 v_mfma_f32_32x32x16_bf16 v[80:95], v[212:215], a[120:123], v[80:95]
 ds_read_b64_tr_b16 v[208:209], v248 offset:2304
 ds_read_b64_tr_b16 v[210:211], v248 offset:3840
 s_waitcnt lgkmcnt(8)
 v_mfma_f32_32x32x16_bf16 v[0:15], v[192:195], a[124:127], v[0:15]
 ds_read_b64_tr_b16 v[212:213], v249 offset:2368
 ds_read_b64_tr_b16 v[214:215], v249 offset:3904
 s_waitcnt lgkmcnt(8)
 v_mfma_f32_32x32x16_bf16 v[16:31], v[196:199], a[124:127], v[16:31]
 ds_read_b64_tr_b16 v[192:193], v248 offset:8192
 ds_read_b64_tr_b16 v[194:195], v248 offset:9728
 s_waitcnt lgkmcnt(8)
 v_mfma_f32_32x32x16_bf16 v[32:47], v[200:203], a[124:127], v[32:47]
 ds_read_b64_tr_b16 v[196:197], v249 offset:8256
 ds_read_b64_tr_b16 v[198:199], v249 offset:9792
 s_waitcnt lgkmcnt(8)
 v_mfma_f32_32x32x16_bf16 v[48:63], v[204:207], a[124:127], v[48:63]
 ds_read_b64_tr_b16 v[200:201], v248 offset:8320
 ds_read_b64_tr_b16 v[202:203], v248 offset:9856
 s_waitcnt lgkmcnt(8)
 v_mfma_f32_32x32x16_bf16 v[64:79], v[208:211], a[124:127], v[64:79]
 ds_read_b64_tr_b16 v[204:205], v249 offset:8384
 ds_read_b64_tr_b16 v[206:207], v249 offset:9920
 s_waitcnt lgkmcnt(8)
 v_mfma_f32_32x32x16_bf16 v[80:95], v[212:215], a[124:127], v[80:95]
 s_waitcnt vmcnt(16)
 s_barrier
 ds_read_b64_tr_b16 v[208:209], v248 offset:8448
 ds_read_b64_tr_b16 v[210:211], v248 offset:9984
 s_waitcnt lgkmcnt(8)
 v_mfma_f32_32x32x16_bf16 v[0:15], v[192:195], a[128:131], v[0:15]
 ds_read_b64_tr_b16 v[212:213], v249 offset:8512
 ds_read_b64_tr_b16 v[214:215], v249 offset:10048
 s_waitcnt lgkmcnt(8)
 v_mfma_f32_32x32x16_bf16 v[16:31], v[196:199], a[128:131], v[16:31]
 s_add_u32 m0, s19, 49152
 s_add_u32 s29, s55, 256
 buffer_load_dwordx4 v239, s[36:39], s29 offen lds
 s_add_u32 m0, s19, 50176
 s_add_u32 s29, s55, 10496
 buffer_load_dwordx4 v239, s[36:39], s29 offen lds
 s_add_u32 m0, s19, 51200
 s_add_u32 s29, s55, 20736
 buffer_load_dwordx4 v239, s[36:39], s29 offen lds
 s_add_u32 m0, s19, 52224
 s_add_u32 s29, s55, 30976
 buffer_load_dwordx4 v239, s[36:39], s29 offen lds
 s_add_u32 m0, s19, 53248
 s_add_u32 s29, s55, 41216
 buffer_load_dwordx4 v239, s[36:39], s29 offen lds
 s_add_u32 m0, s19, 54272
 s_add_u32 s29, s55, 51456
 buffer_load_dwordx4 v239, s[36:39], s29 offen lds
 ds_read_b64_tr_b16 v[192:193], v248 offset:14336
 ds_read_b64_tr_b16 v[194:195], v248 offset:15872
 s_waitcnt lgkmcnt(8)
 v_mfma_f32_32x32x16_bf16 v[32:47], v[200:203], a[128:131], v[32:47]
 ds_read_b64_tr_b16 v[196:197], v249 offset:14400
 ds_read_b64_tr_b16 v[198:199], v249 offset:15936
 s_waitcnt lgkmcnt(8)
 v_mfma_f32_32x32x16_bf16 v[48:63], v[204:207], a[128:131], v[48:63]
 ds_read_b64_tr_b16 v[200:201], v248 offset:14464
 ds_read_b64_tr_b16 v[202:203], v248 offset:16000
 s_waitcnt lgkmcnt(8)
 v_mfma_f32_32x32x16_bf16 v[64:79], v[208:211], a[128:131], v[64:79]
 ds_read_b64_tr_b16 v[204:205], v249 offset:14528
 ds_read_b64_tr_b16 v[206:207], v249 offset:16064
 s_waitcnt lgkmcnt(8)
 v_mfma_f32_32x32x16_bf16 v[80:95], v[212:215], a[128:131], v[80:95]
 ds_read_b64_tr_b16 v[208:209], v248 offset:14592
 ds_read_b64_tr_b16 v[210:211], v248 offset:16128
 s_waitcnt lgkmcnt(8)
 v_mfma_f32_32x32x16_bf16 v[0:15], v[192:195], a[132:135], v[0:15]
 ds_read_b64_tr_b16 v[212:213], v249 offset:14656
 ds_read_b64_tr_b16 v[214:215], v249 offset:16192
 s_waitcnt lgkmcnt(8)
 v_mfma_f32_32x32x16_bf16 v[16:31], v[196:199], a[132:135], v[16:31]
 ds_read_b64_tr_b16 v[192:193], v248 offset:20480
 ds_read_b64_tr_b16 v[194:195], v248 offset:22016
 s_waitcnt lgkmcnt(8)
 v_mfma_f32_32x32x16_bf16 v[32:47], v[200:203], a[132:135], v[32:47]
 ds_read_b64_tr_b16 v[196:197], v249 offset:20544
 ds_read_b64_tr_b16 v[198:199], v249 offset:22080
 s_waitcnt lgkmcnt(8)
 v_mfma_f32_32x32x16_bf16 v[48:63], v[204:207], a[132:135], v[48:63]
 ds_read_b64_tr_b16 v[200:201], v248 offset:20608
 ds_read_b64_tr_b16 v[202:203], v248 offset:22144
 s_waitcnt lgkmcnt(8)
 v_mfma_f32_32x32x16_bf16 v[64:79], v[208:211], a[132:135], v[64:79]
 ds_read_b64_tr_b16 v[204:205], v249 offset:20672
 ds_read_b64_tr_b16 v[206:207], v249 offset:22208
 s_waitcnt lgkmcnt(8)
 v_mfma_f32_32x32x16_bf16 v[80:95], v[212:215], a[132:135], v[80:95]
 ds_read_b64_tr_b16 v[208:209], v248 offset:20736
 ds_read_b64_tr_b16 v[210:211], v248 offset:22272
 s_waitcnt lgkmcnt(8)
 v_mfma_f32_32x32x16_bf16 v[0:15], v[192:195], a[136:139], v[0:15]
 ds_read_b64_tr_b16 v[212:213], v249 offset:20800
 ds_read_b64_tr_b16 v[214:215], v249 offset:22336
 s_waitcnt lgkmcnt(8)
 v_mfma_f32_32x32x16_bf16 v[16:31], v[196:199], a[136:139], v[16:31]
 ds_read_b64_tr_b16 v[192:193], v248 offset:26624
 ds_read_b64_tr_b16 v[194:195], v248 offset:28160
 s_waitcnt lgkmcnt(8)
 v_mfma_f32_32x32x16_bf16 v[32:47], v[200:203], a[136:139], v[32:47]
 ds_read_b64_tr_b16 v[196:197], v249 offset:26688
 ds_read_b64_tr_b16 v[198:199], v249 offset:28224
 s_waitcnt lgkmcnt(8)
 v_mfma_f32_32x32x16_bf16 v[48:63], v[204:207], a[136:139], v[48:63]
 ds_read_b64_tr_b16 v[200:201], v248 offset:26752
 ds_read_b64_tr_b16 v[202:203], v248 offset:28288
 s_waitcnt lgkmcnt(8)
 v_mfma_f32_32x32x16_bf16 v[64:79], v[208:211], a[136:139], v[64:79]
 ds_read_b64_tr_b16 v[204:205], v249 offset:26816
 ds_read_b64_tr_b16 v[206:207], v249 offset:28352
 s_waitcnt lgkmcnt(8)
 v_mfma_f32_32x32x16_bf16 v[80:95], v[212:215], a[136:139], v[80:95]
 ds_read_b64_tr_b16 v[208:209], v248 offset:26880
 ds_read_b64_tr_b16 v[210:211], v248 offset:28416
 s_waitcnt lgkmcnt(8)
 v_mfma_f32_32x32x16_bf16 v[0:15], v[192:195], a[140:143], v[0:15]
 ds_read_b64_tr_b16 v[212:213], v249 offset:26944
 ds_read_b64_tr_b16 v[214:215], v249 offset:28480
 s_waitcnt lgkmcnt(8)
 v_mfma_f32_32x32x16_bf16 v[16:31], v[196:199], a[140:143], v[16:31]
 ds_read_b64_tr_b16 v[192:193], v248 offset:32768
 ds_read_b64_tr_b16 v[194:195], v248 offset:34304
 s_waitcnt lgkmcnt(8)
 v_mfma_f32_32x32x16_bf16 v[32:47], v[200:203], a[140:143], v[32:47]
 ds_read_b64_tr_b16 v[196:197], v249 offset:32832
 ds_read_b64_tr_b16 v[198:199], v249 offset:34368
 s_waitcnt lgkmcnt(8)
 v_mfma_f32_32x32x16_bf16 v[48:63], v[204:207], a[140:143], v[48:63]
 ds_read_b64_tr_b16 v[200:201], v248 offset:32896
 ds_read_b64_tr_b16 v[202:203], v248 offset:34432
 s_waitcnt lgkmcnt(8)
 v_mfma_f32_32x32x16_bf16 v[64:79], v[208:211], a[140:143], v[64:79]
 ds_read_b64_tr_b16 v[204:205], v249 offset:32960
 ds_read_b64_tr_b16 v[206:207], v249 offset:34496
 s_waitcnt lgkmcnt(8)
 v_mfma_f32_32x32x16_bf16 v[80:95], v[212:215], a[140:143], v[80:95]
 s_waitcnt vmcnt(12)
 s_barrier
 ds_read_b64_tr_b16 v[208:209], v248 offset:33024
 ds_read_b64_tr_b16 v[210:211], v248 offset:34560
 s_waitcnt lgkmcnt(8)
 v_mfma_f32_32x32x16_bf16 v[0:15], v[192:195], a[144:147], v[0:15]
 ds_read_b64_tr_b16 v[212:213], v249 offset:33088
 ds_read_b64_tr_b16 v[214:215], v249 offset:34624
 s_waitcnt lgkmcnt(8)
 v_mfma_f32_32x32x16_bf16 v[16:31], v[196:199], a[144:147], v[16:31]
 s_add_u32 m0, s19, 73728
 s_add_u32 s29, s55, 384
 buffer_load_dwordx4 v239, s[36:39], s29 offen lds
 s_add_u32 m0, s19, 74752
 s_add_u32 s29, s55, 10624
 buffer_load_dwordx4 v239, s[36:39], s29 offen lds
 s_add_u32 m0, s19, 75776
 s_add_u32 s29, s55, 20864
 buffer_load_dwordx4 v239, s[36:39], s29 offen lds
 s_add_u32 m0, s19, 76800
 s_add_u32 s29, s55, 31104
 buffer_load_dwordx4 v239, s[36:39], s29 offen lds
 s_add_u32 m0, s19, 77824
 s_add_u32 s29, s55, 41344
 buffer_load_dwordx4 v239, s[36:39], s29 offen lds
 s_add_u32 m0, s19, 78848
 s_add_u32 s29, s55, 51584
 buffer_load_dwordx4 v239, s[36:39], s29 offen lds
 ds_read_b64_tr_b16 v[192:193], v248 offset:38912
 ds_read_b64_tr_b16 v[194:195], v248 offset:40448
 s_waitcnt lgkmcnt(8)
 v_mfma_f32_32x32x16_bf16 v[32:47], v[200:203], a[144:147], v[32:47]
 ds_read_b64_tr_b16 v[196:197], v249 offset:38976
 ds_read_b64_tr_b16 v[198:199], v249 offset:40512
 s_waitcnt lgkmcnt(8)
 v_mfma_f32_32x32x16_bf16 v[48:63], v[204:207], a[144:147], v[48:63]
 ds_read_b64_tr_b16 v[200:201], v248 offset:39040
 ds_read_b64_tr_b16 v[202:203], v248 offset:40576
 s_waitcnt lgkmcnt(8)
 v_mfma_f32_32x32x16_bf16 v[64:79], v[208:211], a[144:147], v[64:79]
 ds_read_b64_tr_b16 v[204:205], v249 offset:39104
 ds_read_b64_tr_b16 v[206:207], v249 offset:40640
 s_waitcnt lgkmcnt(8)
 v_mfma_f32_32x32x16_bf16 v[80:95], v[212:215], a[144:147], v[80:95]
 ds_read_b64_tr_b16 v[208:209], v248 offset:39168
 ds_read_b64_tr_b16 v[210:211], v248 offset:40704
 s_waitcnt lgkmcnt(8)
 v_mfma_f32_32x32x16_bf16 v[0:15], v[192:195], a[148:151], v[0:15]
 ds_read_b64_tr_b16 v[212:213], v249 offset:39232
 ds_read_b64_tr_b16 v[214:215], v249 offset:40768
 s_waitcnt lgkmcnt(8)
 v_mfma_f32_32x32x16_bf16 v[16:31], v[196:199], a[148:151], v[16:31]
 ds_read_b64_tr_b16 v[192:193], v248 offset:45056
 ds_read_b64_tr_b16 v[194:195], v248 offset:46592
 s_waitcnt lgkmcnt(8)
 v_mfma_f32_32x32x16_bf16 v[32:47], v[200:203], a[148:151], v[32:47]
 ds_read_b64_tr_b16 v[196:197], v249 offset:45120
 ds_read_b64_tr_b16 v[198:199], v249 offset:46656
 s_waitcnt lgkmcnt(8)
 v_mfma_f32_32x32x16_bf16 v[48:63], v[204:207], a[148:151], v[48:63]
 ds_read_b64_tr_b16 v[200:201], v248 offset:45184
 ds_read_b64_tr_b16 v[202:203], v248 offset:46720
 s_waitcnt lgkmcnt(8)
 v_mfma_f32_32x32x16_bf16 v[64:79], v[208:211], a[148:151], v[64:79]
 ds_read_b64_tr_b16 v[204:205], v249 offset:45248
 ds_read_b64_tr_b16 v[206:207], v249 offset:46784
 s_waitcnt lgkmcnt(8)
 v_mfma_f32_32x32x16_bf16 v[80:95], v[212:215], a[148:151], v[80:95]
 ds_read_b64_tr_b16 v[208:209], v248 offset:45312
 ds_read_b64_tr_b16 v[210:211], v248 offset:46848
 s_waitcnt lgkmcnt(8)
 v_mfma_f32_32x32x16_bf16 v[0:15], v[192:195], a[152:155], v[0:15]
 ds_read_b64_tr_b16 v[212:213], v249 offset:45376
 ds_read_b64_tr_b16 v[214:215], v249 offset:46912
 s_waitcnt lgkmcnt(8)
 v_mfma_f32_32x32x16_bf16 v[16:31], v[196:199], a[152:155], v[16:31]
 ds_read_b64_tr_b16 v[192:193], v248 offset:51200
 ds_read_b64_tr_b16 v[194:195], v248 offset:52736
 s_waitcnt lgkmcnt(8)
 v_mfma_f32_32x32x16_bf16 v[32:47], v[200:203], a[152:155], v[32:47]
 ds_read_b64_tr_b16 v[196:197], v249 offset:51264
 ds_read_b64_tr_b16 v[198:199], v249 offset:52800
 s_waitcnt lgkmcnt(8)
 v_mfma_f32_32x32x16_bf16 v[48:63], v[204:207], a[152:155], v[48:63]
 ds_read_b64_tr_b16 v[200:201], v248 offset:51328
 ds_read_b64_tr_b16 v[202:203], v248 offset:52864
 s_waitcnt lgkmcnt(8)
 v_mfma_f32_32x32x16_bf16 v[64:79], v[208:211], a[152:155], v[64:79]
 ds_read_b64_tr_b16 v[204:205], v249 offset:51392
 ds_read_b64_tr_b16 v[206:207], v249 offset:52928
 s_waitcnt lgkmcnt(8)
 v_mfma_f32_32x32x16_bf16 v[80:95], v[212:215], a[152:155], v[80:95]
 ds_read_b64_tr_b16 v[208:209], v248 offset:51456
 ds_read_b64_tr_b16 v[210:211], v248 offset:52992
 s_waitcnt lgkmcnt(8)
 v_mfma_f32_32x32x16_bf16 v[0:15], v[192:195], a[156:159], v[0:15]
 ds_read_b64_tr_b16 v[212:213], v249 offset:51520
 ds_read_b64_tr_b16 v[214:215], v249 offset:53056
 s_waitcnt lgkmcnt(8)
 v_mfma_f32_32x32x16_bf16 v[16:31], v[196:199], a[156:159], v[16:31]
 ds_read_b64_tr_b16 v[192:193], v242 offset:0
 ds_read_b64_tr_b16 v[194:195], v242 offset:1024
 s_waitcnt lgkmcnt(8)
 v_mfma_f32_32x32x16_bf16 v[32:47], v[200:203], a[156:159], v[32:47]
 ds_read_b64_tr_b16 v[196:197], v243 offset:64
 ds_read_b64_tr_b16 v[198:199], v243 offset:1088
 s_waitcnt lgkmcnt(8)
 v_mfma_f32_32x32x16_bf16 v[48:63], v[204:207], a[156:159], v[48:63]
 ds_read_b64_tr_b16 v[200:201], v242 offset:2048
 ds_read_b64_tr_b16 v[202:203], v242 offset:3072
 s_waitcnt lgkmcnt(8)
 v_mfma_f32_32x32x16_bf16 v[64:79], v[208:211], a[156:159], v[64:79]
 ds_read_b64_tr_b16 v[204:205], v243 offset:2112
 ds_read_b64_tr_b16 v[206:207], v243 offset:3136
 s_waitcnt lgkmcnt(8)
 v_mfma_f32_32x32x16_bf16 v[80:95], v[212:215], a[156:159], v[80:95]
 s_waitcnt vmcnt(12)
 s_barrier
 ds_read_b64_tr_b16 v[208:209], v242 offset:4096
 ds_read_b64_tr_b16 v[210:211], v242 offset:5120
 s_nop 15
 v_cvt_pk_bf16_f32 v96, v0, v1
 v_cvt_pk_bf16_f32 v97, v2, v3
 v_cvt_pk_bf16_f32 v98, v4, v5
 v_cvt_pk_bf16_f32 v99, v6, v7
 v_cvt_pk_bf16_f32 v100, v8, v9
 v_cvt_pk_bf16_f32 v101, v10, v11
 v_cvt_pk_bf16_f32 v102, v12, v13
 v_cvt_pk_bf16_f32 v103, v14, v15
 v_cvt_pk_bf16_f32 v104, v16, v17
 v_cvt_pk_bf16_f32 v105, v18, v19
 v_cvt_pk_bf16_f32 v106, v20, v21
 v_cvt_pk_bf16_f32 v107, v22, v23
 v_cvt_pk_bf16_f32 v108, v24, v25
 v_cvt_pk_bf16_f32 v109, v26, v27
 v_cvt_pk_bf16_f32 v110, v28, v29
 v_cvt_pk_bf16_f32 v111, v30, v31
 v_cvt_pk_bf16_f32 v112, v32, v33
 v_cvt_pk_bf16_f32 v113, v34, v35
 v_cvt_pk_bf16_f32 v114, v36, v37
 v_cvt_pk_bf16_f32 v115, v38, v39
 v_cvt_pk_bf16_f32 v116, v40, v41
 v_cvt_pk_bf16_f32 v117, v42, v43
 v_cvt_pk_bf16_f32 v118, v44, v45
 v_cvt_pk_bf16_f32 v119, v46, v47
 v_cvt_pk_bf16_f32 v120, v48, v49
 v_cvt_pk_bf16_f32 v121, v50, v51
 v_cvt_pk_bf16_f32 v122, v52, v53
 v_cvt_pk_bf16_f32 v123, v54, v55
 v_cvt_pk_bf16_f32 v124, v56, v57
 v_cvt_pk_bf16_f32 v125, v58, v59
 v_cvt_pk_bf16_f32 v126, v60, v61
 v_cvt_pk_bf16_f32 v127, v62, v63
 v_cvt_pk_bf16_f32 v128, v64, v65
 v_cvt_pk_bf16_f32 v129, v66, v67
 v_cvt_pk_bf16_f32 v130, v68, v69
 v_cvt_pk_bf16_f32 v131, v70, v71
 v_cvt_pk_bf16_f32 v132, v72, v73
 v_cvt_pk_bf16_f32 v133, v74, v75
 v_cvt_pk_bf16_f32 v134, v76, v77
 v_cvt_pk_bf16_f32 v135, v78, v79
 v_cvt_pk_bf16_f32 v136, v80, v81
 v_cvt_pk_bf16_f32 v137, v82, v83
 v_cvt_pk_bf16_f32 v138, v84, v85
 v_cvt_pk_bf16_f32 v139, v86, v87
 v_cvt_pk_bf16_f32 v140, v88, v89
 v_cvt_pk_bf16_f32 v141, v90, v91
 v_cvt_pk_bf16_f32 v142, v92, v93
 v_cvt_pk_bf16_f32 v143, v94, v95
 s_nop 1
 s_waitcnt lgkmcnt(8)
 v_mfma_f32_32x32x16_bf16 v[0:15], v[96:99], v[192:195], 0
 ds_read_b64_tr_b16 v[212:213], v243 offset:4160
 ds_read_b64_tr_b16 v[214:215], v243 offset:5184
 s_waitcnt lgkmcnt(8)
 v_mfma_f32_32x32x16_bf16 v[16:31], v[96:99], v[196:199], 0
 s_add_u32 m0, s19, 98304
 s_add_u32 s29, s55, 512
 buffer_load_dwordx4 v239, s[36:39], s29 offen lds
 s_add_u32 m0, s19, 99328
 s_add_u32 s29, s55, 10752
 buffer_load_dwordx4 v239, s[36:39], s29 offen lds
 s_add_u32 m0, s19, 100352
 s_add_u32 s29, s55, 20992
 buffer_load_dwordx4 v239, s[36:39], s29 offen lds
 s_add_u32 m0, s19, 101376
 s_add_u32 s29, s55, 31232
 buffer_load_dwordx4 v239, s[36:39], s29 offen lds
 s_add_u32 m0, s19, 102400
 s_add_u32 s29, s55, 41472
 buffer_load_dwordx4 v239, s[36:39], s29 offen lds
 s_add_u32 m0, s19, 103424
 s_add_u32 s29, s55, 51712
 buffer_load_dwordx4 v239, s[36:39], s29 offen lds
 ds_read_b64_tr_b16 v[192:193], v242 offset:6144
 ds_read_b64_tr_b16 v[194:195], v242 offset:7168
 s_waitcnt lgkmcnt(8)
 v_mfma_f32_32x32x16_bf16 v[0:15], v[100:103], v[200:203], v[0:15]
 ds_read_b64_tr_b16 v[196:197], v243 offset:6208
 ds_read_b64_tr_b16 v[198:199], v243 offset:7232
 s_waitcnt lgkmcnt(8)
 v_mfma_f32_32x32x16_bf16 v[16:31], v[100:103], v[204:207], v[16:31]
 ds_read_b64_tr_b16 v[200:201], v242 offset:8192
 ds_read_b64_tr_b16 v[202:203], v242 offset:9216
 s_waitcnt lgkmcnt(8)
 v_mfma_f32_32x32x16_bf16 v[0:15], v[104:107], v[208:211], v[0:15]
 ds_read_b64_tr_b16 v[204:205], v243 offset:8256
 ds_read_b64_tr_b16 v[206:207], v243 offset:9280
 s_waitcnt lgkmcnt(8)
 v_mfma_f32_32x32x16_bf16 v[16:31], v[104:107], v[212:215], v[16:31]
 ds_read_b64_tr_b16 v[208:209], v242 offset:10240
 ds_read_b64_tr_b16 v[210:211], v242 offset:11264
 s_waitcnt lgkmcnt(8)
 v_mfma_f32_32x32x16_bf16 v[0:15], v[108:111], v[192:195], v[0:15]
 ds_read_b64_tr_b16 v[212:213], v243 offset:10304
 ds_read_b64_tr_b16 v[214:215], v243 offset:11328
 s_waitcnt lgkmcnt(8)
 v_mfma_f32_32x32x16_bf16 v[16:31], v[108:111], v[196:199], v[16:31]
 ds_read_b64_tr_b16 v[192:193], v242 offset:12288
 ds_read_b64_tr_b16 v[194:195], v242 offset:13312
 s_waitcnt lgkmcnt(8)
 v_mfma_f32_32x32x16_bf16 v[0:15], v[112:115], v[200:203], v[0:15]
 ds_read_b64_tr_b16 v[196:197], v243 offset:12352
 ds_read_b64_tr_b16 v[198:199], v243 offset:13376
 s_waitcnt lgkmcnt(8)
 v_mfma_f32_32x32x16_bf16 v[16:31], v[112:115], v[204:207], v[16:31]
 ds_read_b64_tr_b16 v[200:201], v242 offset:14336
 ds_read_b64_tr_b16 v[202:203], v242 offset:15360
 s_waitcnt lgkmcnt(8)
 v_mfma_f32_32x32x16_bf16 v[0:15], v[116:119], v[208:211], v[0:15]
 ds_read_b64_tr_b16 v[204:205], v243 offset:14400
 ds_read_b64_tr_b16 v[206:207], v243 offset:15424
 s_waitcnt lgkmcnt(8)
 v_mfma_f32_32x32x16_bf16 v[16:31], v[116:119], v[212:215], v[16:31]
 ds_read_b64_tr_b16 v[208:209], v242 offset:16384
 ds_read_b64_tr_b16 v[210:211], v242 offset:17408
 s_waitcnt lgkmcnt(8)
 v_mfma_f32_32x32x16_bf16 v[0:15], v[120:123], v[192:195], v[0:15]
 ds_read_b64_tr_b16 v[212:213], v243 offset:16448
 ds_read_b64_tr_b16 v[214:215], v243 offset:17472
 s_waitcnt lgkmcnt(8)
 v_mfma_f32_32x32x16_bf16 v[16:31], v[120:123], v[196:199], v[16:31]
 ds_read_b64_tr_b16 v[192:193], v242 offset:18432
 ds_read_b64_tr_b16 v[194:195], v242 offset:19456
 s_waitcnt lgkmcnt(8)
 v_mfma_f32_32x32x16_bf16 v[0:15], v[124:127], v[200:203], v[0:15]
 ds_read_b64_tr_b16 v[196:197], v243 offset:18496
 ds_read_b64_tr_b16 v[198:199], v243 offset:19520
 s_waitcnt lgkmcnt(8)
 v_mfma_f32_32x32x16_bf16 v[16:31], v[124:127], v[204:207], v[16:31]
 ds_read_b64_tr_b16 v[200:201], v242 offset:20480
 ds_read_b64_tr_b16 v[202:203], v242 offset:21504
 s_waitcnt lgkmcnt(8)
 v_mfma_f32_32x32x16_bf16 v[0:15], v[128:131], v[208:211], v[0:15]
 ds_read_b64_tr_b16 v[204:205], v243 offset:20544
 ds_read_b64_tr_b16 v[206:207], v243 offset:21568
 s_waitcnt lgkmcnt(8)
 v_mfma_f32_32x32x16_bf16 v[16:31], v[128:131], v[212:215], v[16:31]
 ds_read_b64_tr_b16 v[208:209], v242 offset:22528
 ds_read_b64_tr_b16 v[210:211], v242 offset:23552
 s_waitcnt lgkmcnt(8)
 v_mfma_f32_32x32x16_bf16 v[0:15], v[132:135], v[192:195], v[0:15]
 ds_read_b64_tr_b16 v[212:213], v243 offset:22592
 ds_read_b64_tr_b16 v[214:215], v243 offset:23616
 s_waitcnt lgkmcnt(8)
 v_mfma_f32_32x32x16_bf16 v[16:31], v[132:135], v[196:199], v[16:31]
 ds_read_b64_tr_b16 v[192:193], v242 offset:24576
 ds_read_b64_tr_b16 v[194:195], v242 offset:25600
 s_waitcnt lgkmcnt(8)
 v_mfma_f32_32x32x16_bf16 v[0:15], v[136:139], v[200:203], v[0:15]
 ds_read_b64_tr_b16 v[196:197], v243 offset:24640
 ds_read_b64_tr_b16 v[198:199], v243 offset:25664
 s_waitcnt lgkmcnt(8)
 v_mfma_f32_32x32x16_bf16 v[16:31], v[136:139], v[204:207], v[16:31]
 ds_read_b64_tr_b16 v[200:201], v242 offset:26624
 ds_read_b64_tr_b16 v[202:203], v242 offset:27648
 s_waitcnt lgkmcnt(8)
 v_mfma_f32_32x32x16_bf16 v[0:15], v[140:143], v[208:211], v[0:15]
 ds_read_b64_tr_b16 v[204:205], v243 offset:26688
 ds_read_b64_tr_b16 v[206:207], v243 offset:27712
 s_waitcnt lgkmcnt(8)
 v_mfma_f32_32x32x16_bf16 v[16:31], v[140:143], v[212:215], v[16:31]
 s_waitcnt vmcnt(12)
 s_barrier
 ds_read_b64_tr_b16 v[208:209], v242 offset:28672
 ds_read_b64_tr_b16 v[210:211], v242 offset:29696
 s_waitcnt lgkmcnt(8)
 v_mfma_f32_32x32x16_bf16 v[32:47], v[96:99], v[192:195], 0
 ds_read_b64_tr_b16 v[212:213], v243 offset:28736
 ds_read_b64_tr_b16 v[214:215], v243 offset:29760
 s_waitcnt lgkmcnt(8)
 v_mfma_f32_32x32x16_bf16 v[48:63], v[96:99], v[196:199], 0
 s_add_u32 m0, s19, 0
 s_add_u32 s29, s55, 640
 buffer_load_dwordx4 v239, s[36:39], s29 offen lds
 s_add_u32 m0, s19, 1024
 s_add_u32 s29, s55, 10880
 buffer_load_dwordx4 v239, s[36:39], s29 offen lds
 s_add_u32 m0, s19, 2048
 s_add_u32 s29, s55, 21120
 buffer_load_dwordx4 v239, s[36:39], s29 offen lds
 s_add_u32 m0, s19, 3072
 s_add_u32 s29, s55, 31360
 buffer_load_dwordx4 v239, s[36:39], s29 offen lds
 s_add_u32 m0, s19, 4096
 s_add_u32 s29, s55, 41600
 buffer_load_dwordx4 v239, s[36:39], s29 offen lds
 s_add_u32 m0, s19, 5120
 s_add_u32 s29, s55, 51840
 buffer_load_dwordx4 v239, s[36:39], s29 offen lds
 ds_read_b64_tr_b16 v[192:193], v242 offset:30720
 ds_read_b64_tr_b16 v[194:195], v242 offset:31744
 s_waitcnt lgkmcnt(8)
 v_mfma_f32_32x32x16_bf16 v[32:47], v[100:103], v[200:203], v[32:47]
 ds_read_b64_tr_b16 v[196:197], v243 offset:30784
 ds_read_b64_tr_b16 v[198:199], v243 offset:31808
 s_waitcnt lgkmcnt(8)
 v_mfma_f32_32x32x16_bf16 v[48:63], v[100:103], v[204:207], v[48:63]
 ds_read_b64_tr_b16 v[200:201], v242 offset:32768
 ds_read_b64_tr_b16 v[202:203], v242 offset:33792
 s_waitcnt lgkmcnt(8)
 v_mfma_f32_32x32x16_bf16 v[32:47], v[104:107], v[208:211], v[32:47]
 ds_read_b64_tr_b16 v[204:205], v243 offset:32832
 ds_read_b64_tr_b16 v[206:207], v243 offset:33856
 s_waitcnt lgkmcnt(8)
 v_mfma_f32_32x32x16_bf16 v[48:63], v[104:107], v[212:215], v[48:63]
 ds_read_b64_tr_b16 v[208:209], v242 offset:34816
 ds_read_b64_tr_b16 v[210:211], v242 offset:35840
 s_waitcnt lgkmcnt(8)
 v_mfma_f32_32x32x16_bf16 v[32:47], v[108:111], v[192:195], v[32:47]
 v_cvt_pk_bf16_f32 v216, v0, v1
 v_cvt_pk_bf16_f32 v217, v2, v3
 v_cvt_pk_bf16_f32 v218, v4, v5
 ds_read_b64_tr_b16 v[212:213], v243 offset:34880
 ds_read_b64_tr_b16 v[214:215], v243 offset:35904
 s_waitcnt lgkmcnt(8)
 v_mfma_f32_32x32x16_bf16 v[48:63], v[108:111], v[196:199], v[48:63]
 ds_read_b64_tr_b16 v[192:193], v242 offset:36864
 ds_read_b64_tr_b16 v[194:195], v242 offset:37888
 s_waitcnt lgkmcnt(8)
 v_mfma_f32_32x32x16_bf16 v[32:47], v[112:115], v[200:203], v[32:47]
 v_cvt_pk_bf16_f32 v219, v6, v7
 v_cvt_pk_bf16_f32 v220, v8, v9
 v_cvt_pk_bf16_f32 v221, v10, v11
 ds_read_b64_tr_b16 v[196:197], v243 offset:36928
 ds_read_b64_tr_b16 v[198:199], v243 offset:37952
 s_waitcnt lgkmcnt(8)
 v_mfma_f32_32x32x16_bf16 v[48:63], v[112:115], v[204:207], v[48:63]
 ds_read_b64_tr_b16 v[200:201], v242 offset:38912
 ds_read_b64_tr_b16 v[202:203], v242 offset:39936
 s_waitcnt lgkmcnt(8)
 v_mfma_f32_32x32x16_bf16 v[32:47], v[116:119], v[208:211], v[32:47]
 v_cvt_pk_bf16_f32 v222, v12, v13
 v_cvt_pk_bf16_f32 v223, v14, v15
 buffer_store_dwordx4 v[216:219], v244, s[8:11], s53 offen offset:0 sc1
 ds_read_b64_tr_b16 v[204:205], v243 offset:38976
 ds_read_b64_tr_b16 v[206:207], v243 offset:40000
 s_waitcnt lgkmcnt(8)
 v_mfma_f32_32x32x16_bf16 v[48:63], v[116:119], v[212:215], v[48:63]
 ds_read_b64_tr_b16 v[208:209], v242 offset:40960
 ds_read_b64_tr_b16 v[210:211], v242 offset:41984
 s_waitcnt lgkmcnt(8)
 v_mfma_f32_32x32x16_bf16 v[32:47], v[120:123], v[192:195], v[32:47]
 buffer_store_dwordx4 v[220:223], v244, s[8:11], s53 offen offset:1024 sc1
 v_cvt_pk_bf16_f32 v224, v16, v17
 v_cvt_pk_bf16_f32 v225, v18, v19
 ds_read_b64_tr_b16 v[212:213], v243 offset:41024
 ds_read_b64_tr_b16 v[214:215], v243 offset:42048
 s_waitcnt lgkmcnt(8)
 v_mfma_f32_32x32x16_bf16 v[48:63], v[120:123], v[196:199], v[48:63]
 ds_read_b64_tr_b16 v[192:193], v242 offset:43008
 ds_read_b64_tr_b16 v[194:195], v242 offset:44032
 s_waitcnt lgkmcnt(8)
 v_mfma_f32_32x32x16_bf16 v[32:47], v[124:127], v[200:203], v[32:47]
 v_cvt_pk_bf16_f32 v226, v20, v21
 v_cvt_pk_bf16_f32 v227, v22, v23
 v_cvt_pk_bf16_f32 v228, v24, v25
 ds_read_b64_tr_b16 v[196:197], v243 offset:43072
 ds_read_b64_tr_b16 v[198:199], v243 offset:44096
 s_waitcnt lgkmcnt(8)
 v_mfma_f32_32x32x16_bf16 v[48:63], v[124:127], v[204:207], v[48:63]
 ds_read_b64_tr_b16 v[200:201], v242 offset:45056
 ds_read_b64_tr_b16 v[202:203], v242 offset:46080
 s_waitcnt lgkmcnt(8)
 v_mfma_f32_32x32x16_bf16 v[32:47], v[128:131], v[208:211], v[32:47]
 v_cvt_pk_bf16_f32 v229, v26, v27
 v_cvt_pk_bf16_f32 v230, v28, v29
 v_cvt_pk_bf16_f32 v231, v30, v31
 ds_read_b64_tr_b16 v[204:205], v243 offset:45120
 ds_read_b64_tr_b16 v[206:207], v243 offset:46144
 s_waitcnt lgkmcnt(8)
 v_mfma_f32_32x32x16_bf16 v[48:63], v[128:131], v[212:215], v[48:63]
 ds_read_b64_tr_b16 v[208:209], v242 offset:47104
 ds_read_b64_tr_b16 v[210:211], v242 offset:48128
 s_waitcnt lgkmcnt(8)
 v_mfma_f32_32x32x16_bf16 v[32:47], v[132:135], v[192:195], v[32:47]
 buffer_store_dwordx4 v[224:227], v244, s[8:11], s53 offen offset:2048 sc1
 buffer_store_dwordx4 v[228:231], v244, s[8:11], s53 offen offset:3072 sc1
 s_add_u32 s53, s53, 4096
 ds_read_b64_tr_b16 v[212:213], v243 offset:47168
 ds_read_b64_tr_b16 v[214:215], v243 offset:48192
 s_waitcnt lgkmcnt(8)
 v_mfma_f32_32x32x16_bf16 v[48:63], v[132:135], v[196:199], v[48:63]
 ds_read_b64_tr_b16 v[192:193], v242 offset:49152
 ds_read_b64_tr_b16 v[194:195], v242 offset:50176
 s_waitcnt lgkmcnt(8)
 v_mfma_f32_32x32x16_bf16 v[32:47], v[136:139], v[200:203], v[32:47]
 ds_read_b64_tr_b16 v[196:197], v243 offset:49216
 ds_read_b64_tr_b16 v[198:199], v243 offset:50240
 s_waitcnt lgkmcnt(8)
 v_mfma_f32_32x32x16_bf16 v[48:63], v[136:139], v[204:207], v[48:63]
 ds_read_b64_tr_b16 v[200:201], v242 offset:51200
 ds_read_b64_tr_b16 v[202:203], v242 offset:52224
 s_waitcnt lgkmcnt(8)
 v_mfma_f32_32x32x16_bf16 v[32:47], v[140:143], v[208:211], v[32:47]
 ds_read_b64_tr_b16 v[204:205], v243 offset:51264
 ds_read_b64_tr_b16 v[206:207], v243 offset:52288
 s_waitcnt lgkmcnt(8)
 v_mfma_f32_32x32x16_bf16 v[48:63], v[140:143], v[212:215], v[48:63]
 s_waitcnt vmcnt(16)
 s_barrier
 ds_read_b64_tr_b16 v[208:209], v242 offset:53248
 ds_read_b64_tr_b16 v[210:211], v242 offset:54272
 s_waitcnt lgkmcnt(8)
 v_mfma_f32_32x32x16_bf16 v[0:15], v[96:99], v[192:195], 0
 ds_read_b64_tr_b16 v[212:213], v243 offset:53312
 ds_read_b64_tr_b16 v[214:215], v243 offset:54336
 s_waitcnt lgkmcnt(8)
 v_mfma_f32_32x32x16_bf16 v[16:31], v[96:99], v[196:199], 0
 s_add_u32 m0, s19, 24576
 s_add_u32 s29, s55, 768
 buffer_load_dwordx4 v239, s[36:39], s29 offen lds
 s_add_u32 m0, s19, 25600
 s_add_u32 s29, s55, 11008
 buffer_load_dwordx4 v239, s[36:39], s29 offen lds
 s_add_u32 m0, s19, 26624
 s_add_u32 s29, s55, 21248
 buffer_load_dwordx4 v239, s[36:39], s29 offen lds
 s_add_u32 m0, s19, 27648
 s_add_u32 s29, s55, 31488
 buffer_load_dwordx4 v239, s[36:39], s29 offen lds
 s_add_u32 m0, s19, 28672
 s_add_u32 s29, s55, 41728
 buffer_load_dwordx4 v239, s[36:39], s29 offen lds
 s_add_u32 m0, s19, 29696
 s_add_u32 s29, s55, 51968
 buffer_load_dwordx4 v239, s[36:39], s29 offen lds
 ds_read_b64_tr_b16 v[192:193], v242 offset:55296
 ds_read_b64_tr_b16 v[194:195], v242 offset:56320
 s_waitcnt lgkmcnt(8)
 v_mfma_f32_32x32x16_bf16 v[0:15], v[100:103], v[200:203], v[0:15]
 ds_read_b64_tr_b16 v[196:197], v243 offset:55360
 ds_read_b64_tr_b16 v[198:199], v243 offset:56384
 s_waitcnt lgkmcnt(8)
 v_mfma_f32_32x32x16_bf16 v[16:31], v[100:103], v[204:207], v[16:31]
 ds_read_b64_tr_b16 v[200:201], v242 offset:57344
 ds_read_b64_tr_b16 v[202:203], v242 offset:58368
 s_waitcnt lgkmcnt(8)
 v_mfma_f32_32x32x16_bf16 v[0:15], v[104:107], v[208:211], v[0:15]
 ds_read_b64_tr_b16 v[204:205], v243 offset:57408
 ds_read_b64_tr_b16 v[206:207], v243 offset:58432
 s_waitcnt lgkmcnt(8)
 v_mfma_f32_32x32x16_bf16 v[16:31], v[104:107], v[212:215], v[16:31]
 ds_read_b64_tr_b16 v[208:209], v242 offset:59392
 ds_read_b64_tr_b16 v[210:211], v242 offset:60416
 s_waitcnt lgkmcnt(8)
 v_mfma_f32_32x32x16_bf16 v[0:15], v[108:111], v[192:195], v[0:15]
 v_cvt_pk_bf16_f32 v216, v32, v33
 v_cvt_pk_bf16_f32 v217, v34, v35
 v_cvt_pk_bf16_f32 v218, v36, v37
 ds_read_b64_tr_b16 v[212:213], v243 offset:59456
 ds_read_b64_tr_b16 v[214:215], v243 offset:60480
 s_waitcnt lgkmcnt(8)
 v_mfma_f32_32x32x16_bf16 v[16:31], v[108:111], v[196:199], v[16:31]
 ds_read_b64_tr_b16 v[192:193], v242 offset:61440
 ds_read_b64_tr_b16 v[194:195], v242 offset:62464
 s_waitcnt lgkmcnt(8)
 v_mfma_f32_32x32x16_bf16 v[0:15], v[112:115], v[200:203], v[0:15]
 v_cvt_pk_bf16_f32 v219, v38, v39
 v_cvt_pk_bf16_f32 v220, v40, v41
 v_cvt_pk_bf16_f32 v221, v42, v43
 ds_read_b64_tr_b16 v[196:197], v243 offset:61504
 ds_read_b64_tr_b16 v[198:199], v243 offset:62528
 s_waitcnt lgkmcnt(8)
 v_mfma_f32_32x32x16_bf16 v[16:31], v[112:115], v[204:207], v[16:31]
 ds_read_b64_tr_b16 v[200:201], v242 offset:63488
 ds_read_b64_tr_b16 v[202:203], v242 offset:64512
 s_waitcnt lgkmcnt(8)
 v_mfma_f32_32x32x16_bf16 v[0:15], v[116:119], v[208:211], v[0:15]
 v_cvt_pk_bf16_f32 v222, v44, v45
 v_cvt_pk_bf16_f32 v223, v46, v47
 buffer_store_dwordx4 v[216:219], v244, s[8:11], s53 offen offset:0 sc1
 ds_read_b64_tr_b16 v[204:205], v243 offset:63552
 ds_read_b64_tr_b16 v[206:207], v243 offset:64576
 s_waitcnt lgkmcnt(8)
 v_mfma_f32_32x32x16_bf16 v[16:31], v[116:119], v[212:215], v[16:31]
 ds_read_b64_tr_b16 v[208:209], v250 offset:0
 ds_read_b64_tr_b16 v[210:211], v250 offset:1024
 s_waitcnt lgkmcnt(8)
 v_mfma_f32_32x32x16_bf16 v[0:15], v[120:123], v[192:195], v[0:15]
 buffer_store_dwordx4 v[220:223], v244, s[8:11], s53 offen offset:1024 sc1
 v_cvt_pk_bf16_f32 v224, v48, v49
 v_cvt_pk_bf16_f32 v225, v50, v51
 ds_read_b64_tr_b16 v[212:213], v251 offset:64
 ds_read_b64_tr_b16 v[214:215], v251 offset:1088
 s_waitcnt lgkmcnt(8)
 v_mfma_f32_32x32x16_bf16 v[16:31], v[120:123], v[196:199], v[16:31]
 ds_read_b64_tr_b16 v[192:193], v250 offset:2048
 ds_read_b64_tr_b16 v[194:195], v250 offset:3072
 s_waitcnt lgkmcnt(8)
 v_mfma_f32_32x32x16_bf16 v[0:15], v[124:127], v[200:203], v[0:15]
 v_cvt_pk_bf16_f32 v226, v52, v53
 v_cvt_pk_bf16_f32 v227, v54, v55
 v_cvt_pk_bf16_f32 v228, v56, v57
 ds_read_b64_tr_b16 v[196:197], v251 offset:2112
 ds_read_b64_tr_b16 v[198:199], v251 offset:3136
 s_waitcnt lgkmcnt(8)
 v_mfma_f32_32x32x16_bf16 v[16:31], v[124:127], v[204:207], v[16:31]
 ds_read_b64_tr_b16 v[200:201], v250 offset:4096
 ds_read_b64_tr_b16 v[202:203], v250 offset:5120
 s_waitcnt lgkmcnt(8)
 v_mfma_f32_32x32x16_bf16 v[0:15], v[128:131], v[208:211], v[0:15]
 v_cvt_pk_bf16_f32 v229, v58, v59
 v_cvt_pk_bf16_f32 v230, v60, v61
 v_cvt_pk_bf16_f32 v231, v62, v63
 ds_read_b64_tr_b16 v[204:205], v251 offset:4160
 ds_read_b64_tr_b16 v[206:207], v251 offset:5184
 s_waitcnt lgkmcnt(8)
 v_mfma_f32_32x32x16_bf16 v[16:31], v[128:131], v[212:215], v[16:31]
 ds_read_b64_tr_b16 v[208:209], v250 offset:6144
 ds_read_b64_tr_b16 v[210:211], v250 offset:7168
 s_waitcnt lgkmcnt(8)
 v_mfma_f32_32x32x16_bf16 v[0:15], v[132:135], v[192:195], v[0:15]
 buffer_store_dwordx4 v[224:227], v244, s[8:11], s53 offen offset:2048 sc1
 buffer_store_dwordx4 v[228:231], v244, s[8:11], s53 offen offset:3072 sc1
 s_add_u32 s53, s53, 4096
 ds_read_b64_tr_b16 v[212:213], v251 offset:6208
 ds_read_b64_tr_b16 v[214:215], v251 offset:7232
 s_waitcnt lgkmcnt(8)
 v_mfma_f32_32x32x16_bf16 v[16:31], v[132:135], v[196:199], v[16:31]
 ds_read_b64_tr_b16 v[192:193], v250 offset:8192
 ds_read_b64_tr_b16 v[194:195], v250 offset:9216
 s_waitcnt lgkmcnt(8)
 v_mfma_f32_32x32x16_bf16 v[0:15], v[136:139], v[200:203], v[0:15]
 ds_read_b64_tr_b16 v[196:197], v251 offset:8256
 ds_read_b64_tr_b16 v[198:199], v251 offset:9280
 s_waitcnt lgkmcnt(8)
 v_mfma_f32_32x32x16_bf16 v[16:31], v[136:139], v[204:207], v[16:31]
 ds_read_b64_tr_b16 v[200:201], v250 offset:10240
 ds_read_b64_tr_b16 v[202:203], v250 offset:11264
 s_waitcnt lgkmcnt(8)
 v_mfma_f32_32x32x16_bf16 v[0:15], v[140:143], v[208:211], v[0:15]
 ds_read_b64_tr_b16 v[204:205], v251 offset:10304
 ds_read_b64_tr_b16 v[206:207], v251 offset:11328
 s_waitcnt lgkmcnt(8)
 v_mfma_f32_32x32x16_bf16 v[16:31], v[140:143], v[212:215], v[16:31]
 s_waitcnt vmcnt(20)
 s_barrier
 ds_read_b64_tr_b16 v[208:209], v250 offset:12288
 ds_read_b64_tr_b16 v[210:211], v250 offset:13312
 s_waitcnt lgkmcnt(8)
 v_mfma_f32_32x32x16_bf16 v[32:47], v[96:99], v[192:195], 0
 ds_read_b64_tr_b16 v[212:213], v251 offset:12352
 ds_read_b64_tr_b16 v[214:215], v251 offset:13376
 s_waitcnt lgkmcnt(8)
 v_mfma_f32_32x32x16_bf16 v[48:63], v[96:99], v[196:199], 0
 s_add_u32 m0, s19, 49152
 s_add_u32 s29, s55, 896
 buffer_load_dwordx4 v239, s[36:39], s29 offen lds
 s_add_u32 m0, s19, 50176
 s_add_u32 s29, s55, 11136
 buffer_load_dwordx4 v239, s[36:39], s29 offen lds
 s_add_u32 m0, s19, 51200
 s_add_u32 s29, s55, 21376
 buffer_load_dwordx4 v239, s[36:39], s29 offen lds
 s_add_u32 m0, s19, 52224
 s_add_u32 s29, s55, 31616
 buffer_load_dwordx4 v239, s[36:39], s29 offen lds
 s_add_u32 m0, s19, 53248
 s_add_u32 s29, s55, 41856
 buffer_load_dwordx4 v239, s[36:39], s29 offen lds
 s_add_u32 m0, s19, 54272
 s_add_u32 s29, s55, 52096
 buffer_load_dwordx4 v239, s[36:39], s29 offen lds
 ds_read_b64_tr_b16 v[192:193], v250 offset:14336
 ds_read_b64_tr_b16 v[194:195], v250 offset:15360
 s_waitcnt lgkmcnt(8)
 v_mfma_f32_32x32x16_bf16 v[32:47], v[100:103], v[200:203], v[32:47]
 ds_read_b64_tr_b16 v[196:197], v251 offset:14400
 ds_read_b64_tr_b16 v[198:199], v251 offset:15424
 s_waitcnt lgkmcnt(8)
 v_mfma_f32_32x32x16_bf16 v[48:63], v[100:103], v[204:207], v[48:63]
 ds_read_b64_tr_b16 v[200:201], v250 offset:16384
 ds_read_b64_tr_b16 v[202:203], v250 offset:17408
 s_waitcnt lgkmcnt(8)
 v_mfma_f32_32x32x16_bf16 v[32:47], v[104:107], v[208:211], v[32:47]
 ds_read_b64_tr_b16 v[204:205], v251 offset:16448
 ds_read_b64_tr_b16 v[206:207], v251 offset:17472
 s_waitcnt lgkmcnt(8)
 v_mfma_f32_32x32x16_bf16 v[48:63], v[104:107], v[212:215], v[48:63]
 ds_read_b64_tr_b16 v[208:209], v250 offset:18432
 ds_read_b64_tr_b16 v[210:211], v250 offset:19456
 s_waitcnt lgkmcnt(8)
 v_mfma_f32_32x32x16_bf16 v[32:47], v[108:111], v[192:195], v[32:47]
 v_cvt_pk_bf16_f32 v216, v0, v1
 v_cvt_pk_bf16_f32 v217, v2, v3
 v_cvt_pk_bf16_f32 v218, v4, v5
 ds_read_b64_tr_b16 v[212:213], v251 offset:18496
 ds_read_b64_tr_b16 v[214:215], v251 offset:19520
 s_waitcnt lgkmcnt(8)
 v_mfma_f32_32x32x16_bf16 v[48:63], v[108:111], v[196:199], v[48:63]
 ds_read_b64_tr_b16 v[192:193], v250 offset:20480
 ds_read_b64_tr_b16 v[194:195], v250 offset:21504
 s_waitcnt lgkmcnt(8)
 v_mfma_f32_32x32x16_bf16 v[32:47], v[112:115], v[200:203], v[32:47]
 v_cvt_pk_bf16_f32 v219, v6, v7
 v_cvt_pk_bf16_f32 v220, v8, v9
 v_cvt_pk_bf16_f32 v221, v10, v11
 ds_read_b64_tr_b16 v[196:197], v251 offset:20544
 ds_read_b64_tr_b16 v[198:199], v251 offset:21568
 s_waitcnt lgkmcnt(8)
 v_mfma_f32_32x32x16_bf16 v[48:63], v[112:115], v[204:207], v[48:63]
 ds_read_b64_tr_b16 v[200:201], v250 offset:22528
 ds_read_b64_tr_b16 v[202:203], v250 offset:23552
 s_waitcnt lgkmcnt(8)
 v_mfma_f32_32x32x16_bf16 v[32:47], v[116:119], v[208:211], v[32:47]
 v_cvt_pk_bf16_f32 v222, v12, v13
 v_cvt_pk_bf16_f32 v223, v14, v15
 buffer_store_dwordx4 v[216:219], v244, s[8:11], s53 offen offset:0 sc1
 ds_read_b64_tr_b16 v[204:205], v251 offset:22592
 ds_read_b64_tr_b16 v[206:207], v251 offset:23616
 s_waitcnt lgkmcnt(8)
 v_mfma_f32_32x32x16_bf16 v[48:63], v[116:119], v[212:215], v[48:63]
 ds_read_b64_tr_b16 v[208:209], v250 offset:24576
 ds_read_b64_tr_b16 v[210:211], v250 offset:25600
 s_waitcnt lgkmcnt(8)
 v_mfma_f32_32x32x16_bf16 v[32:47], v[120:123], v[192:195], v[32:47]
 buffer_store_dwordx4 v[220:223], v244, s[8:11], s53 offen offset:1024 sc1
 v_cvt_pk_bf16_f32 v224, v16, v17
 v_cvt_pk_bf16_f32 v225, v18, v19
 ds_read_b64_tr_b16 v[212:213], v251 offset:24640
 ds_read_b64_tr_b16 v[214:215], v251 offset:25664
 s_waitcnt lgkmcnt(8)
 v_mfma_f32_32x32x16_bf16 v[48:63], v[120:123], v[196:199], v[48:63]
 ds_read_b64_tr_b16 v[192:193], v250 offset:26624
 ds_read_b64_tr_b16 v[194:195], v250 offset:27648
 s_waitcnt lgkmcnt(8)
 v_mfma_f32_32x32x16_bf16 v[32:47], v[124:127], v[200:203], v[32:47]
 v_cvt_pk_bf16_f32 v226, v20, v21
 v_cvt_pk_bf16_f32 v227, v22, v23
 v_cvt_pk_bf16_f32 v228, v24, v25
 ds_read_b64_tr_b16 v[196:197], v251 offset:26688
 ds_read_b64_tr_b16 v[198:199], v251 offset:27712
 s_waitcnt lgkmcnt(8)
 v_mfma_f32_32x32x16_bf16 v[48:63], v[124:127], v[204:207], v[48:63]
 ds_read_b64_tr_b16 v[200:201], v250 offset:28672
 ds_read_b64_tr_b16 v[202:203], v250 offset:29696
 s_waitcnt lgkmcnt(8)
 v_mfma_f32_32x32x16_bf16 v[32:47], v[128:131], v[208:211], v[32:47]
 v_cvt_pk_bf16_f32 v229, v26, v27
 v_cvt_pk_bf16_f32 v230, v28, v29
 v_cvt_pk_bf16_f32 v231, v30, v31
 ds_read_b64_tr_b16 v[204:205], v251 offset:28736
 ds_read_b64_tr_b16 v[206:207], v251 offset:29760
 s_waitcnt lgkmcnt(8)
 v_mfma_f32_32x32x16_bf16 v[48:63], v[128:131], v[212:215], v[48:63]
 ds_read_b64_tr_b16 v[208:209], v250 offset:30720
 ds_read_b64_tr_b16 v[210:211], v250 offset:31744
 s_waitcnt lgkmcnt(8)
 v_mfma_f32_32x32x16_bf16 v[32:47], v[132:135], v[192:195], v[32:47]
 buffer_store_dwordx4 v[224:227], v244, s[8:11], s53 offen offset:2048 sc1
 buffer_store_dwordx4 v[228:231], v244, s[8:11], s53 offen offset:3072 sc1
 s_add_u32 s53, s53, 4096
 ds_read_b64_tr_b16 v[212:213], v251 offset:30784
 ds_read_b64_tr_b16 v[214:215], v251 offset:31808
 s_waitcnt lgkmcnt(8)
 v_mfma_f32_32x32x16_bf16 v[48:63], v[132:135], v[196:199], v[48:63]
 ds_read_b64_tr_b16 v[192:193], v250 offset:32768
 ds_read_b64_tr_b16 v[194:195], v250 offset:33792
 s_waitcnt lgkmcnt(8)
 v_mfma_f32_32x32x16_bf16 v[32:47], v[136:139], v[200:203], v[32:47]
 ds_read_b64_tr_b16 v[196:197], v251 offset:32832
 ds_read_b64_tr_b16 v[198:199], v251 offset:33856
 s_waitcnt lgkmcnt(8)
 v_mfma_f32_32x32x16_bf16 v[48:63], v[136:139], v[204:207], v[48:63]
 ds_read_b64_tr_b16 v[200:201], v250 offset:34816
 ds_read_b64_tr_b16 v[202:203], v250 offset:35840
 s_waitcnt lgkmcnt(8)
 v_mfma_f32_32x32x16_bf16 v[32:47], v[140:143], v[208:211], v[32:47]
 ds_read_b64_tr_b16 v[204:205], v251 offset:34880
 ds_read_b64_tr_b16 v[206:207], v251 offset:35904
 s_waitcnt lgkmcnt(8)
 v_mfma_f32_32x32x16_bf16 v[48:63], v[140:143], v[212:215], v[48:63]
 s_waitcnt vmcnt(24)
 s_barrier
 ds_read_b64_tr_b16 v[208:209], v250 offset:36864
 ds_read_b64_tr_b16 v[210:211], v250 offset:37888
 s_waitcnt lgkmcnt(8)
 v_mfma_f32_32x32x16_bf16 v[0:15], v[96:99], v[192:195], 0
 ds_read_b64_tr_b16 v[212:213], v251 offset:36928
 ds_read_b64_tr_b16 v[214:215], v251 offset:37952
 s_waitcnt lgkmcnt(8)
 v_mfma_f32_32x32x16_bf16 v[16:31], v[96:99], v[196:199], 0
 s_add_u32 m0, s19, 73728
 s_add_u32 s29, s55, 1024
 buffer_load_dwordx4 v239, s[36:39], s29 offen lds
 s_add_u32 m0, s19, 74752
 s_add_u32 s29, s55, 11264
 buffer_load_dwordx4 v239, s[36:39], s29 offen lds
 s_add_u32 m0, s19, 75776
 s_add_u32 s29, s55, 21504
 buffer_load_dwordx4 v239, s[36:39], s29 offen lds
 s_add_u32 m0, s19, 76800
 s_add_u32 s29, s55, 31744
 buffer_load_dwordx4 v239, s[36:39], s29 offen lds
 s_add_u32 m0, s19, 77824
 s_add_u32 s29, s55, 41984
 buffer_load_dwordx4 v239, s[36:39], s29 offen lds
 s_add_u32 m0, s19, 78848
 s_add_u32 s29, s55, 52224
 buffer_load_dwordx4 v239, s[36:39], s29 offen lds
 ds_read_b64_tr_b16 v[192:193], v250 offset:38912
 ds_read_b64_tr_b16 v[194:195], v250 offset:39936
 s_waitcnt lgkmcnt(8)
 v_mfma_f32_32x32x16_bf16 v[0:15], v[100:103], v[200:203], v[0:15]
 ds_read_b64_tr_b16 v[196:197], v251 offset:38976
 ds_read_b64_tr_b16 v[198:199], v251 offset:40000
 s_waitcnt lgkmcnt(8)
 v_mfma_f32_32x32x16_bf16 v[16:31], v[100:103], v[204:207], v[16:31]
 ds_read_b64_tr_b16 v[200:201], v250 offset:40960
 ds_read_b64_tr_b16 v[202:203], v250 offset:41984
 s_waitcnt lgkmcnt(8)
 v_mfma_f32_32x32x16_bf16 v[0:15], v[104:107], v[208:211], v[0:15]
 ds_read_b64_tr_b16 v[204:205], v251 offset:41024
 ds_read_b64_tr_b16 v[206:207], v251 offset:42048
 s_waitcnt lgkmcnt(8)
 v_mfma_f32_32x32x16_bf16 v[16:31], v[104:107], v[212:215], v[16:31]
 ds_read_b64_tr_b16 v[208:209], v250 offset:43008
 ds_read_b64_tr_b16 v[210:211], v250 offset:44032
 s_waitcnt lgkmcnt(8)
 v_mfma_f32_32x32x16_bf16 v[0:15], v[108:111], v[192:195], v[0:15]
 v_cvt_pk_bf16_f32 v216, v32, v33
 v_cvt_pk_bf16_f32 v217, v34, v35
 v_cvt_pk_bf16_f32 v218, v36, v37
 ds_read_b64_tr_b16 v[212:213], v251 offset:43072
 ds_read_b64_tr_b16 v[214:215], v251 offset:44096
 s_waitcnt lgkmcnt(8)
 v_mfma_f32_32x32x16_bf16 v[16:31], v[108:111], v[196:199], v[16:31]
 ds_read_b64_tr_b16 v[192:193], v250 offset:45056
 ds_read_b64_tr_b16 v[194:195], v250 offset:46080
 s_waitcnt lgkmcnt(8)
 v_mfma_f32_32x32x16_bf16 v[0:15], v[112:115], v[200:203], v[0:15]
 v_cvt_pk_bf16_f32 v219, v38, v39
 v_cvt_pk_bf16_f32 v220, v40, v41
 v_cvt_pk_bf16_f32 v221, v42, v43
 ds_read_b64_tr_b16 v[196:197], v251 offset:45120
 ds_read_b64_tr_b16 v[198:199], v251 offset:46144
 s_waitcnt lgkmcnt(8)
 v_mfma_f32_32x32x16_bf16 v[16:31], v[112:115], v[204:207], v[16:31]
 ds_read_b64_tr_b16 v[200:201], v250 offset:47104
 ds_read_b64_tr_b16 v[202:203], v250 offset:48128
 s_waitcnt lgkmcnt(8)
 v_mfma_f32_32x32x16_bf16 v[0:15], v[116:119], v[208:211], v[0:15]
 v_cvt_pk_bf16_f32 v222, v44, v45
 v_cvt_pk_bf16_f32 v223, v46, v47
 buffer_store_dwordx4 v[216:219], v244, s[8:11], s53 offen offset:0 sc1
 ds_read_b64_tr_b16 v[204:205], v251 offset:47168
 ds_read_b64_tr_b16 v[206:207], v251 offset:48192
 s_waitcnt lgkmcnt(8)
 v_mfma_f32_32x32x16_bf16 v[16:31], v[116:119], v[212:215], v[16:31]
 ds_read_b64_tr_b16 v[208:209], v250 offset:49152
 ds_read_b64_tr_b16 v[210:211], v250 offset:50176
 s_waitcnt lgkmcnt(8)
 v_mfma_f32_32x32x16_bf16 v[0:15], v[120:123], v[192:195], v[0:15]
 buffer_store_dwordx4 v[220:223], v244, s[8:11], s53 offen offset:1024 sc1
 v_cvt_pk_bf16_f32 v224, v48, v49
 v_cvt_pk_bf16_f32 v225, v50, v51
 ds_read_b64_tr_b16 v[212:213], v251 offset:49216
 ds_read_b64_tr_b16 v[214:215], v251 offset:50240
 s_waitcnt lgkmcnt(8)
 v_mfma_f32_32x32x16_bf16 v[16:31], v[120:123], v[196:199], v[16:31]
 ds_read_b64_tr_b16 v[192:193], v250 offset:51200
 ds_read_b64_tr_b16 v[194:195], v250 offset:52224
 s_waitcnt lgkmcnt(8)
 v_mfma_f32_32x32x16_bf16 v[0:15], v[124:127], v[200:203], v[0:15]
 v_cvt_pk_bf16_f32 v226, v52, v53
 v_cvt_pk_bf16_f32 v227, v54, v55
 v_cvt_pk_bf16_f32 v228, v56, v57
 ds_read_b64_tr_b16 v[196:197], v251 offset:51264
 ds_read_b64_tr_b16 v[198:199], v251 offset:52288
 s_waitcnt lgkmcnt(8)
 v_mfma_f32_32x32x16_bf16 v[16:31], v[124:127], v[204:207], v[16:31]
 ds_read_b64_tr_b16 v[200:201], v250 offset:53248
 ds_read_b64_tr_b16 v[202:203], v250 offset:54272
 s_waitcnt lgkmcnt(8)
 v_mfma_f32_32x32x16_bf16 v[0:15], v[128:131], v[208:211], v[0:15]
 v_cvt_pk_bf16_f32 v229, v58, v59
 v_cvt_pk_bf16_f32 v230, v60, v61
 v_cvt_pk_bf16_f32 v231, v62, v63
 ds_read_b64_tr_b16 v[204:205], v251 offset:53312
 ds_read_b64_tr_b16 v[206:207], v251 offset:54336
 s_waitcnt lgkmcnt(8)
 v_mfma_f32_32x32x16_bf16 v[16:31], v[128:131], v[212:215], v[16:31]
 ds_read_b64_tr_b16 v[208:209], v250 offset:55296
 ds_read_b64_tr_b16 v[210:211], v250 offset:56320
 s_waitcnt lgkmcnt(8)
 v_mfma_f32_32x32x16_bf16 v[0:15], v[132:135], v[192:195], v[0:15]
 buffer_store_dwordx4 v[224:227], v244, s[8:11], s53 offen offset:2048 sc1
 buffer_store_dwordx4 v[228:231], v244, s[8:11], s53 offen offset:3072 sc1
 s_add_u32 s53, s53, 4096
 ds_read_b64_tr_b16 v[212:213], v251 offset:55360
 ds_read_b64_tr_b16 v[214:215], v251 offset:56384
 s_waitcnt lgkmcnt(8)
 v_mfma_f32_32x32x16_bf16 v[16:31], v[132:135], v[196:199], v[16:31]
 ds_read_b64_tr_b16 v[192:193], v242 offset:0
 ds_read_b64_tr_b16 v[194:195], v242 offset:1024
 s_waitcnt lgkmcnt(8)
 v_mfma_f32_32x32x16_bf16 v[0:15], v[136:139], v[200:203], v[0:15]
 ds_read_b64_tr_b16 v[196:197], v243 offset:64
 ds_read_b64_tr_b16 v[198:199], v243 offset:1088
 s_waitcnt lgkmcnt(8)
 v_mfma_f32_32x32x16_bf16 v[16:31], v[136:139], v[204:207], v[16:31]
 ds_read_b64_tr_b16 v[200:201], v242 offset:2048
 ds_read_b64_tr_b16 v[202:203], v242 offset:3072
 s_waitcnt lgkmcnt(8)
 v_mfma_f32_32x32x16_bf16 v[0:15], v[140:143], v[208:211], v[0:15]
 ds_read_b64_tr_b16 v[204:205], v243 offset:2112
 ds_read_b64_tr_b16 v[206:207], v243 offset:3136
 s_waitcnt lgkmcnt(8)
 v_mfma_f32_32x32x16_bf16 v[16:31], v[140:143], v[212:215], v[16:31]
 s_waitcnt vmcnt(24)
 s_barrier
 ds_read_b64_tr_b16 v[208:209], v242 offset:4096
 ds_read_b64_tr_b16 v[210:211], v242 offset:5120
 s_waitcnt lgkmcnt(8)
 v_mfma_f32_32x32x16_bf16 v[32:47], v[96:99], v[192:195], 0
 ds_read_b64_tr_b16 v[212:213], v243 offset:4160
 ds_read_b64_tr_b16 v[214:215], v243 offset:5184
 s_waitcnt lgkmcnt(8)
 v_mfma_f32_32x32x16_bf16 v[48:63], v[96:99], v[196:199], 0
 s_add_u32 m0, s19, 98304
 s_add_u32 s29, s55, 1152
 buffer_load_dwordx4 v239, s[36:39], s29 offen lds
 s_add_u32 m0, s19, 99328
 s_add_u32 s29, s55, 11392
 buffer_load_dwordx4 v239, s[36:39], s29 offen lds
 s_add_u32 m0, s19, 100352
 s_add_u32 s29, s55, 21632
 buffer_load_dwordx4 v239, s[36:39], s29 offen lds
 s_add_u32 m0, s19, 101376
 s_add_u32 s29, s55, 31872
 buffer_load_dwordx4 v239, s[36:39], s29 offen lds
 s_add_u32 m0, s19, 102400
 s_add_u32 s29, s55, 42112
 buffer_load_dwordx4 v239, s[36:39], s29 offen lds
 s_add_u32 m0, s19, 103424
 s_add_u32 s29, s55, 52352
 buffer_load_dwordx4 v239, s[36:39], s29 offen lds
 ds_read_b64_tr_b16 v[192:193], v242 offset:6144
 ds_read_b64_tr_b16 v[194:195], v242 offset:7168
 s_waitcnt lgkmcnt(8)
 v_mfma_f32_32x32x16_bf16 v[32:47], v[100:103], v[200:203], v[32:47]
 ds_read_b64_tr_b16 v[196:197], v243 offset:6208
 ds_read_b64_tr_b16 v[198:199], v243 offset:7232
 s_waitcnt lgkmcnt(8)
 v_mfma_f32_32x32x16_bf16 v[48:63], v[100:103], v[204:207], v[48:63]
 ds_read_b64_tr_b16 v[200:201], v242 offset:8192
 ds_read_b64_tr_b16 v[202:203], v242 offset:9216
 s_waitcnt lgkmcnt(8)
 v_mfma_f32_32x32x16_bf16 v[32:47], v[104:107], v[208:211], v[32:47]
 ds_read_b64_tr_b16 v[204:205], v243 offset:8256
 ds_read_b64_tr_b16 v[206:207], v243 offset:9280
 s_waitcnt lgkmcnt(8)
 v_mfma_f32_32x32x16_bf16 v[48:63], v[104:107], v[212:215], v[48:63]
 ds_read_b64_tr_b16 v[208:209], v242 offset:10240
 ds_read_b64_tr_b16 v[210:211], v242 offset:11264
 s_waitcnt lgkmcnt(8)
 v_mfma_f32_32x32x16_bf16 v[32:47], v[108:111], v[192:195], v[32:47]
 v_cvt_pk_bf16_f32 v216, v0, v1
 v_cvt_pk_bf16_f32 v217, v2, v3
 v_cvt_pk_bf16_f32 v218, v4, v5
 ds_read_b64_tr_b16 v[212:213], v243 offset:10304
 ds_read_b64_tr_b16 v[214:215], v243 offset:11328
 s_waitcnt lgkmcnt(8)
 v_mfma_f32_32x32x16_bf16 v[48:63], v[108:111], v[196:199], v[48:63]
 ds_read_b64_tr_b16 v[192:193], v242 offset:12288
 ds_read_b64_tr_b16 v[194:195], v242 offset:13312
 s_waitcnt lgkmcnt(8)
 v_mfma_f32_32x32x16_bf16 v[32:47], v[112:115], v[200:203], v[32:47]
 v_cvt_pk_bf16_f32 v219, v6, v7
 v_cvt_pk_bf16_f32 v220, v8, v9
 v_cvt_pk_bf16_f32 v221, v10, v11
 ds_read_b64_tr_b16 v[196:197], v243 offset:12352
 ds_read_b64_tr_b16 v[198:199], v243 offset:13376
 s_waitcnt lgkmcnt(8)
 v_mfma_f32_32x32x16_bf16 v[48:63], v[112:115], v[204:207], v[48:63]
 ds_read_b64_tr_b16 v[200:201], v242 offset:14336
 ds_read_b64_tr_b16 v[202:203], v242 offset:15360
 s_waitcnt lgkmcnt(8)
 v_mfma_f32_32x32x16_bf16 v[32:47], v[116:119], v[208:211], v[32:47]
 v_cvt_pk_bf16_f32 v222, v12, v13
 v_cvt_pk_bf16_f32 v223, v14, v15
 buffer_store_dwordx4 v[216:219], v244, s[8:11], s53 offen offset:0 sc1
 ds_read_b64_tr_b16 v[204:205], v243 offset:14400
 ds_read_b64_tr_b16 v[206:207], v243 offset:15424
 s_waitcnt lgkmcnt(8)
 v_mfma_f32_32x32x16_bf16 v[48:63], v[116:119], v[212:215], v[48:63]
 ds_read_b64_tr_b16 v[208:209], v242 offset:16384
 ds_read_b64_tr_b16 v[210:211], v242 offset:17408
 s_waitcnt lgkmcnt(8)
 v_mfma_f32_32x32x16_bf16 v[32:47], v[120:123], v[192:195], v[32:47]
 buffer_store_dwordx4 v[220:223], v244, s[8:11], s53 offen offset:1024 sc1
 v_cvt_pk_bf16_f32 v224, v16, v17
 v_cvt_pk_bf16_f32 v225, v18, v19
 ds_read_b64_tr_b16 v[212:213], v243 offset:16448
 ds_read_b64_tr_b16 v[214:215], v243 offset:17472
 s_waitcnt lgkmcnt(8)
 v_mfma_f32_32x32x16_bf16 v[48:63], v[120:123], v[196:199], v[48:63]
 ds_read_b64_tr_b16 v[192:193], v242 offset:18432
 ds_read_b64_tr_b16 v[194:195], v242 offset:19456
 s_waitcnt lgkmcnt(8)
 v_mfma_f32_32x32x16_bf16 v[32:47], v[124:127], v[200:203], v[32:47]
 v_cvt_pk_bf16_f32 v226, v20, v21
 v_cvt_pk_bf16_f32 v227, v22, v23
 v_cvt_pk_bf16_f32 v228, v24, v25
 ds_read_b64_tr_b16 v[196:197], v243 offset:18496
 ds_read_b64_tr_b16 v[198:199], v243 offset:19520
 s_waitcnt lgkmcnt(8)
 v_mfma_f32_32x32x16_bf16 v[48:63], v[124:127], v[204:207], v[48:63]
 ds_read_b64_tr_b16 v[200:201], v242 offset:20480
 ds_read_b64_tr_b16 v[202:203], v242 offset:21504
 s_waitcnt lgkmcnt(8)
 v_mfma_f32_32x32x16_bf16 v[32:47], v[128:131], v[208:211], v[32:47]
 v_cvt_pk_bf16_f32 v229, v26, v27
 v_cvt_pk_bf16_f32 v230, v28, v29
 v_cvt_pk_bf16_f32 v231, v30, v31
 ds_read_b64_tr_b16 v[204:205], v243 offset:20544
 ds_read_b64_tr_b16 v[206:207], v243 offset:21568
 s_waitcnt lgkmcnt(8)
 v_mfma_f32_32x32x16_bf16 v[48:63], v[128:131], v[212:215], v[48:63]
 ds_read_b64_tr_b16 v[208:209], v242 offset:22528
 ds_read_b64_tr_b16 v[210:211], v242 offset:23552
 s_waitcnt lgkmcnt(8)
 v_mfma_f32_32x32x16_bf16 v[32:47], v[132:135], v[192:195], v[32:47]
 buffer_store_dwordx4 v[224:227], v244, s[8:11], s53 offen offset:2048 sc1
 buffer_store_dwordx4 v[228:231], v244, s[8:11], s53 offen offset:3072 sc1
 s_add_u32 s53, s53, 4096
 ds_read_b64_tr_b16 v[212:213], v243 offset:22592
 ds_read_b64_tr_b16 v[214:215], v243 offset:23616
 s_waitcnt lgkmcnt(8)
 v_mfma_f32_32x32x16_bf16 v[48:63], v[132:135], v[196:199], v[48:63]
 ds_read_b64_tr_b16 v[192:193], v242 offset:24576
 ds_read_b64_tr_b16 v[194:195], v242 offset:25600
 s_waitcnt lgkmcnt(8)
 v_mfma_f32_32x32x16_bf16 v[32:47], v[136:139], v[200:203], v[32:47]
 ds_read_b64_tr_b16 v[196:197], v243 offset:24640
 ds_read_b64_tr_b16 v[198:199], v243 offset:25664
 s_waitcnt lgkmcnt(8)
 v_mfma_f32_32x32x16_bf16 v[48:63], v[136:139], v[204:207], v[48:63]
 ds_read_b64_tr_b16 v[200:201], v242 offset:26624
 ds_read_b64_tr_b16 v[202:203], v242 offset:27648
 s_waitcnt lgkmcnt(8)
 v_mfma_f32_32x32x16_bf16 v[32:47], v[140:143], v[208:211], v[32:47]
 ds_read_b64_tr_b16 v[204:205], v243 offset:26688
 ds_read_b64_tr_b16 v[206:207], v243 offset:27712
 s_waitcnt lgkmcnt(8)
 v_mfma_f32_32x32x16_bf16 v[48:63], v[140:143], v[212:215], v[48:63]
 s_waitcnt vmcnt(24)
 s_barrier
 ds_read_b64_tr_b16 v[208:209], v242 offset:28672
 ds_read_b64_tr_b16 v[210:211], v242 offset:29696
 s_waitcnt lgkmcnt(8)
 v_mfma_f32_32x32x16_bf16 v[0:15], v[96:99], v[192:195], 0
 ds_read_b64_tr_b16 v[212:213], v243 offset:28736
 ds_read_b64_tr_b16 v[214:215], v243 offset:29760
 s_waitcnt lgkmcnt(8)
 v_mfma_f32_32x32x16_bf16 v[16:31], v[96:99], v[196:199], 0
 ds_read_b64_tr_b16 v[192:193], v242 offset:30720
 ds_read_b64_tr_b16 v[194:195], v242 offset:31744
 s_waitcnt lgkmcnt(8)
 v_mfma_f32_32x32x16_bf16 v[0:15], v[100:103], v[200:203], v[0:15]
 ds_read_b64_tr_b16 v[196:197], v243 offset:30784
 ds_read_b64_tr_b16 v[198:199], v243 offset:31808
 s_waitcnt lgkmcnt(8)
 v_mfma_f32_32x32x16_bf16 v[16:31], v[100:103], v[204:207], v[16:31]
 ds_read_b64_tr_b16 v[200:201], v242 offset:32768
 ds_read_b64_tr_b16 v[202:203], v242 offset:33792
 s_waitcnt lgkmcnt(8)
 v_mfma_f32_32x32x16_bf16 v[0:15], v[104:107], v[208:211], v[0:15]
 ds_read_b64_tr_b16 v[204:205], v243 offset:32832
 ds_read_b64_tr_b16 v[206:207], v243 offset:33856
 s_waitcnt lgkmcnt(8)
 v_mfma_f32_32x32x16_bf16 v[16:31], v[104:107], v[212:215], v[16:31]
 ds_read_b64_tr_b16 v[208:209], v242 offset:34816
 ds_read_b64_tr_b16 v[210:211], v242 offset:35840
 s_waitcnt lgkmcnt(8)
 v_mfma_f32_32x32x16_bf16 v[0:15], v[108:111], v[192:195], v[0:15]
 v_cvt_pk_bf16_f32 v216, v32, v33
 v_cvt_pk_bf16_f32 v217, v34, v35
 v_cvt_pk_bf16_f32 v218, v36, v37
 ds_read_b64_tr_b16 v[212:213], v243 offset:34880
 ds_read_b64_tr_b16 v[214:215], v243 offset:35904
 s_waitcnt lgkmcnt(8)
 v_mfma_f32_32x32x16_bf16 v[16:31], v[108:111], v[196:199], v[16:31]
 ds_read_b64_tr_b16 v[192:193], v242 offset:36864
 ds_read_b64_tr_b16 v[194:195], v242 offset:37888
 s_waitcnt lgkmcnt(8)
 v_mfma_f32_32x32x16_bf16 v[0:15], v[112:115], v[200:203], v[0:15]
 v_cvt_pk_bf16_f32 v219, v38, v39
 v_cvt_pk_bf16_f32 v220, v40, v41
 v_cvt_pk_bf16_f32 v221, v42, v43
 ds_read_b64_tr_b16 v[196:197], v243 offset:36928
 ds_read_b64_tr_b16 v[198:199], v243 offset:37952
 s_waitcnt lgkmcnt(8)
 v_mfma_f32_32x32x16_bf16 v[16:31], v[112:115], v[204:207], v[16:31]
 ds_read_b64_tr_b16 v[200:201], v242 offset:38912
 ds_read_b64_tr_b16 v[202:203], v242 offset:39936
 s_waitcnt lgkmcnt(8)
 v_mfma_f32_32x32x16_bf16 v[0:15], v[116:119], v[208:211], v[0:15]
 v_cvt_pk_bf16_f32 v222, v44, v45
 v_cvt_pk_bf16_f32 v223, v46, v47
 buffer_store_dwordx4 v[216:219], v244, s[8:11], s53 offen offset:0 sc1
 ds_read_b64_tr_b16 v[204:205], v243 offset:38976
 ds_read_b64_tr_b16 v[206:207], v243 offset:40000
 s_waitcnt lgkmcnt(8)
 v_mfma_f32_32x32x16_bf16 v[16:31], v[116:119], v[212:215], v[16:31]
 ds_read_b64_tr_b16 v[208:209], v242 offset:40960
 ds_read_b64_tr_b16 v[210:211], v242 offset:41984
 s_waitcnt lgkmcnt(8)
 v_mfma_f32_32x32x16_bf16 v[0:15], v[120:123], v[192:195], v[0:15]
 buffer_store_dwordx4 v[220:223], v244, s[8:11], s53 offen offset:1024 sc1
 v_cvt_pk_bf16_f32 v224, v48, v49
 v_cvt_pk_bf16_f32 v225, v50, v51
 ds_read_b64_tr_b16 v[212:213], v243 offset:41024
 ds_read_b64_tr_b16 v[214:215], v243 offset:42048
 s_waitcnt lgkmcnt(8)
 v_mfma_f32_32x32x16_bf16 v[16:31], v[120:123], v[196:199], v[16:31]
 ds_read_b64_tr_b16 v[192:193], v242 offset:43008
 ds_read_b64_tr_b16 v[194:195], v242 offset:44032
 s_waitcnt lgkmcnt(8)
 v_mfma_f32_32x32x16_bf16 v[0:15], v[124:127], v[200:203], v[0:15]
 v_cvt_pk_bf16_f32 v226, v52, v53
 v_cvt_pk_bf16_f32 v227, v54, v55
 v_cvt_pk_bf16_f32 v228, v56, v57
 ds_read_b64_tr_b16 v[196:197], v243 offset:43072
 ds_read_b64_tr_b16 v[198:199], v243 offset:44096
 s_waitcnt lgkmcnt(8)
 v_mfma_f32_32x32x16_bf16 v[16:31], v[124:127], v[204:207], v[16:31]
 ds_read_b64_tr_b16 v[200:201], v242 offset:45056
 ds_read_b64_tr_b16 v[202:203], v242 offset:46080
 s_waitcnt lgkmcnt(8)
 v_mfma_f32_32x32x16_bf16 v[0:15], v[128:131], v[208:211], v[0:15]
 v_cvt_pk_bf16_f32 v229, v58, v59
 v_cvt_pk_bf16_f32 v230, v60, v61
 v_cvt_pk_bf16_f32 v231, v62, v63
 ds_read_b64_tr_b16 v[204:205], v243 offset:45120
 ds_read_b64_tr_b16 v[206:207], v243 offset:46144
 s_waitcnt lgkmcnt(8)
 v_mfma_f32_32x32x16_bf16 v[16:31], v[128:131], v[212:215], v[16:31]
 ds_read_b64_tr_b16 v[208:209], v242 offset:47104
 ds_read_b64_tr_b16 v[210:211], v242 offset:48128
 s_waitcnt lgkmcnt(8)
 v_mfma_f32_32x32x16_bf16 v[0:15], v[132:135], v[192:195], v[0:15]
 buffer_store_dwordx4 v[224:227], v244, s[8:11], s53 offen offset:2048 sc1
 buffer_store_dwordx4 v[228:231], v244, s[8:11], s53 offen offset:3072 sc1
 s_add_u32 s53, s53, 4096
 ds_read_b64_tr_b16 v[212:213], v243 offset:47168
 ds_read_b64_tr_b16 v[214:215], v243 offset:48192
 s_waitcnt lgkmcnt(8)
 v_mfma_f32_32x32x16_bf16 v[16:31], v[132:135], v[196:199], v[16:31]
 ds_read_b64_tr_b16 v[192:193], v242 offset:49152
 ds_read_b64_tr_b16 v[194:195], v242 offset:50176
 s_waitcnt lgkmcnt(8)
 v_mfma_f32_32x32x16_bf16 v[0:15], v[136:139], v[200:203], v[0:15]
 ds_read_b64_tr_b16 v[196:197], v243 offset:49216
 ds_read_b64_tr_b16 v[198:199], v243 offset:50240
 s_waitcnt lgkmcnt(8)
 v_mfma_f32_32x32x16_bf16 v[16:31], v[136:139], v[204:207], v[16:31]
 ds_read_b64_tr_b16 v[200:201], v242 offset:51200
 ds_read_b64_tr_b16 v[202:203], v242 offset:52224
 s_waitcnt lgkmcnt(8)
 v_mfma_f32_32x32x16_bf16 v[0:15], v[140:143], v[208:211], v[0:15]
 ds_read_b64_tr_b16 v[204:205], v243 offset:51264
 ds_read_b64_tr_b16 v[206:207], v243 offset:52288
 s_waitcnt lgkmcnt(8)
 v_mfma_f32_32x32x16_bf16 v[16:31], v[140:143], v[212:215], v[16:31]
 s_waitcnt vmcnt(18)
 s_barrier
 ds_read_b64_tr_b16 v[208:209], v242 offset:53248
 ds_read_b64_tr_b16 v[210:211], v242 offset:54272
 s_waitcnt lgkmcnt(8)
 v_mfma_f32_32x32x16_bf16 v[32:47], v[96:99], v[192:195], 0
 ds_read_b64_tr_b16 v[212:213], v243 offset:53312
 ds_read_b64_tr_b16 v[214:215], v243 offset:54336
 s_waitcnt lgkmcnt(8)
 v_mfma_f32_32x32x16_bf16 v[48:63], v[96:99], v[196:199], 0
 ds_read_b64_tr_b16 v[192:193], v242 offset:55296
 ds_read_b64_tr_b16 v[194:195], v242 offset:56320
 s_waitcnt lgkmcnt(8)
 v_mfma_f32_32x32x16_bf16 v[32:47], v[100:103], v[200:203], v[32:47]
 ds_read_b64_tr_b16 v[196:197], v243 offset:55360
 ds_read_b64_tr_b16 v[198:199], v243 offset:56384
 s_waitcnt lgkmcnt(8)
 v_mfma_f32_32x32x16_bf16 v[48:63], v[100:103], v[204:207], v[48:63]
 ds_read_b64_tr_b16 v[200:201], v242 offset:57344
 ds_read_b64_tr_b16 v[202:203], v242 offset:58368
 s_waitcnt lgkmcnt(8)
 v_mfma_f32_32x32x16_bf16 v[32:47], v[104:107], v[208:211], v[32:47]
 ds_read_b64_tr_b16 v[204:205], v243 offset:57408
 ds_read_b64_tr_b16 v[206:207], v243 offset:58432
 s_waitcnt lgkmcnt(8)
 v_mfma_f32_32x32x16_bf16 v[48:63], v[104:107], v[212:215], v[48:63]
 ds_read_b64_tr_b16 v[208:209], v242 offset:59392
 ds_read_b64_tr_b16 v[210:211], v242 offset:60416
 s_waitcnt lgkmcnt(8)
 v_mfma_f32_32x32x16_bf16 v[32:47], v[108:111], v[192:195], v[32:47]
 v_cvt_pk_bf16_f32 v216, v0, v1
 v_cvt_pk_bf16_f32 v217, v2, v3
 v_cvt_pk_bf16_f32 v218, v4, v5
 ds_read_b64_tr_b16 v[212:213], v243 offset:59456
 ds_read_b64_tr_b16 v[214:215], v243 offset:60480
 s_waitcnt lgkmcnt(8)
 v_mfma_f32_32x32x16_bf16 v[48:63], v[108:111], v[196:199], v[48:63]
 ds_read_b64_tr_b16 v[192:193], v242 offset:61440
 ds_read_b64_tr_b16 v[194:195], v242 offset:62464
 s_waitcnt lgkmcnt(8)
 v_mfma_f32_32x32x16_bf16 v[32:47], v[112:115], v[200:203], v[32:47]
 v_cvt_pk_bf16_f32 v219, v6, v7
 v_cvt_pk_bf16_f32 v220, v8, v9
 v_cvt_pk_bf16_f32 v221, v10, v11
 ds_read_b64_tr_b16 v[196:197], v243 offset:61504
 ds_read_b64_tr_b16 v[198:199], v243 offset:62528
 s_waitcnt lgkmcnt(8)
 v_mfma_f32_32x32x16_bf16 v[48:63], v[112:115], v[204:207], v[48:63]
 ds_read_b64_tr_b16 v[200:201], v242 offset:63488
 ds_read_b64_tr_b16 v[202:203], v242 offset:64512
 s_waitcnt lgkmcnt(8)
 v_mfma_f32_32x32x16_bf16 v[32:47], v[116:119], v[208:211], v[32:47]
 v_cvt_pk_bf16_f32 v222, v12, v13
 v_cvt_pk_bf16_f32 v223, v14, v15
 buffer_store_dwordx4 v[216:219], v244, s[8:11], s53 offen offset:0 sc1
 ds_read_b64_tr_b16 v[204:205], v243 offset:63552
 ds_read_b64_tr_b16 v[206:207], v243 offset:64576
 s_waitcnt lgkmcnt(8)
 v_mfma_f32_32x32x16_bf16 v[48:63], v[116:119], v[212:215], v[48:63]
 ds_read_b64_tr_b16 v[208:209], v250 offset:0
 ds_read_b64_tr_b16 v[210:211], v250 offset:1024
 s_waitcnt lgkmcnt(8)
 v_mfma_f32_32x32x16_bf16 v[32:47], v[120:123], v[192:195], v[32:47]
 buffer_store_dwordx4 v[220:223], v244, s[8:11], s53 offen offset:1024 sc1
 v_cvt_pk_bf16_f32 v224, v16, v17
 v_cvt_pk_bf16_f32 v225, v18, v19
 ds_read_b64_tr_b16 v[212:213], v251 offset:64
 ds_read_b64_tr_b16 v[214:215], v251 offset:1088
 s_waitcnt lgkmcnt(8)
 v_mfma_f32_32x32x16_bf16 v[48:63], v[120:123], v[196:199], v[48:63]
 ds_read_b64_tr_b16 v[192:193], v250 offset:2048
 ds_read_b64_tr_b16 v[194:195], v250 offset:3072
 s_waitcnt lgkmcnt(8)
 v_mfma_f32_32x32x16_bf16 v[32:47], v[124:127], v[200:203], v[32:47]
 v_cvt_pk_bf16_f32 v226, v20, v21
 v_cvt_pk_bf16_f32 v227, v22, v23
 v_cvt_pk_bf16_f32 v228, v24, v25
 ds_read_b64_tr_b16 v[196:197], v251 offset:2112
 ds_read_b64_tr_b16 v[198:199], v251 offset:3136
 s_waitcnt lgkmcnt(8)
 v_mfma_f32_32x32x16_bf16 v[48:63], v[124:127], v[204:207], v[48:63]
 ds_read_b64_tr_b16 v[200:201], v250 offset:4096
 ds_read_b64_tr_b16 v[202:203], v250 offset:5120
 s_waitcnt lgkmcnt(8)
 v_mfma_f32_32x32x16_bf16 v[32:47], v[128:131], v[208:211], v[32:47]
 v_cvt_pk_bf16_f32 v229, v26, v27
 v_cvt_pk_bf16_f32 v230, v28, v29
 v_cvt_pk_bf16_f32 v231, v30, v31
 ds_read_b64_tr_b16 v[204:205], v251 offset:4160
 ds_read_b64_tr_b16 v[206:207], v251 offset:5184
 s_waitcnt lgkmcnt(8)
 v_mfma_f32_32x32x16_bf16 v[48:63], v[128:131], v[212:215], v[48:63]
 ds_read_b64_tr_b16 v[208:209], v250 offset:6144
 ds_read_b64_tr_b16 v[210:211], v250 offset:7168
 s_waitcnt lgkmcnt(8)
 v_mfma_f32_32x32x16_bf16 v[32:47], v[132:135], v[192:195], v[32:47]
 buffer_store_dwordx4 v[224:227], v244, s[8:11], s53 offen offset:2048 sc1
 buffer_store_dwordx4 v[228:231], v244, s[8:11], s53 offen offset:3072 sc1
 s_add_u32 s53, s53, 4096
 ds_read_b64_tr_b16 v[212:213], v251 offset:6208
 ds_read_b64_tr_b16 v[214:215], v251 offset:7232
 s_waitcnt lgkmcnt(8)
 v_mfma_f32_32x32x16_bf16 v[48:63], v[132:135], v[196:199], v[48:63]
 ds_read_b64_tr_b16 v[192:193], v250 offset:8192
 ds_read_b64_tr_b16 v[194:195], v250 offset:9216
 s_waitcnt lgkmcnt(8)
 v_mfma_f32_32x32x16_bf16 v[32:47], v[136:139], v[200:203], v[32:47]
 ds_read_b64_tr_b16 v[196:197], v251 offset:8256
 ds_read_b64_tr_b16 v[198:199], v251 offset:9280
 s_waitcnt lgkmcnt(8)
 v_mfma_f32_32x32x16_bf16 v[48:63], v[136:139], v[204:207], v[48:63]
 ds_read_b64_tr_b16 v[200:201], v250 offset:10240
 ds_read_b64_tr_b16 v[202:203], v250 offset:11264
 s_waitcnt lgkmcnt(8)
 v_mfma_f32_32x32x16_bf16 v[32:47], v[140:143], v[208:211], v[32:47]
 ds_read_b64_tr_b16 v[204:205], v251 offset:10304
 ds_read_b64_tr_b16 v[206:207], v251 offset:11328
 s_waitcnt lgkmcnt(8)
 v_mfma_f32_32x32x16_bf16 v[48:63], v[140:143], v[212:215], v[48:63]
 s_waitcnt vmcnt(12)
 s_barrier
 ds_read_b64_tr_b16 v[208:209], v250 offset:12288
 ds_read_b64_tr_b16 v[210:211], v250 offset:13312
 s_waitcnt lgkmcnt(8)
 v_mfma_f32_32x32x16_bf16 v[0:15], v[96:99], v[192:195], 0
 ds_read_b64_tr_b16 v[212:213], v251 offset:12352
 ds_read_b64_tr_b16 v[214:215], v251 offset:13376
 s_waitcnt lgkmcnt(8)
 v_mfma_f32_32x32x16_bf16 v[16:31], v[96:99], v[196:199], 0
 ds_read_b64_tr_b16 v[192:193], v250 offset:14336
 ds_read_b64_tr_b16 v[194:195], v250 offset:15360
 s_waitcnt lgkmcnt(8)
 v_mfma_f32_32x32x16_bf16 v[0:15], v[100:103], v[200:203], v[0:15]
 ds_read_b64_tr_b16 v[196:197], v251 offset:14400
 ds_read_b64_tr_b16 v[198:199], v251 offset:15424
 s_waitcnt lgkmcnt(8)
 v_mfma_f32_32x32x16_bf16 v[16:31], v[100:103], v[204:207], v[16:31]
 ds_read_b64_tr_b16 v[200:201], v250 offset:16384
 ds_read_b64_tr_b16 v[202:203], v250 offset:17408
 s_waitcnt lgkmcnt(8)
 v_mfma_f32_32x32x16_bf16 v[0:15], v[104:107], v[208:211], v[0:15]
 ds_read_b64_tr_b16 v[204:205], v251 offset:16448
 ds_read_b64_tr_b16 v[206:207], v251 offset:17472
 s_waitcnt lgkmcnt(8)
 v_mfma_f32_32x32x16_bf16 v[16:31], v[104:107], v[212:215], v[16:31]
 ds_read_b64_tr_b16 v[208:209], v250 offset:18432
 ds_read_b64_tr_b16 v[210:211], v250 offset:19456
 s_waitcnt lgkmcnt(8)
 v_mfma_f32_32x32x16_bf16 v[0:15], v[108:111], v[192:195], v[0:15]
 v_cvt_pk_bf16_f32 v216, v32, v33
 v_cvt_pk_bf16_f32 v217, v34, v35
 v_cvt_pk_bf16_f32 v218, v36, v37
 ds_read_b64_tr_b16 v[212:213], v251 offset:18496
 ds_read_b64_tr_b16 v[214:215], v251 offset:19520
 s_waitcnt lgkmcnt(8)
 v_mfma_f32_32x32x16_bf16 v[16:31], v[108:111], v[196:199], v[16:31]
 ds_read_b64_tr_b16 v[192:193], v250 offset:20480
 ds_read_b64_tr_b16 v[194:195], v250 offset:21504
 s_waitcnt lgkmcnt(8)
 v_mfma_f32_32x32x16_bf16 v[0:15], v[112:115], v[200:203], v[0:15]
 v_cvt_pk_bf16_f32 v219, v38, v39
 v_cvt_pk_bf16_f32 v220, v40, v41
 v_cvt_pk_bf16_f32 v221, v42, v43
 ds_read_b64_tr_b16 v[196:197], v251 offset:20544
 ds_read_b64_tr_b16 v[198:199], v251 offset:21568
 s_waitcnt lgkmcnt(8)
 v_mfma_f32_32x32x16_bf16 v[16:31], v[112:115], v[204:207], v[16:31]
 ds_read_b64_tr_b16 v[200:201], v250 offset:22528
 ds_read_b64_tr_b16 v[202:203], v250 offset:23552
 s_waitcnt lgkmcnt(8)
 v_mfma_f32_32x32x16_bf16 v[0:15], v[116:119], v[208:211], v[0:15]
 v_cvt_pk_bf16_f32 v222, v44, v45
 v_cvt_pk_bf16_f32 v223, v46, v47
 buffer_store_dwordx4 v[216:219], v244, s[8:11], s53 offen offset:0 sc1
 ds_read_b64_tr_b16 v[204:205], v251 offset:22592
 ds_read_b64_tr_b16 v[206:207], v251 offset:23616
 s_waitcnt lgkmcnt(8)
 v_mfma_f32_32x32x16_bf16 v[16:31], v[116:119], v[212:215], v[16:31]
 ds_read_b64_tr_b16 v[208:209], v250 offset:24576
 ds_read_b64_tr_b16 v[210:211], v250 offset:25600
 s_waitcnt lgkmcnt(8)
 v_mfma_f32_32x32x16_bf16 v[0:15], v[120:123], v[192:195], v[0:15]
 buffer_store_dwordx4 v[220:223], v244, s[8:11], s53 offen offset:1024 sc1
 v_cvt_pk_bf16_f32 v224, v48, v49
 v_cvt_pk_bf16_f32 v225, v50, v51
 ds_read_b64_tr_b16 v[212:213], v251 offset:24640
 ds_read_b64_tr_b16 v[214:215], v251 offset:25664
 s_waitcnt lgkmcnt(8)
 v_mfma_f32_32x32x16_bf16 v[16:31], v[120:123], v[196:199], v[16:31]
 ds_read_b64_tr_b16 v[192:193], v250 offset:26624
 ds_read_b64_tr_b16 v[194:195], v250 offset:27648
 s_waitcnt lgkmcnt(8)
 v_mfma_f32_32x32x16_bf16 v[0:15], v[124:127], v[200:203], v[0:15]
 v_cvt_pk_bf16_f32 v226, v52, v53
 v_cvt_pk_bf16_f32 v227, v54, v55
 v_cvt_pk_bf16_f32 v228, v56, v57
 ds_read_b64_tr_b16 v[196:197], v251 offset:26688
 ds_read_b64_tr_b16 v[198:199], v251 offset:27712
 s_waitcnt lgkmcnt(8)
 v_mfma_f32_32x32x16_bf16 v[16:31], v[124:127], v[204:207], v[16:31]
 ds_read_b64_tr_b16 v[200:201], v250 offset:28672
 ds_read_b64_tr_b16 v[202:203], v250 offset:29696
 s_waitcnt lgkmcnt(8)
 v_mfma_f32_32x32x16_bf16 v[0:15], v[128:131], v[208:211], v[0:15]
 v_cvt_pk_bf16_f32 v229, v58, v59
 v_cvt_pk_bf16_f32 v230, v60, v61
 v_cvt_pk_bf16_f32 v231, v62, v63
 ds_read_b64_tr_b16 v[204:205], v251 offset:28736
 ds_read_b64_tr_b16 v[206:207], v251 offset:29760
 s_waitcnt lgkmcnt(8)
 v_mfma_f32_32x32x16_bf16 v[16:31], v[128:131], v[212:215], v[16:31]
 ds_read_b64_tr_b16 v[208:209], v250 offset:30720
 ds_read_b64_tr_b16 v[210:211], v250 offset:31744
 s_waitcnt lgkmcnt(8)
 v_mfma_f32_32x32x16_bf16 v[0:15], v[132:135], v[192:195], v[0:15]
 buffer_store_dwordx4 v[224:227], v244, s[8:11], s53 offen offset:2048 sc1
 buffer_store_dwordx4 v[228:231], v244, s[8:11], s53 offen offset:3072 sc1
 s_add_u32 s53, s53, 4096
 ds_read_b64_tr_b16 v[212:213], v251 offset:30784
 ds_read_b64_tr_b16 v[214:215], v251 offset:31808
 s_waitcnt lgkmcnt(8)
 v_mfma_f32_32x32x16_bf16 v[16:31], v[132:135], v[196:199], v[16:31]
 ds_read_b64_tr_b16 v[192:193], v250 offset:32768
 ds_read_b64_tr_b16 v[194:195], v250 offset:33792
 s_waitcnt lgkmcnt(8)
 v_mfma_f32_32x32x16_bf16 v[0:15], v[136:139], v[200:203], v[0:15]
 ds_read_b64_tr_b16 v[196:197], v251 offset:32832
 ds_read_b64_tr_b16 v[198:199], v251 offset:33856
 s_waitcnt lgkmcnt(8)
 v_mfma_f32_32x32x16_bf16 v[16:31], v[136:139], v[204:207], v[16:31]
 ds_read_b64_tr_b16 v[200:201], v250 offset:34816
 ds_read_b64_tr_b16 v[202:203], v250 offset:35840
 s_waitcnt lgkmcnt(8)
 v_mfma_f32_32x32x16_bf16 v[0:15], v[140:143], v[208:211], v[0:15]
 ds_read_b64_tr_b16 v[204:205], v251 offset:34880
 ds_read_b64_tr_b16 v[206:207], v251 offset:35904
 s_waitcnt lgkmcnt(8)
 v_mfma_f32_32x32x16_bf16 v[16:31], v[140:143], v[212:215], v[16:31]
 s_barrier
 ds_read_b64_tr_b16 v[208:209], v250 offset:36864
 ds_read_b64_tr_b16 v[210:211], v250 offset:37888
 s_waitcnt lgkmcnt(8)
 v_mfma_f32_32x32x16_bf16 v[32:47], v[96:99], v[192:195], 0
 ds_read_b64_tr_b16 v[212:213], v251 offset:36928
 ds_read_b64_tr_b16 v[214:215], v251 offset:37952
 s_waitcnt lgkmcnt(8)
 v_mfma_f32_32x32x16_bf16 v[48:63], v[96:99], v[196:199], 0
 ds_read_b64_tr_b16 v[192:193], v250 offset:38912
 ds_read_b64_tr_b16 v[194:195], v250 offset:39936
 s_waitcnt lgkmcnt(8)
 v_mfma_f32_32x32x16_bf16 v[32:47], v[100:103], v[200:203], v[32:47]
 ds_read_b64_tr_b16 v[196:197], v251 offset:38976
 ds_read_b64_tr_b16 v[198:199], v251 offset:40000
 s_waitcnt lgkmcnt(8)
 v_mfma_f32_32x32x16_bf16 v[48:63], v[100:103], v[204:207], v[48:63]
 ds_read_b64_tr_b16 v[200:201], v250 offset:40960
 ds_read_b64_tr_b16 v[202:203], v250 offset:41984
 s_waitcnt lgkmcnt(8)
 v_mfma_f32_32x32x16_bf16 v[32:47], v[104:107], v[208:211], v[32:47]
 ds_read_b64_tr_b16 v[204:205], v251 offset:41024
 ds_read_b64_tr_b16 v[206:207], v251 offset:42048
 s_waitcnt lgkmcnt(8)
 v_mfma_f32_32x32x16_bf16 v[48:63], v[104:107], v[212:215], v[48:63]
 ds_read_b64_tr_b16 v[208:209], v250 offset:43008
 ds_read_b64_tr_b16 v[210:211], v250 offset:44032
 s_waitcnt lgkmcnt(8)
 v_mfma_f32_32x32x16_bf16 v[32:47], v[108:111], v[192:195], v[32:47]
 v_cvt_pk_bf16_f32 v216, v0, v1
 v_cvt_pk_bf16_f32 v217, v2, v3
 v_cvt_pk_bf16_f32 v218, v4, v5
 ds_read_b64_tr_b16 v[212:213], v251 offset:43072
 ds_read_b64_tr_b16 v[214:215], v251 offset:44096
 s_waitcnt lgkmcnt(8)
 v_mfma_f32_32x32x16_bf16 v[48:63], v[108:111], v[196:199], v[48:63]
 ds_read_b64_tr_b16 v[192:193], v250 offset:45056
 ds_read_b64_tr_b16 v[194:195], v250 offset:46080
 s_waitcnt lgkmcnt(8)
 v_mfma_f32_32x32x16_bf16 v[32:47], v[112:115], v[200:203], v[32:47]
 v_cvt_pk_bf16_f32 v219, v6, v7
 v_cvt_pk_bf16_f32 v220, v8, v9
 v_cvt_pk_bf16_f32 v221, v10, v11
 ds_read_b64_tr_b16 v[196:197], v251 offset:45120
 ds_read_b64_tr_b16 v[198:199], v251 offset:46144
 s_waitcnt lgkmcnt(8)
 v_mfma_f32_32x32x16_bf16 v[48:63], v[112:115], v[204:207], v[48:63]
 ds_read_b64_tr_b16 v[200:201], v250 offset:47104
 ds_read_b64_tr_b16 v[202:203], v250 offset:48128
 s_waitcnt lgkmcnt(8)
 v_mfma_f32_32x32x16_bf16 v[32:47], v[116:119], v[208:211], v[32:47]
 v_cvt_pk_bf16_f32 v222, v12, v13
 v_cvt_pk_bf16_f32 v223, v14, v15
 buffer_store_dwordx4 v[216:219], v244, s[8:11], s53 offen offset:0 sc1
 ds_read_b64_tr_b16 v[204:205], v251 offset:47168
 ds_read_b64_tr_b16 v[206:207], v251 offset:48192
 s_waitcnt lgkmcnt(8)
 v_mfma_f32_32x32x16_bf16 v[48:63], v[116:119], v[212:215], v[48:63]
 ds_read_b64_tr_b16 v[208:209], v250 offset:49152
 ds_read_b64_tr_b16 v[210:211], v250 offset:50176
 s_waitcnt lgkmcnt(8)
 v_mfma_f32_32x32x16_bf16 v[32:47], v[120:123], v[192:195], v[32:47]
 buffer_store_dwordx4 v[220:223], v244, s[8:11], s53 offen offset:1024 sc1
 v_cvt_pk_bf16_f32 v224, v16, v17
 v_cvt_pk_bf16_f32 v225, v18, v19
 ds_read_b64_tr_b16 v[212:213], v251 offset:49216
 ds_read_b64_tr_b16 v[214:215], v251 offset:50240
 s_waitcnt lgkmcnt(8)
 v_mfma_f32_32x32x16_bf16 v[48:63], v[120:123], v[196:199], v[48:63]
 ds_read_b64_tr_b16 v[192:193], v250 offset:51200
 ds_read_b64_tr_b16 v[194:195], v250 offset:52224
 s_waitcnt lgkmcnt(8)
 v_mfma_f32_32x32x16_bf16 v[32:47], v[124:127], v[200:203], v[32:47]
 v_cvt_pk_bf16_f32 v226, v20, v21
 v_cvt_pk_bf16_f32 v227, v22, v23
 v_cvt_pk_bf16_f32 v228, v24, v25
 ds_read_b64_tr_b16 v[196:197], v251 offset:51264
 ds_read_b64_tr_b16 v[198:199], v251 offset:52288
 s_waitcnt lgkmcnt(8)
 v_mfma_f32_32x32x16_bf16 v[48:63], v[124:127], v[204:207], v[48:63]
 ds_read_b64_tr_b16 v[200:201], v250 offset:53248
 ds_read_b64_tr_b16 v[202:203], v250 offset:54272
 s_waitcnt lgkmcnt(8)
 v_mfma_f32_32x32x16_bf16 v[32:47], v[128:131], v[208:211], v[32:47]
 v_cvt_pk_bf16_f32 v229, v26, v27
 v_cvt_pk_bf16_f32 v230, v28, v29
 v_cvt_pk_bf16_f32 v231, v30, v31
 ds_read_b64_tr_b16 v[204:205], v251 offset:53312
 ds_read_b64_tr_b16 v[206:207], v251 offset:54336
 s_waitcnt lgkmcnt(8)
 v_mfma_f32_32x32x16_bf16 v[48:63], v[128:131], v[212:215], v[48:63]
 ds_read_b64_tr_b16 v[208:209], v250 offset:55296
 ds_read_b64_tr_b16 v[210:211], v250 offset:56320
 s_waitcnt lgkmcnt(8)
 v_mfma_f32_32x32x16_bf16 v[32:47], v[132:135], v[192:195], v[32:47]
 buffer_store_dwordx4 v[224:227], v244, s[8:11], s53 offen offset:2048 sc1
 buffer_store_dwordx4 v[228:231], v244, s[8:11], s53 offen offset:3072 sc1
 s_add_u32 s53, s53, 4096
 ds_read_b64_tr_b16 v[212:213], v251 offset:55360
 ds_read_b64_tr_b16 v[214:215], v251 offset:56384
 s_waitcnt lgkmcnt(8)
 v_mfma_f32_32x32x16_bf16 v[48:63], v[132:135], v[196:199], v[48:63]
 s_waitcnt lgkmcnt(6)
 v_mfma_f32_32x32x16_bf16 v[32:47], v[136:139], v[200:203], v[32:47]
 s_waitcnt lgkmcnt(4)
 v_mfma_f32_32x32x16_bf16 v[48:63], v[136:139], v[204:207], v[48:63]
 s_waitcnt lgkmcnt(2)
 v_mfma_f32_32x32x16_bf16 v[32:47], v[140:143], v[208:211], v[32:47]
 s_waitcnt lgkmcnt(0)
 v_mfma_f32_32x32x16_bf16 v[48:63], v[140:143], v[212:215], v[48:63]
 s_nop 15
 s_nop 3
 v_cvt_pk_bf16_f32 v216, v32, v33
 v_cvt_pk_bf16_f32 v217, v34, v35
 v_cvt_pk_bf16_f32 v218, v36, v37
 v_cvt_pk_bf16_f32 v219, v38, v39
 v_cvt_pk_bf16_f32 v220, v40, v41
 v_cvt_pk_bf16_f32 v221, v42, v43
 v_cvt_pk_bf16_f32 v222, v44, v45
 v_cvt_pk_bf16_f32 v223, v46, v47
 buffer_store_dwordx4 v[216:219], v244, s[8:11], s53 offen offset:0 sc1
 buffer_store_dwordx4 v[220:223], v244, s[8:11], s53 offen offset:1024 sc1
 v_cvt_pk_bf16_f32 v224, v48, v49
 v_cvt_pk_bf16_f32 v225, v50, v51
 v_cvt_pk_bf16_f32 v226, v52, v53
 v_cvt_pk_bf16_f32 v227, v54, v55
 v_cvt_pk_bf16_f32 v228, v56, v57
 v_cvt_pk_bf16_f32 v229, v58, v59
 v_cvt_pk_bf16_f32 v230, v60, v61
 v_cvt_pk_bf16_f32 v231, v62, v63
 buffer_store_dwordx4 v[224:227], v244, s[8:11], s53 offen offset:2048 sc1
 buffer_store_dwordx4 v[228:231], v244, s[8:11], s53 offen offset:3072 sc1
 s_add_u32 s53, s53, 4096
 s_lshl_b32 s28, s50, 5
 s_add_u32 s28, s28, s51
 s_lshl_b32 s28, s28, 2
 s_add_u32 s28, s28, 6328320
 s_waitcnt vmcnt(0)
 s_barrier
 s_cmp_eq_u32 s14, 0
 s_cbranch_scc0 sg_58
 s_mov_b64 exec, 1
 v_mov_b32 v233, 0
 v_mov_b32 v234, 2
 buffer_atomic_add v234, v233, s[8:11], s28 offen sc1
 s_mov_b64 exec, -1
sg_58:
 s_branch wk_next
wk_sp:
 s_sub_u32 s50, s50, 1
 s_and_b32 s49, s48, 1
 s_bitcmp1_b32 s48, 1
 s_cbranch_scc1 wk_sv
 s_mul_i32 s52, s51, 384
 s_cmp_eq_u32 s49, 0
 s_cselect_b32 s64, s20, s24
 s_cselect_b32 s65, s21, s25
 s_mov_b32 s66, 0x780000
 s_mov_b32 s67, 0x20000
 s_mov_b32 s28, 71303168
 s_cselect_b32 s54, s28, 46137344
 s_cselect_b64 vcc, -1, 0
 v_cndmask_b32 v244, v245, v244, vcc
 s_lshl_b32 s48, s50, 2
 s_add_u32 s48, s48, s14
 s_mul_i32 s48, s48, 40960
 s_lshl_b32 s53, s50, 2
 s_add_u32 s53, s53, s14
 s_lshl_b32 s53, s53, 5
 s_add_u32 s53, s53, s51
 s_mul_i32 s53, s53, 12288
 s_add_u32 s53, s53, s54
 s_add_u32 m0, s19, 0
 s_add_u32 s29, s52, 0
 buffer_load_dwordx4 v236, s[64:67], s29 offen lds
 s_add_u32 m0, s19, 1024
 s_add_u32 s29, s52, 0
 buffer_load_dwordx4 v237, s[64:67], s29 offen lds
 s_add_u32 m0, s19, 2048
 s_add_u32 s29, s52, 0
 buffer_load_dwordx4 v238, s[64:67], s29 offen lds
 s_add_u32 m0, s19, 3072
 s_add_u32 s29, s52, 98304
 buffer_load_dwordx4 v236, s[64:67], s29 offen lds
 s_add_u32 m0, s19, 4096
 s_add_u32 s29, s52, 98304
 buffer_load_dwordx4 v237, s[64:67], s29 offen lds
 s_add_u32 m0, s19, 5120
 s_add_u32 s29, s52, 98304
 buffer_load_dwordx4 v238, s[64:67], s29 offen lds
 buffer_load_dwordx4 a[0:3], v232, s[8:11], s48 offen offset:0
 buffer_load_dwordx4 a[4:7], v232, s[8:11], s48 offen offset:1024
 buffer_load_dwordx4 a[8:11], v232, s[8:11], s48 offen offset:2048
 buffer_load_dwordx4 a[12:15], v232, s[8:11], s48 offen offset:3072
 s_add_u32 s48, s48, 4096
 s_add_u32 m0, s19, 24576
 s_add_u32 s29, s52, 786432
 buffer_load_dwordx4 v236, s[64:67], s29 offen lds
 s_add_u32 m0, s19, 25600
 s_add_u32 s29, s52, 786432
 buffer_load_dwordx4 v237, s[64:67], s29 offen lds
 s_add_u32 m0, s19, 26624
 s_add_u32 s29, s52, 786432
 buffer_load_dwordx4 v238, s[64:67], s29 offen lds
 s_add_u32 m0, s19, 27648
 s_add_u32 s29, s52, 884736
 buffer_load_dwordx4 v236, s[64:67], s29 offen lds
 s_add_u32 m0, s19, 28672
 s_add_u32 s29, s52, 884736
 buffer_load_dwordx4 v237, s[64:67], s29 offen lds
 s_add_u32 m0, s19, 29696
 s_add_u32 s29, s52, 884736
 buffer_load_dwordx4 v238, s[64:67], s29 offen lds
 buffer_load_dwordx4 a[16:19], v232, s[8:11], s48 offen offset:0
 buffer_load_dwordx4 a[20:23], v232, s[8:11], s48 offen offset:1024
 buffer_load_dwordx4 a[24:27], v232, s[8:11], s48 offen offset:2048
 buffer_load_dwordx4 a[28:31], v232, s[8:11], s48 offen offset:3072
 s_add_u32 s48, s48, 4096
 s_add_u32 m0, s19, 49152
 s_add_u32 s29, s52, 1572864
 buffer_load_dwordx4 v236, s[64:67], s29 offen lds
 s_add_u32 m0, s19, 50176
 s_add_u32 s29, s52, 1572864
 buffer_load_dwordx4 v237, s[64:67], s29 offen lds
 s_add_u32 m0, s19, 51200
 s_add_u32 s29, s52, 1572864
 buffer_load_dwordx4 v238, s[64:67], s29 offen lds
 s_add_u32 m0, s19, 52224
 s_add_u32 s29, s52, 1671168
 buffer_load_dwordx4 v236, s[64:67], s29 offen lds
 s_add_u32 m0, s19, 53248
 s_add_u32 s29, s52, 1671168
 buffer_load_dwordx4 v237, s[64:67], s29 offen lds
 s_add_u32 m0, s19, 54272
 s_add_u32 s29, s52, 1671168
 buffer_load_dwordx4 v238, s[64:67], s29 offen lds
 buffer_load_dwordx4 a[32:35], v232, s[8:11], s48 offen offset:0
 buffer_load_dwordx4 a[36:39], v232, s[8:11], s48 offen offset:1024
 buffer_load_dwordx4 a[40:43], v232, s[8:11], s48 offen offset:2048
 buffer_load_dwordx4 a[44:47], v232, s[8:11], s48 offen offset:3072
 s_add_u32 s48, s48, 4096
 s_add_u32 m0, s19, 73728
 s_add_u32 s29, s52, 2359296
 buffer_load_dwordx4 v236, s[64:67], s29 offen lds
 s_add_u32 m0, s19, 74752
 s_add_u32 s29, s52, 2359296
 buffer_load_dwordx4 v237, s[64:67], s29 offen lds
 s_add_u32 m0, s19, 75776
 s_add_u32 s29, s52, 2359296
 buffer_load_dwordx4 v238, s[64:67], s29 offen lds
 s_add_u32 m0, s19, 76800
 s_add_u32 s29, s52, 2457600
 buffer_load_dwordx4 v236, s[64:67], s29 offen lds
 s_add_u32 m0, s19, 77824
 s_add_u32 s29, s52, 2457600
 buffer_load_dwordx4 v237, s[64:67], s29 offen lds
 s_add_u32 m0, s19, 78848
 s_add_u32 s29, s52, 2457600
 buffer_load_dwordx4 v238, s[64:67], s29 offen lds
 buffer_load_dwordx4 a[48:51], v232, s[8:11], s48 offen offset:0
 buffer_load_dwordx4 a[52:55], v232, s[8:11], s48 offen offset:1024
 buffer_load_dwordx4 a[56:59], v232, s[8:11], s48 offen offset:2048
 buffer_load_dwordx4 a[60:63], v232, s[8:11], s48 offen offset:3072
 s_add_u32 s48, s48, 4096
 s_waitcnt vmcnt(34)
 s_waitcnt vmcnt(24)
 s_barrier
 ds_read_b64_tr_b16 v[192:193], v240 offset:0
 ds_read_b64_tr_b16 v[194:195], v240 offset:1536
 ds_read_b64_tr_b16 v[196:197], v241 offset:64
 ds_read_b64_tr_b16 v[198:199], v241 offset:1600
 ds_read_b64_tr_b16 v[200:201], v240 offset:128
 ds_read_b64_tr_b16 v[202:203], v240 offset:1664
 ds_read_b64_tr_b16 v[204:205], v241 offset:192
 ds_read_b64_tr_b16 v[206:207], v241 offset:1728
 ds_read_b64_tr_b16 v[208:209], v240 offset:256
 ds_read_b64_tr_b16 v[210:211], v240 offset:1792
 s_waitcnt lgkmcnt(8)
 v_mfma_f32_32x32x16_bf16 v[0:15], v[192:195], a[0:3], 0
 ds_read_b64_tr_b16 v[212:213], v241 offset:320
 ds_read_b64_tr_b16 v[214:215], v241 offset:1856
 s_waitcnt lgkmcnt(8)
 v_mfma_f32_32x32x16_bf16 v[16:31], v[196:199], a[0:3], 0
 s_add_u32 m0, s19, 98304
 s_add_u32 s29, s52, 3145728
 buffer_load_dwordx4 v236, s[64:67], s29 offen lds
 s_add_u32 m0, s19, 99328
 s_add_u32 s29, s52, 3145728
 buffer_load_dwordx4 v237, s[64:67], s29 offen lds
 s_add_u32 m0, s19, 100352
 s_add_u32 s29, s52, 3145728
 buffer_load_dwordx4 v238, s[64:67], s29 offen lds
 s_add_u32 m0, s19, 101376
 s_add_u32 s29, s52, 3244032
 buffer_load_dwordx4 v236, s[64:67], s29 offen lds
 s_add_u32 m0, s19, 102400
 s_add_u32 s29, s52, 3244032
 buffer_load_dwordx4 v237, s[64:67], s29 offen lds
 s_add_u32 m0, s19, 103424
 s_add_u32 s29, s52, 3244032
 buffer_load_dwordx4 v238, s[64:67], s29 offen lds
 ds_read_b64_tr_b16 v[192:193], v240 offset:6144
 ds_read_b64_tr_b16 v[194:195], v240 offset:7680
 s_waitcnt lgkmcnt(8)
 v_mfma_f32_32x32x16_bf16 v[32:47], v[200:203], a[0:3], 0
 ds_read_b64_tr_b16 v[196:197], v241 offset:6208
 ds_read_b64_tr_b16 v[198:199], v241 offset:7744
 s_waitcnt lgkmcnt(8)
 v_mfma_f32_32x32x16_bf16 v[48:63], v[204:207], a[0:3], 0
 ds_read_b64_tr_b16 v[200:201], v240 offset:6272
 ds_read_b64_tr_b16 v[202:203], v240 offset:7808
 s_waitcnt lgkmcnt(8)
 v_mfma_f32_32x32x16_bf16 v[64:79], v[208:211], a[0:3], 0
 ds_read_b64_tr_b16 v[204:205], v241 offset:6336
 ds_read_b64_tr_b16 v[206:207], v241 offset:7872
 s_waitcnt lgkmcnt(8)
 v_mfma_f32_32x32x16_bf16 v[80:95], v[212:215], a[0:3], 0
 ds_read_b64_tr_b16 v[208:209], v240 offset:6400
 ds_read_b64_tr_b16 v[210:211], v240 offset:7936
 s_waitcnt lgkmcnt(8)
 v_mfma_f32_32x32x16_bf16 v[0:15], v[192:195], a[4:7], v[0:15]
 ds_read_b64_tr_b16 v[212:213], v241 offset:6464
 ds_read_b64_tr_b16 v[214:215], v241 offset:8000
 s_waitcnt lgkmcnt(8)
 v_mfma_f32_32x32x16_bf16 v[16:31], v[196:199], a[4:7], v[16:31]
 ds_read_b64_tr_b16 v[192:193], v240 offset:12288
 ds_read_b64_tr_b16 v[194:195], v240 offset:13824
 s_waitcnt lgkmcnt(8)
 v_mfma_f32_32x32x16_bf16 v[32:47], v[200:203], a[4:7], v[32:47]
 buffer_load_dwordx4 a[64:67], v232, s[8:11], s48 offen offset:0
 buffer_load_dwordx4 a[68:71], v232, s[8:11], s48 offen offset:1024
 buffer_load_dwordx4 a[72:75], v232, s[8:11], s48 offen offset:2048
 buffer_load_dwordx4 a[76:79], v232, s[8:11], s48 offen offset:3072
 s_add_u32 s48, s48, 4096
 ds_read_b64_tr_b16 v[196:197], v241 offset:12352
 ds_read_b64_tr_b16 v[198:199], v241 offset:13888
 s_waitcnt lgkmcnt(8)
 v_mfma_f32_32x32x16_bf16 v[48:63], v[204:207], a[4:7], v[48:63]
 ds_read_b64_tr_b16 v[200:201], v240 offset:12416
 ds_read_b64_tr_b16 v[202:203], v240 offset:13952
 s_waitcnt lgkmcnt(8)
 v_mfma_f32_32x32x16_bf16 v[64:79], v[208:211], a[4:7], v[64:79]
 ds_read_b64_tr_b16 v[204:205], v241 offset:12480
 ds_read_b64_tr_b16 v[206:207], v241 offset:14016
 s_waitcnt lgkmcnt(8)
 v_mfma_f32_32x32x16_bf16 v[80:95], v[212:215], a[4:7], v[80:95]
 ds_read_b64_tr_b16 v[208:209], v240 offset:12544
 ds_read_b64_tr_b16 v[210:211], v240 offset:14080
 s_waitcnt lgkmcnt(8)
 v_mfma_f32_32x32x16_bf16 v[0:15], v[192:195], a[8:11], v[0:15]
 ds_read_b64_tr_b16 v[212:213], v241 offset:12608
 ds_read_b64_tr_b16 v[214:215], v241 offset:14144
 s_waitcnt lgkmcnt(8)
 v_mfma_f32_32x32x16_bf16 v[16:31], v[196:199], a[8:11], v[16:31]
 ds_read_b64_tr_b16 v[192:193], v240 offset:18432
 ds_read_b64_tr_b16 v[194:195], v240 offset:19968
 s_waitcnt lgkmcnt(8)
 v_mfma_f32_32x32x16_bf16 v[32:47], v[200:203], a[8:11], v[32:47]
 ds_read_b64_tr_b16 v[196:197], v241 offset:18496
 ds_read_b64_tr_b16 v[198:199], v241 offset:20032
 s_waitcnt lgkmcnt(8)
 v_mfma_f32_32x32x16_bf16 v[48:63], v[204:207], a[8:11], v[48:63]
 ds_read_b64_tr_b16 v[200:201], v240 offset:18560
 ds_read_b64_tr_b16 v[202:203], v240 offset:20096
 s_waitcnt lgkmcnt(8)
 v_mfma_f32_32x32x16_bf16 v[64:79], v[208:211], a[8:11], v[64:79]
 ds_read_b64_tr_b16 v[204:205], v241 offset:18624
 ds_read_b64_tr_b16 v[206:207], v241 offset:20160
 s_waitcnt lgkmcnt(8)
 v_mfma_f32_32x32x16_bf16 v[80:95], v[212:215], a[8:11], v[80:95]
 ds_read_b64_tr_b16 v[208:209], v240 offset:18688
 ds_read_b64_tr_b16 v[210:211], v240 offset:20224
 s_waitcnt lgkmcnt(8)
 v_mfma_f32_32x32x16_bf16 v[0:15], v[192:195], a[12:15], v[0:15]
 ds_read_b64_tr_b16 v[212:213], v241 offset:18752
 ds_read_b64_tr_b16 v[214:215], v241 offset:20288
 s_waitcnt lgkmcnt(8)
 v_mfma_f32_32x32x16_bf16 v[16:31], v[196:199], a[12:15], v[16:31]
 ds_read_b64_tr_b16 v[192:193], v240 offset:24576
 ds_read_b64_tr_b16 v[194:195], v240 offset:26112
 s_waitcnt lgkmcnt(8)
 v_mfma_f32_32x32x16_bf16 v[32:47], v[200:203], a[12:15], v[32:47]
 ds_read_b64_tr_b16 v[196:197], v241 offset:24640
 ds_read_b64_tr_b16 v[198:199], v241 offset:26176
 s_waitcnt lgkmcnt(8)
 v_mfma_f32_32x32x16_bf16 v[48:63], v[204:207], a[12:15], v[48:63]
 ds_read_b64_tr_b16 v[200:201], v240 offset:24704
 ds_read_b64_tr_b16 v[202:203], v240 offset:26240
 s_waitcnt lgkmcnt(8)
 v_mfma_f32_32x32x16_bf16 v[64:79], v[208:211], a[12:15], v[64:79]
 ds_read_b64_tr_b16 v[204:205], v241 offset:24768
 ds_read_b64_tr_b16 v[206:207], v241 offset:26304
 s_waitcnt lgkmcnt(8)
 v_mfma_f32_32x32x16_bf16 v[80:95], v[212:215], a[12:15], v[80:95]
 s_waitcnt vmcnt(24)
 s_barrier
 ds_read_b64_tr_b16 v[208:209], v240 offset:24832
 ds_read_b64_tr_b16 v[210:211], v240 offset:26368
 s_waitcnt lgkmcnt(8)
 v_mfma_f32_32x32x16_bf16 v[0:15], v[192:195], a[16:19], v[0:15]
 ds_read_b64_tr_b16 v[212:213], v241 offset:24896
 ds_read_b64_tr_b16 v[214:215], v241 offset:26432
 s_waitcnt lgkmcnt(8)
 v_mfma_f32_32x32x16_bf16 v[16:31], v[196:199], a[16:19], v[16:31]
 s_add_u32 m0, s19, 0
 s_add_u32 s29, s52, 3932160
 buffer_load_dwordx4 v236, s[64:67], s29 offen lds
 s_add_u32 m0, s19, 1024
 s_add_u32 s29, s52, 3932160
 buffer_load_dwordx4 v237, s[64:67], s29 offen lds
 s_add_u32 m0, s19, 2048
 s_add_u32 s29, s52, 3932160
 buffer_load_dwordx4 v238, s[64:67], s29 offen lds
 s_add_u32 m0, s19, 3072
 s_add_u32 s29, s52, 4030464
 buffer_load_dwordx4 v236, s[64:67], s29 offen lds
 s_add_u32 m0, s19, 4096
 s_add_u32 s29, s52, 4030464
 buffer_load_dwordx4 v237, s[64:67], s29 offen lds
 s_add_u32 m0, s19, 5120
 s_add_u32 s29, s52, 4030464
 buffer_load_dwordx4 v238, s[64:67], s29 offen lds
 ds_read_b64_tr_b16 v[192:193], v240 offset:30720
 ds_read_b64_tr_b16 v[194:195], v240 offset:32256
 s_waitcnt lgkmcnt(8)
 v_mfma_f32_32x32x16_bf16 v[32:47], v[200:203], a[16:19], v[32:47]
 ds_read_b64_tr_b16 v[196:197], v241 offset:30784
 ds_read_b64_tr_b16 v[198:199], v241 offset:32320
 s_waitcnt lgkmcnt(8)
 v_mfma_f32_32x32x16_bf16 v[48:63], v[204:207], a[16:19], v[48:63]
 ds_read_b64_tr_b16 v[200:201], v240 offset:30848
 ds_read_b64_tr_b16 v[202:203], v240 offset:32384
 s_waitcnt lgkmcnt(8)
 v_mfma_f32_32x32x16_bf16 v[64:79], v[208:211], a[16:19], v[64:79]
 ds_read_b64_tr_b16 v[204:205], v241 offset:30912
 ds_read_b64_tr_b16 v[206:207], v241 offset:32448
 s_waitcnt lgkmcnt(8)
 v_mfma_f32_32x32x16_bf16 v[80:95], v[212:215], a[16:19], v[80:95]
 ds_read_b64_tr_b16 v[208:209], v240 offset:30976
 ds_read_b64_tr_b16 v[210:211], v240 offset:32512
 s_waitcnt lgkmcnt(8)
 v_mfma_f32_32x32x16_bf16 v[0:15], v[192:195], a[20:23], v[0:15]
 ds_read_b64_tr_b16 v[212:213], v241 offset:31040
 ds_read_b64_tr_b16 v[214:215], v241 offset:32576
 s_waitcnt lgkmcnt(8)
 v_mfma_f32_32x32x16_bf16 v[16:31], v[196:199], a[20:23], v[16:31]
 ds_read_b64_tr_b16 v[192:193], v240 offset:36864
 ds_read_b64_tr_b16 v[194:195], v240 offset:38400
 s_waitcnt lgkmcnt(8)
 v_mfma_f32_32x32x16_bf16 v[32:47], v[200:203], a[20:23], v[32:47]
 buffer_load_dwordx4 a[80:83], v232, s[8:11], s48 offen offset:0
 buffer_load_dwordx4 a[84:87], v232, s[8:11], s48 offen offset:1024
 buffer_load_dwordx4 a[88:91], v232, s[8:11], s48 offen offset:2048
 buffer_load_dwordx4 a[92:95], v232, s[8:11], s48 offen offset:3072
 s_add_u32 s48, s48, 4096
 ds_read_b64_tr_b16 v[196:197], v241 offset:36928
 ds_read_b64_tr_b16 v[198:199], v241 offset:38464
 s_waitcnt lgkmcnt(8)
 v_mfma_f32_32x32x16_bf16 v[48:63], v[204:207], a[20:23], v[48:63]
 ds_read_b64_tr_b16 v[200:201], v240 offset:36992
 ds_read_b64_tr_b16 v[202:203], v240 offset:38528
 s_waitcnt lgkmcnt(8)
 v_mfma_f32_32x32x16_bf16 v[64:79], v[208:211], a[20:23], v[64:79]
 ds_read_b64_tr_b16 v[204:205], v241 offset:37056
 ds_read_b64_tr_b16 v[206:207], v241 offset:38592
 s_waitcnt lgkmcnt(8)
 v_mfma_f32_32x32x16_bf16 v[80:95], v[212:215], a[20:23], v[80:95]
 ds_read_b64_tr_b16 v[208:209], v240 offset:37120
 ds_read_b64_tr_b16 v[210:211], v240 offset:38656
 s_waitcnt lgkmcnt(8)
 v_mfma_f32_32x32x16_bf16 v[0:15], v[192:195], a[24:27], v[0:15]
 ds_read_b64_tr_b16 v[212:213], v241 offset:37184
 ds_read_b64_tr_b16 v[214:215], v241 offset:38720
 s_waitcnt lgkmcnt(8)
 v_mfma_f32_32x32x16_bf16 v[16:31], v[196:199], a[24:27], v[16:31]
 ds_read_b64_tr_b16 v[192:193], v240 offset:43008
 ds_read_b64_tr_b16 v[194:195], v240 offset:44544
 s_waitcnt lgkmcnt(8)
 v_mfma_f32_32x32x16_bf16 v[32:47], v[200:203], a[24:27], v[32:47]
 ds_read_b64_tr_b16 v[196:197], v241 offset:43072
 ds_read_b64_tr_b16 v[198:199], v241 offset:44608
 s_waitcnt lgkmcnt(8)
 v_mfma_f32_32x32x16_bf16 v[48:63], v[204:207], a[24:27], v[48:63]
 ds_read_b64_tr_b16 v[200:201], v240 offset:43136
 ds_read_b64_tr_b16 v[202:203], v240 offset:44672
 s_waitcnt lgkmcnt(8)
 v_mfma_f32_32x32x16_bf16 v[64:79], v[208:211], a[24:27], v[64:79]
 ds_read_b64_tr_b16 v[204:205], v241 offset:43200
 ds_read_b64_tr_b16 v[206:207], v241 offset:44736
 s_waitcnt lgkmcnt(8)
 v_mfma_f32_32x32x16_bf16 v[80:95], v[212:215], a[24:27], v[80:95]
 ds_read_b64_tr_b16 v[208:209], v240 offset:43264
 ds_read_b64_tr_b16 v[210:211], v240 offset:44800
 s_waitcnt lgkmcnt(8)
 v_mfma_f32_32x32x16_bf16 v[0:15], v[192:195], a[28:31], v[0:15]
 ds_read_b64_tr_b16 v[212:213], v241 offset:43328
 ds_read_b64_tr_b16 v[214:215], v241 offset:44864
 s_waitcnt lgkmcnt(8)
 v_mfma_f32_32x32x16_bf16 v[16:31], v[196:199], a[28:31], v[16:31]
 ds_read_b64_tr_b16 v[192:193], v240 offset:49152
 ds_read_b64_tr_b16 v[194:195], v240 offset:50688
 s_waitcnt lgkmcnt(8)
 v_mfma_f32_32x32x16_bf16 v[32:47], v[200:203], a[28:31], v[32:47]
 ds_read_b64_tr_b16 v[196:197], v241 offset:49216
 ds_read_b64_tr_b16 v[198:199], v241 offset:50752
 s_waitcnt lgkmcnt(8)
 v_mfma_f32_32x32x16_bf16 v[48:63], v[204:207], a[28:31], v[48:63]
 ds_read_b64_tr_b16 v[200:201], v240 offset:49280
 ds_read_b64_tr_b16 v[202:203], v240 offset:50816
 s_waitcnt lgkmcnt(8)
 v_mfma_f32_32x32x16_bf16 v[64:79], v[208:211], a[28:31], v[64:79]
 ds_read_b64_tr_b16 v[204:205], v241 offset:49344
 ds_read_b64_tr_b16 v[206:207], v241 offset:50880
 s_waitcnt lgkmcnt(8)
 v_mfma_f32_32x32x16_bf16 v[80:95], v[212:215], a[28:31], v[80:95]
 s_waitcnt vmcnt(24)
 s_barrier
 ds_read_b64_tr_b16 v[208:209], v240 offset:49408
 ds_read_b64_tr_b16 v[210:211], v240 offset:50944
 s_waitcnt lgkmcnt(8)
 v_mfma_f32_32x32x16_bf16 v[0:15], v[192:195], a[32:35], v[0:15]
 ds_read_b64_tr_b16 v[212:213], v241 offset:49472
 ds_read_b64_tr_b16 v[214:215], v241 offset:51008
 s_waitcnt lgkmcnt(8)
 v_mfma_f32_32x32x16_bf16 v[16:31], v[196:199], a[32:35], v[16:31]
 s_add_u32 m0, s19, 24576
 s_add_u32 s29, s52, 4718592
 buffer_load_dwordx4 v236, s[64:67], s29 offen lds
 s_add_u32 m0, s19, 25600
 s_add_u32 s29, s52, 4718592
 buffer_load_dwordx4 v237, s[64:67], s29 offen lds
 s_add_u32 m0, s19, 26624
 s_add_u32 s29, s52, 4718592
 buffer_load_dwordx4 v238, s[64:67], s29 offen lds
 s_add_u32 m0, s19, 27648
 s_add_u32 s29, s52, 4816896
 buffer_load_dwordx4 v236, s[64:67], s29 offen lds
 s_add_u32 m0, s19, 28672
 s_add_u32 s29, s52, 4816896
 buffer_load_dwordx4 v237, s[64:67], s29 offen lds
 s_add_u32 m0, s19, 29696
 s_add_u32 s29, s52, 4816896
 buffer_load_dwordx4 v238, s[64:67], s29 offen lds
 ds_read_b64_tr_b16 v[192:193], v240 offset:55296
 ds_read_b64_tr_b16 v[194:195], v240 offset:56832
 s_waitcnt lgkmcnt(8)
 v_mfma_f32_32x32x16_bf16 v[32:47], v[200:203], a[32:35], v[32:47]
 ds_read_b64_tr_b16 v[196:197], v241 offset:55360
 ds_read_b64_tr_b16 v[198:199], v241 offset:56896
 s_waitcnt lgkmcnt(8)
 v_mfma_f32_32x32x16_bf16 v[48:63], v[204:207], a[32:35], v[48:63]
 ds_read_b64_tr_b16 v[200:201], v240 offset:55424
 ds_read_b64_tr_b16 v[202:203], v240 offset:56960
 s_waitcnt lgkmcnt(8)
 v_mfma_f32_32x32x16_bf16 v[64:79], v[208:211], a[32:35], v[64:79]
 ds_read_b64_tr_b16 v[204:205], v241 offset:55488
 ds_read_b64_tr_b16 v[206:207], v241 offset:57024
 s_waitcnt lgkmcnt(8)
 v_mfma_f32_32x32x16_bf16 v[80:95], v[212:215], a[32:35], v[80:95]
 ds_read_b64_tr_b16 v[208:209], v240 offset:55552
 ds_read_b64_tr_b16 v[210:211], v240 offset:57088
 s_waitcnt lgkmcnt(8)
 v_mfma_f32_32x32x16_bf16 v[0:15], v[192:195], a[36:39], v[0:15]
 ds_read_b64_tr_b16 v[212:213], v241 offset:55616
 ds_read_b64_tr_b16 v[214:215], v241 offset:57152
 s_waitcnt lgkmcnt(8)
 v_mfma_f32_32x32x16_bf16 v[16:31], v[196:199], a[36:39], v[16:31]
 ds_read_b64_tr_b16 v[192:193], v240 offset:61440
 ds_read_b64_tr_b16 v[194:195], v240 offset:62976
 s_waitcnt lgkmcnt(8)
 v_mfma_f32_32x32x16_bf16 v[32:47], v[200:203], a[36:39], v[32:47]
 buffer_load_dwordx4 a[96:99], v232, s[8:11], s48 offen offset:0
 buffer_load_dwordx4 a[100:103], v232, s[8:11], s48 offen offset:1024
 buffer_load_dwordx4 a[104:107], v232, s[8:11], s48 offen offset:2048
 buffer_load_dwordx4 a[108:111], v232, s[8:11], s48 offen offset:3072
 s_add_u32 s48, s48, 4096
 ds_read_b64_tr_b16 v[196:197], v241 offset:61504
 ds_read_b64_tr_b16 v[198:199], v241 offset:63040
 s_waitcnt lgkmcnt(8)
 v_mfma_f32_32x32x16_bf16 v[48:63], v[204:207], a[36:39], v[48:63]
 ds_read_b64_tr_b16 v[200:201], v240 offset:61568
 ds_read_b64_tr_b16 v[202:203], v240 offset:63104
 s_waitcnt lgkmcnt(8)
 v_mfma_f32_32x32x16_bf16 v[64:79], v[208:211], a[36:39], v[64:79]
 ds_read_b64_tr_b16 v[204:205], v241 offset:61632
 ds_read_b64_tr_b16 v[206:207], v241 offset:63168
 s_waitcnt lgkmcnt(8)
 v_mfma_f32_32x32x16_bf16 v[80:95], v[212:215], a[36:39], v[80:95]
 ds_read_b64_tr_b16 v[208:209], v240 offset:61696
 ds_read_b64_tr_b16 v[210:211], v240 offset:63232
 s_waitcnt lgkmcnt(8)
 v_mfma_f32_32x32x16_bf16 v[0:15], v[192:195], a[40:43], v[0:15]
 ds_read_b64_tr_b16 v[212:213], v241 offset:61760
 ds_read_b64_tr_b16 v[214:215], v241 offset:63296
 s_waitcnt lgkmcnt(8)
 v_mfma_f32_32x32x16_bf16 v[16:31], v[196:199], a[40:43], v[16:31]
 ds_read_b64_tr_b16 v[192:193], v248 offset:2048
 ds_read_b64_tr_b16 v[194:195], v248 offset:3584
 s_waitcnt lgkmcnt(8)
 v_mfma_f32_32x32x16_bf16 v[32:47], v[200:203], a[40:43], v[32:47]
 ds_read_b64_tr_b16 v[196:197], v249 offset:2112
 ds_read_b64_tr_b16 v[198:199], v249 offset:3648
 s_waitcnt lgkmcnt(8)
 v_mfma_f32_32x32x16_bf16 v[48:63], v[204:207], a[40:43], v[48:63]
 ds_read_b64_tr_b16 v[200:201], v248 offset:2176
 ds_read_b64_tr_b16 v[202:203], v248 offset:3712
 s_waitcnt lgkmcnt(8)
 v_mfma_f32_32x32x16_bf16 v[64:79], v[208:211], a[40:43], v[64:79]
 ds_read_b64_tr_b16 v[204:205], v249 offset:2240
 ds_read_b64_tr_b16 v[206:207], v249 offset:3776
 s_waitcnt lgkmcnt(8)
 v_mfma_f32_32x32x16_bf16 v[80:95], v[212:215], a[40:43], v[80:95]
 ds_read_b64_tr_b16 v[208:209], v248 offset:2304
 ds_read_b64_tr_b16 v[210:211], v248 offset:3840
 s_waitcnt lgkmcnt(8)
 v_mfma_f32_32x32x16_bf16 v[0:15], v[192:195], a[44:47], v[0:15]
 ds_read_b64_tr_b16 v[212:213], v249 offset:2368
 ds_read_b64_tr_b16 v[214:215], v249 offset:3904
 s_waitcnt lgkmcnt(8)
 v_mfma_f32_32x32x16_bf16 v[16:31], v[196:199], a[44:47], v[16:31]
 ds_read_b64_tr_b16 v[192:193], v248 offset:8192
 ds_read_b64_tr_b16 v[194:195], v248 offset:9728
 s_waitcnt lgkmcnt(8)
 v_mfma_f32_32x32x16_bf16 v[32:47], v[200:203], a[44:47], v[32:47]
 ds_read_b64_tr_b16 v[196:197], v249 offset:8256
 ds_read_b64_tr_b16 v[198:199], v249 offset:9792
 s_waitcnt lgkmcnt(8)
 v_mfma_f32_32x32x16_bf16 v[48:63], v[204:207], a[44:47], v[48:63]
 ds_read_b64_tr_b16 v[200:201], v248 offset:8320
 ds_read_b64_tr_b16 v[202:203], v248 offset:9856
 s_waitcnt lgkmcnt(8)
 v_mfma_f32_32x32x16_bf16 v[64:79], v[208:211], a[44:47], v[64:79]
 ds_read_b64_tr_b16 v[204:205], v249 offset:8384
 ds_read_b64_tr_b16 v[206:207], v249 offset:9920
 s_waitcnt lgkmcnt(8)
 v_mfma_f32_32x32x16_bf16 v[80:95], v[212:215], a[44:47], v[80:95]
 s_waitcnt vmcnt(24)
 s_barrier
 ds_read_b64_tr_b16 v[208:209], v248 offset:8448
 ds_read_b64_tr_b16 v[210:211], v248 offset:9984
 s_waitcnt lgkmcnt(8)
 v_mfma_f32_32x32x16_bf16 v[0:15], v[192:195], a[48:51], v[0:15]
 ds_read_b64_tr_b16 v[212:213], v249 offset:8512
 ds_read_b64_tr_b16 v[214:215], v249 offset:10048
 s_waitcnt lgkmcnt(8)
 v_mfma_f32_32x32x16_bf16 v[16:31], v[196:199], a[48:51], v[16:31]
 s_add_u32 m0, s19, 49152
 s_add_u32 s29, s52, 5505024
 buffer_load_dwordx4 v236, s[64:67], s29 offen lds
 s_add_u32 m0, s19, 50176
 s_add_u32 s29, s52, 5505024
 buffer_load_dwordx4 v237, s[64:67], s29 offen lds
 s_add_u32 m0, s19, 51200
 s_add_u32 s29, s52, 5505024
 buffer_load_dwordx4 v238, s[64:67], s29 offen lds
 s_add_u32 m0, s19, 52224
 s_add_u32 s29, s52, 5603328
 buffer_load_dwordx4 v236, s[64:67], s29 offen lds
 s_add_u32 m0, s19, 53248
 s_add_u32 s29, s52, 5603328
 buffer_load_dwordx4 v237, s[64:67], s29 offen lds
 s_add_u32 m0, s19, 54272
 s_add_u32 s29, s52, 5603328
 buffer_load_dwordx4 v238, s[64:67], s29 offen lds
 ds_read_b64_tr_b16 v[192:193], v248 offset:14336
 ds_read_b64_tr_b16 v[194:195], v248 offset:15872
 s_waitcnt lgkmcnt(8)
 v_mfma_f32_32x32x16_bf16 v[32:47], v[200:203], a[48:51], v[32:47]
 ds_read_b64_tr_b16 v[196:197], v249 offset:14400
 ds_read_b64_tr_b16 v[198:199], v249 offset:15936
 s_waitcnt lgkmcnt(8)
 v_mfma_f32_32x32x16_bf16 v[48:63], v[204:207], a[48:51], v[48:63]
 ds_read_b64_tr_b16 v[200:201], v248 offset:14464
 ds_read_b64_tr_b16 v[202:203], v248 offset:16000
 s_waitcnt lgkmcnt(8)
 v_mfma_f32_32x32x16_bf16 v[64:79], v[208:211], a[48:51], v[64:79]
 ds_read_b64_tr_b16 v[204:205], v249 offset:14528
 ds_read_b64_tr_b16 v[206:207], v249 offset:16064
 s_waitcnt lgkmcnt(8)
 v_mfma_f32_32x32x16_bf16 v[80:95], v[212:215], a[48:51], v[80:95]
 ds_read_b64_tr_b16 v[208:209], v248 offset:14592
 ds_read_b64_tr_b16 v[210:211], v248 offset:16128
 s_waitcnt lgkmcnt(8)
 v_mfma_f32_32x32x16_bf16 v[0:15], v[192:195], a[52:55], v[0:15]
 ds_read_b64_tr_b16 v[212:213], v249 offset:14656
 ds_read_b64_tr_b16 v[214:215], v249 offset:16192
 s_waitcnt lgkmcnt(8)
 v_mfma_f32_32x32x16_bf16 v[16:31], v[196:199], a[52:55], v[16:31]
 ds_read_b64_tr_b16 v[192:193], v248 offset:20480
 ds_read_b64_tr_b16 v[194:195], v248 offset:22016
 s_waitcnt lgkmcnt(8)
 v_mfma_f32_32x32x16_bf16 v[32:47], v[200:203], a[52:55], v[32:47]
 buffer_load_dwordx4 a[112:115], v232, s[8:11], s48 offen offset:0
 buffer_load_dwordx4 a[116:119], v232, s[8:11], s48 offen offset:1024
 buffer_load_dwordx4 a[120:123], v232, s[8:11], s48 offen offset:2048
 buffer_load_dwordx4 a[124:127], v232, s[8:11], s48 offen offset:3072
 s_add_u32 s48, s48, 4096
 ds_read_b64_tr_b16 v[196:197], v249 offset:20544
 ds_read_b64_tr_b16 v[198:199], v249 offset:22080
 s_waitcnt lgkmcnt(8)
 v_mfma_f32_32x32x16_bf16 v[48:63], v[204:207], a[52:55], v[48:63]
 ds_read_b64_tr_b16 v[200:201], v248 offset:20608
 ds_read_b64_tr_b16 v[202:203], v248 offset:22144
 s_waitcnt lgkmcnt(8)
 v_mfma_f32_32x32x16_bf16 v[64:79], v[208:211], a[52:55], v[64:79]
 ds_read_b64_tr_b16 v[204:205], v249 offset:20672
 ds_read_b64_tr_b16 v[206:207], v249 offset:22208
 s_waitcnt lgkmcnt(8)
 v_mfma_f32_32x32x16_bf16 v[80:95], v[212:215], a[52:55], v[80:95]
 ds_read_b64_tr_b16 v[208:209], v248 offset:20736
 ds_read_b64_tr_b16 v[210:211], v248 offset:22272
 s_waitcnt lgkmcnt(8)
 v_mfma_f32_32x32x16_bf16 v[0:15], v[192:195], a[56:59], v[0:15]
 ds_read_b64_tr_b16 v[212:213], v249 offset:20800
 ds_read_b64_tr_b16 v[214:215], v249 offset:22336
 s_waitcnt lgkmcnt(8)
 v_mfma_f32_32x32x16_bf16 v[16:31], v[196:199], a[56:59], v[16:31]
 ds_read_b64_tr_b16 v[192:193], v248 offset:26624
 ds_read_b64_tr_b16 v[194:195], v248 offset:28160
 s_waitcnt lgkmcnt(8)
 v_mfma_f32_32x32x16_bf16 v[32:47], v[200:203], a[56:59], v[32:47]
 ds_read_b64_tr_b16 v[196:197], v249 offset:26688
 ds_read_b64_tr_b16 v[198:199], v249 offset:28224
 s_waitcnt lgkmcnt(8)
 v_mfma_f32_32x32x16_bf16 v[48:63], v[204:207], a[56:59], v[48:63]
 ds_read_b64_tr_b16 v[200:201], v248 offset:26752
 ds_read_b64_tr_b16 v[202:203], v248 offset:28288
 s_waitcnt lgkmcnt(8)
 v_mfma_f32_32x32x16_bf16 v[64:79], v[208:211], a[56:59], v[64:79]
 ds_read_b64_tr_b16 v[204:205], v249 offset:26816
 ds_read_b64_tr_b16 v[206:207], v249 offset:28352
 s_waitcnt lgkmcnt(8)
 v_mfma_f32_32x32x16_bf16 v[80:95], v[212:215], a[56:59], v[80:95]
 ds_read_b64_tr_b16 v[208:209], v248 offset:26880
 ds_read_b64_tr_b16 v[210:211], v248 offset:28416
 s_waitcnt lgkmcnt(8)
 v_mfma_f32_32x32x16_bf16 v[0:15], v[192:195], a[60:63], v[0:15]
 ds_read_b64_tr_b16 v[212:213], v249 offset:26944
 ds_read_b64_tr_b16 v[214:215], v249 offset:28480
 s_waitcnt lgkmcnt(8)
 v_mfma_f32_32x32x16_bf16 v[16:31], v[196:199], a[60:63], v[16:31]
 ds_read_b64_tr_b16 v[192:193], v248 offset:32768
 ds_read_b64_tr_b16 v[194:195], v248 offset:34304
 s_waitcnt lgkmcnt(8)
 v_mfma_f32_32x32x16_bf16 v[32:47], v[200:203], a[60:63], v[32:47]
 ds_read_b64_tr_b16 v[196:197], v249 offset:32832
 ds_read_b64_tr_b16 v[198:199], v249 offset:34368
 s_waitcnt lgkmcnt(8)
 v_mfma_f32_32x32x16_bf16 v[48:63], v[204:207], a[60:63], v[48:63]
 ds_read_b64_tr_b16 v[200:201], v248 offset:32896
 ds_read_b64_tr_b16 v[202:203], v248 offset:34432
 s_waitcnt lgkmcnt(8)
 v_mfma_f32_32x32x16_bf16 v[64:79], v[208:211], a[60:63], v[64:79]
 ds_read_b64_tr_b16 v[204:205], v249 offset:32960
 ds_read_b64_tr_b16 v[206:207], v249 offset:34496
 s_waitcnt lgkmcnt(8)
 v_mfma_f32_32x32x16_bf16 v[80:95], v[212:215], a[60:63], v[80:95]
 s_waitcnt vmcnt(24)
 s_barrier
 ds_read_b64_tr_b16 v[208:209], v248 offset:33024
 ds_read_b64_tr_b16 v[210:211], v248 offset:34560
 s_waitcnt lgkmcnt(8)
 v_mfma_f32_32x32x16_bf16 v[0:15], v[192:195], a[64:67], v[0:15]
 ds_read_b64_tr_b16 v[212:213], v249 offset:33088
 ds_read_b64_tr_b16 v[214:215], v249 offset:34624
 s_waitcnt lgkmcnt(8)
 v_mfma_f32_32x32x16_bf16 v[16:31], v[196:199], a[64:67], v[16:31]
 s_add_u32 m0, s19, 73728
 s_add_u32 s29, s52, 6291456
 buffer_load_dwordx4 v236, s[64:67], s29 offen lds
 s_add_u32 m0, s19, 74752
 s_add_u32 s29, s52, 6291456
 buffer_load_dwordx4 v237, s[64:67], s29 offen lds
 s_add_u32 m0, s19, 75776
 s_add_u32 s29, s52, 6291456
 buffer_load_dwordx4 v238, s[64:67], s29 offen lds
 s_add_u32 m0, s19, 76800
 s_add_u32 s29, s52, 6389760
 buffer_load_dwordx4 v236, s[64:67], s29 offen lds
 s_add_u32 m0, s19, 77824
 s_add_u32 s29, s52, 6389760
 buffer_load_dwordx4 v237, s[64:67], s29 offen lds
 s_add_u32 m0, s19, 78848
 s_add_u32 s29, s52, 6389760
 buffer_load_dwordx4 v238, s[64:67], s29 offen lds
 ds_read_b64_tr_b16 v[192:193], v248 offset:38912
 ds_read_b64_tr_b16 v[194:195], v248 offset:40448
 s_waitcnt lgkmcnt(8)
 v_mfma_f32_32x32x16_bf16 v[32:47], v[200:203], a[64:67], v[32:47]
 ds_read_b64_tr_b16 v[196:197], v249 offset:38976
 ds_read_b64_tr_b16 v[198:199], v249 offset:40512
 s_waitcnt lgkmcnt(8)
 v_mfma_f32_32x32x16_bf16 v[48:63], v[204:207], a[64:67], v[48:63]
 ds_read_b64_tr_b16 v[200:201], v248 offset:39040
 ds_read_b64_tr_b16 v[202:203], v248 offset:40576
 s_waitcnt lgkmcnt(8)
 v_mfma_f32_32x32x16_bf16 v[64:79], v[208:211], a[64:67], v[64:79]
 ds_read_b64_tr_b16 v[204:205], v249 offset:39104
 ds_read_b64_tr_b16 v[206:207], v249 offset:40640
 s_waitcnt lgkmcnt(8)
 v_mfma_f32_32x32x16_bf16 v[80:95], v[212:215], a[64:67], v[80:95]
 ds_read_b64_tr_b16 v[208:209], v248 offset:39168
 ds_read_b64_tr_b16 v[210:211], v248 offset:40704
 s_waitcnt lgkmcnt(8)
 v_mfma_f32_32x32x16_bf16 v[0:15], v[192:195], a[68:71], v[0:15]
 ds_read_b64_tr_b16 v[212:213], v249 offset:39232
 ds_read_b64_tr_b16 v[214:215], v249 offset:40768
 s_waitcnt lgkmcnt(8)
 v_mfma_f32_32x32x16_bf16 v[16:31], v[196:199], a[68:71], v[16:31]
 ds_read_b64_tr_b16 v[192:193], v248 offset:45056
 ds_read_b64_tr_b16 v[194:195], v248 offset:46592
 s_waitcnt lgkmcnt(8)
 v_mfma_f32_32x32x16_bf16 v[32:47], v[200:203], a[68:71], v[32:47]
 buffer_load_dwordx4 a[128:131], v232, s[8:11], s48 offen offset:0
 buffer_load_dwordx4 a[132:135], v232, s[8:11], s48 offen offset:1024
 buffer_load_dwordx4 a[136:139], v232, s[8:11], s48 offen offset:2048
 buffer_load_dwordx4 a[140:143], v232, s[8:11], s48 offen offset:3072
 s_add_u32 s48, s48, 4096
 ds_read_b64_tr_b16 v[196:197], v249 offset:45120
 ds_read_b64_tr_b16 v[198:199], v249 offset:46656
 s_waitcnt lgkmcnt(8)
 v_mfma_f32_32x32x16_bf16 v[48:63], v[204:207], a[68:71], v[48:63]
 ds_read_b64_tr_b16 v[200:201], v248 offset:45184
 ds_read_b64_tr_b16 v[202:203], v248 offset:46720
 s_waitcnt lgkmcnt(8)
 v_mfma_f32_32x32x16_bf16 v[64:79], v[208:211], a[68:71], v[64:79]
 ds_read_b64_tr_b16 v[204:205], v249 offset:45248
 ds_read_b64_tr_b16 v[206:207], v249 offset:46784
 s_waitcnt lgkmcnt(8)
 v_mfma_f32_32x32x16_bf16 v[80:95], v[212:215], a[68:71], v[80:95]
 ds_read_b64_tr_b16 v[208:209], v248 offset:45312
 ds_read_b64_tr_b16 v[210:211], v248 offset:46848
 s_waitcnt lgkmcnt(8)
 v_mfma_f32_32x32x16_bf16 v[0:15], v[192:195], a[72:75], v[0:15]
 ds_read_b64_tr_b16 v[212:213], v249 offset:45376
 ds_read_b64_tr_b16 v[214:215], v249 offset:46912
 s_waitcnt lgkmcnt(8)
 v_mfma_f32_32x32x16_bf16 v[16:31], v[196:199], a[72:75], v[16:31]
 ds_read_b64_tr_b16 v[192:193], v248 offset:51200
 ds_read_b64_tr_b16 v[194:195], v248 offset:52736
 s_waitcnt lgkmcnt(8)
 v_mfma_f32_32x32x16_bf16 v[32:47], v[200:203], a[72:75], v[32:47]
 ds_read_b64_tr_b16 v[196:197], v249 offset:51264
 ds_read_b64_tr_b16 v[198:199], v249 offset:52800
 s_waitcnt lgkmcnt(8)
 v_mfma_f32_32x32x16_bf16 v[48:63], v[204:207], a[72:75], v[48:63]
 ds_read_b64_tr_b16 v[200:201], v248 offset:51328
 ds_read_b64_tr_b16 v[202:203], v248 offset:52864
 s_waitcnt lgkmcnt(8)
 v_mfma_f32_32x32x16_bf16 v[64:79], v[208:211], a[72:75], v[64:79]
 ds_read_b64_tr_b16 v[204:205], v249 offset:51392
 ds_read_b64_tr_b16 v[206:207], v249 offset:52928
 s_waitcnt lgkmcnt(8)
 v_mfma_f32_32x32x16_bf16 v[80:95], v[212:215], a[72:75], v[80:95]
 ds_read_b64_tr_b16 v[208:209], v248 offset:51456
 ds_read_b64_tr_b16 v[210:211], v248 offset:52992
 s_waitcnt lgkmcnt(8)
 v_mfma_f32_32x32x16_bf16 v[0:15], v[192:195], a[76:79], v[0:15]
 ds_read_b64_tr_b16 v[212:213], v249 offset:51520
 ds_read_b64_tr_b16 v[214:215], v249 offset:53056
 s_waitcnt lgkmcnt(8)
 v_mfma_f32_32x32x16_bf16 v[16:31], v[196:199], a[76:79], v[16:31]
 ds_read_b64_tr_b16 v[192:193], v240 offset:0
 ds_read_b64_tr_b16 v[194:195], v240 offset:1536
 s_waitcnt lgkmcnt(8)
 v_mfma_f32_32x32x16_bf16 v[32:47], v[200:203], a[76:79], v[32:47]
 ds_read_b64_tr_b16 v[196:197], v241 offset:64
 ds_read_b64_tr_b16 v[198:199], v241 offset:1600
 s_waitcnt lgkmcnt(8)
 v_mfma_f32_32x32x16_bf16 v[48:63], v[204:207], a[76:79], v[48:63]
 ds_read_b64_tr_b16 v[200:201], v240 offset:128
 ds_read_b64_tr_b16 v[202:203], v240 offset:1664
 s_waitcnt lgkmcnt(8)
 v_mfma_f32_32x32x16_bf16 v[64:79], v[208:211], a[76:79], v[64:79]
 ds_read_b64_tr_b16 v[204:205], v241 offset:192
 ds_read_b64_tr_b16 v[206:207], v241 offset:1728
 s_waitcnt lgkmcnt(8)
 v_mfma_f32_32x32x16_bf16 v[80:95], v[212:215], a[76:79], v[80:95]
 s_waitcnt vmcnt(24)
 s_barrier
 ds_read_b64_tr_b16 v[208:209], v240 offset:256
 ds_read_b64_tr_b16 v[210:211], v240 offset:1792
 s_waitcnt lgkmcnt(8)
 v_mfma_f32_32x32x16_bf16 v[0:15], v[192:195], a[80:83], v[0:15]
 ds_read_b64_tr_b16 v[212:213], v241 offset:320
 ds_read_b64_tr_b16 v[214:215], v241 offset:1856
 s_waitcnt lgkmcnt(8)
 v_mfma_f32_32x32x16_bf16 v[16:31], v[196:199], a[80:83], v[16:31]
 s_add_u32 m0, s19, 98304
 s_add_u32 s29, s52, 7077888
 buffer_load_dwordx4 v236, s[64:67], s29 offen lds
 s_add_u32 m0, s19, 99328
 s_add_u32 s29, s52, 7077888
 buffer_load_dwordx4 v237, s[64:67], s29 offen lds
 s_add_u32 m0, s19, 100352
 s_add_u32 s29, s52, 7077888
 buffer_load_dwordx4 v238, s[64:67], s29 offen lds
 s_add_u32 m0, s19, 101376
 s_add_u32 s29, s52, 7176192
 buffer_load_dwordx4 v236, s[64:67], s29 offen lds
 s_add_u32 m0, s19, 102400
 s_add_u32 s29, s52, 7176192
 buffer_load_dwordx4 v237, s[64:67], s29 offen lds
 s_add_u32 m0, s19, 103424
 s_add_u32 s29, s52, 7176192
 buffer_load_dwordx4 v238, s[64:67], s29 offen lds
 ds_read_b64_tr_b16 v[192:193], v240 offset:6144
 ds_read_b64_tr_b16 v[194:195], v240 offset:7680
 s_waitcnt lgkmcnt(8)
 v_mfma_f32_32x32x16_bf16 v[32:47], v[200:203], a[80:83], v[32:47]
 ds_read_b64_tr_b16 v[196:197], v241 offset:6208
 ds_read_b64_tr_b16 v[198:199], v241 offset:7744
 s_waitcnt lgkmcnt(8)
 v_mfma_f32_32x32x16_bf16 v[48:63], v[204:207], a[80:83], v[48:63]
 ds_read_b64_tr_b16 v[200:201], v240 offset:6272
 ds_read_b64_tr_b16 v[202:203], v240 offset:7808
 s_waitcnt lgkmcnt(8)
 v_mfma_f32_32x32x16_bf16 v[64:79], v[208:211], a[80:83], v[64:79]
 ds_read_b64_tr_b16 v[204:205], v241 offset:6336
 ds_read_b64_tr_b16 v[206:207], v241 offset:7872
 s_waitcnt lgkmcnt(8)
 v_mfma_f32_32x32x16_bf16 v[80:95], v[212:215], a[80:83], v[80:95]
 ds_read_b64_tr_b16 v[208:209], v240 offset:6400
 ds_read_b64_tr_b16 v[210:211], v240 offset:7936
 s_waitcnt lgkmcnt(8)
 v_mfma_f32_32x32x16_bf16 v[0:15], v[192:195], a[84:87], v[0:15]
 ds_read_b64_tr_b16 v[212:213], v241 offset:6464
 ds_read_b64_tr_b16 v[214:215], v241 offset:8000
 s_waitcnt lgkmcnt(8)
 v_mfma_f32_32x32x16_bf16 v[16:31], v[196:199], a[84:87], v[16:31]
 ds_read_b64_tr_b16 v[192:193], v240 offset:12288
 ds_read_b64_tr_b16 v[194:195], v240 offset:13824
 s_waitcnt lgkmcnt(8)
 v_mfma_f32_32x32x16_bf16 v[32:47], v[200:203], a[84:87], v[32:47]
 buffer_load_dwordx4 a[144:147], v232, s[8:11], s48 offen offset:0
 buffer_load_dwordx4 a[148:151], v232, s[8:11], s48 offen offset:1024
 buffer_load_dwordx4 a[152:155], v232, s[8:11], s48 offen offset:2048
 buffer_load_dwordx4 a[156:159], v232, s[8:11], s48 offen offset:3072
 s_add_u32 s48, s48, 4096
 ds_read_b64_tr_b16 v[196:197], v241 offset:12352
 ds_read_b64_tr_b16 v[198:199], v241 offset:13888
 s_waitcnt lgkmcnt(8)
 v_mfma_f32_32x32x16_bf16 v[48:63], v[204:207], a[84:87], v[48:63]
 ds_read_b64_tr_b16 v[200:201], v240 offset:12416
 ds_read_b64_tr_b16 v[202:203], v240 offset:13952
 s_waitcnt lgkmcnt(8)
 v_mfma_f32_32x32x16_bf16 v[64:79], v[208:211], a[84:87], v[64:79]
 ds_read_b64_tr_b16 v[204:205], v241 offset:12480
 ds_read_b64_tr_b16 v[206:207], v241 offset:14016
 s_waitcnt lgkmcnt(8)
 v_mfma_f32_32x32x16_bf16 v[80:95], v[212:215], a[84:87], v[80:95]
 ds_read_b64_tr_b16 v[208:209], v240 offset:12544
 ds_read_b64_tr_b16 v[210:211], v240 offset:14080
 s_waitcnt lgkmcnt(8)
 v_mfma_f32_32x32x16_bf16 v[0:15], v[192:195], a[88:91], v[0:15]
 ds_read_b64_tr_b16 v[212:213], v241 offset:12608
 ds_read_b64_tr_b16 v[214:215], v241 offset:14144
 s_waitcnt lgkmcnt(8)
 v_mfma_f32_32x32x16_bf16 v[16:31], v[196:199], a[88:91], v[16:31]
 ds_read_b64_tr_b16 v[192:193], v240 offset:18432
 ds_read_b64_tr_b16 v[194:195], v240 offset:19968
 s_waitcnt lgkmcnt(8)
 v_mfma_f32_32x32x16_bf16 v[32:47], v[200:203], a[88:91], v[32:47]
 ds_read_b64_tr_b16 v[196:197], v241 offset:18496
 ds_read_b64_tr_b16 v[198:199], v241 offset:20032
 s_waitcnt lgkmcnt(8)
 v_mfma_f32_32x32x16_bf16 v[48:63], v[204:207], a[88:91], v[48:63]
 ds_read_b64_tr_b16 v[200:201], v240 offset:18560
 ds_read_b64_tr_b16 v[202:203], v240 offset:20096
 s_waitcnt lgkmcnt(8)
 v_mfma_f32_32x32x16_bf16 v[64:79], v[208:211], a[88:91], v[64:79]
 ds_read_b64_tr_b16 v[204:205], v241 offset:18624
 ds_read_b64_tr_b16 v[206:207], v241 offset:20160
 s_waitcnt lgkmcnt(8)
 v_mfma_f32_32x32x16_bf16 v[80:95], v[212:215], a[88:91], v[80:95]
 ds_read_b64_tr_b16 v[208:209], v240 offset:18688
 ds_read_b64_tr_b16 v[210:211], v240 offset:20224
 s_waitcnt lgkmcnt(8)
 v_mfma_f32_32x32x16_bf16 v[0:15], v[192:195], a[92:95], v[0:15]
 ds_read_b64_tr_b16 v[212:213], v241 offset:18752
 ds_read_b64_tr_b16 v[214:215], v241 offset:20288
 s_waitcnt lgkmcnt(8)
 v_mfma_f32_32x32x16_bf16 v[16:31], v[196:199], a[92:95], v[16:31]
 ds_read_b64_tr_b16 v[192:193], v240 offset:24576
 ds_read_b64_tr_b16 v[194:195], v240 offset:26112
 s_waitcnt lgkmcnt(8)
 v_mfma_f32_32x32x16_bf16 v[32:47], v[200:203], a[92:95], v[32:47]
 ds_read_b64_tr_b16 v[196:197], v241 offset:24640
 ds_read_b64_tr_b16 v[198:199], v241 offset:26176
 s_waitcnt lgkmcnt(8)
 v_mfma_f32_32x32x16_bf16 v[48:63], v[204:207], a[92:95], v[48:63]
 ds_read_b64_tr_b16 v[200:201], v240 offset:24704
 ds_read_b64_tr_b16 v[202:203], v240 offset:26240
 s_waitcnt lgkmcnt(8)
 v_mfma_f32_32x32x16_bf16 v[64:79], v[208:211], a[92:95], v[64:79]
 ds_read_b64_tr_b16 v[204:205], v241 offset:24768
 ds_read_b64_tr_b16 v[206:207], v241 offset:26304
 s_waitcnt lgkmcnt(8)
 v_mfma_f32_32x32x16_bf16 v[80:95], v[212:215], a[92:95], v[80:95]
 s_waitcnt vmcnt(24)
 s_barrier
 ds_read_b64_tr_b16 v[208:209], v240 offset:24832
 ds_read_b64_tr_b16 v[210:211], v240 offset:26368
 s_waitcnt lgkmcnt(8)
 v_mfma_f32_32x32x16_bf16 v[0:15], v[192:195], a[96:99], v[0:15]
 ds_read_b64_tr_b16 v[212:213], v241 offset:24896
 ds_read_b64_tr_b16 v[214:215], v241 offset:26432
 s_waitcnt lgkmcnt(8)
 v_mfma_f32_32x32x16_bf16 v[16:31], v[196:199], a[96:99], v[16:31]
 ds_read_b64_tr_b16 v[192:193], v240 offset:30720
 ds_read_b64_tr_b16 v[194:195], v240 offset:32256
 s_waitcnt lgkmcnt(8)
 v_mfma_f32_32x32x16_bf16 v[32:47], v[200:203], a[96:99], v[32:47]
 ds_read_b64_tr_b16 v[196:197], v241 offset:30784
 ds_read_b64_tr_b16 v[198:199], v241 offset:32320
 s_waitcnt lgkmcnt(8)
 v_mfma_f32_32x32x16_bf16 v[48:63], v[204:207], a[96:99], v[48:63]
 ds_read_b64_tr_b16 v[200:201], v240 offset:30848
 ds_read_b64_tr_b16 v[202:203], v240 offset:32384
 s_waitcnt lgkmcnt(8)
 v_mfma_f32_32x32x16_bf16 v[64:79], v[208:211], a[96:99], v[64:79]
 ds_read_b64_tr_b16 v[204:205], v241 offset:30912
 ds_read_b64_tr_b16 v[206:207], v241 offset:32448
 s_waitcnt lgkmcnt(8)
 v_mfma_f32_32x32x16_bf16 v[80:95], v[212:215], a[96:99], v[80:95]
 ds_read_b64_tr_b16 v[208:209], v240 offset:30976
 ds_read_b64_tr_b16 v[210:211], v240 offset:32512
 s_waitcnt lgkmcnt(8)
 v_mfma_f32_32x32x16_bf16 v[0:15], v[192:195], a[100:103], v[0:15]
 ds_read_b64_tr_b16 v[212:213], v241 offset:31040
 ds_read_b64_tr_b16 v[214:215], v241 offset:32576
 s_waitcnt lgkmcnt(8)
 v_mfma_f32_32x32x16_bf16 v[16:31], v[196:199], a[100:103], v[16:31]
 ds_read_b64_tr_b16 v[192:193], v240 offset:36864
 ds_read_b64_tr_b16 v[194:195], v240 offset:38400
 s_waitcnt lgkmcnt(8)
 v_mfma_f32_32x32x16_bf16 v[32:47], v[200:203], a[100:103], v[32:47]
 ds_read_b64_tr_b16 v[196:197], v241 offset:36928
 ds_read_b64_tr_b16 v[198:199], v241 offset:38464
 s_waitcnt lgkmcnt(8)
 v_mfma_f32_32x32x16_bf16 v[48:63], v[204:207], a[100:103], v[48:63]
 ds_read_b64_tr_b16 v[200:201], v240 offset:36992
 ds_read_b64_tr_b16 v[202:203], v240 offset:38528
 s_waitcnt lgkmcnt(8)
 v_mfma_f32_32x32x16_bf16 v[64:79], v[208:211], a[100:103], v[64:79]
 ds_read_b64_tr_b16 v[204:205], v241 offset:37056
 ds_read_b64_tr_b16 v[206:207], v241 offset:38592
 s_waitcnt lgkmcnt(8)
 v_mfma_f32_32x32x16_bf16 v[80:95], v[212:215], a[100:103], v[80:95]
 ds_read_b64_tr_b16 v[208:209], v240 offset:37120
 ds_read_b64_tr_b16 v[210:211], v240 offset:38656
 s_waitcnt lgkmcnt(8)
 v_mfma_f32_32x32x16_bf16 v[0:15], v[192:195], a[104:107], v[0:15]
 ds_read_b64_tr_b16 v[212:213], v241 offset:37184
 ds_read_b64_tr_b16 v[214:215], v241 offset:38720
 s_waitcnt lgkmcnt(8)
 v_mfma_f32_32x32x16_bf16 v[16:31], v[196:199], a[104:107], v[16:31]
 ds_read_b64_tr_b16 v[192:193], v240 offset:43008
 ds_read_b64_tr_b16 v[194:195], v240 offset:44544
 s_waitcnt lgkmcnt(8)
 v_mfma_f32_32x32x16_bf16 v[32:47], v[200:203], a[104:107], v[32:47]
 ds_read_b64_tr_b16 v[196:197], v241 offset:43072
 ds_read_b64_tr_b16 v[198:199], v241 offset:44608
 s_waitcnt lgkmcnt(8)
 v_mfma_f32_32x32x16_bf16 v[48:63], v[204:207], a[104:107], v[48:63]
 ds_read_b64_tr_b16 v[200:201], v240 offset:43136
 ds_read_b64_tr_b16 v[202:203], v240 offset:44672
 s_waitcnt lgkmcnt(8)
 v_mfma_f32_32x32x16_bf16 v[64:79], v[208:211], a[104:107], v[64:79]
 ds_read_b64_tr_b16 v[204:205], v241 offset:43200
 ds_read_b64_tr_b16 v[206:207], v241 offset:44736
 s_waitcnt lgkmcnt(8)
 v_mfma_f32_32x32x16_bf16 v[80:95], v[212:215], a[104:107], v[80:95]
 ds_read_b64_tr_b16 v[208:209], v240 offset:43264
 ds_read_b64_tr_b16 v[210:211], v240 offset:44800
 s_waitcnt lgkmcnt(8)
 v_mfma_f32_32x32x16_bf16 v[0:15], v[192:195], a[108:111], v[0:15]
 ds_read_b64_tr_b16 v[212:213], v241 offset:43328
 ds_read_b64_tr_b16 v[214:215], v241 offset:44864
 s_waitcnt lgkmcnt(8)
 v_mfma_f32_32x32x16_bf16 v[16:31], v[196:199], a[108:111], v[16:31]
 ds_read_b64_tr_b16 v[192:193], v240 offset:49152
 ds_read_b64_tr_b16 v[194:195], v240 offset:50688
 s_waitcnt lgkmcnt(8)
 v_mfma_f32_32x32x16_bf16 v[32:47], v[200:203], a[108:111], v[32:47]
 ds_read_b64_tr_b16 v[196:197], v241 offset:49216
 ds_read_b64_tr_b16 v[198:199], v241 offset:50752
 s_waitcnt lgkmcnt(8)
 v_mfma_f32_32x32x16_bf16 v[48:63], v[204:207], a[108:111], v[48:63]
 ds_read_b64_tr_b16 v[200:201], v240 offset:49280
 ds_read_b64_tr_b16 v[202:203], v240 offset:50816
 s_waitcnt lgkmcnt(8)
 v_mfma_f32_32x32x16_bf16 v[64:79], v[208:211], a[108:111], v[64:79]
 ds_read_b64_tr_b16 v[204:205], v241 offset:49344
 ds_read_b64_tr_b16 v[206:207], v241 offset:50880
 s_waitcnt lgkmcnt(8)
 v_mfma_f32_32x32x16_bf16 v[80:95], v[212:215], a[108:111], v[80:95]
 s_waitcnt vmcnt(14)
 s_barrier
 ds_read_b64_tr_b16 v[208:209], v240 offset:49408
 ds_read_b64_tr_b16 v[210:211], v240 offset:50944
 s_waitcnt lgkmcnt(8)
 v_mfma_f32_32x32x16_bf16 v[0:15], v[192:195], a[112:115], v[0:15]
 ds_read_b64_tr_b16 v[212:213], v241 offset:49472
 ds_read_b64_tr_b16 v[214:215], v241 offset:51008
 s_waitcnt lgkmcnt(8)
 v_mfma_f32_32x32x16_bf16 v[16:31], v[196:199], a[112:115], v[16:31]
 ds_read_b64_tr_b16 v[192:193], v240 offset:55296
 ds_read_b64_tr_b16 v[194:195], v240 offset:56832
 s_waitcnt lgkmcnt(8)
 v_mfma_f32_32x32x16_bf16 v[32:47], v[200:203], a[112:115], v[32:47]
 ds_read_b64_tr_b16 v[196:197], v241 offset:55360
 ds_read_b64_tr_b16 v[198:199], v241 offset:56896
 s_waitcnt lgkmcnt(8)
 v_mfma_f32_32x32x16_bf16 v[48:63], v[204:207], a[112:115], v[48:63]
 ds_read_b64_tr_b16 v[200:201], v240 offset:55424
 ds_read_b64_tr_b16 v[202:203], v240 offset:56960
 s_waitcnt lgkmcnt(8)
 v_mfma_f32_32x32x16_bf16 v[64:79], v[208:211], a[112:115], v[64:79]
 ds_read_b64_tr_b16 v[204:205], v241 offset:55488
 ds_read_b64_tr_b16 v[206:207], v241 offset:57024
 s_waitcnt lgkmcnt(8)
 v_mfma_f32_32x32x16_bf16 v[80:95], v[212:215], a[112:115], v[80:95]
 ds_read_b64_tr_b16 v[208:209], v240 offset:55552
 ds_read_b64_tr_b16 v[210:211], v240 offset:57088
 s_waitcnt lgkmcnt(8)
 v_mfma_f32_32x32x16_bf16 v[0:15], v[192:195], a[116:119], v[0:15]
 ds_read_b64_tr_b16 v[212:213], v241 offset:55616
 ds_read_b64_tr_b16 v[214:215], v241 offset:57152
 s_waitcnt lgkmcnt(8)
 v_mfma_f32_32x32x16_bf16 v[16:31], v[196:199], a[116:119], v[16:31]
 ds_read_b64_tr_b16 v[192:193], v240 offset:61440
 ds_read_b64_tr_b16 v[194:195], v240 offset:62976
 s_waitcnt lgkmcnt(8)
 v_mfma_f32_32x32x16_bf16 v[32:47], v[200:203], a[116:119], v[32:47]
 ds_read_b64_tr_b16 v[196:197], v241 offset:61504
 ds_read_b64_tr_b16 v[198:199], v241 offset:63040
 s_waitcnt lgkmcnt(8)
 v_mfma_f32_32x32x16_bf16 v[48:63], v[204:207], a[116:119], v[48:63]
 ds_read_b64_tr_b16 v[200:201], v240 offset:61568
 ds_read_b64_tr_b16 v[202:203], v240 offset:63104
 s_waitcnt lgkmcnt(8)
 v_mfma_f32_32x32x16_bf16 v[64:79], v[208:211], a[116:119], v[64:79]
 ds_read_b64_tr_b16 v[204:205], v241 offset:61632
 ds_read_b64_tr_b16 v[206:207], v241 offset:63168
 s_waitcnt lgkmcnt(8)
 v_mfma_f32_32x32x16_bf16 v[80:95], v[212:215], a[116:119], v[80:95]
 ds_read_b64_tr_b16 v[208:209], v240 offset:61696
 ds_read_b64_tr_b16 v[210:211], v240 offset:63232
 s_waitcnt lgkmcnt(8)
 v_mfma_f32_32x32x16_bf16 v[0:15], v[192:195], a[120:123], v[0:15]
 ds_read_b64_tr_b16 v[212:213], v241 offset:61760
 ds_read_b64_tr_b16 v[214:215], v241 offset:63296
 s_waitcnt lgkmcnt(8)
 v_mfma_f32_32x32x16_bf16 v[16:31], v[196:199], a[120:123], v[16:31]
 ds_read_b64_tr_b16 v[192:193], v248 offset:2048
 ds_read_b64_tr_b16 v[194:195], v248 offset:3584
 s_waitcnt lgkmcnt(8)
 v_mfma_f32_32x32x16_bf16 v[32:47], v[200:203], a[120:123], v[32:47]
 ds_read_b64_tr_b16 v[196:197], v249 offset:2112
 ds_read_b64_tr_b16 v[198:199], v249 offset:3648
 s_waitcnt lgkmcnt(8)
 v_mfma_f32_32x32x16_bf16 v[48:63], v[204:207], a[120:123], v[48:63]
 ds_read_b64_tr_b16 v[200:201], v248 offset:2176
 ds_read_b64_tr_b16 v[202:203], v248 offset:3712
 s_waitcnt lgkmcnt(8)
 v_mfma_f32_32x32x16_bf16 v[64:79], v[208:211], a[120:123], v[64:79]
 ds_read_b64_tr_b16 v[204:205], v249 offset:2240
 ds_read_b64_tr_b16 v[206:207], v249 offset:3776
 s_waitcnt lgkmcnt(8)
 v_mfma_f32_32x32x16_bf16 v[80:95], v[212:215], a[120:123], v[80:95]
 ds_read_b64_tr_b16 v[208:209], v248 offset:2304
 ds_read_b64_tr_b16 v[210:211], v248 offset:3840
 s_waitcnt lgkmcnt(8)
 v_mfma_f32_32x32x16_bf16 v[0:15], v[192:195], a[124:127], v[0:15]
 ds_read_b64_tr_b16 v[212:213], v249 offset:2368
 ds_read_b64_tr_b16 v[214:215], v249 offset:3904
 s_waitcnt lgkmcnt(8)
 v_mfma_f32_32x32x16_bf16 v[16:31], v[196:199], a[124:127], v[16:31]
 ds_read_b64_tr_b16 v[192:193], v248 offset:8192
 ds_read_b64_tr_b16 v[194:195], v248 offset:9728
 s_waitcnt lgkmcnt(8)
 v_mfma_f32_32x32x16_bf16 v[32:47], v[200:203], a[124:127], v[32:47]
 ds_read_b64_tr_b16 v[196:197], v249 offset:8256
 ds_read_b64_tr_b16 v[198:199], v249 offset:9792
 s_waitcnt lgkmcnt(8)
 v_mfma_f32_32x32x16_bf16 v[48:63], v[204:207], a[124:127], v[48:63]
 ds_read_b64_tr_b16 v[200:201], v248 offset:8320
 ds_read_b64_tr_b16 v[202:203], v248 offset:9856
 s_waitcnt lgkmcnt(8)
 v_mfma_f32_32x32x16_bf16 v[64:79], v[208:211], a[124:127], v[64:79]
 ds_read_b64_tr_b16 v[204:205], v249 offset:8384
 ds_read_b64_tr_b16 v[206:207], v249 offset:9920
 s_waitcnt lgkmcnt(8)
 v_mfma_f32_32x32x16_bf16 v[80:95], v[212:215], a[124:127], v[80:95]
 s_waitcnt vmcnt(4)
 s_barrier
 ds_read_b64_tr_b16 v[208:209], v248 offset:8448
 ds_read_b64_tr_b16 v[210:211], v248 offset:9984
 s_waitcnt lgkmcnt(8)
 v_mfma_f32_32x32x16_bf16 v[0:15], v[192:195], a[128:131], v[0:15]
 ds_read_b64_tr_b16 v[212:213], v249 offset:8512
 ds_read_b64_tr_b16 v[214:215], v249 offset:10048
 s_waitcnt lgkmcnt(8)
 v_mfma_f32_32x32x16_bf16 v[16:31], v[196:199], a[128:131], v[16:31]
 ds_read_b64_tr_b16 v[192:193], v248 offset:14336
 ds_read_b64_tr_b16 v[194:195], v248 offset:15872
 s_waitcnt lgkmcnt(8)
 v_mfma_f32_32x32x16_bf16 v[32:47], v[200:203], a[128:131], v[32:47]
 ds_read_b64_tr_b16 v[196:197], v249 offset:14400
 ds_read_b64_tr_b16 v[198:199], v249 offset:15936
 s_waitcnt lgkmcnt(8)
 v_mfma_f32_32x32x16_bf16 v[48:63], v[204:207], a[128:131], v[48:63]
 ds_read_b64_tr_b16 v[200:201], v248 offset:14464
 ds_read_b64_tr_b16 v[202:203], v248 offset:16000
 s_waitcnt lgkmcnt(8)
 v_mfma_f32_32x32x16_bf16 v[64:79], v[208:211], a[128:131], v[64:79]
 ds_read_b64_tr_b16 v[204:205], v249 offset:14528
 ds_read_b64_tr_b16 v[206:207], v249 offset:16064
 s_waitcnt lgkmcnt(8)
 v_mfma_f32_32x32x16_bf16 v[80:95], v[212:215], a[128:131], v[80:95]
 ds_read_b64_tr_b16 v[208:209], v248 offset:14592
 ds_read_b64_tr_b16 v[210:211], v248 offset:16128
 s_waitcnt lgkmcnt(8)
 v_mfma_f32_32x32x16_bf16 v[0:15], v[192:195], a[132:135], v[0:15]
 ds_read_b64_tr_b16 v[212:213], v249 offset:14656
 ds_read_b64_tr_b16 v[214:215], v249 offset:16192
 s_waitcnt lgkmcnt(8)
 v_mfma_f32_32x32x16_bf16 v[16:31], v[196:199], a[132:135], v[16:31]
 ds_read_b64_tr_b16 v[192:193], v248 offset:20480
 ds_read_b64_tr_b16 v[194:195], v248 offset:22016
 s_waitcnt lgkmcnt(8)
 v_mfma_f32_32x32x16_bf16 v[32:47], v[200:203], a[132:135], v[32:47]
 ds_read_b64_tr_b16 v[196:197], v249 offset:20544
 ds_read_b64_tr_b16 v[198:199], v249 offset:22080
 s_waitcnt lgkmcnt(8)
 v_mfma_f32_32x32x16_bf16 v[48:63], v[204:207], a[132:135], v[48:63]
 ds_read_b64_tr_b16 v[200:201], v248 offset:20608
 ds_read_b64_tr_b16 v[202:203], v248 offset:22144
 s_waitcnt lgkmcnt(8)
 v_mfma_f32_32x32x16_bf16 v[64:79], v[208:211], a[132:135], v[64:79]
 ds_read_b64_tr_b16 v[204:205], v249 offset:20672
 ds_read_b64_tr_b16 v[206:207], v249 offset:22208
 s_waitcnt lgkmcnt(8)
 v_mfma_f32_32x32x16_bf16 v[80:95], v[212:215], a[132:135], v[80:95]
 ds_read_b64_tr_b16 v[208:209], v248 offset:20736
 ds_read_b64_tr_b16 v[210:211], v248 offset:22272
 s_waitcnt lgkmcnt(8)
 v_mfma_f32_32x32x16_bf16 v[0:15], v[192:195], a[136:139], v[0:15]
 ds_read_b64_tr_b16 v[212:213], v249 offset:20800
 ds_read_b64_tr_b16 v[214:215], v249 offset:22336
 s_waitcnt lgkmcnt(8)
 v_mfma_f32_32x32x16_bf16 v[16:31], v[196:199], a[136:139], v[16:31]
 ds_read_b64_tr_b16 v[192:193], v248 offset:26624
 ds_read_b64_tr_b16 v[194:195], v248 offset:28160
 s_waitcnt lgkmcnt(8)
 v_mfma_f32_32x32x16_bf16 v[32:47], v[200:203], a[136:139], v[32:47]
 ds_read_b64_tr_b16 v[196:197], v249 offset:26688
 ds_read_b64_tr_b16 v[198:199], v249 offset:28224
 s_waitcnt lgkmcnt(8)
 v_mfma_f32_32x32x16_bf16 v[48:63], v[204:207], a[136:139], v[48:63]
 ds_read_b64_tr_b16 v[200:201], v248 offset:26752
 ds_read_b64_tr_b16 v[202:203], v248 offset:28288
 s_waitcnt lgkmcnt(8)
 v_mfma_f32_32x32x16_bf16 v[64:79], v[208:211], a[136:139], v[64:79]
 ds_read_b64_tr_b16 v[204:205], v249 offset:26816
 ds_read_b64_tr_b16 v[206:207], v249 offset:28352
 s_waitcnt lgkmcnt(8)
 v_mfma_f32_32x32x16_bf16 v[80:95], v[212:215], a[136:139], v[80:95]
 ds_read_b64_tr_b16 v[208:209], v248 offset:26880
 ds_read_b64_tr_b16 v[210:211], v248 offset:28416
 s_waitcnt lgkmcnt(8)
 v_mfma_f32_32x32x16_bf16 v[0:15], v[192:195], a[140:143], v[0:15]
 ds_read_b64_tr_b16 v[212:213], v249 offset:26944
 ds_read_b64_tr_b16 v[214:215], v249 offset:28480
 s_waitcnt lgkmcnt(8)
 v_mfma_f32_32x32x16_bf16 v[16:31], v[196:199], a[140:143], v[16:31]
 ds_read_b64_tr_b16 v[192:193], v248 offset:32768
 ds_read_b64_tr_b16 v[194:195], v248 offset:34304
 s_waitcnt lgkmcnt(8)
 v_mfma_f32_32x32x16_bf16 v[32:47], v[200:203], a[140:143], v[32:47]
 ds_read_b64_tr_b16 v[196:197], v249 offset:32832
 ds_read_b64_tr_b16 v[198:199], v249 offset:34368
 s_waitcnt lgkmcnt(8)
 v_mfma_f32_32x32x16_bf16 v[48:63], v[204:207], a[140:143], v[48:63]
 ds_read_b64_tr_b16 v[200:201], v248 offset:32896
 ds_read_b64_tr_b16 v[202:203], v248 offset:34432
 s_waitcnt lgkmcnt(8)
 v_mfma_f32_32x32x16_bf16 v[64:79], v[208:211], a[140:143], v[64:79]
 ds_read_b64_tr_b16 v[204:205], v249 offset:32960
 ds_read_b64_tr_b16 v[206:207], v249 offset:34496
 s_waitcnt lgkmcnt(8)
 v_mfma_f32_32x32x16_bf16 v[80:95], v[212:215], a[140:143], v[80:95]
 s_barrier
 ds_read_b64_tr_b16 v[208:209], v248 offset:33024
 ds_read_b64_tr_b16 v[210:211], v248 offset:34560
 s_waitcnt vmcnt(0)
 s_waitcnt lgkmcnt(8)
 v_mfma_f32_32x32x16_bf16 v[0:15], v[192:195], a[144:147], v[0:15]
 ds_read_b64_tr_b16 v[212:213], v249 offset:33088
 ds_read_b64_tr_b16 v[214:215], v249 offset:34624
 s_waitcnt lgkmcnt(8)
 v_mfma_f32_32x32x16_bf16 v[16:31], v[196:199], a[144:147], v[16:31]
 ds_read_b64_tr_b16 v[192:193], v248 offset:38912
 ds_read_b64_tr_b16 v[194:195], v248 offset:40448
 s_waitcnt lgkmcnt(8)
 v_mfma_f32_32x32x16_bf16 v[32:47], v[200:203], a[144:147], v[32:47]
 ds_read_b64_tr_b16 v[196:197], v249 offset:38976
 ds_read_b64_tr_b16 v[198:199], v249 offset:40512
 s_waitcnt lgkmcnt(8)
 v_mfma_f32_32x32x16_bf16 v[48:63], v[204:207], a[144:147], v[48:63]
 ds_read_b64_tr_b16 v[200:201], v248 offset:39040
 ds_read_b64_tr_b16 v[202:203], v248 offset:40576
 s_waitcnt lgkmcnt(8)
 v_mfma_f32_32x32x16_bf16 v[64:79], v[208:211], a[144:147], v[64:79]
 ds_read_b64_tr_b16 v[204:205], v249 offset:39104
 ds_read_b64_tr_b16 v[206:207], v249 offset:40640
 s_waitcnt lgkmcnt(8)
 v_mfma_f32_32x32x16_bf16 v[80:95], v[212:215], a[144:147], v[80:95]
 ds_read_b64_tr_b16 v[208:209], v248 offset:39168
 ds_read_b64_tr_b16 v[210:211], v248 offset:40704
 s_waitcnt lgkmcnt(8)
 v_mfma_f32_32x32x16_bf16 v[0:15], v[192:195], a[148:151], v[0:15]
 ds_read_b64_tr_b16 v[212:213], v249 offset:39232
 ds_read_b64_tr_b16 v[214:215], v249 offset:40768
 s_waitcnt lgkmcnt(8)
 v_mfma_f32_32x32x16_bf16 v[16:31], v[196:199], a[148:151], v[16:31]
 ds_read_b64_tr_b16 v[192:193], v248 offset:45056
 ds_read_b64_tr_b16 v[194:195], v248 offset:46592
 s_waitcnt lgkmcnt(8)
 v_mfma_f32_32x32x16_bf16 v[32:47], v[200:203], a[148:151], v[32:47]
 ds_read_b64_tr_b16 v[196:197], v249 offset:45120
 ds_read_b64_tr_b16 v[198:199], v249 offset:46656
 s_waitcnt lgkmcnt(8)
 v_mfma_f32_32x32x16_bf16 v[48:63], v[204:207], a[148:151], v[48:63]
 ds_read_b64_tr_b16 v[200:201], v248 offset:45184
 ds_read_b64_tr_b16 v[202:203], v248 offset:46720
 s_waitcnt lgkmcnt(8)
 v_mfma_f32_32x32x16_bf16 v[64:79], v[208:211], a[148:151], v[64:79]
 ds_read_b64_tr_b16 v[204:205], v249 offset:45248
 ds_read_b64_tr_b16 v[206:207], v249 offset:46784
 s_waitcnt lgkmcnt(8)
 v_mfma_f32_32x32x16_bf16 v[80:95], v[212:215], a[148:151], v[80:95]
 ds_read_b64_tr_b16 v[208:209], v248 offset:45312
 ds_read_b64_tr_b16 v[210:211], v248 offset:46848
 s_waitcnt lgkmcnt(8)
 v_mfma_f32_32x32x16_bf16 v[0:15], v[192:195], a[152:155], v[0:15]
 ds_read_b64_tr_b16 v[212:213], v249 offset:45376
 ds_read_b64_tr_b16 v[214:215], v249 offset:46912
 s_waitcnt lgkmcnt(8)
 v_mfma_f32_32x32x16_bf16 v[16:31], v[196:199], a[152:155], v[16:31]
 ds_read_b64_tr_b16 v[192:193], v248 offset:51200
 ds_read_b64_tr_b16 v[194:195], v248 offset:52736
 s_waitcnt lgkmcnt(8)
 v_mfma_f32_32x32x16_bf16 v[32:47], v[200:203], a[152:155], v[32:47]
 ds_read_b64_tr_b16 v[196:197], v249 offset:51264
 ds_read_b64_tr_b16 v[198:199], v249 offset:52800
 s_waitcnt lgkmcnt(8)
 v_mfma_f32_32x32x16_bf16 v[48:63], v[204:207], a[152:155], v[48:63]
 ds_read_b64_tr_b16 v[200:201], v248 offset:51328
 ds_read_b64_tr_b16 v[202:203], v248 offset:52864
 s_waitcnt lgkmcnt(8)
 v_mfma_f32_32x32x16_bf16 v[64:79], v[208:211], a[152:155], v[64:79]
 ds_read_b64_tr_b16 v[204:205], v249 offset:51392
 ds_read_b64_tr_b16 v[206:207], v249 offset:52928
 s_waitcnt lgkmcnt(8)
 v_mfma_f32_32x32x16_bf16 v[80:95], v[212:215], a[152:155], v[80:95]
 ds_read_b64_tr_b16 v[208:209], v248 offset:51456
 ds_read_b64_tr_b16 v[210:211], v248 offset:52992
 s_waitcnt lgkmcnt(8)
 v_mfma_f32_32x32x16_bf16 v[0:15], v[192:195], a[156:159], v[0:15]
 ds_read_b64_tr_b16 v[212:213], v249 offset:51520
 ds_read_b64_tr_b16 v[214:215], v249 offset:53056
 s_waitcnt lgkmcnt(8)
 v_mfma_f32_32x32x16_bf16 v[16:31], v[196:199], a[156:159], v[16:31]
 s_waitcnt lgkmcnt(6)
 v_mfma_f32_32x32x16_bf16 v[32:47], v[200:203], a[156:159], v[32:47]
 s_waitcnt lgkmcnt(4)
 v_mfma_f32_32x32x16_bf16 v[48:63], v[204:207], a[156:159], v[48:63]
 s_waitcnt lgkmcnt(2)
 v_mfma_f32_32x32x16_bf16 v[64:79], v[208:211], a[156:159], v[64:79]
 s_waitcnt lgkmcnt(0)
 v_mfma_f32_32x32x16_bf16 v[80:95], v[212:215], a[156:159], v[80:95]
 s_nop 15
 s_nop 3
 v_cvt_pk_bf16_f32 v216, v0, v1
 v_cvt_pk_bf16_f32 v217, v2, v3
 v_cvt_pk_bf16_f32 v218, v4, v5
 v_cvt_pk_bf16_f32 v219, v6, v7
 v_cvt_pk_bf16_f32 v220, v8, v9
 v_cvt_pk_bf16_f32 v221, v10, v11
 v_cvt_pk_bf16_f32 v222, v12, v13
 v_cvt_pk_bf16_f32 v223, v14, v15
 buffer_store_dwordx4 v[216:219], v244, s[8:11], s53 offen offset:0 sc1
 buffer_store_dwordx4 v[220:223], v244, s[8:11], s53 offen offset:512 sc1
 s_add_u32 s53, s53, 1024
 v_cvt_pk_bf16_f32 v224, v16, v17
 v_cvt_pk_bf16_f32 v225, v18, v19
 v_cvt_pk_bf16_f32 v226, v20, v21
 v_cvt_pk_bf16_f32 v227, v22, v23
 v_cvt_pk_bf16_f32 v228, v24, v25
 v_cvt_pk_bf16_f32 v229, v26, v27
 v_cvt_pk_bf16_f32 v230, v28, v29
 v_cvt_pk_bf16_f32 v231, v30, v31
 buffer_store_dwordx4 v[224:227], v244, s[8:11], s53 offen offset:0 sc1
 buffer_store_dwordx4 v[228:231], v244, s[8:11], s53 offen offset:512 sc1
 s_add_u32 s53, s53, 1024
 v_cvt_pk_bf16_f32 v216, v32, v33
 v_cvt_pk_bf16_f32 v217, v34, v35
 v_cvt_pk_bf16_f32 v218, v36, v37
 v_cvt_pk_bf16_f32 v219, v38, v39
 v_cvt_pk_bf16_f32 v220, v40, v41
 v_cvt_pk_bf16_f32 v221, v42, v43
 v_cvt_pk_bf16_f32 v222, v44, v45
 v_cvt_pk_bf16_f32 v223, v46, v47
 buffer_store_dwordx4 v[216:219], v244, s[8:11], s53 offen offset:0 sc1
 buffer_store_dwordx4 v[220:223], v244, s[8:11], s53 offen offset:512 sc1
 s_add_u32 s53, s53, 1024
 v_cvt_pk_bf16_f32 v224, v48, v49
 v_cvt_pk_bf16_f32 v225, v50, v51
 v_cvt_pk_bf16_f32 v226, v52, v53
 v_cvt_pk_bf16_f32 v227, v54, v55
 v_cvt_pk_bf16_f32 v228, v56, v57
 v_cvt_pk_bf16_f32 v229, v58, v59
 v_cvt_pk_bf16_f32 v230, v60, v61
 v_cvt_pk_bf16_f32 v231, v62, v63
 buffer_store_dwordx4 v[224:227], v244, s[8:11], s53 offen offset:0 sc1
 buffer_store_dwordx4 v[228:231], v244, s[8:11], s53 offen offset:512 sc1
 s_add_u32 s53, s53, 1024
 v_cvt_pk_bf16_f32 v216, v64, v65
 v_cvt_pk_bf16_f32 v217, v66, v67
 v_cvt_pk_bf16_f32 v218, v68, v69
 v_cvt_pk_bf16_f32 v219, v70, v71
 v_cvt_pk_bf16_f32 v220, v72, v73
 v_cvt_pk_bf16_f32 v221, v74, v75
 v_cvt_pk_bf16_f32 v222, v76, v77
 v_cvt_pk_bf16_f32 v223, v78, v79
 buffer_store_dwordx4 v[216:219], v244, s[8:11], s53 offen offset:0 sc1
 buffer_store_dwordx4 v[220:223], v244, s[8:11], s53 offen offset:512 sc1
 s_add_u32 s53, s53, 1024
 v_cvt_pk_bf16_f32 v224, v80, v81
 v_cvt_pk_bf16_f32 v225, v82, v83
 v_cvt_pk_bf16_f32 v226, v84, v85
 v_cvt_pk_bf16_f32 v227, v86, v87
 v_cvt_pk_bf16_f32 v228, v88, v89
 v_cvt_pk_bf16_f32 v229, v90, v91
 v_cvt_pk_bf16_f32 v230, v92, v93
 v_cvt_pk_bf16_f32 v231, v94, v95
 buffer_store_dwordx4 v[224:227], v244, s[8:11], s53 offen offset:0 sc1
 buffer_store_dwordx4 v[228:231], v244, s[8:11], s53 offen offset:512 sc1
 s_add_u32 s53, s53, 1024
 s_lshl_b32 s28, s50, 5
 s_add_u32 s28, s28, s51
 s_lshl_b32 s28, s28, 2
 s_add_u32 s28, s28, 6324224
 s_waitcnt vmcnt(0)
 s_barrier
 s_cmp_eq_u32 s14, 0
 s_cbranch_scc0 sg_59
 s_mov_b64 exec, 1
 v_mov_b32 v233, 0
 v_mov_b32 v234, 1
 buffer_atomic_add v234, v233, s[8:11], s28 offen sc1
 s_mov_b64 exec, -1
sg_59:
 s_branch wk_next
wk_sv:
 v_accvgpr_read_b32 v244, a222
 s_mul_i32 s52, s51, 384
 s_mul_i32 s55, s51, 245760
 s_mul_i32 s28, s49, 640
 s_add_u32 s55, s55, s28
 s_lshl_b32 s48, s50, 2
 s_add_u32 s48, s48, s14
 s_mul_i32 s48, s48, 40960
 s_lshl_b32 s53, s50, 2
 s_add_u32 s53, s53, s14
 s_lshl_b32 s53, s53, 5
 s_add_u32 s53, s53, s51
 s_mul_i32 s53, s53, 40960
 s_add_u32 s53, s53, 96468992
 s_mul_i32 s28, s49, 20480
 s_add_u32 s53, s53, s28
 s_add_u32 m0, s19, 0
 s_add_u32 s29, s52, 0
 buffer_load_dwordx4 v236, s[32:35], s29 offen lds
 s_add_u32 m0, s19, 1024
 s_add_u32 s29, s52, 0
 buffer_load_dwordx4 v237, s[32:35], s29 offen lds
 s_add_u32 m0, s19, 2048
 s_add_u32 s29, s52, 0
 buffer_load_dwordx4 v238, s[32:35], s29 offen lds
 s_add_u32 m0, s19, 3072
 s_add_u32 s29, s52, 98304
 buffer_load_dwordx4 v236, s[32:35], s29 offen lds
 s_add_u32 m0, s19, 4096
 s_add_u32 s29, s52, 98304
 buffer_load_dwordx4 v237, s[32:35], s29 offen lds
 s_add_u32 m0, s19, 5120
 s_add_u32 s29, s52, 98304
 buffer_load_dwordx4 v238, s[32:35], s29 offen lds
 buffer_load_dwordx4 a[0:3], v232, s[8:11], s48 offen offset:0
 buffer_load_dwordx4 a[4:7], v232, s[8:11], s48 offen offset:1024
 buffer_load_dwordx4 a[8:11], v232, s[8:11], s48 offen offset:2048
 buffer_load_dwordx4 a[12:15], v232, s[8:11], s48 offen offset:3072
 s_add_u32 s48, s48, 4096
 s_add_u32 m0, s19, 24576
 s_add_u32 s29, s52, 786432
 buffer_load_dwordx4 v236, s[32:35], s29 offen lds
 s_add_u32 m0, s19, 25600
 s_add_u32 s29, s52, 786432
 buffer_load_dwordx4 v237, s[32:35], s29 offen lds
 s_add_u32 m0, s19, 26624
 s_add_u32 s29, s52, 786432
 buffer_load_dwordx4 v238, s[32:35], s29 offen lds
 s_add_u32 m0, s19, 27648
 s_add_u32 s29, s52, 884736
 buffer_load_dwordx4 v236, s[32:35], s29 offen lds
 s_add_u32 m0, s19, 28672
 s_add_u32 s29, s52, 884736
 buffer_load_dwordx4 v237, s[32:35], s29 offen lds
 s_add_u32 m0, s19, 29696
 s_add_u32 s29, s52, 884736
 buffer_load_dwordx4 v238, s[32:35], s29 offen lds
 buffer_load_dwordx4 a[16:19], v232, s[8:11], s48 offen offset:0
 buffer_load_dwordx4 a[20:23], v232, s[8:11], s48 offen offset:1024
 buffer_load_dwordx4 a[24:27], v232, s[8:11], s48 offen offset:2048
 buffer_load_dwordx4 a[28:31], v232, s[8:11], s48 offen offset:3072
 s_add_u32 s48, s48, 4096
 s_add_u32 m0, s19, 49152
 s_add_u32 s29, s52, 1572864
 buffer_load_dwordx4 v236, s[32:35], s29 offen lds
 s_add_u32 m0, s19, 50176
 s_add_u32 s29, s52, 1572864
 buffer_load_dwordx4 v237, s[32:35], s29 offen lds
 s_add_u32 m0, s19, 51200
 s_add_u32 s29, s52, 1572864
 buffer_load_dwordx4 v238, s[32:35], s29 offen lds
 s_add_u32 m0, s19, 52224
 s_add_u32 s29, s52, 1671168
 buffer_load_dwordx4 v236, s[32:35], s29 offen lds
 s_add_u32 m0, s19, 53248
 s_add_u32 s29, s52, 1671168
 buffer_load_dwordx4 v237, s[32:35], s29 offen lds
 s_add_u32 m0, s19, 54272
 s_add_u32 s29, s52, 1671168
 buffer_load_dwordx4 v238, s[32:35], s29 offen lds
 buffer_load_dwordx4 a[32:35], v232, s[8:11], s48 offen offset:0
 buffer_load_dwordx4 a[36:39], v232, s[8:11], s48 offen offset:1024
 buffer_load_dwordx4 a[40:43], v232, s[8:11], s48 offen offset:2048
 buffer_load_dwordx4 a[44:47], v232, s[8:11], s48 offen offset:3072
 s_add_u32 s48, s48, 4096
 s_add_u32 m0, s19, 73728
 s_add_u32 s29, s52, 2359296
 buffer_load_dwordx4 v236, s[32:35], s29 offen lds
 s_add_u32 m0, s19, 74752
 s_add_u32 s29, s52, 2359296
 buffer_load_dwordx4 v237, s[32:35], s29 offen lds
 s_add_u32 m0, s19, 75776
 s_add_u32 s29, s52, 2359296
 buffer_load_dwordx4 v238, s[32:35], s29 offen lds
 s_add_u32 m0, s19, 76800
 s_add_u32 s29, s52, 2457600
 buffer_load_dwordx4 v236, s[32:35], s29 offen lds
 s_add_u32 m0, s19, 77824
 s_add_u32 s29, s52, 2457600
 buffer_load_dwordx4 v237, s[32:35], s29 offen lds
 s_add_u32 m0, s19, 78848
 s_add_u32 s29, s52, 2457600
 buffer_load_dwordx4 v238, s[32:35], s29 offen lds
 buffer_load_dwordx4 a[48:51], v232, s[8:11], s48 offen offset:0
 buffer_load_dwordx4 a[52:55], v232, s[8:11], s48 offen offset:1024
 buffer_load_dwordx4 a[56:59], v232, s[8:11], s48 offen offset:2048
 buffer_load_dwordx4 a[60:63], v232, s[8:11], s48 offen offset:3072
 s_add_u32 s48, s48, 4096
 s_waitcnt vmcnt(34)
 s_waitcnt vmcnt(24)
 s_barrier
 ds_read_b64_tr_b16 v[192:193], v240 offset:0
 ds_read_b64_tr_b16 v[194:195], v240 offset:1536
 ds_read_b64_tr_b16 v[196:197], v241 offset:64
 ds_read_b64_tr_b16 v[198:199], v241 offset:1600
 ds_read_b64_tr_b16 v[200:201], v240 offset:128
 ds_read_b64_tr_b16 v[202:203], v240 offset:1664
 ds_read_b64_tr_b16 v[204:205], v241 offset:192
 ds_read_b64_tr_b16 v[206:207], v241 offset:1728
 ds_read_b64_tr_b16 v[208:209], v240 offset:256
 ds_read_b64_tr_b16 v[210:211], v240 offset:1792
 s_waitcnt lgkmcnt(8)
 v_mfma_f32_32x32x16_bf16 v[0:15], v[192:195], a[0:3], 0
 ds_read_b64_tr_b16 v[212:213], v241 offset:320
 ds_read_b64_tr_b16 v[214:215], v241 offset:1856
 s_waitcnt lgkmcnt(8)
 v_mfma_f32_32x32x16_bf16 v[16:31], v[196:199], a[0:3], 0
 s_add_u32 m0, s19, 98304
 s_add_u32 s29, s52, 3145728
 buffer_load_dwordx4 v236, s[32:35], s29 offen lds
 s_add_u32 m0, s19, 99328
 s_add_u32 s29, s52, 3145728
 buffer_load_dwordx4 v237, s[32:35], s29 offen lds
 s_add_u32 m0, s19, 100352
 s_add_u32 s29, s52, 3145728
 buffer_load_dwordx4 v238, s[32:35], s29 offen lds
 s_add_u32 m0, s19, 101376
 s_add_u32 s29, s52, 3244032
 buffer_load_dwordx4 v236, s[32:35], s29 offen lds
 s_add_u32 m0, s19, 102400
 s_add_u32 s29, s52, 3244032
 buffer_load_dwordx4 v237, s[32:35], s29 offen lds
 s_add_u32 m0, s19, 103424
 s_add_u32 s29, s52, 3244032
 buffer_load_dwordx4 v238, s[32:35], s29 offen lds
 ds_read_b64_tr_b16 v[192:193], v240 offset:6144
 ds_read_b64_tr_b16 v[194:195], v240 offset:7680
 s_waitcnt lgkmcnt(8)
 v_mfma_f32_32x32x16_bf16 v[32:47], v[200:203], a[0:3], 0
 ds_read_b64_tr_b16 v[196:197], v241 offset:6208
 ds_read_b64_tr_b16 v[198:199], v241 offset:7744
 s_waitcnt lgkmcnt(8)
 v_mfma_f32_32x32x16_bf16 v[48:63], v[204:207], a[0:3], 0
 ds_read_b64_tr_b16 v[200:201], v240 offset:6272
 ds_read_b64_tr_b16 v[202:203], v240 offset:7808
 s_waitcnt lgkmcnt(8)
 v_mfma_f32_32x32x16_bf16 v[64:79], v[208:211], a[0:3], 0
 ds_read_b64_tr_b16 v[204:205], v241 offset:6336
 ds_read_b64_tr_b16 v[206:207], v241 offset:7872
 s_waitcnt lgkmcnt(8)
 v_mfma_f32_32x32x16_bf16 v[80:95], v[212:215], a[0:3], 0
 ds_read_b64_tr_b16 v[208:209], v240 offset:6400
 ds_read_b64_tr_b16 v[210:211], v240 offset:7936
 s_waitcnt lgkmcnt(8)
 v_mfma_f32_32x32x16_bf16 v[0:15], v[192:195], a[4:7], v[0:15]
 ds_read_b64_tr_b16 v[212:213], v241 offset:6464
 ds_read_b64_tr_b16 v[214:215], v241 offset:8000
 s_waitcnt lgkmcnt(8)
 v_mfma_f32_32x32x16_bf16 v[16:31], v[196:199], a[4:7], v[16:31]
 ds_read_b64_tr_b16 v[192:193], v240 offset:12288
 ds_read_b64_tr_b16 v[194:195], v240 offset:13824
 s_waitcnt lgkmcnt(8)
 v_mfma_f32_32x32x16_bf16 v[32:47], v[200:203], a[4:7], v[32:47]
 buffer_load_dwordx4 a[64:67], v232, s[8:11], s48 offen offset:0
 buffer_load_dwordx4 a[68:71], v232, s[8:11], s48 offen offset:1024
 buffer_load_dwordx4 a[72:75], v232, s[8:11], s48 offen offset:2048
 buffer_load_dwordx4 a[76:79], v232, s[8:11], s48 offen offset:3072
 s_add_u32 s48, s48, 4096
 ds_read_b64_tr_b16 v[196:197], v241 offset:12352
 ds_read_b64_tr_b16 v[198:199], v241 offset:13888
 s_waitcnt lgkmcnt(8)
 v_mfma_f32_32x32x16_bf16 v[48:63], v[204:207], a[4:7], v[48:63]
 ds_read_b64_tr_b16 v[200:201], v240 offset:12416
 ds_read_b64_tr_b16 v[202:203], v240 offset:13952
 s_waitcnt lgkmcnt(8)
 v_mfma_f32_32x32x16_bf16 v[64:79], v[208:211], a[4:7], v[64:79]
 ds_read_b64_tr_b16 v[204:205], v241 offset:12480
 ds_read_b64_tr_b16 v[206:207], v241 offset:14016
 s_waitcnt lgkmcnt(8)
 v_mfma_f32_32x32x16_bf16 v[80:95], v[212:215], a[4:7], v[80:95]
 ds_read_b64_tr_b16 v[208:209], v240 offset:12544
 ds_read_b64_tr_b16 v[210:211], v240 offset:14080
 s_waitcnt lgkmcnt(8)
 v_mfma_f32_32x32x16_bf16 v[0:15], v[192:195], a[8:11], v[0:15]
 ds_read_b64_tr_b16 v[212:213], v241 offset:12608
 ds_read_b64_tr_b16 v[214:215], v241 offset:14144
 s_waitcnt lgkmcnt(8)
 v_mfma_f32_32x32x16_bf16 v[16:31], v[196:199], a[8:11], v[16:31]
 ds_read_b64_tr_b16 v[192:193], v240 offset:18432
 ds_read_b64_tr_b16 v[194:195], v240 offset:19968
 s_waitcnt lgkmcnt(8)
 v_mfma_f32_32x32x16_bf16 v[32:47], v[200:203], a[8:11], v[32:47]
 ds_read_b64_tr_b16 v[196:197], v241 offset:18496
 ds_read_b64_tr_b16 v[198:199], v241 offset:20032
 s_waitcnt lgkmcnt(8)
 v_mfma_f32_32x32x16_bf16 v[48:63], v[204:207], a[8:11], v[48:63]
 ds_read_b64_tr_b16 v[200:201], v240 offset:18560
 ds_read_b64_tr_b16 v[202:203], v240 offset:20096
 s_waitcnt lgkmcnt(8)
 v_mfma_f32_32x32x16_bf16 v[64:79], v[208:211], a[8:11], v[64:79]
 ds_read_b64_tr_b16 v[204:205], v241 offset:18624
 ds_read_b64_tr_b16 v[206:207], v241 offset:20160
 s_waitcnt lgkmcnt(8)
 v_mfma_f32_32x32x16_bf16 v[80:95], v[212:215], a[8:11], v[80:95]
 ds_read_b64_tr_b16 v[208:209], v240 offset:18688
 ds_read_b64_tr_b16 v[210:211], v240 offset:20224
 s_waitcnt lgkmcnt(8)
 v_mfma_f32_32x32x16_bf16 v[0:15], v[192:195], a[12:15], v[0:15]
 ds_read_b64_tr_b16 v[212:213], v241 offset:18752
 ds_read_b64_tr_b16 v[214:215], v241 offset:20288
 s_waitcnt lgkmcnt(8)
 v_mfma_f32_32x32x16_bf16 v[16:31], v[196:199], a[12:15], v[16:31]
 ds_read_b64_tr_b16 v[192:193], v240 offset:24576
 ds_read_b64_tr_b16 v[194:195], v240 offset:26112
 s_waitcnt lgkmcnt(8)
 v_mfma_f32_32x32x16_bf16 v[32:47], v[200:203], a[12:15], v[32:47]
 ds_read_b64_tr_b16 v[196:197], v241 offset:24640
 ds_read_b64_tr_b16 v[198:199], v241 offset:26176
 s_waitcnt lgkmcnt(8)
 v_mfma_f32_32x32x16_bf16 v[48:63], v[204:207], a[12:15], v[48:63]
 ds_read_b64_tr_b16 v[200:201], v240 offset:24704
 ds_read_b64_tr_b16 v[202:203], v240 offset:26240
 s_waitcnt lgkmcnt(8)
 v_mfma_f32_32x32x16_bf16 v[64:79], v[208:211], a[12:15], v[64:79]
 ds_read_b64_tr_b16 v[204:205], v241 offset:24768
 ds_read_b64_tr_b16 v[206:207], v241 offset:26304
 s_waitcnt lgkmcnt(8)
 v_mfma_f32_32x32x16_bf16 v[80:95], v[212:215], a[12:15], v[80:95]
 s_waitcnt vmcnt(24)
 s_barrier
 ds_read_b64_tr_b16 v[208:209], v240 offset:24832
 ds_read_b64_tr_b16 v[210:211], v240 offset:26368
 s_waitcnt lgkmcnt(8)
 v_mfma_f32_32x32x16_bf16 v[0:15], v[192:195], a[16:19], v[0:15]
 ds_read_b64_tr_b16 v[212:213], v241 offset:24896
 ds_read_b64_tr_b16 v[214:215], v241 offset:26432
 s_waitcnt lgkmcnt(8)
 v_mfma_f32_32x32x16_bf16 v[16:31], v[196:199], a[16:19], v[16:31]
 s_add_u32 m0, s19, 0
 s_add_u32 s29, s52, 3932160
 buffer_load_dwordx4 v236, s[32:35], s29 offen lds
 s_add_u32 m0, s19, 1024
 s_add_u32 s29, s52, 3932160
 buffer_load_dwordx4 v237, s[32:35], s29 offen lds
 s_add_u32 m0, s19, 2048
 s_add_u32 s29, s52, 3932160
 buffer_load_dwordx4 v238, s[32:35], s29 offen lds
 s_add_u32 m0, s19, 3072
 s_add_u32 s29, s52, 4030464
 buffer_load_dwordx4 v236, s[32:35], s29 offen lds
 s_add_u32 m0, s19, 4096
 s_add_u32 s29, s52, 4030464
 buffer_load_dwordx4 v237, s[32:35], s29 offen lds
 s_add_u32 m0, s19, 5120
 s_add_u32 s29, s52, 4030464
 buffer_load_dwordx4 v238, s[32:35], s29 offen lds
 ds_read_b64_tr_b16 v[192:193], v240 offset:30720
 ds_read_b64_tr_b16 v[194:195], v240 offset:32256
 s_waitcnt lgkmcnt(8)
 v_mfma_f32_32x32x16_bf16 v[32:47], v[200:203], a[16:19], v[32:47]
 ds_read_b64_tr_b16 v[196:197], v241 offset:30784
 ds_read_b64_tr_b16 v[198:199], v241 offset:32320
 s_waitcnt lgkmcnt(8)
 v_mfma_f32_32x32x16_bf16 v[48:63], v[204:207], a[16:19], v[48:63]
 ds_read_b64_tr_b16 v[200:201], v240 offset:30848
 ds_read_b64_tr_b16 v[202:203], v240 offset:32384
 s_waitcnt lgkmcnt(8)
 v_mfma_f32_32x32x16_bf16 v[64:79], v[208:211], a[16:19], v[64:79]
 ds_read_b64_tr_b16 v[204:205], v241 offset:30912
 ds_read_b64_tr_b16 v[206:207], v241 offset:32448
 s_waitcnt lgkmcnt(8)
 v_mfma_f32_32x32x16_bf16 v[80:95], v[212:215], a[16:19], v[80:95]
 ds_read_b64_tr_b16 v[208:209], v240 offset:30976
 ds_read_b64_tr_b16 v[210:211], v240 offset:32512
 s_waitcnt lgkmcnt(8)
 v_mfma_f32_32x32x16_bf16 v[0:15], v[192:195], a[20:23], v[0:15]
 ds_read_b64_tr_b16 v[212:213], v241 offset:31040
 ds_read_b64_tr_b16 v[214:215], v241 offset:32576
 s_waitcnt lgkmcnt(8)
 v_mfma_f32_32x32x16_bf16 v[16:31], v[196:199], a[20:23], v[16:31]
 ds_read_b64_tr_b16 v[192:193], v240 offset:36864
 ds_read_b64_tr_b16 v[194:195], v240 offset:38400
 s_waitcnt lgkmcnt(8)
 v_mfma_f32_32x32x16_bf16 v[32:47], v[200:203], a[20:23], v[32:47]
 buffer_load_dwordx4 a[80:83], v232, s[8:11], s48 offen offset:0
 buffer_load_dwordx4 a[84:87], v232, s[8:11], s48 offen offset:1024
 buffer_load_dwordx4 a[88:91], v232, s[8:11], s48 offen offset:2048
 buffer_load_dwordx4 a[92:95], v232, s[8:11], s48 offen offset:3072
 s_add_u32 s48, s48, 4096
 ds_read_b64_tr_b16 v[196:197], v241 offset:36928
 ds_read_b64_tr_b16 v[198:199], v241 offset:38464
 s_waitcnt lgkmcnt(8)
 v_mfma_f32_32x32x16_bf16 v[48:63], v[204:207], a[20:23], v[48:63]
 ds_read_b64_tr_b16 v[200:201], v240 offset:36992
 ds_read_b64_tr_b16 v[202:203], v240 offset:38528
 s_waitcnt lgkmcnt(8)
 v_mfma_f32_32x32x16_bf16 v[64:79], v[208:211], a[20:23], v[64:79]
 ds_read_b64_tr_b16 v[204:205], v241 offset:37056
 ds_read_b64_tr_b16 v[206:207], v241 offset:38592
 s_waitcnt lgkmcnt(8)
 v_mfma_f32_32x32x16_bf16 v[80:95], v[212:215], a[20:23], v[80:95]
 ds_read_b64_tr_b16 v[208:209], v240 offset:37120
 ds_read_b64_tr_b16 v[210:211], v240 offset:38656
 s_waitcnt lgkmcnt(8)
 v_mfma_f32_32x32x16_bf16 v[0:15], v[192:195], a[24:27], v[0:15]
 ds_read_b64_tr_b16 v[212:213], v241 offset:37184
 ds_read_b64_tr_b16 v[214:215], v241 offset:38720
 s_waitcnt lgkmcnt(8)
 v_mfma_f32_32x32x16_bf16 v[16:31], v[196:199], a[24:27], v[16:31]
 ds_read_b64_tr_b16 v[192:193], v240 offset:43008
 ds_read_b64_tr_b16 v[194:195], v240 offset:44544
 s_waitcnt lgkmcnt(8)
 v_mfma_f32_32x32x16_bf16 v[32:47], v[200:203], a[24:27], v[32:47]
 ds_read_b64_tr_b16 v[196:197], v241 offset:43072
 ds_read_b64_tr_b16 v[198:199], v241 offset:44608
 s_waitcnt lgkmcnt(8)
 v_mfma_f32_32x32x16_bf16 v[48:63], v[204:207], a[24:27], v[48:63]
 ds_read_b64_tr_b16 v[200:201], v240 offset:43136
 ds_read_b64_tr_b16 v[202:203], v240 offset:44672
 s_waitcnt lgkmcnt(8)
 v_mfma_f32_32x32x16_bf16 v[64:79], v[208:211], a[24:27], v[64:79]
 ds_read_b64_tr_b16 v[204:205], v241 offset:43200
 ds_read_b64_tr_b16 v[206:207], v241 offset:44736
 s_waitcnt lgkmcnt(8)
 v_mfma_f32_32x32x16_bf16 v[80:95], v[212:215], a[24:27], v[80:95]
 ds_read_b64_tr_b16 v[208:209], v240 offset:43264
 ds_read_b64_tr_b16 v[210:211], v240 offset:44800
 s_waitcnt lgkmcnt(8)
 v_mfma_f32_32x32x16_bf16 v[0:15], v[192:195], a[28:31], v[0:15]
 ds_read_b64_tr_b16 v[212:213], v241 offset:43328
 ds_read_b64_tr_b16 v[214:215], v241 offset:44864
 s_waitcnt lgkmcnt(8)
 v_mfma_f32_32x32x16_bf16 v[16:31], v[196:199], a[28:31], v[16:31]
 ds_read_b64_tr_b16 v[192:193], v240 offset:49152
 ds_read_b64_tr_b16 v[194:195], v240 offset:50688
 s_waitcnt lgkmcnt(8)
 v_mfma_f32_32x32x16_bf16 v[32:47], v[200:203], a[28:31], v[32:47]
 ds_read_b64_tr_b16 v[196:197], v241 offset:49216
 ds_read_b64_tr_b16 v[198:199], v241 offset:50752
 s_waitcnt lgkmcnt(8)
 v_mfma_f32_32x32x16_bf16 v[48:63], v[204:207], a[28:31], v[48:63]
 ds_read_b64_tr_b16 v[200:201], v240 offset:49280
 ds_read_b64_tr_b16 v[202:203], v240 offset:50816
 s_waitcnt lgkmcnt(8)
 v_mfma_f32_32x32x16_bf16 v[64:79], v[208:211], a[28:31], v[64:79]
 ds_read_b64_tr_b16 v[204:205], v241 offset:49344
 ds_read_b64_tr_b16 v[206:207], v241 offset:50880
 s_waitcnt lgkmcnt(8)
 v_mfma_f32_32x32x16_bf16 v[80:95], v[212:215], a[28:31], v[80:95]
 s_waitcnt vmcnt(24)
 s_barrier
 ds_read_b64_tr_b16 v[208:209], v240 offset:49408
 ds_read_b64_tr_b16 v[210:211], v240 offset:50944
 s_waitcnt lgkmcnt(8)
 v_mfma_f32_32x32x16_bf16 v[0:15], v[192:195], a[32:35], v[0:15]
 ds_read_b64_tr_b16 v[212:213], v241 offset:49472
 ds_read_b64_tr_b16 v[214:215], v241 offset:51008
 s_waitcnt lgkmcnt(8)
 v_mfma_f32_32x32x16_bf16 v[16:31], v[196:199], a[32:35], v[16:31]
 s_add_u32 m0, s19, 24576
 s_add_u32 s29, s52, 4718592
 buffer_load_dwordx4 v236, s[32:35], s29 offen lds
 s_add_u32 m0, s19, 25600
 s_add_u32 s29, s52, 4718592
 buffer_load_dwordx4 v237, s[32:35], s29 offen lds
 s_add_u32 m0, s19, 26624
 s_add_u32 s29, s52, 4718592
 buffer_load_dwordx4 v238, s[32:35], s29 offen lds
 s_add_u32 m0, s19, 27648
 s_add_u32 s29, s52, 4816896
 buffer_load_dwordx4 v236, s[32:35], s29 offen lds
 s_add_u32 m0, s19, 28672
 s_add_u32 s29, s52, 4816896
 buffer_load_dwordx4 v237, s[32:35], s29 offen lds
 s_add_u32 m0, s19, 29696
 s_add_u32 s29, s52, 4816896
 buffer_load_dwordx4 v238, s[32:35], s29 offen lds
 ds_read_b64_tr_b16 v[192:193], v240 offset:55296
 ds_read_b64_tr_b16 v[194:195], v240 offset:56832
 s_waitcnt lgkmcnt(8)
 v_mfma_f32_32x32x16_bf16 v[32:47], v[200:203], a[32:35], v[32:47]
 ds_read_b64_tr_b16 v[196:197], v241 offset:55360
 ds_read_b64_tr_b16 v[198:199], v241 offset:56896
 s_waitcnt lgkmcnt(8)
 v_mfma_f32_32x32x16_bf16 v[48:63], v[204:207], a[32:35], v[48:63]
 ds_read_b64_tr_b16 v[200:201], v240 offset:55424
 ds_read_b64_tr_b16 v[202:203], v240 offset:56960
 s_waitcnt lgkmcnt(8)
 v_mfma_f32_32x32x16_bf16 v[64:79], v[208:211], a[32:35], v[64:79]
 ds_read_b64_tr_b16 v[204:205], v241 offset:55488
 ds_read_b64_tr_b16 v[206:207], v241 offset:57024
 s_waitcnt lgkmcnt(8)
 v_mfma_f32_32x32x16_bf16 v[80:95], v[212:215], a[32:35], v[80:95]
 ds_read_b64_tr_b16 v[208:209], v240 offset:55552
 ds_read_b64_tr_b16 v[210:211], v240 offset:57088
 s_waitcnt lgkmcnt(8)
 v_mfma_f32_32x32x16_bf16 v[0:15], v[192:195], a[36:39], v[0:15]
 ds_read_b64_tr_b16 v[212:213], v241 offset:55616
 ds_read_b64_tr_b16 v[214:215], v241 offset:57152
 s_waitcnt lgkmcnt(8)
 v_mfma_f32_32x32x16_bf16 v[16:31], v[196:199], a[36:39], v[16:31]
 ds_read_b64_tr_b16 v[192:193], v240 offset:61440
 ds_read_b64_tr_b16 v[194:195], v240 offset:62976
 s_waitcnt lgkmcnt(8)
 v_mfma_f32_32x32x16_bf16 v[32:47], v[200:203], a[36:39], v[32:47]
 buffer_load_dwordx4 a[96:99], v232, s[8:11], s48 offen offset:0
 buffer_load_dwordx4 a[100:103], v232, s[8:11], s48 offen offset:1024
 buffer_load_dwordx4 a[104:107], v232, s[8:11], s48 offen offset:2048
 buffer_load_dwordx4 a[108:111], v232, s[8:11], s48 offen offset:3072
 s_add_u32 s48, s48, 4096
 ds_read_b64_tr_b16 v[196:197], v241 offset:61504
 ds_read_b64_tr_b16 v[198:199], v241 offset:63040
 s_waitcnt lgkmcnt(8)
 v_mfma_f32_32x32x16_bf16 v[48:63], v[204:207], a[36:39], v[48:63]
 ds_read_b64_tr_b16 v[200:201], v240 offset:61568
 ds_read_b64_tr_b16 v[202:203], v240 offset:63104
 s_waitcnt lgkmcnt(8)
 v_mfma_f32_32x32x16_bf16 v[64:79], v[208:211], a[36:39], v[64:79]
 ds_read_b64_tr_b16 v[204:205], v241 offset:61632
 ds_read_b64_tr_b16 v[206:207], v241 offset:63168
 s_waitcnt lgkmcnt(8)
 v_mfma_f32_32x32x16_bf16 v[80:95], v[212:215], a[36:39], v[80:95]
 ds_read_b64_tr_b16 v[208:209], v240 offset:61696
 ds_read_b64_tr_b16 v[210:211], v240 offset:63232
 s_waitcnt lgkmcnt(8)
 v_mfma_f32_32x32x16_bf16 v[0:15], v[192:195], a[40:43], v[0:15]
 ds_read_b64_tr_b16 v[212:213], v241 offset:61760
 ds_read_b64_tr_b16 v[214:215], v241 offset:63296
 s_waitcnt lgkmcnt(8)
 v_mfma_f32_32x32x16_bf16 v[16:31], v[196:199], a[40:43], v[16:31]
 ds_read_b64_tr_b16 v[192:193], v248 offset:2048
 ds_read_b64_tr_b16 v[194:195], v248 offset:3584
 s_waitcnt lgkmcnt(8)
 v_mfma_f32_32x32x16_bf16 v[32:47], v[200:203], a[40:43], v[32:47]
 ds_read_b64_tr_b16 v[196:197], v249 offset:2112
 ds_read_b64_tr_b16 v[198:199], v249 offset:3648
 s_waitcnt lgkmcnt(8)
 v_mfma_f32_32x32x16_bf16 v[48:63], v[204:207], a[40:43], v[48:63]
 ds_read_b64_tr_b16 v[200:201], v248 offset:2176
 ds_read_b64_tr_b16 v[202:203], v248 offset:3712
 s_waitcnt lgkmcnt(8)
 v_mfma_f32_32x32x16_bf16 v[64:79], v[208:211], a[40:43], v[64:79]
 ds_read_b64_tr_b16 v[204:205], v249 offset:2240
 ds_read_b64_tr_b16 v[206:207], v249 offset:3776
 s_waitcnt lgkmcnt(8)
 v_mfma_f32_32x32x16_bf16 v[80:95], v[212:215], a[40:43], v[80:95]
 ds_read_b64_tr_b16 v[208:209], v248 offset:2304
 ds_read_b64_tr_b16 v[210:211], v248 offset:3840
 s_waitcnt lgkmcnt(8)
 v_mfma_f32_32x32x16_bf16 v[0:15], v[192:195], a[44:47], v[0:15]
 ds_read_b64_tr_b16 v[212:213], v249 offset:2368
 ds_read_b64_tr_b16 v[214:215], v249 offset:3904
 s_waitcnt lgkmcnt(8)
 v_mfma_f32_32x32x16_bf16 v[16:31], v[196:199], a[44:47], v[16:31]
 ds_read_b64_tr_b16 v[192:193], v248 offset:8192
 ds_read_b64_tr_b16 v[194:195], v248 offset:9728
 s_waitcnt lgkmcnt(8)
 v_mfma_f32_32x32x16_bf16 v[32:47], v[200:203], a[44:47], v[32:47]
 ds_read_b64_tr_b16 v[196:197], v249 offset:8256
 ds_read_b64_tr_b16 v[198:199], v249 offset:9792
 s_waitcnt lgkmcnt(8)
 v_mfma_f32_32x32x16_bf16 v[48:63], v[204:207], a[44:47], v[48:63]
 ds_read_b64_tr_b16 v[200:201], v248 offset:8320
 ds_read_b64_tr_b16 v[202:203], v248 offset:9856
 s_waitcnt lgkmcnt(8)
 v_mfma_f32_32x32x16_bf16 v[64:79], v[208:211], a[44:47], v[64:79]
 ds_read_b64_tr_b16 v[204:205], v249 offset:8384
 ds_read_b64_tr_b16 v[206:207], v249 offset:9920
 s_waitcnt lgkmcnt(8)
 v_mfma_f32_32x32x16_bf16 v[80:95], v[212:215], a[44:47], v[80:95]
 s_waitcnt vmcnt(24)
 s_barrier
 ds_read_b64_tr_b16 v[208:209], v248 offset:8448
 ds_read_b64_tr_b16 v[210:211], v248 offset:9984
 s_waitcnt lgkmcnt(8)
 v_mfma_f32_32x32x16_bf16 v[0:15], v[192:195], a[48:51], v[0:15]
 ds_read_b64_tr_b16 v[212:213], v249 offset:8512
 ds_read_b64_tr_b16 v[214:215], v249 offset:10048
 s_waitcnt lgkmcnt(8)
 v_mfma_f32_32x32x16_bf16 v[16:31], v[196:199], a[48:51], v[16:31]
 s_add_u32 m0, s19, 49152
 s_add_u32 s29, s52, 5505024
 buffer_load_dwordx4 v236, s[32:35], s29 offen lds
 s_add_u32 m0, s19, 50176
 s_add_u32 s29, s52, 5505024
 buffer_load_dwordx4 v237, s[32:35], s29 offen lds
 s_add_u32 m0, s19, 51200
 s_add_u32 s29, s52, 5505024
 buffer_load_dwordx4 v238, s[32:35], s29 offen lds
 s_add_u32 m0, s19, 52224
 s_add_u32 s29, s52, 5603328
 buffer_load_dwordx4 v236, s[32:35], s29 offen lds
 s_add_u32 m0, s19, 53248
 s_add_u32 s29, s52, 5603328
 buffer_load_dwordx4 v237, s[32:35], s29 offen lds
 s_add_u32 m0, s19, 54272
 s_add_u32 s29, s52, 5603328
 buffer_load_dwordx4 v238, s[32:35], s29 offen lds
 ds_read_b64_tr_b16 v[192:193], v248 offset:14336
 ds_read_b64_tr_b16 v[194:195], v248 offset:15872
 s_waitcnt lgkmcnt(8)
 v_mfma_f32_32x32x16_bf16 v[32:47], v[200:203], a[48:51], v[32:47]
 ds_read_b64_tr_b16 v[196:197], v249 offset:14400
 ds_read_b64_tr_b16 v[198:199], v249 offset:15936
 s_waitcnt lgkmcnt(8)
 v_mfma_f32_32x32x16_bf16 v[48:63], v[204:207], a[48:51], v[48:63]
 ds_read_b64_tr_b16 v[200:201], v248 offset:14464
 ds_read_b64_tr_b16 v[202:203], v248 offset:16000
 s_waitcnt lgkmcnt(8)
 v_mfma_f32_32x32x16_bf16 v[64:79], v[208:211], a[48:51], v[64:79]
 ds_read_b64_tr_b16 v[204:205], v249 offset:14528
 ds_read_b64_tr_b16 v[206:207], v249 offset:16064
 s_waitcnt lgkmcnt(8)
 v_mfma_f32_32x32x16_bf16 v[80:95], v[212:215], a[48:51], v[80:95]
 ds_read_b64_tr_b16 v[208:209], v248 offset:14592
 ds_read_b64_tr_b16 v[210:211], v248 offset:16128
 s_waitcnt lgkmcnt(8)
 v_mfma_f32_32x32x16_bf16 v[0:15], v[192:195], a[52:55], v[0:15]
 ds_read_b64_tr_b16 v[212:213], v249 offset:14656
 ds_read_b64_tr_b16 v[214:215], v249 offset:16192
 s_waitcnt lgkmcnt(8)
 v_mfma_f32_32x32x16_bf16 v[16:31], v[196:199], a[52:55], v[16:31]
 ds_read_b64_tr_b16 v[192:193], v248 offset:20480
 ds_read_b64_tr_b16 v[194:195], v248 offset:22016
 s_waitcnt lgkmcnt(8)
 v_mfma_f32_32x32x16_bf16 v[32:47], v[200:203], a[52:55], v[32:47]
 buffer_load_dwordx4 a[112:115], v232, s[8:11], s48 offen offset:0
 buffer_load_dwordx4 a[116:119], v232, s[8:11], s48 offen offset:1024
 buffer_load_dwordx4 a[120:123], v232, s[8:11], s48 offen offset:2048
 buffer_load_dwordx4 a[124:127], v232, s[8:11], s48 offen offset:3072
 s_add_u32 s48, s48, 4096
 ds_read_b64_tr_b16 v[196:197], v249 offset:20544
 ds_read_b64_tr_b16 v[198:199], v249 offset:22080
 s_waitcnt lgkmcnt(8)
 v_mfma_f32_32x32x16_bf16 v[48:63], v[204:207], a[52:55], v[48:63]
 ds_read_b64_tr_b16 v[200:201], v248 offset:20608
 ds_read_b64_tr_b16 v[202:203], v248 offset:22144
 s_waitcnt lgkmcnt(8)
 v_mfma_f32_32x32x16_bf16 v[64:79], v[208:211], a[52:55], v[64:79]
 ds_read_b64_tr_b16 v[204:205], v249 offset:20672
 ds_read_b64_tr_b16 v[206:207], v249 offset:22208
 s_waitcnt lgkmcnt(8)
 v_mfma_f32_32x32x16_bf16 v[80:95], v[212:215], a[52:55], v[80:95]
 ds_read_b64_tr_b16 v[208:209], v248 offset:20736
 ds_read_b64_tr_b16 v[210:211], v248 offset:22272
 s_waitcnt lgkmcnt(8)
 v_mfma_f32_32x32x16_bf16 v[0:15], v[192:195], a[56:59], v[0:15]
 ds_read_b64_tr_b16 v[212:213], v249 offset:20800
 ds_read_b64_tr_b16 v[214:215], v249 offset:22336
 s_waitcnt lgkmcnt(8)
 v_mfma_f32_32x32x16_bf16 v[16:31], v[196:199], a[56:59], v[16:31]
 ds_read_b64_tr_b16 v[192:193], v248 offset:26624
 ds_read_b64_tr_b16 v[194:195], v248 offset:28160
 s_waitcnt lgkmcnt(8)
 v_mfma_f32_32x32x16_bf16 v[32:47], v[200:203], a[56:59], v[32:47]
 ds_read_b64_tr_b16 v[196:197], v249 offset:26688
 ds_read_b64_tr_b16 v[198:199], v249 offset:28224
 s_waitcnt lgkmcnt(8)
 v_mfma_f32_32x32x16_bf16 v[48:63], v[204:207], a[56:59], v[48:63]
 ds_read_b64_tr_b16 v[200:201], v248 offset:26752
 ds_read_b64_tr_b16 v[202:203], v248 offset:28288
 s_waitcnt lgkmcnt(8)
 v_mfma_f32_32x32x16_bf16 v[64:79], v[208:211], a[56:59], v[64:79]
 ds_read_b64_tr_b16 v[204:205], v249 offset:26816
 ds_read_b64_tr_b16 v[206:207], v249 offset:28352
 s_waitcnt lgkmcnt(8)
 v_mfma_f32_32x32x16_bf16 v[80:95], v[212:215], a[56:59], v[80:95]
 ds_read_b64_tr_b16 v[208:209], v248 offset:26880
 ds_read_b64_tr_b16 v[210:211], v248 offset:28416
 s_waitcnt lgkmcnt(8)
 v_mfma_f32_32x32x16_bf16 v[0:15], v[192:195], a[60:63], v[0:15]
 ds_read_b64_tr_b16 v[212:213], v249 offset:26944
 ds_read_b64_tr_b16 v[214:215], v249 offset:28480
 s_waitcnt lgkmcnt(8)
 v_mfma_f32_32x32x16_bf16 v[16:31], v[196:199], a[60:63], v[16:31]
 ds_read_b64_tr_b16 v[192:193], v248 offset:32768
 ds_read_b64_tr_b16 v[194:195], v248 offset:34304
 s_waitcnt lgkmcnt(8)
 v_mfma_f32_32x32x16_bf16 v[32:47], v[200:203], a[60:63], v[32:47]
 ds_read_b64_tr_b16 v[196:197], v249 offset:32832
 ds_read_b64_tr_b16 v[198:199], v249 offset:34368
 s_waitcnt lgkmcnt(8)
 v_mfma_f32_32x32x16_bf16 v[48:63], v[204:207], a[60:63], v[48:63]
 ds_read_b64_tr_b16 v[200:201], v248 offset:32896
 ds_read_b64_tr_b16 v[202:203], v248 offset:34432
 s_waitcnt lgkmcnt(8)
 v_mfma_f32_32x32x16_bf16 v[64:79], v[208:211], a[60:63], v[64:79]
 ds_read_b64_tr_b16 v[204:205], v249 offset:32960
 ds_read_b64_tr_b16 v[206:207], v249 offset:34496
 s_waitcnt lgkmcnt(8)
 v_mfma_f32_32x32x16_bf16 v[80:95], v[212:215], a[60:63], v[80:95]
 s_waitcnt vmcnt(24)
 s_barrier
 ds_read_b64_tr_b16 v[208:209], v248 offset:33024
 ds_read_b64_tr_b16 v[210:211], v248 offset:34560
 s_waitcnt lgkmcnt(8)
 v_mfma_f32_32x32x16_bf16 v[0:15], v[192:195], a[64:67], v[0:15]
 ds_read_b64_tr_b16 v[212:213], v249 offset:33088
 ds_read_b64_tr_b16 v[214:215], v249 offset:34624
 s_waitcnt lgkmcnt(8)
 v_mfma_f32_32x32x16_bf16 v[16:31], v[196:199], a[64:67], v[16:31]
 s_add_u32 m0, s19, 73728
 s_add_u32 s29, s52, 6291456
 buffer_load_dwordx4 v236, s[32:35], s29 offen lds
 s_add_u32 m0, s19, 74752
 s_add_u32 s29, s52, 6291456
 buffer_load_dwordx4 v237, s[32:35], s29 offen lds
 s_add_u32 m0, s19, 75776
 s_add_u32 s29, s52, 6291456
 buffer_load_dwordx4 v238, s[32:35], s29 offen lds
 s_add_u32 m0, s19, 76800
 s_add_u32 s29, s52, 6389760
 buffer_load_dwordx4 v236, s[32:35], s29 offen lds
 s_add_u32 m0, s19, 77824
 s_add_u32 s29, s52, 6389760
 buffer_load_dwordx4 v237, s[32:35], s29 offen lds
 s_add_u32 m0, s19, 78848
 s_add_u32 s29, s52, 6389760
 buffer_load_dwordx4 v238, s[32:35], s29 offen lds
 ds_read_b64_tr_b16 v[192:193], v248 offset:38912
 ds_read_b64_tr_b16 v[194:195], v248 offset:40448
 s_waitcnt lgkmcnt(8)
 v_mfma_f32_32x32x16_bf16 v[32:47], v[200:203], a[64:67], v[32:47]
 ds_read_b64_tr_b16 v[196:197], v249 offset:38976
 ds_read_b64_tr_b16 v[198:199], v249 offset:40512
 s_waitcnt lgkmcnt(8)
 v_mfma_f32_32x32x16_bf16 v[48:63], v[204:207], a[64:67], v[48:63]
 ds_read_b64_tr_b16 v[200:201], v248 offset:39040
 ds_read_b64_tr_b16 v[202:203], v248 offset:40576
 s_waitcnt lgkmcnt(8)
 v_mfma_f32_32x32x16_bf16 v[64:79], v[208:211], a[64:67], v[64:79]
 ds_read_b64_tr_b16 v[204:205], v249 offset:39104
 ds_read_b64_tr_b16 v[206:207], v249 offset:40640
 s_waitcnt lgkmcnt(8)
 v_mfma_f32_32x32x16_bf16 v[80:95], v[212:215], a[64:67], v[80:95]
 ds_read_b64_tr_b16 v[208:209], v248 offset:39168
 ds_read_b64_tr_b16 v[210:211], v248 offset:40704
 s_waitcnt lgkmcnt(8)
 v_mfma_f32_32x32x16_bf16 v[0:15], v[192:195], a[68:71], v[0:15]
 ds_read_b64_tr_b16 v[212:213], v249 offset:39232
 ds_read_b64_tr_b16 v[214:215], v249 offset:40768
 s_waitcnt lgkmcnt(8)
 v_mfma_f32_32x32x16_bf16 v[16:31], v[196:199], a[68:71], v[16:31]
 ds_read_b64_tr_b16 v[192:193], v248 offset:45056
 ds_read_b64_tr_b16 v[194:195], v248 offset:46592
 s_waitcnt lgkmcnt(8)
 v_mfma_f32_32x32x16_bf16 v[32:47], v[200:203], a[68:71], v[32:47]
 buffer_load_dwordx4 a[128:131], v232, s[8:11], s48 offen offset:0
 buffer_load_dwordx4 a[132:135], v232, s[8:11], s48 offen offset:1024
 buffer_load_dwordx4 a[136:139], v232, s[8:11], s48 offen offset:2048
 buffer_load_dwordx4 a[140:143], v232, s[8:11], s48 offen offset:3072
 s_add_u32 s48, s48, 4096
 ds_read_b64_tr_b16 v[196:197], v249 offset:45120
 ds_read_b64_tr_b16 v[198:199], v249 offset:46656
 s_waitcnt lgkmcnt(8)
 v_mfma_f32_32x32x16_bf16 v[48:63], v[204:207], a[68:71], v[48:63]
 ds_read_b64_tr_b16 v[200:201], v248 offset:45184
 ds_read_b64_tr_b16 v[202:203], v248 offset:46720
 s_waitcnt lgkmcnt(8)
 v_mfma_f32_32x32x16_bf16 v[64:79], v[208:211], a[68:71], v[64:79]
 ds_read_b64_tr_b16 v[204:205], v249 offset:45248
 ds_read_b64_tr_b16 v[206:207], v249 offset:46784
 s_waitcnt lgkmcnt(8)
 v_mfma_f32_32x32x16_bf16 v[80:95], v[212:215], a[68:71], v[80:95]
 ds_read_b64_tr_b16 v[208:209], v248 offset:45312
 ds_read_b64_tr_b16 v[210:211], v248 offset:46848
 s_waitcnt lgkmcnt(8)
 v_mfma_f32_32x32x16_bf16 v[0:15], v[192:195], a[72:75], v[0:15]
 ds_read_b64_tr_b16 v[212:213], v249 offset:45376
 ds_read_b64_tr_b16 v[214:215], v249 offset:46912
 s_waitcnt lgkmcnt(8)
 v_mfma_f32_32x32x16_bf16 v[16:31], v[196:199], a[72:75], v[16:31]
 ds_read_b64_tr_b16 v[192:193], v248 offset:51200
 ds_read_b64_tr_b16 v[194:195], v248 offset:52736
 s_waitcnt lgkmcnt(8)
 v_mfma_f32_32x32x16_bf16 v[32:47], v[200:203], a[72:75], v[32:47]
 ds_read_b64_tr_b16 v[196:197], v249 offset:51264
 ds_read_b64_tr_b16 v[198:199], v249 offset:52800
 s_waitcnt lgkmcnt(8)
 v_mfma_f32_32x32x16_bf16 v[48:63], v[204:207], a[72:75], v[48:63]
 ds_read_b64_tr_b16 v[200:201], v248 offset:51328
 ds_read_b64_tr_b16 v[202:203], v248 offset:52864
 s_waitcnt lgkmcnt(8)
 v_mfma_f32_32x32x16_bf16 v[64:79], v[208:211], a[72:75], v[64:79]
 ds_read_b64_tr_b16 v[204:205], v249 offset:51392
 ds_read_b64_tr_b16 v[206:207], v249 offset:52928
 s_waitcnt lgkmcnt(8)
 v_mfma_f32_32x32x16_bf16 v[80:95], v[212:215], a[72:75], v[80:95]
 ds_read_b64_tr_b16 v[208:209], v248 offset:51456
 ds_read_b64_tr_b16 v[210:211], v248 offset:52992
 s_waitcnt lgkmcnt(8)
 v_mfma_f32_32x32x16_bf16 v[0:15], v[192:195], a[76:79], v[0:15]
 ds_read_b64_tr_b16 v[212:213], v249 offset:51520
 ds_read_b64_tr_b16 v[214:215], v249 offset:53056
 s_waitcnt lgkmcnt(8)
 v_mfma_f32_32x32x16_bf16 v[16:31], v[196:199], a[76:79], v[16:31]
 ds_read_b64_tr_b16 v[192:193], v240 offset:0
 ds_read_b64_tr_b16 v[194:195], v240 offset:1536
 s_waitcnt lgkmcnt(8)
 v_mfma_f32_32x32x16_bf16 v[32:47], v[200:203], a[76:79], v[32:47]
 ds_read_b64_tr_b16 v[196:197], v241 offset:64
 ds_read_b64_tr_b16 v[198:199], v241 offset:1600
 s_waitcnt lgkmcnt(8)
 v_mfma_f32_32x32x16_bf16 v[48:63], v[204:207], a[76:79], v[48:63]
 ds_read_b64_tr_b16 v[200:201], v240 offset:128
 ds_read_b64_tr_b16 v[202:203], v240 offset:1664
 s_waitcnt lgkmcnt(8)
 v_mfma_f32_32x32x16_bf16 v[64:79], v[208:211], a[76:79], v[64:79]
 ds_read_b64_tr_b16 v[204:205], v241 offset:192
 ds_read_b64_tr_b16 v[206:207], v241 offset:1728
 s_waitcnt lgkmcnt(8)
 v_mfma_f32_32x32x16_bf16 v[80:95], v[212:215], a[76:79], v[80:95]
 s_waitcnt vmcnt(24)
 s_barrier
 ds_read_b64_tr_b16 v[208:209], v240 offset:256
 ds_read_b64_tr_b16 v[210:211], v240 offset:1792
 s_waitcnt lgkmcnt(8)
 v_mfma_f32_32x32x16_bf16 v[0:15], v[192:195], a[80:83], v[0:15]
 ds_read_b64_tr_b16 v[212:213], v241 offset:320
 ds_read_b64_tr_b16 v[214:215], v241 offset:1856
 s_waitcnt lgkmcnt(8)
 v_mfma_f32_32x32x16_bf16 v[16:31], v[196:199], a[80:83], v[16:31]
 s_add_u32 m0, s19, 98304
 s_add_u32 s29, s52, 7077888
 buffer_load_dwordx4 v236, s[32:35], s29 offen lds
 s_add_u32 m0, s19, 99328
 s_add_u32 s29, s52, 7077888
 buffer_load_dwordx4 v237, s[32:35], s29 offen lds
 s_add_u32 m0, s19, 100352
 s_add_u32 s29, s52, 7077888
 buffer_load_dwordx4 v238, s[32:35], s29 offen lds
 s_add_u32 m0, s19, 101376
 s_add_u32 s29, s52, 7176192
 buffer_load_dwordx4 v236, s[32:35], s29 offen lds
 s_add_u32 m0, s19, 102400
 s_add_u32 s29, s52, 7176192
 buffer_load_dwordx4 v237, s[32:35], s29 offen lds
 s_add_u32 m0, s19, 103424
 s_add_u32 s29, s52, 7176192
 buffer_load_dwordx4 v238, s[32:35], s29 offen lds
 ds_read_b64_tr_b16 v[192:193], v240 offset:6144
 ds_read_b64_tr_b16 v[194:195], v240 offset:7680
 s_waitcnt lgkmcnt(8)
 v_mfma_f32_32x32x16_bf16 v[32:47], v[200:203], a[80:83], v[32:47]
 ds_read_b64_tr_b16 v[196:197], v241 offset:6208
 ds_read_b64_tr_b16 v[198:199], v241 offset:7744
 s_waitcnt lgkmcnt(8)
 v_mfma_f32_32x32x16_bf16 v[48:63], v[204:207], a[80:83], v[48:63]
 ds_read_b64_tr_b16 v[200:201], v240 offset:6272
 ds_read_b64_tr_b16 v[202:203], v240 offset:7808
 s_waitcnt lgkmcnt(8)
 v_mfma_f32_32x32x16_bf16 v[64:79], v[208:211], a[80:83], v[64:79]
 ds_read_b64_tr_b16 v[204:205], v241 offset:6336
 ds_read_b64_tr_b16 v[206:207], v241 offset:7872
 s_waitcnt lgkmcnt(8)
 v_mfma_f32_32x32x16_bf16 v[80:95], v[212:215], a[80:83], v[80:95]
 ds_read_b64_tr_b16 v[208:209], v240 offset:6400
 ds_read_b64_tr_b16 v[210:211], v240 offset:7936
 s_waitcnt lgkmcnt(8)
 v_mfma_f32_32x32x16_bf16 v[0:15], v[192:195], a[84:87], v[0:15]
 ds_read_b64_tr_b16 v[212:213], v241 offset:6464
 ds_read_b64_tr_b16 v[214:215], v241 offset:8000
 s_waitcnt lgkmcnt(8)
 v_mfma_f32_32x32x16_bf16 v[16:31], v[196:199], a[84:87], v[16:31]
 ds_read_b64_tr_b16 v[192:193], v240 offset:12288
 ds_read_b64_tr_b16 v[194:195], v240 offset:13824
 s_waitcnt lgkmcnt(8)
 v_mfma_f32_32x32x16_bf16 v[32:47], v[200:203], a[84:87], v[32:47]
 buffer_load_dwordx4 a[144:147], v232, s[8:11], s48 offen offset:0
 buffer_load_dwordx4 a[148:151], v232, s[8:11], s48 offen offset:1024
 buffer_load_dwordx4 a[152:155], v232, s[8:11], s48 offen offset:2048
 buffer_load_dwordx4 a[156:159], v232, s[8:11], s48 offen offset:3072
 s_add_u32 s48, s48, 4096
 ds_read_b64_tr_b16 v[196:197], v241 offset:12352
 ds_read_b64_tr_b16 v[198:199], v241 offset:13888
 s_waitcnt lgkmcnt(8)
 v_mfma_f32_32x32x16_bf16 v[48:63], v[204:207], a[84:87], v[48:63]
 ds_read_b64_tr_b16 v[200:201], v240 offset:12416
 ds_read_b64_tr_b16 v[202:203], v240 offset:13952
 s_waitcnt lgkmcnt(8)
 v_mfma_f32_32x32x16_bf16 v[64:79], v[208:211], a[84:87], v[64:79]
 ds_read_b64_tr_b16 v[204:205], v241 offset:12480
 ds_read_b64_tr_b16 v[206:207], v241 offset:14016
 s_waitcnt lgkmcnt(8)
 v_mfma_f32_32x32x16_bf16 v[80:95], v[212:215], a[84:87], v[80:95]
 ds_read_b64_tr_b16 v[208:209], v240 offset:12544
 ds_read_b64_tr_b16 v[210:211], v240 offset:14080
 s_waitcnt lgkmcnt(8)
 v_mfma_f32_32x32x16_bf16 v[0:15], v[192:195], a[88:91], v[0:15]
 ds_read_b64_tr_b16 v[212:213], v241 offset:12608
 ds_read_b64_tr_b16 v[214:215], v241 offset:14144
 s_waitcnt lgkmcnt(8)
 v_mfma_f32_32x32x16_bf16 v[16:31], v[196:199], a[88:91], v[16:31]
 ds_read_b64_tr_b16 v[192:193], v240 offset:18432
 ds_read_b64_tr_b16 v[194:195], v240 offset:19968
 s_waitcnt lgkmcnt(8)
 v_mfma_f32_32x32x16_bf16 v[32:47], v[200:203], a[88:91], v[32:47]
 ds_read_b64_tr_b16 v[196:197], v241 offset:18496
 ds_read_b64_tr_b16 v[198:199], v241 offset:20032
 s_waitcnt lgkmcnt(8)
 v_mfma_f32_32x32x16_bf16 v[48:63], v[204:207], a[88:91], v[48:63]
 ds_read_b64_tr_b16 v[200:201], v240 offset:18560
 ds_read_b64_tr_b16 v[202:203], v240 offset:20096
 s_waitcnt lgkmcnt(8)
 v_mfma_f32_32x32x16_bf16 v[64:79], v[208:211], a[88:91], v[64:79]
 ds_read_b64_tr_b16 v[204:205], v241 offset:18624
 ds_read_b64_tr_b16 v[206:207], v241 offset:20160
 s_waitcnt lgkmcnt(8)
 v_mfma_f32_32x32x16_bf16 v[80:95], v[212:215], a[88:91], v[80:95]
 ds_read_b64_tr_b16 v[208:209], v240 offset:18688
 ds_read_b64_tr_b16 v[210:211], v240 offset:20224
 s_waitcnt lgkmcnt(8)
 v_mfma_f32_32x32x16_bf16 v[0:15], v[192:195], a[92:95], v[0:15]
 ds_read_b64_tr_b16 v[212:213], v241 offset:18752
 ds_read_b64_tr_b16 v[214:215], v241 offset:20288
 s_waitcnt lgkmcnt(8)
 v_mfma_f32_32x32x16_bf16 v[16:31], v[196:199], a[92:95], v[16:31]
 ds_read_b64_tr_b16 v[192:193], v240 offset:24576
 ds_read_b64_tr_b16 v[194:195], v240 offset:26112
 s_waitcnt lgkmcnt(8)
 v_mfma_f32_32x32x16_bf16 v[32:47], v[200:203], a[92:95], v[32:47]
 ds_read_b64_tr_b16 v[196:197], v241 offset:24640
 ds_read_b64_tr_b16 v[198:199], v241 offset:26176
 s_waitcnt lgkmcnt(8)
 v_mfma_f32_32x32x16_bf16 v[48:63], v[204:207], a[92:95], v[48:63]
 ds_read_b64_tr_b16 v[200:201], v240 offset:24704
 ds_read_b64_tr_b16 v[202:203], v240 offset:26240
 s_waitcnt lgkmcnt(8)
 v_mfma_f32_32x32x16_bf16 v[64:79], v[208:211], a[92:95], v[64:79]
 ds_read_b64_tr_b16 v[204:205], v241 offset:24768
 ds_read_b64_tr_b16 v[206:207], v241 offset:26304
 s_waitcnt lgkmcnt(8)
 v_mfma_f32_32x32x16_bf16 v[80:95], v[212:215], a[92:95], v[80:95]
 s_waitcnt vmcnt(24)
 s_barrier
 ds_read_b64_tr_b16 v[208:209], v240 offset:24832
 ds_read_b64_tr_b16 v[210:211], v240 offset:26368
 s_waitcnt lgkmcnt(8)
 v_mfma_f32_32x32x16_bf16 v[0:15], v[192:195], a[96:99], v[0:15]
 ds_read_b64_tr_b16 v[212:213], v241 offset:24896
 ds_read_b64_tr_b16 v[214:215], v241 offset:26432
 s_waitcnt lgkmcnt(8)
 v_mfma_f32_32x32x16_bf16 v[16:31], v[196:199], a[96:99], v[16:31]
 s_add_u32 m0, s19, 0
 s_add_u32 s29, s55, 0
 buffer_load_dwordx4 v239, s[36:39], s29 offen lds
 s_add_u32 m0, s19, 1024
 s_add_u32 s29, s55, 10240
 buffer_load_dwordx4 v239, s[36:39], s29 offen lds
 s_add_u32 m0, s19, 2048
 s_add_u32 s29, s55, 20480
 buffer_load_dwordx4 v239, s[36:39], s29 offen lds
 s_add_u32 m0, s19, 3072
 s_add_u32 s29, s55, 30720
 buffer_load_dwordx4 v239, s[36:39], s29 offen lds
 s_add_u32 m0, s19, 4096
 s_add_u32 s29, s55, 40960
 buffer_load_dwordx4 v239, s[36:39], s29 offen lds
 s_add_u32 m0, s19, 5120
 s_add_u32 s29, s55, 51200
 buffer_load_dwordx4 v239, s[36:39], s29 offen lds
 ds_read_b64_tr_b16 v[192:193], v240 offset:30720
 ds_read_b64_tr_b16 v[194:195], v240 offset:32256
 s_waitcnt lgkmcnt(8)
 v_mfma_f32_32x32x16_bf16 v[32:47], v[200:203], a[96:99], v[32:47]
 ds_read_b64_tr_b16 v[196:197], v241 offset:30784
 ds_read_b64_tr_b16 v[198:199], v241 offset:32320
 s_waitcnt lgkmcnt(8)
 v_mfma_f32_32x32x16_bf16 v[48:63], v[204:207], a[96:99], v[48:63]
 ds_read_b64_tr_b16 v[200:201], v240 offset:30848
 ds_read_b64_tr_b16 v[202:203], v240 offset:32384
 s_waitcnt lgkmcnt(8)
 v_mfma_f32_32x32x16_bf16 v[64:79], v[208:211], a[96:99], v[64:79]
 ds_read_b64_tr_b16 v[204:205], v241 offset:30912
 ds_read_b64_tr_b16 v[206:207], v241 offset:32448
 s_waitcnt lgkmcnt(8)
 v_mfma_f32_32x32x16_bf16 v[80:95], v[212:215], a[96:99], v[80:95]
 ds_read_b64_tr_b16 v[208:209], v240 offset:30976
 ds_read_b64_tr_b16 v[210:211], v240 offset:32512
 s_waitcnt lgkmcnt(8)
 v_mfma_f32_32x32x16_bf16 v[0:15], v[192:195], a[100:103], v[0:15]
 ds_read_b64_tr_b16 v[212:213], v241 offset:31040
 ds_read_b64_tr_b16 v[214:215], v241 offset:32576
 s_waitcnt lgkmcnt(8)
 v_mfma_f32_32x32x16_bf16 v[16:31], v[196:199], a[100:103], v[16:31]
 ds_read_b64_tr_b16 v[192:193], v240 offset:36864
 ds_read_b64_tr_b16 v[194:195], v240 offset:38400
 s_waitcnt lgkmcnt(8)
 v_mfma_f32_32x32x16_bf16 v[32:47], v[200:203], a[100:103], v[32:47]
 ds_read_b64_tr_b16 v[196:197], v241 offset:36928
 ds_read_b64_tr_b16 v[198:199], v241 offset:38464
 s_waitcnt lgkmcnt(8)
 v_mfma_f32_32x32x16_bf16 v[48:63], v[204:207], a[100:103], v[48:63]
 ds_read_b64_tr_b16 v[200:201], v240 offset:36992
 ds_read_b64_tr_b16 v[202:203], v240 offset:38528
 s_waitcnt lgkmcnt(8)
 v_mfma_f32_32x32x16_bf16 v[64:79], v[208:211], a[100:103], v[64:79]
 ds_read_b64_tr_b16 v[204:205], v241 offset:37056
 ds_read_b64_tr_b16 v[206:207], v241 offset:38592
 s_waitcnt lgkmcnt(8)
 v_mfma_f32_32x32x16_bf16 v[80:95], v[212:215], a[100:103], v[80:95]
 ds_read_b64_tr_b16 v[208:209], v240 offset:37120
 ds_read_b64_tr_b16 v[210:211], v240 offset:38656
 s_waitcnt lgkmcnt(8)
 v_mfma_f32_32x32x16_bf16 v[0:15], v[192:195], a[104:107], v[0:15]
 ds_read_b64_tr_b16 v[212:213], v241 offset:37184
 ds_read_b64_tr_b16 v[214:215], v241 offset:38720
 s_waitcnt lgkmcnt(8)
 v_mfma_f32_32x32x16_bf16 v[16:31], v[196:199], a[104:107], v[16:31]
 ds_read_b64_tr_b16 v[192:193], v240 offset:43008
 ds_read_b64_tr_b16 v[194:195], v240 offset:44544
 s_waitcnt lgkmcnt(8)
 v_mfma_f32_32x32x16_bf16 v[32:47], v[200:203], a[104:107], v[32:47]
 ds_read_b64_tr_b16 v[196:197], v241 offset:43072
 ds_read_b64_tr_b16 v[198:199], v241 offset:44608
 s_waitcnt lgkmcnt(8)
 v_mfma_f32_32x32x16_bf16 v[48:63], v[204:207], a[104:107], v[48:63]
 ds_read_b64_tr_b16 v[200:201], v240 offset:43136
 ds_read_b64_tr_b16 v[202:203], v240 offset:44672
 s_waitcnt lgkmcnt(8)
 v_mfma_f32_32x32x16_bf16 v[64:79], v[208:211], a[104:107], v[64:79]
 ds_read_b64_tr_b16 v[204:205], v241 offset:43200
 ds_read_b64_tr_b16 v[206:207], v241 offset:44736
 s_waitcnt lgkmcnt(8)
 v_mfma_f32_32x32x16_bf16 v[80:95], v[212:215], a[104:107], v[80:95]
 ds_read_b64_tr_b16 v[208:209], v240 offset:43264
 ds_read_b64_tr_b16 v[210:211], v240 offset:44800
 s_waitcnt lgkmcnt(8)
 v_mfma_f32_32x32x16_bf16 v[0:15], v[192:195], a[108:111], v[0:15]
 ds_read_b64_tr_b16 v[212:213], v241 offset:43328
 ds_read_b64_tr_b16 v[214:215], v241 offset:44864
 s_waitcnt lgkmcnt(8)
 v_mfma_f32_32x32x16_bf16 v[16:31], v[196:199], a[108:111], v[16:31]
 ds_read_b64_tr_b16 v[192:193], v240 offset:49152
 ds_read_b64_tr_b16 v[194:195], v240 offset:50688
 s_waitcnt lgkmcnt(8)
 v_mfma_f32_32x32x16_bf16 v[32:47], v[200:203], a[108:111], v[32:47]
 ds_read_b64_tr_b16 v[196:197], v241 offset:49216
 ds_read_b64_tr_b16 v[198:199], v241 offset:50752
 s_waitcnt lgkmcnt(8)
 v_mfma_f32_32x32x16_bf16 v[48:63], v[204:207], a[108:111], v[48:63]
 ds_read_b64_tr_b16 v[200:201], v240 offset:49280
 ds_read_b64_tr_b16 v[202:203], v240 offset:50816
 s_waitcnt lgkmcnt(8)
 v_mfma_f32_32x32x16_bf16 v[64:79], v[208:211], a[108:111], v[64:79]
 ds_read_b64_tr_b16 v[204:205], v241 offset:49344
 ds_read_b64_tr_b16 v[206:207], v241 offset:50880
 s_waitcnt lgkmcnt(8)
 v_mfma_f32_32x32x16_bf16 v[80:95], v[212:215], a[108:111], v[80:95]
 s_waitcnt vmcnt(20)
 s_barrier
 ds_read_b64_tr_b16 v[208:209], v240 offset:49408
 ds_read_b64_tr_b16 v[210:211], v240 offset:50944
 s_waitcnt lgkmcnt(8)
 v_mfma_f32_32x32x16_bf16 v[0:15], v[192:195], a[112:115], v[0:15]
 ds_read_b64_tr_b16 v[212:213], v241 offset:49472
 ds_read_b64_tr_b16 v[214:215], v241 offset:51008
 s_waitcnt lgkmcnt(8)
 v_mfma_f32_32x32x16_bf16 v[16:31], v[196:199], a[112:115], v[16:31]
 s_add_u32 m0, s19, 24576
 s_add_u32 s29, s55, 128
 buffer_load_dwordx4 v239, s[36:39], s29 offen lds
 s_add_u32 m0, s19, 25600
 s_add_u32 s29, s55, 10368
 buffer_load_dwordx4 v239, s[36:39], s29 offen lds
 s_add_u32 m0, s19, 26624
 s_add_u32 s29, s55, 20608
 buffer_load_dwordx4 v239, s[36:39], s29 offen lds
 s_add_u32 m0, s19, 27648
 s_add_u32 s29, s55, 30848
 buffer_load_dwordx4 v239, s[36:39], s29 offen lds
 s_add_u32 m0, s19, 28672
 s_add_u32 s29, s55, 41088
 buffer_load_dwordx4 v239, s[36:39], s29 offen lds
 s_add_u32 m0, s19, 29696
 s_add_u32 s29, s55, 51328
 buffer_load_dwordx4 v239, s[36:39], s29 offen lds
 ds_read_b64_tr_b16 v[192:193], v240 offset:55296
 ds_read_b64_tr_b16 v[194:195], v240 offset:56832
 s_waitcnt lgkmcnt(8)
 v_mfma_f32_32x32x16_bf16 v[32:47], v[200:203], a[112:115], v[32:47]
 ds_read_b64_tr_b16 v[196:197], v241 offset:55360
 ds_read_b64_tr_b16 v[198:199], v241 offset:56896
 s_waitcnt lgkmcnt(8)
 v_mfma_f32_32x32x16_bf16 v[48:63], v[204:207], a[112:115], v[48:63]
 ds_read_b64_tr_b16 v[200:201], v240 offset:55424
 ds_read_b64_tr_b16 v[202:203], v240 offset:56960
 s_waitcnt lgkmcnt(8)
 v_mfma_f32_32x32x16_bf16 v[64:79], v[208:211], a[112:115], v[64:79]
 ds_read_b64_tr_b16 v[204:205], v241 offset:55488
 ds_read_b64_tr_b16 v[206:207], v241 offset:57024
 s_waitcnt lgkmcnt(8)
 v_mfma_f32_32x32x16_bf16 v[80:95], v[212:215], a[112:115], v[80:95]
 ds_read_b64_tr_b16 v[208:209], v240 offset:55552
 ds_read_b64_tr_b16 v[210:211], v240 offset:57088
 s_waitcnt lgkmcnt(8)
 v_mfma_f32_32x32x16_bf16 v[0:15], v[192:195], a[116:119], v[0:15]
 ds_read_b64_tr_b16 v[212:213], v241 offset:55616
 ds_read_b64_tr_b16 v[214:215], v241 offset:57152
 s_waitcnt lgkmcnt(8)
 v_mfma_f32_32x32x16_bf16 v[16:31], v[196:199], a[116:119], v[16:31]
 ds_read_b64_tr_b16 v[192:193], v240 offset:61440
 ds_read_b64_tr_b16 v[194:195], v240 offset:62976
 s_waitcnt lgkmcnt(8)
 v_mfma_f32_32x32x16_bf16 v[32:47], v[200:203], a[116:119], v[32:47]
 ds_read_b64_tr_b16 v[196:197], v241 offset:61504
 ds_read_b64_tr_b16 v[198:199], v241 offset:63040
 s_waitcnt lgkmcnt(8)
 v_mfma_f32_32x32x16_bf16 v[48:63], v[204:207], a[116:119], v[48:63]
 ds_read_b64_tr_b16 v[200:201], v240 offset:61568
 ds_read_b64_tr_b16 v[202:203], v240 offset:63104
 s_waitcnt lgkmcnt(8)
 v_mfma_f32_32x32x16_bf16 v[64:79], v[208:211], a[116:119], v[64:79]
 ds_read_b64_tr_b16 v[204:205], v241 offset:61632
 ds_read_b64_tr_b16 v[206:207], v241 offset:63168
 s_waitcnt lgkmcnt(8)
 v_mfma_f32_32x32x16_bf16 v[80:95], v[212:215], a[116:119], v[80:95]
 ds_read_b64_tr_b16 v[208:209], v240 offset:61696
 ds_read_b64_tr_b16 v[210:211], v240 offset:63232
 s_waitcnt lgkmcnt(8)
 v_mfma_f32_32x32x16_bf16 v[0:15], v[192:195], a[120:123], v[0:15]
 ds_read_b64_tr_b16 v[212:213], v241 offset:61760
 ds_read_b64_tr_b16 v[214:215], v241 offset:63296
 s_waitcnt lgkmcnt(8)
 v_mfma_f32_32x32x16_bf16 v[16:31], v[196:199], a[120:123], v[16:31]
 ds_read_b64_tr_b16 v[192:193], v248 offset:2048
 ds_read_b64_tr_b16 v[194:195], v248 offset:3584
 s_waitcnt lgkmcnt(8)
 v_mfma_f32_32x32x16_bf16 v[32:47], v[200:203], a[120:123], v[32:47]
 ds_read_b64_tr_b16 v[196:197], v249 offset:2112
 ds_read_b64_tr_b16 v[198:199], v249 offset:3648
 s_waitcnt lgkmcnt(8)
 v_mfma_f32_32x32x16_bf16 v[48:63], v[204:207], a[120:123], v[48:63]
 ds_read_b64_tr_b16 v[200:201], v248 offset:2176
 ds_read_b64_tr_b16 v[202:203], v248 offset:3712
 s_waitcnt lgkmcnt(8)
 v_mfma_f32_32x32x16_bf16 v[64:79], v[208:211], a[120:123], v[64:79]
 ds_read_b64_tr_b16 v[204:205], v249 offset:2240
 ds_read_b64_tr_b16 v[206:207], v249 offset:3776
 s_waitcnt lgkmcnt(8)
 v_mfma_f32_32x32x16_bf16 v[80:95], v[212:215], a[120:123], v[80:95]
 ds_read_b64_tr_b16 v[208:209], v248 offset:2304
 ds_read_b64_tr_b16 v[210:211], v248 offset:3840
 s_waitcnt lgkmcnt(8)
 v_mfma_f32_32x32x16_bf16 v[0:15], v[192:195], a[124:127], v[0:15]
 ds_read_b64_tr_b16 v[212:213], v249 offset:2368
 ds_read_b64_tr_b16 v[214:215], v249 offset:3904
 s_waitcnt lgkmcnt(8)
 v_mfma_f32_32x32x16_bf16 v[16:31], v[196:199], a[124:127], v[16:31]
 ds_read_b64_tr_b16 v[192:193], v248 offset:8192
 ds_read_b64_tr_b16 v[194:195], v248 offset:9728
 s_waitcnt lgkmcnt(8)
 v_mfma_f32_32x32x16_bf16 v[32:47], v[200:203], a[124:127], v[32:47]
 ds_read_b64_tr_b16 v[196:197], v249 offset:8256
 ds_read_b64_tr_b16 v[198:199], v249 offset:9792
 s_waitcnt lgkmcnt(8)
 v_mfma_f32_32x32x16_bf16 v[48:63], v[204:207], a[124:127], v[48:63]
 ds_read_b64_tr_b16 v[200:201], v248 offset:8320
 ds_read_b64_tr_b16 v[202:203], v248 offset:9856
 s_waitcnt lgkmcnt(8)
 v_mfma_f32_32x32x16_bf16 v[64:79], v[208:211], a[124:127], v[64:79]
 ds_read_b64_tr_b16 v[204:205], v249 offset:8384
 ds_read_b64_tr_b16 v[206:207], v249 offset:9920
 s_waitcnt lgkmcnt(8)
 v_mfma_f32_32x32x16_bf16 v[80:95], v[212:215], a[124:127], v[80:95]
 s_waitcnt vmcnt(16)
 s_barrier
 ds_read_b64_tr_b16 v[208:209], v248 offset:8448
 ds_read_b64_tr_b16 v[210:211], v248 offset:9984
 s_waitcnt lgkmcnt(8)
 v_mfma_f32_32x32x16_bf16 v[0:15], v[192:195], a[128:131], v[0:15]
 ds_read_b64_tr_b16 v[212:213], v249 offset:8512
 ds_read_b64_tr_b16 v[214:215], v249 offset:10048
 s_waitcnt lgkmcnt(8)
 v_mfma_f32_32x32x16_bf16 v[16:31], v[196:199], a[128:131], v[16:31]
 s_add_u32 m0, s19, 49152
 s_add_u32 s29, s55, 256
 buffer_load_dwordx4 v239, s[36:39], s29 offen lds
 s_add_u32 m0, s19, 50176
 s_add_u32 s29, s55, 10496
 buffer_load_dwordx4 v239, s[36:39], s29 offen lds
 s_add_u32 m0, s19, 51200
 s_add_u32 s29, s55, 20736
 buffer_load_dwordx4 v239, s[36:39], s29 offen lds
 s_add_u32 m0, s19, 52224
 s_add_u32 s29, s55, 30976
 buffer_load_dwordx4 v239, s[36:39], s29 offen lds
 s_add_u32 m0, s19, 53248
 s_add_u32 s29, s55, 41216
 buffer_load_dwordx4 v239, s[36:39], s29 offen lds
 s_add_u32 m0, s19, 54272
 s_add_u32 s29, s55, 51456
 buffer_load_dwordx4 v239, s[36:39], s29 offen lds
 ds_read_b64_tr_b16 v[192:193], v248 offset:14336
 ds_read_b64_tr_b16 v[194:195], v248 offset:15872
 s_waitcnt lgkmcnt(8)
 v_mfma_f32_32x32x16_bf16 v[32:47], v[200:203], a[128:131], v[32:47]
 ds_read_b64_tr_b16 v[196:197], v249 offset:14400
 ds_read_b64_tr_b16 v[198:199], v249 offset:15936
 s_waitcnt lgkmcnt(8)
 v_mfma_f32_32x32x16_bf16 v[48:63], v[204:207], a[128:131], v[48:63]
 ds_read_b64_tr_b16 v[200:201], v248 offset:14464
 ds_read_b64_tr_b16 v[202:203], v248 offset:16000
 s_waitcnt lgkmcnt(8)
 v_mfma_f32_32x32x16_bf16 v[64:79], v[208:211], a[128:131], v[64:79]
 ds_read_b64_tr_b16 v[204:205], v249 offset:14528
 ds_read_b64_tr_b16 v[206:207], v249 offset:16064
 s_waitcnt lgkmcnt(8)
 v_mfma_f32_32x32x16_bf16 v[80:95], v[212:215], a[128:131], v[80:95]
 ds_read_b64_tr_b16 v[208:209], v248 offset:14592
 ds_read_b64_tr_b16 v[210:211], v248 offset:16128
 s_waitcnt lgkmcnt(8)
 v_mfma_f32_32x32x16_bf16 v[0:15], v[192:195], a[132:135], v[0:15]
 ds_read_b64_tr_b16 v[212:213], v249 offset:14656
 ds_read_b64_tr_b16 v[214:215], v249 offset:16192
 s_waitcnt lgkmcnt(8)
 v_mfma_f32_32x32x16_bf16 v[16:31], v[196:199], a[132:135], v[16:31]
 ds_read_b64_tr_b16 v[192:193], v248 offset:20480
 ds_read_b64_tr_b16 v[194:195], v248 offset:22016
 s_waitcnt lgkmcnt(8)
 v_mfma_f32_32x32x16_bf16 v[32:47], v[200:203], a[132:135], v[32:47]
 ds_read_b64_tr_b16 v[196:197], v249 offset:20544
 ds_read_b64_tr_b16 v[198:199], v249 offset:22080
 s_waitcnt lgkmcnt(8)
 v_mfma_f32_32x32x16_bf16 v[48:63], v[204:207], a[132:135], v[48:63]
 ds_read_b64_tr_b16 v[200:201], v248 offset:20608
 ds_read_b64_tr_b16 v[202:203], v248 offset:22144
 s_waitcnt lgkmcnt(8)
 v_mfma_f32_32x32x16_bf16 v[64:79], v[208:211], a[132:135], v[64:79]
 ds_read_b64_tr_b16 v[204:205], v249 offset:20672
 ds_read_b64_tr_b16 v[206:207], v249 offset:22208
 s_waitcnt lgkmcnt(8)
 v_mfma_f32_32x32x16_bf16 v[80:95], v[212:215], a[132:135], v[80:95]
 ds_read_b64_tr_b16 v[208:209], v248 offset:20736
 ds_read_b64_tr_b16 v[210:211], v248 offset:22272
 s_waitcnt lgkmcnt(8)
 v_mfma_f32_32x32x16_bf16 v[0:15], v[192:195], a[136:139], v[0:15]
 ds_read_b64_tr_b16 v[212:213], v249 offset:20800
 ds_read_b64_tr_b16 v[214:215], v249 offset:22336
 s_waitcnt lgkmcnt(8)
 v_mfma_f32_32x32x16_bf16 v[16:31], v[196:199], a[136:139], v[16:31]
 ds_read_b64_tr_b16 v[192:193], v248 offset:26624
 ds_read_b64_tr_b16 v[194:195], v248 offset:28160
 s_waitcnt lgkmcnt(8)
 v_mfma_f32_32x32x16_bf16 v[32:47], v[200:203], a[136:139], v[32:47]
 ds_read_b64_tr_b16 v[196:197], v249 offset:26688
 ds_read_b64_tr_b16 v[198:199], v249 offset:28224
 s_waitcnt lgkmcnt(8)
 v_mfma_f32_32x32x16_bf16 v[48:63], v[204:207], a[136:139], v[48:63]
 ds_read_b64_tr_b16 v[200:201], v248 offset:26752
 ds_read_b64_tr_b16 v[202:203], v248 offset:28288
 s_waitcnt lgkmcnt(8)
 v_mfma_f32_32x32x16_bf16 v[64:79], v[208:211], a[136:139], v[64:79]
 ds_read_b64_tr_b16 v[204:205], v249 offset:26816
 ds_read_b64_tr_b16 v[206:207], v249 offset:28352
 s_waitcnt lgkmcnt(8)
 v_mfma_f32_32x32x16_bf16 v[80:95], v[212:215], a[136:139], v[80:95]
 ds_read_b64_tr_b16 v[208:209], v248 offset:26880
 ds_read_b64_tr_b16 v[210:211], v248 offset:28416
 s_waitcnt lgkmcnt(8)
 v_mfma_f32_32x32x16_bf16 v[0:15], v[192:195], a[140:143], v[0:15]
 ds_read_b64_tr_b16 v[212:213], v249 offset:26944
 ds_read_b64_tr_b16 v[214:215], v249 offset:28480
 s_waitcnt lgkmcnt(8)
 v_mfma_f32_32x32x16_bf16 v[16:31], v[196:199], a[140:143], v[16:31]
 ds_read_b64_tr_b16 v[192:193], v248 offset:32768
 ds_read_b64_tr_b16 v[194:195], v248 offset:34304
 s_waitcnt lgkmcnt(8)
 v_mfma_f32_32x32x16_bf16 v[32:47], v[200:203], a[140:143], v[32:47]
 ds_read_b64_tr_b16 v[196:197], v249 offset:32832
 ds_read_b64_tr_b16 v[198:199], v249 offset:34368
 s_waitcnt lgkmcnt(8)
 v_mfma_f32_32x32x16_bf16 v[48:63], v[204:207], a[140:143], v[48:63]
 ds_read_b64_tr_b16 v[200:201], v248 offset:32896
 ds_read_b64_tr_b16 v[202:203], v248 offset:34432
 s_waitcnt lgkmcnt(8)
 v_mfma_f32_32x32x16_bf16 v[64:79], v[208:211], a[140:143], v[64:79]
 ds_read_b64_tr_b16 v[204:205], v249 offset:32960
 ds_read_b64_tr_b16 v[206:207], v249 offset:34496
 s_waitcnt lgkmcnt(8)
 v_mfma_f32_32x32x16_bf16 v[80:95], v[212:215], a[140:143], v[80:95]
 s_waitcnt vmcnt(12)
 s_barrier
 ds_read_b64_tr_b16 v[208:209], v248 offset:33024
 ds_read_b64_tr_b16 v[210:211], v248 offset:34560
 s_waitcnt lgkmcnt(8)
 v_mfma_f32_32x32x16_bf16 v[0:15], v[192:195], a[144:147], v[0:15]
 ds_read_b64_tr_b16 v[212:213], v249 offset:33088
 ds_read_b64_tr_b16 v[214:215], v249 offset:34624
 s_waitcnt lgkmcnt(8)
 v_mfma_f32_32x32x16_bf16 v[16:31], v[196:199], a[144:147], v[16:31]
 s_add_u32 m0, s19, 73728
 s_add_u32 s29, s55, 384
 buffer_load_dwordx4 v239, s[36:39], s29 offen lds
 s_add_u32 m0, s19, 74752
 s_add_u32 s29, s55, 10624
 buffer_load_dwordx4 v239, s[36:39], s29 offen lds
 s_add_u32 m0, s19, 75776
 s_add_u32 s29, s55, 20864
 buffer_load_dwordx4 v239, s[36:39], s29 offen lds
 s_add_u32 m0, s19, 76800
 s_add_u32 s29, s55, 31104
 buffer_load_dwordx4 v239, s[36:39], s29 offen lds
 s_add_u32 m0, s19, 77824
 s_add_u32 s29, s55, 41344
 buffer_load_dwordx4 v239, s[36:39], s29 offen lds
 s_add_u32 m0, s19, 78848
 s_add_u32 s29, s55, 51584
 buffer_load_dwordx4 v239, s[36:39], s29 offen lds
 ds_read_b64_tr_b16 v[192:193], v248 offset:38912
 ds_read_b64_tr_b16 v[194:195], v248 offset:40448
 s_waitcnt lgkmcnt(8)
 v_mfma_f32_32x32x16_bf16 v[32:47], v[200:203], a[144:147], v[32:47]
 ds_read_b64_tr_b16 v[196:197], v249 offset:38976
 ds_read_b64_tr_b16 v[198:199], v249 offset:40512
 s_waitcnt lgkmcnt(8)
 v_mfma_f32_32x32x16_bf16 v[48:63], v[204:207], a[144:147], v[48:63]
 ds_read_b64_tr_b16 v[200:201], v248 offset:39040
 ds_read_b64_tr_b16 v[202:203], v248 offset:40576
 s_waitcnt lgkmcnt(8)
 v_mfma_f32_32x32x16_bf16 v[64:79], v[208:211], a[144:147], v[64:79]
 ds_read_b64_tr_b16 v[204:205], v249 offset:39104
 ds_read_b64_tr_b16 v[206:207], v249 offset:40640
 s_waitcnt lgkmcnt(8)
 v_mfma_f32_32x32x16_bf16 v[80:95], v[212:215], a[144:147], v[80:95]
 ds_read_b64_tr_b16 v[208:209], v248 offset:39168
 ds_read_b64_tr_b16 v[210:211], v248 offset:40704
 s_waitcnt lgkmcnt(8)
 v_mfma_f32_32x32x16_bf16 v[0:15], v[192:195], a[148:151], v[0:15]
 ds_read_b64_tr_b16 v[212:213], v249 offset:39232
 ds_read_b64_tr_b16 v[214:215], v249 offset:40768
 s_waitcnt lgkmcnt(8)
 v_mfma_f32_32x32x16_bf16 v[16:31], v[196:199], a[148:151], v[16:31]
 ds_read_b64_tr_b16 v[192:193], v248 offset:45056
 ds_read_b64_tr_b16 v[194:195], v248 offset:46592
 s_waitcnt lgkmcnt(8)
 v_mfma_f32_32x32x16_bf16 v[32:47], v[200:203], a[148:151], v[32:47]
 ds_read_b64_tr_b16 v[196:197], v249 offset:45120
 ds_read_b64_tr_b16 v[198:199], v249 offset:46656
 s_waitcnt lgkmcnt(8)
 v_mfma_f32_32x32x16_bf16 v[48:63], v[204:207], a[148:151], v[48:63]
 ds_read_b64_tr_b16 v[200:201], v248 offset:45184
 ds_read_b64_tr_b16 v[202:203], v248 offset:46720
 s_waitcnt lgkmcnt(8)
 v_mfma_f32_32x32x16_bf16 v[64:79], v[208:211], a[148:151], v[64:79]
 ds_read_b64_tr_b16 v[204:205], v249 offset:45248
 ds_read_b64_tr_b16 v[206:207], v249 offset:46784
 s_waitcnt lgkmcnt(8)
 v_mfma_f32_32x32x16_bf16 v[80:95], v[212:215], a[148:151], v[80:95]
 ds_read_b64_tr_b16 v[208:209], v248 offset:45312
 ds_read_b64_tr_b16 v[210:211], v248 offset:46848
 s_waitcnt lgkmcnt(8)
 v_mfma_f32_32x32x16_bf16 v[0:15], v[192:195], a[152:155], v[0:15]
 ds_read_b64_tr_b16 v[212:213], v249 offset:45376
 ds_read_b64_tr_b16 v[214:215], v249 offset:46912
 s_waitcnt lgkmcnt(8)
 v_mfma_f32_32x32x16_bf16 v[16:31], v[196:199], a[152:155], v[16:31]
 ds_read_b64_tr_b16 v[192:193], v248 offset:51200
 ds_read_b64_tr_b16 v[194:195], v248 offset:52736
 s_waitcnt lgkmcnt(8)
 v_mfma_f32_32x32x16_bf16 v[32:47], v[200:203], a[152:155], v[32:47]
 ds_read_b64_tr_b16 v[196:197], v249 offset:51264
 ds_read_b64_tr_b16 v[198:199], v249 offset:52800
 s_waitcnt lgkmcnt(8)
 v_mfma_f32_32x32x16_bf16 v[48:63], v[204:207], a[152:155], v[48:63]
 ds_read_b64_tr_b16 v[200:201], v248 offset:51328
 ds_read_b64_tr_b16 v[202:203], v248 offset:52864
 s_waitcnt lgkmcnt(8)
 v_mfma_f32_32x32x16_bf16 v[64:79], v[208:211], a[152:155], v[64:79]
 ds_read_b64_tr_b16 v[204:205], v249 offset:51392
 ds_read_b64_tr_b16 v[206:207], v249 offset:52928
 s_waitcnt lgkmcnt(8)
 v_mfma_f32_32x32x16_bf16 v[80:95], v[212:215], a[152:155], v[80:95]
 ds_read_b64_tr_b16 v[208:209], v248 offset:51456
 ds_read_b64_tr_b16 v[210:211], v248 offset:52992
 s_waitcnt lgkmcnt(8)
 v_mfma_f32_32x32x16_bf16 v[0:15], v[192:195], a[156:159], v[0:15]
 ds_read_b64_tr_b16 v[212:213], v249 offset:51520
 ds_read_b64_tr_b16 v[214:215], v249 offset:53056
 s_waitcnt lgkmcnt(8)
 v_mfma_f32_32x32x16_bf16 v[16:31], v[196:199], a[156:159], v[16:31]
 ds_read_b64_tr_b16 v[192:193], v242 offset:0
 ds_read_b64_tr_b16 v[194:195], v242 offset:1024
 s_waitcnt lgkmcnt(8)
 v_mfma_f32_32x32x16_bf16 v[32:47], v[200:203], a[156:159], v[32:47]
 ds_read_b64_tr_b16 v[196:197], v243 offset:64
 ds_read_b64_tr_b16 v[198:199], v243 offset:1088
 s_waitcnt lgkmcnt(8)
 v_mfma_f32_32x32x16_bf16 v[48:63], v[204:207], a[156:159], v[48:63]
 ds_read_b64_tr_b16 v[200:201], v242 offset:2048
 ds_read_b64_tr_b16 v[202:203], v242 offset:3072
 s_waitcnt lgkmcnt(8)
 v_mfma_f32_32x32x16_bf16 v[64:79], v[208:211], a[156:159], v[64:79]
 ds_read_b64_tr_b16 v[204:205], v243 offset:2112
 ds_read_b64_tr_b16 v[206:207], v243 offset:3136
 s_waitcnt lgkmcnt(8)
 v_mfma_f32_32x32x16_bf16 v[80:95], v[212:215], a[156:159], v[80:95]
 s_waitcnt vmcnt(12)
 s_barrier
 ds_read_b64_tr_b16 v[208:209], v242 offset:4096
 ds_read_b64_tr_b16 v[210:211], v242 offset:5120
 s_nop 15
 v_cvt_pk_bf16_f32 v96, v0, v1
 v_cvt_pk_bf16_f32 v97, v2, v3
 v_cvt_pk_bf16_f32 v98, v4, v5
 v_cvt_pk_bf16_f32 v99, v6, v7
 v_cvt_pk_bf16_f32 v100, v8, v9
 v_cvt_pk_bf16_f32 v101, v10, v11
 v_cvt_pk_bf16_f32 v102, v12, v13
 v_cvt_pk_bf16_f32 v103, v14, v15
 v_cvt_pk_bf16_f32 v104, v16, v17
 v_cvt_pk_bf16_f32 v105, v18, v19
 v_cvt_pk_bf16_f32 v106, v20, v21
 v_cvt_pk_bf16_f32 v107, v22, v23
 v_cvt_pk_bf16_f32 v108, v24, v25
 v_cvt_pk_bf16_f32 v109, v26, v27
 v_cvt_pk_bf16_f32 v110, v28, v29
 v_cvt_pk_bf16_f32 v111, v30, v31
 v_cvt_pk_bf16_f32 v112, v32, v33
 v_cvt_pk_bf16_f32 v113, v34, v35
 v_cvt_pk_bf16_f32 v114, v36, v37
 v_cvt_pk_bf16_f32 v115, v38, v39
 v_cvt_pk_bf16_f32 v116, v40, v41
 v_cvt_pk_bf16_f32 v117, v42, v43
 v_cvt_pk_bf16_f32 v118, v44, v45
 v_cvt_pk_bf16_f32 v119, v46, v47
 v_cvt_pk_bf16_f32 v120, v48, v49
 v_cvt_pk_bf16_f32 v121, v50, v51
 v_cvt_pk_bf16_f32 v122, v52, v53
 v_cvt_pk_bf16_f32 v123, v54, v55
 v_cvt_pk_bf16_f32 v124, v56, v57
 v_cvt_pk_bf16_f32 v125, v58, v59
 v_cvt_pk_bf16_f32 v126, v60, v61
 v_cvt_pk_bf16_f32 v127, v62, v63
 v_cvt_pk_bf16_f32 v128, v64, v65
 v_cvt_pk_bf16_f32 v129, v66, v67
 v_cvt_pk_bf16_f32 v130, v68, v69
 v_cvt_pk_bf16_f32 v131, v70, v71
 v_cvt_pk_bf16_f32 v132, v72, v73
 v_cvt_pk_bf16_f32 v133, v74, v75
 v_cvt_pk_bf16_f32 v134, v76, v77
 v_cvt_pk_bf16_f32 v135, v78, v79
 v_cvt_pk_bf16_f32 v136, v80, v81
 v_cvt_pk_bf16_f32 v137, v82, v83
 v_cvt_pk_bf16_f32 v138, v84, v85
 v_cvt_pk_bf16_f32 v139, v86, v87
 v_cvt_pk_bf16_f32 v140, v88, v89
 v_cvt_pk_bf16_f32 v141, v90, v91
 v_cvt_pk_bf16_f32 v142, v92, v93
 v_cvt_pk_bf16_f32 v143, v94, v95
 s_nop 1
 s_waitcnt lgkmcnt(8)
 v_mfma_f32_32x32x16_bf16 v[0:15], v[96:99], v[192:195], 0
 ds_read_b64_tr_b16 v[212:213], v243 offset:4160
 ds_read_b64_tr_b16 v[214:215], v243 offset:5184
 s_waitcnt lgkmcnt(8)
 v_mfma_f32_32x32x16_bf16 v[16:31], v[96:99], v[196:199], 0
 s_add_u32 m0, s19, 98304
 s_add_u32 s29, s55, 512
 buffer_load_dwordx4 v239, s[36:39], s29 offen lds
 s_add_u32 m0, s19, 99328
 s_add_u32 s29, s55, 10752
 buffer_load_dwordx4 v239, s[36:39], s29 offen lds
 s_add_u32 m0, s19, 100352
 s_add_u32 s29, s55, 20992
 buffer_load_dwordx4 v239, s[36:39], s29 offen lds
 s_add_u32 m0, s19, 101376
 s_add_u32 s29, s55, 31232
 buffer_load_dwordx4 v239, s[36:39], s29 offen lds
 s_add_u32 m0, s19, 102400
 s_add_u32 s29, s55, 41472
 buffer_load_dwordx4 v239, s[36:39], s29 offen lds
 s_add_u32 m0, s19, 103424
 s_add_u32 s29, s55, 51712
 buffer_load_dwordx4 v239, s[36:39], s29 offen lds
 ds_read_b64_tr_b16 v[192:193], v242 offset:6144
 ds_read_b64_tr_b16 v[194:195], v242 offset:7168
 s_waitcnt lgkmcnt(8)
 v_mfma_f32_32x32x16_bf16 v[0:15], v[100:103], v[200:203], v[0:15]
 ds_read_b64_tr_b16 v[196:197], v243 offset:6208
 ds_read_b64_tr_b16 v[198:199], v243 offset:7232
 s_waitcnt lgkmcnt(8)
 v_mfma_f32_32x32x16_bf16 v[16:31], v[100:103], v[204:207], v[16:31]
 ds_read_b64_tr_b16 v[200:201], v242 offset:8192
 ds_read_b64_tr_b16 v[202:203], v242 offset:9216
 s_waitcnt lgkmcnt(8)
 v_mfma_f32_32x32x16_bf16 v[0:15], v[104:107], v[208:211], v[0:15]
 ds_read_b64_tr_b16 v[204:205], v243 offset:8256
 ds_read_b64_tr_b16 v[206:207], v243 offset:9280
 s_waitcnt lgkmcnt(8)
 v_mfma_f32_32x32x16_bf16 v[16:31], v[104:107], v[212:215], v[16:31]
 ds_read_b64_tr_b16 v[208:209], v242 offset:10240
 ds_read_b64_tr_b16 v[210:211], v242 offset:11264
 s_waitcnt lgkmcnt(8)
 v_mfma_f32_32x32x16_bf16 v[0:15], v[108:111], v[192:195], v[0:15]
 ds_read_b64_tr_b16 v[212:213], v243 offset:10304
 ds_read_b64_tr_b16 v[214:215], v243 offset:11328
 s_waitcnt lgkmcnt(8)
 v_mfma_f32_32x32x16_bf16 v[16:31], v[108:111], v[196:199], v[16:31]
 ds_read_b64_tr_b16 v[192:193], v242 offset:12288
 ds_read_b64_tr_b16 v[194:195], v242 offset:13312
 s_waitcnt lgkmcnt(8)
 v_mfma_f32_32x32x16_bf16 v[0:15], v[112:115], v[200:203], v[0:15]
 ds_read_b64_tr_b16 v[196:197], v243 offset:12352
 ds_read_b64_tr_b16 v[198:199], v243 offset:13376
 s_waitcnt lgkmcnt(8)
 v_mfma_f32_32x32x16_bf16 v[16:31], v[112:115], v[204:207], v[16:31]
 ds_read_b64_tr_b16 v[200:201], v242 offset:14336
 ds_read_b64_tr_b16 v[202:203], v242 offset:15360
 s_waitcnt lgkmcnt(8)
 v_mfma_f32_32x32x16_bf16 v[0:15], v[116:119], v[208:211], v[0:15]
 ds_read_b64_tr_b16 v[204:205], v243 offset:14400
 ds_read_b64_tr_b16 v[206:207], v243 offset:15424
 s_waitcnt lgkmcnt(8)
 v_mfma_f32_32x32x16_bf16 v[16:31], v[116:119], v[212:215], v[16:31]
 ds_read_b64_tr_b16 v[208:209], v242 offset:16384
 ds_read_b64_tr_b16 v[210:211], v242 offset:17408
 s_waitcnt lgkmcnt(8)
 v_mfma_f32_32x32x16_bf16 v[0:15], v[120:123], v[192:195], v[0:15]
 ds_read_b64_tr_b16 v[212:213], v243 offset:16448
 ds_read_b64_tr_b16 v[214:215], v243 offset:17472
 s_waitcnt lgkmcnt(8)
 v_mfma_f32_32x32x16_bf16 v[16:31], v[120:123], v[196:199], v[16:31]
 ds_read_b64_tr_b16 v[192:193], v242 offset:18432
 ds_read_b64_tr_b16 v[194:195], v242 offset:19456
 s_waitcnt lgkmcnt(8)
 v_mfma_f32_32x32x16_bf16 v[0:15], v[124:127], v[200:203], v[0:15]
 ds_read_b64_tr_b16 v[196:197], v243 offset:18496
 ds_read_b64_tr_b16 v[198:199], v243 offset:19520
 s_waitcnt lgkmcnt(8)
 v_mfma_f32_32x32x16_bf16 v[16:31], v[124:127], v[204:207], v[16:31]
 ds_read_b64_tr_b16 v[200:201], v242 offset:20480
 ds_read_b64_tr_b16 v[202:203], v242 offset:21504
 s_waitcnt lgkmcnt(8)
 v_mfma_f32_32x32x16_bf16 v[0:15], v[128:131], v[208:211], v[0:15]
 ds_read_b64_tr_b16 v[204:205], v243 offset:20544
 ds_read_b64_tr_b16 v[206:207], v243 offset:21568
 s_waitcnt lgkmcnt(8)
 v_mfma_f32_32x32x16_bf16 v[16:31], v[128:131], v[212:215], v[16:31]
 ds_read_b64_tr_b16 v[208:209], v242 offset:22528
 ds_read_b64_tr_b16 v[210:211], v242 offset:23552
 s_waitcnt lgkmcnt(8)
 v_mfma_f32_32x32x16_bf16 v[0:15], v[132:135], v[192:195], v[0:15]
 ds_read_b64_tr_b16 v[212:213], v243 offset:22592
 ds_read_b64_tr_b16 v[214:215], v243 offset:23616
 s_waitcnt lgkmcnt(8)
 v_mfma_f32_32x32x16_bf16 v[16:31], v[132:135], v[196:199], v[16:31]
 ds_read_b64_tr_b16 v[192:193], v242 offset:24576
 ds_read_b64_tr_b16 v[194:195], v242 offset:25600
 s_waitcnt lgkmcnt(8)
 v_mfma_f32_32x32x16_bf16 v[0:15], v[136:139], v[200:203], v[0:15]
 ds_read_b64_tr_b16 v[196:197], v243 offset:24640
 ds_read_b64_tr_b16 v[198:199], v243 offset:25664
 s_waitcnt lgkmcnt(8)
 v_mfma_f32_32x32x16_bf16 v[16:31], v[136:139], v[204:207], v[16:31]
 ds_read_b64_tr_b16 v[200:201], v242 offset:26624
 ds_read_b64_tr_b16 v[202:203], v242 offset:27648
 s_waitcnt lgkmcnt(8)
 v_mfma_f32_32x32x16_bf16 v[0:15], v[140:143], v[208:211], v[0:15]
 ds_read_b64_tr_b16 v[204:205], v243 offset:26688
 ds_read_b64_tr_b16 v[206:207], v243 offset:27712
 s_waitcnt lgkmcnt(8)
 v_mfma_f32_32x32x16_bf16 v[16:31], v[140:143], v[212:215], v[16:31]
 s_waitcnt vmcnt(12)
 s_barrier
 ds_read_b64_tr_b16 v[208:209], v242 offset:28672
 ds_read_b64_tr_b16 v[210:211], v242 offset:29696
 s_waitcnt lgkmcnt(8)
 v_mfma_f32_32x32x16_bf16 v[32:47], v[96:99], v[192:195], 0
 ds_read_b64_tr_b16 v[212:213], v243 offset:28736
 ds_read_b64_tr_b16 v[214:215], v243 offset:29760
 s_waitcnt lgkmcnt(8)
 v_mfma_f32_32x32x16_bf16 v[48:63], v[96:99], v[196:199], 0
 ds_read_b64_tr_b16 v[192:193], v242 offset:30720
 ds_read_b64_tr_b16 v[194:195], v242 offset:31744
 s_waitcnt lgkmcnt(8)
 v_mfma_f32_32x32x16_bf16 v[32:47], v[100:103], v[200:203], v[32:47]
 ds_read_b64_tr_b16 v[196:197], v243 offset:30784
 ds_read_b64_tr_b16 v[198:199], v243 offset:31808
 s_waitcnt lgkmcnt(8)
 v_mfma_f32_32x32x16_bf16 v[48:63], v[100:103], v[204:207], v[48:63]
 ds_read_b64_tr_b16 v[200:201], v242 offset:32768
 ds_read_b64_tr_b16 v[202:203], v242 offset:33792
 s_waitcnt lgkmcnt(8)
 v_mfma_f32_32x32x16_bf16 v[32:47], v[104:107], v[208:211], v[32:47]
 ds_read_b64_tr_b16 v[204:205], v243 offset:32832
 ds_read_b64_tr_b16 v[206:207], v243 offset:33856
 s_waitcnt lgkmcnt(8)
 v_mfma_f32_32x32x16_bf16 v[48:63], v[104:107], v[212:215], v[48:63]
 ds_read_b64_tr_b16 v[208:209], v242 offset:34816
 ds_read_b64_tr_b16 v[210:211], v242 offset:35840
 s_waitcnt lgkmcnt(8)
 v_mfma_f32_32x32x16_bf16 v[32:47], v[108:111], v[192:195], v[32:47]
 v_cvt_pk_bf16_f32 v216, v0, v1
 v_cvt_pk_bf16_f32 v217, v2, v3
 v_cvt_pk_bf16_f32 v218, v4, v5
 ds_read_b64_tr_b16 v[212:213], v243 offset:34880
 ds_read_b64_tr_b16 v[214:215], v243 offset:35904
 s_waitcnt lgkmcnt(8)
 v_mfma_f32_32x32x16_bf16 v[48:63], v[108:111], v[196:199], v[48:63]
 ds_read_b64_tr_b16 v[192:193], v242 offset:36864
 ds_read_b64_tr_b16 v[194:195], v242 offset:37888
 s_waitcnt lgkmcnt(8)
 v_mfma_f32_32x32x16_bf16 v[32:47], v[112:115], v[200:203], v[32:47]
 v_cvt_pk_bf16_f32 v219, v6, v7
 v_cvt_pk_bf16_f32 v220, v8, v9
 v_cvt_pk_bf16_f32 v221, v10, v11
 ds_read_b64_tr_b16 v[196:197], v243 offset:36928
 ds_read_b64_tr_b16 v[198:199], v243 offset:37952
 s_waitcnt lgkmcnt(8)
 v_mfma_f32_32x32x16_bf16 v[48:63], v[112:115], v[204:207], v[48:63]
 ds_read_b64_tr_b16 v[200:201], v242 offset:38912
 ds_read_b64_tr_b16 v[202:203], v242 offset:39936
 s_waitcnt lgkmcnt(8)
 v_mfma_f32_32x32x16_bf16 v[32:47], v[116:119], v[208:211], v[32:47]
 v_cvt_pk_bf16_f32 v222, v12, v13
 v_cvt_pk_bf16_f32 v223, v14, v15
 buffer_store_dwordx4 v[216:219], v244, s[8:11], s53 offen offset:0 sc1
 ds_read_b64_tr_b16 v[204:205], v243 offset:38976
 ds_read_b64_tr_b16 v[206:207], v243 offset:40000
 s_waitcnt lgkmcnt(8)
 v_mfma_f32_32x32x16_bf16 v[48:63], v[116:119], v[212:215], v[48:63]
 ds_read_b64_tr_b16 v[208:209], v242 offset:40960
 ds_read_b64_tr_b16 v[210:211], v242 offset:41984
 s_waitcnt lgkmcnt(8)
 v_mfma_f32_32x32x16_bf16 v[32:47], v[120:123], v[192:195], v[32:47]
 buffer_store_dwordx4 v[220:223], v244, s[8:11], s53 offen offset:1024 sc1
 v_cvt_pk_bf16_f32 v224, v16, v17
 v_cvt_pk_bf16_f32 v225, v18, v19
 ds_read_b64_tr_b16 v[212:213], v243 offset:41024
 ds_read_b64_tr_b16 v[214:215], v243 offset:42048
 s_waitcnt lgkmcnt(8)
 v_mfma_f32_32x32x16_bf16 v[48:63], v[120:123], v[196:199], v[48:63]
 ds_read_b64_tr_b16 v[192:193], v242 offset:43008
 ds_read_b64_tr_b16 v[194:195], v242 offset:44032
 s_waitcnt lgkmcnt(8)
 v_mfma_f32_32x32x16_bf16 v[32:47], v[124:127], v[200:203], v[32:47]
 v_cvt_pk_bf16_f32 v226, v20, v21
 v_cvt_pk_bf16_f32 v227, v22, v23
 v_cvt_pk_bf16_f32 v228, v24, v25
 ds_read_b64_tr_b16 v[196:197], v243 offset:43072
 ds_read_b64_tr_b16 v[198:199], v243 offset:44096
 s_waitcnt lgkmcnt(8)
 v_mfma_f32_32x32x16_bf16 v[48:63], v[124:127], v[204:207], v[48:63]
 ds_read_b64_tr_b16 v[200:201], v242 offset:45056
 ds_read_b64_tr_b16 v[202:203], v242 offset:46080
 s_waitcnt lgkmcnt(8)
 v_mfma_f32_32x32x16_bf16 v[32:47], v[128:131], v[208:211], v[32:47]
 v_cvt_pk_bf16_f32 v229, v26, v27
 v_cvt_pk_bf16_f32 v230, v28, v29
 v_cvt_pk_bf16_f32 v231, v30, v31
 ds_read_b64_tr_b16 v[204:205], v243 offset:45120
 ds_read_b64_tr_b16 v[206:207], v243 offset:46144
 s_waitcnt lgkmcnt(8)
 v_mfma_f32_32x32x16_bf16 v[48:63], v[128:131], v[212:215], v[48:63]
 ds_read_b64_tr_b16 v[208:209], v242 offset:47104
 ds_read_b64_tr_b16 v[210:211], v242 offset:48128
 s_waitcnt lgkmcnt(8)
 v_mfma_f32_32x32x16_bf16 v[32:47], v[132:135], v[192:195], v[32:47]
 buffer_store_dwordx4 v[224:227], v244, s[8:11], s53 offen offset:2048 sc1
 buffer_store_dwordx4 v[228:231], v244, s[8:11], s53 offen offset:3072 sc1
 s_add_u32 s53, s53, 4096
 ds_read_b64_tr_b16 v[212:213], v243 offset:47168
 ds_read_b64_tr_b16 v[214:215], v243 offset:48192
 s_waitcnt lgkmcnt(8)
 v_mfma_f32_32x32x16_bf16 v[48:63], v[132:135], v[196:199], v[48:63]
 ds_read_b64_tr_b16 v[192:193], v242 offset:49152
 ds_read_b64_tr_b16 v[194:195], v242 offset:50176
 s_waitcnt lgkmcnt(8)
 v_mfma_f32_32x32x16_bf16 v[32:47], v[136:139], v[200:203], v[32:47]
 ds_read_b64_tr_b16 v[196:197], v243 offset:49216
 ds_read_b64_tr_b16 v[198:199], v243 offset:50240
 s_waitcnt lgkmcnt(8)
 v_mfma_f32_32x32x16_bf16 v[48:63], v[136:139], v[204:207], v[48:63]
 ds_read_b64_tr_b16 v[200:201], v242 offset:51200
 ds_read_b64_tr_b16 v[202:203], v242 offset:52224
 s_waitcnt lgkmcnt(8)
 v_mfma_f32_32x32x16_bf16 v[32:47], v[140:143], v[208:211], v[32:47]
 ds_read_b64_tr_b16 v[204:205], v243 offset:51264
 ds_read_b64_tr_b16 v[206:207], v243 offset:52288
 s_waitcnt lgkmcnt(8)
 v_mfma_f32_32x32x16_bf16 v[48:63], v[140:143], v[212:215], v[48:63]
 s_waitcnt vmcnt(10)
 s_barrier
 ds_read_b64_tr_b16 v[208:209], v242 offset:53248
 ds_read_b64_tr_b16 v[210:211], v242 offset:54272
 s_waitcnt lgkmcnt(8)
 v_mfma_f32_32x32x16_bf16 v[0:15], v[96:99], v[192:195], 0
 ds_read_b64_tr_b16 v[212:213], v243 offset:53312
 ds_read_b64_tr_b16 v[214:215], v243 offset:54336
 s_waitcnt lgkmcnt(8)
 v_mfma_f32_32x32x16_bf16 v[16:31], v[96:99], v[196:199], 0
 ds_read_b64_tr_b16 v[192:193], v242 offset:55296
 ds_read_b64_tr_b16 v[194:195], v242 offset:56320
 s_waitcnt lgkmcnt(8)
 v_mfma_f32_32x32x16_bf16 v[0:15], v[100:103], v[200:203], v[0:15]
 ds_read_b64_tr_b16 v[196:197], v243 offset:55360
 ds_read_b64_tr_b16 v[198:199], v243 offset:56384
 s_waitcnt lgkmcnt(8)
 v_mfma_f32_32x32x16_bf16 v[16:31], v[100:103], v[204:207], v[16:31]
 ds_read_b64_tr_b16 v[200:201], v242 offset:57344
 ds_read_b64_tr_b16 v[202:203], v242 offset:58368
 s_waitcnt lgkmcnt(8)
 v_mfma_f32_32x32x16_bf16 v[0:15], v[104:107], v[208:211], v[0:15]
 ds_read_b64_tr_b16 v[204:205], v243 offset:57408
 ds_read_b64_tr_b16 v[206:207], v243 offset:58432
 s_waitcnt lgkmcnt(8)
 v_mfma_f32_32x32x16_bf16 v[16:31], v[104:107], v[212:215], v[16:31]
 ds_read_b64_tr_b16 v[208:209], v242 offset:59392
 ds_read_b64_tr_b16 v[210:211], v242 offset:60416
 s_waitcnt lgkmcnt(8)
 v_mfma_f32_32x32x16_bf16 v[0:15], v[108:111], v[192:195], v[0:15]
 v_cvt_pk_bf16_f32 v216, v32, v33
 v_cvt_pk_bf16_f32 v217, v34, v35
 v_cvt_pk_bf16_f32 v218, v36, v37
 ds_read_b64_tr_b16 v[212:213], v243 offset:59456
 ds_read_b64_tr_b16 v[214:215], v243 offset:60480
 s_waitcnt lgkmcnt(8)
 v_mfma_f32_32x32x16_bf16 v[16:31], v[108:111], v[196:199], v[16:31]
 ds_read_b64_tr_b16 v[192:193], v242 offset:61440
 ds_read_b64_tr_b16 v[194:195], v242 offset:62464
 s_waitcnt lgkmcnt(8)
 v_mfma_f32_32x32x16_bf16 v[0:15], v[112:115], v[200:203], v[0:15]
 v_cvt_pk_bf16_f32 v219, v38, v39
 v_cvt_pk_bf16_f32 v220, v40, v41
 v_cvt_pk_bf16_f32 v221, v42, v43
 ds_read_b64_tr_b16 v[196:197], v243 offset:61504
 ds_read_b64_tr_b16 v[198:199], v243 offset:62528
 s_waitcnt lgkmcnt(8)
 v_mfma_f32_32x32x16_bf16 v[16:31], v[112:115], v[204:207], v[16:31]
 ds_read_b64_tr_b16 v[200:201], v242 offset:63488
 ds_read_b64_tr_b16 v[202:203], v242 offset:64512
 s_waitcnt lgkmcnt(8)
 v_mfma_f32_32x32x16_bf16 v[0:15], v[116:119], v[208:211], v[0:15]
 v_cvt_pk_bf16_f32 v222, v44, v45
 v_cvt_pk_bf16_f32 v223, v46, v47
 buffer_store_dwordx4 v[216:219], v244, s[8:11], s53 offen offset:0 sc1
 ds_read_b64_tr_b16 v[204:205], v243 offset:63552
 ds_read_b64_tr_b16 v[206:207], v243 offset:64576
 s_waitcnt lgkmcnt(8)
 v_mfma_f32_32x32x16_bf16 v[16:31], v[116:119], v[212:215], v[16:31]
 ds_read_b64_tr_b16 v[208:209], v250 offset:0
 ds_read_b64_tr_b16 v[210:211], v250 offset:1024
 s_waitcnt lgkmcnt(8)
 v_mfma_f32_32x32x16_bf16 v[0:15], v[120:123], v[192:195], v[0:15]
 buffer_store_dwordx4 v[220:223], v244, s[8:11], s53 offen offset:1024 sc1
 v_cvt_pk_bf16_f32 v224, v48, v49
 v_cvt_pk_bf16_f32 v225, v50, v51
 ds_read_b64_tr_b16 v[212:213], v251 offset:64
 ds_read_b64_tr_b16 v[214:215], v251 offset:1088
 s_waitcnt lgkmcnt(8)
 v_mfma_f32_32x32x16_bf16 v[16:31], v[120:123], v[196:199], v[16:31]
 ds_read_b64_tr_b16 v[192:193], v250 offset:2048
 ds_read_b64_tr_b16 v[194:195], v250 offset:3072
 s_waitcnt lgkmcnt(8)
 v_mfma_f32_32x32x16_bf16 v[0:15], v[124:127], v[200:203], v[0:15]
 v_cvt_pk_bf16_f32 v226, v52, v53
 v_cvt_pk_bf16_f32 v227, v54, v55
 v_cvt_pk_bf16_f32 v228, v56, v57
 ds_read_b64_tr_b16 v[196:197], v251 offset:2112
 ds_read_b64_tr_b16 v[198:199], v251 offset:3136
 s_waitcnt lgkmcnt(8)
 v_mfma_f32_32x32x16_bf16 v[16:31], v[124:127], v[204:207], v[16:31]
 ds_read_b64_tr_b16 v[200:201], v250 offset:4096
 ds_read_b64_tr_b16 v[202:203], v250 offset:5120
 s_waitcnt lgkmcnt(8)
 v_mfma_f32_32x32x16_bf16 v[0:15], v[128:131], v[208:211], v[0:15]
 v_cvt_pk_bf16_f32 v229, v58, v59
 v_cvt_pk_bf16_f32 v230, v60, v61
 v_cvt_pk_bf16_f32 v231, v62, v63
 ds_read_b64_tr_b16 v[204:205], v251 offset:4160
 ds_read_b64_tr_b16 v[206:207], v251 offset:5184
 s_waitcnt lgkmcnt(8)
 v_mfma_f32_32x32x16_bf16 v[16:31], v[128:131], v[212:215], v[16:31]
 ds_read_b64_tr_b16 v[208:209], v250 offset:6144
 ds_read_b64_tr_b16 v[210:211], v250 offset:7168
 s_waitcnt lgkmcnt(8)
 v_mfma_f32_32x32x16_bf16 v[0:15], v[132:135], v[192:195], v[0:15]
 buffer_store_dwordx4 v[224:227], v244, s[8:11], s53 offen offset:2048 sc1
 buffer_store_dwordx4 v[228:231], v244, s[8:11], s53 offen offset:3072 sc1
 s_add_u32 s53, s53, 4096
 ds_read_b64_tr_b16 v[212:213], v251 offset:6208
 ds_read_b64_tr_b16 v[214:215], v251 offset:7232
 s_waitcnt lgkmcnt(8)
 v_mfma_f32_32x32x16_bf16 v[16:31], v[132:135], v[196:199], v[16:31]
 ds_read_b64_tr_b16 v[192:193], v250 offset:8192
 ds_read_b64_tr_b16 v[194:195], v250 offset:9216
 s_waitcnt lgkmcnt(8)
 v_mfma_f32_32x32x16_bf16 v[0:15], v[136:139], v[200:203], v[0:15]
 ds_read_b64_tr_b16 v[196:197], v251 offset:8256
 ds_read_b64_tr_b16 v[198:199], v251 offset:9280
 s_waitcnt lgkmcnt(8)
 v_mfma_f32_32x32x16_bf16 v[16:31], v[136:139], v[204:207], v[16:31]
 ds_read_b64_tr_b16 v[200:201], v250 offset:10240
 ds_read_b64_tr_b16 v[202:203], v250 offset:11264
 s_waitcnt lgkmcnt(8)
 v_mfma_f32_32x32x16_bf16 v[0:15], v[140:143], v[208:211], v[0:15]
 ds_read_b64_tr_b16 v[204:205], v251 offset:10304
 ds_read_b64_tr_b16 v[206:207], v251 offset:11328
 s_waitcnt lgkmcnt(8)
 v_mfma_f32_32x32x16_bf16 v[16:31], v[140:143], v[212:215], v[16:31]
 s_waitcnt vmcnt(8)
 s_barrier
 ds_read_b64_tr_b16 v[208:209], v250 offset:12288
 ds_read_b64_tr_b16 v[210:211], v250 offset:13312
 s_waitcnt lgkmcnt(8)
 v_mfma_f32_32x32x16_bf16 v[32:47], v[96:99], v[192:195], 0
 ds_read_b64_tr_b16 v[212:213], v251 offset:12352
 ds_read_b64_tr_b16 v[214:215], v251 offset:13376
 s_waitcnt lgkmcnt(8)
 v_mfma_f32_32x32x16_bf16 v[48:63], v[96:99], v[196:199], 0
 ds_read_b64_tr_b16 v[192:193], v250 offset:14336
 ds_read_b64_tr_b16 v[194:195], v250 offset:15360
 s_waitcnt lgkmcnt(8)
 v_mfma_f32_32x32x16_bf16 v[32:47], v[100:103], v[200:203], v[32:47]
 ds_read_b64_tr_b16 v[196:197], v251 offset:14400
 ds_read_b64_tr_b16 v[198:199], v251 offset:15424
 s_waitcnt lgkmcnt(8)
 v_mfma_f32_32x32x16_bf16 v[48:63], v[100:103], v[204:207], v[48:63]
 ds_read_b64_tr_b16 v[200:201], v250 offset:16384
 ds_read_b64_tr_b16 v[202:203], v250 offset:17408
 s_waitcnt lgkmcnt(8)
 v_mfma_f32_32x32x16_bf16 v[32:47], v[104:107], v[208:211], v[32:47]
 ds_read_b64_tr_b16 v[204:205], v251 offset:16448
 ds_read_b64_tr_b16 v[206:207], v251 offset:17472
 s_waitcnt lgkmcnt(8)
 v_mfma_f32_32x32x16_bf16 v[48:63], v[104:107], v[212:215], v[48:63]
 ds_read_b64_tr_b16 v[208:209], v250 offset:18432
 ds_read_b64_tr_b16 v[210:211], v250 offset:19456
 s_waitcnt lgkmcnt(8)
 v_mfma_f32_32x32x16_bf16 v[32:47], v[108:111], v[192:195], v[32:47]
 v_cvt_pk_bf16_f32 v216, v0, v1
 v_cvt_pk_bf16_f32 v217, v2, v3
 v_cvt_pk_bf16_f32 v218, v4, v5
 ds_read_b64_tr_b16 v[212:213], v251 offset:18496
 ds_read_b64_tr_b16 v[214:215], v251 offset:19520
 s_waitcnt lgkmcnt(8)
 v_mfma_f32_32x32x16_bf16 v[48:63], v[108:111], v[196:199], v[48:63]
 ds_read_b64_tr_b16 v[192:193], v250 offset:20480
 ds_read_b64_tr_b16 v[194:195], v250 offset:21504
 s_waitcnt lgkmcnt(8)
 v_mfma_f32_32x32x16_bf16 v[32:47], v[112:115], v[200:203], v[32:47]
 v_cvt_pk_bf16_f32 v219, v6, v7
 v_cvt_pk_bf16_f32 v220, v8, v9
 v_cvt_pk_bf16_f32 v221, v10, v11
 ds_read_b64_tr_b16 v[196:197], v251 offset:20544
 ds_read_b64_tr_b16 v[198:199], v251 offset:21568
 s_waitcnt lgkmcnt(8)
 v_mfma_f32_32x32x16_bf16 v[48:63], v[112:115], v[204:207], v[48:63]
 ds_read_b64_tr_b16 v[200:201], v250 offset:22528
 ds_read_b64_tr_b16 v[202:203], v250 offset:23552
 s_waitcnt lgkmcnt(8)
 v_mfma_f32_32x32x16_bf16 v[32:47], v[116:119], v[208:211], v[32:47]
 v_cvt_pk_bf16_f32 v222, v12, v13
 v_cvt_pk_bf16_f32 v223, v14, v15
 buffer_store_dwordx4 v[216:219], v244, s[8:11], s53 offen offset:0 sc1
 ds_read_b64_tr_b16 v[204:205], v251 offset:22592
 ds_read_b64_tr_b16 v[206:207], v251 offset:23616
 s_waitcnt lgkmcnt(8)
 v_mfma_f32_32x32x16_bf16 v[48:63], v[116:119], v[212:215], v[48:63]
 ds_read_b64_tr_b16 v[208:209], v250 offset:24576
 ds_read_b64_tr_b16 v[210:211], v250 offset:25600
 s_waitcnt lgkmcnt(8)
 v_mfma_f32_32x32x16_bf16 v[32:47], v[120:123], v[192:195], v[32:47]
 buffer_store_dwordx4 v[220:223], v244, s[8:11], s53 offen offset:1024 sc1
 v_cvt_pk_bf16_f32 v224, v16, v17
 v_cvt_pk_bf16_f32 v225, v18, v19
 ds_read_b64_tr_b16 v[212:213], v251 offset:24640
 ds_read_b64_tr_b16 v[214:215], v251 offset:25664
 s_waitcnt lgkmcnt(8)
 v_mfma_f32_32x32x16_bf16 v[48:63], v[120:123], v[196:199], v[48:63]
 ds_read_b64_tr_b16 v[192:193], v250 offset:26624
 ds_read_b64_tr_b16 v[194:195], v250 offset:27648
 s_waitcnt lgkmcnt(8)
 v_mfma_f32_32x32x16_bf16 v[32:47], v[124:127], v[200:203], v[32:47]
 v_cvt_pk_bf16_f32 v226, v20, v21
 v_cvt_pk_bf16_f32 v227, v22, v23
 v_cvt_pk_bf16_f32 v228, v24, v25
 ds_read_b64_tr_b16 v[196:197], v251 offset:26688
 ds_read_b64_tr_b16 v[198:199], v251 offset:27712
 s_waitcnt lgkmcnt(8)
 v_mfma_f32_32x32x16_bf16 v[48:63], v[124:127], v[204:207], v[48:63]
 ds_read_b64_tr_b16 v[200:201], v250 offset:28672
 ds_read_b64_tr_b16 v[202:203], v250 offset:29696
 s_waitcnt lgkmcnt(8)
 v_mfma_f32_32x32x16_bf16 v[32:47], v[128:131], v[208:211], v[32:47]
 v_cvt_pk_bf16_f32 v229, v26, v27
 v_cvt_pk_bf16_f32 v230, v28, v29
 v_cvt_pk_bf16_f32 v231, v30, v31
 ds_read_b64_tr_b16 v[204:205], v251 offset:28736
 ds_read_b64_tr_b16 v[206:207], v251 offset:29760
 s_waitcnt lgkmcnt(8)
 v_mfma_f32_32x32x16_bf16 v[48:63], v[128:131], v[212:215], v[48:63]
 ds_read_b64_tr_b16 v[208:209], v250 offset:30720
 ds_read_b64_tr_b16 v[210:211], v250 offset:31744
 s_waitcnt lgkmcnt(8)
 v_mfma_f32_32x32x16_bf16 v[32:47], v[132:135], v[192:195], v[32:47]
 buffer_store_dwordx4 v[224:227], v244, s[8:11], s53 offen offset:2048 sc1
 buffer_store_dwordx4 v[228:231], v244, s[8:11], s53 offen offset:3072 sc1
 s_add_u32 s53, s53, 4096
 ds_read_b64_tr_b16 v[212:213], v251 offset:30784
 ds_read_b64_tr_b16 v[214:215], v251 offset:31808
 s_waitcnt lgkmcnt(8)
 v_mfma_f32_32x32x16_bf16 v[48:63], v[132:135], v[196:199], v[48:63]
 ds_read_b64_tr_b16 v[192:193], v250 offset:32768
 ds_read_b64_tr_b16 v[194:195], v250 offset:33792
 s_waitcnt lgkmcnt(8)
 v_mfma_f32_32x32x16_bf16 v[32:47], v[136:139], v[200:203], v[32:47]
 ds_read_b64_tr_b16 v[196:197], v251 offset:32832
 ds_read_b64_tr_b16 v[198:199], v251 offset:33856
 s_waitcnt lgkmcnt(8)
 v_mfma_f32_32x32x16_bf16 v[48:63], v[136:139], v[204:207], v[48:63]
 ds_read_b64_tr_b16 v[200:201], v250 offset:34816
 ds_read_b64_tr_b16 v[202:203], v250 offset:35840
 s_waitcnt lgkmcnt(8)
 v_mfma_f32_32x32x16_bf16 v[32:47], v[140:143], v[208:211], v[32:47]
 ds_read_b64_tr_b16 v[204:205], v251 offset:34880
 ds_read_b64_tr_b16 v[206:207], v251 offset:35904
 s_waitcnt lgkmcnt(8)
 v_mfma_f32_32x32x16_bf16 v[48:63], v[140:143], v[212:215], v[48:63]
 s_barrier
 ds_read_b64_tr_b16 v[208:209], v250 offset:36864
 ds_read_b64_tr_b16 v[210:211], v250 offset:37888
 s_waitcnt lgkmcnt(8)
 v_mfma_f32_32x32x16_bf16 v[0:15], v[96:99], v[192:195], 0
 ds_read_b64_tr_b16 v[212:213], v251 offset:36928
 ds_read_b64_tr_b16 v[214:215], v251 offset:37952
 s_waitcnt lgkmcnt(8)
 v_mfma_f32_32x32x16_bf16 v[16:31], v[96:99], v[196:199], 0
 ds_read_b64_tr_b16 v[192:193], v250 offset:38912
 ds_read_b64_tr_b16 v[194:195], v250 offset:39936
 s_waitcnt lgkmcnt(8)
 v_mfma_f32_32x32x16_bf16 v[0:15], v[100:103], v[200:203], v[0:15]
 ds_read_b64_tr_b16 v[196:197], v251 offset:38976
 ds_read_b64_tr_b16 v[198:199], v251 offset:40000
 s_waitcnt lgkmcnt(8)
 v_mfma_f32_32x32x16_bf16 v[16:31], v[100:103], v[204:207], v[16:31]
 ds_read_b64_tr_b16 v[200:201], v250 offset:40960
 ds_read_b64_tr_b16 v[202:203], v250 offset:41984
 s_waitcnt lgkmcnt(8)
 v_mfma_f32_32x32x16_bf16 v[0:15], v[104:107], v[208:211], v[0:15]
 ds_read_b64_tr_b16 v[204:205], v251 offset:41024
 ds_read_b64_tr_b16 v[206:207], v251 offset:42048
 s_waitcnt lgkmcnt(8)
 v_mfma_f32_32x32x16_bf16 v[16:31], v[104:107], v[212:215], v[16:31]
 ds_read_b64_tr_b16 v[208:209], v250 offset:43008
 ds_read_b64_tr_b16 v[210:211], v250 offset:44032
 s_waitcnt lgkmcnt(8)
 v_mfma_f32_32x32x16_bf16 v[0:15], v[108:111], v[192:195], v[0:15]
 v_cvt_pk_bf16_f32 v216, v32, v33
 v_cvt_pk_bf16_f32 v217, v34, v35
 v_cvt_pk_bf16_f32 v218, v36, v37
 ds_read_b64_tr_b16 v[212:213], v251 offset:43072
 ds_read_b64_tr_b16 v[214:215], v251 offset:44096
 s_waitcnt lgkmcnt(8)
 v_mfma_f32_32x32x16_bf16 v[16:31], v[108:111], v[196:199], v[16:31]
 ds_read_b64_tr_b16 v[192:193], v250 offset:45056
 ds_read_b64_tr_b16 v[194:195], v250 offset:46080
 s_waitcnt lgkmcnt(8)
 v_mfma_f32_32x32x16_bf16 v[0:15], v[112:115], v[200:203], v[0:15]
 v_cvt_pk_bf16_f32 v219, v38, v39
 v_cvt_pk_bf16_f32 v220, v40, v41
 v_cvt_pk_bf16_f32 v221, v42, v43
 ds_read_b64_tr_b16 v[196:197], v251 offset:45120
 ds_read_b64_tr_b16 v[198:199], v251 offset:46144
 s_waitcnt lgkmcnt(8)
 v_mfma_f32_32x32x16_bf16 v[16:31], v[112:115], v[204:207], v[16:31]
 ds_read_b64_tr_b16 v[200:201], v250 offset:47104
 ds_read_b64_tr_b16 v[202:203], v250 offset:48128
 s_waitcnt lgkmcnt(8)
 v_mfma_f32_32x32x16_bf16 v[0:15], v[116:119], v[208:211], v[0:15]
 v_cvt_pk_bf16_f32 v222, v44, v45
 v_cvt_pk_bf16_f32 v223, v46, v47
 buffer_store_dwordx4 v[216:219], v244, s[8:11], s53 offen offset:0 sc1
 ds_read_b64_tr_b16 v[204:205], v251 offset:47168
 ds_read_b64_tr_b16 v[206:207], v251 offset:48192
 s_waitcnt lgkmcnt(8)
 v_mfma_f32_32x32x16_bf16 v[16:31], v[116:119], v[212:215], v[16:31]
 ds_read_b64_tr_b16 v[208:209], v250 offset:49152
 ds_read_b64_tr_b16 v[210:211], v250 offset:50176
 s_waitcnt lgkmcnt(8)
 v_mfma_f32_32x32x16_bf16 v[0:15], v[120:123], v[192:195], v[0:15]
 buffer_store_dwordx4 v[220:223], v244, s[8:11], s53 offen offset:1024 sc1
 v_cvt_pk_bf16_f32 v224, v48, v49
 v_cvt_pk_bf16_f32 v225, v50, v51
 ds_read_b64_tr_b16 v[212:213], v251 offset:49216
 ds_read_b64_tr_b16 v[214:215], v251 offset:50240
 s_waitcnt lgkmcnt(8)
 v_mfma_f32_32x32x16_bf16 v[16:31], v[120:123], v[196:199], v[16:31]
 ds_read_b64_tr_b16 v[192:193], v250 offset:51200
 ds_read_b64_tr_b16 v[194:195], v250 offset:52224
 s_waitcnt lgkmcnt(8)
 v_mfma_f32_32x32x16_bf16 v[0:15], v[124:127], v[200:203], v[0:15]
 v_cvt_pk_bf16_f32 v226, v52, v53
 v_cvt_pk_bf16_f32 v227, v54, v55
 v_cvt_pk_bf16_f32 v228, v56, v57
 ds_read_b64_tr_b16 v[196:197], v251 offset:51264
 ds_read_b64_tr_b16 v[198:199], v251 offset:52288
 s_waitcnt lgkmcnt(8)
 v_mfma_f32_32x32x16_bf16 v[16:31], v[124:127], v[204:207], v[16:31]
 ds_read_b64_tr_b16 v[200:201], v250 offset:53248
 ds_read_b64_tr_b16 v[202:203], v250 offset:54272
 s_waitcnt lgkmcnt(8)
 v_mfma_f32_32x32x16_bf16 v[0:15], v[128:131], v[208:211], v[0:15]
 v_cvt_pk_bf16_f32 v229, v58, v59
 v_cvt_pk_bf16_f32 v230, v60, v61
 v_cvt_pk_bf16_f32 v231, v62, v63
 ds_read_b64_tr_b16 v[204:205], v251 offset:53312
 ds_read_b64_tr_b16 v[206:207], v251 offset:54336
 s_waitcnt lgkmcnt(8)
 v_mfma_f32_32x32x16_bf16 v[16:31], v[128:131], v[212:215], v[16:31]
 ds_read_b64_tr_b16 v[208:209], v250 offset:55296
 ds_read_b64_tr_b16 v[210:211], v250 offset:56320
 s_waitcnt lgkmcnt(8)
 v_mfma_f32_32x32x16_bf16 v[0:15], v[132:135], v[192:195], v[0:15]
 buffer_store_dwordx4 v[224:227], v244, s[8:11], s53 offen offset:2048 sc1
 buffer_store_dwordx4 v[228:231], v244, s[8:11], s53 offen offset:3072 sc1
 s_add_u32 s53, s53, 4096
 ds_read_b64_tr_b16 v[212:213], v251 offset:55360
 ds_read_b64_tr_b16 v[214:215], v251 offset:56384
 s_waitcnt lgkmcnt(8)
 v_mfma_f32_32x32x16_bf16 v[16:31], v[132:135], v[196:199], v[16:31]
 s_waitcnt lgkmcnt(6)
 v_mfma_f32_32x32x16_bf16 v[0:15], v[136:139], v[200:203], v[0:15]
 s_waitcnt lgkmcnt(4)
 v_mfma_f32_32x32x16_bf16 v[16:31], v[136:139], v[204:207], v[16:31]
 s_waitcnt lgkmcnt(2)
 v_mfma_f32_32x32x16_bf16 v[0:15], v[140:143], v[208:211], v[0:15]
 s_waitcnt lgkmcnt(0)
 v_mfma_f32_32x32x16_bf16 v[16:31], v[140:143], v[212:215], v[16:31]
 s_nop 15
 s_nop 3
 v_cvt_pk_bf16_f32 v216, v0, v1
 v_cvt_pk_bf16_f32 v217, v2, v3
 v_cvt_pk_bf16_f32 v218, v4, v5
 v_cvt_pk_bf16_f32 v219, v6, v7
 v_cvt_pk_bf16_f32 v220, v8, v9
 v_cvt_pk_bf16_f32 v221, v10, v11
 v_cvt_pk_bf16_f32 v222, v12, v13
 v_cvt_pk_bf16_f32 v223, v14, v15
 buffer_store_dwordx4 v[216:219], v244, s[8:11], s53 offen offset:0 sc1
 buffer_store_dwordx4 v[220:223], v244, s[8:11], s53 offen offset:1024 sc1
 v_cvt_pk_bf16_f32 v224, v16, v17
 v_cvt_pk_bf16_f32 v225, v18, v19
 v_cvt_pk_bf16_f32 v226, v20, v21
 v_cvt_pk_bf16_f32 v227, v22, v23
 v_cvt_pk_bf16_f32 v228, v24, v25
 v_cvt_pk_bf16_f32 v229, v26, v27
 v_cvt_pk_bf16_f32 v230, v28, v29
 v_cvt_pk_bf16_f32 v231, v30, v31
 buffer_store_dwordx4 v[224:227], v244, s[8:11], s53 offen offset:2048 sc1
 buffer_store_dwordx4 v[228:231], v244, s[8:11], s53 offen offset:3072 sc1
 s_add_u32 s53, s53, 4096
 s_lshl_b32 s28, s50, 5
 s_add_u32 s28, s28, s51
 s_lshl_b32 s28, s28, 2
 s_add_u32 s28, s28, 6328320
 s_waitcnt vmcnt(0)
 s_barrier
 s_cmp_eq_u32 s14, 0
 s_cbranch_scc0 sg_60
 s_mov_b64 exec, 1
 v_mov_b32 v233, 0
 v_mov_b32 v234, 1
 buffer_atomic_add v234, v233, s[8:11], s28 offen sc1
 s_mov_b64 exec, -1
sg_60:
 s_branch wk_next
 s_endpgm
role_S_slow2:
 v_lshlrev_b32 v120, 4, v0
 v_add_u32 v1, 1024, v0
 v_lshlrev_b32 v121, 3, v1
 v_and_b32 v2, 63, v0
 v_lshlrev_b32 v124, 4, v2
 v_lshrrev_b32 v3, 4, v2
 v_and_b32 v4, 15, v2
 v_bfe_u32 v5, v4, 1, 1
 v_lshrrev_b32 v6, 2, v4
 v_and_b32 v7, 1, v4
 v_lshl_add_u32 v6, v6, 1, v7
 v_lshlrev_b32 v122, 8, v3
 v_lshl_add_u32 v122, v5, 7, v122
 v_lshl_add_u32 v122, v6, 4, v122
 v_mov_b32 v123, 0x4444
 v_mov_b32 v7, 0xeeee
 v_cmp_eq_u32 vcc, 1, v5
 s_nop 1
 v_cndmask_b32 v123, v123, v7, vcc
 s_mov_b32 s42, 0x00003f80
 s_mov_b32 s43, 0x3f800000
 s_mov_b32 s40, 0x00ff00ff
 s_mov_b32 s41, 0x00ff00ff
 s_mov_b32 s45, 200000
 s_lshl_b32 s36, s12, 16
 s_add_u32 s36, s36, 3145728
 s_lshl_b32 s18, s12, 3
 s_lshl_b32 s46, s12, 7
 s_add_u32 s46, s46, 6344704
 s_mov_b32 s16, 0
 s_mul_i32 s28, s14, 384
 s_add_u32 s28, s28, 0
 v_add_u32 v8, s28, v2
 v_mul_u32_u24 v9, 0xaaab, v8
 v_lshrrev_b32 v9, 20, v9
 v_mul_u32_u24 v10, 24, v9
 v_sub_u32 v10, v8, v10
 v_bfe_u32 v11, v9, 2, 2
 v_lshlrev_b32 v11, 1, v11
 v_xor_b32 v10, v10, v11
 v_mul_u32_u24 v9, 12288, v9
 v_lshl_add_u32 v130, v10, 4, v9
 s_mul_i32 s28, s14, 384
 s_add_u32 s28, s28, 64
 v_add_u32 v8, s28, v2
 v_mul_u32_u24 v9, 0xaaab, v8
 v_lshrrev_b32 v9, 20, v9
 v_mul_u32_u24 v10, 24, v9
 v_sub_u32 v10, v8, v10
 v_bfe_u32 v11, v9, 2, 2
 v_lshlrev_b32 v11, 1, v11
 v_xor_b32 v10, v10, v11
 v_mul_u32_u24 v9, 12288, v9
 v_lshl_add_u32 v131, v10, 4, v9
 s_mul_i32 s28, s14, 384
 s_add_u32 s28, s28, 128
 v_add_u32 v8, s28, v2
 v_mul_u32_u24 v9, 0xaaab, v8
 v_lshrrev_b32 v9, 20, v9
 v_mul_u32_u24 v10, 24, v9
 v_sub_u32 v10, v8, v10
 v_bfe_u32 v11, v9, 2, 2
 v_lshlrev_b32 v11, 1, v11
 v_xor_b32 v10, v10, v11
 v_mul_u32_u24 v9, 12288, v9
 v_lshl_add_u32 v132, v10, 4, v9
 s_mul_i32 s28, s14, 384
 s_add_u32 s28, s28, 192
 v_add_u32 v8, s28, v2
 v_mul_u32_u24 v9, 0xaaab, v8
 v_lshrrev_b32 v9, 20, v9
 v_mul_u32_u24 v10, 24, v9
 v_sub_u32 v10, v8, v10
 v_bfe_u32 v11, v9, 2, 2
 v_lshlrev_b32 v11, 1, v11
 v_xor_b32 v10, v10, v11
 v_mul_u32_u24 v9, 12288, v9
 v_lshl_add_u32 v133, v10, 4, v9
 s_mul_i32 s28, s14, 384
 s_add_u32 s28, s28, 256
 v_add_u32 v8, s28, v2
 v_mul_u32_u24 v9, 0xaaab, v8
 v_lshrrev_b32 v9, 20, v9
 v_mul_u32_u24 v10, 24, v9
 v_sub_u32 v10, v8, v10
 v_bfe_u32 v11, v9, 2, 2
 v_lshlrev_b32 v11, 1, v11
 v_xor_b32 v10, v10, v11
 v_mul_u32_u24 v9, 12288, v9
 v_lshl_add_u32 v134, v10, 4, v9
 s_mul_i32 s28, s14, 384
 s_add_u32 s28, s28, 320
 v_add_u32 v8, s28, v2
 v_mul_u32_u24 v9, 0xaaab, v8
 v_lshrrev_b32 v9, 20, v9
 v_mul_u32_u24 v10, 24, v9
 v_sub_u32 v10, v8, v10
 v_bfe_u32 v11, v9, 2, 2
 v_lshlrev_b32 v11, 1, v11
 v_xor_b32 v10, v10, v11
 v_mul_u32_u24 v9, 12288, v9
 v_lshl_add_u32 v135, v10, 4, v9
 v_lshrrev_b32 v8, 1, v3
 v_lshlrev_b32 v8, 4, v8
 v_and_b32 v9, 1, v3
 v_lshl_add_u32 v8, v9, 2, v8
 v_lshrrev_b32 v9, 2, v4
 v_and_b32 v10, 1, v9
 v_add_u32 v8, v8, v10
 v_lshrrev_b32 v11, 1, v9
 v_lshl_add_u32 v8, v11, 3, v8
 v_bfe_u32 v11, v8, 2, 2
 v_mul_u32_u24 v8, 384, v8
 v_and_b32 v9, 3, v2
 v_lshl_add_u32 v8, v9, 3, v8
 s_mul_i32 s28, s14, 3
 s_add_u32 s28, s28, 0
 v_xor_b32 v9, s28, v11
 v_lshl_add_u32 v12, v9, 5, v8
 s_mul_i32 s28, s14, 3
 s_add_u32 s28, s28, 1
 v_xor_b32 v9, s28, v11
 v_lshl_add_u32 v14, v9, 5, v8
 s_mul_i32 s28, s14, 3
 s_add_u32 s28, s28, 2
 v_xor_b32 v9, s28, v11
 v_lshl_add_u32 v15, v9, 5, v8
 s_mul_i32 s47, s15, 384
 s_mul_i32 s28, s14, 6144
 s_add_u32 m0, s28, 0
 s_add_u32 s29, s47, 0
 buffer_load_dwordx4 v130, s[20:23], s29 offen lds
 s_mul_i32 s28, s14, 6144
 s_add_u32 m0, s28, 1024
 s_add_u32 s29, s47, 0
 buffer_load_dwordx4 v131, s[20:23], s29 offen lds
 s_mul_i32 s28, s14, 6144
 s_add_u32 m0, s28, 2048
 s_add_u32 s29, s47, 0
 buffer_load_dwordx4 v132, s[20:23], s29 offen lds
 s_mul_i32 s28, s14, 6144
 s_add_u32 m0, s28, 3072
 s_add_u32 s29, s47, 0
 buffer_load_dwordx4 v133, s[20:23], s29 offen lds
 s_mul_i32 s28, s14, 6144
 s_add_u32 m0, s28, 4096
 s_add_u32 s29, s47, 0
 buffer_load_dwordx4 v134, s[20:23], s29 offen lds
 s_mul_i32 s28, s14, 6144
 s_add_u32 m0, s28, 5120
 s_add_u32 s29, s47, 0
 buffer_load_dwordx4 v135, s[20:23], s29 offen lds
 s_mul_i32 s28, s14, 6144
 s_add_u32 m0, s28, 24576
 s_add_u32 s29, s47, 0
 buffer_load_dwordx4 v130, s[24:27], s29 offen lds
 s_mul_i32 s28, s14, 6144
 s_add_u32 m0, s28, 25600
 s_add_u32 s29, s47, 0
 buffer_load_dwordx4 v131, s[24:27], s29 offen lds
 s_mul_i32 s28, s14, 6144
 s_add_u32 m0, s28, 26624
 s_add_u32 s29, s47, 0
 buffer_load_dwordx4 v132, s[24:27], s29 offen lds
 s_mul_i32 s28, s14, 6144
 s_add_u32 m0, s28, 27648
 s_add_u32 s29, s47, 0
 buffer_load_dwordx4 v133, s[24:27], s29 offen lds
 s_mul_i32 s28, s14, 6144
 s_add_u32 m0, s28, 28672
 s_add_u32 s29, s47, 0
 buffer_load_dwordx4 v134, s[24:27], s29 offen lds
 s_mul_i32 s28, s14, 6144
 s_add_u32 m0, s28, 29696
 s_add_u32 s29, s47, 0
 buffer_load_dwordx4 v135, s[24:27], s29 offen lds
 s_mul_i32 s28, s14, 6144
 s_add_u32 m0, s28, 49152
 s_add_u32 s29, s47, 786432
 buffer_load_dwordx4 v130, s[20:23], s29 offen lds
 s_mul_i32 s28, s14, 6144
 s_add_u32 m0, s28, 50176
 s_add_u32 s29, s47, 786432
 buffer_load_dwordx4 v131, s[20:23], s29 offen lds
 s_mul_i32 s28, s14, 6144
 s_add_u32 m0, s28, 51200
 s_add_u32 s29, s47, 786432
 buffer_load_dwordx4 v132, s[20:23], s29 offen lds
 s_mul_i32 s28, s14, 6144
 s_add_u32 m0, s28, 52224
 s_add_u32 s29, s47, 786432
 buffer_load_dwordx4 v133, s[20:23], s29 offen lds
 s_mul_i32 s28, s14, 6144
 s_add_u32 m0, s28, 53248
 s_add_u32 s29, s47, 786432
 buffer_load_dwordx4 v134, s[20:23], s29 offen lds
 s_mul_i32 s28, s14, 6144
 s_add_u32 m0, s28, 54272
 s_add_u32 s29, s47, 786432
 buffer_load_dwordx4 v135, s[20:23], s29 offen lds
 s_mul_i32 s28, s14, 6144
 s_add_u32 m0, s28, 73728
 s_add_u32 s29, s47, 786432
 buffer_load_dwordx4 v130, s[24:27], s29 offen lds
 s_mul_i32 s28, s14, 6144
 s_add_u32 m0, s28, 74752
 s_add_u32 s29, s47, 786432
 buffer_load_dwordx4 v131, s[24:27], s29 offen lds
 s_mul_i32 s28, s14, 6144
 s_add_u32 m0, s28, 75776
 s_add_u32 s29, s47, 786432
 buffer_load_dwordx4 v132, s[24:27], s29 offen lds
 s_mul_i32 s28, s14, 6144
 s_add_u32 m0, s28, 76800
 s_add_u32 s29, s47, 786432
 buffer_load_dwordx4 v133, s[24:27], s29 offen lds
 s_mul_i32 s28, s14, 6144
 s_add_u32 m0, s28, 77824
 s_add_u32 s29, s47, 786432
 buffer_load_dwordx4 v134, s[24:27], s29 offen lds
 s_mul_i32 s28, s14, 6144
 s_add_u32 m0, s28, 78848
 s_add_u32 s29, s47, 786432
 buffer_load_dwordx4 v135, s[24:27], s29 offen lds
 s_mul_i32 s28, s14, 6144
 s_add_u32 m0, s28, 98304
 s_add_u32 s29, s47, 1572864
 buffer_load_dwordx4 v130, s[20:23], s29 offen lds
 s_mul_i32 s28, s14, 6144
 s_add_u32 m0, s28, 99328
 s_add_u32 s29, s47, 1572864
 buffer_load_dwordx4 v131, s[20:23], s29 offen lds
 s_mul_i32 s28, s14, 6144
 s_add_u32 m0, s28, 100352
 s_add_u32 s29, s47, 1572864
 buffer_load_dwordx4 v132, s[20:23], s29 offen lds
 s_mul_i32 s28, s14, 6144
 s_add_u32 m0, s28, 101376
 s_add_u32 s29, s47, 1572864
 buffer_load_dwordx4 v133, s[20:23], s29 offen lds
 s_mul_i32 s28, s14, 6144
 s_add_u32 m0, s28, 102400
 s_add_u32 s29, s47, 1572864
 buffer_load_dwordx4 v134, s[20:23], s29 offen lds
 s_mul_i32 s28, s14, 6144
 s_add_u32 m0, s28, 103424
 s_add_u32 s29, s47, 1572864
 buffer_load_dwordx4 v135, s[20:23], s29 offen lds
 s_waitcnt vmcnt(24) lgkmcnt(0)
 s_barrier
 s_mul_i32 s28, s14, 6144
 s_add_u32 m0, s28, 122880
 s_add_u32 s29, s47, 1572864
 buffer_load_dwordx4 v130, s[24:27], s29 offen lds
 s_mul_i32 s28, s14, 6144
 s_add_u32 m0, s28, 123904
 s_add_u32 s29, s47, 1572864
 buffer_load_dwordx4 v131, s[24:27], s29 offen lds
 s_mul_i32 s28, s14, 6144
 s_add_u32 m0, s28, 124928
 s_add_u32 s29, s47, 1572864
 buffer_load_dwordx4 v132, s[24:27], s29 offen lds
 s_mul_i32 s28, s14, 6144
 s_add_u32 m0, s28, 125952
 s_add_u32 s29, s47, 1572864
 buffer_load_dwordx4 v133, s[24:27], s29 offen lds
 s_mul_i32 s28, s14, 6144
 s_add_u32 m0, s28, 126976
 s_add_u32 s29, s47, 1572864
 buffer_load_dwordx4 v134, s[24:27], s29 offen lds
 s_mul_i32 s28, s14, 6144
 s_add_u32 m0, s28, 128000
 s_add_u32 s29, s47, 1572864
 buffer_load_dwordx4 v135, s[24:27], s29 offen lds
 v_add_u32 v13, 0, v12
 ds_read_b64_tr_b16 a[0:1], v13 offset:0
 ds_read_b64_tr_b16 a[2:3], v13 offset:768
 ds_read_b64_tr_b16 a[4:5], v13 offset:12288
 ds_read_b64_tr_b16 a[6:7], v13 offset:13056
 v_add_u32 v13, 0, v14
 ds_read_b64_tr_b16 a[8:9], v13 offset:0
 ds_read_b64_tr_b16 a[10:11], v13 offset:768
 ds_read_b64_tr_b16 a[12:13], v13 offset:12288
 ds_read_b64_tr_b16 a[14:15], v13 offset:13056
 v_add_u32 v13, 0, v15
 ds_read_b64_tr_b16 a[16:17], v13 offset:0
 ds_read_b64_tr_b16 a[18:19], v13 offset:768
 ds_read_b64_tr_b16 a[20:21], v13 offset:12288
 ds_read_b64_tr_b16 a[22:23], v13 offset:13056
 s_waitcnt vmcnt(24) lgkmcnt(0)
 s_barrier
 s_mul_i32 s28, s14, 6144
 s_add_u32 m0, s28, 0
 s_add_u32 s29, s47, 2359296
 buffer_load_dwordx4 v130, s[20:23], s29 offen lds
 s_mul_i32 s28, s14, 6144
 s_add_u32 m0, s28, 1024
 s_add_u32 s29, s47, 2359296
 buffer_load_dwordx4 v131, s[20:23], s29 offen lds
 s_mul_i32 s28, s14, 6144
 s_add_u32 m0, s28, 2048
 s_add_u32 s29, s47, 2359296
 buffer_load_dwordx4 v132, s[20:23], s29 offen lds
 s_mul_i32 s28, s14, 6144
 s_add_u32 m0, s28, 3072
 s_add_u32 s29, s47, 2359296
 buffer_load_dwordx4 v133, s[20:23], s29 offen lds
 s_mul_i32 s28, s14, 6144
 s_add_u32 m0, s28, 4096
 s_add_u32 s29, s47, 2359296
 buffer_load_dwordx4 v134, s[20:23], s29 offen lds
 s_mul_i32 s28, s14, 6144
 s_add_u32 m0, s28, 5120
 s_add_u32 s29, s47, 2359296
 buffer_load_dwordx4 v135, s[20:23], s29 offen lds
 v_add_u32 v13, 24576, v12
 ds_read_b64_tr_b16 v[16:17], v13 offset:0
 ds_read_b64_tr_b16 v[18:19], v13 offset:768
 ds_read_b64_tr_b16 v[20:21], v13 offset:12288
 ds_read_b64_tr_b16 v[22:23], v13 offset:13056
 v_add_u32 v13, 24576, v14
 ds_read_b64_tr_b16 a[24:25], v13 offset:0
 ds_read_b64_tr_b16 a[26:27], v13 offset:768
 ds_read_b64_tr_b16 a[28:29], v13 offset:12288
 ds_read_b64_tr_b16 a[30:31], v13 offset:13056
 v_add_u32 v13, 24576, v15
 ds_read_b64_tr_b16 a[32:33], v13 offset:0
 ds_read_b64_tr_b16 a[34:35], v13 offset:768
 ds_read_b64_tr_b16 a[36:37], v13 offset:12288
 ds_read_b64_tr_b16 a[38:39], v13 offset:13056
 s_waitcnt vmcnt(24) lgkmcnt(0)
 s_barrier
 s_mul_i32 s28, s14, 6144
 s_add_u32 m0, s28, 24576
 s_add_u32 s29, s47, 2359296
 buffer_load_dwordx4 v130, s[24:27], s29 offen lds
 s_mul_i32 s28, s14, 6144
 s_add_u32 m0, s28, 25600
 s_add_u32 s29, s47, 2359296
 buffer_load_dwordx4 v131, s[24:27], s29 offen lds
 s_mul_i32 s28, s14, 6144
 s_add_u32 m0, s28, 26624
 s_add_u32 s29, s47, 2359296
 buffer_load_dwordx4 v132, s[24:27], s29 offen lds
 s_mul_i32 s28, s14, 6144
 s_add_u32 m0, s28, 27648
 s_add_u32 s29, s47, 2359296
 buffer_load_dwordx4 v133, s[24:27], s29 offen lds
 s_mul_i32 s28, s14, 6144
 s_add_u32 m0, s28, 28672
 s_add_u32 s29, s47, 2359296
 buffer_load_dwordx4 v134, s[24:27], s29 offen lds
 s_mul_i32 s28, s14, 6144
 s_add_u32 m0, s28, 29696
 s_add_u32 s29, s47, 2359296
 buffer_load_dwordx4 v135, s[24:27], s29 offen lds
 v_add_u32 v13, 49152, v12
 ds_read_b64_tr_b16 a[40:41], v13 offset:0
 ds_read_b64_tr_b16 a[42:43], v13 offset:768
 ds_read_b64_tr_b16 a[44:45], v13 offset:12288
 ds_read_b64_tr_b16 a[46:47], v13 offset:13056
 v_add_u32 v13, 49152, v14
 ds_read_b64_tr_b16 v[24:25], v13 offset:0
 ds_read_b64_tr_b16 v[26:27], v13 offset:768
 ds_read_b64_tr_b16 v[28:29], v13 offset:12288
 ds_read_b64_tr_b16 v[30:31], v13 offset:13056
 v_add_u32 v13, 49152, v15
 ds_read_b64_tr_b16 a[48:49], v13 offset:0
 ds_read_b64_tr_b16 a[50:51], v13 offset:768
 ds_read_b64_tr_b16 a[52:53], v13 offset:12288
 ds_read_b64_tr_b16 a[54:55], v13 offset:13056
 s_waitcnt vmcnt(24) lgkmcnt(0)
 s_barrier
 s_mul_i32 s28, s14, 6144
 s_add_u32 m0, s28, 49152
 s_add_u32 s29, s47, 3145728
 buffer_load_dwordx4 v130, s[20:23], s29 offen lds
 s_mul_i32 s28, s14, 6144
 s_add_u32 m0, s28, 50176
 s_add_u32 s29, s47, 3145728
 buffer_load_dwordx4 v131, s[20:23], s29 offen lds
 s_mul_i32 s28, s14, 6144
 s_add_u32 m0, s28, 51200
 s_add_u32 s29, s47, 3145728
 buffer_load_dwordx4 v132, s[20:23], s29 offen lds
 s_mul_i32 s28, s14, 6144
 s_add_u32 m0, s28, 52224
 s_add_u32 s29, s47, 3145728
 buffer_load_dwordx4 v133, s[20:23], s29 offen lds
 s_mul_i32 s28, s14, 6144
 s_add_u32 m0, s28, 53248
 s_add_u32 s29, s47, 3145728
 buffer_load_dwordx4 v134, s[20:23], s29 offen lds
 s_mul_i32 s28, s14, 6144
 s_add_u32 m0, s28, 54272
 s_add_u32 s29, s47, 3145728
 buffer_load_dwordx4 v135, s[20:23], s29 offen lds
 v_add_u32 v13, 73728, v12
 ds_read_b64_tr_b16 a[56:57], v13 offset:0
 ds_read_b64_tr_b16 a[58:59], v13 offset:768
 ds_read_b64_tr_b16 a[60:61], v13 offset:12288
 ds_read_b64_tr_b16 a[62:63], v13 offset:13056
 v_add_u32 v13, 73728, v14
 ds_read_b64_tr_b16 a[64:65], v13 offset:0
 ds_read_b64_tr_b16 a[66:67], v13 offset:768
 ds_read_b64_tr_b16 a[68:69], v13 offset:12288
 ds_read_b64_tr_b16 a[70:71], v13 offset:13056
 v_add_u32 v13, 73728, v15
 ds_read_b64_tr_b16 v[32:33], v13 offset:0
 ds_read_b64_tr_b16 v[34:35], v13 offset:768
 ds_read_b64_tr_b16 v[36:37], v13 offset:12288
 ds_read_b64_tr_b16 v[38:39], v13 offset:13056
 s_waitcnt vmcnt(24) lgkmcnt(0)
 s_barrier
 s_mul_i32 s28, s14, 6144
 s_add_u32 m0, s28, 73728
 s_add_u32 s29, s47, 3145728
 buffer_load_dwordx4 v130, s[24:27], s29 offen lds
 s_mul_i32 s28, s14, 6144
 s_add_u32 m0, s28, 74752
 s_add_u32 s29, s47, 3145728
 buffer_load_dwordx4 v131, s[24:27], s29 offen lds
 s_mul_i32 s28, s14, 6144
 s_add_u32 m0, s28, 75776
 s_add_u32 s29, s47, 3145728
 buffer_load_dwordx4 v132, s[24:27], s29 offen lds
 s_mul_i32 s28, s14, 6144
 s_add_u32 m0, s28, 76800
 s_add_u32 s29, s47, 3145728
 buffer_load_dwordx4 v133, s[24:27], s29 offen lds
 s_mul_i32 s28, s14, 6144
 s_add_u32 m0, s28, 77824
 s_add_u32 s29, s47, 3145728
 buffer_load_dwordx4 v134, s[24:27], s29 offen lds
 s_mul_i32 s28, s14, 6144
 s_add_u32 m0, s28, 78848
 s_add_u32 s29, s47, 3145728
 buffer_load_dwordx4 v135, s[24:27], s29 offen lds
 v_add_u32 v13, 98304, v12
 ds_read_b64_tr_b16 a[72:73], v13 offset:0
 ds_read_b64_tr_b16 a[74:75], v13 offset:768
 ds_read_b64_tr_b16 a[76:77], v13 offset:12288
 ds_read_b64_tr_b16 a[78:79], v13 offset:13056
 v_add_u32 v13, 98304, v14
 ds_read_b64_tr_b16 a[80:81], v13 offset:0
 ds_read_b64_tr_b16 a[82:83], v13 offset:768
 ds_read_b64_tr_b16 a[84:85], v13 offset:12288
 ds_read_b64_tr_b16 a[86:87], v13 offset:13056
 v_add_u32 v13, 98304, v15
 ds_read_b64_tr_b16 a[88:89], v13 offset:0
 ds_read_b64_tr_b16 a[90:91], v13 offset:768
 ds_read_b64_tr_b16 a[92:93], v13 offset:12288
 ds_read_b64_tr_b16 a[94:95], v13 offset:13056
 s_waitcnt vmcnt(24) lgkmcnt(0)
 s_barrier
 s_mul_i32 s28, s14, 6144
 s_add_u32 m0, s28, 98304
 s_add_u32 s29, s47, 3932160
 buffer_load_dwordx4 v130, s[20:23], s29 offen lds
 s_mul_i32 s28, s14, 6144
 s_add_u32 m0, s28, 99328
 s_add_u32 s29, s47, 3932160
 buffer_load_dwordx4 v131, s[20:23], s29 offen lds
 s_mul_i32 s28, s14, 6144
 s_add_u32 m0, s28, 100352
 s_add_u32 s29, s47, 3932160
 buffer_load_dwordx4 v132, s[20:23], s29 offen lds
 s_mul_i32 s28, s14, 6144
 s_add_u32 m0, s28, 101376
 s_add_u32 s29, s47, 3932160
 buffer_load_dwordx4 v133, s[20:23], s29 offen lds
 s_mul_i32 s28, s14, 6144
 s_add_u32 m0, s28, 102400
 s_add_u32 s29, s47, 3932160
 buffer_load_dwordx4 v134, s[20:23], s29 offen lds
 s_mul_i32 s28, s14, 6144
 s_add_u32 m0, s28, 103424
 s_add_u32 s29, s47, 3932160
 buffer_load_dwordx4 v135, s[20:23], s29 offen lds
 v_add_u32 v13, 122880, v12
 ds_read_b64_tr_b16 v[40:41], v13 offset:0
 ds_read_b64_tr_b16 v[42:43], v13 offset:768
 ds_read_b64_tr_b16 v[44:45], v13 offset:12288
 ds_read_b64_tr_b16 v[46:47], v13 offset:13056
 v_add_u32 v13, 122880, v14
 ds_read_b64_tr_b16 a[96:97], v13 offset:0
 ds_read_b64_tr_b16 a[98:99], v13 offset:768
 ds_read_b64_tr_b16 a[100:101], v13 offset:12288
 ds_read_b64_tr_b16 a[102:103], v13 offset:13056
 v_add_u32 v13, 122880, v15
 ds_read_b64_tr_b16 a[104:105], v13 offset:0
 ds_read_b64_tr_b16 a[106:107], v13 offset:768
 ds_read_b64_tr_b16 a[108:109], v13 offset:12288
 ds_read_b64_tr_b16 a[110:111], v13 offset:13056
 s_waitcnt vmcnt(24) lgkmcnt(0)
 s_barrier
 s_mul_i32 s28, s14, 6144
 s_add_u32 m0, s28, 122880
 s_add_u32 s29, s47, 3932160
 buffer_load_dwordx4 v130, s[24:27], s29 offen lds
 s_mul_i32 s28, s14, 6144
 s_add_u32 m0, s28, 123904
 s_add_u32 s29, s47, 3932160
 buffer_load_dwordx4 v131, s[24:27], s29 offen lds
 s_mul_i32 s28, s14, 6144
 s_add_u32 m0, s28, 124928
 s_add_u32 s29, s47, 3932160
 buffer_load_dwordx4 v132, s[24:27], s29 offen lds
 s_mul_i32 s28, s14, 6144
 s_add_u32 m0, s28, 125952
 s_add_u32 s29, s47, 3932160
 buffer_load_dwordx4 v133, s[24:27], s29 offen lds
 s_mul_i32 s28, s14, 6144
 s_add_u32 m0, s28, 126976
 s_add_u32 s29, s47, 3932160
 buffer_load_dwordx4 v134, s[24:27], s29 offen lds
 s_mul_i32 s28, s14, 6144
 s_add_u32 m0, s28, 128000
 s_add_u32 s29, s47, 3932160
 buffer_load_dwordx4 v135, s[24:27], s29 offen lds
 v_add_u32 v13, 0, v12
 ds_read_b64_tr_b16 a[112:113], v13 offset:0
 ds_read_b64_tr_b16 a[114:115], v13 offset:768
 ds_read_b64_tr_b16 a[116:117], v13 offset:12288
 ds_read_b64_tr_b16 a[118:119], v13 offset:13056
 v_add_u32 v13, 0, v14
 ds_read_b64_tr_b16 v[48:49], v13 offset:0
 ds_read_b64_tr_b16 v[50:51], v13 offset:768
 ds_read_b64_tr_b16 v[52:53], v13 offset:12288
 ds_read_b64_tr_b16 v[54:55], v13 offset:13056
 v_add_u32 v13, 0, v15
 ds_read_b64_tr_b16 a[120:121], v13 offset:0
 ds_read_b64_tr_b16 a[122:123], v13 offset:768
 ds_read_b64_tr_b16 a[124:125], v13 offset:12288
 ds_read_b64_tr_b16 a[126:127], v13 offset:13056
 s_waitcnt vmcnt(24) lgkmcnt(0)
 s_barrier
 s_mul_i32 s28, s14, 6144
 s_add_u32 m0, s28, 0
 s_add_u32 s29, s47, 4718592
 buffer_load_dwordx4 v130, s[20:23], s29 offen lds
 s_mul_i32 s28, s14, 6144
 s_add_u32 m0, s28, 1024
 s_add_u32 s29, s47, 4718592
 buffer_load_dwordx4 v131, s[20:23], s29 offen lds
 s_mul_i32 s28, s14, 6144
 s_add_u32 m0, s28, 2048
 s_add_u32 s29, s47, 4718592
 buffer_load_dwordx4 v132, s[20:23], s29 offen lds
 s_mul_i32 s28, s14, 6144
 s_add_u32 m0, s28, 3072
 s_add_u32 s29, s47, 4718592
 buffer_load_dwordx4 v133, s[20:23], s29 offen lds
 s_mul_i32 s28, s14, 6144
 s_add_u32 m0, s28, 4096
 s_add_u32 s29, s47, 4718592
 buffer_load_dwordx4 v134, s[20:23], s29 offen lds
 s_mul_i32 s28, s14, 6144
 s_add_u32 m0, s28, 5120
 s_add_u32 s29, s47, 4718592
 buffer_load_dwordx4 v135, s[20:23], s29 offen lds
 v_add_u32 v13, 24576, v12
 ds_read_b64_tr_b16 a[128:129], v13 offset:0
 ds_read_b64_tr_b16 a[130:131], v13 offset:768
 ds_read_b64_tr_b16 a[132:133], v13 offset:12288
 ds_read_b64_tr_b16 a[134:135], v13 offset:13056
 v_add_u32 v13, 24576, v14
 ds_read_b64_tr_b16 a[136:137], v13 offset:0
 ds_read_b64_tr_b16 a[138:139], v13 offset:768
 ds_read_b64_tr_b16 a[140:141], v13 offset:12288
 ds_read_b64_tr_b16 a[142:143], v13 offset:13056
 v_add_u32 v13, 24576, v15
 ds_read_b64_tr_b16 v[56:57], v13 offset:0
 ds_read_b64_tr_b16 v[58:59], v13 offset:768
 ds_read_b64_tr_b16 v[60:61], v13 offset:12288
 ds_read_b64_tr_b16 v[62:63], v13 offset:13056
 s_waitcnt vmcnt(24) lgkmcnt(0)
 s_barrier
 s_mul_i32 s28, s14, 6144
 s_add_u32 m0, s28, 24576
 s_add_u32 s29, s47, 4718592
 buffer_load_dwordx4 v130, s[24:27], s29 offen lds
 s_mul_i32 s28, s14, 6144
 s_add_u32 m0, s28, 25600
 s_add_u32 s29, s47, 4718592
 buffer_load_dwordx4 v131, s[24:27], s29 offen lds
 s_mul_i32 s28, s14, 6144
 s_add_u32 m0, s28, 26624
 s_add_u32 s29, s47, 4718592
 buffer_load_dwordx4 v132, s[24:27], s29 offen lds
 s_mul_i32 s28, s14, 6144
 s_add_u32 m0, s28, 27648
 s_add_u32 s29, s47, 4718592
 buffer_load_dwordx4 v133, s[24:27], s29 offen lds
 s_mul_i32 s28, s14, 6144
 s_add_u32 m0, s28, 28672
 s_add_u32 s29, s47, 4718592
 buffer_load_dwordx4 v134, s[24:27], s29 offen lds
 s_mul_i32 s28, s14, 6144
 s_add_u32 m0, s28, 29696
 s_add_u32 s29, s47, 4718592
 buffer_load_dwordx4 v135, s[24:27], s29 offen lds
 v_add_u32 v13, 49152, v12
 ds_read_b64_tr_b16 a[144:145], v13 offset:0
 ds_read_b64_tr_b16 a[146:147], v13 offset:768
 ds_read_b64_tr_b16 a[148:149], v13 offset:12288
 ds_read_b64_tr_b16 a[150:151], v13 offset:13056
 v_add_u32 v13, 49152, v14
 ds_read_b64_tr_b16 a[152:153], v13 offset:0
 ds_read_b64_tr_b16 a[154:155], v13 offset:768
 ds_read_b64_tr_b16 a[156:157], v13 offset:12288
 ds_read_b64_tr_b16 a[158:159], v13 offset:13056
 v_add_u32 v13, 49152, v15
 ds_read_b64_tr_b16 a[160:161], v13 offset:0
 ds_read_b64_tr_b16 a[162:163], v13 offset:768
 ds_read_b64_tr_b16 a[164:165], v13 offset:12288
 ds_read_b64_tr_b16 a[166:167], v13 offset:13056
 s_waitcnt vmcnt(24) lgkmcnt(0)
 s_barrier
 s_mul_i32 s28, s14, 6144
 s_add_u32 m0, s28, 49152
 s_add_u32 s29, s47, 5505024
 buffer_load_dwordx4 v130, s[20:23], s29 offen lds
 s_mul_i32 s28, s14, 6144
 s_add_u32 m0, s28, 50176
 s_add_u32 s29, s47, 5505024
 buffer_load_dwordx4 v131, s[20:23], s29 offen lds
 s_mul_i32 s28, s14, 6144
 s_add_u32 m0, s28, 51200
 s_add_u32 s29, s47, 5505024
 buffer_load_dwordx4 v132, s[20:23], s29 offen lds
 s_mul_i32 s28, s14, 6144
 s_add_u32 m0, s28, 52224
 s_add_u32 s29, s47, 5505024
 buffer_load_dwordx4 v133, s[20:23], s29 offen lds
 s_mul_i32 s28, s14, 6144
 s_add_u32 m0, s28, 53248
 s_add_u32 s29, s47, 5505024
 buffer_load_dwordx4 v134, s[20:23], s29 offen lds
 s_mul_i32 s28, s14, 6144
 s_add_u32 m0, s28, 54272
 s_add_u32 s29, s47, 5505024
 buffer_load_dwordx4 v135, s[20:23], s29 offen lds
 v_add_u32 v13, 73728, v12
 ds_read_b64_tr_b16 a[168:169], v13 offset:0
 ds_read_b64_tr_b16 a[170:171], v13 offset:768
 ds_read_b64_tr_b16 a[172:173], v13 offset:12288
 ds_read_b64_tr_b16 a[174:175], v13 offset:13056
 v_add_u32 v13, 73728, v14
 ds_read_b64_tr_b16 a[176:177], v13 offset:0
 ds_read_b64_tr_b16 a[178:179], v13 offset:768
 ds_read_b64_tr_b16 a[180:181], v13 offset:12288
 ds_read_b64_tr_b16 a[182:183], v13 offset:13056
 v_add_u32 v13, 73728, v15
 ds_read_b64_tr_b16 a[184:185], v13 offset:0
 ds_read_b64_tr_b16 a[186:187], v13 offset:768
 ds_read_b64_tr_b16 a[188:189], v13 offset:12288
 ds_read_b64_tr_b16 a[190:191], v13 offset:13056
 s_waitcnt vmcnt(24) lgkmcnt(0)
 s_barrier
 s_mul_i32 s28, s14, 6144
 s_add_u32 m0, s28, 73728
 s_add_u32 s29, s47, 5505024
 buffer_load_dwordx4 v130, s[24:27], s29 offen lds
 s_mul_i32 s28, s14, 6144
 s_add_u32 m0, s28, 74752
 s_add_u32 s29, s47, 5505024
 buffer_load_dwordx4 v131, s[24:27], s29 offen lds
 s_mul_i32 s28, s14, 6144
 s_add_u32 m0, s28, 75776
 s_add_u32 s29, s47, 5505024
 buffer_load_dwordx4 v132, s[24:27], s29 offen lds
 s_mul_i32 s28, s14, 6144
 s_add_u32 m0, s28, 76800
 s_add_u32 s29, s47, 5505024
 buffer_load_dwordx4 v133, s[24:27], s29 offen lds
 s_mul_i32 s28, s14, 6144
 s_add_u32 m0, s28, 77824
 s_add_u32 s29, s47, 5505024
 buffer_load_dwordx4 v134, s[24:27], s29 offen lds
 s_mul_i32 s28, s14, 6144
 s_add_u32 m0, s28, 78848
 s_add_u32 s29, s47, 5505024
 buffer_load_dwordx4 v135, s[24:27], s29 offen lds
 v_add_u32 v13, 98304, v12
 ds_read_b64_tr_b16 a[192:193], v13 offset:0
 ds_read_b64_tr_b16 a[194:195], v13 offset:768
 ds_read_b64_tr_b16 a[196:197], v13 offset:12288
 ds_read_b64_tr_b16 a[198:199], v13 offset:13056
 v_add_u32 v13, 98304, v14
 ds_read_b64_tr_b16 v[72:73], v13 offset:0
 ds_read_b64_tr_b16 v[74:75], v13 offset:768
 ds_read_b64_tr_b16 v[76:77], v13 offset:12288
 ds_read_b64_tr_b16 v[78:79], v13 offset:13056
 v_add_u32 v13, 98304, v15
 ds_read_b64_tr_b16 a[200:201], v13 offset:0
 ds_read_b64_tr_b16 a[202:203], v13 offset:768
 ds_read_b64_tr_b16 a[204:205], v13 offset:12288
 ds_read_b64_tr_b16 a[206:207], v13 offset:13056
 s_waitcnt vmcnt(24) lgkmcnt(0)
 s_barrier
 s_mul_i32 s28, s14, 6144
 s_add_u32 m0, s28, 98304
 s_add_u32 s29, s47, 6291456
 buffer_load_dwordx4 v130, s[20:23], s29 offen lds
 s_mul_i32 s28, s14, 6144
 s_add_u32 m0, s28, 99328
 s_add_u32 s29, s47, 6291456
 buffer_load_dwordx4 v131, s[20:23], s29 offen lds
 s_mul_i32 s28, s14, 6144
 s_add_u32 m0, s28, 100352
 s_add_u32 s29, s47, 6291456
 buffer_load_dwordx4 v132, s[20:23], s29 offen lds
 s_mul_i32 s28, s14, 6144
 s_add_u32 m0, s28, 101376
 s_add_u32 s29, s47, 6291456
 buffer_load_dwordx4 v133, s[20:23], s29 offen lds
 s_mul_i32 s28, s14, 6144
 s_add_u32 m0, s28, 102400
 s_add_u32 s29, s47, 6291456
 buffer_load_dwordx4 v134, s[20:23], s29 offen lds
 s_mul_i32 s28, s14, 6144
 s_add_u32 m0, s28, 103424
 s_add_u32 s29, s47, 6291456
 buffer_load_dwordx4 v135, s[20:23], s29 offen lds
 v_add_u32 v13, 122880, v12
 ds_read_b64_tr_b16 v[96:97], v13 offset:0
 ds_read_b64_tr_b16 v[98:99], v13 offset:768
 ds_read_b64_tr_b16 v[100:101], v13 offset:12288
 ds_read_b64_tr_b16 v[102:103], v13 offset:13056
 v_add_u32 v13, 122880, v14
 ds_read_b64_tr_b16 v[112:113], v13 offset:0
 ds_read_b64_tr_b16 v[114:115], v13 offset:768
 ds_read_b64_tr_b16 v[116:117], v13 offset:12288
 ds_read_b64_tr_b16 v[118:119], v13 offset:13056
 v_add_u32 v13, 122880, v15
 ds_read_b64_tr_b16 a[208:209], v13 offset:0
 ds_read_b64_tr_b16 a[210:211], v13 offset:768
 ds_read_b64_tr_b16 a[212:213], v13 offset:12288
 ds_read_b64_tr_b16 a[214:215], v13 offset:13056
 s_waitcnt vmcnt(24) lgkmcnt(0)
 s_barrier
 s_mul_i32 s28, s14, 6144
 s_add_u32 m0, s28, 122880
 s_add_u32 s29, s47, 6291456
 buffer_load_dwordx4 v130, s[24:27], s29 offen lds
 s_mul_i32 s28, s14, 6144
 s_add_u32 m0, s28, 123904
 s_add_u32 s29, s47, 6291456
 buffer_load_dwordx4 v131, s[24:27], s29 offen lds
 s_mul_i32 s28, s14, 6144
 s_add_u32 m0, s28, 124928
 s_add_u32 s29, s47, 6291456
 buffer_load_dwordx4 v132, s[24:27], s29 offen lds
 s_mul_i32 s28, s14, 6144
 s_add_u32 m0, s28, 125952
 s_add_u32 s29, s47, 6291456
 buffer_load_dwordx4 v133, s[24:27], s29 offen lds
 s_mul_i32 s28, s14, 6144
 s_add_u32 m0, s28, 126976
 s_add_u32 s29, s47, 6291456
 buffer_load_dwordx4 v134, s[24:27], s29 offen lds
 s_mul_i32 s28, s14, 6144
 s_add_u32 m0, s28, 128000
 s_add_u32 s29, s47, 6291456
 buffer_load_dwordx4 v135, s[24:27], s29 offen lds
 v_add_u32 v13, 0, v12
 ds_read_b64_tr_b16 a[216:217], v13 offset:0
 ds_read_b64_tr_b16 a[218:219], v13 offset:768
 ds_read_b64_tr_b16 a[220:221], v13 offset:12288
 ds_read_b64_tr_b16 a[222:223], v13 offset:13056
 v_add_u32 v13, 0, v14
 ds_read_b64_tr_b16 a[224:225], v13 offset:0
 ds_read_b64_tr_b16 a[226:227], v13 offset:768
 ds_read_b64_tr_b16 a[228:229], v13 offset:12288
 ds_read_b64_tr_b16 a[230:231], v13 offset:13056
 v_add_u32 v13, 0, v15
 ds_read_b64_tr_b16 a[232:233], v13 offset:0
 ds_read_b64_tr_b16 a[234:235], v13 offset:768
 ds_read_b64_tr_b16 a[236:237], v13 offset:12288
 ds_read_b64_tr_b16 a[238:239], v13 offset:13056
 s_waitcnt vmcnt(24) lgkmcnt(0)
 s_barrier
 s_mul_i32 s28, s14, 6144
 s_add_u32 m0, s28, 0
 s_add_u32 s29, s47, 7077888
 buffer_load_dwordx4 v130, s[20:23], s29 offen lds
 s_mul_i32 s28, s14, 6144
 s_add_u32 m0, s28, 1024
 s_add_u32 s29, s47, 7077888
 buffer_load_dwordx4 v131, s[20:23], s29 offen lds
 s_mul_i32 s28, s14, 6144
 s_add_u32 m0, s28, 2048
 s_add_u32 s29, s47, 7077888
 buffer_load_dwordx4 v132, s[20:23], s29 offen lds
 s_mul_i32 s28, s14, 6144
 s_add_u32 m0, s28, 3072
 s_add_u32 s29, s47, 7077888
 buffer_load_dwordx4 v133, s[20:23], s29 offen lds
 s_mul_i32 s28, s14, 6144
 s_add_u32 m0, s28, 4096
 s_add_u32 s29, s47, 7077888
 buffer_load_dwordx4 v134, s[20:23], s29 offen lds
 s_mul_i32 s28, s14, 6144
 s_add_u32 m0, s28, 5120
 s_add_u32 s29, s47, 7077888
 buffer_load_dwordx4 v135, s[20:23], s29 offen lds
 v_add_u32 v13, 24576, v12
 ds_read_b64_tr_b16 a[240:241], v13 offset:0
 ds_read_b64_tr_b16 a[242:243], v13 offset:768
 ds_read_b64_tr_b16 a[244:245], v13 offset:12288
 ds_read_b64_tr_b16 a[246:247], v13 offset:13056
 v_add_u32 v13, 24576, v14
 ds_read_b64_tr_b16 a[248:249], v13 offset:0
 ds_read_b64_tr_b16 a[250:251], v13 offset:768
 ds_read_b64_tr_b16 a[252:253], v13 offset:12288
 ds_read_b64_tr_b16 a[254:255], v13 offset:13056
 v_add_u32 v13, 24576, v15
 ds_read_b64_tr_b16 v[136:137], v13 offset:0
 ds_read_b64_tr_b16 v[138:139], v13 offset:768
 ds_read_b64_tr_b16 v[140:141], v13 offset:12288
 ds_read_b64_tr_b16 v[142:143], v13 offset:13056
 s_waitcnt vmcnt(24) lgkmcnt(0)
 s_barrier
 s_mul_i32 s28, s14, 6144
 s_add_u32 m0, s28, 24576
 s_add_u32 s29, s47, 7077888
 buffer_load_dwordx4 v130, s[24:27], s29 offen lds
 s_mul_i32 s28, s14, 6144
 s_add_u32 m0, s28, 25600
 s_add_u32 s29, s47, 7077888
 buffer_load_dwordx4 v131, s[24:27], s29 offen lds
 s_mul_i32 s28, s14, 6144
 s_add_u32 m0, s28, 26624
 s_add_u32 s29, s47, 7077888
 buffer_load_dwordx4 v132, s[24:27], s29 offen lds
 s_mul_i32 s28, s14, 6144
 s_add_u32 m0, s28, 27648
 s_add_u32 s29, s47, 7077888
 buffer_load_dwordx4 v133, s[24:27], s29 offen lds
 s_mul_i32 s28, s14, 6144
 s_add_u32 m0, s28, 28672
 s_add_u32 s29, s47, 7077888
 buffer_load_dwordx4 v134, s[24:27], s29 offen lds
 s_mul_i32 s28, s14, 6144
 s_add_u32 m0, s28, 29696
 s_add_u32 s29, s47, 7077888
 buffer_load_dwordx4 v135, s[24:27], s29 offen lds
 v_add_u32 v13, 49152, v12
 ds_read_b64_tr_b16 v[64:65], v13 offset:0
 ds_read_b64_tr_b16 v[66:67], v13 offset:768
 ds_read_b64_tr_b16 v[68:69], v13 offset:12288
 ds_read_b64_tr_b16 v[70:71], v13 offset:13056
 v_add_u32 v13, 49152, v14
 ds_read_b64_tr_b16 v[144:145], v13 offset:0
 ds_read_b64_tr_b16 v[146:147], v13 offset:768
 ds_read_b64_tr_b16 v[148:149], v13 offset:12288
 ds_read_b64_tr_b16 v[150:151], v13 offset:13056
 v_add_u32 v13, 49152, v15
 ds_read_b64_tr_b16 v[88:89], v13 offset:0
 ds_read_b64_tr_b16 v[90:91], v13 offset:768
 ds_read_b64_tr_b16 v[92:93], v13 offset:12288
 ds_read_b64_tr_b16 v[94:95], v13 offset:13056
 s_waitcnt vmcnt(24) lgkmcnt(0)
 s_barrier
 v_add_u32 v13, 73728, v12
 ds_read_b64_tr_b16 v[152:153], v13 offset:0
 ds_read_b64_tr_b16 v[154:155], v13 offset:768
 ds_read_b64_tr_b16 v[156:157], v13 offset:12288
 ds_read_b64_tr_b16 v[158:159], v13 offset:13056
 v_add_u32 v13, 73728, v14
 ds_read_b64_tr_b16 v[160:161], v13 offset:0
 ds_read_b64_tr_b16 v[162:163], v13 offset:768
 ds_read_b64_tr_b16 v[164:165], v13 offset:12288
 ds_read_b64_tr_b16 v[166:167], v13 offset:13056
 v_add_u32 v13, 73728, v15
 ds_read_b64_tr_b16 v[168:169], v13 offset:0
 ds_read_b64_tr_b16 v[170:171], v13 offset:768
 ds_read_b64_tr_b16 v[172:173], v13 offset:12288
 ds_read_b64_tr_b16 v[174:175], v13 offset:13056
 s_waitcnt vmcnt(18) lgkmcnt(0)
 s_barrier
 v_add_u32 v13, 98304, v12
 ds_read_b64_tr_b16 v[176:177], v13 offset:0
 ds_read_b64_tr_b16 v[178:179], v13 offset:768
 ds_read_b64_tr_b16 v[180:181], v13 offset:12288
 ds_read_b64_tr_b16 v[182:183], v13 offset:13056
 v_add_u32 v13, 98304, v14
 ds_read_b64_tr_b16 v[184:185], v13 offset:0
 ds_read_b64_tr_b16 v[186:187], v13 offset:768
 ds_read_b64_tr_b16 v[188:189], v13 offset:12288
 ds_read_b64_tr_b16 v[190:191], v13 offset:13056
 v_add_u32 v13, 98304, v15
 ds_read_b64_tr_b16 v[192:193], v13 offset:0
 ds_read_b64_tr_b16 v[194:195], v13 offset:768
 ds_read_b64_tr_b16 v[196:197], v13 offset:12288
 ds_read_b64_tr_b16 v[198:199], v13 offset:13056
 s_waitcnt vmcnt(12) lgkmcnt(0)
 s_barrier
 v_add_u32 v13, 122880, v12
 ds_read_b64_tr_b16 v[104:105], v13 offset:0
 ds_read_b64_tr_b16 v[106:107], v13 offset:768
 ds_read_b64_tr_b16 v[108:109], v13 offset:12288
 ds_read_b64_tr_b16 v[110:111], v13 offset:13056
 v_add_u32 v13, 122880, v14
 ds_read_b64_tr_b16 v[200:201], v13 offset:0
 ds_read_b64_tr_b16 v[202:203], v13 offset:768
 ds_read_b64_tr_b16 v[204:205], v13 offset:12288
 ds_read_b64_tr_b16 v[206:207], v13 offset:13056
 v_add_u32 v13, 122880, v15
 ds_read_b64_tr_b16 v[208:209], v13 offset:0
 ds_read_b64_tr_b16 v[210:211], v13 offset:768
 ds_read_b64_tr_b16 v[212:213], v13 offset:12288
 ds_read_b64_tr_b16 v[214:215], v13 offset:13056
 s_waitcnt vmcnt(6) lgkmcnt(0)
 s_barrier
 v_add_u32 v13, 0, v12
 ds_read_b64_tr_b16 v[216:217], v13 offset:0
 ds_read_b64_tr_b16 v[218:219], v13 offset:768
 ds_read_b64_tr_b16 v[220:221], v13 offset:12288
 ds_read_b64_tr_b16 v[222:223], v13 offset:13056
 v_add_u32 v13, 0, v14
 ds_read_b64_tr_b16 v[80:81], v13 offset:0
 ds_read_b64_tr_b16 v[82:83], v13 offset:768
 ds_read_b64_tr_b16 v[84:85], v13 offset:12288
 ds_read_b64_tr_b16 v[86:87], v13 offset:13056
 v_add_u32 v13, 0, v15
 ds_read_b64_tr_b16 v[224:225], v13 offset:0
 ds_read_b64_tr_b16 v[226:227], v13 offset:768
 ds_read_b64_tr_b16 v[228:229], v13 offset:12288
 ds_read_b64_tr_b16 v[230:231], v13 offset:13056
 s_waitcnt vmcnt(0) lgkmcnt(0)
 s_barrier
 v_add_u32 v13, 24576, v12
 ds_read_b64_tr_b16 v[232:233], v13 offset:0
 ds_read_b64_tr_b16 v[234:235], v13 offset:768
 ds_read_b64_tr_b16 v[236:237], v13 offset:12288
 ds_read_b64_tr_b16 v[238:239], v13 offset:13056
 v_add_u32 v13, 24576, v14
 ds_read_b64_tr_b16 v[240:241], v13 offset:0
 ds_read_b64_tr_b16 v[242:243], v13 offset:768
 ds_read_b64_tr_b16 v[244:245], v13 offset:12288
 ds_read_b64_tr_b16 v[246:247], v13 offset:13056
 v_add_u32 v13, 24576, v15
 ds_read_b64_tr_b16 v[248:249], v13 offset:0
 ds_read_b64_tr_b16 v[250:251], v13 offset:768
 ds_read_b64_tr_b16 v[252:253], v13 offset:12288
 ds_read_b64_tr_b16 v[254:255], v13 offset:13056
 s_waitcnt lgkmcnt(0)
 s_barrier
 s_mov_b32 s45, 200000
 v_lshlrev_b32 v7, 3, v4
 s_mov_b32 s28, 6356992
 buffer_load_dwordx2 v[8:9], v7, s[8:11], s28 offen sc1
 s_waitcnt vmcnt(0)
 v_cmp_lt_i32 vcc, v9, v8
 s_and_b32 s19, vcc_lo, 65535
 s_mul_i32 s28, s14, 26624
 s_add_u32 s28, s28, 40960
 v_add_u32 v126, s28, v124
 ds_write_b128 v126, v[16:19] offset:0
 ds_write_b128 v126, v[20:23] offset:1024
 ds_write_b128 v126, v[24:27] offset:2048
 ds_write_b128 v126, v[28:31] offset:3072
 ds_write_b128 v126, v[32:35] offset:4096
 ds_write_b128 v126, v[36:39] offset:5120
 ds_write_b128 v126, v[40:43] offset:6144
 ds_write_b128 v126, v[44:47] offset:7168
 ds_write_b128 v126, v[48:51] offset:8192
 ds_write_b128 v126, v[52:55] offset:9216
 ds_write_b128 v126, v[56:59] offset:10240
 ds_write_b128 v126, v[60:63] offset:11264
 ds_write_b128 v126, v[64:67] offset:12288
 ds_write_b128 v126, v[68:71] offset:13312
 ds_write_b128 v126, v[72:75] offset:14336
 ds_write_b128 v126, v[76:79] offset:15360
 ds_write_b128 v126, v[80:83] offset:16384
 ds_write_b128 v126, v[84:87] offset:17408
 ds_write_b128 v126, v[88:91] offset:18432
 ds_write_b128 v126, v[92:95] offset:19456
 ds_write_b128 v126, v[96:99] offset:20480
 ds_write_b128 v126, v[100:103] offset:21504
 ds_write_b128 v126, v[104:107] offset:22528
 ds_write_b128 v126, v[108:111] offset:23552
 ds_write_b128 v126, v[112:115] offset:24576
 ds_write_b128 v126, v[116:119] offset:25600
 s_waitcnt lgkmcnt(0)
 v_lshrrev_b32 v8, 2, v4
 v_and_b32 v8, 1, v8
 v_lshlrev_b32 v8, 7, v8
 v_lshl_add_u32 v8, v3, 5, v8
 v_lshrrev_b32 v9, 3, v4
 v_lshl_add_u32 v8, v9, 3, v8
 v_and_b32 v9, 3, v4
 v_lshl_add_u32 v8, v9, 1, v8
 s_mul_i32 s28, s14, 768
 s_add_u32 s28, s28, 10240
 v_add_u32 v125, s28, v8
 v_and_b32 v9, 7, v4
 v_lshlrev_b32 v9, 4, v9
 v_lshl_add_u32 v127, v3, 7, v9
 s_and_b32 s28, s14, 2
 s_mul_i32 s28, s28, 3072
 v_add_u32 v130, s28, v124
 v_mov_b32 v10, 0xf149f2ca
 v_mov_b32 v11, 0
 v_cmp_gt_u32 vcc, 2, v3
 s_nop 1
 v_cndmask_b32 v116, v10, v11, vcc
 v_cndmask_b32 v117, v10, v11, vcc
 v_cndmask_b32 v118, v10, v11, vcc
 v_cndmask_b32 v119, v10, v11, vcc
 s_cmp_eq_u32 s14, 0
 s_cbranch_scc1 w0_61
 s_sub_u32 s28, s14, 1
 s_lshl_b32 s28, s28, 4
 v_add_u32 v8, s28, v4
 v_lshrrev_b32 v9, 1, v3
 v_lshlrev_b32 v9, 4, v9
 v_and_b32 v12, 1, v3
 v_lshl_add_u32 v9, v12, 2, v9
 v_add_u32 v13, 0, v9
 v_cmp_le_u32 vcc, v13, v8
 s_nop 1
 v_cndmask_b32 v108, v10, v11, vcc
 v_add_u32 v13, 1, v9
 v_cmp_le_u32 vcc, v13, v8
 s_nop 1
 v_cndmask_b32 v109, v10, v11, vcc
 v_add_u32 v13, 2, v9
 v_cmp_le_u32 vcc, v13, v8
 s_nop 1
 v_cndmask_b32 v110, v10, v11, vcc
 v_add_u32 v13, 3, v9
 v_cmp_le_u32 vcc, v13, v8
 s_nop 1
 v_cndmask_b32 v111, v10, v11, vcc
 v_add_u32 v13, 8, v9
 v_cmp_le_u32 vcc, v13, v8
 s_nop 1
 v_cndmask_b32 v112, v10, v11, vcc
 v_add_u32 v13, 9, v9
 v_cmp_le_u32 vcc, v13, v8
 s_nop 1
 v_cndmask_b32 v113, v10, v11, vcc
 v_add_u32 v13, 10, v9
 v_cmp_le_u32 vcc, v13, v8
 s_nop 1
 v_cndmask_b32 v114, v10, v11, vcc
 v_add_u32 v13, 11, v9
 v_cmp_le_u32 vcc, v13, v8
 s_nop 1
 v_cndmask_b32 v115, v10, v11, vcc
 v_lshrrev_b32 v9, 1, v3
 v_lshlrev_b32 v9, 10, v9
 v_lshl_add_u32 v9, v8, 5, v9
 v_lshl_add_u32 v128, v12, 4, v9
 v_lshlrev_b32 v9, 4, v8
 v_lshl_add_u32 v9, v3, 3, v9
 v_add_u32 v129, 2048, v9
 s_branch wd_62
w0_61:
 v_lshrrev_b32 v8, 3, v4
 v_lshl_add_u32 v128, v8, 3, v127
 v_and_b32 v9, 7, v4
 v_lshlrev_b32 v9, 4, v9
 v_lshl_add_u32 v9, v3, 2, v9
 v_add_u32 v129, 512, v9
 v_mov_b32 v9, 137216
 v_cndmask_b32 v132, v9, v127, s[40:41]
 v_cndmask_b32 v133, v127, v9, s[40:41]
 v_lshrrev_b32 v9, 2, v4
 v_and_b32 v12, 1, v4
 v_lshl_add_u32 v9, v9, 1, v12
 v_lshlrev_b32 v9, 4, v9
 v_lshl_add_u32 v134, v3, 7, v9
 v_cndmask_b32 v112, v10, v11, s[40:41]
 v_cndmask_b32 v113, v10, v11, s[40:41]
 v_mov_b32 v114, 0
 v_mov_b32 v115, 0
 v_mov_b32 v116, 0x3dd53b95
 v_mov_b32 v12, 0
 v_mov_b32 v13, 0
 v_mov_b32 v14, 0
 v_mov_b32 v15, 0
 v_add_u32 v9, 147456, v124
 ds_write_b128 v9, v[12:15]
 ds_write_b128 v9, v[12:15] offset:1024
 ds_write_b128 v9, v[12:15] offset:2048
wd_62:
 s_mov_b32 s44, 0x3dd53b95
 s_mul_i32 s37, s15, 12288
 s_lshl_b32 s50, s12, 20
 s_mul_i32 s28, s13, 10240
 s_add_u32 s50, s50, s28
 s_add_u32 s50, s50, 4194304
 s_mul_i32 s51, s15, 10240
 s_add_u32 s51, s51, 25165824
 v_add_u32 v135, 4096, v120
 s_mul_i32 s38, s13, 640
 s_lshl_b32 s28, s12, 16
 s_add_u32 s38, s38, s28
 s_add_u32 s38, s38, 3407872
 s_mul_i32 s39, s15, 2560
 s_add_u32 s39, s39, 18874368
 s_mul_i32 s48, s12, 655360
 s_add_u32 s48, s48, 96468992
 s_mul_i32 s28, s13, 40
 s_mul_i32 s29, s14, 160
 v_and_b32 v8, 63, v2
 v_add_u32 v8, 0, v8
 v_add_u32 v8, s29, v8
 v_and_b32 v13, 1, v8
 v_lshrrev_b32 v8, 1, v8
 v_mul_u32_u24 v9, 0xccd, v8
 v_lshrrev_b32 v9, 16, v9
 v_mul_u32_u24 v10, 20, v9
 v_sub_u32 v10, v8, v10
 v_cmp_le_u32 vcc, 10, v10
 v_subrev_u32 v11, 10, v10
 s_nop 0
 v_cndmask_b32 v10, v10, v11, vcc
 v_cndmask_b32 v11, 0, 1, vcc
 v_lshl_add_u32 v10, v10, 2, s28
 v_mul_u32_u24 v9, 40960, v9
 v_lshl_add_u32 v9, v11, 10, v9
 v_lshrrev_b32 v11, 5, v10
 v_lshl_add_u32 v9, v11, 11, v9
 v_and_b32 v11, 31, v10
 v_lshl_add_u32 v9, v11, 5, v9
 v_lshl_add_u32 v131, v13, 6, v9
 v_and_b32 v8, 63, v2
 v_add_u32 v8, 64, v8
 v_add_u32 v8, s29, v8
 v_and_b32 v13, 1, v8
 v_lshrrev_b32 v8, 1, v8
 v_mul_u32_u24 v9, 0xccd, v8
 v_lshrrev_b32 v9, 16, v9
 v_mul_u32_u24 v10, 20, v9
 v_sub_u32 v10, v8, v10
 v_cmp_le_u32 vcc, 10, v10
 v_subrev_u32 v11, 10, v10
 s_nop 0
 v_cndmask_b32 v10, v10, v11, vcc
 v_cndmask_b32 v11, 0, 1, vcc
 v_lshl_add_u32 v10, v10, 2, s28
 v_mul_u32_u24 v9, 40960, v9
 v_lshl_add_u32 v9, v11, 10, v9
 v_lshrrev_b32 v11, 5, v10
 v_lshl_add_u32 v9, v11, 11, v9
 v_and_b32 v11, 31, v10
 v_lshl_add_u32 v9, v11, 5, v9
 v_lshl_add_u32 v119, v13, 6, v9
 v_and_b32 v8, 31, v2
 v_add_u32 v8, 128, v8
 v_add_u32 v8, s29, v8
 v_and_b32 v13, 1, v8
 v_lshrrev_b32 v8, 1, v8
 v_mul_u32_u24 v9, 0xccd, v8
 v_lshrrev_b32 v9, 16, v9
 v_mul_u32_u24 v10, 20, v9
 v_sub_u32 v10, v8, v10
 v_cmp_le_u32 vcc, 10, v10
 v_subrev_u32 v11, 10, v10
 s_nop 0
 v_cndmask_b32 v10, v10, v11, vcc
 v_cndmask_b32 v11, 0, 1, vcc
 v_lshl_add_u32 v10, v10, 2, s28
 v_mul_u32_u24 v9, 40960, v9
 v_lshl_add_u32 v9, v11, 10, v9
 v_lshrrev_b32 v11, 5, v10
 v_lshl_add_u32 v9, v11, 11, v9
 v_and_b32 v11, 31, v10
 v_lshl_add_u32 v9, v11, 5, v9
 v_lshl_add_u32 v117, v13, 6, v9
 s_cmp_eq_u32 s14, 3
 s_cbranch_scc0 n3_63
 s_and_b32 s28, s16, 3
 s_cbranch_scc1 fo_65
 s_lshr_b32 s28, s16, 2
 s_lshl_b32 s28, s28, 5
 s_add_u32 s28, s28, s15
 s_lshl_b32 s28, s28, 2
 s_add_u32 s28, s28, 6324224
 v_bfe_u32 v36, v124, 4, 1
 v_lshlrev_b32 v36, 12, v36
fq_64:
 buffer_load_dword v37, v36, s[8:11], s28 offen sc1
 s_waitcnt vmcnt(0)
 v_cmp_gt_u32 vcc, 2, v37
 s_cbranch_vccz fo_65
 s_sub_u32 s45, s45, 1
 s_cbranch_scc0 fq_64
 s_mov_b32 s45, 0
fo_65:
 s_mul_i32 s28, s16, 393216
 s_add_u32 s28, s28, s37
 s_add_u32 s29, s28, 71303168
 s_add_u32 s28, s28, 46137344
 s_mov_b32 m0, 16384
 s_nop 0
 buffer_load_dwordx4 v124, s[8:11], s28 offen sc1 lds
 s_add_u32 s28, s28, 1024
 s_mov_b32 m0, 17408
 s_nop 0
 buffer_load_dwordx4 v124, s[8:11], s28 offen sc1 lds
 s_add_u32 s28, s28, 1024
 s_mov_b32 m0, 18432
 s_nop 0
 buffer_load_dwordx4 v124, s[8:11], s28 offen sc1 lds
 s_add_u32 s28, s28, 1024
 s_mov_b32 m0, 19456
 s_nop 0
 buffer_load_dwordx4 v124, s[8:11], s28 offen sc1 lds
 s_add_u32 s28, s28, 1024
 s_mov_b32 m0, 20480
 s_nop 0
 buffer_load_dwordx4 v124, s[8:11], s28 offen sc1 lds
 s_add_u32 s28, s28, 1024
 s_mov_b32 m0, 21504
 s_nop 0
 buffer_load_dwordx4 v124, s[8:11], s28 offen sc1 lds
 s_add_u32 s28, s28, 1024
 s_mov_b32 m0, 22528
 s_nop 0
 buffer_load_dwordx4 v124, s[8:11], s28 offen sc1 lds
 s_add_u32 s28, s28, 1024
 s_mov_b32 m0, 23552
 s_nop 0
 buffer_load_dwordx4 v124, s[8:11], s28 offen sc1 lds
 s_add_u32 s28, s28, 1024
 s_mov_b32 m0, 24576
 s_nop 0
 buffer_load_dwordx4 v124, s[8:11], s28 offen sc1 lds
 s_add_u32 s28, s28, 1024
 s_mov_b32 m0, 25600
 s_nop 0
 buffer_load_dwordx4 v124, s[8:11], s28 offen sc1 lds
 s_add_u32 s28, s28, 1024
 s_mov_b32 m0, 26624
 s_nop 0
 buffer_load_dwordx4 v124, s[8:11], s28 offen sc1 lds
 s_add_u32 s28, s28, 1024
 s_mov_b32 m0, 27648
 s_nop 0
 buffer_load_dwordx4 v124, s[8:11], s28 offen sc1 lds
 s_add_u32 s28, s28, 1024
 s_mov_b32 m0, 28672
 s_nop 0
 buffer_load_dwordx4 v124, s[8:11], s29 offen sc1 lds
 s_add_u32 s29, s29, 1024
 s_mov_b32 m0, 29696
 s_nop 0
 buffer_load_dwordx4 v124, s[8:11], s29 offen sc1 lds
 s_add_u32 s29, s29, 1024
 s_mov_b32 m0, 30720
 s_nop 0
 buffer_load_dwordx4 v124, s[8:11], s29 offen sc1 lds
 s_add_u32 s29, s29, 1024
 s_mov_b32 m0, 31744
 s_nop 0
 buffer_load_dwordx4 v124, s[8:11], s29 offen sc1 lds
 s_add_u32 s29, s29, 1024
 s_mov_b32 m0, 32768
 s_nop 0
 buffer_load_dwordx4 v124, s[8:11], s29 offen sc1 lds
 s_add_u32 s29, s29, 1024
 s_mov_b32 m0, 33792
 s_nop 0
 buffer_load_dwordx4 v124, s[8:11], s29 offen sc1 lds
 s_add_u32 s29, s29, 1024
 s_mov_b32 m0, 34816
 s_nop 0
 buffer_load_dwordx4 v124, s[8:11], s29 offen sc1 lds
 s_add_u32 s29, s29, 1024
 s_mov_b32 m0, 35840
 s_nop 0
 buffer_load_dwordx4 v124, s[8:11], s29 offen sc1 lds
 s_add_u32 s29, s29, 1024
 s_mov_b32 m0, 36864
 s_nop 0
 buffer_load_dwordx4 v124, s[8:11], s29 offen sc1 lds
 s_add_u32 s29, s29, 1024
 s_mov_b32 m0, 37888
 s_nop 0
 buffer_load_dwordx4 v124, s[8:11], s29 offen sc1 lds
 s_add_u32 s29, s29, 1024
 s_mov_b32 m0, 38912
 s_nop 0
 buffer_load_dwordx4 v124, s[8:11], s29 offen sc1 lds
 s_add_u32 s29, s29, 1024
 s_mov_b32 m0, 39936
 s_nop 0
 buffer_load_dwordx4 v124, s[8:11], s29 offen sc1 lds
 s_add_u32 s29, s29, 1024
n3_63:
 .p2align 6
Sstep_66:
 s_and_b32 s28, s16, 3
 s_lshl_b32 s29, s28, 1
 s_add_u32 s29, s29, s18
 s_lshr_b32 s17, s19, s29
 s_lshl_b32 s29, s29, 14
 s_add_u32 s29, s29, 180355072
 s_and_b32 s31, s17, 1
 s_lshl_b32 s31, s31, 13
 s_add_u32 s31, s31, s29
 s_and_b32 s17, s17, 2
 s_lshl_b32 s17, s17, 12
 s_add_u32 s17, s17, s29
 s_add_u32 s17, s17, 8192
 s_lshl_b32 s28, s28, 14
 s_add_u32 s30, s28, s36
 s_add_u32 s34, s30, 4096
 s_add_u32 s35, s31, 4096
 v_pk_mov_b32 v[48:49], 0, 0
 v_pk_mov_b32 v[50:51], 0, 0
 v_pk_mov_b32 v[52:53], 0, 0
 v_pk_mov_b32 v[54:55], 0, 0
 v_pk_mov_b32 v[56:57], 0, 0
 v_pk_mov_b32 v[58:59], 0, 0
 v_pk_mov_b32 v[60:61], 0, 0
 v_pk_mov_b32 v[62:63], 0, 0
 v_pk_mov_b32 v[64:65], 0, 0
 v_pk_mov_b32 v[66:67], 0, 0
 v_pk_mov_b32 v[68:69], 0, 0
 v_pk_mov_b32 v[70:71], 0, 0
 s_sub_u32 s49, s16, 1
 s_max_i32 s49, s49, 0
 s_mul_i32 s53, s49, 327680
 s_add_u32 s53, s53, s51
 s_and_b32 s52, s49, 3
 s_lshl_b32 s52, s52, 18
 s_add_u32 s52, s52, s50
 s_add_u32 s54, s16, 2
 s_and_b32 s54, s54, 3
 s_lshl_b32 s54, s54, 18
 s_add_u32 s54, s54, s50
 s_add_u32 s55, s16, 1
 s_min_u32 s55, s55, 63
 s_mul_i32 s55, s55, 1310720
 s_add_u32 s55, s55, s48
 ds_read_b128 v[72:75], v126 offset:0
 ds_read_b128 v[76:79], v126 offset:1024
 ds_read_b128 v[80:83], v126 offset:2048
 ds_read_b128 v[84:87], v126 offset:3072
 ds_read_b128 v[88:91], v126 offset:4096
 ds_read_b128 v[92:95], v126 offset:5120
pl_67:
 buffer_load_dwordx4 v[96:99], v120, s[8:11], s30 offen offset:0 sc1
 buffer_load_dwordx4 v[100:103], v120, s[8:11], s34 offen offset:0 sc1
 buffer_load_dwordx2 v[104:105], v121, s[8:11], s30 offen sc1
 s_waitcnt vmcnt(0)
 v_max3_u32 v0, v96, v100, v104
 v_cmp_eq_u32 vcc, -1, v0
 s_cbranch_vccz ok_71
 s_sub_u32 s45, s45, 1
 s_cbranch_scc0 pl_67
 s_mov_b32 s45, 0
ok_71:
 buffer_load_dwordx4 v[36:39], v120, s[8:11], s31 offen offset:0 sc1
 buffer_load_dwordx4 v[40:43], v120, s[8:11], s35 offen offset:0 sc1
 buffer_load_dwordx2 v[44:45], v121, s[8:11], s17 offen sc1
 v_lshlrev_b32 v16, 16, v96
 v_and_b32 v17, 0xffff0000, v96
 v_lshlrev_b32 v18, 16, v97
 v_and_b32 v19, 0xffff0000, v97
 v_lshlrev_b32 v20, 16, v98
 v_and_b32 v21, 0xffff0000, v98
 v_lshlrev_b32 v22, 16, v99
 v_and_b32 v23, 0xffff0000, v99
 v_lshlrev_b32 v24, 16, v100
 v_and_b32 v25, 0xffff0000, v100
 v_lshlrev_b32 v26, 16, v101
 v_and_b32 v27, 0xffff0000, v101
 v_lshlrev_b32 v28, 16, v102
 v_and_b32 v29, 0xffff0000, v102
 v_lshlrev_b32 v30, 16, v103
 v_and_b32 v31, 0xffff0000, v103
 v_lshlrev_b32 v32, 16, v104
 v_and_b32 v33, 0xffff0000, v104
 v_lshlrev_b32 v34, 16, v105
 v_and_b32 v35, 0xffff0000, v105
 s_branch g_69
pr_68:
 buffer_load_dwordx4 v[36:39], v120, s[8:11], s31 offen offset:0 sc1
 buffer_load_dwordx4 v[40:43], v120, s[8:11], s35 offen offset:0 sc1
 buffer_load_dwordx2 v[44:45], v121, s[8:11], s17 offen sc1
g_69:
 s_waitcnt vmcnt(0)
 v_max3_u32 v0, v36, v40, v44
 v_cmp_eq_u32 vcc, -1, v0
 v_dot2_f32_bf16 v4, v36, s42, v16
 v_dot2_f32_bf16 v5, v36, s43, v17
 v_dot2_f32_bf16 v6, v37, s42, v18
 v_dot2_f32_bf16 v7, v37, s43, v19
 v_dot2_f32_bf16 v8, v38, s42, v20
 v_dot2_f32_bf16 v9, v38, s43, v21
 v_dot2_f32_bf16 v10, v39, s42, v22
 v_dot2_f32_bf16 v11, v39, s43, v23
 s_cbranch_vccz ok_72
 s_sub_u32 s45, s45, 1
 s_cbranch_scc0 pr_68
 s_mov_b32 s45, 0
ok_72:
 v_cvt_pk_bf16_f32 v96, v4, v5
 v_cvt_pk_bf16_f32 v97, v6, v7
 v_cvt_pk_bf16_f32 v98, v8, v9
 v_cvt_pk_bf16_f32 v99, v10, v11
 ds_write_b128 v120, v[96:99] offset:0
 v_dot2_f32_bf16 v24, v40, s42, v24
 v_dot2_f32_bf16 v25, v40, s43, v25
 v_dot2_f32_bf16 v26, v41, s42, v26
 v_dot2_f32_bf16 v27, v41, s43, v27
 v_dot2_f32_bf16 v28, v42, s42, v28
 v_dot2_f32_bf16 v29, v42, s43, v29
 v_dot2_f32_bf16 v30, v43, s42, v30
 v_dot2_f32_bf16 v31, v43, s43, v31
 v_cvt_pk_bf16_f32 v100, v24, v25
 v_cvt_pk_bf16_f32 v101, v26, v27
 v_cvt_pk_bf16_f32 v102, v28, v29
 v_cvt_pk_bf16_f32 v103, v30, v31
 ds_write_b128 v120, v[100:103] offset:4096
 v_dot2_f32_bf16 v32, v44, s42, v32
 v_dot2_f32_bf16 v33, v44, s43, v33
 v_dot2_f32_bf16 v34, v45, s42, v34
 v_dot2_f32_bf16 v35, v45, s43, v35
 s_nop 0
 v_cvt_pk_bf16_f32 v104, v32, v33
 s_nop 0
 v_cvt_pk_bf16_f32 v105, v34, v35
 ds_write_b64 v121, v[104:105]
gs_70:
 s_waitcnt lgkmcnt(0)
 s_barrier
 ds_read_b128 v[0:3], v122 offset:0
 ds_read_b128 v[4:7], v122 offset:1024
 s_waitcnt lgkmcnt(1)
 v_smfmac_f32_16x16x64_bf16 v[48:51], v[0:3], a[0:7], v123
 ds_read_b128 v[8:11], v122 offset:2048
 v_smfmac_f32_16x16x64_bf16 v[52:55], v[0:3], a[8:15], v123
 ds_read_b128 v[12:15], v122 offset:3072
 v_smfmac_f32_16x16x64_bf16 v[56:59], v[0:3], a[16:23], v123
 ds_read_b128 v[16:19], v122 offset:4096
 v_smfmac_f32_16x16x64_bf16 v[60:63], v[0:3], v[72:79], v123
 ds_read_b128 v[72:75], v126 offset:6144
 ds_read_b128 v[76:79], v126 offset:7168
 ds_read_b128 v[20:23], v122 offset:5120
 v_smfmac_f32_16x16x64_bf16 v[64:67], v[0:3], a[24:31], v123
 ds_read_b128 v[24:27], v122 offset:6144
 v_smfmac_f32_16x16x64_bf16 v[68:71], v[0:3], a[32:39], v123
 ds_read_b128 v[28:31], v122 offset:7168
 s_waitcnt lgkmcnt(8)
 v_smfmac_f32_16x16x64_bf16 v[48:51], v[4:7], a[40:47], v123
 ds_read_b128 v[32:35], v122 offset:8192
 v_smfmac_f32_16x16x64_bf16 v[52:55], v[4:7], v[80:87], v123
 ds_read_b128 v[80:83], v126 offset:8192
 ds_read_b128 v[84:87], v126 offset:9216
 ds_read_b128 v[36:39], v122 offset:9216
 v_smfmac_f32_16x16x64_bf16 v[56:59], v[4:7], a[48:55], v123
 v_smfmac_f32_16x16x64_bf16 v[60:63], v[4:7], a[56:63], v123
 buffer_load_dwordx4 v[96:99], v120, s[8:11], s52 offen sc1
 v_smfmac_f32_16x16x64_bf16 v[64:67], v[4:7], a[64:71], v123
 v_smfmac_f32_16x16x64_bf16 v[68:71], v[4:7], v[88:95], v123
 ds_read_b128 v[88:91], v126 offset:10240
 ds_read_b128 v[92:95], v126 offset:11264
 buffer_load_dwordx4 v[100:103], v135, s[8:11], s52 offen sc1
 s_waitcnt lgkmcnt(13)
 v_smfmac_f32_16x16x64_bf16 v[48:51], v[8:11], a[72:79], v123
 v_smfmac_f32_16x16x64_bf16 v[52:55], v[8:11], a[80:87], v123
 buffer_load_dwordx2 v[104:105], v121, s[8:11], s52 offen sc1
 v_smfmac_f32_16x16x64_bf16 v[56:59], v[8:11], a[88:95], v123
 s_waitcnt lgkmcnt(9)
 v_smfmac_f32_16x16x64_bf16 v[60:63], v[8:11], v[72:79], v123
 ds_read_b128 v[72:75], v126 offset:12288
 ds_read_b128 v[76:79], v126 offset:13312
 v_smfmac_f32_16x16x64_bf16 v[64:67], v[8:11], a[96:103], v123
 v_mov_b32 v40, -1
 v_mov_b32 v41, -1
 v_mov_b32 v42, -1
 v_mov_b32 v43, -1
 buffer_store_dwordx4 v[40:43], v120, s[8:11], s54 offen sc1
 v_smfmac_f32_16x16x64_bf16 v[68:71], v[8:11], a[104:111], v123
 v_smfmac_f32_16x16x64_bf16 v[48:51], v[12:15], a[112:119], v123
 s_waitcnt lgkmcnt(5)
 v_smfmac_f32_16x16x64_bf16 v[52:55], v[12:15], v[80:87], v123
 ds_read_b128 v[80:83], v126 offset:14336
 ds_read_b128 v[84:87], v126 offset:15360
 v_smfmac_f32_16x16x64_bf16 v[56:59], v[12:15], a[120:127], v123
 buffer_store_dwordx4 v[40:43], v135, s[8:11], s54 offen sc1
 v_smfmac_f32_16x16x64_bf16 v[60:63], v[12:15], a[128:135], v123
 v_smfmac_f32_16x16x64_bf16 v[64:67], v[12:15], a[136:143], v123
 s_waitcnt lgkmcnt(4)
 v_smfmac_f32_16x16x64_bf16 v[68:71], v[12:15], v[88:95], v123
 ds_read_b128 v[88:91], v126 offset:16384
 ds_read_b128 v[92:95], v126 offset:17408
 v_smfmac_f32_16x16x64_bf16 v[48:51], v[16:19], a[144:151], v123
 ds_read_b128 v[0:3], v124 offset:16384
 buffer_store_dwordx2 v[40:41], v121, s[8:11], s54 offen sc1
 v_smfmac_f32_16x16x64_bf16 v[48:51], v[20:23], a[192:199], v123
 ds_read_b128 v[4:7], v124 offset:17408
 v_smfmac_f32_16x16x64_bf16 v[48:51], v[24:27], a[216:223], v123
 ds_read_b128 v[8:11], v124 offset:18432
 s_waitcnt lgkmcnt(7)
 v_smfmac_f32_16x16x64_bf16 v[48:51], v[28:31], v[72:79], v123
 ds_read_b128 v[72:75], v126 offset:18432
 ds_read_b128 v[76:79], v126 offset:19456
 ds_read_b128 v[12:15], v124 offset:19456
 v_smfmac_f32_16x16x64_bf16 v[48:51], v[32:35], v[176:183], v123
 v_smfmac_f32_16x16x64_bf16 v[48:51], v[36:39], v[216:223], v123
 v_smfmac_f32_16x16x64_bf16 v[52:55], v[16:19], a[152:159], v123
 ds_read_b128 v[40:43], v124 offset:26624
 s_waitcnt lgkmcnt(9)
 v_smfmac_f32_16x16x64_bf16 v[52:55], v[20:23], v[80:87], v123
 ds_read_b128 v[80:83], v126 offset:20480
 ds_read_b128 v[84:87], v126 offset:21504
 ds_read_b128 v[44:47], v124 offset:27648
 v_smfmac_f32_16x16x64_bf16 v[52:55], v[24:27], a[224:231], v123
 v_smfmac_f32_16x16x64_bf16 v[52:55], v[28:31], v[144:151], v123
 v_smfmac_f32_16x16x64_bf16 v[52:55], v[32:35], v[184:191], v123
 s_waitcnt vmcnt(3)
 buffer_store_dwordx4 v[96:99], v120, s[8:11], s53 offen sc1
 s_waitcnt lgkmcnt(10)
 v_smfmac_f32_16x16x64_bf16 v[52:55], v[36:39], v[88:95], v123
 ds_read_b128 v[88:91], v126 offset:22528
 ds_read_b128 v[92:95], v126 offset:23552
 v_smfmac_f32_16x16x64_bf16 v[56:59], v[16:19], a[160:167], v123
 v_smfmac_f32_16x16x64_bf16 v[56:59], v[20:23], a[200:207], v123
 v_pk_add_f32 v[48:49], v[48:49], v[50:51]
 v_cvt_pk_bf16_f32 v49, v48, v49
 v_smfmac_f32_16x16x64_bf16 v[56:59], v[24:27], a[232:239], v123
 ds_write_b16 v125, v49 offset:0
 ds_write_b16_d16_hi v125, v49 offset:16
 s_waitcnt lgkmcnt(9)
 v_smfmac_f32_16x16x64_bf16 v[56:59], v[28:31], v[72:79], v123
 ds_read_b128 v[72:75], v126 offset:24576
 ds_read_b128 v[76:79], v126 offset:25600
 v_smfmac_f32_16x16x64_bf16 v[56:59], v[32:35], v[192:199], v123
 buffer_store_dwordx4 v[100:103], v135, s[8:11], s53 offen sc1
 v_smfmac_f32_16x16x64_bf16 v[56:59], v[36:39], v[224:231], v123
 v_smfmac_f32_16x16x64_bf16 v[60:63], v[16:19], a[168:175], v123
 s_waitcnt lgkmcnt(7)
 v_smfmac_f32_16x16x64_bf16 v[60:63], v[20:23], v[80:87], v123
 v_pk_add_f32 v[52:53], v[52:53], v[54:55]
 v_cvt_pk_bf16_f32 v53, v52, v53
 v_smfmac_f32_16x16x64_bf16 v[60:63], v[24:27], a[240:247], v123
 ds_write_b16 v125, v53 offset:256
 ds_write_b16_d16_hi v125, v53 offset:272
 v_smfmac_f32_16x16x64_bf16 v[60:63], v[28:31], v[152:159], v123
 s_waitcnt lgkmcnt(6)
 v_smfmac_f32_16x16x64_bf16 v[60:63], v[32:35], v[88:95], v123
 buffer_store_dwordx2 v[104:105], v121, s[8:11], s53 offen sc1
 v_smfmac_f32_16x16x64_bf16 v[60:63], v[36:39], v[232:239], v123
 v_smfmac_f32_16x16x64_bf16 v[64:67], v[16:19], a[176:183], v123
 s_waitcnt lgkmcnt(2)
 v_smfmac_f32_16x16x64_bf16 v[64:67], v[20:23], v[72:79], v123
 v_pk_add_f32 v[56:57], v[56:57], v[58:59]
 v_cvt_pk_bf16_f32 v57, v56, v57
 v_smfmac_f32_16x16x64_bf16 v[64:67], v[24:27], a[248:255], v123
 ds_write_b16 v125, v57 offset:512
 ds_write_b16_d16_hi v125, v57 offset:528
 v_smfmac_f32_16x16x64_bf16 v[64:67], v[28:31], v[160:167], v123
 v_smfmac_f32_16x16x64_bf16 v[64:67], v[32:35], v[200:207], v123
 v_smfmac_f32_16x16x64_bf16 v[64:67], v[36:39], v[240:247], v123
 v_smfmac_f32_16x16x64_bf16 v[68:71], v[16:19], a[184:191], v123
 ds_read_b128 v[16:19], v124 offset:20480
 v_smfmac_f32_16x16x64_bf16 v[68:71], v[20:23], a[208:215], v123
 ds_read_b128 v[20:23], v124 offset:21504
 v_pk_add_f32 v[60:61], v[60:61], v[62:63]
 v_cvt_pk_bf16_f32 v61, v60, v61
 v_smfmac_f32_16x16x64_bf16 v[68:71], v[24:27], v[136:143], v123
 ds_read_b128 v[24:27], v124 offset:22528
 ds_write_b16 v125, v61 offset:3072
 ds_write_b16_d16_hi v125, v61 offset:3088
 v_smfmac_f32_16x16x64_bf16 v[68:71], v[28:31], v[168:175], v123
 ds_read_b128 v[28:31], v124 offset:23552
 v_smfmac_f32_16x16x64_bf16 v[68:71], v[32:35], v[208:215], v123
 ds_read_b128 v[32:35], v124 offset:24576
 v_smfmac_f32_16x16x64_bf16 v[68:71], v[36:39], v[248:255], v123
 ds_read_b128 v[36:39], v124 offset:25600
 s_nop 0
 v_pk_add_f32 v[64:65], v[64:65], v[66:67]
 v_cvt_pk_bf16_f32 v65, v64, v65
 ds_write_b16 v125, v65 offset:3328
 ds_write_b16_d16_hi v125, v65 offset:3344
 s_nop 1
 v_pk_add_f32 v[68:69], v[68:69], v[70:71]
 v_cvt_pk_bf16_f32 v69, v68, v69
 ds_write_b16 v125, v69 offset:3584
 ds_write_b16_d16_hi v125, v69 offset:3600
 s_waitcnt lgkmcnt(0)
 s_barrier
 s_cmp_eq_u32 s14, 0
 s_cbranch_scc0 wx_73
 ds_read_b128 v[72:75], v132 offset:10240
 ds_read_b128 v[100:103], v133 offset:10240
 ds_read_b128 v[48:51], v134 offset:13312
 ds_read_b128 v[76:79], v132 offset:10752
 ds_read_b128 v[104:107], v133 offset:10752
 ds_read_b128 v[52:55], v134 offset:13824
 s_and_b32 s28, s16, 3
 s_lshl_b32 s28, s28, 14
 s_add_u32 s32, s28, s38
 s_waitcnt lgkmcnt(5)
 v_mfma_f32_16x16x32_bf16 v[96:99], v[0:3], v[72:75], 0
 ds_read_b128 v[0:3], v133 offset:11264
 s_waitcnt lgkmcnt(5)
 v_mfma_f32_16x16x32_bf16 v[96:99], v[24:27], v[100:103], v[96:99]
 ds_read_b128 v[80:83], v132 offset:11264
 ds_read_b128 v[56:59], v134 offset:14336
 s_waitcnt lgkmcnt(6)
 v_mfma_f32_16x16x32_bf16 v[108:111], v[48:51], v[72:75], v[112:115]
 s_waitcnt lgkmcnt(5)
 v_mfma_f32_16x16x32_bf16 v[96:99], v[4:7], v[76:79], v[96:99]
 ds_read_b128 v[4:7], v133 offset:11776
 s_waitcnt lgkmcnt(5)
 v_mfma_f32_16x16x32_bf16 v[96:99], v[28:31], v[104:107], v[96:99]
 ds_read_b128 v[84:87], v132 offset:11776
 ds_read_b128 v[60:63], v134 offset:14848
 s_waitcnt lgkmcnt(6)
 v_mfma_f32_16x16x32_bf16 v[108:111], v[52:55], v[76:79], v[108:111]
 s_waitcnt lgkmcnt(4)
 v_mfma_f32_16x16x32_bf16 v[96:99], v[8:11], v[80:83], v[96:99]
 ds_read_b128 v[8:11], v133 offset:12288
 v_mfma_f32_16x16x32_bf16 v[96:99], v[32:35], v[0:3], v[96:99]
 ds_read_b128 v[88:91], v132 offset:12288
 ds_read_b128 v[64:67], v134 offset:15360
 s_waitcnt lgkmcnt(6)
 v_mfma_f32_16x16x32_bf16 v[108:111], v[56:59], v[80:83], v[108:111]
 s_waitcnt lgkmcnt(4)
 v_mfma_f32_16x16x32_bf16 v[96:99], v[12:15], v[84:87], v[96:99]
 ds_read_b128 v[12:15], v133 offset:12800
 v_mfma_f32_16x16x32_bf16 v[96:99], v[36:39], v[4:7], v[96:99]
 ds_read_b128 v[92:95], v132 offset:12800
 ds_read_b128 v[68:71], v134 offset:15872
 s_waitcnt lgkmcnt(6)
 v_mfma_f32_16x16x32_bf16 v[108:111], v[60:63], v[84:87], v[108:111]
 s_waitcnt lgkmcnt(4)
 v_mfma_f32_16x16x32_bf16 v[96:99], v[16:19], v[88:91], v[96:99]
 v_mfma_f32_16x16x32_bf16 v[96:99], v[40:43], v[8:11], v[96:99]
 s_waitcnt lgkmcnt(1)
 v_mfma_f32_16x16x32_bf16 v[96:99], v[20:23], v[92:95], v[96:99]
 v_mfma_f32_16x16x32_bf16 v[96:99], v[44:47], v[12:15], v[96:99]
 v_mfma_f32_16x16x32_bf16 v[108:111], v[64:67], v[88:91], v[108:111]
 s_waitcnt lgkmcnt(0)
 v_mfma_f32_16x16x32_bf16 v[108:111], v[68:71], v[92:95], v[108:111]
 s_nop 5
 v_max3_f32 v6, v96, v97, v98
 v_max_f32 v6, v6, v99
 v_max3_f32 v6, v6, v108, v109
 s_nop 1
 v_max_f32_dpp v6, v6, v6 row_ror:8 row_mask:0xf bank_mask:0xf
 v_mov_b32 v7, v6
 s_nop 1
 v_permlane16_swap_b32 v6, v7
 v_max_f32 v6, v6, v7
 v_mov_b32 v7, v6
 s_nop 1
 v_permlane32_swap_b32 v6, v7
 v_max_f32 v6, v6, v7
 v_mul_f32 v6, s44, v6
 v_pk_fma_f32 v[96:97], v[96:97], v[116:117], v[6:7] op_sel_hi:[1,0,0] neg_lo:[0,0,1] neg_hi:[0,0,1]
 v_pk_fma_f32 v[98:99], v[98:99], v[116:117], v[6:7] op_sel_hi:[1,0,0] neg_lo:[0,0,1] neg_hi:[0,0,1]
 v_pk_fma_f32 v[108:109], v[108:109], v[116:117], v[6:7] op_sel_hi:[1,0,0] neg_lo:[0,0,1] neg_hi:[0,0,1]
 v_exp_f32 v96, v96
 v_exp_f32 v97, v97
 v_exp_f32 v98, v98
 v_exp_f32 v99, v99
 v_exp_f32 v108, v108
 v_exp_f32 v109, v109
 v_pk_add_f32 v[6:7], v[96:97], v[98:99]
 v_pk_add_f32 v[6:7], v[6:7], v[108:109]
 v_add_f32 v6, v6, v7
 s_nop 1
 v_add_f32_dpp v6, v6, v6 row_ror:8 row_mask:0xf bank_mask:0xf
 v_mov_b32 v7, v6
 s_nop 1
 v_permlane16_swap_b32 v6, v7
 v_add_f32 v6, v6, v7
 v_mov_b32 v7, v6
 s_nop 1
 v_permlane32_swap_b32 v6, v7
 v_add_f32 v6, v6, v7
 v_rcp_f32 v6, v6
 s_nop 0
 v_pk_mul_f32 v[96:97], v[96:97], v[6:7] op_sel_hi:[1,0]
 v_pk_mul_f32 v[98:99], v[98:99], v[6:7] op_sel_hi:[1,0]
 v_pk_mul_f32 v[108:109], v[108:109], v[6:7] op_sel_hi:[1,0]
 v_cvt_pk_bf16_f32 v8, v96, v97
 v_cvt_pk_bf16_f32 v9, v98, v99
 v_cvt_pk_bf16_f32 v10, v108, v109
 buffer_store_dwordx2 v[8:9], v128, s[8:11], s32 offen sc1
 s_mov_b64 exec, s[40:41]
 buffer_store_dword v10, v129, s[8:11], s32 offen sc1
 s_mov_b64 exec, -1
 s_barrier
 s_branch wend_75
wx_73:
 s_cmp_eq_u32 s14, 3
 s_cbranch_scc1 w3_74
 s_sleep 3
 ds_read_b128 v[72:75], v130 offset:28672
 ds_read_b128 v[48:51], v127 offset:13312
 ds_read_b128 v[76:79], v130 offset:29696
 ds_read_b128 v[52:55], v127 offset:13824
 ds_read_b128 v[80:83], v130 offset:30720
 ds_read_b128 v[56:59], v127 offset:14336
 ds_read_b128 v[84:87], v130 offset:31744
 ds_read_b128 v[60:63], v127 offset:14848
 ds_read_b128 v[88:91], v130 offset:32768
 ds_read_b128 v[64:67], v127 offset:15360
 ds_read_b128 v[92:95], v130 offset:33792
 ds_read_b128 v[68:71], v127 offset:15872
 s_mul_i32 s28, s16, 81920
 s_add_u32 s32, s28, s39
 s_waitcnt lgkmcnt(10)
 v_mfma_f32_16x16x32_bf16 v[96:99], v[0:3], v[72:75], v[108:111]
 v_mfma_f32_16x16x32_bf16 v[100:103], v[24:27], v[72:75], v[112:115]
 v_mfma_f32_16x16x32_bf16 v[104:107], v[48:51], v[72:75], 0
 s_waitcnt lgkmcnt(8)
 v_mfma_f32_16x16x32_bf16 v[96:99], v[4:7], v[76:79], v[96:99]
 v_mfma_f32_16x16x32_bf16 v[100:103], v[28:31], v[76:79], v[100:103]
 v_mfma_f32_16x16x32_bf16 v[104:107], v[52:55], v[76:79], v[104:107]
 s_waitcnt lgkmcnt(6)
 v_mfma_f32_16x16x32_bf16 v[96:99], v[8:11], v[80:83], v[96:99]
 v_mfma_f32_16x16x32_bf16 v[100:103], v[32:35], v[80:83], v[100:103]
 v_mfma_f32_16x16x32_bf16 v[104:107], v[56:59], v[80:83], v[104:107]
 s_waitcnt lgkmcnt(4)
 v_mfma_f32_16x16x32_bf16 v[96:99], v[12:15], v[84:87], v[96:99]
 v_mfma_f32_16x16x32_bf16 v[100:103], v[36:39], v[84:87], v[100:103]
 v_mfma_f32_16x16x32_bf16 v[104:107], v[60:63], v[84:87], v[104:107]
 s_waitcnt lgkmcnt(2)
 v_mfma_f32_16x16x32_bf16 v[96:99], v[16:19], v[88:91], v[96:99]
 v_mfma_f32_16x16x32_bf16 v[100:103], v[40:43], v[88:91], v[100:103]
 v_mfma_f32_16x16x32_bf16 v[104:107], v[64:67], v[88:91], v[104:107]
 s_waitcnt lgkmcnt(0)
 v_mfma_f32_16x16x32_bf16 v[96:99], v[20:23], v[92:95], v[96:99]
 v_mfma_f32_16x16x32_bf16 v[100:103], v[44:47], v[92:95], v[100:103]
 v_mfma_f32_16x16x32_bf16 v[104:107], v[68:71], v[92:95], v[104:107]
 s_barrier
 s_nop 6
 s_nop 1
 v_add_f32 v104, v104, v116
 v_add_f32 v105, v105, v116
 v_add_f32 v106, v106, v116
 v_add_f32 v107, v107, v116
 v_max3_f32 v6, v96, v97, v98
 v_max3_f32 v7, v99, v100, v101
 v_max3_f32 v8, v102, v103, v104
 v_max3_f32 v9, v105, v106, v107
 v_max3_f32 v6, v6, v7, v8
 v_max_f32 v6, v6, v9
 v_mov_b32 v7, v6
 s_nop 1
 v_permlane16_swap_b32 v6, v7
 v_max_f32 v6, v6, v7
 v_mov_b32 v7, v6
 s_nop 1
 v_permlane32_swap_b32 v6, v7
 v_max_f32 v6, v6, v7
 v_mul_f32 v6, s44, v6
 v_fma_f32 v96, v96, s44, -v6
 v_fma_f32 v97, v97, s44, -v6
 v_fma_f32 v98, v98, s44, -v6
 v_fma_f32 v99, v99, s44, -v6
 v_fma_f32 v100, v100, s44, -v6
 v_fma_f32 v101, v101, s44, -v6
 v_fma_f32 v102, v102, s44, -v6
 v_fma_f32 v103, v103, s44, -v6
 v_fma_f32 v104, v104, s44, -v6
 v_fma_f32 v105, v105, s44, -v6
 v_fma_f32 v106, v106, s44, -v6
 v_fma_f32 v107, v107, s44, -v6
 v_exp_f32 v96, v96
 v_exp_f32 v97, v97
 v_exp_f32 v98, v98
 v_exp_f32 v99, v99
 v_exp_f32 v100, v100
 v_exp_f32 v101, v101
 v_exp_f32 v102, v102
 v_exp_f32 v103, v103
 v_exp_f32 v104, v104
 v_exp_f32 v105, v105
 v_exp_f32 v106, v106
 v_exp_f32 v107, v107
 v_add_f32 v6, v96, v97
 v_add_f32 v6, v6, v98
 v_add_f32 v6, v6, v99
 v_add_f32 v6, v6, v100
 v_add_f32 v6, v6, v101
 v_add_f32 v6, v6, v102
 v_add_f32 v6, v6, v103
 v_add_f32 v6, v6, v104
 v_add_f32 v6, v6, v105
 v_add_f32 v6, v6, v106
 v_add_f32 v6, v6, v107
 v_mov_b32 v7, v6
 s_nop 1
 v_permlane16_swap_b32 v6, v7
 v_add_f32 v6, v6, v7
 v_mov_b32 v7, v6
 s_nop 1
 v_permlane32_swap_b32 v6, v7
 v_add_f32 v6, v6, v7
 v_rcp_f32 v6, v6
 s_nop 0
 v_mul_f32 v96, v96, v6
 v_mul_f32 v97, v97, v6
 v_mul_f32 v98, v98, v6
 v_mul_f32 v99, v99, v6
 v_mul_f32 v100, v100, v6
 v_mul_f32 v101, v101, v6
 v_mul_f32 v102, v102, v6
 v_mul_f32 v103, v103, v6
 v_mul_f32 v104, v104, v6
 v_mul_f32 v105, v105, v6
 v_mul_f32 v106, v106, v6
 v_mul_f32 v107, v107, v6
 v_cvt_pk_bf16_f32 v8, v96, v97
 v_cvt_pk_bf16_f32 v9, v98, v99
 v_cvt_pk_bf16_f32 v10, v100, v101
 v_cvt_pk_bf16_f32 v11, v102, v103
 v_cvt_pk_bf16_f32 v12, v104, v105
 v_cvt_pk_bf16_f32 v13, v106, v107
 buffer_store_dwordx4 v[8:11], v128, s[8:11], s32 offen sc1
 s_mov_b32 exec_hi, 0
 buffer_store_dwordx2 v[12:13], v129, s[8:11], s32 offen sc1
 s_mov_b32 exec_hi, -1
 s_branch wend_75
w3_74:
 s_add_u32 s28, s16, 2
 s_and_b32 s28, s28, 3
 s_lshl_b32 s28, s28, 14
 s_add_u32 s28, s28, s38
 v_mov_b32 v0, -1
 v_mov_b32 v1, -1
 v_mov_b32 v2, -1
 v_mov_b32 v3, -1
 s_mov_b32 exec_hi, 0xff
 buffer_store_dwordx4 v[0:3], v124, s[8:11], s28 offen sc1
 s_mov_b32 exec_hi, -1
 s_barrier
 s_add_u32 s33, s16, 1
 s_min_u32 s33, s33, 63
 s_mul_i32 s28, s33, 393216
 s_add_u32 s28, s28, s37
 s_add_u32 s29, s28, 71303168
 s_add_u32 s28, s28, 46137344
 s_mov_b32 m0, 16384
 s_nop 0
 buffer_load_dwordx4 v124, s[8:11], s28 offen sc1 lds
 s_add_u32 s28, s28, 1024
 s_mov_b32 m0, 17408
 s_nop 0
 buffer_load_dwordx4 v124, s[8:11], s28 offen sc1 lds
 s_add_u32 s28, s28, 1024
 s_mov_b32 m0, 18432
 s_nop 0
 buffer_load_dwordx4 v124, s[8:11], s28 offen sc1 lds
 s_add_u32 s28, s28, 1024
 s_mov_b32 m0, 19456
 s_nop 0
 buffer_load_dwordx4 v124, s[8:11], s28 offen sc1 lds
 s_add_u32 s28, s28, 1024
 s_mov_b32 m0, 20480
 s_nop 0
 buffer_load_dwordx4 v124, s[8:11], s28 offen sc1 lds
 s_add_u32 s28, s28, 1024
 s_mov_b32 m0, 21504
 s_nop 0
 buffer_load_dwordx4 v124, s[8:11], s28 offen sc1 lds
 s_add_u32 s28, s28, 1024
 s_mov_b32 m0, 22528
 s_nop 0
 buffer_load_dwordx4 v124, s[8:11], s28 offen sc1 lds
 s_add_u32 s28, s28, 1024
 s_mov_b32 m0, 23552
 s_nop 0
 buffer_load_dwordx4 v124, s[8:11], s28 offen sc1 lds
 s_add_u32 s28, s28, 1024
 s_mov_b32 m0, 24576
 s_nop 0
 buffer_load_dwordx4 v124, s[8:11], s28 offen sc1 lds
 s_add_u32 s28, s28, 1024
 s_mov_b32 m0, 25600
 s_nop 0
 buffer_load_dwordx4 v124, s[8:11], s28 offen sc1 lds
 s_add_u32 s28, s28, 1024
 s_mov_b32 m0, 26624
 s_nop 0
 buffer_load_dwordx4 v124, s[8:11], s28 offen sc1 lds
 s_add_u32 s28, s28, 1024
 s_mov_b32 m0, 27648
 s_nop 0
 buffer_load_dwordx4 v124, s[8:11], s28 offen sc1 lds
 s_add_u32 s28, s28, 1024
 s_mov_b32 m0, 28672
 s_nop 0
 buffer_load_dwordx4 v124, s[8:11], s29 offen sc1 lds
 s_add_u32 s29, s29, 1024
 s_mov_b32 m0, 29696
 s_nop 0
 buffer_load_dwordx4 v124, s[8:11], s29 offen sc1 lds
 s_add_u32 s29, s29, 1024
 s_mov_b32 m0, 30720
 s_nop 0
 buffer_load_dwordx4 v124, s[8:11], s29 offen sc1 lds
 s_add_u32 s29, s29, 1024
 s_mov_b32 m0, 31744
 s_nop 0
 buffer_load_dwordx4 v124, s[8:11], s29 offen sc1 lds
 s_add_u32 s29, s29, 1024
 s_mov_b32 m0, 32768
 s_nop 0
 buffer_load_dwordx4 v124, s[8:11], s29 offen sc1 lds
 s_add_u32 s29, s29, 1024
 s_mov_b32 m0, 33792
 s_nop 0
 buffer_load_dwordx4 v124, s[8:11], s29 offen sc1 lds
 s_add_u32 s29, s29, 1024
 s_mov_b32 m0, 34816
 s_nop 0
 buffer_load_dwordx4 v124, s[8:11], s29 offen sc1 lds
 s_add_u32 s29, s29, 1024
 s_mov_b32 m0, 35840
 s_nop 0
 buffer_load_dwordx4 v124, s[8:11], s29 offen sc1 lds
 s_add_u32 s29, s29, 1024
 s_mov_b32 m0, 36864
 s_nop 0
 buffer_load_dwordx4 v124, s[8:11], s29 offen sc1 lds
 s_add_u32 s29, s29, 1024
 s_mov_b32 m0, 37888
 s_nop 0
 buffer_load_dwordx4 v124, s[8:11], s29 offen sc1 lds
 s_add_u32 s29, s29, 1024
 s_mov_b32 m0, 38912
 s_nop 0
 buffer_load_dwordx4 v124, s[8:11], s29 offen sc1 lds
 s_add_u32 s29, s29, 1024
 s_mov_b32 m0, 39936
 s_nop 0
 buffer_load_dwordx4 v124, s[8:11], s29 offen sc1 lds
 s_add_u32 s29, s29, 1024
 s_cmp_lt_u32 s16, 2
 s_cbranch_scc1 nf_77
 s_sub_u32 s29, s16, 2
 s_lshl_b32 s28, s29, 7
 s_add_u32 s28, s28, 6291456
 s_mov_b64 exec, 1
 v_mov_b32 v104, 0
 v_mov_b32 v105, 1
 buffer_atomic_add v105, v104, s[8:11], s28 offen sc1
 s_mov_b64 exec, -1
nf_77:
 s_add_u32 s33, s16, 2
 s_min_u32 s33, s33, 63
 s_and_b32 s28, s33, 3
 s_cbranch_scc1 fo_79
 s_lshr_b32 s28, s33, 2
 s_lshl_b32 s28, s28, 5
 s_add_u32 s28, s28, s15
 s_lshl_b32 s28, s28, 2
 s_add_u32 s28, s28, 6324224
 v_bfe_u32 v36, v124, 4, 1
 v_lshlrev_b32 v36, 12, v36
fq_78:
 buffer_load_dword v37, v36, s[8:11], s28 offen sc1
 s_waitcnt vmcnt(0)
 v_cmp_gt_u32 vcc, 2, v37
 s_cbranch_vccz fo_79
 s_sub_u32 s45, s45, 1
 s_cbranch_scc0 fq_78
 s_mov_b32 s45, 0
fo_79:
 s_branch w4_76
wend_75:
w4_76:
 s_add_u32 s16, s16, 1
 s_cmp_lt_u32 s16, 64
 s_cbranch_scc1 Sstep_66
 s_waitcnt vmcnt(0)
 s_barrier
 s_cmp_eq_u32 s14, 3
 s_cbranch_scc0 e3_80
 s_mov_b32 s29, 62
 s_lshl_b32 s28, s29, 7
 s_add_u32 s28, s28, 6291456
 s_mov_b64 exec, 1
 v_mov_b32 v104, 0
 v_mov_b32 v105, 1
 buffer_atomic_add v105, v104, s[8:11], s28 offen sc1
 s_mov_b64 exec, -1
rt_81:
 s_mov_b32 s49, 63
 s_and_b32 s28, s49, 3
 s_lshl_b32 s28, s28, 18
 s_add_u32 s28, s28, s50
 buffer_load_dwordx4 v[8:11], v124, s[8:11], s28 offen offset:0 sc1
 buffer_load_dwordx4 v[12:15], v124, s[8:11], s28 offen offset:1024 sc1
 buffer_load_dwordx4 v[16:19], v124, s[8:11], s28 offen offset:2048 sc1
 buffer_load_dwordx4 v[20:23], v124, s[8:11], s28 offen offset:3072 sc1
 s_add_u32 s28, s28, 4096
 buffer_load_dwordx4 v[24:27], v124, s[8:11], s28 offen offset:0 sc1
 buffer_load_dwordx4 v[28:31], v124, s[8:11], s28 offen offset:1024 sc1
 buffer_load_dwordx4 v[32:35], v124, s[8:11], s28 offen offset:2048 sc1
 buffer_load_dwordx4 v[36:39], v124, s[8:11], s28 offen offset:3072 sc1
 s_add_u32 s28, s28, 4096
 buffer_load_dwordx4 v[40:43], v124, s[8:11], s28 offen offset:0 sc1
 buffer_load_dwordx4 v[44:47], v124, s[8:11], s28 offen offset:1024 sc1
 s_waitcnt vmcnt(0)
 v_max3_u32 v0, v8, v12, v16
 v_max3_u32 v1, v20, v24, v28
 v_max3_u32 v2, v32, v36, v40
 v_max3_u32 v3, v44, v0, v1
 v_max_u32 v4, v2, v3
 v_cmp_eq_u32 vcc, -1, v4
 s_cbranch_vccz ok_82
 s_sub_u32 s45, s45, 1
 s_cbranch_scc0 rt_81
 s_mov_b32 s45, 0
ok_82:
 s_mul_i32 s28, s49, 327680
 s_add_u32 s28, s28, s51
 buffer_store_dwordx4 v[8:11], v124, s[8:11], s28 offen offset:0 sc1
 buffer_store_dwordx4 v[12:15], v124, s[8:11], s28 offen offset:1024 sc1
 buffer_store_dwordx4 v[16:19], v124, s[8:11], s28 offen offset:2048 sc1
 buffer_store_dwordx4 v[20:23], v124, s[8:11], s28 offen offset:3072 sc1
 s_add_u32 s28, s28, 4096
 buffer_store_dwordx4 v[24:27], v124, s[8:11], s28 offen offset:0 sc1
 buffer_store_dwordx4 v[28:31], v124, s[8:11], s28 offen offset:1024 sc1
 buffer_store_dwordx4 v[32:35], v124, s[8:11], s28 offen offset:2048 sc1
 buffer_store_dwordx4 v[36:39], v124, s[8:11], s28 offen offset:3072 sc1
 s_add_u32 s28, s28, 4096
 buffer_store_dwordx4 v[40:43], v124, s[8:11], s28 offen offset:0 sc1
 buffer_store_dwordx4 v[44:47], v124, s[8:11], s28 offen offset:1024 sc1
 s_waitcnt vmcnt(0)
 s_mov_b32 s29, 63
 s_lshl_b32 s28, s29, 7
 s_add_u32 s28, s28, 6291456
 s_mov_b64 exec, 1
 v_mov_b32 v104, 0
 v_mov_b32 v105, 1
 buffer_atomic_add v105, v104, s[8:11], s28 offen sc1
 s_mov_b64 exec, -1
e3_80:
 s_mov_b32 s46, s13
 s_endpgm
role_V_slow2:
 v_lshlrev_b32 v148, 4, v0
 v_add_u32 v1, 1024, v0
 v_lshlrev_b32 v149, 3, v1
 v_and_b32 v2, 63, v0
 v_lshlrev_b32 v152, 4, v2
 v_lshrrev_b32 v3, 4, v2
 v_and_b32 v4, 15, v2
 v_bfe_u32 v5, v4, 1, 1
 v_lshrrev_b32 v6, 2, v4
 v_and_b32 v7, 1, v4
 v_lshl_add_u32 v6, v6, 1, v7
 v_lshlrev_b32 v150, 8, v3
 v_lshl_add_u32 v150, v5, 7, v150
 v_lshl_add_u32 v150, v6, 4, v150
 v_mov_b32 v151, 0x4444
 v_mov_b32 v7, 0xeeee
 v_cmp_eq_u32 vcc, 1, v5
 s_nop 1
 v_cndmask_b32 v151, v151, v7, vcc
 s_mov_b32 s42, 0x00003f80
 s_mov_b32 s43, 0x3f800000
 s_mov_b32 s40, 0x00ff00ff
 s_mov_b32 s41, 0x00ff00ff
 s_mov_b32 s45, 200000
 s_lshl_b32 s36, s12, 16
 s_add_u32 s36, s36, 3145728
 s_lshl_b32 s18, s12, 3
 s_lshl_b32 s46, s12, 7
 s_add_u32 s46, s46, 6344704
 s_mov_b32 s16, 0
 s_mul_i32 s28, s14, 384
 s_add_u32 s28, s28, 0
 v_add_u32 v8, s28, v2
 v_mul_u32_u24 v9, 0xaaab, v8
 v_lshrrev_b32 v9, 20, v9
 v_mul_u32_u24 v10, 24, v9
 v_sub_u32 v10, v8, v10
 v_bfe_u32 v11, v9, 2, 2
 v_lshlrev_b32 v11, 1, v11
 v_xor_b32 v10, v10, v11
 v_mul_u32_u24 v9, 12288, v9
 v_lshl_add_u32 v153, v10, 4, v9
 s_mul_i32 s28, s14, 384
 s_add_u32 s28, s28, 64
 v_add_u32 v8, s28, v2
 v_mul_u32_u24 v9, 0xaaab, v8
 v_lshrrev_b32 v9, 20, v9
 v_mul_u32_u24 v10, 24, v9
 v_sub_u32 v10, v8, v10
 v_bfe_u32 v11, v9, 2, 2
 v_lshlrev_b32 v11, 1, v11
 v_xor_b32 v10, v10, v11
 v_mul_u32_u24 v9, 12288, v9
 v_lshl_add_u32 v154, v10, 4, v9
 s_mul_i32 s28, s14, 384
 s_add_u32 s28, s28, 128
 v_add_u32 v8, s28, v2
 v_mul_u32_u24 v9, 0xaaab, v8
 v_lshrrev_b32 v9, 20, v9
 v_mul_u32_u24 v10, 24, v9
 v_sub_u32 v10, v8, v10
 v_bfe_u32 v11, v9, 2, 2
 v_lshlrev_b32 v11, 1, v11
 v_xor_b32 v10, v10, v11
 v_mul_u32_u24 v9, 12288, v9
 v_lshl_add_u32 v155, v10, 4, v9
 s_mul_i32 s28, s14, 384
 s_add_u32 s28, s28, 192
 v_add_u32 v8, s28, v2
 v_mul_u32_u24 v9, 0xaaab, v8
 v_lshrrev_b32 v9, 20, v9
 v_mul_u32_u24 v10, 24, v9
 v_sub_u32 v10, v8, v10
 v_bfe_u32 v11, v9, 2, 2
 v_lshlrev_b32 v11, 1, v11
 v_xor_b32 v10, v10, v11
 v_mul_u32_u24 v9, 12288, v9
 v_lshl_add_u32 v156, v10, 4, v9
 s_mul_i32 s28, s14, 384
 s_add_u32 s28, s28, 256
 v_add_u32 v8, s28, v2
 v_mul_u32_u24 v9, 0xaaab, v8
 v_lshrrev_b32 v9, 20, v9
 v_mul_u32_u24 v10, 24, v9
 v_sub_u32 v10, v8, v10
 v_bfe_u32 v11, v9, 2, 2
 v_lshlrev_b32 v11, 1, v11
 v_xor_b32 v10, v10, v11
 v_mul_u32_u24 v9, 12288, v9
 v_lshl_add_u32 v157, v10, 4, v9
 s_mul_i32 s28, s14, 384
 s_add_u32 s28, s28, 320
 v_add_u32 v8, s28, v2
 v_mul_u32_u24 v9, 0xaaab, v8
 v_lshrrev_b32 v9, 20, v9
 v_mul_u32_u24 v10, 24, v9
 v_sub_u32 v10, v8, v10
 v_bfe_u32 v11, v9, 2, 2
 v_lshlrev_b32 v11, 1, v11
 v_xor_b32 v10, v10, v11
 v_mul_u32_u24 v9, 12288, v9
 v_lshl_add_u32 v158, v10, 4, v9
 v_lshrrev_b32 v8, 1, v3
 v_lshlrev_b32 v8, 4, v8
 v_and_b32 v9, 1, v3
 v_lshl_add_u32 v8, v9, 2, v8
 v_lshrrev_b32 v9, 2, v4
 v_and_b32 v10, 1, v9
 v_add_u32 v8, v8, v10
 v_lshrrev_b32 v11, 1, v9
 v_lshl_add_u32 v8, v11, 3, v8
 v_bfe_u32 v11, v8, 2, 2
 v_mul_u32_u24 v8, 384, v8
 v_and_b32 v9, 3, v2
 v_lshl_add_u32 v8, v9, 3, v8
 s_mul_i32 s28, s14, 3
 s_add_u32 s28, s28, 0
 v_xor_b32 v9, s28, v11
 v_lshl_add_u32 v163, v9, 5, v8
 s_mul_i32 s28, s14, 3
 s_add_u32 s28, s28, 1
 v_xor_b32 v9, s28, v11
 v_lshl_add_u32 v164, v9, 5, v8
 s_mul_i32 s28, s14, 3
 s_add_u32 s28, s28, 2
 v_xor_b32 v9, s28, v11
 v_lshl_add_u32 v165, v9, 5, v8
 v_lshrrev_b32 v8, 1, v3
 v_lshlrev_b32 v8, 4, v8
 v_and_b32 v9, 1, v3
 v_lshl_add_u32 v8, v9, 2, v8
 v_lshrrev_b32 v9, 2, v4
 v_and_b32 v10, 1, v9
 v_add_u32 v8, v8, v10
 v_lshrrev_b32 v11, 1, v9
 v_lshl_add_u32 v8, v11, 3, v8
 v_bfe_u32 v11, v8, 2, 2
 v_lshl_add_u32 v11, v11, 1, v10
 v_mul_u32_u24 v8, 256, v8
 v_and_b32 v9, 3, v2
 v_lshl_add_u32 v8, v9, 3, v8
 s_mul_i32 s28, s14, 2
 s_add_u32 s28, s28, 0
 v_xor_b32 v9, s28, v11
 v_lshl_add_u32 v166, v9, 5, v8
 s_mul_i32 s28, s14, 2
 s_add_u32 s28, s28, 1
 v_xor_b32 v9, s28, v11
 v_lshl_add_u32 v5, v9, 5, v8
 s_lshl_b32 s28, s14, 4
 s_add_u32 s28, s28, 0
 v_add_u32 v8, s28, v3
 v_mul_u32_u24 v8, 1280, v8
 v_and_b32 v9, 1, v3
 v_or_b32 v9, 0, v9
 v_lshlrev_b32 v9, 1, v9
 v_xor_b32 v9, v9, v4
 v_lshl_add_u32 v159, v9, 4, v8
 s_lshl_b32 s28, s14, 4
 s_add_u32 s28, s28, 4
 v_add_u32 v8, s28, v3
 v_mul_u32_u24 v8, 1280, v8
 v_and_b32 v9, 1, v3
 v_or_b32 v9, 2, v9
 v_lshlrev_b32 v9, 1, v9
 v_xor_b32 v9, v9, v4
 v_lshl_add_u32 v160, v9, 4, v8
 s_lshl_b32 s28, s14, 4
 s_add_u32 s28, s28, 8
 v_add_u32 v8, s28, v3
 v_mul_u32_u24 v8, 1280, v8
 v_and_b32 v9, 1, v3
 v_or_b32 v9, 4, v9
 v_lshlrev_b32 v9, 1, v9
 v_xor_b32 v9, v9, v4
 v_lshl_add_u32 v161, v9, 4, v8
 s_lshl_b32 s28, s14, 4
 s_add_u32 s28, s28, 12
 v_add_u32 v8, s28, v3
 v_mul_u32_u24 v8, 1280, v8
 v_and_b32 v9, 1, v3
 v_or_b32 v9, 6, v9
 v_lshlrev_b32 v9, 1, v9
 v_xor_b32 v9, v9, v4
 v_lshl_add_u32 v162, v9, 4, v8
 s_mul_i32 s47, s15, 384
 s_mul_i32 s48, s15, 245760
 s_mul_i32 s28, s14, 6144
 s_add_u32 m0, s28, 0
 s_add_u32 s29, s47, 0
 buffer_load_dwordx4 v153, s[20:23], s29 offen lds
 s_mul_i32 s28, s14, 6144
 s_add_u32 m0, s28, 1024
 s_add_u32 s29, s47, 0
 buffer_load_dwordx4 v154, s[20:23], s29 offen lds
 s_mul_i32 s28, s14, 6144
 s_add_u32 m0, s28, 2048
 s_add_u32 s29, s47, 0
 buffer_load_dwordx4 v155, s[20:23], s29 offen lds
 s_mul_i32 s28, s14, 6144
 s_add_u32 m0, s28, 3072
 s_add_u32 s29, s47, 0
 buffer_load_dwordx4 v156, s[20:23], s29 offen lds
 s_mul_i32 s28, s14, 6144
 s_add_u32 m0, s28, 4096
 s_add_u32 s29, s47, 0
 buffer_load_dwordx4 v157, s[20:23], s29 offen lds
 s_mul_i32 s28, s14, 6144
 s_add_u32 m0, s28, 5120
 s_add_u32 s29, s47, 0
 buffer_load_dwordx4 v158, s[20:23], s29 offen lds
 s_mul_i32 s28, s14, 6144
 s_add_u32 m0, s28, 24576
 s_add_u32 s29, s47, 786432
 buffer_load_dwordx4 v153, s[20:23], s29 offen lds
 s_mul_i32 s28, s14, 6144
 s_add_u32 m0, s28, 25600
 s_add_u32 s29, s47, 786432
 buffer_load_dwordx4 v154, s[20:23], s29 offen lds
 s_mul_i32 s28, s14, 6144
 s_add_u32 m0, s28, 26624
 s_add_u32 s29, s47, 786432
 buffer_load_dwordx4 v155, s[20:23], s29 offen lds
 s_mul_i32 s28, s14, 6144
 s_add_u32 m0, s28, 27648
 s_add_u32 s29, s47, 786432
 buffer_load_dwordx4 v156, s[20:23], s29 offen lds
 s_mul_i32 s28, s14, 6144
 s_add_u32 m0, s28, 28672
 s_add_u32 s29, s47, 786432
 buffer_load_dwordx4 v157, s[20:23], s29 offen lds
 s_mul_i32 s28, s14, 6144
 s_add_u32 m0, s28, 29696
 s_add_u32 s29, s47, 786432
 buffer_load_dwordx4 v158, s[20:23], s29 offen lds
 s_mul_i32 s28, s14, 6144
 s_add_u32 m0, s28, 49152
 s_add_u32 s29, s47, 1572864
 buffer_load_dwordx4 v153, s[20:23], s29 offen lds
 s_mul_i32 s28, s14, 6144
 s_add_u32 m0, s28, 50176
 s_add_u32 s29, s47, 1572864
 buffer_load_dwordx4 v154, s[20:23], s29 offen lds
 s_mul_i32 s28, s14, 6144
 s_add_u32 m0, s28, 51200
 s_add_u32 s29, s47, 1572864
 buffer_load_dwordx4 v155, s[20:23], s29 offen lds
 s_mul_i32 s28, s14, 6144
 s_add_u32 m0, s28, 52224
 s_add_u32 s29, s47, 1572864
 buffer_load_dwordx4 v156, s[20:23], s29 offen lds
 s_mul_i32 s28, s14, 6144
 s_add_u32 m0, s28, 53248
 s_add_u32 s29, s47, 1572864
 buffer_load_dwordx4 v157, s[20:23], s29 offen lds
 s_mul_i32 s28, s14, 6144
 s_add_u32 m0, s28, 54272
 s_add_u32 s29, s47, 1572864
 buffer_load_dwordx4 v158, s[20:23], s29 offen lds
 s_mul_i32 s28, s14, 6144
 s_add_u32 m0, s28, 73728
 s_add_u32 s29, s47, 2359296
 buffer_load_dwordx4 v153, s[20:23], s29 offen lds
 s_mul_i32 s28, s14, 6144
 s_add_u32 m0, s28, 74752
 s_add_u32 s29, s47, 2359296
 buffer_load_dwordx4 v154, s[20:23], s29 offen lds
 s_mul_i32 s28, s14, 6144
 s_add_u32 m0, s28, 75776
 s_add_u32 s29, s47, 2359296
 buffer_load_dwordx4 v155, s[20:23], s29 offen lds
 s_mul_i32 s28, s14, 6144
 s_add_u32 m0, s28, 76800
 s_add_u32 s29, s47, 2359296
 buffer_load_dwordx4 v156, s[20:23], s29 offen lds
 s_mul_i32 s28, s14, 6144
 s_add_u32 m0, s28, 77824
 s_add_u32 s29, s47, 2359296
 buffer_load_dwordx4 v157, s[20:23], s29 offen lds
 s_mul_i32 s28, s14, 6144
 s_add_u32 m0, s28, 78848
 s_add_u32 s29, s47, 2359296
 buffer_load_dwordx4 v158, s[20:23], s29 offen lds
 s_mul_i32 s28, s14, 6144
 s_add_u32 m0, s28, 98304
 s_add_u32 s29, s47, 3145728
 buffer_load_dwordx4 v153, s[20:23], s29 offen lds
 s_mul_i32 s28, s14, 6144
 s_add_u32 m0, s28, 99328
 s_add_u32 s29, s47, 3145728
 buffer_load_dwordx4 v154, s[20:23], s29 offen lds
 s_mul_i32 s28, s14, 6144
 s_add_u32 m0, s28, 100352
 s_add_u32 s29, s47, 3145728
 buffer_load_dwordx4 v155, s[20:23], s29 offen lds
 s_mul_i32 s28, s14, 6144
 s_add_u32 m0, s28, 101376
 s_add_u32 s29, s47, 3145728
 buffer_load_dwordx4 v156, s[20:23], s29 offen lds
 s_mul_i32 s28, s14, 6144
 s_add_u32 m0, s28, 102400
 s_add_u32 s29, s47, 3145728
 buffer_load_dwordx4 v157, s[20:23], s29 offen lds
 s_mul_i32 s28, s14, 6144
 s_add_u32 m0, s28, 103424
 s_add_u32 s29, s47, 3145728
 buffer_load_dwordx4 v158, s[20:23], s29 offen lds
 s_waitcnt vmcnt(24) lgkmcnt(0)
 s_barrier
 s_mul_i32 s28, s14, 6144
 s_add_u32 m0, s28, 122880
 s_add_u32 s29, s47, 3932160
 buffer_load_dwordx4 v153, s[20:23], s29 offen lds
 s_mul_i32 s28, s14, 6144
 s_add_u32 m0, s28, 123904
 s_add_u32 s29, s47, 3932160
 buffer_load_dwordx4 v154, s[20:23], s29 offen lds
 s_mul_i32 s28, s14, 6144
 s_add_u32 m0, s28, 124928
 s_add_u32 s29, s47, 3932160
 buffer_load_dwordx4 v155, s[20:23], s29 offen lds
 s_mul_i32 s28, s14, 6144
 s_add_u32 m0, s28, 125952
 s_add_u32 s29, s47, 3932160
 buffer_load_dwordx4 v156, s[20:23], s29 offen lds
 s_mul_i32 s28, s14, 6144
 s_add_u32 m0, s28, 126976
 s_add_u32 s29, s47, 3932160
 buffer_load_dwordx4 v157, s[20:23], s29 offen lds
 s_mul_i32 s28, s14, 6144
 s_add_u32 m0, s28, 128000
 s_add_u32 s29, s47, 3932160
 buffer_load_dwordx4 v158, s[20:23], s29 offen lds
 v_add_u32 v167, 0, v163
 ds_read_b64_tr_b16 a[0:1], v167 offset:0
 ds_read_b64_tr_b16 a[2:3], v167 offset:768
 ds_read_b64_tr_b16 a[4:5], v167 offset:12288
 ds_read_b64_tr_b16 a[6:7], v167 offset:13056
 v_add_u32 v167, 0, v164
 ds_read_b64_tr_b16 a[8:9], v167 offset:0
 ds_read_b64_tr_b16 a[10:11], v167 offset:768
 ds_read_b64_tr_b16 a[12:13], v167 offset:12288
 ds_read_b64_tr_b16 a[14:15], v167 offset:13056
 v_add_u32 v167, 0, v165
 ds_read_b64_tr_b16 v[12:13], v167 offset:0
 ds_read_b64_tr_b16 v[14:15], v167 offset:768
 ds_read_b64_tr_b16 v[16:17], v167 offset:12288
 ds_read_b64_tr_b16 v[18:19], v167 offset:13056
 s_waitcnt vmcnt(24) lgkmcnt(0)
 s_barrier
 s_mul_i32 s28, s14, 6144
 s_add_u32 m0, s28, 0
 s_add_u32 s29, s47, 4718592
 buffer_load_dwordx4 v153, s[20:23], s29 offen lds
 s_mul_i32 s28, s14, 6144
 s_add_u32 m0, s28, 1024
 s_add_u32 s29, s47, 4718592
 buffer_load_dwordx4 v154, s[20:23], s29 offen lds
 s_mul_i32 s28, s14, 6144
 s_add_u32 m0, s28, 2048
 s_add_u32 s29, s47, 4718592
 buffer_load_dwordx4 v155, s[20:23], s29 offen lds
 s_mul_i32 s28, s14, 6144
 s_add_u32 m0, s28, 3072
 s_add_u32 s29, s47, 4718592
 buffer_load_dwordx4 v156, s[20:23], s29 offen lds
 s_mul_i32 s28, s14, 6144
 s_add_u32 m0, s28, 4096
 s_add_u32 s29, s47, 4718592
 buffer_load_dwordx4 v157, s[20:23], s29 offen lds
 s_mul_i32 s28, s14, 6144
 s_add_u32 m0, s28, 5120
 s_add_u32 s29, s47, 4718592
 buffer_load_dwordx4 v158, s[20:23], s29 offen lds
 v_add_u32 v167, 24576, v163
 ds_read_b64_tr_b16 a[16:17], v167 offset:0
 ds_read_b64_tr_b16 a[18:19], v167 offset:768
 ds_read_b64_tr_b16 a[20:21], v167 offset:12288
 ds_read_b64_tr_b16 a[22:23], v167 offset:13056
 v_add_u32 v167, 24576, v164
 ds_read_b64_tr_b16 a[24:25], v167 offset:0
 ds_read_b64_tr_b16 a[26:27], v167 offset:768
 ds_read_b64_tr_b16 a[28:29], v167 offset:12288
 ds_read_b64_tr_b16 a[30:31], v167 offset:13056
 v_add_u32 v167, 24576, v165
 ds_read_b64_tr_b16 v[20:21], v167 offset:0
 ds_read_b64_tr_b16 v[22:23], v167 offset:768
 ds_read_b64_tr_b16 v[24:25], v167 offset:12288
 ds_read_b64_tr_b16 v[26:27], v167 offset:13056
 s_waitcnt vmcnt(24) lgkmcnt(0)
 s_barrier
 s_mul_i32 s28, s14, 6144
 s_add_u32 m0, s28, 24576
 s_add_u32 s29, s47, 5505024
 buffer_load_dwordx4 v153, s[20:23], s29 offen lds
 s_mul_i32 s28, s14, 6144
 s_add_u32 m0, s28, 25600
 s_add_u32 s29, s47, 5505024
 buffer_load_dwordx4 v154, s[20:23], s29 offen lds
 s_mul_i32 s28, s14, 6144
 s_add_u32 m0, s28, 26624
 s_add_u32 s29, s47, 5505024
 buffer_load_dwordx4 v155, s[20:23], s29 offen lds
 s_mul_i32 s28, s14, 6144
 s_add_u32 m0, s28, 27648
 s_add_u32 s29, s47, 5505024
 buffer_load_dwordx4 v156, s[20:23], s29 offen lds
 s_mul_i32 s28, s14, 6144
 s_add_u32 m0, s28, 28672
 s_add_u32 s29, s47, 5505024
 buffer_load_dwordx4 v157, s[20:23], s29 offen lds
 s_mul_i32 s28, s14, 6144
 s_add_u32 m0, s28, 29696
 s_add_u32 s29, s47, 5505024
 buffer_load_dwordx4 v158, s[20:23], s29 offen lds
 v_add_u32 v167, 49152, v163
 ds_read_b64_tr_b16 a[32:33], v167 offset:0
 ds_read_b64_tr_b16 a[34:35], v167 offset:768
 ds_read_b64_tr_b16 a[36:37], v167 offset:12288
 ds_read_b64_tr_b16 a[38:39], v167 offset:13056
 v_add_u32 v167, 49152, v164
 ds_read_b64_tr_b16 a[40:41], v167 offset:0
 ds_read_b64_tr_b16 a[42:43], v167 offset:768
 ds_read_b64_tr_b16 a[44:45], v167 offset:12288
 ds_read_b64_tr_b16 a[46:47], v167 offset:13056
 v_add_u32 v167, 49152, v165
 ds_read_b64_tr_b16 a[48:49], v167 offset:0
 ds_read_b64_tr_b16 a[50:51], v167 offset:768
 ds_read_b64_tr_b16 a[52:53], v167 offset:12288
 ds_read_b64_tr_b16 a[54:55], v167 offset:13056
 s_waitcnt vmcnt(24) lgkmcnt(0)
 s_barrier
 s_mul_i32 s28, s14, 6144
 s_add_u32 m0, s28, 49152
 s_add_u32 s29, s47, 6291456
 buffer_load_dwordx4 v153, s[20:23], s29 offen lds
 s_mul_i32 s28, s14, 6144
 s_add_u32 m0, s28, 50176
 s_add_u32 s29, s47, 6291456
 buffer_load_dwordx4 v154, s[20:23], s29 offen lds
 s_mul_i32 s28, s14, 6144
 s_add_u32 m0, s28, 51200
 s_add_u32 s29, s47, 6291456
 buffer_load_dwordx4 v155, s[20:23], s29 offen lds
 s_mul_i32 s28, s14, 6144
 s_add_u32 m0, s28, 52224
 s_add_u32 s29, s47, 6291456
 buffer_load_dwordx4 v156, s[20:23], s29 offen lds
 s_mul_i32 s28, s14, 6144
 s_add_u32 m0, s28, 53248
 s_add_u32 s29, s47, 6291456
 buffer_load_dwordx4 v157, s[20:23], s29 offen lds
 s_mul_i32 s28, s14, 6144
 s_add_u32 m0, s28, 54272
 s_add_u32 s29, s47, 6291456
 buffer_load_dwordx4 v158, s[20:23], s29 offen lds
 v_add_u32 v167, 73728, v163
 ds_read_b64_tr_b16 v[28:29], v167 offset:0
 ds_read_b64_tr_b16 v[30:31], v167 offset:768
 ds_read_b64_tr_b16 v[32:33], v167 offset:12288
 ds_read_b64_tr_b16 v[34:35], v167 offset:13056
 v_add_u32 v167, 73728, v164
 ds_read_b64_tr_b16 a[56:57], v167 offset:0
 ds_read_b64_tr_b16 a[58:59], v167 offset:768
 ds_read_b64_tr_b16 a[60:61], v167 offset:12288
 ds_read_b64_tr_b16 a[62:63], v167 offset:13056
 v_add_u32 v167, 73728, v165
 ds_read_b64_tr_b16 a[64:65], v167 offset:0
 ds_read_b64_tr_b16 a[66:67], v167 offset:768
 ds_read_b64_tr_b16 a[68:69], v167 offset:12288
 ds_read_b64_tr_b16 a[70:71], v167 offset:13056
 s_waitcnt vmcnt(24) lgkmcnt(0)
 s_barrier
 s_mul_i32 s28, s14, 6144
 s_add_u32 m0, s28, 73728
 s_add_u32 s29, s47, 7077888
 buffer_load_dwordx4 v153, s[20:23], s29 offen lds
 s_mul_i32 s28, s14, 6144
 s_add_u32 m0, s28, 74752
 s_add_u32 s29, s47, 7077888
 buffer_load_dwordx4 v154, s[20:23], s29 offen lds
 s_mul_i32 s28, s14, 6144
 s_add_u32 m0, s28, 75776
 s_add_u32 s29, s47, 7077888
 buffer_load_dwordx4 v155, s[20:23], s29 offen lds
 s_mul_i32 s28, s14, 6144
 s_add_u32 m0, s28, 76800
 s_add_u32 s29, s47, 7077888
 buffer_load_dwordx4 v156, s[20:23], s29 offen lds
 s_mul_i32 s28, s14, 6144
 s_add_u32 m0, s28, 77824
 s_add_u32 s29, s47, 7077888
 buffer_load_dwordx4 v157, s[20:23], s29 offen lds
 s_mul_i32 s28, s14, 6144
 s_add_u32 m0, s28, 78848
 s_add_u32 s29, s47, 7077888
 buffer_load_dwordx4 v158, s[20:23], s29 offen lds
 v_add_u32 v167, 98304, v163
 ds_read_b64_tr_b16 v[36:37], v167 offset:0
 ds_read_b64_tr_b16 v[38:39], v167 offset:768
 ds_read_b64_tr_b16 v[40:41], v167 offset:12288
 ds_read_b64_tr_b16 v[42:43], v167 offset:13056
 v_add_u32 v167, 98304, v164
 ds_read_b64_tr_b16 a[72:73], v167 offset:0
 ds_read_b64_tr_b16 a[74:75], v167 offset:768
 ds_read_b64_tr_b16 a[76:77], v167 offset:12288
 ds_read_b64_tr_b16 a[78:79], v167 offset:13056
 v_add_u32 v167, 98304, v165
 ds_read_b64_tr_b16 a[80:81], v167 offset:0
 ds_read_b64_tr_b16 a[82:83], v167 offset:768
 ds_read_b64_tr_b16 a[84:85], v167 offset:12288
 ds_read_b64_tr_b16 a[86:87], v167 offset:13056
 s_waitcnt vmcnt(24) lgkmcnt(0)
 s_barrier
 s_mul_i32 s28, s14, 4096
 s_add_u32 m0, s28, 98304
 s_add_u32 s29, s48, 0
 buffer_load_dwordx4 v159, s[24:27], s29 offen lds
 s_mul_i32 s28, s14, 4096
 s_add_u32 m0, s28, 99328
 s_add_u32 s29, s48, 0
 buffer_load_dwordx4 v160, s[24:27], s29 offen lds
 s_mul_i32 s28, s14, 4096
 s_add_u32 m0, s28, 100352
 s_add_u32 s29, s48, 0
 buffer_load_dwordx4 v161, s[24:27], s29 offen lds
 s_mul_i32 s28, s14, 4096
 s_add_u32 m0, s28, 101376
 s_add_u32 s29, s48, 0
 buffer_load_dwordx4 v162, s[24:27], s29 offen lds
 v_add_u32 v167, 122880, v163
 ds_read_b64_tr_b16 a[88:89], v167 offset:0
 ds_read_b64_tr_b16 a[90:91], v167 offset:768
 ds_read_b64_tr_b16 a[92:93], v167 offset:12288
 ds_read_b64_tr_b16 a[94:95], v167 offset:13056
 v_add_u32 v167, 122880, v164
 ds_read_b64_tr_b16 v[52:53], v167 offset:0
 ds_read_b64_tr_b16 v[54:55], v167 offset:768
 ds_read_b64_tr_b16 v[56:57], v167 offset:12288
 ds_read_b64_tr_b16 v[58:59], v167 offset:13056
 v_add_u32 v167, 122880, v165
 ds_read_b64_tr_b16 a[96:97], v167 offset:0
 ds_read_b64_tr_b16 a[98:99], v167 offset:768
 ds_read_b64_tr_b16 a[100:101], v167 offset:12288
 ds_read_b64_tr_b16 a[102:103], v167 offset:13056
 s_waitcnt vmcnt(22) lgkmcnt(0)
 s_barrier
 s_mul_i32 s28, s14, 4096
 s_add_u32 m0, s28, 122880
 s_add_u32 s29, s48, 256
 buffer_load_dwordx4 v159, s[24:27], s29 offen lds
 s_mul_i32 s28, s14, 4096
 s_add_u32 m0, s28, 123904
 s_add_u32 s29, s48, 256
 buffer_load_dwordx4 v160, s[24:27], s29 offen lds
 s_mul_i32 s28, s14, 4096
 s_add_u32 m0, s28, 124928
 s_add_u32 s29, s48, 256
 buffer_load_dwordx4 v161, s[24:27], s29 offen lds
 s_mul_i32 s28, s14, 4096
 s_add_u32 m0, s28, 125952
 s_add_u32 s29, s48, 256
 buffer_load_dwordx4 v162, s[24:27], s29 offen lds
 v_add_u32 v167, 0, v163
 ds_read_b64_tr_b16 a[104:105], v167 offset:0
 ds_read_b64_tr_b16 a[106:107], v167 offset:768
 ds_read_b64_tr_b16 a[108:109], v167 offset:12288
 ds_read_b64_tr_b16 a[110:111], v167 offset:13056
 v_add_u32 v167, 0, v164
 ds_read_b64_tr_b16 a[112:113], v167 offset:0
 ds_read_b64_tr_b16 a[114:115], v167 offset:768
 ds_read_b64_tr_b16 a[116:117], v167 offset:12288
 ds_read_b64_tr_b16 a[118:119], v167 offset:13056
 v_add_u32 v167, 0, v165
 ds_read_b64_tr_b16 v[68:69], v167 offset:0
 ds_read_b64_tr_b16 v[70:71], v167 offset:768
 ds_read_b64_tr_b16 v[72:73], v167 offset:12288
 ds_read_b64_tr_b16 v[74:75], v167 offset:13056
 s_waitcnt vmcnt(20) lgkmcnt(0)
 s_barrier
 s_mul_i32 s28, s14, 4096
 s_add_u32 m0, s28, 0
 s_add_u32 s29, s48, 512
 buffer_load_dwordx4 v159, s[24:27], s29 offen lds
 s_mul_i32 s28, s14, 4096
 s_add_u32 m0, s28, 1024
 s_add_u32 s29, s48, 512
 buffer_load_dwordx4 v160, s[24:27], s29 offen lds
 s_mul_i32 s28, s14, 4096
 s_add_u32 m0, s28, 2048
 s_add_u32 s29, s48, 512
 buffer_load_dwordx4 v161, s[24:27], s29 offen lds
 s_mul_i32 s28, s14, 4096
 s_add_u32 m0, s28, 3072
 s_add_u32 s29, s48, 512
 buffer_load_dwordx4 v162, s[24:27], s29 offen lds
 v_add_u32 v167, 24576, v163
 ds_read_b64_tr_b16 a[120:121], v167 offset:0
 ds_read_b64_tr_b16 a[122:123], v167 offset:768
 ds_read_b64_tr_b16 a[124:125], v167 offset:12288
 ds_read_b64_tr_b16 a[126:127], v167 offset:13056
 v_add_u32 v167, 24576, v164
 ds_read_b64_tr_b16 a[128:129], v167 offset:0
 ds_read_b64_tr_b16 a[130:131], v167 offset:768
 ds_read_b64_tr_b16 a[132:133], v167 offset:12288
 ds_read_b64_tr_b16 a[134:135], v167 offset:13056
 v_add_u32 v167, 24576, v165
 ds_read_b64_tr_b16 a[136:137], v167 offset:0
 ds_read_b64_tr_b16 a[138:139], v167 offset:768
 ds_read_b64_tr_b16 a[140:141], v167 offset:12288
 ds_read_b64_tr_b16 a[142:143], v167 offset:13056
 s_waitcnt vmcnt(18) lgkmcnt(0)
 s_barrier
 s_mul_i32 s28, s14, 4096
 s_add_u32 m0, s28, 24576
 s_add_u32 s29, s48, 768
 buffer_load_dwordx4 v159, s[24:27], s29 offen lds
 s_mul_i32 s28, s14, 4096
 s_add_u32 m0, s28, 25600
 s_add_u32 s29, s48, 768
 buffer_load_dwordx4 v160, s[24:27], s29 offen lds
 s_mul_i32 s28, s14, 4096
 s_add_u32 m0, s28, 26624
 s_add_u32 s29, s48, 768
 buffer_load_dwordx4 v161, s[24:27], s29 offen lds
 s_mul_i32 s28, s14, 4096
 s_add_u32 m0, s28, 27648
 s_add_u32 s29, s48, 768
 buffer_load_dwordx4 v162, s[24:27], s29 offen lds
 v_add_u32 v167, 49152, v163
 ds_read_b64_tr_b16 v[44:45], v167 offset:0
 ds_read_b64_tr_b16 v[46:47], v167 offset:768
 ds_read_b64_tr_b16 v[48:49], v167 offset:12288
 ds_read_b64_tr_b16 v[50:51], v167 offset:13056
 v_add_u32 v167, 49152, v164
 ds_read_b64_tr_b16 a[144:145], v167 offset:0
 ds_read_b64_tr_b16 a[146:147], v167 offset:768
 ds_read_b64_tr_b16 a[148:149], v167 offset:12288
 ds_read_b64_tr_b16 a[150:151], v167 offset:13056
 v_add_u32 v167, 49152, v165
 ds_read_b64_tr_b16 a[152:153], v167 offset:0
 ds_read_b64_tr_b16 a[154:155], v167 offset:768
 ds_read_b64_tr_b16 a[156:157], v167 offset:12288
 ds_read_b64_tr_b16 a[158:159], v167 offset:13056
 s_waitcnt vmcnt(16) lgkmcnt(0)
 s_barrier
 s_mul_i32 s28, s14, 4096
 s_add_u32 m0, s28, 49152
 s_add_u32 s29, s48, 1024
 buffer_load_dwordx4 v159, s[24:27], s29 offen lds
 s_mul_i32 s28, s14, 4096
 s_add_u32 m0, s28, 50176
 s_add_u32 s29, s48, 1024
 buffer_load_dwordx4 v160, s[24:27], s29 offen lds
 s_mul_i32 s28, s14, 4096
 s_add_u32 m0, s28, 51200
 s_add_u32 s29, s48, 1024
 buffer_load_dwordx4 v161, s[24:27], s29 offen lds
 s_mul_i32 s28, s14, 4096
 s_add_u32 m0, s28, 52224
 s_add_u32 s29, s48, 1024
 buffer_load_dwordx4 v162, s[24:27], s29 offen lds
 v_add_u32 v167, 73728, v163
 ds_read_b64_tr_b16 a[160:161], v167 offset:0
 ds_read_b64_tr_b16 a[162:163], v167 offset:768
 ds_read_b64_tr_b16 a[164:165], v167 offset:12288
 ds_read_b64_tr_b16 a[166:167], v167 offset:13056
 v_add_u32 v167, 73728, v164
 ds_read_b64_tr_b16 v[60:61], v167 offset:0
 ds_read_b64_tr_b16 v[62:63], v167 offset:768
 ds_read_b64_tr_b16 v[64:65], v167 offset:12288
 ds_read_b64_tr_b16 v[66:67], v167 offset:13056
 v_add_u32 v167, 73728, v165
 ds_read_b64_tr_b16 a[168:169], v167 offset:0
 ds_read_b64_tr_b16 a[170:171], v167 offset:768
 ds_read_b64_tr_b16 a[172:173], v167 offset:12288
 ds_read_b64_tr_b16 a[174:175], v167 offset:13056
 s_waitcnt vmcnt(16) lgkmcnt(0)
 s_barrier
 s_mul_i32 s28, s14, 4096
 s_add_u32 m0, s28, 73728
 s_add_u32 s29, s48, 81920
 buffer_load_dwordx4 v159, s[24:27], s29 offen lds
 s_mul_i32 s28, s14, 4096
 s_add_u32 m0, s28, 74752
 s_add_u32 s29, s48, 81920
 buffer_load_dwordx4 v160, s[24:27], s29 offen lds
 s_mul_i32 s28, s14, 4096
 s_add_u32 m0, s28, 75776
 s_add_u32 s29, s48, 81920
 buffer_load_dwordx4 v161, s[24:27], s29 offen lds
 s_mul_i32 s28, s14, 4096
 s_add_u32 m0, s28, 76800
 s_add_u32 s29, s48, 81920
 buffer_load_dwordx4 v162, s[24:27], s29 offen lds
 v_add_u32 v167, 98304, v166
 ds_read_b64_tr_b16 v[76:77], v167 offset:0
 ds_read_b64_tr_b16 v[78:79], v167 offset:512
 ds_read_b64_tr_b16 v[80:81], v167 offset:8192
 ds_read_b64_tr_b16 v[82:83], v167 offset:8704
 v_add_u32 v167, 98304, v5
 ds_read_b64_tr_b16 v[84:85], v167 offset:0
 ds_read_b64_tr_b16 v[86:87], v167 offset:512
 ds_read_b64_tr_b16 v[88:89], v167 offset:8192
 ds_read_b64_tr_b16 v[90:91], v167 offset:8704
 s_waitcnt vmcnt(16) lgkmcnt(0)
 s_barrier
 s_mul_i32 s28, s14, 4096
 s_add_u32 m0, s28, 98304
 s_add_u32 s29, s48, 82176
 buffer_load_dwordx4 v159, s[24:27], s29 offen lds
 s_mul_i32 s28, s14, 4096
 s_add_u32 m0, s28, 99328
 s_add_u32 s29, s48, 82176
 buffer_load_dwordx4 v160, s[24:27], s29 offen lds
 s_mul_i32 s28, s14, 4096
 s_add_u32 m0, s28, 100352
 s_add_u32 s29, s48, 82176
 buffer_load_dwordx4 v161, s[24:27], s29 offen lds
 s_mul_i32 s28, s14, 4096
 s_add_u32 m0, s28, 101376
 s_add_u32 s29, s48, 82176
 buffer_load_dwordx4 v162, s[24:27], s29 offen lds
 v_add_u32 v167, 122880, v166
 ds_read_b64_tr_b16 a[208:209], v167 offset:0
 ds_read_b64_tr_b16 a[210:211], v167 offset:512
 ds_read_b64_tr_b16 a[212:213], v167 offset:8192
 ds_read_b64_tr_b16 a[214:215], v167 offset:8704
 v_add_u32 v167, 122880, v5
 ds_read_b64_tr_b16 a[224:225], v167 offset:0
 ds_read_b64_tr_b16 a[226:227], v167 offset:512
 ds_read_b64_tr_b16 a[228:229], v167 offset:8192
 ds_read_b64_tr_b16 a[230:231], v167 offset:8704
 s_waitcnt vmcnt(16) lgkmcnt(0)
 s_barrier
 s_mul_i32 s28, s14, 4096
 s_add_u32 m0, s28, 122880
 s_add_u32 s29, s48, 82432
 buffer_load_dwordx4 v159, s[24:27], s29 offen lds
 s_mul_i32 s28, s14, 4096
 s_add_u32 m0, s28, 123904
 s_add_u32 s29, s48, 82432
 buffer_load_dwordx4 v160, s[24:27], s29 offen lds
 s_mul_i32 s28, s14, 4096
 s_add_u32 m0, s28, 124928
 s_add_u32 s29, s48, 82432
 buffer_load_dwordx4 v161, s[24:27], s29 offen lds
 s_mul_i32 s28, s14, 4096
 s_add_u32 m0, s28, 125952
 s_add_u32 s29, s48, 82432
 buffer_load_dwordx4 v162, s[24:27], s29 offen lds
 v_add_u32 v167, 0, v166
 ds_read_b64_tr_b16 a[240:241], v167 offset:0
 ds_read_b64_tr_b16 a[242:243], v167 offset:512
 ds_read_b64_tr_b16 a[244:245], v167 offset:8192
 ds_read_b64_tr_b16 a[246:247], v167 offset:8704
 v_add_u32 v167, 0, v5
 ds_read_b64_tr_b16 v[168:169], v167 offset:0
 ds_read_b64_tr_b16 v[170:171], v167 offset:512
 ds_read_b64_tr_b16 v[172:173], v167 offset:8192
 ds_read_b64_tr_b16 v[174:175], v167 offset:8704
 s_waitcnt vmcnt(16) lgkmcnt(0)
 s_barrier
 s_mul_i32 s28, s14, 4096
 s_add_u32 m0, s28, 0
 s_add_u32 s29, s48, 82688
 buffer_load_dwordx4 v159, s[24:27], s29 offen lds
 s_mul_i32 s28, s14, 4096
 s_add_u32 m0, s28, 1024
 s_add_u32 s29, s48, 82688
 buffer_load_dwordx4 v160, s[24:27], s29 offen lds
 s_mul_i32 s28, s14, 4096
 s_add_u32 m0, s28, 2048
 s_add_u32 s29, s48, 82688
 buffer_load_dwordx4 v161, s[24:27], s29 offen lds
 s_mul_i32 s28, s14, 4096
 s_add_u32 m0, s28, 3072
 s_add_u32 s29, s48, 82688
 buffer_load_dwordx4 v162, s[24:27], s29 offen lds
 v_add_u32 v167, 24576, v166
 ds_read_b64_tr_b16 v[184:185], v167 offset:0
 ds_read_b64_tr_b16 v[186:187], v167 offset:512
 ds_read_b64_tr_b16 v[188:189], v167 offset:8192
 ds_read_b64_tr_b16 v[190:191], v167 offset:8704
 v_add_u32 v167, 24576, v5
 ds_read_b64_tr_b16 v[124:125], v167 offset:0
 ds_read_b64_tr_b16 v[126:127], v167 offset:512
 ds_read_b64_tr_b16 v[128:129], v167 offset:8192
 ds_read_b64_tr_b16 v[130:131], v167 offset:8704
 s_waitcnt vmcnt(16) lgkmcnt(0)
 s_barrier
 s_mul_i32 s28, s14, 4096
 s_add_u32 m0, s28, 24576
 s_add_u32 s29, s48, 82944
 buffer_load_dwordx4 v159, s[24:27], s29 offen lds
 s_mul_i32 s28, s14, 4096
 s_add_u32 m0, s28, 25600
 s_add_u32 s29, s48, 82944
 buffer_load_dwordx4 v160, s[24:27], s29 offen lds
 s_mul_i32 s28, s14, 4096
 s_add_u32 m0, s28, 26624
 s_add_u32 s29, s48, 82944
 buffer_load_dwordx4 v161, s[24:27], s29 offen lds
 s_mul_i32 s28, s14, 4096
 s_add_u32 m0, s28, 27648
 s_add_u32 s29, s48, 82944
 buffer_load_dwordx4 v162, s[24:27], s29 offen lds
 v_add_u32 v167, 49152, v166
 ds_read_b64_tr_b16 v[132:133], v167 offset:0
 ds_read_b64_tr_b16 v[134:135], v167 offset:512
 ds_read_b64_tr_b16 v[136:137], v167 offset:8192
 ds_read_b64_tr_b16 v[138:139], v167 offset:8704
 v_add_u32 v167, 49152, v5
 ds_read_b64_tr_b16 v[240:241], v167 offset:0
 ds_read_b64_tr_b16 v[242:243], v167 offset:512
 ds_read_b64_tr_b16 v[244:245], v167 offset:8192
 ds_read_b64_tr_b16 v[246:247], v167 offset:8704
 s_waitcnt vmcnt(16) lgkmcnt(0)
 s_barrier
 s_mul_i32 s28, s14, 4096
 s_add_u32 m0, s28, 49152
 s_add_u32 s29, s48, 163840
 buffer_load_dwordx4 v159, s[24:27], s29 offen lds
 s_mul_i32 s28, s14, 4096
 s_add_u32 m0, s28, 50176
 s_add_u32 s29, s48, 163840
 buffer_load_dwordx4 v160, s[24:27], s29 offen lds
 s_mul_i32 s28, s14, 4096
 s_add_u32 m0, s28, 51200
 s_add_u32 s29, s48, 163840
 buffer_load_dwordx4 v161, s[24:27], s29 offen lds
 s_mul_i32 s28, s14, 4096
 s_add_u32 m0, s28, 52224
 s_add_u32 s29, s48, 163840
 buffer_load_dwordx4 v162, s[24:27], s29 offen lds
 v_add_u32 v167, 73728, v166
 ds_read_b64_tr_b16 a[176:177], v167 offset:0
 ds_read_b64_tr_b16 a[178:179], v167 offset:512
 ds_read_b64_tr_b16 a[180:181], v167 offset:8192
 ds_read_b64_tr_b16 a[182:183], v167 offset:8704
 v_add_u32 v167, 73728, v5
 ds_read_b64_tr_b16 a[192:193], v167 offset:0
 ds_read_b64_tr_b16 a[194:195], v167 offset:512
 ds_read_b64_tr_b16 a[196:197], v167 offset:8192
 ds_read_b64_tr_b16 a[198:199], v167 offset:8704
 s_waitcnt vmcnt(16) lgkmcnt(0)
 s_barrier
 s_mul_i32 s28, s14, 4096
 s_add_u32 m0, s28, 73728
 s_add_u32 s29, s48, 164096
 buffer_load_dwordx4 v159, s[24:27], s29 offen lds
 s_mul_i32 s28, s14, 4096
 s_add_u32 m0, s28, 74752
 s_add_u32 s29, s48, 164096
 buffer_load_dwordx4 v160, s[24:27], s29 offen lds
 s_mul_i32 s28, s14, 4096
 s_add_u32 m0, s28, 75776
 s_add_u32 s29, s48, 164096
 buffer_load_dwordx4 v161, s[24:27], s29 offen lds
 s_mul_i32 s28, s14, 4096
 s_add_u32 m0, s28, 76800
 s_add_u32 s29, s48, 164096
 buffer_load_dwordx4 v162, s[24:27], s29 offen lds
 v_add_u32 v167, 98304, v166
 ds_read_b64_tr_b16 v[92:93], v167 offset:0
 ds_read_b64_tr_b16 v[94:95], v167 offset:512
 ds_read_b64_tr_b16 v[96:97], v167 offset:8192
 ds_read_b64_tr_b16 v[98:99], v167 offset:8704
 v_add_u32 v167, 98304, v5
 ds_read_b64_tr_b16 v[100:101], v167 offset:0
 ds_read_b64_tr_b16 v[102:103], v167 offset:512
 ds_read_b64_tr_b16 v[104:105], v167 offset:8192
 ds_read_b64_tr_b16 v[106:107], v167 offset:8704
 s_waitcnt vmcnt(16) lgkmcnt(0)
 s_barrier
 s_mul_i32 s28, s14, 4096
 s_add_u32 m0, s28, 98304
 s_add_u32 s29, s48, 164352
 buffer_load_dwordx4 v159, s[24:27], s29 offen lds
 s_mul_i32 s28, s14, 4096
 s_add_u32 m0, s28, 99328
 s_add_u32 s29, s48, 164352
 buffer_load_dwordx4 v160, s[24:27], s29 offen lds
 s_mul_i32 s28, s14, 4096
 s_add_u32 m0, s28, 100352
 s_add_u32 s29, s48, 164352
 buffer_load_dwordx4 v161, s[24:27], s29 offen lds
 s_mul_i32 s28, s14, 4096
 s_add_u32 m0, s28, 101376
 s_add_u32 s29, s48, 164352
 buffer_load_dwordx4 v162, s[24:27], s29 offen lds
 v_add_u32 v167, 122880, v166
 ds_read_b64_tr_b16 a[248:249], v167 offset:0
 ds_read_b64_tr_b16 a[250:251], v167 offset:512
 ds_read_b64_tr_b16 a[252:253], v167 offset:8192
 ds_read_b64_tr_b16 a[254:255], v167 offset:8704
 v_add_u32 v167, 122880, v5
 ds_read_b64_tr_b16 v[176:177], v167 offset:0
 ds_read_b64_tr_b16 v[178:179], v167 offset:512
 ds_read_b64_tr_b16 v[180:181], v167 offset:8192
 ds_read_b64_tr_b16 v[182:183], v167 offset:8704
 s_waitcnt vmcnt(16) lgkmcnt(0)
 s_barrier
 s_mul_i32 s28, s14, 4096
 s_add_u32 m0, s28, 122880
 s_add_u32 s29, s48, 164608
 buffer_load_dwordx4 v159, s[24:27], s29 offen lds
 s_mul_i32 s28, s14, 4096
 s_add_u32 m0, s28, 123904
 s_add_u32 s29, s48, 164608
 buffer_load_dwordx4 v160, s[24:27], s29 offen lds
 s_mul_i32 s28, s14, 4096
 s_add_u32 m0, s28, 124928
 s_add_u32 s29, s48, 164608
 buffer_load_dwordx4 v161, s[24:27], s29 offen lds
 s_mul_i32 s28, s14, 4096
 s_add_u32 m0, s28, 125952
 s_add_u32 s29, s48, 164608
 buffer_load_dwordx4 v162, s[24:27], s29 offen lds
 v_add_u32 v167, 0, v166
 ds_read_b64_tr_b16 v[192:193], v167 offset:0
 ds_read_b64_tr_b16 v[194:195], v167 offset:512
 ds_read_b64_tr_b16 v[196:197], v167 offset:8192
 ds_read_b64_tr_b16 v[198:199], v167 offset:8704
 v_add_u32 v167, 0, v5
 ds_read_b64_tr_b16 v[208:209], v167 offset:0
 ds_read_b64_tr_b16 v[210:211], v167 offset:512
 ds_read_b64_tr_b16 v[212:213], v167 offset:8192
 ds_read_b64_tr_b16 v[214:215], v167 offset:8704
 s_waitcnt vmcnt(16) lgkmcnt(0)
 s_barrier
 s_mul_i32 s28, s14, 4096
 s_add_u32 m0, s28, 0
 s_add_u32 s29, s48, 164864
 buffer_load_dwordx4 v159, s[24:27], s29 offen lds
 s_mul_i32 s28, s14, 4096
 s_add_u32 m0, s28, 1024
 s_add_u32 s29, s48, 164864
 buffer_load_dwordx4 v160, s[24:27], s29 offen lds
 s_mul_i32 s28, s14, 4096
 s_add_u32 m0, s28, 2048
 s_add_u32 s29, s48, 164864
 buffer_load_dwordx4 v161, s[24:27], s29 offen lds
 s_mul_i32 s28, s14, 4096
 s_add_u32 m0, s28, 3072
 s_add_u32 s29, s48, 164864
 buffer_load_dwordx4 v162, s[24:27], s29 offen lds
 v_add_u32 v167, 24576, v166
 ds_read_b64_tr_b16 v[224:225], v167 offset:0
 ds_read_b64_tr_b16 v[226:227], v167 offset:512
 ds_read_b64_tr_b16 v[228:229], v167 offset:8192
 ds_read_b64_tr_b16 v[230:231], v167 offset:8704
 v_add_u32 v167, 24576, v5
 ds_read_b64_tr_b16 v[140:141], v167 offset:0
 ds_read_b64_tr_b16 v[142:143], v167 offset:512
 ds_read_b64_tr_b16 v[144:145], v167 offset:8192
 ds_read_b64_tr_b16 v[146:147], v167 offset:8704
 s_waitcnt vmcnt(16) lgkmcnt(0)
 s_barrier
 v_add_u32 v167, 49152, v166
 ds_read_b64_tr_b16 a[184:185], v167 offset:0
 ds_read_b64_tr_b16 a[186:187], v167 offset:512
 ds_read_b64_tr_b16 a[188:189], v167 offset:8192
 ds_read_b64_tr_b16 a[190:191], v167 offset:8704
 v_add_u32 v167, 49152, v5
 ds_read_b64_tr_b16 a[200:201], v167 offset:0
 ds_read_b64_tr_b16 a[202:203], v167 offset:512
 ds_read_b64_tr_b16 a[204:205], v167 offset:8192
 ds_read_b64_tr_b16 a[206:207], v167 offset:8704
 s_waitcnt vmcnt(12) lgkmcnt(0)
 s_barrier
 v_add_u32 v167, 73728, v166
 ds_read_b64_tr_b16 a[216:217], v167 offset:0
 ds_read_b64_tr_b16 a[218:219], v167 offset:512
 ds_read_b64_tr_b16 a[220:221], v167 offset:8192
 ds_read_b64_tr_b16 a[222:223], v167 offset:8704
 v_add_u32 v167, 73728, v5
 ds_read_b64_tr_b16 a[232:233], v167 offset:0
 ds_read_b64_tr_b16 a[234:235], v167 offset:512
 ds_read_b64_tr_b16 a[236:237], v167 offset:8192
 ds_read_b64_tr_b16 a[238:239], v167 offset:8704
 s_waitcnt vmcnt(8) lgkmcnt(0)
 s_barrier
 v_add_u32 v167, 98304, v166
 ds_read_b64_tr_b16 v[108:109], v167 offset:0
 ds_read_b64_tr_b16 v[110:111], v167 offset:512
 ds_read_b64_tr_b16 v[112:113], v167 offset:8192
 ds_read_b64_tr_b16 v[114:115], v167 offset:8704
 v_add_u32 v167, 98304, v5
 ds_read_b64_tr_b16 v[116:117], v167 offset:0
 ds_read_b64_tr_b16 v[118:119], v167 offset:512
 ds_read_b64_tr_b16 v[120:121], v167 offset:8192
 ds_read_b64_tr_b16 v[122:123], v167 offset:8704
 s_waitcnt vmcnt(4) lgkmcnt(0)
 s_barrier
 v_add_u32 v167, 122880, v166
 ds_read_b64_tr_b16 v[200:201], v167 offset:0
 ds_read_b64_tr_b16 v[202:203], v167 offset:512
 ds_read_b64_tr_b16 v[204:205], v167 offset:8192
 ds_read_b64_tr_b16 v[206:207], v167 offset:8704
 v_add_u32 v167, 122880, v5
 ds_read_b64_tr_b16 v[216:217], v167 offset:0
 ds_read_b64_tr_b16 v[218:219], v167 offset:512
 ds_read_b64_tr_b16 v[220:221], v167 offset:8192
 ds_read_b64_tr_b16 v[222:223], v167 offset:8704
 s_waitcnt vmcnt(0) lgkmcnt(0)
 s_barrier
 v_add_u32 v167, 0, v166
 ds_read_b64_tr_b16 v[232:233], v167 offset:0
 ds_read_b64_tr_b16 v[234:235], v167 offset:512
 ds_read_b64_tr_b16 v[236:237], v167 offset:8192
 ds_read_b64_tr_b16 v[238:239], v167 offset:8704
 v_add_u32 v167, 0, v5
 ds_read_b64_tr_b16 v[248:249], v167 offset:0
 ds_read_b64_tr_b16 v[250:251], v167 offset:512
 ds_read_b64_tr_b16 v[252:253], v167 offset:8192
 ds_read_b64_tr_b16 v[254:255], v167 offset:8704
 s_waitcnt lgkmcnt(0)
 s_barrier
 s_mov_b32 s45, 200000
 v_lshlrev_b32 v7, 3, v4
 s_mov_b32 s28, 6356992
 buffer_load_dwordx2 v[8:9], v7, s[8:11], s28 offen sc1
 s_waitcnt vmcnt(0)
 v_cmp_lt_i32 vcc, v9, v8
 s_and_b32 s19, vcc_lo, 65535
 s_mul_i32 s28, s14, 34816
 s_add_u32 s28, s28, 16384
 v_add_u32 v154, s28, v152
 ds_write_b128 v154, v[12:15] offset:0
 ds_write_b128 v154, v[16:19] offset:1024
 ds_write_b128 v154, v[20:23] offset:2048
 ds_write_b128 v154, v[24:27] offset:3072
 ds_write_b128 v154, v[28:31] offset:4096
 ds_write_b128 v154, v[32:35] offset:5120
 ds_write_b128 v154, v[36:39] offset:6144
 ds_write_b128 v154, v[40:43] offset:7168
 ds_write_b128 v154, v[44:47] offset:8192
 ds_write_b128 v154, v[48:51] offset:9216
 ds_write_b128 v154, v[52:55] offset:10240
 ds_write_b128 v154, v[56:59] offset:11264
 ds_write_b128 v154, v[60:63] offset:12288
 ds_write_b128 v154, v[64:67] offset:13312
 ds_write_b128 v154, v[68:71] offset:14336
 ds_write_b128 v154, v[72:75] offset:15360
 ds_write_b128 v154, v[76:79] offset:16384
 ds_write_b128 v154, v[80:83] offset:17408
 ds_write_b128 v154, v[84:87] offset:18432
 ds_write_b128 v154, v[88:91] offset:19456
 ds_write_b128 v154, v[92:95] offset:20480
 ds_write_b128 v154, v[96:99] offset:21504
 ds_write_b128 v154, v[100:103] offset:22528
 ds_write_b128 v154, v[104:107] offset:23552
 ds_write_b128 v154, v[108:111] offset:24576
 ds_write_b128 v154, v[112:115] offset:25600
 ds_write_b128 v154, v[116:119] offset:26624
 ds_write_b128 v154, v[120:123] offset:27648
 ds_write_b128 v154, v[124:127] offset:28672
 ds_write_b128 v154, v[128:131] offset:29696
 ds_write_b128 v154, v[132:135] offset:30720
 ds_write_b128 v154, v[136:139] offset:31744
 ds_write_b128 v154, v[140:143] offset:32768
 ds_write_b128 v154, v[144:147] offset:33792
 s_waitcnt lgkmcnt(0)
 v_lshrrev_b32 v8, 3, v4
 v_lshlrev_b32 v8, 7, v8
 v_lshl_add_u32 v8, v3, 5, v8
 v_and_b32 v9, 7, v4
 v_lshl_add_u32 v8, v9, 1, v8
 s_mul_i32 s28, s14, 768
 s_add_u32 s28, s28, 10240
 v_add_u32 v153, s28, v8
 s_mul_i32 s28, s13, 40
 v_add_u32 v10, s28, v4
 v_add_u32 v11, 16, v10
 v_add_u32 v12, s28, v9
 v_add_u32 v12, 32, v12
 v_lshrrev_b32 v13, 5, v10
 v_lshlrev_b32 v13, 11, v13
 v_and_b32 v14, 31, v10
 v_lshl_add_u32 v13, v14, 5, v13
 v_lshrrev_b32 v14, 1, v3
 v_lshl_add_u32 v13, v14, 10, v13
 v_and_b32 v14, 1, v3
 v_lshl_add_u32 v155, v14, 4, v13
 v_lshrrev_b32 v13, 5, v11
 v_lshlrev_b32 v13, 11, v13
 v_and_b32 v14, 31, v11
 v_lshl_add_u32 v13, v14, 5, v13
 v_lshrrev_b32 v14, 1, v3
 v_lshl_add_u32 v13, v14, 10, v13
 v_and_b32 v14, 1, v3
 v_lshl_add_u32 v156, v14, 4, v13
 v_lshrrev_b32 v13, 5, v12
 v_lshlrev_b32 v13, 11, v13
 v_and_b32 v14, 31, v12
 v_lshl_add_u32 v13, v14, 5, v13
 v_lshrrev_b32 v14, 1, v3
 v_lshl_add_u32 v13, v14, 10, v13
 v_and_b32 v14, 1, v3
 v_lshl_add_u32 v167, v14, 4, v13
 v_lshrrev_b32 v13, 1, v3
 v_lshlrev_b32 v13, 11, v13
 v_and_b32 v14, 1, v3
 v_lshl_add_u32 v13, v14, 8, v13
 v_lshl_add_u32 v13, v4, 4, v13
 s_lshl_b32 s28, s14, 9
 v_add_u32 v157, s28, v13
 v_lshlrev_b32 v13, 4, v4
 v_lshl_add_u32 v13, v3, 2, v13
 v_add_u32 v166, s28, v13
 s_lshl_b32 s28, s14, 2
 v_add_u32 v13, s28, v3
 v_mul_u32_u24 v14, 10240, v13
 v_lshl_add_u32 v158, v10, 4, v14
 v_lshl_add_u32 v159, v12, 4, v14
 v_mul_u32_u24 v14, 640, v13
 v_lshl_add_u32 v14, v9, 4, v14
 v_add_u32 v161, 512, v14
 s_mul_i32 s28, s14, 2560
 v_lshlrev_b32 v14, 7, v3
 v_lshl_add_u32 v14, v9, 4, v14
 v_lshrrev_b32 v15, 3, v4
 v_mul_u32_u24 v15, 640, v15
 v_add3_u32 v160, s28, v14, v15
 s_mul_i32 s28, s14, 1536
 s_add_u32 s28, s28, 155648
 v_add_u32 v162, s28, v14
 v_lshrrev_b32 v15, 3, v4
 v_lshl_add_u32 v162, v15, 9, v162
 v_lshrrev_b32 v13, 3, v2
 v_lshlrev_b32 v13, 8, v13
 v_lshl_add_u32 v163, v9, 4, v13
 v_add_u32 v163, 155648, v163
 s_mul_i32 s28, s13, 640
 v_add_u32 v164, s28, v152
 s_lshl_b32 s37, s12, 4
 s_lshl_b32 s28, s14, 2
 s_add_u32 s37, s37, s28
 s_mul_i32 s37, s37, 40960
 s_add_u32 s37, s37, 96468992
 s_lshl_b32 s38, s12, 20
 s_add_u32 s38, s38, 4194304
 s_mul_i32 s47, s13, 10240
 s_mul_i32 s39, s15, 10240
 s_add_u32 s39, s39, 25165824
 s_xor_b32 s49, s12, 1
 s_lshl_b32 s49, s49, 3
 v_cmp_gt_u32 vcc, 8192, v164
 s_mov_b64 s[58:59], vcc
 v_mov_b32 v136, 0
 v_mov_b32 v137, 0
 v_mov_b32 v138, 0
 v_mov_b32 v139, 0
 v_mov_b32 v140, 0
 v_mov_b32 v141, 0
 v_mov_b32 v142, 0
 v_mov_b32 v143, 0
 v_mov_b32 v144, 0
 v_mov_b32 v145, 0
 v_mov_b32 v146, 0
 v_mov_b32 v147, 0
 s_and_b32 s28, s14, 1
 s_mul_i32 s28, s28, 48
 v_add_u32 v13, s28, v2
 v_lshlrev_b32 v166, 4, v13
 v_add_u32 v166, 155648, v166
 v_lshrrev_b32 v14, 4, v13
 v_lshlrev_b32 v14, 7, v14
 v_and_b32 v15, 7, v13
 v_lshl_add_u32 v14, v15, 4, v14
 v_bfe_u32 v15, v13, 3, 1
 v_lshl_add_u32 v14, v15, 3, v14
 s_mul_i32 s28, s13, 640
 v_add_u32 v163, s28, v14
 v_cmp_gt_u32 vcc, 8192, v163
 s_mov_b64 s[4:5], vcc
 s_mov_b32 s6, -1
 s_cmp_eq_u32 s14, 0
 s_cselect_b32 s7, 0xffff, 0
 s_lshr_b32 s28, s16, 2
 s_lshl_b32 s28, s28, 5
 s_lshl_b32 s29, s12, 4
 s_add_u32 s28, s28, s29
 s_lshl_b32 s28, s28, 2
 s_add_u32 s28, s28, 6328320
 v_bfe_u32 v100, v152, 4, 4
 v_lshlrev_b32 v100, 2, v100
fu_83:
 buffer_load_dword v101, v100, s[8:11], s28 offen sc1
 s_waitcnt vmcnt(0)
 v_cmp_gt_u32 vcc, 2, v101
 s_cbranch_vccz fo_84
 s_sub_u32 s45, s45, 1
 s_cbranch_scc0 fu_83
 s_mov_b32 s45, 0
fo_84:
 .p2align 6
Vstep_85:
 s_and_b32 s28, s16, 3
 s_lshl_b32 s29, s28, 1
 s_add_u32 s29, s29, s18
 s_lshr_b32 s17, s19, s29
 s_lshl_b32 s29, s29, 14
 s_add_u32 s29, s29, 180355072
 s_and_b32 s31, s17, 1
 s_lshl_b32 s31, s31, 13
 s_add_u32 s31, s31, s29
 s_and_b32 s17, s17, 2
 s_lshl_b32 s17, s17, 12
 s_add_u32 s17, s17, s29
 s_add_u32 s17, s17, 8192
 s_lshl_b32 s28, s28, 14
 s_add_u32 s30, s28, s36
 s_add_u32 s34, s30, 4096
 s_add_u32 s35, s31, 4096
 v_pk_mov_b32 v[88:89], 0, 0
 v_pk_mov_b32 v[90:91], 0, 0
 v_pk_mov_b32 v[92:93], 0, 0
 v_pk_mov_b32 v[94:95], 0, 0
 v_pk_mov_b32 v[96:97], 0, 0
 v_pk_mov_b32 v[98:99], 0, 0
 ds_read_b128 v[100:103], v154 offset:0
 ds_read_b128 v[104:107], v154 offset:1024
 ds_read_b128 v[108:111], v154 offset:2048
 ds_read_b128 v[112:115], v154 offset:3072
 ds_read_b128 v[116:119], v154 offset:4096
 ds_read_b128 v[120:123], v154 offset:5120
 s_mul_i32 s50, s16, 1310720
 s_add_u32 s50, s50, s37
 s_add_u32 s28, s16, 2
 s_and_b32 s28, s28, 3
 s_lshl_b32 s51, s28, 18
 s_add_u32 s51, s51, s38
 s_add_u32 s51, s51, s47
 s_lshl_b32 s28, s28, 14
 s_add_u32 s60, s28, s36
 s_sub_u32 s54, s16, 1
 s_max_i32 s54, s54, 0
 s_mul_i32 s54, s54, 327680
 s_add_u32 s54, s54, s39
 s_and_b32 s28, s16, 3
 s_lshl_b32 s55, s28, 18
 s_add_u32 s55, s55, s38
 s_add_u32 s56, s55, s47
 s_lshl_b32 s57, s28, 14
 s_add_u32 s57, s57, s36
 s_add_u32 s57, s57, 262144
 s_cmp_eq_u32 s14, 2
 s_cbranch_scc0 w1_87
 s_add_u32 s28, s16, 2
 s_and_b32 s28, s28, 3
 s_lshl_b32 s29, s28, 1
 s_add_u32 s29, s29, s49
 s_lshr_b32 s61, s19, s29
 s_lshl_b32 s29, s29, 14
 s_add_u32 s29, s29, 180355072
 s_and_b32 s53, s61, 1
 s_lshl_b32 s53, s53, 13
 s_add_u32 s53, s53, s29
 s_and_b32 s61, s61, 2
 s_lshl_b32 s61, s61, 12
 s_add_u32 s61, s61, s29
 s_add_u32 s61, s61, 8192
 s_lshl_b32 s28, s28, 14
 s_add_u32 s52, s28, s36
 v_mov_b32 v165, s61
 v_mov_b32 v20, s53
 v_cndmask_b32 v165, v165, v20, s[58:59]
 v_add_u32 v165, v165, v164
 v_mov_b32 v0, -1
 v_mov_b32 v1, -1
 v_mov_b32 v2, -1
 v_mov_b32 v3, -1
 s_mov_b32 exec_hi, 0xff
 buffer_store_dwordx4 v[0:3], v164, s[8:11], s52 offen sc1
 buffer_store_dwordx4 v[0:3], v165, s[8:11], 0 offen sc1
 s_mov_b32 exec_hi, -1
w1_87:
 s_cmp_le_u32 s14, 1
 s_cbranch_scc0 w0_86
 s_add_u32 s28, s16, 1
 s_and_b32 s28, s28, 3
 s_lshl_b32 s29, s28, 1
 s_add_u32 s29, s29, s49
 s_lshr_b32 s61, s19, s29
 s_lshl_b32 s29, s29, 14
 s_add_u32 s29, s29, 180355072
 s_and_b32 s53, s61, 1
 s_lshl_b32 s53, s53, 13
 s_add_u32 s53, s53, s29
 s_and_b32 s61, s61, 2
 s_lshl_b32 s61, s61, 12
 s_add_u32 s61, s61, s29
 s_add_u32 s61, s61, 8192
 s_lshl_b32 s28, s28, 14
 s_add_u32 s52, s28, s36
 v_mov_b32 v165, s61
 v_mov_b32 v20, s53
 v_cndmask_b32 v165, v165, v20, s[4:5]
 v_add_u32 v165, v165, v163
w0_86:
pl_88:
 buffer_load_dwordx4 v[124:127], v148, s[8:11], s30 offen offset:0 sc1
 buffer_load_dwordx4 v[128:131], v148, s[8:11], s34 offen offset:0 sc1
 buffer_load_dwordx2 v[132:133], v149, s[8:11], s30 offen sc1
 s_waitcnt vmcnt(0)
 v_max3_u32 v0, v124, v128, v132
 v_cmp_eq_u32 vcc, -1, v0
 s_cbranch_vccz ok_92
 s_sub_u32 s45, s45, 1
 s_cbranch_scc0 pl_88
 s_mov_b32 s45, 0
ok_92:
 buffer_load_dwordx4 v[40:43], v148, s[8:11], s31 offen offset:0 sc1
 buffer_load_dwordx4 v[44:47], v148, s[8:11], s35 offen offset:0 sc1
 buffer_load_dwordx2 v[48:49], v149, s[8:11], s17 offen sc1
 v_lshlrev_b32 v16, 16, v124
 v_and_b32 v17, 0xffff0000, v124
 v_lshlrev_b32 v18, 16, v125
 v_and_b32 v19, 0xffff0000, v125
 v_lshlrev_b32 v20, 16, v126
 v_and_b32 v21, 0xffff0000, v126
 v_lshlrev_b32 v22, 16, v127
 v_and_b32 v23, 0xffff0000, v127
 v_lshlrev_b32 v24, 16, v128
 v_and_b32 v25, 0xffff0000, v128
 v_lshlrev_b32 v26, 16, v129
 v_and_b32 v27, 0xffff0000, v129
 v_lshlrev_b32 v28, 16, v130
 v_and_b32 v29, 0xffff0000, v130
 v_lshlrev_b32 v30, 16, v131
 v_and_b32 v31, 0xffff0000, v131
 v_lshlrev_b32 v32, 16, v132
 v_and_b32 v33, 0xffff0000, v132
 v_lshlrev_b32 v34, 16, v133
 v_and_b32 v35, 0xffff0000, v133
 s_branch g_90
pr_89:
 buffer_load_dwordx4 v[40:43], v148, s[8:11], s31 offen offset:0 sc1
 buffer_load_dwordx4 v[44:47], v148, s[8:11], s35 offen offset:0 sc1
 buffer_load_dwordx2 v[48:49], v149, s[8:11], s17 offen sc1
g_90:
 s_waitcnt vmcnt(0)
 v_max3_u32 v0, v40, v44, v48
 v_cmp_eq_u32 vcc, -1, v0
 v_dot2_f32_bf16 v4, v40, s42, v16
 v_dot2_f32_bf16 v5, v40, s43, v17
 v_dot2_f32_bf16 v6, v41, s42, v18
 v_dot2_f32_bf16 v7, v41, s43, v19
 v_dot2_f32_bf16 v8, v42, s42, v20
 v_dot2_f32_bf16 v9, v42, s43, v21
 v_dot2_f32_bf16 v10, v43, s42, v22
 v_dot2_f32_bf16 v11, v43, s43, v23
 s_cbranch_vccz ok_93
 s_sub_u32 s45, s45, 1
 s_cbranch_scc0 pr_89
 s_mov_b32 s45, 0
ok_93:
 v_cvt_pk_bf16_f32 v124, v4, v5
 v_cvt_pk_bf16_f32 v125, v6, v7
 v_cvt_pk_bf16_f32 v126, v8, v9
 v_cvt_pk_bf16_f32 v127, v10, v11
 ds_write_b128 v148, v[124:127] offset:0
 v_dot2_f32_bf16 v24, v44, s42, v24
 v_dot2_f32_bf16 v25, v44, s43, v25
 v_dot2_f32_bf16 v26, v45, s42, v26
 v_dot2_f32_bf16 v27, v45, s43, v27
 v_dot2_f32_bf16 v28, v46, s42, v28
 v_dot2_f32_bf16 v29, v46, s43, v29
 v_dot2_f32_bf16 v30, v47, s42, v30
 v_dot2_f32_bf16 v31, v47, s43, v31
 v_cvt_pk_bf16_f32 v128, v24, v25
 v_cvt_pk_bf16_f32 v129, v26, v27
 v_cvt_pk_bf16_f32 v130, v28, v29
 v_cvt_pk_bf16_f32 v131, v30, v31
 ds_write_b128 v148, v[128:131] offset:4096
 v_dot2_f32_bf16 v32, v48, s42, v32
 v_dot2_f32_bf16 v33, v48, s43, v33
 v_dot2_f32_bf16 v34, v49, s42, v34
 v_dot2_f32_bf16 v35, v49, s43, v35
 s_nop 0
 v_cvt_pk_bf16_f32 v132, v32, v33
 s_nop 0
 v_cvt_pk_bf16_f32 v133, v34, v35
 ds_write_b64 v149, v[132:133]
 buffer_load_dwordx4 v[40:43], v155, s[8:11], s50 offen
 buffer_load_dwordx4 v[44:47], v156, s[8:11], s50 offen
 s_mov_b64 exec, s[40:41]
 buffer_load_dwordx4 v[48:51], v167, s[8:11], s50 offen
 s_mov_b64 exec, -1
 s_add_u32 s50, s50, 40960
 buffer_load_dwordx4 v[52:55], v155, s[8:11], s50 offen
 buffer_load_dwordx4 v[56:59], v156, s[8:11], s50 offen
 s_mov_b64 exec, s[40:41]
 buffer_load_dwordx4 v[60:63], v167, s[8:11], s50 offen
 s_mov_b64 exec, -1
 s_add_u32 s50, s50, 40960
gs_91:
 s_waitcnt lgkmcnt(0)
 s_barrier
 ds_read_b128 v[0:3], v150 offset:0
 ds_read_b128 v[4:7], v150 offset:1024
 ds_read_b128 v[8:11], v150 offset:2048
 s_waitcnt lgkmcnt(2)
 v_smfmac_f32_16x16x64_bf16 v[88:91], v[0:3], a[0:7], v151
 ds_read_b128 v[12:15], v150 offset:3072
 v_smfmac_f32_16x16x64_bf16 v[92:95], v[0:3], a[8:15], v151
 ds_read_b128 v[16:19], v150 offset:4096
 v_smfmac_f32_16x16x64_bf16 v[96:99], v[0:3], v[100:107], v151
 ds_read_b128 v[100:103], v154 offset:6144
 ds_read_b128 v[104:107], v154 offset:7168
 ds_read_b128 v[20:23], v150 offset:5120
 buffer_load_dwordx4 v[64:67], v155, s[8:11], s50 offen
 s_waitcnt lgkmcnt(6)
 v_smfmac_f32_16x16x64_bf16 v[88:91], v[4:7], a[16:23], v151
 ds_read_b128 v[24:27], v150 offset:6144
 v_smfmac_f32_16x16x64_bf16 v[92:95], v[4:7], a[24:31], v151
 ds_read_b128 v[28:31], v150 offset:7168
 v_smfmac_f32_16x16x64_bf16 v[96:99], v[4:7], v[108:115], v151
 ds_read_b128 v[108:111], v154 offset:8192
 ds_read_b128 v[112:115], v154 offset:9216
 ds_read_b128 v[32:35], v150 offset:8192
 buffer_load_dwordx4 v[68:71], v156, s[8:11], s50 offen
 s_waitcnt lgkmcnt(10)
 v_smfmac_f32_16x16x64_bf16 v[88:91], v[8:11], a[32:39], v151
 ds_read_b128 v[36:39], v150 offset:9216
 v_smfmac_f32_16x16x64_bf16 v[92:95], v[8:11], a[40:47], v151
 v_smfmac_f32_16x16x64_bf16 v[96:99], v[8:11], a[48:55], v151
 s_mov_b64 exec, s[40:41]
 buffer_load_dwordx4 v[72:75], v167, s[8:11], s50 offen
 s_mov_b64 exec, -1
 s_add_u32 s50, s50, 40960
 s_waitcnt lgkmcnt(10)
 v_smfmac_f32_16x16x64_bf16 v[88:91], v[12:15], v[116:123], v151
 ds_read_b128 v[116:119], v154 offset:10240
 ds_read_b128 v[120:123], v154 offset:11264
 v_smfmac_f32_16x16x64_bf16 v[92:95], v[12:15], a[56:63], v151
 v_smfmac_f32_16x16x64_bf16 v[96:99], v[12:15], a[64:71], v151
 buffer_load_dwordx4 v[76:79], v155, s[8:11], s50 offen
 s_waitcnt lgkmcnt(9)
 v_smfmac_f32_16x16x64_bf16 v[88:91], v[16:19], v[100:107], v151
 ds_read_b128 v[100:103], v154 offset:12288
 ds_read_b128 v[104:107], v154 offset:13312
 s_waitcnt lgkmcnt(10)
 v_smfmac_f32_16x16x64_bf16 v[88:91], v[20:23], a[88:95], v151
 s_waitcnt lgkmcnt(9)
 v_smfmac_f32_16x16x64_bf16 v[88:91], v[24:27], a[104:111], v151
 buffer_load_dwordx4 v[80:83], v156, s[8:11], s50 offen
 s_waitcnt lgkmcnt(8)
 v_smfmac_f32_16x16x64_bf16 v[88:91], v[28:31], a[120:127], v151
 s_waitcnt lgkmcnt(5)
 v_smfmac_f32_16x16x64_bf16 v[88:91], v[32:35], v[108:115], v151
 ds_read_b128 v[108:111], v154 offset:14336
 ds_read_b128 v[112:115], v154 offset:15360
 s_waitcnt lgkmcnt(6)
 v_smfmac_f32_16x16x64_bf16 v[88:91], v[36:39], a[160:167], v151
 s_mov_b64 exec, s[40:41]
 buffer_load_dwordx4 v[84:87], v167, s[8:11], s50 offen
 s_mov_b64 exec, -1
 s_add_u32 s50, s50, 40960
 v_smfmac_f32_16x16x64_bf16 v[92:95], v[16:19], a[72:79], v151
 s_waitcnt lgkmcnt(4)
 v_smfmac_f32_16x16x64_bf16 v[92:95], v[20:23], v[116:123], v151
 ds_read_b128 v[116:119], v154 offset:16384
 ds_read_b128 v[120:123], v154 offset:17408
 v_smfmac_f32_16x16x64_bf16 v[92:95], v[24:27], a[112:119], v151
 v_smfmac_f32_16x16x64_bf16 v[92:95], v[28:31], a[128:135], v151
 v_smfmac_f32_16x16x64_bf16 v[92:95], v[32:35], a[144:151], v151
 s_waitcnt lgkmcnt(4)
 v_smfmac_f32_16x16x64_bf16 v[92:95], v[36:39], v[100:107], v151
 ds_read_b128 v[100:103], v154 offset:18432
 ds_read_b128 v[104:107], v154 offset:19456
 v_smfmac_f32_16x16x64_bf16 v[96:99], v[16:19], a[80:87], v151
 v_smfmac_f32_16x16x64_bf16 v[96:99], v[20:23], a[96:103], v151
 v_pk_add_f32 v[88:89], v[88:89], v[90:91]
 v_cvt_pk_bf16_f32 v89, v88, v89
 s_waitcnt lgkmcnt(4)
 v_smfmac_f32_16x16x64_bf16 v[96:99], v[24:27], v[108:115], v151
 ds_read_b128 v[108:111], v154 offset:20480
 ds_read_b128 v[112:115], v154 offset:21504
 ds_write_b16 v153, v89 offset:0
 ds_write_b16_d16_hi v153, v89 offset:16
 v_smfmac_f32_16x16x64_bf16 v[96:99], v[28:31], a[136:143], v151
 v_smfmac_f32_16x16x64_bf16 v[96:99], v[32:35], a[152:159], v151
 v_smfmac_f32_16x16x64_bf16 v[96:99], v[36:39], a[168:175], v151
 v_pk_mov_b32 v[0:1], 0, 0
 v_pk_mov_b32 v[2:3], 0, 0
 v_pk_add_f32 v[92:93], v[92:93], v[94:95]
 v_cvt_pk_bf16_f32 v93, v92, v93
 ds_write_b16 v153, v93 offset:256
 ds_write_b16_d16_hi v153, v93 offset:272
 v_pk_mov_b32 v[4:5], 0, 0
 v_pk_mov_b32 v[6:7], 0, 0
 v_pk_mov_b32 v[8:9], 0, 0
 v_pk_add_f32 v[96:97], v[96:97], v[98:99]
 v_cvt_pk_bf16_f32 v97, v96, v97
 ds_write_b16 v153, v97 offset:512
 ds_write_b16_d16_hi v153, v97 offset:528
 v_pk_mov_b32 v[10:11], 0, 0
 v_pk_mov_b32 v[12:13], 0, 0
 v_pk_mov_b32 v[14:15], 0, 0
 v_pk_mov_b32 v[16:17], 0, 0
 v_pk_mov_b32 v[18:19], 0, 0
 v_pk_mov_b32 v[20:21], 0, 0
 v_pk_mov_b32 v[22:23], 0, 0
 v_pk_mov_b32 v[24:25], 0, 0
 v_pk_mov_b32 v[26:27], 0, 0
 v_pk_mov_b32 v[28:29], 0, 0
 v_pk_mov_b32 v[30:31], 0, 0
 v_pk_mov_b32 v[32:33], 0, 0
 v_pk_mov_b32 v[34:35], 0, 0
 v_pk_mov_b32 v[36:37], 0, 0
 v_pk_mov_b32 v[38:39], 0, 0
 s_waitcnt lgkmcnt(0)
 s_barrier
 ds_read_b128 v[124:127], v150 offset:10240
 ds_read_b128 v[128:131], v150 offset:11264
 ds_read_b128 v[132:135], v150 offset:12288
 s_waitcnt lgkmcnt(2)
 v_smfmac_f32_16x16x64_bf16 v[0:3], v[124:127], v[116:123], v151
 ds_read_b128 v[116:119], v154 offset:22528
 ds_read_b128 v[120:123], v154 offset:23552
 s_waitcnt lgkmcnt(3)
 v_smfmac_f32_16x16x64_bf16 v[0:3], v[128:131], a[176:183], v151
 s_waitcnt lgkmcnt(2)
 v_smfmac_f32_16x16x64_bf16 v[0:3], v[132:135], a[184:191], v151
 v_smfmac_f32_16x16x64_bf16 v[4:7], v[124:127], v[100:107], v151
 ds_read_b128 v[100:103], v154 offset:24576
 ds_read_b128 v[104:107], v154 offset:25600
 v_smfmac_f32_16x16x64_bf16 v[4:7], v[128:131], a[192:199], v151
 v_smfmac_f32_16x16x64_bf16 v[4:7], v[132:135], a[200:207], v151
 v_smfmac_f32_16x16x64_bf16 v[8:11], v[124:127], a[208:215], v151
 v_smfmac_f32_16x16x64_bf16 v[8:11], v[128:131], v[108:115], v151
 ds_read_b128 v[108:111], v154 offset:26624
 ds_read_b128 v[112:115], v154 offset:27648
 v_smfmac_f32_16x16x64_bf16 v[8:11], v[132:135], a[216:223], v151
 v_smfmac_f32_16x16x64_bf16 v[12:15], v[124:127], a[224:231], v151
 s_waitcnt lgkmcnt(4)
 v_smfmac_f32_16x16x64_bf16 v[12:15], v[128:131], v[116:123], v151
 ds_read_b128 v[116:119], v154 offset:28672
 ds_read_b128 v[120:123], v154 offset:29696
 v_smfmac_f32_16x16x64_bf16 v[12:15], v[132:135], a[232:239], v151
 v_pk_add_f32 v[0:1], v[0:1], v[2:3]
 v_cvt_pk_bf16_f32 v136, v0, v1
 v_smfmac_f32_16x16x64_bf16 v[16:19], v[124:127], a[240:247], v151
 v_smfmac_f32_16x16x64_bf16 v[16:19], v[128:131], a[248:255], v151
 s_waitcnt lgkmcnt(4)
 v_smfmac_f32_16x16x64_bf16 v[16:19], v[132:135], v[100:107], v151
 ds_read_b128 v[100:103], v154 offset:30720
 ds_read_b128 v[104:107], v154 offset:31744
 v_pk_add_f32 v[4:5], v[4:5], v[6:7]
 v_cvt_pk_bf16_f32 v137, v4, v5
 v_smfmac_f32_16x16x64_bf16 v[20:23], v[124:127], v[168:175], v151
 v_smfmac_f32_16x16x64_bf16 v[20:23], v[128:131], v[176:183], v151
 s_waitcnt lgkmcnt(4)
 v_smfmac_f32_16x16x64_bf16 v[20:23], v[132:135], v[108:115], v151
 ds_read_b128 v[108:111], v154 offset:32768
 ds_read_b128 v[112:115], v154 offset:33792
 v_pk_add_f32 v[8:9], v[8:9], v[10:11]
 v_cvt_pk_bf16_f32 v138, v8, v9
 v_smfmac_f32_16x16x64_bf16 v[24:27], v[124:127], v[184:191], v151
 v_smfmac_f32_16x16x64_bf16 v[24:27], v[128:131], v[192:199], v151
 v_smfmac_f32_16x16x64_bf16 v[24:27], v[132:135], v[200:207], v151
 v_pk_add_f32 v[12:13], v[12:13], v[14:15]
 v_cvt_pk_bf16_f32 v139, v12, v13
 s_waitcnt lgkmcnt(4)
 v_smfmac_f32_16x16x64_bf16 v[28:31], v[124:127], v[116:123], v151
 v_smfmac_f32_16x16x64_bf16 v[28:31], v[128:131], v[208:215], v151
 v_permlane32_swap_b32 v136, v138
 v_permlane32_swap_b32 v137, v139
 v_smfmac_f32_16x16x64_bf16 v[28:31], v[132:135], v[216:223], v151
 v_pk_add_f32 v[16:17], v[16:17], v[18:19]
 v_cvt_pk_bf16_f32 v140, v16, v17
 s_waitcnt lgkmcnt(2)
 v_smfmac_f32_16x16x64_bf16 v[32:35], v[124:127], v[100:107], v151
 v_permlane16_swap_b32 v136, v137
 v_permlane16_swap_b32 v138, v139
 buffer_store_dwordx4 v[136:139], v157, s[8:11], s56 offen sc1
 s_add_u32 s56, s56, 4096
 v_smfmac_f32_16x16x64_bf16 v[32:35], v[128:131], v[224:231], v151
 v_smfmac_f32_16x16x64_bf16 v[32:35], v[132:135], v[232:239], v151
 v_pk_add_f32 v[20:21], v[20:21], v[22:23]
 v_cvt_pk_bf16_f32 v141, v20, v21
 v_smfmac_f32_16x16x64_bf16 v[36:39], v[124:127], v[240:247], v151
 s_waitcnt lgkmcnt(0)
 v_smfmac_f32_16x16x64_bf16 v[36:39], v[128:131], v[108:115], v151
 v_smfmac_f32_16x16x64_bf16 v[36:39], v[132:135], v[248:255], v151
 v_pk_add_f32 v[24:25], v[24:25], v[26:27]
 v_cvt_pk_bf16_f32 v142, v24, v25
 v_pk_add_f32 v[28:29], v[28:29], v[30:31]
 v_cvt_pk_bf16_f32 v143, v28, v29
 s_nop 0
 v_pk_add_f32 v[32:33], v[32:33], v[34:35]
 v_cvt_pk_bf16_f32 v144, v32, v33
 v_permlane32_swap_b32 v140, v142
 v_permlane32_swap_b32 v141, v143
 v_pk_add_f32 v[36:37], v[36:37], v[38:39]
 v_cvt_pk_bf16_f32 v145, v36, v37
 v_permlane16_swap_b32 v140, v141
 v_permlane16_swap_b32 v142, v143
 buffer_store_dwordx4 v[140:143], v157, s[8:11], s56 offen sc1
 s_add_u32 s56, s56, 4096
 v_permlane32_swap_b32 v144, v146
 v_permlane32_swap_b32 v145, v147
 s_nop 1
 v_permlane16_swap_b32 v144, v145
 v_permlane16_swap_b32 v146, v147
 s_mov_b32 exec_hi, 0
 buffer_store_dwordx4 v[144:147], v157, s[8:11], s56 offen sc1
 s_mov_b32 exec_hi, -1
 s_cmp_eq_u32 s16, 63
 s_cbranch_scc1 last_94
 s_waitcnt vmcnt(0)
pu_95:
 buffer_load_dwordx4 v[124:127], v158, s[8:11], s55 offen sc1
 buffer_load_dwordx4 v[128:131], v158, s[8:11], s55 offen offset:256 sc1
 buffer_load_dwordx4 v[132:135], v159, s[8:11], s55 offen sc1
 buffer_load_dwordx4 v[0:3], v160, s[8:11], s57 offen offset:0 sc1
 buffer_load_dwordx4 v[8:11], v160, s[8:11], s57 offen offset:1280 sc1
 buffer_load_dwordx4 v[16:19], v161, s[8:11], s57 offen sc1
 s_waitcnt vmcnt(3)
 v_max3_u32 v100, v124, v128, v132
 v_cmp_eq_u32 vcc, -1, v100
 s_cbranch_vccz ok_98
 s_sub_u32 s45, s45, 1
 s_cbranch_scc0 pu_95
 s_mov_b32 s45, 0
ok_98:
 s_branch pc_97
pp_96:
 buffer_load_dwordx4 v[0:3], v160, s[8:11], s57 offen offset:0 sc1
 buffer_load_dwordx4 v[8:11], v160, s[8:11], s57 offen offset:1280 sc1
 buffer_load_dwordx4 v[16:19], v161, s[8:11], s57 offen sc1
pc_97:
 s_waitcnt vmcnt(0)
 v_max3_u32 v20, v0, v8, v16
 v_cmp_eq_u32 vcc, -1, v20
 v_mfma_f32_16x16x32_bf16 v[88:91], v[40:43], v[0:3], 0
 v_mov_b32_dpp v4, v0 row_ror:8 row_mask:0xf bank_mask:0xf
 v_mov_b32_dpp v5, v1 row_ror:8 row_mask:0xf bank_mask:0xf
 v_mov_b32_dpp v6, v2 row_ror:8 row_mask:0xf bank_mask:0xf
 v_mov_b32_dpp v7, v3 row_ror:8 row_mask:0xf bank_mask:0xf
 s_cbranch_vccz ok_99
 s_sub_u32 s45, s45, 1
 s_cbranch_scc0 pp_96
 s_mov_b32 s45, 0
ok_99:
 v_mfma_f32_16x16x32_bf16 v[92:95], v[44:47], v[0:3], 0
 v_mfma_f32_16x16x32_bf16 v[96:99], v[48:51], v[0:3], 0
 v_mfma_f32_16x16x32_bf16 v[88:91], v[52:55], v[4:7], v[88:91]
 v_mfma_f32_16x16x32_bf16 v[92:95], v[56:59], v[4:7], v[92:95]
 v_mfma_f32_16x16x32_bf16 v[96:99], v[60:63], v[4:7], v[96:99]
 v_mfma_f32_16x16x32_bf16 v[88:91], v[64:67], v[8:11], v[88:91]
 v_mov_b32_dpp v12, v8 row_ror:8 row_mask:0xf bank_mask:0xf
 v_mov_b32_dpp v13, v9 row_ror:8 row_mask:0xf bank_mask:0xf
 v_mov_b32_dpp v14, v10 row_ror:8 row_mask:0xf bank_mask:0xf
 v_mov_b32_dpp v15, v11 row_ror:8 row_mask:0xf bank_mask:0xf
 v_mfma_f32_16x16x32_bf16 v[92:95], v[68:71], v[8:11], v[92:95]
 v_mfma_f32_16x16x32_bf16 v[96:99], v[72:75], v[8:11], v[96:99]
 v_mfma_f32_16x16x32_bf16 v[88:91], v[76:79], v[12:15], v[88:91]
 v_mfma_f32_16x16x32_bf16 v[92:95], v[80:83], v[12:15], v[92:95]
 v_mfma_f32_16x16x32_bf16 v[96:99], v[84:87], v[12:15], v[96:99]
 v_mfma_f32_16x16x32_bf16 v[88:91], v[124:127], v[16:19], v[88:91]
 v_mfma_f32_16x16x32_bf16 v[92:95], v[128:131], v[16:19], v[92:95]
 v_mfma_f32_16x16x32_bf16 v[96:99], v[132:135], v[16:19], v[96:99]
 s_nop 6
 v_mov_b32_dpp v88, v92 row_ror:8 row_mask:0xf bank_mask:0xc
 v_mov_b32_dpp v89, v93 row_ror:8 row_mask:0xf bank_mask:0xc
 v_mov_b32_dpp v90, v94 row_ror:8 row_mask:0xf bank_mask:0xc
 v_mov_b32_dpp v91, v95 row_ror:8 row_mask:0xf bank_mask:0xc
 ds_write_b128 v162, v[88:91]
 s_mov_b64 exec, s[40:41]
 ds_write_b128 v162, v[96:99] offset:1024
 s_mov_b64 exec, -1
 s_waitcnt vmcnt(0) lgkmcnt(0)
 s_barrier
 s_cmp_ge_u32 s14, 2
 s_cbranch_scc1 nx_100
 ds_read_b128 v[0:3], v166 offset:0
 ds_read_b128 v[4:7], v166 offset:1536
 ds_read_b128 v[8:11], v166 offset:3072
 ds_read_b128 v[12:15], v166 offset:4608
 s_waitcnt lgkmcnt(2)
 v_pk_add_f32 v[0:1], v[0:1], v[4:5]
 v_pk_add_f32 v[2:3], v[2:3], v[6:7]
 s_waitcnt lgkmcnt(0)
 v_pk_add_f32 v[8:9], v[8:9], v[12:13]
 v_pk_add_f32 v[10:11], v[10:11], v[14:15]
 v_pk_add_f32 v[0:1], v[0:1], v[8:9]
 v_pk_add_f32 v[2:3], v[2:3], v[10:11]
 s_mov_b64 exec, s[6:7]
 v_cvt_pk_bf16_f32 v4, v0, v1
 v_cvt_pk_bf16_f32 v5, v2, v3
 buffer_store_dwordx2 v[4:5], v165, s[8:11], 0 offen sc1
 buffer_store_dwordx2 v[4:5], v163, s[8:11], s52 offen sc1
 s_mov_b64 exec, -1
nx_100:
 s_add_u32 s16, s16, 1
 s_branch Vstep_85
last_94:
 s_add_u32 s46, s13, 16
 s_endpgm
.section .rodata,"a"
.p2align 6
.amdhsa_kernel parallel_sum__memory_aug_recurrent_mem_tr__glu_gated_glu__prompt_kernel
  .amdhsa_next_free_vgpr 512
  .amdhsa_next_free_sgpr 102
  .amdhsa_accum_offset 256
  .amdhsa_group_segment_fixed_size 0
  .amdhsa_kernarg_size 112
  .amdhsa_user_sgpr_count 2
  .amdhsa_user_sgpr_kernarg_segment_ptr 1
  .amdhsa_system_sgpr_workgroup_id_x 1
  .amdhsa_float_denorm_mode_32 3
.end_amdhsa_kernel
```
